```python
import torch

def _softmax(x, axis=-1):
    return torch.softmax(x, dim=axis)
def _gelu(x):
    return torch.nn.functional.gelu(x, approximate="tanh")
def _silu(x):
    return torch.nn.functional.silu(x)
def _sigmoid(x):
    return torch.sigmoid(x)
def _layernorm(x, axis=-1, eps=1e-5):
    m = x.mean(dim=axis, keepdim=True)
    v = x.var(dim=axis, keepdim=True, unbiased=False)
    return (x - m) / torch.sqrt(v + eps)
def _scatter_add(tgt, idx, src, axis=0):
    return tgt.clone().index_add_(axis, idx, src)
def _segment_sum(src, seg, n):
    out = torch.zeros((n,) + src.shape[1:], dtype=src.dtype)
    return out.index_add_(0, seg, src)
def _pad(x, pw):
    flat = tuple(v for pair in reversed(pw) for v in pair)
    return torch.nn.functional.pad(x, flat)

kernel_name = 'recurrent_scan__mha_block_cached__moe_arch_mod__prompt'

def setup_inputs():

    _w = (lambda a: (lambda t: t.to(torch.bfloat16) if t.is_floating_point() else t)(torch.as_tensor(a)))
    def _A_setup():
        B, Sq, D = 1, 2048, 640
        H, Sk, Dh = 32, 2048, 128
        return {
            "x": _w((lambda *s: torch.randn(*s, dtype=torch.bfloat16) * 0.05)(B, Sq, D)),
            "k_cache": _w((lambda *s: torch.randn(*s, dtype=torch.bfloat16) * 1.6)(B, H, Sk, Dh)),
            "v_cache": _w((lambda *s: torch.randn(*s, dtype=torch.bfloat16) * 0.2)(B, H, Sk, Dh)),
            "wq": _w((lambda *s: torch.randn(*s, dtype=torch.bfloat16) * 1.6)(D, H * Dh) * (D ** -0.5)),
            "wo": _w((lambda *s: torch.randn(*s, dtype=torch.bfloat16) * 0.2)(H * Dh, D) * ((H * Dh) ** -0.5)),
        }
    _A_in = _A_setup()

    def _B_setup():
        B, S, D, F, C = 1, 2048, 640, 1728, 8
        return {
            "x": _w((lambda *s: torch.randn(*s, dtype=torch.bfloat16) * 0.05)(B, S, D)),
            "w_r": _w((lambda *s: torch.randn(*s, dtype=torch.bfloat16) * 0.2)(D)),
            "w_gate": _w((lambda *s: torch.randn(*s, dtype=torch.bfloat16) * 0.1)(D, F)),
            "w_up": _w((lambda *s: torch.randn(*s, dtype=torch.bfloat16) * 0.1)(D, F)),
            "w_down": _w((lambda *s: torch.randn(*s, dtype=torch.bfloat16) * 0.1)(F, D)),
        }
    _B_in = _B_setup()

    return {
        "A_x": _A_in["x"],
        "A_k_cache": _A_in["k_cache"],
        "A_v_cache": _A_in["v_cache"],
        "A_wq": _A_in["wq"],
        "A_wo": _A_in["wo"],
        "B_x": _B_in["x"],
        "B_w_r": _B_in["w_r"],
        "B_w_gate": _B_in["w_gate"],
        "B_w_up": _B_in["w_up"],
        "B_w_down": _B_in["w_down"],
    }

def reference(A_x, A_k_cache, A_v_cache, A_wq, A_wo, B_x, B_w_r, B_w_gate, B_w_up, B_w_down):
    def _A_ref(x, k_cache, v_cache, wq, wo):
        B, Sq, D = x.shape
        H, Dh = 32, 128
        q = (lambda x, *d: x.permute(*d))((x @ wq).reshape(B, Sq, H, Dh), 0, 2, 1, 3)
        scores = torch.einsum("bhqd,bhkd->bhqk", q, k_cache) * (Dh ** -0.5)
        p = _softmax(scores, axis=-1)
        o = torch.einsum("bhqk,bhkd->bhqd", p, v_cache)
        return (lambda x, *d: x.permute(*d))(o, 0, 2, 1, 3).reshape(B, Sq, H * Dh) @ wo

    def _B_ref(x, w_r, w_gate, w_up, w_down):
        B, S, D = x.shape
        C = 8
        r = x @ w_r
        idx = torch.argsort(-r, axis=-1)[:, :C]
        idx_e = (lambda x, n, axis: torch.repeat_interleave(x, n, dim=axis))(idx.reshape(B, C, 1), D, axis=2)
        x_sel = (lambda x, i, axis: torch.take_along_dim(x, i, dim=axis))(x, idx_e, axis=1)
        g = _silu(x_sel @ w_gate)
        u = x_sel @ w_up
        y = (g * u) @ w_down
        r_sel = _sigmoid((lambda x, i, axis: torch.take_along_dim(x, i, dim=axis))(r, idx, axis=1))
        y = y * r_sel.reshape(B, C, 1)
        b_off = (torch.arange(B) * S).reshape(B, 1)
        flat_idx = (idx + b_off).reshape(B * C)
        zero = (x * 0.0).reshape(B * S, D)
        upd = _scatter_add(zero, flat_idx, y.reshape(B * C, D), axis=0)
        return x + upd.reshape(B, S, D)

    x = A_x
    xn = _layernorm(x, axis=-1)
    s = _A_ref(xn, A_k_cache, A_v_cache, A_wq, A_wo)
    g = _silu(_B_ref(xn, B_w_r, B_w_gate, B_w_up, B_w_down))
    return x + s * g
```

```asm
; @launch kernel=ln_kernel grid=(256,1,1) block=(256,1,1) lds=20480
; @launch kernel=attn_kernel grid=(256,1,1) block=(256,1,1) lds=163840
; @launch kernel=ffn_kernel grid=(216,1,1) block=(256,1,1) lds=40960
; @launch kernel=oproj_kernel grid=(256,1,1) block=(256,1,1) lds=65536
.amdgcn_target "amdgcn-amd-amdhsa--gfx950"
.text
.p2align 8
.type ln_kernel,@function
ln_kernel:
    s_cmp_ge_u32 s2, 256
    s_cbranch_scc1 L_ln_end
    s_load_dwordx2 s[40:41], s[0:1], 0
    s_load_dwordx2 s[42:43], s[0:1], 32
    s_load_dwordx2 s[44:45], s[0:1], 48
    s_load_dwordx2 s[46:47], s[0:1], 96
    v_lshrrev_b32 v2, 6, v0
    v_and_b32 v1, 63, v0
    s_lshl_b32 s6, s2, 3
    v_readfirstlane_b32 s5, v2
    s_nop 0
    s_lshl_b32 s7, s5, 1
    s_add_u32 s6, s6, s7
    s_waitcnt lgkmcnt(0)
    s_mov_b32 s8, s40
    s_mov_b32 s9, s41
    s_mov_b32 s10, 0x280000
    s_mov_b32 s11, 0x20000
    s_mov_b32 s12, s44
    s_mov_b32 s13, s45
    s_mov_b32 s14, 0x500
    s_mov_b32 s15, 0x20000
    s_mov_b32 s16, s46
    s_mov_b32 s17, s47
    s_mov_b32 s18, 0x2000000
    s_mov_b32 s19, 0x20000
    s_mov_b32 s20, s42
    s_mov_b32 s21, s43
    s_mov_b32 s22, 0x500000
    s_mov_b32 s23, 0x20000
    v_lshrrev_b32 v44, 5, v1
    v_add_u32 v44, s6, v44
    v_and_b32 v46, 31, v1
    v_lshlrev_b32 v46, 3, v46
    v_mul_u32_u24 v45, 1280, v44
    v_add_u32 v45, v45, v46
    buffer_load_dwordx2 v[4:5], v45, s[8:11], 0 offen offset:0
    buffer_load_dwordx2 v[6:7], v45, s[8:11], 0 offen offset:256
    buffer_load_dwordx2 v[8:9], v45, s[8:11], 0 offen offset:512
    buffer_load_dwordx2 v[10:11], v45, s[8:11], 0 offen offset:768
    buffer_load_dwordx2 v[12:13], v45, s[8:11], 0 offen offset:1024
    buffer_load_dwordx2 v[14:15], v46, s[12:15], 0 offen offset:0
    buffer_load_dwordx2 v[16:17], v46, s[12:15], 0 offen offset:256
    buffer_load_dwordx2 v[18:19], v46, s[12:15], 0 offen offset:512
    buffer_load_dwordx2 v[20:21], v46, s[12:15], 0 offen offset:768
    buffer_load_dwordx2 v[22:23], v46, s[12:15], 0 offen offset:1024
    s_lshr_b32 s24, s2, 1
    s_and_b32 s25, s2, 1
    s_lshl_b32 s25, s25, 2
    s_add_u32 s25, s25, s5
    s_mul_i32 s26, s5, 5120
    s_mov_b32 s27, 4096
    s_mul_i32 s28, s24, 40960
    s_mul_i32 s29, s25, 160
    s_add_u32 s28, s28, s29
    v_add_u32 v57, 0, v1
    v_mul_u32_u24 v58, 6554, v57
    v_lshrrev_b32 v58, 16, v58
    v_mul_u32_u24 v52, 1120, v58
    v_lshl_add_u32 v52, v57, 4, v52
    v_add_u32 v52, s28, v52
    v_add_u32 v57, 64, v1
    v_mul_u32_u24 v58, 6554, v57
    v_lshrrev_b32 v58, 16, v58
    v_mul_u32_u24 v53, 1120, v58
    v_lshl_add_u32 v53, v57, 4, v53
    v_add_u32 v53, s28, v53
    v_add_u32 v57, 128, v1
    v_mul_u32_u24 v58, 6554, v57
    v_lshrrev_b32 v58, 16, v58
    v_mul_u32_u24 v54, 1120, v58
    v_lshl_add_u32 v54, v57, 4, v54
    v_add_u32 v54, s28, v54
    v_add_u32 v57, 192, v1
    v_mul_u32_u24 v58, 6554, v57
    v_lshrrev_b32 v58, 16, v58
    v_mul_u32_u24 v55, 1120, v58
    v_lshl_add_u32 v55, v57, 4, v55
    v_add_u32 v55, s28, v55
    v_add_u32 v57, 256, v1
    v_mul_u32_u24 v58, 6554, v57
    v_lshrrev_b32 v58, 16, v58
    v_mul_u32_u24 v56, 1120, v58
    v_lshl_add_u32 v56, v57, 4, v56
    v_add_u32 v56, s28, v56
    v_lshrrev_b32 v57, 2, v1
    v_mul_u32_u24 v57, 160, v57
    v_and_b32 v58, 3, v1
    v_lshl_add_u32 v57, v58, 3, v57
    v_add_u32 v57, s26, v57
    s_lshl_b32 s28, s25, 7
    s_add_u32 s28, s28, s24
    s_mul_i32 s28, s28, 5120
    s_add_u32 s28, s28, 0x1400000
    v_lshlrev_b32 v58, 4, v1
    v_add_u32 v58, s28, v58
    s_add_u32 m0, s26, 0
    s_nop 0
    buffer_load_dwordx4 v52, s[20:23], 0 offen lds
    s_add_u32 m0, s26, 1024
    s_nop 0
    buffer_load_dwordx4 v53, s[20:23], 0 offen lds
    s_add_u32 m0, s26, 2048
    s_nop 0
    buffer_load_dwordx4 v54, s[20:23], 0 offen lds
    s_add_u32 m0, s26, 3072
    s_nop 0
    buffer_load_dwordx4 v55, s[20:23], 0 offen lds
    s_add_u32 m0, s26, 4096
    s_nop 0
    buffer_load_dwordx4 v56, s[20:23], 0 offen lds
    s_waitcnt vmcnt(5)
    v_lshlrev_b32 v24, 16, v4
    v_and_b32 v25, 0xffff0000, v4
    v_lshlrev_b32 v26, 16, v5
    v_and_b32 v27, 0xffff0000, v5
    v_lshlrev_b32 v28, 16, v6
    v_and_b32 v29, 0xffff0000, v6
    v_lshlrev_b32 v30, 16, v7
    v_and_b32 v31, 0xffff0000, v7
    v_lshlrev_b32 v32, 16, v8
    v_and_b32 v33, 0xffff0000, v8
    v_lshlrev_b32 v34, 16, v9
    v_and_b32 v35, 0xffff0000, v9
    v_lshlrev_b32 v36, 16, v10
    v_and_b32 v37, 0xffff0000, v10
    v_lshlrev_b32 v38, 16, v11
    v_and_b32 v39, 0xffff0000, v11
    v_lshlrev_b32 v40, 16, v12
    v_and_b32 v41, 0xffff0000, v12
    v_lshlrev_b32 v42, 16, v13
    v_and_b32 v43, 0xffff0000, v13
    v_add_f32 v45, v24, v25
    v_add_f32 v46, v26, v27
    v_add_f32 v45, v45, v28
    v_add_f32 v46, v46, v29
    v_add_f32 v45, v45, v30
    v_add_f32 v46, v46, v31
    v_add_f32 v45, v45, v32
    v_add_f32 v46, v46, v33
    v_add_f32 v45, v45, v34
    v_add_f32 v46, v46, v35
    v_add_f32 v45, v45, v36
    v_add_f32 v46, v46, v37
    v_add_f32 v45, v45, v38
    v_add_f32 v46, v46, v39
    v_add_f32 v45, v45, v40
    v_add_f32 v46, v46, v41
    v_add_f32 v45, v45, v42
    v_add_f32 v46, v46, v43
    v_add_f32 v45, v45, v46
    s_nop 1
    v_add_f32_dpp v45, v45, v45 quad_perm:[1,0,3,2] row_mask:0xf bank_mask:0xf
    s_nop 1
    v_add_f32_dpp v45, v45, v45 quad_perm:[2,3,0,1] row_mask:0xf bank_mask:0xf
    s_nop 1
    v_add_f32_dpp v45, v45, v45 row_half_mirror row_mask:0xf bank_mask:0xf
    s_nop 1
    v_add_f32_dpp v45, v45, v45 row_mirror row_mask:0xf bank_mask:0xf
    v_mov_b32 v46, v45
    s_nop 1
    v_permlane16_swap_b32 v45, v46
    v_add_f32 v45, v45, v46
    v_mul_f32 v47, 0x3acccccd, v45
    v_sub_f32 v4, v24, v47
    v_mul_f32 v45, v4, v4
    v_sub_f32 v5, v25, v47
    v_mul_f32 v48, v5, v5
    v_sub_f32 v4, v26, v47
    v_fmac_f32 v45, v4, v4
    v_sub_f32 v5, v27, v47
    v_fmac_f32 v48, v5, v5
    v_sub_f32 v4, v28, v47
    v_fmac_f32 v45, v4, v4
    v_sub_f32 v5, v29, v47
    v_fmac_f32 v48, v5, v5
    v_sub_f32 v4, v30, v47
    v_fmac_f32 v45, v4, v4
    v_sub_f32 v5, v31, v47
    v_fmac_f32 v48, v5, v5
    v_sub_f32 v4, v32, v47
    v_fmac_f32 v45, v4, v4
    v_sub_f32 v5, v33, v47
    v_fmac_f32 v48, v5, v5
    v_sub_f32 v4, v34, v47
    v_fmac_f32 v45, v4, v4
    v_sub_f32 v5, v35, v47
    v_fmac_f32 v48, v5, v5
    v_sub_f32 v4, v36, v47
    v_fmac_f32 v45, v4, v4
    v_sub_f32 v5, v37, v47
    v_fmac_f32 v48, v5, v5
    v_sub_f32 v4, v38, v47
    v_fmac_f32 v45, v4, v4
    v_sub_f32 v5, v39, v47
    v_fmac_f32 v48, v5, v5
    v_sub_f32 v4, v40, v47
    v_fmac_f32 v45, v4, v4
    v_sub_f32 v5, v41, v47
    v_fmac_f32 v48, v5, v5
    v_sub_f32 v4, v42, v47
    v_fmac_f32 v45, v4, v4
    v_sub_f32 v5, v43, v47
    v_fmac_f32 v48, v5, v5
    v_add_f32 v45, v45, v48
    s_nop 1
    v_add_f32_dpp v45, v45, v45 quad_perm:[1,0,3,2] row_mask:0xf bank_mask:0xf
    s_nop 1
    v_add_f32_dpp v45, v45, v45 quad_perm:[2,3,0,1] row_mask:0xf bank_mask:0xf
    s_nop 1
    v_add_f32_dpp v45, v45, v45 row_half_mirror row_mask:0xf bank_mask:0xf
    s_nop 1
    v_add_f32_dpp v45, v45, v45 row_mirror row_mask:0xf bank_mask:0xf
    v_mov_b32 v46, v45
    s_nop 1
    v_permlane16_swap_b32 v45, v46
    v_add_f32 v45, v45, v46
    v_mul_f32 v45, 0x3acccccd, v45
    v_cvt_pk_bf16_f32 v46, v47, v45
    v_lshlrev_b32 v47, 16, v46
    v_and_b32 v45, 0xffff0000, v46
    v_add_f32 v45, 0x3727c5ac, v45
    v_cvt_pk_bf16_f32 v45, v45, v45
    v_lshlrev_b32 v45, 16, v45
    v_sqrt_f32 v45, v45
    v_sub_f32 v24, v24, v47
    v_sub_f32 v25, v25, v47
    v_sub_f32 v26, v26, v47
    v_sub_f32 v27, v27, v47
    v_sub_f32 v28, v28, v47
    v_sub_f32 v29, v29, v47
    v_sub_f32 v30, v30, v47
    v_sub_f32 v31, v31, v47
    v_sub_f32 v32, v32, v47
    v_sub_f32 v33, v33, v47
    v_sub_f32 v34, v34, v47
    v_sub_f32 v35, v35, v47
    v_sub_f32 v36, v36, v47
    v_sub_f32 v37, v37, v47
    v_sub_f32 v38, v38, v47
    v_sub_f32 v39, v39, v47
    v_sub_f32 v40, v40, v47
    v_sub_f32 v41, v41, v47
    v_sub_f32 v42, v42, v47
    v_sub_f32 v43, v43, v47
    v_cvt_pk_bf16_f32 v45, v45, v45
    v_lshlrev_b32 v45, 16, v45
    v_rcp_f32 v48, v45
    v_cvt_pk_bf16_f32 v4, v24, v25
    v_cvt_pk_bf16_f32 v5, v26, v27
    v_cvt_pk_bf16_f32 v6, v28, v29
    v_cvt_pk_bf16_f32 v7, v30, v31
    v_cvt_pk_bf16_f32 v8, v32, v33
    v_cvt_pk_bf16_f32 v9, v34, v35
    v_cvt_pk_bf16_f32 v10, v36, v37
    v_cvt_pk_bf16_f32 v11, v38, v39
    v_cvt_pk_bf16_f32 v12, v40, v41
    v_cvt_pk_bf16_f32 v13, v42, v43
    v_lshlrev_b32 v24, 16, v4
    v_and_b32 v25, 0xffff0000, v4
    v_lshlrev_b32 v26, 16, v5
    v_and_b32 v27, 0xffff0000, v5
    v_lshlrev_b32 v28, 16, v6
    v_and_b32 v29, 0xffff0000, v6
    v_lshlrev_b32 v30, 16, v7
    v_and_b32 v31, 0xffff0000, v7
    v_lshlrev_b32 v32, 16, v8
    v_and_b32 v33, 0xffff0000, v8
    v_lshlrev_b32 v34, 16, v9
    v_and_b32 v35, 0xffff0000, v9
    v_lshlrev_b32 v36, 16, v10
    v_and_b32 v37, 0xffff0000, v10
    v_lshlrev_b32 v38, 16, v11
    v_and_b32 v39, 0xffff0000, v11
    v_lshlrev_b32 v40, 16, v12
    v_and_b32 v41, 0xffff0000, v12
    v_lshlrev_b32 v42, 16, v13
    v_and_b32 v43, 0xffff0000, v13
    v_mul_f32 v24, v24, v48
    v_mul_f32 v25, v25, v48
    v_mul_f32 v26, v26, v48
    v_mul_f32 v27, v27, v48
    v_mul_f32 v28, v28, v48
    v_mul_f32 v29, v29, v48
    v_mul_f32 v30, v30, v48
    v_mul_f32 v31, v31, v48
    v_mul_f32 v32, v32, v48
    v_mul_f32 v33, v33, v48
    v_mul_f32 v34, v34, v48
    v_mul_f32 v35, v35, v48
    v_mul_f32 v36, v36, v48
    v_mul_f32 v37, v37, v48
    v_mul_f32 v38, v38, v48
    v_mul_f32 v39, v39, v48
    v_mul_f32 v40, v40, v48
    v_mul_f32 v41, v41, v48
    v_mul_f32 v42, v42, v48
    v_mul_f32 v43, v43, v48
    v_cvt_pk_bf16_f32 v4, v24, v25
    v_cvt_pk_bf16_f32 v5, v26, v27
    v_cvt_pk_bf16_f32 v6, v28, v29
    v_cvt_pk_bf16_f32 v7, v30, v31
    v_cvt_pk_bf16_f32 v8, v32, v33
    v_cvt_pk_bf16_f32 v9, v34, v35
    v_cvt_pk_bf16_f32 v10, v36, v37
    v_cvt_pk_bf16_f32 v11, v38, v39
    v_cvt_pk_bf16_f32 v12, v40, v41
    v_cvt_pk_bf16_f32 v13, v42, v43
    v_mov_b32 v45, 0
    v_dot2c_f32_bf16 v45, v4, v14
    v_dot2c_f32_bf16 v45, v5, v15
    v_dot2c_f32_bf16 v45, v6, v16
    v_dot2c_f32_bf16 v45, v7, v17
    v_dot2c_f32_bf16 v45, v8, v18
    v_dot2c_f32_bf16 v45, v9, v19
    v_dot2c_f32_bf16 v45, v10, v20
    v_dot2c_f32_bf16 v45, v11, v21
    v_dot2c_f32_bf16 v45, v12, v22
    v_dot2c_f32_bf16 v45, v13, v23
    s_nop 2
    s_nop 1
    v_add_f32_dpp v45, v45, v45 quad_perm:[1,0,3,2] row_mask:0xf bank_mask:0xf
    s_nop 1
    v_add_f32_dpp v45, v45, v45 quad_perm:[2,3,0,1] row_mask:0xf bank_mask:0xf
    s_nop 1
    v_add_f32_dpp v45, v45, v45 row_half_mirror row_mask:0xf bank_mask:0xf
    s_nop 1
    v_add_f32_dpp v45, v45, v45 row_mirror row_mask:0xf bank_mask:0xf
    v_mov_b32 v46, v45
    s_nop 1
    v_permlane16_swap_b32 v45, v46
    v_add_f32 v45, v45, v46
    v_cvt_pk_bf16_f32 v45, v45, v45
    v_lshlrev_b32 v45, 16, v45
    v_ashrrev_i32 v46, 31, v45
    v_or_b32 v46, 0x80000000, v46
    v_xor_b32 v45, v45, v46
    v_and_b32 v45, 0xffff0000, v45
    v_sub_u32 v46, 0xffff, v44
    v_or_b32 v45, v45, v46
    v_mov_b32 v4, v47
    v_mov_b32 v5, v48
    v_lshlrev_b32 v46, 3, v44
    v_lshlrev_b32 v44, 2, v44
    s_mov_b32 s28, 0x280000
    s_mov_b32 s29, 0x288000
    s_mov_b32 exec_lo, 1
    s_mov_b32 exec_hi, 1
    buffer_store_dwordx2 v[4:5], v46, s[16:19], s28 offen
    buffer_store_dword v45, v44, s[16:19], s29 offen
    s_mov_b64 exec, -1
    s_waitcnt vmcnt(2)
    ds_read_b64_tr_b16 v[60:61], v57 offset:0
    ds_read_b64_tr_b16 v[62:63], v57 offset:2560
    ds_read_b64_tr_b16 v[64:65], v57 offset:32
    ds_read_b64_tr_b16 v[66:67], v57 offset:2592
    ds_read_b64_tr_b16 v[68:69], v57 offset:64
    ds_read_b64_tr_b16 v[70:71], v57 offset:2624
    ds_read_b64_tr_b16 v[72:73], v57 offset:96
    ds_read_b64_tr_b16 v[74:75], v57 offset:2656
    ds_read_b64_tr_b16 v[76:77], v57 offset:128
    ds_read_b64_tr_b16 v[78:79], v57 offset:2688
    s_waitcnt lgkmcnt(0)
    buffer_store_dwordx4 v[60:63], v58, s[16:19], 0 offen offset:0
    buffer_store_dwordx4 v[64:67], v58, s[16:19], 0 offen offset:1024
    buffer_store_dwordx4 v[68:71], v58, s[16:19], 0 offen offset:2048
    buffer_store_dwordx4 v[72:75], v58, s[16:19], 0 offen offset:3072
    buffer_store_dwordx4 v[76:79], v58, s[16:19], s27 offen offset:0
L_ln_end:
    s_endpgm

.p2align 8
.type attn_kernel,@function
attn_kernel:
    s_cmp_ge_u32 s2, 256
    s_cbranch_scc1 L_attn_end
    s_load_dwordx8 s[48:55], s[0:1], 0
    s_load_dwordx2 s[56:57], s[0:1], 96
    v_lshrrev_b32 v24, 6, v0
    v_and_b32 v19, 63, v0
    s_and_b32 s40, s2, 7
    v_readfirstlane_b32 s5, v24
    s_lshl_b32 s40, s40, 2
    s_lshr_b32 s41, s2, 3
    s_and_b32 s41, s41, 3
    s_add_u32 s3, s40, s41
    s_lshr_b32 s4, s2, 5
    v_lshrrev_b32 v26, 4, v19
    v_and_b32 v25, 15, v19
    v_lshlrev_b32 v27, 1, v26
    v_xor_b32 v27, v25, v27
    s_lshl_b32 s42, s5, 4
    v_add_u32 v28, s42, v26
    v_lshlrev_b32 v29, 4, v27
    v_xor_b32 v30, 0x80, v29
    v_lshl_add_u32 v31, v28, 13, v29
    v_lshl_add_u32 v32, v28, 13, v30
    v_add_u32 v44, 0, v31
    v_add_u32 v45, 31744, v31
    v_add_u32 v46, 63488, v32
    v_add_u32 v47, 95232, v32
    v_lshl_add_u32 v17, v28, 8, v29
    v_lshl_add_u32 v18, v28, 8, v30
    v_xor_b32 v25, v25, v26
    v_xor_b32 v29, 0, v25
    v_lshlrev_b32 v29, 4, v29
    v_lshl_add_u32 v13, v28, 8, v29
    v_xor_b32 v29, 4, v25
    v_lshlrev_b32 v29, 4, v29
    v_lshl_add_u32 v14, v28, 8, v29
    v_xor_b32 v29, 8, v25
    v_lshlrev_b32 v29, 4, v29
    v_lshl_add_u32 v15, v28, 8, v29
    v_xor_b32 v29, 12, v25
    v_lshlrev_b32 v29, 4, v29
    v_lshl_add_u32 v16, v28, 8, v29
    v_lshrrev_b32 v24, 3, v19
    v_and_b32 v25, 7, v19
    v_xor_b32 v25, v25, v26
    v_mul_u32_u24 v24, 1280, v24
    s_mul_i32 s42, s5, 81920
    v_lshl_add_u32 v27, v25, 4, v24
    v_xor_b32 v25, 4, v25
    v_lshl_add_u32 v28, v25, 4, v24
    v_add_u32 v27, s42, v27
    v_add_u32 v28, s42, v28
    v_add_u32 v36, 0, v27
    v_add_u32 v37, 9216, v28
    v_add_u32 v38, 18432, v27
    v_add_u32 v39, 27648, v28
    v_add_u32 v40, 40960, v27
    v_add_u32 v41, 50176, v28
    v_add_u32 v42, 59392, v27
    v_add_u32 v43, 68608, v28
    s_waitcnt lgkmcnt(0)
    s_lshl_b32 s40, s3, 8
    s_add_u32 s20, s54, s40
    s_addc_u32 s21, s55, 0
    s_mov_b32 s22, 0x4fe100
    s_mov_b32 s23, 0x20000
    s_mul_i32 s40, s4, 327680
    s_add_u32 s16, s48, s40
    s_addc_u32 s17, s49, 0
    s_mov_b32 s18, 0x50000
    s_mov_b32 s19, 0x20000
    s_lshl_b32 s40, s3, 19
    s_add_u32 s8, s50, s40
    s_addc_u32 s9, s51, 0
    s_mov_b32 s10, 0x80000
    s_mov_b32 s11, 0x20000
    s_add_u32 s12, s52, s40
    s_addc_u32 s13, s53, 0
    s_mov_b32 s14, 0x80000
    s_mov_b32 s15, 0x20000
    s_mul_i32 s38, s5, 24576
    s_lshl_b32 s40, s5, 12
    s_add_u32 s39, s40, 98304
    s_mov_b32 s34, s39
    s_mov_b32 s28, 0
    s_mov_b32 s29, 0
    s_add_u32 m0, s39, 0
    s_mov_b32 s37, 0
    buffer_load_dwordx4 v44, s[20:23], s37 offen offset:0 lds
    buffer_load_dwordx4 v45, s[20:23], s37 offen offset:1024 lds
    buffer_load_dwordx4 v46, s[20:23], s37 offen offset:2048 lds
    buffer_load_dwordx4 v47, s[20:23], s37 offen offset:3072 lds
    s_add_u32 m0, s38, 0
    s_mov_b32 s36, 0
    buffer_load_dwordx4 v36, s[16:19], s36 offen offset:0 lds
    buffer_load_dwordx4 v37, s[16:19], s36 offen offset:1024 lds
    buffer_load_dwordx4 v38, s[16:19], s36 offen offset:2048 lds
    buffer_load_dwordx4 v39, s[16:19], s36 offen offset:3072 lds
    s_add_u32 m0, s38, 4096
    s_nop 0
    buffer_load_dwordx4 v40, s[16:19], s36 offen offset:0 lds
    buffer_load_dwordx4 v41, s[16:19], s36 offen offset:1024 lds
    buffer_load_dwordx4 v42, s[16:19], s36 offen offset:2048 lds
    buffer_load_dwordx4 v43, s[16:19], s36 offen offset:3072 lds
    s_add_u32 m0, s39, 16384
    s_mov_b32 s37, 524288
    buffer_load_dwordx4 v44, s[20:23], s37 offen offset:0 lds
    buffer_load_dwordx4 v45, s[20:23], s37 offen offset:1024 lds
    buffer_load_dwordx4 v46, s[20:23], s37 offen offset:2048 lds
    buffer_load_dwordx4 v47, s[20:23], s37 offen offset:3072 lds
    s_add_u32 m0, s38, 8192
    s_mov_b32 s36, 128
    buffer_load_dwordx4 v36, s[16:19], s36 offen offset:0 lds
    buffer_load_dwordx4 v37, s[16:19], s36 offen offset:1024 lds
    buffer_load_dwordx4 v38, s[16:19], s36 offen offset:2048 lds
    buffer_load_dwordx4 v39, s[16:19], s36 offen offset:3072 lds
    s_add_u32 m0, s38, 12288
    s_nop 0
    buffer_load_dwordx4 v40, s[16:19], s36 offen offset:0 lds
    buffer_load_dwordx4 v41, s[16:19], s36 offen offset:1024 lds
    buffer_load_dwordx4 v42, s[16:19], s36 offen offset:2048 lds
    buffer_load_dwordx4 v43, s[16:19], s36 offen offset:3072 lds
    s_add_u32 m0, s39, 32768
    s_mov_b32 s37, 1048576
    buffer_load_dwordx4 v44, s[20:23], s37 offen offset:0 lds
    buffer_load_dwordx4 v45, s[20:23], s37 offen offset:1024 lds
    buffer_load_dwordx4 v46, s[20:23], s37 offen offset:2048 lds
    buffer_load_dwordx4 v47, s[20:23], s37 offen offset:3072 lds
    s_add_u32 m0, s38, 16384
    s_mov_b32 s36, 256
    buffer_load_dwordx4 v36, s[16:19], s36 offen offset:0 lds
    buffer_load_dwordx4 v37, s[16:19], s36 offen offset:1024 lds
    buffer_load_dwordx4 v38, s[16:19], s36 offen offset:2048 lds
    buffer_load_dwordx4 v39, s[16:19], s36 offen offset:3072 lds
    s_add_u32 m0, s38, 20480
    s_nop 0
    buffer_load_dwordx4 v40, s[16:19], s36 offen offset:0 lds
    buffer_load_dwordx4 v41, s[16:19], s36 offen offset:1024 lds
    buffer_load_dwordx4 v42, s[16:19], s36 offen offset:2048 lds
    buffer_load_dwordx4 v43, s[16:19], s36 offen offset:3072 lds
    s_add_u32 m0, s34, 49152
    s_nop 0
    buffer_load_dwordx4 v13, s[8:11], s28 offen offset:0 lds
    buffer_load_dwordx4 v14, s[8:11], s28 offen offset:1024 lds
    buffer_load_dwordx4 v15, s[8:11], s28 offen offset:2048 lds
    buffer_load_dwordx4 v16, s[8:11], s28 offen offset:3072 lds
    s_add_u32 s28, s28, 16384
    s_and_b32 s40, s5, 1
    s_lshl_b32 s40, s40, 12
    s_cmp_ge_u32 s5, 2
    s_cselect_b32 s30, 32, 8
    s_cselect_b32 s31, 40, 16
    s_cselect_b32 s32, 0, 56
    s_cselect_b32 s33, 48, 24
    s_lshl_b32 s30, s30, 10
    s_add_u32 s30, s30, s40
    s_lshl_b32 s31, s31, 10
    s_add_u32 s31, s31, s40
    s_lshl_b32 s32, s32, 10
    s_add_u32 s32, s32, s40
    s_lshl_b32 s33, s33, 10
    s_add_u32 s33, s33, s40
    s_mov_b32 s44, 0x3e0293ee
    s_mov_b32 s45, 0x3e0293ee
    s_lshl_b32 s40, s4, 2
    s_add_u32 s40, s40, s5
    s_lshl_b32 s40, s40, 5
    s_add_u32 s40, s40, s3
    s_lshl_b32 s40, s40, 14
    s_add_u32 s40, s40, 0x400000
    s_add_u32 s24, s56, s40
    s_addc_u32 s25, s57, 0
    s_mov_b32 s26, 0x4000
    s_mov_b32 s27, 0x20000
    v_lshrrev_b32 v24, 4, v19
    v_and_b32 v25, 15, v19
    v_xor_b32 v26, v24, v25
    v_lshlrev_b32 v27, 8, v25
    v_add_u32 v27, 98304, v27
    s_add_u32 s41, s5, 0
    s_and_b32 s41, s41, 3
    s_lshl_b32 s41, s41, 2
    v_xor_b32 v28, s41, v26
    v_lshl_add_u32 v1, v28, 4, v27
    s_add_u32 s41, s5, 1
    s_and_b32 s41, s41, 3
    s_lshl_b32 s41, s41, 2
    v_xor_b32 v28, s41, v26
    v_lshl_add_u32 v2, v28, 4, v27
    s_add_u32 s41, s5, 2
    s_and_b32 s41, s41, 3
    s_lshl_b32 s41, s41, 2
    v_xor_b32 v28, s41, v26
    v_lshl_add_u32 v3, v28, 4, v27
    s_add_u32 s41, s5, 3
    s_and_b32 s41, s41, 3
    s_lshl_b32 s41, s41, 2
    v_xor_b32 v28, s41, v26
    v_lshl_add_u32 v4, v28, 4, v27
    v_lshrrev_b32 v26, 1, v25
    v_xor_b32 v26, v24, v26
    v_lshlrev_b32 v27, 7, v25
    v_add_u32 v27, s38, v27
    v_xor_b32 v28, 0, v26
    v_lshl_add_u32 v48, v28, 4, v27
    v_xor_b32 v28, 4, v26
    v_lshl_add_u32 v49, v28, 4, v27
    v_bfe_u32 v26, v19, 2, 2
    v_bfe_u32 v27, v19, 2, 3
    v_and_b32 v28, 3, v19
    v_lshlrev_b32 v28, 3, v28
    v_lshl_add_u32 v29, v24, 2, v26
    v_lshl_add_u32 v29, v29, 8, v28
    v_lshl_add_u32 v30, v24, 3, v26
    v_lshl_add_u32 v30, v30, 8, v28
    v_add_u32 v30, 98304, v30
    v_xor_b32 v31, 0, v27
    v_lshl_add_u32 v5, v31, 5, v29
    v_xor_b32 v31, 1, v27
    v_lshl_add_u32 v6, v31, 5, v29
    v_xor_b32 v31, 2, v27
    v_lshl_add_u32 v7, v31, 5, v29
    v_xor_b32 v31, 3, v27
    v_lshl_add_u32 v8, v31, 5, v29
    v_xor_b32 v31, 4, v27
    v_lshl_add_u32 v9, v31, 5, v29
    v_xor_b32 v31, 5, v27
    v_lshl_add_u32 v10, v31, 5, v29
    v_xor_b32 v31, 6, v27
    v_lshl_add_u32 v11, v31, 5, v29
    v_xor_b32 v31, 7, v27
    v_lshl_add_u32 v12, v31, 5, v29
    s_lshl_b32 s42, s5, 1
    s_add_u32 s41, s42, 0
    s_and_b32 s41, s41, 7
    v_xor_b32 v31, s41, v27
    v_lshl_add_u32 v50, v31, 5, v30
    s_add_u32 s41, s42, 1
    s_and_b32 s41, s41, 7
    v_xor_b32 v31, s41, v27
    v_lshl_add_u32 v51, v31, 5, v30
    s_add_u32 s41, s42, 2
    s_and_b32 s41, s41, 7
    v_xor_b32 v31, s41, v27
    v_lshl_add_u32 v52, v31, 5, v30
    s_add_u32 s41, s42, 3
    s_and_b32 s41, s41, 7
    v_xor_b32 v31, s41, v27
    v_lshl_add_u32 v53, v31, 5, v30
    s_add_u32 s41, s42, 4
    s_and_b32 s41, s41, 7
    v_xor_b32 v31, s41, v27
    v_lshl_add_u32 v54, v31, 5, v30
    s_add_u32 s41, s42, 5
    s_and_b32 s41, s41, 7
    v_xor_b32 v31, s41, v27
    v_lshl_add_u32 v55, v31, 5, v30
    s_add_u32 s41, s42, 6
    s_and_b32 s41, s41, 7
    v_xor_b32 v31, s41, v27
    v_lshl_add_u32 v56, v31, 5, v30
    s_add_u32 s41, s42, 7
    s_and_b32 s41, s41, 7
    v_xor_b32 v31, s41, v27
    v_lshl_add_u32 v57, v31, 5, v30
    s_lshl_b32 s41, s5, 7
    s_add_u32 s41, s41, 65536
    v_lshl_add_u32 v58, v24, 4, s41
    s_mov_b32 s60, s56
    s_mov_b32 s61, s57
    s_mov_b32 s62, 0x2000000
    s_mov_b32 s63, 0x20000
    s_lshl_b32 s41, s4, 2
    s_add_u32 s41, s41, s5
    s_lshl_b32 s41, s41, 9
    s_add_u32 s46, s41, 0x280000
    v_lshlrev_b32 v59, 3, v25
    v_mov_b32 v32, 0x3f803f80
    v_mov_b32 v33, 0x3f803f80
    v_mov_b32 v34, 0x3f803f80
    v_mov_b32 v35, 0x3f803f80
    v_mov_b32 v20, 0
    v_mov_b32 v252, 0
    v_mov_b32 v21, 0
    v_mov_b32 v253, 0
    v_mov_b32 v22, 0
    v_mov_b32 v254, 0
    v_mov_b32 v23, 0
    v_mov_b32 v255, 0
    v_and_b32 v28, 1, v19
    v_cmp_eq_u32 vcc, 0, v28
    v_mov_b32 v29, 0x44444444
    v_mov_b32 v30, 0xeeeeeeee
    v_cndmask_b32 v248, v30, v29, vcc
    v_accvgpr_write_b32 a224, 0
    v_accvgpr_write_b32 a225, 0
    v_accvgpr_write_b32 a226, 0
    v_accvgpr_write_b32 a227, 0
    v_accvgpr_write_b32 a228, 0
    v_accvgpr_write_b32 a229, 0
    v_accvgpr_write_b32 a230, 0
    v_accvgpr_write_b32 a231, 0
    v_accvgpr_write_b32 a232, 0
    v_accvgpr_write_b32 a233, 0
    v_accvgpr_write_b32 a234, 0
    v_accvgpr_write_b32 a235, 0
    v_accvgpr_write_b32 a236, 0
    v_accvgpr_write_b32 a237, 0
    v_accvgpr_write_b32 a238, 0
    v_accvgpr_write_b32 a239, 0
    v_and_b32 v28, 2, v19
    v_cmp_eq_u32 vcc, 0, v28
    v_mov_b32 v29, 0x3f803f80
    s_nop 0
    v_cndmask_b32 v244, 0, v29, vcc
    v_cndmask_b32 v245, 0, v29, vcc
    v_cndmask_b32 v246, 0, v29, vcc
    v_cndmask_b32 v247, 0, v29, vcc
    buffer_load_dwordx2 v[108:109], v59, s[60:63], s46 offen offset:0
    buffer_load_dwordx2 v[110:111], v59, s[60:63], s46 offen offset:128
    buffer_load_dwordx2 v[112:113], v59, s[60:63], s46 offen offset:256
    buffer_load_dwordx2 v[114:115], v59, s[60:63], s46 offen offset:384
    s_waitcnt vmcnt(32)
    s_barrier
    ds_read_b64_tr_b16 a[0:1], v50 offset:0
    ds_read_b64_tr_b16 a[2:3], v50 offset:1024
    ds_read_b128 a[32:35], v48 offset:0
    ds_read_b128 a[36:39], v48 offset:2048
    ds_read_b128 a[40:43], v48 offset:4096
    ds_read_b128 a[44:47], v48 offset:6144
    ds_read_b64_tr_b16 a[4:5], v51 offset:0
    ds_read_b64_tr_b16 a[6:7], v51 offset:1024
    ds_read_b64_tr_b16 a[8:9], v52 offset:0
    ds_read_b64_tr_b16 a[10:11], v52 offset:1024
    ds_read_b64_tr_b16 a[12:13], v53 offset:0
    ds_read_b64_tr_b16 a[14:15], v53 offset:1024
    ds_read_b64_tr_b16 a[16:17], v54 offset:0
    ds_read_b64_tr_b16 a[18:19], v54 offset:1024
    ds_read_b64_tr_b16 a[20:21], v55 offset:0
    ds_read_b64_tr_b16 a[22:23], v55 offset:1024
    ds_read_b64_tr_b16 a[24:25], v56 offset:0
    ds_read_b64_tr_b16 a[26:27], v56 offset:1024
    ds_read_b64_tr_b16 a[28:29], v57 offset:0
    ds_read_b64_tr_b16 a[30:31], v57 offset:1024
    s_waitcnt lgkmcnt(0)
    v_mfma_f32_16x16x32_bf16 v[100:103], a[0:3], v[32:35], 0
    ds_read_b64_tr_b16 a[48:49], v50 offset:8192
    v_mfma_f32_16x16x32_bf16 v[104:107], a[4:7], v[32:35], 0
    ds_read_b64_tr_b16 a[50:51], v50 offset:9216
    v_mfma_f32_16x16x32_bf16 v[116:119], a[0:3], a[32:35], 0
    ds_read_b128 a[80:83], v49 offset:0
    v_mfma_f32_16x16x32_bf16 v[148:151], a[0:3], a[36:39], 0
    ds_read_b128 a[84:87], v49 offset:2048
    v_mfma_f32_16x16x32_bf16 v[180:183], a[0:3], a[40:43], 0
    ds_read_b128 a[88:91], v49 offset:4096
    v_mfma_f32_16x16x32_bf16 v[212:215], a[0:3], a[44:47], 0
    ds_read_b128 a[92:95], v49 offset:6144
    v_mfma_f32_16x16x32_bf16 v[120:123], a[4:7], a[32:35], 0
    ds_read_b64_tr_b16 a[52:53], v51 offset:8192
    v_mfma_f32_16x16x32_bf16 v[152:155], a[4:7], a[36:39], 0
    ds_read_b64_tr_b16 a[54:55], v51 offset:9216
    v_mfma_f32_16x16x32_bf16 v[184:187], a[4:7], a[40:43], 0
    ds_read_b64_tr_b16 a[56:57], v52 offset:8192
    v_mfma_f32_16x16x32_bf16 v[216:219], a[4:7], a[44:47], 0
    ds_read_b64_tr_b16 a[58:59], v52 offset:9216
    v_mfma_f32_16x16x32_bf16 v[124:127], a[8:11], a[32:35], 0
    ds_read_b64_tr_b16 a[60:61], v53 offset:8192
    v_mfma_f32_16x16x32_bf16 v[156:159], a[8:11], a[36:39], 0
    ds_read_b64_tr_b16 a[62:63], v53 offset:9216
    v_mfma_f32_16x16x32_bf16 v[188:191], a[8:11], a[40:43], 0
    ds_read_b64_tr_b16 a[64:65], v54 offset:8192
    v_mfma_f32_16x16x32_bf16 v[220:223], a[8:11], a[44:47], 0
    ds_read_b64_tr_b16 a[66:67], v54 offset:9216
    v_mfma_f32_16x16x32_bf16 v[128:131], a[12:15], a[32:35], 0
    ds_read_b64_tr_b16 a[68:69], v55 offset:8192
    v_mfma_f32_16x16x32_bf16 v[160:163], a[12:15], a[36:39], 0
    ds_read_b64_tr_b16 a[70:71], v55 offset:9216
    v_mfma_f32_16x16x32_bf16 v[192:195], a[12:15], a[40:43], 0
    ds_read_b64_tr_b16 a[72:73], v56 offset:8192
    v_mfma_f32_16x16x32_bf16 v[224:227], a[12:15], a[44:47], 0
    ds_read_b64_tr_b16 a[74:75], v56 offset:9216
    v_mfma_f32_16x16x32_bf16 v[132:135], a[16:19], a[32:35], 0
    ds_read_b64_tr_b16 a[76:77], v57 offset:8192
    v_mfma_f32_16x16x32_bf16 v[164:167], a[16:19], a[36:39], 0
    ds_read_b64_tr_b16 a[78:79], v57 offset:9216
    v_mfma_f32_16x16x32_bf16 v[196:199], a[16:19], a[40:43], 0
    v_mfma_f32_16x16x32_bf16 v[228:231], a[16:19], a[44:47], 0
    v_mfma_f32_16x16x32_bf16 v[136:139], a[20:23], a[32:35], 0
    v_mfma_f32_16x16x32_bf16 v[168:171], a[20:23], a[36:39], 0
    v_mfma_f32_16x16x32_bf16 v[200:203], a[20:23], a[40:43], 0
    v_mfma_f32_16x16x32_bf16 v[232:235], a[20:23], a[44:47], 0
    v_mfma_f32_16x16x32_bf16 v[140:143], a[24:27], a[32:35], 0
    v_mfma_f32_16x16x32_bf16 v[172:175], a[24:27], a[36:39], 0
    v_mfma_f32_16x16x32_bf16 v[204:207], a[24:27], a[40:43], 0
    v_mfma_f32_16x16x32_bf16 v[236:239], a[24:27], a[44:47], 0
    v_mfma_f32_16x16x32_bf16 v[144:147], a[28:31], a[32:35], 0
    v_mfma_f32_16x16x32_bf16 v[176:179], a[28:31], a[36:39], 0
    v_mfma_f32_16x16x32_bf16 v[208:211], a[28:31], a[40:43], 0
    v_mfma_f32_16x16x32_bf16 v[240:243], a[28:31], a[44:47], 0
    s_waitcnt vmcnt(20) lgkmcnt(0)
    s_barrier
    v_mfma_f32_16x16x32_bf16 v[100:103], a[48:51], v[32:35], v[100:103]
    ds_read_b64_tr_b16 a[0:1], v50 offset:16384
    v_mfma_f32_16x16x32_bf16 v[104:107], a[52:55], v[32:35], v[104:107]
    ds_read_b64_tr_b16 a[2:3], v50 offset:17408
    v_mfma_f32_16x16x32_bf16 v[116:119], a[48:51], a[80:83], v[116:119]
    ds_read_b128 a[32:35], v48 offset:8192
    v_mfma_f32_16x16x32_bf16 v[148:151], a[48:51], a[84:87], v[148:151]
    ds_read_b128 a[36:39], v48 offset:10240
    v_mfma_f32_16x16x32_bf16 v[180:183], a[48:51], a[88:91], v[180:183]
    ds_read_b128 a[40:43], v48 offset:12288
    v_mfma_f32_16x16x32_bf16 v[212:215], a[48:51], a[92:95], v[212:215]
    ds_read_b128 a[44:47], v48 offset:14336
    v_mfma_f32_16x16x32_bf16 v[120:123], a[52:55], a[80:83], v[120:123]
    ds_read_b64_tr_b16 a[4:5], v51 offset:16384
    v_mfma_f32_16x16x32_bf16 v[152:155], a[52:55], a[84:87], v[152:155]
    ds_read_b64_tr_b16 a[6:7], v51 offset:17408
    v_mfma_f32_16x16x32_bf16 v[184:187], a[52:55], a[88:91], v[184:187]
    ds_read_b64_tr_b16 a[8:9], v52 offset:16384
    v_mfma_f32_16x16x32_bf16 v[216:219], a[52:55], a[92:95], v[216:219]
    ds_read_b64_tr_b16 a[10:11], v52 offset:17408
    v_mfma_f32_16x16x32_bf16 v[124:127], a[56:59], a[80:83], v[124:127]
    ds_read_b64_tr_b16 a[12:13], v53 offset:16384
    v_mfma_f32_16x16x32_bf16 v[156:159], a[56:59], a[84:87], v[156:159]
    ds_read_b64_tr_b16 a[14:15], v53 offset:17408
    v_mfma_f32_16x16x32_bf16 v[188:191], a[56:59], a[88:91], v[188:191]
    ds_read_b64_tr_b16 a[16:17], v54 offset:16384
    v_mfma_f32_16x16x32_bf16 v[220:223], a[56:59], a[92:95], v[220:223]
    ds_read_b64_tr_b16 a[18:19], v54 offset:17408
    v_mfma_f32_16x16x32_bf16 v[128:131], a[60:63], a[80:83], v[128:131]
    ds_read_b64_tr_b16 a[20:21], v55 offset:16384
    v_mfma_f32_16x16x32_bf16 v[160:163], a[60:63], a[84:87], v[160:163]
    ds_read_b64_tr_b16 a[22:23], v55 offset:17408
    v_mfma_f32_16x16x32_bf16 v[192:195], a[60:63], a[88:91], v[192:195]
    ds_read_b64_tr_b16 a[24:25], v56 offset:16384
    v_mfma_f32_16x16x32_bf16 v[224:227], a[60:63], a[92:95], v[224:227]
    ds_read_b64_tr_b16 a[26:27], v56 offset:17408
    v_mfma_f32_16x16x32_bf16 v[132:135], a[64:67], a[80:83], v[132:135]
    ds_read_b64_tr_b16 a[28:29], v57 offset:16384
    v_mfma_f32_16x16x32_bf16 v[164:167], a[64:67], a[84:87], v[164:167]
    ds_read_b64_tr_b16 a[30:31], v57 offset:17408
    v_mfma_f32_16x16x32_bf16 v[196:199], a[64:67], a[88:91], v[196:199]
    v_mfma_f32_16x16x32_bf16 v[228:231], a[64:67], a[92:95], v[228:231]
    v_mfma_f32_16x16x32_bf16 v[136:139], a[68:71], a[80:83], v[136:139]
    v_mfma_f32_16x16x32_bf16 v[168:171], a[68:71], a[84:87], v[168:171]
    s_add_u32 m0, s39, 0
    s_mov_b32 s37, 1572864
    v_mfma_f32_16x16x32_bf16 v[200:203], a[68:71], a[88:91], v[200:203]
    buffer_load_dwordx4 v44, s[20:23], s37 offen offset:0 lds
    buffer_load_dwordx4 v45, s[20:23], s37 offen offset:1024 lds
    buffer_load_dwordx4 v46, s[20:23], s37 offen offset:2048 lds
    buffer_load_dwordx4 v47, s[20:23], s37 offen offset:3072 lds
    v_mfma_f32_16x16x32_bf16 v[232:235], a[68:71], a[92:95], v[232:235]
    v_mfma_f32_16x16x32_bf16 v[140:143], a[72:75], a[80:83], v[140:143]
    v_mfma_f32_16x16x32_bf16 v[172:175], a[72:75], a[84:87], v[172:175]
    v_mfma_f32_16x16x32_bf16 v[204:207], a[72:75], a[88:91], v[204:207]
    v_mfma_f32_16x16x32_bf16 v[236:239], a[72:75], a[92:95], v[236:239]
    s_add_u32 m0, s38, 0
    s_mov_b32 s36, 384
    v_mfma_f32_16x16x32_bf16 v[144:147], a[76:79], a[80:83], v[144:147]
    buffer_load_dwordx4 v36, s[16:19], s36 offen offset:0 lds
    buffer_load_dwordx4 v37, s[16:19], s36 offen offset:1024 lds
    buffer_load_dwordx4 v38, s[16:19], s36 offen offset:2048 lds
    buffer_load_dwordx4 v39, s[16:19], s36 offen offset:3072 lds
    v_mfma_f32_16x16x32_bf16 v[176:179], a[76:79], a[84:87], v[176:179]
    v_mfma_f32_16x16x32_bf16 v[208:211], a[76:79], a[88:91], v[208:211]
    v_mfma_f32_16x16x32_bf16 v[240:243], a[76:79], a[92:95], v[240:243]
    s_waitcnt lgkmcnt(0)
    v_mfma_f32_16x16x32_bf16 v[100:103], a[0:3], v[32:35], v[100:103]
    ds_read_b64_tr_b16 a[48:49], v50 offset:24576
    v_mfma_f32_16x16x32_bf16 v[104:107], a[4:7], v[32:35], v[104:107]
    ds_read_b64_tr_b16 a[50:51], v50 offset:25600
    v_mfma_f32_16x16x32_bf16 v[116:119], a[0:3], a[32:35], v[116:119]
    ds_read_b128 a[80:83], v49 offset:8192
    v_mfma_f32_16x16x32_bf16 v[148:151], a[0:3], a[36:39], v[148:151]
    ds_read_b128 a[84:87], v49 offset:10240
    v_mfma_f32_16x16x32_bf16 v[180:183], a[0:3], a[40:43], v[180:183]
    ds_read_b128 a[88:91], v49 offset:12288
    v_mfma_f32_16x16x32_bf16 v[212:215], a[0:3], a[44:47], v[212:215]
    ds_read_b128 a[92:95], v49 offset:14336
    v_mfma_f32_16x16x32_bf16 v[120:123], a[4:7], a[32:35], v[120:123]
    ds_read_b64_tr_b16 a[52:53], v51 offset:24576
    v_mfma_f32_16x16x32_bf16 v[152:155], a[4:7], a[36:39], v[152:155]
    ds_read_b64_tr_b16 a[54:55], v51 offset:25600
    v_mfma_f32_16x16x32_bf16 v[184:187], a[4:7], a[40:43], v[184:187]
    ds_read_b64_tr_b16 a[56:57], v52 offset:24576
    v_mfma_f32_16x16x32_bf16 v[216:219], a[4:7], a[44:47], v[216:219]
    ds_read_b64_tr_b16 a[58:59], v52 offset:25600
    v_mfma_f32_16x16x32_bf16 v[124:127], a[8:11], a[32:35], v[124:127]
    ds_read_b64_tr_b16 a[60:61], v53 offset:24576
    v_mfma_f32_16x16x32_bf16 v[156:159], a[8:11], a[36:39], v[156:159]
    ds_read_b64_tr_b16 a[62:63], v53 offset:25600
    v_mfma_f32_16x16x32_bf16 v[188:191], a[8:11], a[40:43], v[188:191]
    ds_read_b64_tr_b16 a[64:65], v54 offset:24576
    v_mfma_f32_16x16x32_bf16 v[220:223], a[8:11], a[44:47], v[220:223]
    ds_read_b64_tr_b16 a[66:67], v54 offset:25600
    v_mfma_f32_16x16x32_bf16 v[128:131], a[12:15], a[32:35], v[128:131]
    ds_read_b64_tr_b16 a[68:69], v55 offset:24576
    v_mfma_f32_16x16x32_bf16 v[160:163], a[12:15], a[36:39], v[160:163]
    ds_read_b64_tr_b16 a[70:71], v55 offset:25600
    v_mfma_f32_16x16x32_bf16 v[192:195], a[12:15], a[40:43], v[192:195]
    ds_read_b64_tr_b16 a[72:73], v56 offset:24576
    v_mfma_f32_16x16x32_bf16 v[224:227], a[12:15], a[44:47], v[224:227]
    ds_read_b64_tr_b16 a[74:75], v56 offset:25600
    v_mfma_f32_16x16x32_bf16 v[132:135], a[16:19], a[32:35], v[132:135]
    ds_read_b64_tr_b16 a[76:77], v57 offset:24576
    v_mfma_f32_16x16x32_bf16 v[164:167], a[16:19], a[36:39], v[164:167]
    ds_read_b64_tr_b16 a[78:79], v57 offset:25600
    v_mfma_f32_16x16x32_bf16 v[196:199], a[16:19], a[40:43], v[196:199]
    v_mfma_f32_16x16x32_bf16 v[228:231], a[16:19], a[44:47], v[228:231]
    v_mfma_f32_16x16x32_bf16 v[136:139], a[20:23], a[32:35], v[136:139]
    v_mfma_f32_16x16x32_bf16 v[168:171], a[20:23], a[36:39], v[168:171]
    s_add_u32 m0, s38, 4096
    v_mfma_f32_16x16x32_bf16 v[200:203], a[20:23], a[40:43], v[200:203]
    buffer_load_dwordx4 v40, s[16:19], s36 offen offset:0 lds
    buffer_load_dwordx4 v41, s[16:19], s36 offen offset:1024 lds
    buffer_load_dwordx4 v42, s[16:19], s36 offen offset:2048 lds
    buffer_load_dwordx4 v43, s[16:19], s36 offen offset:3072 lds
    v_mfma_f32_16x16x32_bf16 v[232:235], a[20:23], a[44:47], v[232:235]
    v_mfma_f32_16x16x32_bf16 v[140:143], a[24:27], a[32:35], v[140:143]
    v_mfma_f32_16x16x32_bf16 v[172:175], a[24:27], a[36:39], v[172:175]
    v_mfma_f32_16x16x32_bf16 v[204:207], a[24:27], a[40:43], v[204:207]
    v_mfma_f32_16x16x32_bf16 v[236:239], a[24:27], a[44:47], v[236:239]
    v_mfma_f32_16x16x32_bf16 v[144:147], a[28:31], a[32:35], v[144:147]
    v_mfma_f32_16x16x32_bf16 v[176:179], a[28:31], a[36:39], v[176:179]
    v_mfma_f32_16x16x32_bf16 v[208:211], a[28:31], a[40:43], v[208:211]
    v_mfma_f32_16x16x32_bf16 v[240:243], a[28:31], a[44:47], v[240:243]
    s_waitcnt vmcnt(20) lgkmcnt(0)
    s_barrier
    v_mfma_f32_16x16x32_bf16 v[100:103], a[48:51], v[32:35], v[100:103]
    ds_read_b64_tr_b16 a[0:1], v50 offset:32768
    v_mfma_f32_16x16x32_bf16 v[104:107], a[52:55], v[32:35], v[104:107]
    ds_read_b64_tr_b16 a[2:3], v50 offset:33792
    v_mfma_f32_16x16x32_bf16 v[116:119], a[48:51], a[80:83], v[116:119]
    ds_read_b128 a[32:35], v48 offset:16384
    v_mfma_f32_16x16x32_bf16 v[148:151], a[48:51], a[84:87], v[148:151]
    ds_read_b128 a[36:39], v48 offset:18432
    v_mfma_f32_16x16x32_bf16 v[180:183], a[48:51], a[88:91], v[180:183]
    ds_read_b128 a[40:43], v48 offset:20480
    v_mfma_f32_16x16x32_bf16 v[212:215], a[48:51], a[92:95], v[212:215]
    ds_read_b128 a[44:47], v48 offset:22528
    v_mfma_f32_16x16x32_bf16 v[120:123], a[52:55], a[80:83], v[120:123]
    ds_read_b64_tr_b16 a[4:5], v51 offset:32768
    v_mfma_f32_16x16x32_bf16 v[152:155], a[52:55], a[84:87], v[152:155]
    ds_read_b64_tr_b16 a[6:7], v51 offset:33792
    v_mfma_f32_16x16x32_bf16 v[184:187], a[52:55], a[88:91], v[184:187]
    ds_read_b64_tr_b16 a[8:9], v52 offset:32768
    v_mfma_f32_16x16x32_bf16 v[216:219], a[52:55], a[92:95], v[216:219]
    ds_read_b64_tr_b16 a[10:11], v52 offset:33792
    v_mfma_f32_16x16x32_bf16 v[124:127], a[56:59], a[80:83], v[124:127]
    ds_read_b64_tr_b16 a[12:13], v53 offset:32768
    v_mfma_f32_16x16x32_bf16 v[156:159], a[56:59], a[84:87], v[156:159]
    ds_read_b64_tr_b16 a[14:15], v53 offset:33792
    v_mfma_f32_16x16x32_bf16 v[188:191], a[56:59], a[88:91], v[188:191]
    ds_read_b64_tr_b16 a[16:17], v54 offset:32768
    v_mfma_f32_16x16x32_bf16 v[220:223], a[56:59], a[92:95], v[220:223]
    ds_read_b64_tr_b16 a[18:19], v54 offset:33792
    v_mfma_f32_16x16x32_bf16 v[128:131], a[60:63], a[80:83], v[128:131]
    ds_read_b64_tr_b16 a[20:21], v55 offset:32768
    v_mfma_f32_16x16x32_bf16 v[160:163], a[60:63], a[84:87], v[160:163]
    ds_read_b64_tr_b16 a[22:23], v55 offset:33792
    v_mfma_f32_16x16x32_bf16 v[192:195], a[60:63], a[88:91], v[192:195]
    ds_read_b64_tr_b16 a[24:25], v56 offset:32768
    v_mfma_f32_16x16x32_bf16 v[224:227], a[60:63], a[92:95], v[224:227]
    ds_read_b64_tr_b16 a[26:27], v56 offset:33792
    v_mfma_f32_16x16x32_bf16 v[132:135], a[64:67], a[80:83], v[132:135]
    ds_read_b64_tr_b16 a[28:29], v57 offset:32768
    v_mfma_f32_16x16x32_bf16 v[164:167], a[64:67], a[84:87], v[164:167]
    ds_read_b64_tr_b16 a[30:31], v57 offset:33792
    v_mfma_f32_16x16x32_bf16 v[196:199], a[64:67], a[88:91], v[196:199]
    v_mfma_f32_16x16x32_bf16 v[228:231], a[64:67], a[92:95], v[228:231]
    v_mfma_f32_16x16x32_bf16 v[136:139], a[68:71], a[80:83], v[136:139]
    v_mfma_f32_16x16x32_bf16 v[168:171], a[68:71], a[84:87], v[168:171]
    s_add_u32 m0, s39, 16384
    s_mov_b32 s37, 2097152
    v_mfma_f32_16x16x32_bf16 v[200:203], a[68:71], a[88:91], v[200:203]
    buffer_load_dwordx4 v44, s[20:23], s37 offen offset:0 lds
    buffer_load_dwordx4 v45, s[20:23], s37 offen offset:1024 lds
    buffer_load_dwordx4 v46, s[20:23], s37 offen offset:2048 lds
    buffer_load_dwordx4 v47, s[20:23], s37 offen offset:3072 lds
    v_mfma_f32_16x16x32_bf16 v[232:235], a[68:71], a[92:95], v[232:235]
    v_mfma_f32_16x16x32_bf16 v[140:143], a[72:75], a[80:83], v[140:143]
    v_mfma_f32_16x16x32_bf16 v[172:175], a[72:75], a[84:87], v[172:175]
    v_mfma_f32_16x16x32_bf16 v[204:207], a[72:75], a[88:91], v[204:207]
    v_mfma_f32_16x16x32_bf16 v[236:239], a[72:75], a[92:95], v[236:239]
    s_add_u32 m0, s38, 8192
    s_mov_b32 s36, 512
    v_mfma_f32_16x16x32_bf16 v[144:147], a[76:79], a[80:83], v[144:147]
    buffer_load_dwordx4 v36, s[16:19], s36 offen offset:0 lds
    buffer_load_dwordx4 v37, s[16:19], s36 offen offset:1024 lds
    buffer_load_dwordx4 v38, s[16:19], s36 offen offset:2048 lds
    buffer_load_dwordx4 v39, s[16:19], s36 offen offset:3072 lds
    v_mfma_f32_16x16x32_bf16 v[176:179], a[76:79], a[84:87], v[176:179]
    v_mfma_f32_16x16x32_bf16 v[208:211], a[76:79], a[88:91], v[208:211]
    v_mfma_f32_16x16x32_bf16 v[240:243], a[76:79], a[92:95], v[240:243]
    s_waitcnt lgkmcnt(0)
    v_mfma_f32_16x16x32_bf16 v[100:103], a[0:3], v[32:35], v[100:103]
    ds_read_b64_tr_b16 a[48:49], v50 offset:40960
    v_mfma_f32_16x16x32_bf16 v[104:107], a[4:7], v[32:35], v[104:107]
    ds_read_b64_tr_b16 a[50:51], v50 offset:41984
    v_mfma_f32_16x16x32_bf16 v[116:119], a[0:3], a[32:35], v[116:119]
    ds_read_b128 a[80:83], v49 offset:16384
    v_mfma_f32_16x16x32_bf16 v[148:151], a[0:3], a[36:39], v[148:151]
    ds_read_b128 a[84:87], v49 offset:18432
    v_mfma_f32_16x16x32_bf16 v[180:183], a[0:3], a[40:43], v[180:183]
    ds_read_b128 a[88:91], v49 offset:20480
    v_mfma_f32_16x16x32_bf16 v[212:215], a[0:3], a[44:47], v[212:215]
    ds_read_b128 a[92:95], v49 offset:22528
    v_mfma_f32_16x16x32_bf16 v[120:123], a[4:7], a[32:35], v[120:123]
    ds_read_b64_tr_b16 a[52:53], v51 offset:40960
    v_mfma_f32_16x16x32_bf16 v[152:155], a[4:7], a[36:39], v[152:155]
    ds_read_b64_tr_b16 a[54:55], v51 offset:41984
    v_mfma_f32_16x16x32_bf16 v[184:187], a[4:7], a[40:43], v[184:187]
    ds_read_b64_tr_b16 a[56:57], v52 offset:40960
    v_mfma_f32_16x16x32_bf16 v[216:219], a[4:7], a[44:47], v[216:219]
    ds_read_b64_tr_b16 a[58:59], v52 offset:41984
    v_mfma_f32_16x16x32_bf16 v[124:127], a[8:11], a[32:35], v[124:127]
    ds_read_b64_tr_b16 a[60:61], v53 offset:40960
    v_mfma_f32_16x16x32_bf16 v[156:159], a[8:11], a[36:39], v[156:159]
    ds_read_b64_tr_b16 a[62:63], v53 offset:41984
    v_mfma_f32_16x16x32_bf16 v[188:191], a[8:11], a[40:43], v[188:191]
    ds_read_b64_tr_b16 a[64:65], v54 offset:40960
    v_mfma_f32_16x16x32_bf16 v[220:223], a[8:11], a[44:47], v[220:223]
    ds_read_b64_tr_b16 a[66:67], v54 offset:41984
    v_mfma_f32_16x16x32_bf16 v[128:131], a[12:15], a[32:35], v[128:131]
    ds_read_b64_tr_b16 a[68:69], v55 offset:40960
    v_mfma_f32_16x16x32_bf16 v[160:163], a[12:15], a[36:39], v[160:163]
    ds_read_b64_tr_b16 a[70:71], v55 offset:41984
    v_mfma_f32_16x16x32_bf16 v[192:195], a[12:15], a[40:43], v[192:195]
    ds_read_b64_tr_b16 a[72:73], v56 offset:40960
    v_mfma_f32_16x16x32_bf16 v[224:227], a[12:15], a[44:47], v[224:227]
    ds_read_b64_tr_b16 a[74:75], v56 offset:41984
    v_mfma_f32_16x16x32_bf16 v[132:135], a[16:19], a[32:35], v[132:135]
    ds_read_b64_tr_b16 a[76:77], v57 offset:40960
    v_mfma_f32_16x16x32_bf16 v[164:167], a[16:19], a[36:39], v[164:167]
    ds_read_b64_tr_b16 a[78:79], v57 offset:41984
    v_mfma_f32_16x16x32_bf16 v[196:199], a[16:19], a[40:43], v[196:199]
    v_mfma_f32_16x16x32_bf16 v[228:231], a[16:19], a[44:47], v[228:231]
    v_mfma_f32_16x16x32_bf16 v[136:139], a[20:23], a[32:35], v[136:139]
    v_mfma_f32_16x16x32_bf16 v[168:171], a[20:23], a[36:39], v[168:171]
    s_add_u32 m0, s38, 12288
    v_mfma_f32_16x16x32_bf16 v[200:203], a[20:23], a[40:43], v[200:203]
    buffer_load_dwordx4 v40, s[16:19], s36 offen offset:0 lds
    buffer_load_dwordx4 v41, s[16:19], s36 offen offset:1024 lds
    buffer_load_dwordx4 v42, s[16:19], s36 offen offset:2048 lds
    buffer_load_dwordx4 v43, s[16:19], s36 offen offset:3072 lds
    v_mfma_f32_16x16x32_bf16 v[232:235], a[20:23], a[44:47], v[232:235]
    v_mfma_f32_16x16x32_bf16 v[140:143], a[24:27], a[32:35], v[140:143]
    v_mfma_f32_16x16x32_bf16 v[172:175], a[24:27], a[36:39], v[172:175]
    v_mfma_f32_16x16x32_bf16 v[204:207], a[24:27], a[40:43], v[204:207]
    v_mfma_f32_16x16x32_bf16 v[236:239], a[24:27], a[44:47], v[236:239]
    v_mfma_f32_16x16x32_bf16 v[144:147], a[28:31], a[32:35], v[144:147]
    v_mfma_f32_16x16x32_bf16 v[176:179], a[28:31], a[36:39], v[176:179]
    v_mfma_f32_16x16x32_bf16 v[208:211], a[28:31], a[40:43], v[208:211]
    v_mfma_f32_16x16x32_bf16 v[240:243], a[28:31], a[44:47], v[240:243]
    s_waitcnt vmcnt(12) lgkmcnt(0)
    s_barrier
    v_mfma_f32_16x16x32_bf16 v[100:103], a[48:51], v[32:35], v[100:103]
    ds_read_b64_tr_b16 a[0:1], v50 offset:0
    v_mfma_f32_16x16x32_bf16 v[104:107], a[52:55], v[32:35], v[104:107]
    ds_read_b64_tr_b16 a[2:3], v50 offset:1024
    v_mfma_f32_16x16x32_bf16 v[116:119], a[48:51], a[80:83], v[116:119]
    ds_read_b128 a[32:35], v48 offset:0
    v_mfma_f32_16x16x32_bf16 v[148:151], a[48:51], a[84:87], v[148:151]
    ds_read_b128 a[36:39], v48 offset:2048
    v_mfma_f32_16x16x32_bf16 v[180:183], a[48:51], a[88:91], v[180:183]
    ds_read_b128 a[40:43], v48 offset:4096
    v_mfma_f32_16x16x32_bf16 v[212:215], a[48:51], a[92:95], v[212:215]
    ds_read_b128 a[44:47], v48 offset:6144
    v_mfma_f32_16x16x32_bf16 v[120:123], a[52:55], a[80:83], v[120:123]
    ds_read_b64_tr_b16 a[4:5], v51 offset:0
    v_mfma_f32_16x16x32_bf16 v[152:155], a[52:55], a[84:87], v[152:155]
    ds_read_b64_tr_b16 a[6:7], v51 offset:1024
    v_mfma_f32_16x16x32_bf16 v[184:187], a[52:55], a[88:91], v[184:187]
    ds_read_b64_tr_b16 a[8:9], v52 offset:0
    v_mfma_f32_16x16x32_bf16 v[216:219], a[52:55], a[92:95], v[216:219]
    ds_read_b64_tr_b16 a[10:11], v52 offset:1024
    v_mfma_f32_16x16x32_bf16 v[124:127], a[56:59], a[80:83], v[124:127]
    ds_read_b64_tr_b16 a[12:13], v53 offset:0
    v_mfma_f32_16x16x32_bf16 v[156:159], a[56:59], a[84:87], v[156:159]
    ds_read_b64_tr_b16 a[14:15], v53 offset:1024
    v_mfma_f32_16x16x32_bf16 v[188:191], a[56:59], a[88:91], v[188:191]
    ds_read_b64_tr_b16 a[16:17], v54 offset:0
    v_mfma_f32_16x16x32_bf16 v[220:223], a[56:59], a[92:95], v[220:223]
    ds_read_b64_tr_b16 a[18:19], v54 offset:1024
    v_mfma_f32_16x16x32_bf16 v[128:131], a[60:63], a[80:83], v[128:131]
    ds_read_b64_tr_b16 a[20:21], v55 offset:0
    v_mfma_f32_16x16x32_bf16 v[160:163], a[60:63], a[84:87], v[160:163]
    ds_read_b64_tr_b16 a[22:23], v55 offset:1024
    v_mfma_f32_16x16x32_bf16 v[192:195], a[60:63], a[88:91], v[192:195]
    ds_read_b64_tr_b16 a[24:25], v56 offset:0
    v_mfma_f32_16x16x32_bf16 v[224:227], a[60:63], a[92:95], v[224:227]
    ds_read_b64_tr_b16 a[26:27], v56 offset:1024
    v_mfma_f32_16x16x32_bf16 v[132:135], a[64:67], a[80:83], v[132:135]
    ds_read_b64_tr_b16 a[28:29], v57 offset:0
    v_mfma_f32_16x16x32_bf16 v[164:167], a[64:67], a[84:87], v[164:167]
    ds_read_b64_tr_b16 a[30:31], v57 offset:1024
    v_mfma_f32_16x16x32_bf16 v[196:199], a[64:67], a[88:91], v[196:199]
    v_mfma_f32_16x16x32_bf16 v[228:231], a[64:67], a[92:95], v[228:231]
    v_mfma_f32_16x16x32_bf16 v[136:139], a[68:71], a[80:83], v[136:139]
    v_mfma_f32_16x16x32_bf16 v[168:171], a[68:71], a[84:87], v[168:171]
    s_add_u32 m0, s39, 32768
    s_mov_b32 s37, 2621440
    v_mfma_f32_16x16x32_bf16 v[200:203], a[68:71], a[88:91], v[200:203]
    buffer_load_dwordx4 v44, s[20:23], s37 offen offset:0 lds
    buffer_load_dwordx4 v45, s[20:23], s37 offen offset:1024 lds
    buffer_load_dwordx4 v46, s[20:23], s37 offen offset:2048 lds
    buffer_load_dwordx4 v47, s[20:23], s37 offen offset:3072 lds
    v_mfma_f32_16x16x32_bf16 v[232:235], a[68:71], a[92:95], v[232:235]
    v_mfma_f32_16x16x32_bf16 v[140:143], a[72:75], a[80:83], v[140:143]
    v_mfma_f32_16x16x32_bf16 v[172:175], a[72:75], a[84:87], v[172:175]
    v_mfma_f32_16x16x32_bf16 v[204:207], a[72:75], a[88:91], v[204:207]
    v_mfma_f32_16x16x32_bf16 v[236:239], a[72:75], a[92:95], v[236:239]
    s_add_u32 m0, s38, 16384
    s_mov_b32 s36, 640
    v_mfma_f32_16x16x32_bf16 v[144:147], a[76:79], a[80:83], v[144:147]
    buffer_load_dwordx4 v36, s[16:19], s36 offen offset:0 lds
    buffer_load_dwordx4 v37, s[16:19], s36 offen offset:1024 lds
    buffer_load_dwordx4 v38, s[16:19], s36 offen offset:2048 lds
    buffer_load_dwordx4 v39, s[16:19], s36 offen offset:3072 lds
    v_mfma_f32_16x16x32_bf16 v[176:179], a[76:79], a[84:87], v[176:179]
    v_mfma_f32_16x16x32_bf16 v[208:211], a[76:79], a[88:91], v[208:211]
    v_mfma_f32_16x16x32_bf16 v[240:243], a[76:79], a[92:95], v[240:243]
    s_waitcnt lgkmcnt(0)
    v_mfma_f32_16x16x32_bf16 v[100:103], a[0:3], v[32:35], v[100:103]
    ds_read_b64_tr_b16 a[48:49], v50 offset:8192
    v_mfma_f32_16x16x32_bf16 v[104:107], a[4:7], v[32:35], v[104:107]
    ds_read_b64_tr_b16 a[50:51], v50 offset:9216
    v_mfma_f32_16x16x32_bf16 v[116:119], a[0:3], a[32:35], v[116:119]
    ds_read_b128 a[80:83], v49 offset:0
    v_mfma_f32_16x16x32_bf16 v[148:151], a[0:3], a[36:39], v[148:151]
    ds_read_b128 a[84:87], v49 offset:2048
    v_mfma_f32_16x16x32_bf16 v[180:183], a[0:3], a[40:43], v[180:183]
    ds_read_b128 a[88:91], v49 offset:4096
    v_mfma_f32_16x16x32_bf16 v[212:215], a[0:3], a[44:47], v[212:215]
    ds_read_b128 a[92:95], v49 offset:6144
    v_mfma_f32_16x16x32_bf16 v[120:123], a[4:7], a[32:35], v[120:123]
    ds_read_b64_tr_b16 a[52:53], v51 offset:8192
    v_mfma_f32_16x16x32_bf16 v[152:155], a[4:7], a[36:39], v[152:155]
    ds_read_b64_tr_b16 a[54:55], v51 offset:9216
    v_mfma_f32_16x16x32_bf16 v[184:187], a[4:7], a[40:43], v[184:187]
    ds_read_b64_tr_b16 a[56:57], v52 offset:8192
    v_mfma_f32_16x16x32_bf16 v[216:219], a[4:7], a[44:47], v[216:219]
    ds_read_b64_tr_b16 a[58:59], v52 offset:9216
    v_mfma_f32_16x16x32_bf16 v[124:127], a[8:11], a[32:35], v[124:127]
    ds_read_b64_tr_b16 a[60:61], v53 offset:8192
    v_mfma_f32_16x16x32_bf16 v[156:159], a[8:11], a[36:39], v[156:159]
    ds_read_b64_tr_b16 a[62:63], v53 offset:9216
    v_mfma_f32_16x16x32_bf16 v[188:191], a[8:11], a[40:43], v[188:191]
    ds_read_b64_tr_b16 a[64:65], v54 offset:8192
    v_mfma_f32_16x16x32_bf16 v[220:223], a[8:11], a[44:47], v[220:223]
    ds_read_b64_tr_b16 a[66:67], v54 offset:9216
    v_mfma_f32_16x16x32_bf16 v[128:131], a[12:15], a[32:35], v[128:131]
    ds_read_b64_tr_b16 a[68:69], v55 offset:8192
    v_mfma_f32_16x16x32_bf16 v[160:163], a[12:15], a[36:39], v[160:163]
    ds_read_b64_tr_b16 a[70:71], v55 offset:9216
    v_mfma_f32_16x16x32_bf16 v[192:195], a[12:15], a[40:43], v[192:195]
    ds_read_b64_tr_b16 a[72:73], v56 offset:8192
    v_mfma_f32_16x16x32_bf16 v[224:227], a[12:15], a[44:47], v[224:227]
    ds_read_b64_tr_b16 a[74:75], v56 offset:9216
    v_mfma_f32_16x16x32_bf16 v[132:135], a[16:19], a[32:35], v[132:135]
    ds_read_b64_tr_b16 a[76:77], v57 offset:8192
    v_mfma_f32_16x16x32_bf16 v[164:167], a[16:19], a[36:39], v[164:167]
    ds_read_b64_tr_b16 a[78:79], v57 offset:9216
    v_mfma_f32_16x16x32_bf16 v[196:199], a[16:19], a[40:43], v[196:199]
    v_mfma_f32_16x16x32_bf16 v[228:231], a[16:19], a[44:47], v[228:231]
    v_mfma_f32_16x16x32_bf16 v[136:139], a[20:23], a[32:35], v[136:139]
    v_mfma_f32_16x16x32_bf16 v[168:171], a[20:23], a[36:39], v[168:171]
    s_add_u32 m0, s38, 20480
    v_mfma_f32_16x16x32_bf16 v[200:203], a[20:23], a[40:43], v[200:203]
    buffer_load_dwordx4 v40, s[16:19], s36 offen offset:0 lds
    buffer_load_dwordx4 v41, s[16:19], s36 offen offset:1024 lds
    buffer_load_dwordx4 v42, s[16:19], s36 offen offset:2048 lds
    buffer_load_dwordx4 v43, s[16:19], s36 offen offset:3072 lds
    v_mfma_f32_16x16x32_bf16 v[232:235], a[20:23], a[44:47], v[232:235]
    v_mfma_f32_16x16x32_bf16 v[140:143], a[24:27], a[32:35], v[140:143]
    v_mfma_f32_16x16x32_bf16 v[172:175], a[24:27], a[36:39], v[172:175]
    v_mfma_f32_16x16x32_bf16 v[204:207], a[24:27], a[40:43], v[204:207]
    v_mfma_f32_16x16x32_bf16 v[236:239], a[24:27], a[44:47], v[236:239]
    v_mfma_f32_16x16x32_bf16 v[144:147], a[28:31], a[32:35], v[144:147]
    v_mfma_f32_16x16x32_bf16 v[176:179], a[28:31], a[36:39], v[176:179]
    v_mfma_f32_16x16x32_bf16 v[208:211], a[28:31], a[40:43], v[208:211]
    v_mfma_f32_16x16x32_bf16 v[240:243], a[28:31], a[44:47], v[240:243]
    s_waitcnt vmcnt(12) lgkmcnt(0)
    s_barrier
    v_mfma_f32_16x16x32_bf16 v[100:103], a[48:51], v[32:35], v[100:103]
    ds_read_b64_tr_b16 a[0:1], v50 offset:16384
    v_mfma_f32_16x16x32_bf16 v[104:107], a[52:55], v[32:35], v[104:107]
    ds_read_b64_tr_b16 a[2:3], v50 offset:17408
    v_mfma_f32_16x16x32_bf16 v[116:119], a[48:51], a[80:83], v[116:119]
    ds_read_b128 a[32:35], v48 offset:8192
    v_mfma_f32_16x16x32_bf16 v[148:151], a[48:51], a[84:87], v[148:151]
    ds_read_b128 a[36:39], v48 offset:10240
    v_mfma_f32_16x16x32_bf16 v[180:183], a[48:51], a[88:91], v[180:183]
    ds_read_b128 a[40:43], v48 offset:12288
    v_mfma_f32_16x16x32_bf16 v[212:215], a[48:51], a[92:95], v[212:215]
    ds_read_b128 a[44:47], v48 offset:14336
    v_mfma_f32_16x16x32_bf16 v[120:123], a[52:55], a[80:83], v[120:123]
    ds_read_b64_tr_b16 a[4:5], v51 offset:16384
    v_mfma_f32_16x16x32_bf16 v[152:155], a[52:55], a[84:87], v[152:155]
    ds_read_b64_tr_b16 a[6:7], v51 offset:17408
    v_mfma_f32_16x16x32_bf16 v[184:187], a[52:55], a[88:91], v[184:187]
    ds_read_b64_tr_b16 a[8:9], v52 offset:16384
    v_mfma_f32_16x16x32_bf16 v[216:219], a[52:55], a[92:95], v[216:219]
    ds_read_b64_tr_b16 a[10:11], v52 offset:17408
    v_mfma_f32_16x16x32_bf16 v[124:127], a[56:59], a[80:83], v[124:127]
    ds_read_b64_tr_b16 a[12:13], v53 offset:16384
    v_mfma_f32_16x16x32_bf16 v[156:159], a[56:59], a[84:87], v[156:159]
    ds_read_b64_tr_b16 a[14:15], v53 offset:17408
    v_mfma_f32_16x16x32_bf16 v[188:191], a[56:59], a[88:91], v[188:191]
    ds_read_b64_tr_b16 a[16:17], v54 offset:16384
    v_mfma_f32_16x16x32_bf16 v[220:223], a[56:59], a[92:95], v[220:223]
    ds_read_b64_tr_b16 a[18:19], v54 offset:17408
    v_mfma_f32_16x16x32_bf16 v[128:131], a[60:63], a[80:83], v[128:131]
    ds_read_b64_tr_b16 a[20:21], v55 offset:16384
    v_mfma_f32_16x16x32_bf16 v[160:163], a[60:63], a[84:87], v[160:163]
    ds_read_b64_tr_b16 a[22:23], v55 offset:17408
    v_mfma_f32_16x16x32_bf16 v[192:195], a[60:63], a[88:91], v[192:195]
    ds_read_b64_tr_b16 a[24:25], v56 offset:16384
    v_mfma_f32_16x16x32_bf16 v[224:227], a[60:63], a[92:95], v[224:227]
    ds_read_b64_tr_b16 a[26:27], v56 offset:17408
    v_mfma_f32_16x16x32_bf16 v[132:135], a[64:67], a[80:83], v[132:135]
    ds_read_b64_tr_b16 a[28:29], v57 offset:16384
    v_mfma_f32_16x16x32_bf16 v[164:167], a[64:67], a[84:87], v[164:167]
    ds_read_b64_tr_b16 a[30:31], v57 offset:17408
    v_mfma_f32_16x16x32_bf16 v[196:199], a[64:67], a[88:91], v[196:199]
    v_mfma_f32_16x16x32_bf16 v[228:231], a[64:67], a[92:95], v[228:231]
    v_mfma_f32_16x16x32_bf16 v[136:139], a[68:71], a[80:83], v[136:139]
    v_mfma_f32_16x16x32_bf16 v[168:171], a[68:71], a[84:87], v[168:171]
    s_add_u32 m0, s39, 0
    s_mov_b32 s37, 3145728
    v_mfma_f32_16x16x32_bf16 v[200:203], a[68:71], a[88:91], v[200:203]
    buffer_load_dwordx4 v44, s[20:23], s37 offen offset:0 lds
    buffer_load_dwordx4 v45, s[20:23], s37 offen offset:1024 lds
    buffer_load_dwordx4 v46, s[20:23], s37 offen offset:2048 lds
    buffer_load_dwordx4 v47, s[20:23], s37 offen offset:3072 lds
    v_mfma_f32_16x16x32_bf16 v[232:235], a[68:71], a[92:95], v[232:235]
    v_mfma_f32_16x16x32_bf16 v[140:143], a[72:75], a[80:83], v[140:143]
    v_mfma_f32_16x16x32_bf16 v[172:175], a[72:75], a[84:87], v[172:175]
    v_mfma_f32_16x16x32_bf16 v[204:207], a[72:75], a[88:91], v[204:207]
    v_mfma_f32_16x16x32_bf16 v[236:239], a[72:75], a[92:95], v[236:239]
    s_add_u32 m0, s38, 0
    s_mov_b32 s36, 768
    v_mfma_f32_16x16x32_bf16 v[144:147], a[76:79], a[80:83], v[144:147]
    buffer_load_dwordx4 v36, s[16:19], s36 offen offset:0 lds
    buffer_load_dwordx4 v37, s[16:19], s36 offen offset:1024 lds
    buffer_load_dwordx4 v38, s[16:19], s36 offen offset:2048 lds
    buffer_load_dwordx4 v39, s[16:19], s36 offen offset:3072 lds
    v_mfma_f32_16x16x32_bf16 v[176:179], a[76:79], a[84:87], v[176:179]
    v_mfma_f32_16x16x32_bf16 v[208:211], a[76:79], a[88:91], v[208:211]
    v_mfma_f32_16x16x32_bf16 v[240:243], a[76:79], a[92:95], v[240:243]
    s_waitcnt lgkmcnt(0)
    v_mfma_f32_16x16x32_bf16 v[100:103], a[0:3], v[32:35], v[100:103]
    ds_read_b64_tr_b16 a[48:49], v50 offset:24576
    v_mfma_f32_16x16x32_bf16 v[104:107], a[4:7], v[32:35], v[104:107]
    ds_read_b64_tr_b16 a[50:51], v50 offset:25600
    v_mfma_f32_16x16x32_bf16 v[116:119], a[0:3], a[32:35], v[116:119]
    ds_read_b128 a[80:83], v49 offset:8192
    v_mfma_f32_16x16x32_bf16 v[148:151], a[0:3], a[36:39], v[148:151]
    ds_read_b128 a[84:87], v49 offset:10240
    v_mfma_f32_16x16x32_bf16 v[180:183], a[0:3], a[40:43], v[180:183]
    ds_read_b128 a[88:91], v49 offset:12288
    v_mfma_f32_16x16x32_bf16 v[212:215], a[0:3], a[44:47], v[212:215]
    ds_read_b128 a[92:95], v49 offset:14336
    v_mfma_f32_16x16x32_bf16 v[120:123], a[4:7], a[32:35], v[120:123]
    ds_read_b64_tr_b16 a[52:53], v51 offset:24576
    v_mfma_f32_16x16x32_bf16 v[152:155], a[4:7], a[36:39], v[152:155]
    ds_read_b64_tr_b16 a[54:55], v51 offset:25600
    v_mfma_f32_16x16x32_bf16 v[184:187], a[4:7], a[40:43], v[184:187]
    ds_read_b64_tr_b16 a[56:57], v52 offset:24576
    v_mfma_f32_16x16x32_bf16 v[216:219], a[4:7], a[44:47], v[216:219]
    ds_read_b64_tr_b16 a[58:59], v52 offset:25600
    v_mfma_f32_16x16x32_bf16 v[124:127], a[8:11], a[32:35], v[124:127]
    ds_read_b64_tr_b16 a[60:61], v53 offset:24576
    v_mfma_f32_16x16x32_bf16 v[156:159], a[8:11], a[36:39], v[156:159]
    ds_read_b64_tr_b16 a[62:63], v53 offset:25600
    v_mfma_f32_16x16x32_bf16 v[188:191], a[8:11], a[40:43], v[188:191]
    ds_read_b64_tr_b16 a[64:65], v54 offset:24576
    v_mfma_f32_16x16x32_bf16 v[220:223], a[8:11], a[44:47], v[220:223]
    ds_read_b64_tr_b16 a[66:67], v54 offset:25600
    v_mfma_f32_16x16x32_bf16 v[128:131], a[12:15], a[32:35], v[128:131]
    ds_read_b64_tr_b16 a[68:69], v55 offset:24576
    v_mfma_f32_16x16x32_bf16 v[160:163], a[12:15], a[36:39], v[160:163]
    ds_read_b64_tr_b16 a[70:71], v55 offset:25600
    v_mfma_f32_16x16x32_bf16 v[192:195], a[12:15], a[40:43], v[192:195]
    ds_read_b64_tr_b16 a[72:73], v56 offset:24576
    v_mfma_f32_16x16x32_bf16 v[224:227], a[12:15], a[44:47], v[224:227]
    ds_read_b64_tr_b16 a[74:75], v56 offset:25600
    v_mfma_f32_16x16x32_bf16 v[132:135], a[16:19], a[32:35], v[132:135]
    ds_read_b64_tr_b16 a[76:77], v57 offset:24576
    v_mfma_f32_16x16x32_bf16 v[164:167], a[16:19], a[36:39], v[164:167]
    ds_read_b64_tr_b16 a[78:79], v57 offset:25600
    v_mfma_f32_16x16x32_bf16 v[196:199], a[16:19], a[40:43], v[196:199]
    v_mfma_f32_16x16x32_bf16 v[228:231], a[16:19], a[44:47], v[228:231]
    v_mfma_f32_16x16x32_bf16 v[136:139], a[20:23], a[32:35], v[136:139]
    v_mfma_f32_16x16x32_bf16 v[168:171], a[20:23], a[36:39], v[168:171]
    s_add_u32 m0, s38, 4096
    v_mfma_f32_16x16x32_bf16 v[200:203], a[20:23], a[40:43], v[200:203]
    buffer_load_dwordx4 v40, s[16:19], s36 offen offset:0 lds
    buffer_load_dwordx4 v41, s[16:19], s36 offen offset:1024 lds
    buffer_load_dwordx4 v42, s[16:19], s36 offen offset:2048 lds
    buffer_load_dwordx4 v43, s[16:19], s36 offen offset:3072 lds
    v_mfma_f32_16x16x32_bf16 v[232:235], a[20:23], a[44:47], v[232:235]
    v_mfma_f32_16x16x32_bf16 v[140:143], a[24:27], a[32:35], v[140:143]
    v_mfma_f32_16x16x32_bf16 v[172:175], a[24:27], a[36:39], v[172:175]
    v_mfma_f32_16x16x32_bf16 v[204:207], a[24:27], a[40:43], v[204:207]
    v_mfma_f32_16x16x32_bf16 v[236:239], a[24:27], a[44:47], v[236:239]
    v_mfma_f32_16x16x32_bf16 v[144:147], a[28:31], a[32:35], v[144:147]
    v_mfma_f32_16x16x32_bf16 v[176:179], a[28:31], a[36:39], v[176:179]
    v_mfma_f32_16x16x32_bf16 v[208:211], a[28:31], a[40:43], v[208:211]
    v_mfma_f32_16x16x32_bf16 v[240:243], a[28:31], a[44:47], v[240:243]
    s_waitcnt vmcnt(12) lgkmcnt(0)
    s_barrier
    v_mfma_f32_16x16x32_bf16 v[100:103], a[48:51], v[32:35], v[100:103]
    ds_read_b64_tr_b16 a[0:1], v50 offset:32768
    v_mfma_f32_16x16x32_bf16 v[104:107], a[52:55], v[32:35], v[104:107]
    ds_read_b64_tr_b16 a[2:3], v50 offset:33792
    v_mfma_f32_16x16x32_bf16 v[116:119], a[48:51], a[80:83], v[116:119]
    ds_read_b128 a[32:35], v48 offset:16384
    v_mfma_f32_16x16x32_bf16 v[148:151], a[48:51], a[84:87], v[148:151]
    ds_read_b128 a[36:39], v48 offset:18432
    v_mfma_f32_16x16x32_bf16 v[180:183], a[48:51], a[88:91], v[180:183]
    ds_read_b128 a[40:43], v48 offset:20480
    v_mfma_f32_16x16x32_bf16 v[212:215], a[48:51], a[92:95], v[212:215]
    ds_read_b128 a[44:47], v48 offset:22528
    v_mfma_f32_16x16x32_bf16 v[120:123], a[52:55], a[80:83], v[120:123]
    ds_read_b64_tr_b16 a[4:5], v51 offset:32768
    v_mfma_f32_16x16x32_bf16 v[152:155], a[52:55], a[84:87], v[152:155]
    ds_read_b64_tr_b16 a[6:7], v51 offset:33792
    v_mfma_f32_16x16x32_bf16 v[184:187], a[52:55], a[88:91], v[184:187]
    ds_read_b64_tr_b16 a[8:9], v52 offset:32768
    v_mfma_f32_16x16x32_bf16 v[216:219], a[52:55], a[92:95], v[216:219]
    ds_read_b64_tr_b16 a[10:11], v52 offset:33792
    v_mfma_f32_16x16x32_bf16 v[124:127], a[56:59], a[80:83], v[124:127]
    ds_read_b64_tr_b16 a[12:13], v53 offset:32768
    v_mfma_f32_16x16x32_bf16 v[156:159], a[56:59], a[84:87], v[156:159]
    ds_read_b64_tr_b16 a[14:15], v53 offset:33792
    v_mfma_f32_16x16x32_bf16 v[188:191], a[56:59], a[88:91], v[188:191]
    ds_read_b64_tr_b16 a[16:17], v54 offset:32768
    v_mfma_f32_16x16x32_bf16 v[220:223], a[56:59], a[92:95], v[220:223]
    ds_read_b64_tr_b16 a[18:19], v54 offset:33792
    v_mfma_f32_16x16x32_bf16 v[128:131], a[60:63], a[80:83], v[128:131]
    ds_read_b64_tr_b16 a[20:21], v55 offset:32768
    v_mfma_f32_16x16x32_bf16 v[160:163], a[60:63], a[84:87], v[160:163]
    ds_read_b64_tr_b16 a[22:23], v55 offset:33792
    v_mfma_f32_16x16x32_bf16 v[192:195], a[60:63], a[88:91], v[192:195]
    ds_read_b64_tr_b16 a[24:25], v56 offset:32768
    v_mfma_f32_16x16x32_bf16 v[224:227], a[60:63], a[92:95], v[224:227]
    ds_read_b64_tr_b16 a[26:27], v56 offset:33792
    v_mfma_f32_16x16x32_bf16 v[132:135], a[64:67], a[80:83], v[132:135]
    ds_read_b64_tr_b16 a[28:29], v57 offset:32768
    v_mfma_f32_16x16x32_bf16 v[164:167], a[64:67], a[84:87], v[164:167]
    ds_read_b64_tr_b16 a[30:31], v57 offset:33792
    v_mfma_f32_16x16x32_bf16 v[196:199], a[64:67], a[88:91], v[196:199]
    v_mfma_f32_16x16x32_bf16 v[228:231], a[64:67], a[92:95], v[228:231]
    v_mfma_f32_16x16x32_bf16 v[136:139], a[68:71], a[80:83], v[136:139]
    v_mfma_f32_16x16x32_bf16 v[168:171], a[68:71], a[84:87], v[168:171]
    s_add_u32 m0, s39, 16384
    s_mov_b32 s37, 3670016
    v_mfma_f32_16x16x32_bf16 v[200:203], a[68:71], a[88:91], v[200:203]
    buffer_load_dwordx4 v44, s[20:23], s37 offen offset:0 lds
    buffer_load_dwordx4 v45, s[20:23], s37 offen offset:1024 lds
    buffer_load_dwordx4 v46, s[20:23], s37 offen offset:2048 lds
    buffer_load_dwordx4 v47, s[20:23], s37 offen offset:3072 lds
    v_mfma_f32_16x16x32_bf16 v[232:235], a[68:71], a[92:95], v[232:235]
    v_mfma_f32_16x16x32_bf16 v[140:143], a[72:75], a[80:83], v[140:143]
    v_mfma_f32_16x16x32_bf16 v[172:175], a[72:75], a[84:87], v[172:175]
    v_mfma_f32_16x16x32_bf16 v[204:207], a[72:75], a[88:91], v[204:207]
    v_mfma_f32_16x16x32_bf16 v[236:239], a[72:75], a[92:95], v[236:239]
    s_add_u32 m0, s38, 8192
    s_mov_b32 s36, 896
    v_mfma_f32_16x16x32_bf16 v[144:147], a[76:79], a[80:83], v[144:147]
    buffer_load_dwordx4 v36, s[16:19], s36 offen offset:0 lds
    buffer_load_dwordx4 v37, s[16:19], s36 offen offset:1024 lds
    buffer_load_dwordx4 v38, s[16:19], s36 offen offset:2048 lds
    buffer_load_dwordx4 v39, s[16:19], s36 offen offset:3072 lds
    v_mfma_f32_16x16x32_bf16 v[176:179], a[76:79], a[84:87], v[176:179]
    v_mfma_f32_16x16x32_bf16 v[208:211], a[76:79], a[88:91], v[208:211]
    v_mfma_f32_16x16x32_bf16 v[240:243], a[76:79], a[92:95], v[240:243]
    s_waitcnt lgkmcnt(0)
    v_mfma_f32_16x16x32_bf16 v[100:103], a[0:3], v[32:35], v[100:103]
    ds_read_b64_tr_b16 a[48:49], v50 offset:40960
    v_mfma_f32_16x16x32_bf16 v[104:107], a[4:7], v[32:35], v[104:107]
    ds_read_b64_tr_b16 a[50:51], v50 offset:41984
    v_mfma_f32_16x16x32_bf16 v[116:119], a[0:3], a[32:35], v[116:119]
    ds_read_b128 a[80:83], v49 offset:16384
    v_mfma_f32_16x16x32_bf16 v[148:151], a[0:3], a[36:39], v[148:151]
    ds_read_b128 a[84:87], v49 offset:18432
    v_mfma_f32_16x16x32_bf16 v[180:183], a[0:3], a[40:43], v[180:183]
    ds_read_b128 a[88:91], v49 offset:20480
    v_mfma_f32_16x16x32_bf16 v[212:215], a[0:3], a[44:47], v[212:215]
    ds_read_b128 a[92:95], v49 offset:22528
    v_mfma_f32_16x16x32_bf16 v[120:123], a[4:7], a[32:35], v[120:123]
    ds_read_b64_tr_b16 a[52:53], v51 offset:40960
    v_mfma_f32_16x16x32_bf16 v[152:155], a[4:7], a[36:39], v[152:155]
    ds_read_b64_tr_b16 a[54:55], v51 offset:41984
    v_mfma_f32_16x16x32_bf16 v[184:187], a[4:7], a[40:43], v[184:187]
    ds_read_b64_tr_b16 a[56:57], v52 offset:40960
    v_mfma_f32_16x16x32_bf16 v[216:219], a[4:7], a[44:47], v[216:219]
    ds_read_b64_tr_b16 a[58:59], v52 offset:41984
    v_mfma_f32_16x16x32_bf16 v[124:127], a[8:11], a[32:35], v[124:127]
    ds_read_b64_tr_b16 a[60:61], v53 offset:40960
    v_mfma_f32_16x16x32_bf16 v[156:159], a[8:11], a[36:39], v[156:159]
    ds_read_b64_tr_b16 a[62:63], v53 offset:41984
    v_mfma_f32_16x16x32_bf16 v[188:191], a[8:11], a[40:43], v[188:191]
    ds_read_b64_tr_b16 a[64:65], v54 offset:40960
    v_mfma_f32_16x16x32_bf16 v[220:223], a[8:11], a[44:47], v[220:223]
    ds_read_b64_tr_b16 a[66:67], v54 offset:41984
    v_mfma_f32_16x16x32_bf16 v[128:131], a[12:15], a[32:35], v[128:131]
    ds_read_b64_tr_b16 a[68:69], v55 offset:40960
    v_mfma_f32_16x16x32_bf16 v[160:163], a[12:15], a[36:39], v[160:163]
    ds_read_b64_tr_b16 a[70:71], v55 offset:41984
    v_mfma_f32_16x16x32_bf16 v[192:195], a[12:15], a[40:43], v[192:195]
    ds_read_b64_tr_b16 a[72:73], v56 offset:40960
    v_mfma_f32_16x16x32_bf16 v[224:227], a[12:15], a[44:47], v[224:227]
    ds_read_b64_tr_b16 a[74:75], v56 offset:41984
    v_mfma_f32_16x16x32_bf16 v[132:135], a[16:19], a[32:35], v[132:135]
    ds_read_b64_tr_b16 a[76:77], v57 offset:40960
    v_mfma_f32_16x16x32_bf16 v[164:167], a[16:19], a[36:39], v[164:167]
    ds_read_b64_tr_b16 a[78:79], v57 offset:41984
    v_mfma_f32_16x16x32_bf16 v[196:199], a[16:19], a[40:43], v[196:199]
    v_mfma_f32_16x16x32_bf16 v[228:231], a[16:19], a[44:47], v[228:231]
    v_mfma_f32_16x16x32_bf16 v[136:139], a[20:23], a[32:35], v[136:139]
    v_mfma_f32_16x16x32_bf16 v[168:171], a[20:23], a[36:39], v[168:171]
    s_add_u32 m0, s38, 12288
    v_mfma_f32_16x16x32_bf16 v[200:203], a[20:23], a[40:43], v[200:203]
    buffer_load_dwordx4 v40, s[16:19], s36 offen offset:0 lds
    buffer_load_dwordx4 v41, s[16:19], s36 offen offset:1024 lds
    buffer_load_dwordx4 v42, s[16:19], s36 offen offset:2048 lds
    buffer_load_dwordx4 v43, s[16:19], s36 offen offset:3072 lds
    v_mfma_f32_16x16x32_bf16 v[232:235], a[20:23], a[44:47], v[232:235]
    v_mfma_f32_16x16x32_bf16 v[140:143], a[24:27], a[32:35], v[140:143]
    v_mfma_f32_16x16x32_bf16 v[172:175], a[24:27], a[36:39], v[172:175]
    v_mfma_f32_16x16x32_bf16 v[204:207], a[24:27], a[40:43], v[204:207]
    v_mfma_f32_16x16x32_bf16 v[236:239], a[24:27], a[44:47], v[236:239]
    v_mfma_f32_16x16x32_bf16 v[144:147], a[28:31], a[32:35], v[144:147]
    v_mfma_f32_16x16x32_bf16 v[176:179], a[28:31], a[36:39], v[176:179]
    v_mfma_f32_16x16x32_bf16 v[208:211], a[28:31], a[40:43], v[208:211]
    v_mfma_f32_16x16x32_bf16 v[240:243], a[28:31], a[44:47], v[240:243]
    s_waitcnt vmcnt(12) lgkmcnt(0)
    s_barrier
    v_mfma_f32_16x16x32_bf16 v[100:103], a[48:51], v[32:35], v[100:103]
    ds_read_b64_tr_b16 a[0:1], v50 offset:0
    v_mfma_f32_16x16x32_bf16 v[104:107], a[52:55], v[32:35], v[104:107]
    ds_read_b64_tr_b16 a[2:3], v50 offset:1024
    v_mfma_f32_16x16x32_bf16 v[116:119], a[48:51], a[80:83], v[116:119]
    ds_read_b128 a[32:35], v48 offset:0
    v_mfma_f32_16x16x32_bf16 v[148:151], a[48:51], a[84:87], v[148:151]
    ds_read_b128 a[36:39], v48 offset:2048
    v_mfma_f32_16x16x32_bf16 v[180:183], a[48:51], a[88:91], v[180:183]
    ds_read_b128 a[40:43], v48 offset:4096
    v_mfma_f32_16x16x32_bf16 v[212:215], a[48:51], a[92:95], v[212:215]
    ds_read_b128 a[44:47], v48 offset:6144
    v_mfma_f32_16x16x32_bf16 v[120:123], a[52:55], a[80:83], v[120:123]
    ds_read_b64_tr_b16 a[4:5], v51 offset:0
    v_mfma_f32_16x16x32_bf16 v[152:155], a[52:55], a[84:87], v[152:155]
    ds_read_b64_tr_b16 a[6:7], v51 offset:1024
    v_mfma_f32_16x16x32_bf16 v[184:187], a[52:55], a[88:91], v[184:187]
    ds_read_b64_tr_b16 a[8:9], v52 offset:0
    v_mfma_f32_16x16x32_bf16 v[216:219], a[52:55], a[92:95], v[216:219]
    ds_read_b64_tr_b16 a[10:11], v52 offset:1024
    v_mfma_f32_16x16x32_bf16 v[124:127], a[56:59], a[80:83], v[124:127]
    ds_read_b64_tr_b16 a[12:13], v53 offset:0
    v_mfma_f32_16x16x32_bf16 v[156:159], a[56:59], a[84:87], v[156:159]
    ds_read_b64_tr_b16 a[14:15], v53 offset:1024
    v_mfma_f32_16x16x32_bf16 v[188:191], a[56:59], a[88:91], v[188:191]
    ds_read_b64_tr_b16 a[16:17], v54 offset:0
    v_mfma_f32_16x16x32_bf16 v[220:223], a[56:59], a[92:95], v[220:223]
    ds_read_b64_tr_b16 a[18:19], v54 offset:1024
    v_mfma_f32_16x16x32_bf16 v[128:131], a[60:63], a[80:83], v[128:131]
    ds_read_b64_tr_b16 a[20:21], v55 offset:0
    v_mfma_f32_16x16x32_bf16 v[160:163], a[60:63], a[84:87], v[160:163]
    ds_read_b64_tr_b16 a[22:23], v55 offset:1024
    v_mfma_f32_16x16x32_bf16 v[192:195], a[60:63], a[88:91], v[192:195]
    ds_read_b64_tr_b16 a[24:25], v56 offset:0
    v_mfma_f32_16x16x32_bf16 v[224:227], a[60:63], a[92:95], v[224:227]
    ds_read_b64_tr_b16 a[26:27], v56 offset:1024
    v_mfma_f32_16x16x32_bf16 v[132:135], a[64:67], a[80:83], v[132:135]
    ds_read_b64_tr_b16 a[28:29], v57 offset:0
    v_mfma_f32_16x16x32_bf16 v[164:167], a[64:67], a[84:87], v[164:167]
    ds_read_b64_tr_b16 a[30:31], v57 offset:1024
    v_mfma_f32_16x16x32_bf16 v[196:199], a[64:67], a[88:91], v[196:199]
    v_mfma_f32_16x16x32_bf16 v[228:231], a[64:67], a[92:95], v[228:231]
    v_mfma_f32_16x16x32_bf16 v[136:139], a[68:71], a[80:83], v[136:139]
    v_mfma_f32_16x16x32_bf16 v[168:171], a[68:71], a[84:87], v[168:171]
    s_add_u32 m0, s39, 32768
    s_mov_b32 s37, 4194304
    v_mfma_f32_16x16x32_bf16 v[200:203], a[68:71], a[88:91], v[200:203]
    buffer_load_dwordx4 v44, s[20:23], s37 offen offset:0 lds
    buffer_load_dwordx4 v45, s[20:23], s37 offen offset:1024 lds
    buffer_load_dwordx4 v46, s[20:23], s37 offen offset:2048 lds
    buffer_load_dwordx4 v47, s[20:23], s37 offen offset:3072 lds
    v_mfma_f32_16x16x32_bf16 v[232:235], a[68:71], a[92:95], v[232:235]
    v_mfma_f32_16x16x32_bf16 v[140:143], a[72:75], a[80:83], v[140:143]
    v_mfma_f32_16x16x32_bf16 v[172:175], a[72:75], a[84:87], v[172:175]
    v_mfma_f32_16x16x32_bf16 v[204:207], a[72:75], a[88:91], v[204:207]
    v_mfma_f32_16x16x32_bf16 v[236:239], a[72:75], a[92:95], v[236:239]
    s_add_u32 m0, s38, 16384
    s_mov_b32 s36, 1024
    v_mfma_f32_16x16x32_bf16 v[144:147], a[76:79], a[80:83], v[144:147]
    buffer_load_dwordx4 v36, s[16:19], s36 offen offset:0 lds
    buffer_load_dwordx4 v37, s[16:19], s36 offen offset:1024 lds
    buffer_load_dwordx4 v38, s[16:19], s36 offen offset:2048 lds
    buffer_load_dwordx4 v39, s[16:19], s36 offen offset:3072 lds
    v_mfma_f32_16x16x32_bf16 v[176:179], a[76:79], a[84:87], v[176:179]
    v_mfma_f32_16x16x32_bf16 v[208:211], a[76:79], a[88:91], v[208:211]
    v_mfma_f32_16x16x32_bf16 v[240:243], a[76:79], a[92:95], v[240:243]
    s_waitcnt lgkmcnt(0)
    v_mfma_f32_16x16x32_bf16 v[100:103], a[0:3], v[32:35], v[100:103]
    ds_read_b64_tr_b16 a[48:49], v50 offset:8192
    v_mfma_f32_16x16x32_bf16 v[104:107], a[4:7], v[32:35], v[104:107]
    ds_read_b64_tr_b16 a[50:51], v50 offset:9216
    v_mfma_f32_16x16x32_bf16 v[116:119], a[0:3], a[32:35], v[116:119]
    ds_read_b128 a[80:83], v49 offset:0
    v_mfma_f32_16x16x32_bf16 v[148:151], a[0:3], a[36:39], v[148:151]
    ds_read_b128 a[84:87], v49 offset:2048
    v_mfma_f32_16x16x32_bf16 v[180:183], a[0:3], a[40:43], v[180:183]
    ds_read_b128 a[88:91], v49 offset:4096
    v_mfma_f32_16x16x32_bf16 v[212:215], a[0:3], a[44:47], v[212:215]
    ds_read_b128 a[92:95], v49 offset:6144
    v_mfma_f32_16x16x32_bf16 v[120:123], a[4:7], a[32:35], v[120:123]
    ds_read_b64_tr_b16 a[52:53], v51 offset:8192
    v_mfma_f32_16x16x32_bf16 v[152:155], a[4:7], a[36:39], v[152:155]
    ds_read_b64_tr_b16 a[54:55], v51 offset:9216
    v_mfma_f32_16x16x32_bf16 v[184:187], a[4:7], a[40:43], v[184:187]
    ds_read_b64_tr_b16 a[56:57], v52 offset:8192
    v_mfma_f32_16x16x32_bf16 v[216:219], a[4:7], a[44:47], v[216:219]
    ds_read_b64_tr_b16 a[58:59], v52 offset:9216
    v_mfma_f32_16x16x32_bf16 v[124:127], a[8:11], a[32:35], v[124:127]
    ds_read_b64_tr_b16 a[60:61], v53 offset:8192
    v_mfma_f32_16x16x32_bf16 v[156:159], a[8:11], a[36:39], v[156:159]
    ds_read_b64_tr_b16 a[62:63], v53 offset:9216
    v_mfma_f32_16x16x32_bf16 v[188:191], a[8:11], a[40:43], v[188:191]
    ds_read_b64_tr_b16 a[64:65], v54 offset:8192
    v_mfma_f32_16x16x32_bf16 v[220:223], a[8:11], a[44:47], v[220:223]
    ds_read_b64_tr_b16 a[66:67], v54 offset:9216
    v_mfma_f32_16x16x32_bf16 v[128:131], a[12:15], a[32:35], v[128:131]
    ds_read_b64_tr_b16 a[68:69], v55 offset:8192
    v_mfma_f32_16x16x32_bf16 v[160:163], a[12:15], a[36:39], v[160:163]
    ds_read_b64_tr_b16 a[70:71], v55 offset:9216
    v_mfma_f32_16x16x32_bf16 v[192:195], a[12:15], a[40:43], v[192:195]
    ds_read_b64_tr_b16 a[72:73], v56 offset:8192
    v_mfma_f32_16x16x32_bf16 v[224:227], a[12:15], a[44:47], v[224:227]
    ds_read_b64_tr_b16 a[74:75], v56 offset:9216
    v_mfma_f32_16x16x32_bf16 v[132:135], a[16:19], a[32:35], v[132:135]
    ds_read_b64_tr_b16 a[76:77], v57 offset:8192
    v_mfma_f32_16x16x32_bf16 v[164:167], a[16:19], a[36:39], v[164:167]
    ds_read_b64_tr_b16 a[78:79], v57 offset:9216
    v_mfma_f32_16x16x32_bf16 v[196:199], a[16:19], a[40:43], v[196:199]
    v_mfma_f32_16x16x32_bf16 v[228:231], a[16:19], a[44:47], v[228:231]
    v_mfma_f32_16x16x32_bf16 v[136:139], a[20:23], a[32:35], v[136:139]
    v_mfma_f32_16x16x32_bf16 v[168:171], a[20:23], a[36:39], v[168:171]
    s_add_u32 m0, s38, 20480
    v_mfma_f32_16x16x32_bf16 v[200:203], a[20:23], a[40:43], v[200:203]
    buffer_load_dwordx4 v40, s[16:19], s36 offen offset:0 lds
    buffer_load_dwordx4 v41, s[16:19], s36 offen offset:1024 lds
    buffer_load_dwordx4 v42, s[16:19], s36 offen offset:2048 lds
    buffer_load_dwordx4 v43, s[16:19], s36 offen offset:3072 lds
    v_mfma_f32_16x16x32_bf16 v[232:235], a[20:23], a[44:47], v[232:235]
    v_mfma_f32_16x16x32_bf16 v[140:143], a[24:27], a[32:35], v[140:143]
    v_mfma_f32_16x16x32_bf16 v[172:175], a[24:27], a[36:39], v[172:175]
    v_mfma_f32_16x16x32_bf16 v[204:207], a[24:27], a[40:43], v[204:207]
    v_mfma_f32_16x16x32_bf16 v[236:239], a[24:27], a[44:47], v[236:239]
    v_mfma_f32_16x16x32_bf16 v[144:147], a[28:31], a[32:35], v[144:147]
    v_mfma_f32_16x16x32_bf16 v[176:179], a[28:31], a[36:39], v[176:179]
    v_mfma_f32_16x16x32_bf16 v[208:211], a[28:31], a[40:43], v[208:211]
    v_mfma_f32_16x16x32_bf16 v[240:243], a[28:31], a[44:47], v[240:243]
    s_waitcnt vmcnt(12) lgkmcnt(0)
    s_barrier
    v_mfma_f32_16x16x32_bf16 v[100:103], a[48:51], v[32:35], v[100:103]
    ds_read_b64_tr_b16 a[0:1], v50 offset:16384
    v_mfma_f32_16x16x32_bf16 v[104:107], a[52:55], v[32:35], v[104:107]
    ds_read_b64_tr_b16 a[2:3], v50 offset:17408
    v_mfma_f32_16x16x32_bf16 v[116:119], a[48:51], a[80:83], v[116:119]
    ds_read_b128 a[32:35], v48 offset:8192
    v_mfma_f32_16x16x32_bf16 v[148:151], a[48:51], a[84:87], v[148:151]
    ds_read_b128 a[36:39], v48 offset:10240
    v_mfma_f32_16x16x32_bf16 v[180:183], a[48:51], a[88:91], v[180:183]
    ds_read_b128 a[40:43], v48 offset:12288
    v_mfma_f32_16x16x32_bf16 v[212:215], a[48:51], a[92:95], v[212:215]
    ds_read_b128 a[44:47], v48 offset:14336
    v_mfma_f32_16x16x32_bf16 v[120:123], a[52:55], a[80:83], v[120:123]
    ds_read_b64_tr_b16 a[4:5], v51 offset:16384
    v_mfma_f32_16x16x32_bf16 v[152:155], a[52:55], a[84:87], v[152:155]
    ds_read_b64_tr_b16 a[6:7], v51 offset:17408
    v_mfma_f32_16x16x32_bf16 v[184:187], a[52:55], a[88:91], v[184:187]
    ds_read_b64_tr_b16 a[8:9], v52 offset:16384
    v_mfma_f32_16x16x32_bf16 v[216:219], a[52:55], a[92:95], v[216:219]
    ds_read_b64_tr_b16 a[10:11], v52 offset:17408
    v_mfma_f32_16x16x32_bf16 v[124:127], a[56:59], a[80:83], v[124:127]
    ds_read_b64_tr_b16 a[12:13], v53 offset:16384
    v_mfma_f32_16x16x32_bf16 v[156:159], a[56:59], a[84:87], v[156:159]
    ds_read_b64_tr_b16 a[14:15], v53 offset:17408
    v_mfma_f32_16x16x32_bf16 v[188:191], a[56:59], a[88:91], v[188:191]
    ds_read_b64_tr_b16 a[16:17], v54 offset:16384
    v_mfma_f32_16x16x32_bf16 v[220:223], a[56:59], a[92:95], v[220:223]
    ds_read_b64_tr_b16 a[18:19], v54 offset:17408
    v_mfma_f32_16x16x32_bf16 v[128:131], a[60:63], a[80:83], v[128:131]
    ds_read_b64_tr_b16 a[20:21], v55 offset:16384
    v_mfma_f32_16x16x32_bf16 v[160:163], a[60:63], a[84:87], v[160:163]
    ds_read_b64_tr_b16 a[22:23], v55 offset:17408
    v_mfma_f32_16x16x32_bf16 v[192:195], a[60:63], a[88:91], v[192:195]
    ds_read_b64_tr_b16 a[24:25], v56 offset:16384
    v_mfma_f32_16x16x32_bf16 v[224:227], a[60:63], a[92:95], v[224:227]
    ds_read_b64_tr_b16 a[26:27], v56 offset:17408
    v_mfma_f32_16x16x32_bf16 v[132:135], a[64:67], a[80:83], v[132:135]
    ds_read_b64_tr_b16 a[28:29], v57 offset:16384
    v_mfma_f32_16x16x32_bf16 v[164:167], a[64:67], a[84:87], v[164:167]
    ds_read_b64_tr_b16 a[30:31], v57 offset:17408
    v_mfma_f32_16x16x32_bf16 v[196:199], a[64:67], a[88:91], v[196:199]
    v_mfma_f32_16x16x32_bf16 v[228:231], a[64:67], a[92:95], v[228:231]
    v_mfma_f32_16x16x32_bf16 v[136:139], a[68:71], a[80:83], v[136:139]
    v_mfma_f32_16x16x32_bf16 v[168:171], a[68:71], a[84:87], v[168:171]
    s_add_u32 m0, s39, 0
    s_mov_b32 s37, 4718592
    v_mfma_f32_16x16x32_bf16 v[200:203], a[68:71], a[88:91], v[200:203]
    buffer_load_dwordx4 v44, s[20:23], s37 offen offset:0 lds
    buffer_load_dwordx4 v45, s[20:23], s37 offen offset:1024 lds
    buffer_load_dwordx4 v46, s[20:23], s37 offen offset:2048 lds
    buffer_load_dwordx4 v47, s[20:23], s37 offen offset:3072 lds
    v_mfma_f32_16x16x32_bf16 v[232:235], a[68:71], a[92:95], v[232:235]
    v_mfma_f32_16x16x32_bf16 v[140:143], a[72:75], a[80:83], v[140:143]
    v_mfma_f32_16x16x32_bf16 v[172:175], a[72:75], a[84:87], v[172:175]
    v_mfma_f32_16x16x32_bf16 v[204:207], a[72:75], a[88:91], v[204:207]
    v_mfma_f32_16x16x32_bf16 v[236:239], a[72:75], a[92:95], v[236:239]
    s_add_u32 m0, s38, 0
    s_mov_b32 s36, 1152
    v_mfma_f32_16x16x32_bf16 v[144:147], a[76:79], a[80:83], v[144:147]
    buffer_load_dwordx4 v36, s[16:19], s36 offen offset:0 lds
    buffer_load_dwordx4 v37, s[16:19], s36 offen offset:1024 lds
    buffer_load_dwordx4 v38, s[16:19], s36 offen offset:2048 lds
    buffer_load_dwordx4 v39, s[16:19], s36 offen offset:3072 lds
    v_mfma_f32_16x16x32_bf16 v[176:179], a[76:79], a[84:87], v[176:179]
    v_mfma_f32_16x16x32_bf16 v[208:211], a[76:79], a[88:91], v[208:211]
    v_mfma_f32_16x16x32_bf16 v[240:243], a[76:79], a[92:95], v[240:243]
    s_waitcnt lgkmcnt(0)
    v_mfma_f32_16x16x32_bf16 v[100:103], a[0:3], v[32:35], v[100:103]
    ds_read_b64_tr_b16 a[48:49], v50 offset:24576
    v_mfma_f32_16x16x32_bf16 v[104:107], a[4:7], v[32:35], v[104:107]
    ds_read_b64_tr_b16 a[50:51], v50 offset:25600
    v_mfma_f32_16x16x32_bf16 v[116:119], a[0:3], a[32:35], v[116:119]
    ds_read_b128 a[80:83], v49 offset:8192
    v_mfma_f32_16x16x32_bf16 v[148:151], a[0:3], a[36:39], v[148:151]
    ds_read_b128 a[84:87], v49 offset:10240
    v_mfma_f32_16x16x32_bf16 v[180:183], a[0:3], a[40:43], v[180:183]
    ds_read_b128 a[88:91], v49 offset:12288
    v_mfma_f32_16x16x32_bf16 v[212:215], a[0:3], a[44:47], v[212:215]
    ds_read_b128 a[92:95], v49 offset:14336
    v_mfma_f32_16x16x32_bf16 v[120:123], a[4:7], a[32:35], v[120:123]
    ds_read_b64_tr_b16 a[52:53], v51 offset:24576
    v_mfma_f32_16x16x32_bf16 v[152:155], a[4:7], a[36:39], v[152:155]
    ds_read_b64_tr_b16 a[54:55], v51 offset:25600
    v_mfma_f32_16x16x32_bf16 v[184:187], a[4:7], a[40:43], v[184:187]
    ds_read_b64_tr_b16 a[56:57], v52 offset:24576
    v_mfma_f32_16x16x32_bf16 v[216:219], a[4:7], a[44:47], v[216:219]
    ds_read_b64_tr_b16 a[58:59], v52 offset:25600
    v_mfma_f32_16x16x32_bf16 v[124:127], a[8:11], a[32:35], v[124:127]
    ds_read_b64_tr_b16 a[60:61], v53 offset:24576
    v_mfma_f32_16x16x32_bf16 v[156:159], a[8:11], a[36:39], v[156:159]
    ds_read_b64_tr_b16 a[62:63], v53 offset:25600
    v_mfma_f32_16x16x32_bf16 v[188:191], a[8:11], a[40:43], v[188:191]
    ds_read_b64_tr_b16 a[64:65], v54 offset:24576
    v_mfma_f32_16x16x32_bf16 v[220:223], a[8:11], a[44:47], v[220:223]
    ds_read_b64_tr_b16 a[66:67], v54 offset:25600
    v_mfma_f32_16x16x32_bf16 v[128:131], a[12:15], a[32:35], v[128:131]
    ds_read_b64_tr_b16 a[68:69], v55 offset:24576
    v_mfma_f32_16x16x32_bf16 v[160:163], a[12:15], a[36:39], v[160:163]
    ds_read_b64_tr_b16 a[70:71], v55 offset:25600
    v_mfma_f32_16x16x32_bf16 v[192:195], a[12:15], a[40:43], v[192:195]
    ds_read_b64_tr_b16 a[72:73], v56 offset:24576
    v_mfma_f32_16x16x32_bf16 v[224:227], a[12:15], a[44:47], v[224:227]
    ds_read_b64_tr_b16 a[74:75], v56 offset:25600
    v_mfma_f32_16x16x32_bf16 v[132:135], a[16:19], a[32:35], v[132:135]
    ds_read_b64_tr_b16 a[76:77], v57 offset:24576
    v_mfma_f32_16x16x32_bf16 v[164:167], a[16:19], a[36:39], v[164:167]
    ds_read_b64_tr_b16 a[78:79], v57 offset:25600
    v_mfma_f32_16x16x32_bf16 v[196:199], a[16:19], a[40:43], v[196:199]
    v_mfma_f32_16x16x32_bf16 v[228:231], a[16:19], a[44:47], v[228:231]
    v_mfma_f32_16x16x32_bf16 v[136:139], a[20:23], a[32:35], v[136:139]
    v_mfma_f32_16x16x32_bf16 v[168:171], a[20:23], a[36:39], v[168:171]
    s_add_u32 m0, s38, 4096
    v_mfma_f32_16x16x32_bf16 v[200:203], a[20:23], a[40:43], v[200:203]
    buffer_load_dwordx4 v40, s[16:19], s36 offen offset:0 lds
    buffer_load_dwordx4 v41, s[16:19], s36 offen offset:1024 lds
    buffer_load_dwordx4 v42, s[16:19], s36 offen offset:2048 lds
    buffer_load_dwordx4 v43, s[16:19], s36 offen offset:3072 lds
    v_mfma_f32_16x16x32_bf16 v[232:235], a[20:23], a[44:47], v[232:235]
    v_mfma_f32_16x16x32_bf16 v[140:143], a[24:27], a[32:35], v[140:143]
    v_mfma_f32_16x16x32_bf16 v[172:175], a[24:27], a[36:39], v[172:175]
    v_mfma_f32_16x16x32_bf16 v[204:207], a[24:27], a[40:43], v[204:207]
    v_mfma_f32_16x16x32_bf16 v[236:239], a[24:27], a[44:47], v[236:239]
    v_mfma_f32_16x16x32_bf16 v[144:147], a[28:31], a[32:35], v[144:147]
    v_mfma_f32_16x16x32_bf16 v[176:179], a[28:31], a[36:39], v[176:179]
    v_mfma_f32_16x16x32_bf16 v[208:211], a[28:31], a[40:43], v[208:211]
    v_mfma_f32_16x16x32_bf16 v[240:243], a[28:31], a[44:47], v[240:243]
    s_waitcnt vmcnt(12) lgkmcnt(0)
    s_barrier
    v_mfma_f32_16x16x32_bf16 v[100:103], a[48:51], v[32:35], v[100:103]
    ds_read_b64_tr_b16 a[0:1], v50 offset:32768
    v_mfma_f32_16x16x32_bf16 v[104:107], a[52:55], v[32:35], v[104:107]
    ds_read_b64_tr_b16 a[2:3], v50 offset:33792
    v_mfma_f32_16x16x32_bf16 v[116:119], a[48:51], a[80:83], v[116:119]
    ds_read_b128 a[32:35], v48 offset:16384
    v_mfma_f32_16x16x32_bf16 v[148:151], a[48:51], a[84:87], v[148:151]
    ds_read_b128 a[36:39], v48 offset:18432
    v_mfma_f32_16x16x32_bf16 v[180:183], a[48:51], a[88:91], v[180:183]
    ds_read_b128 a[40:43], v48 offset:20480
    v_mfma_f32_16x16x32_bf16 v[212:215], a[48:51], a[92:95], v[212:215]
    ds_read_b128 a[44:47], v48 offset:22528
    v_mfma_f32_16x16x32_bf16 v[120:123], a[52:55], a[80:83], v[120:123]
    ds_read_b64_tr_b16 a[4:5], v51 offset:32768
    v_mfma_f32_16x16x32_bf16 v[152:155], a[52:55], a[84:87], v[152:155]
    ds_read_b64_tr_b16 a[6:7], v51 offset:33792
    v_mfma_f32_16x16x32_bf16 v[184:187], a[52:55], a[88:91], v[184:187]
    ds_read_b64_tr_b16 a[8:9], v52 offset:32768
    v_mfma_f32_16x16x32_bf16 v[216:219], a[52:55], a[92:95], v[216:219]
    ds_read_b64_tr_b16 a[10:11], v52 offset:33792
    v_mfma_f32_16x16x32_bf16 v[124:127], a[56:59], a[80:83], v[124:127]
    ds_read_b64_tr_b16 a[12:13], v53 offset:32768
    v_mfma_f32_16x16x32_bf16 v[156:159], a[56:59], a[84:87], v[156:159]
    ds_read_b64_tr_b16 a[14:15], v53 offset:33792
    v_mfma_f32_16x16x32_bf16 v[188:191], a[56:59], a[88:91], v[188:191]
    ds_read_b64_tr_b16 a[16:17], v54 offset:32768
    v_mfma_f32_16x16x32_bf16 v[220:223], a[56:59], a[92:95], v[220:223]
    ds_read_b64_tr_b16 a[18:19], v54 offset:33792
    v_mfma_f32_16x16x32_bf16 v[128:131], a[60:63], a[80:83], v[128:131]
    ds_read_b64_tr_b16 a[20:21], v55 offset:32768
    v_mfma_f32_16x16x32_bf16 v[160:163], a[60:63], a[84:87], v[160:163]
    ds_read_b64_tr_b16 a[22:23], v55 offset:33792
    v_mfma_f32_16x16x32_bf16 v[192:195], a[60:63], a[88:91], v[192:195]
    ds_read_b64_tr_b16 a[24:25], v56 offset:32768
    v_mfma_f32_16x16x32_bf16 v[224:227], a[60:63], a[92:95], v[224:227]
    ds_read_b64_tr_b16 a[26:27], v56 offset:33792
    v_mfma_f32_16x16x32_bf16 v[132:135], a[64:67], a[80:83], v[132:135]
    ds_read_b64_tr_b16 a[28:29], v57 offset:32768
    v_mfma_f32_16x16x32_bf16 v[164:167], a[64:67], a[84:87], v[164:167]
    ds_read_b64_tr_b16 a[30:31], v57 offset:33792
    v_mfma_f32_16x16x32_bf16 v[196:199], a[64:67], a[88:91], v[196:199]
    v_mfma_f32_16x16x32_bf16 v[228:231], a[64:67], a[92:95], v[228:231]
    v_mfma_f32_16x16x32_bf16 v[136:139], a[68:71], a[80:83], v[136:139]
    v_mfma_f32_16x16x32_bf16 v[168:171], a[68:71], a[84:87], v[168:171]
    s_add_u32 m0, s34, 16384
    v_mfma_f32_16x16x32_bf16 v[200:203], a[68:71], a[88:91], v[200:203]
    buffer_load_dwordx4 v13, s[8:11], s28 offen offset:0 lds
    buffer_load_dwordx4 v14, s[8:11], s28 offen offset:1024 lds
    buffer_load_dwordx4 v15, s[8:11], s28 offen offset:2048 lds
    buffer_load_dwordx4 v16, s[8:11], s28 offen offset:3072 lds
    v_mfma_f32_16x16x32_bf16 v[232:235], a[68:71], a[92:95], v[232:235]
    v_mfma_f32_16x16x32_bf16 v[140:143], a[72:75], a[80:83], v[140:143]
    v_mfma_f32_16x16x32_bf16 v[172:175], a[72:75], a[84:87], v[172:175]
    v_mfma_f32_16x16x32_bf16 v[204:207], a[72:75], a[88:91], v[204:207]
    v_mfma_f32_16x16x32_bf16 v[236:239], a[72:75], a[92:95], v[236:239]
    s_add_u32 s28, s28, 16384
    v_mfma_f32_16x16x32_bf16 v[144:147], a[76:79], a[80:83], v[144:147]
    v_mfma_f32_16x16x32_bf16 v[176:179], a[76:79], a[84:87], v[176:179]
    v_mfma_f32_16x16x32_bf16 v[208:211], a[76:79], a[88:91], v[208:211]
    v_mfma_f32_16x16x32_bf16 v[240:243], a[76:79], a[92:95], v[240:243]
    s_waitcnt lgkmcnt(0)
    v_mfma_f32_16x16x32_bf16 v[100:103], a[0:3], v[32:35], v[100:103]
    ds_read_b64_tr_b16 a[48:49], v50 offset:40960
    v_mfma_f32_16x16x32_bf16 v[104:107], a[4:7], v[32:35], v[104:107]
    ds_read_b64_tr_b16 a[50:51], v50 offset:41984
    v_mfma_f32_16x16x32_bf16 v[116:119], a[0:3], a[32:35], v[116:119]
    ds_read_b128 a[80:83], v49 offset:16384
    v_mfma_f32_16x16x32_bf16 v[148:151], a[0:3], a[36:39], v[148:151]
    ds_read_b128 a[84:87], v49 offset:18432
    v_mfma_f32_16x16x32_bf16 v[180:183], a[0:3], a[40:43], v[180:183]
    ds_read_b128 a[88:91], v49 offset:20480
    v_mfma_f32_16x16x32_bf16 v[212:215], a[0:3], a[44:47], v[212:215]
    ds_read_b128 a[92:95], v49 offset:22528
    v_mfma_f32_16x16x32_bf16 v[120:123], a[4:7], a[32:35], v[120:123]
    ds_read_b64_tr_b16 a[52:53], v51 offset:40960
    v_mfma_f32_16x16x32_bf16 v[152:155], a[4:7], a[36:39], v[152:155]
    ds_read_b64_tr_b16 a[54:55], v51 offset:41984
    v_mfma_f32_16x16x32_bf16 v[184:187], a[4:7], a[40:43], v[184:187]
    ds_read_b64_tr_b16 a[56:57], v52 offset:40960
    v_mfma_f32_16x16x32_bf16 v[216:219], a[4:7], a[44:47], v[216:219]
    ds_read_b64_tr_b16 a[58:59], v52 offset:41984
    v_mfma_f32_16x16x32_bf16 v[124:127], a[8:11], a[32:35], v[124:127]
    ds_read_b64_tr_b16 a[60:61], v53 offset:40960
    v_mfma_f32_16x16x32_bf16 v[156:159], a[8:11], a[36:39], v[156:159]
    ds_read_b64_tr_b16 a[62:63], v53 offset:41984
    v_mfma_f32_16x16x32_bf16 v[188:191], a[8:11], a[40:43], v[188:191]
    ds_read_b64_tr_b16 a[64:65], v54 offset:40960
    v_mfma_f32_16x16x32_bf16 v[220:223], a[8:11], a[44:47], v[220:223]
    ds_read_b64_tr_b16 a[66:67], v54 offset:41984
    v_mfma_f32_16x16x32_bf16 v[128:131], a[12:15], a[32:35], v[128:131]
    ds_read_b64_tr_b16 a[68:69], v55 offset:40960
    v_mfma_f32_16x16x32_bf16 v[160:163], a[12:15], a[36:39], v[160:163]
    ds_read_b64_tr_b16 a[70:71], v55 offset:41984
    v_mfma_f32_16x16x32_bf16 v[192:195], a[12:15], a[40:43], v[192:195]
    ds_read_b64_tr_b16 a[72:73], v56 offset:40960
    v_mfma_f32_16x16x32_bf16 v[224:227], a[12:15], a[44:47], v[224:227]
    ds_read_b64_tr_b16 a[74:75], v56 offset:41984
    v_mfma_f32_16x16x32_bf16 v[132:135], a[16:19], a[32:35], v[132:135]
    ds_read_b64_tr_b16 a[76:77], v57 offset:40960
    v_mfma_f32_16x16x32_bf16 v[164:167], a[16:19], a[36:39], v[164:167]
    ds_read_b64_tr_b16 a[78:79], v57 offset:41984
    v_mfma_f32_16x16x32_bf16 v[196:199], a[16:19], a[40:43], v[196:199]
    v_mfma_f32_16x16x32_bf16 v[228:231], a[16:19], a[44:47], v[228:231]
    v_mfma_f32_16x16x32_bf16 v[136:139], a[20:23], a[32:35], v[136:139]
    v_mfma_f32_16x16x32_bf16 v[168:171], a[20:23], a[36:39], v[168:171]
    v_mfma_f32_16x16x32_bf16 v[200:203], a[20:23], a[40:43], v[200:203]
    v_mfma_f32_16x16x32_bf16 v[232:235], a[20:23], a[44:47], v[232:235]
    v_mfma_f32_16x16x32_bf16 v[140:143], a[24:27], a[32:35], v[140:143]
    v_mfma_f32_16x16x32_bf16 v[172:175], a[24:27], a[36:39], v[172:175]
    v_mfma_f32_16x16x32_bf16 v[204:207], a[24:27], a[40:43], v[204:207]
    v_mfma_f32_16x16x32_bf16 v[236:239], a[24:27], a[44:47], v[236:239]
    v_mfma_f32_16x16x32_bf16 v[144:147], a[28:31], a[32:35], v[144:147]
    v_mfma_f32_16x16x32_bf16 v[176:179], a[28:31], a[36:39], v[176:179]
    v_mfma_f32_16x16x32_bf16 v[208:211], a[28:31], a[40:43], v[208:211]
    v_mfma_f32_16x16x32_bf16 v[240:243], a[28:31], a[44:47], v[240:243]
    s_waitcnt vmcnt(4) lgkmcnt(0)
    s_barrier
    v_mfma_f32_16x16x32_bf16 v[100:103], a[48:51], v[32:35], v[100:103]
    ds_read_b64_tr_b16 a[0:1], v50 offset:0
    v_mfma_f32_16x16x32_bf16 v[104:107], a[52:55], v[32:35], v[104:107]
    ds_read_b64_tr_b16 a[2:3], v50 offset:1024
    v_mfma_f32_16x16x32_bf16 v[116:119], a[48:51], a[80:83], v[116:119]
    ds_read_b128 a[32:35], v48 offset:0
    v_mfma_f32_16x16x32_bf16 v[148:151], a[48:51], a[84:87], v[148:151]
    ds_read_b128 a[36:39], v48 offset:2048
    v_mfma_f32_16x16x32_bf16 v[180:183], a[48:51], a[88:91], v[180:183]
    ds_read_b128 a[40:43], v48 offset:4096
    v_mfma_f32_16x16x32_bf16 v[212:215], a[48:51], a[92:95], v[212:215]
    ds_read_b128 a[44:47], v48 offset:6144
    v_mfma_f32_16x16x32_bf16 v[120:123], a[52:55], a[80:83], v[120:123]
    ds_read_b64_tr_b16 a[4:5], v51 offset:0
    v_mfma_f32_16x16x32_bf16 v[152:155], a[52:55], a[84:87], v[152:155]
    ds_read_b64_tr_b16 a[6:7], v51 offset:1024
    v_mfma_f32_16x16x32_bf16 v[184:187], a[52:55], a[88:91], v[184:187]
    ds_read_b64_tr_b16 a[8:9], v52 offset:0
    v_mfma_f32_16x16x32_bf16 v[216:219], a[52:55], a[92:95], v[216:219]
    ds_read_b64_tr_b16 a[10:11], v52 offset:1024
    v_mfma_f32_16x16x32_bf16 v[124:127], a[56:59], a[80:83], v[124:127]
    ds_read_b64_tr_b16 a[12:13], v53 offset:0
    v_mfma_f32_16x16x32_bf16 v[156:159], a[56:59], a[84:87], v[156:159]
    ds_read_b64_tr_b16 a[14:15], v53 offset:1024
    v_mfma_f32_16x16x32_bf16 v[188:191], a[56:59], a[88:91], v[188:191]
    ds_read_b64_tr_b16 a[16:17], v54 offset:0
    v_mfma_f32_16x16x32_bf16 v[220:223], a[56:59], a[92:95], v[220:223]
    ds_read_b64_tr_b16 a[18:19], v54 offset:1024
    v_mfma_f32_16x16x32_bf16 v[128:131], a[60:63], a[80:83], v[128:131]
    ds_read_b64_tr_b16 a[20:21], v55 offset:0
    v_mfma_f32_16x16x32_bf16 v[160:163], a[60:63], a[84:87], v[160:163]
    ds_read_b64_tr_b16 a[22:23], v55 offset:1024
    v_mfma_f32_16x16x32_bf16 v[192:195], a[60:63], a[88:91], v[192:195]
    ds_read_b64_tr_b16 a[24:25], v56 offset:0
    v_mfma_f32_16x16x32_bf16 v[224:227], a[60:63], a[92:95], v[224:227]
    ds_read_b64_tr_b16 a[26:27], v56 offset:1024
    v_mfma_f32_16x16x32_bf16 v[132:135], a[64:67], a[80:83], v[132:135]
    ds_read_b64_tr_b16 a[28:29], v57 offset:0
    v_mfma_f32_16x16x32_bf16 v[164:167], a[64:67], a[84:87], v[164:167]
    ds_read_b64_tr_b16 a[30:31], v57 offset:1024
    v_mfma_f32_16x16x32_bf16 v[196:199], a[64:67], a[88:91], v[196:199]
    v_mfma_f32_16x16x32_bf16 v[228:231], a[64:67], a[92:95], v[228:231]
    v_mfma_f32_16x16x32_bf16 v[136:139], a[68:71], a[80:83], v[136:139]
    v_mfma_f32_16x16x32_bf16 v[168:171], a[68:71], a[84:87], v[168:171]
    s_add_u32 m0, s34, 32768
    v_mfma_f32_16x16x32_bf16 v[200:203], a[68:71], a[88:91], v[200:203]
    buffer_load_dwordx4 v13, s[8:11], s28 offen offset:0 lds
    buffer_load_dwordx4 v14, s[8:11], s28 offen offset:1024 lds
    buffer_load_dwordx4 v15, s[8:11], s28 offen offset:2048 lds
    buffer_load_dwordx4 v16, s[8:11], s28 offen offset:3072 lds
    v_mfma_f32_16x16x32_bf16 v[232:235], a[68:71], a[92:95], v[232:235]
    v_mfma_f32_16x16x32_bf16 v[140:143], a[72:75], a[80:83], v[140:143]
    v_mfma_f32_16x16x32_bf16 v[172:175], a[72:75], a[84:87], v[172:175]
    v_mfma_f32_16x16x32_bf16 v[204:207], a[72:75], a[88:91], v[204:207]
    v_mfma_f32_16x16x32_bf16 v[236:239], a[72:75], a[92:95], v[236:239]
    s_add_u32 s28, s28, 16384
    s_mov_b32 m0, s30
    v_mfma_f32_16x16x32_bf16 v[144:147], a[76:79], a[80:83], v[144:147]
    buffer_load_dwordx4 v17, s[12:15], s29 offen offset:0 lds
    buffer_load_dwordx4 v18, s[12:15], s29 offen offset:1024 lds
    buffer_load_dwordx4 v17, s[12:15], s29 offen offset:2048 lds
    buffer_load_dwordx4 v18, s[12:15], s29 offen offset:3072 lds
    v_mfma_f32_16x16x32_bf16 v[176:179], a[76:79], a[84:87], v[176:179]
    v_mfma_f32_16x16x32_bf16 v[208:211], a[76:79], a[88:91], v[208:211]
    v_mfma_f32_16x16x32_bf16 v[240:243], a[76:79], a[92:95], v[240:243]
    s_waitcnt lgkmcnt(0)
    v_mfma_f32_16x16x32_bf16 v[100:103], a[0:3], v[32:35], v[100:103]
    ds_read_b64_tr_b16 a[48:49], v50 offset:8192
    v_mfma_f32_16x16x32_bf16 v[104:107], a[4:7], v[32:35], v[104:107]
    ds_read_b64_tr_b16 a[50:51], v50 offset:9216
    v_mfma_f32_16x16x32_bf16 v[116:119], a[0:3], a[32:35], v[116:119]
    ds_read_b128 a[80:83], v49 offset:0
    v_mfma_f32_16x16x32_bf16 v[148:151], a[0:3], a[36:39], v[148:151]
    ds_read_b128 a[84:87], v49 offset:2048
    v_mfma_f32_16x16x32_bf16 v[180:183], a[0:3], a[40:43], v[180:183]
    ds_read_b128 a[88:91], v49 offset:4096
    v_mfma_f32_16x16x32_bf16 v[212:215], a[0:3], a[44:47], v[212:215]
    ds_read_b128 a[92:95], v49 offset:6144
    v_mfma_f32_16x16x32_bf16 v[120:123], a[4:7], a[32:35], v[120:123]
    ds_read_b64_tr_b16 a[52:53], v51 offset:8192
    v_mfma_f32_16x16x32_bf16 v[152:155], a[4:7], a[36:39], v[152:155]
    ds_read_b64_tr_b16 a[54:55], v51 offset:9216
    v_mfma_f32_16x16x32_bf16 v[184:187], a[4:7], a[40:43], v[184:187]
    ds_read_b64_tr_b16 a[56:57], v52 offset:8192
    v_mfma_f32_16x16x32_bf16 v[216:219], a[4:7], a[44:47], v[216:219]
    ds_read_b64_tr_b16 a[58:59], v52 offset:9216
    v_mfma_f32_16x16x32_bf16 v[124:127], a[8:11], a[32:35], v[124:127]
    ds_read_b64_tr_b16 a[60:61], v53 offset:8192
    v_mfma_f32_16x16x32_bf16 v[156:159], a[8:11], a[36:39], v[156:159]
    ds_read_b64_tr_b16 a[62:63], v53 offset:9216
    v_mfma_f32_16x16x32_bf16 v[188:191], a[8:11], a[40:43], v[188:191]
    ds_read_b64_tr_b16 a[64:65], v54 offset:8192
    v_mfma_f32_16x16x32_bf16 v[220:223], a[8:11], a[44:47], v[220:223]
    ds_read_b64_tr_b16 a[66:67], v54 offset:9216
    v_mfma_f32_16x16x32_bf16 v[128:131], a[12:15], a[32:35], v[128:131]
    ds_read_b64_tr_b16 a[68:69], v55 offset:8192
    v_mfma_f32_16x16x32_bf16 v[160:163], a[12:15], a[36:39], v[160:163]
    ds_read_b64_tr_b16 a[70:71], v55 offset:9216
    v_mfma_f32_16x16x32_bf16 v[192:195], a[12:15], a[40:43], v[192:195]
    ds_read_b64_tr_b16 a[72:73], v56 offset:8192
    v_mfma_f32_16x16x32_bf16 v[224:227], a[12:15], a[44:47], v[224:227]
    ds_read_b64_tr_b16 a[74:75], v56 offset:9216
    v_mfma_f32_16x16x32_bf16 v[132:135], a[16:19], a[32:35], v[132:135]
    ds_read_b64_tr_b16 a[76:77], v57 offset:8192
    v_mfma_f32_16x16x32_bf16 v[164:167], a[16:19], a[36:39], v[164:167]
    ds_read_b64_tr_b16 a[78:79], v57 offset:9216
    v_mfma_f32_16x16x32_bf16 v[196:199], a[16:19], a[40:43], v[196:199]
    v_mfma_f32_16x16x32_bf16 v[228:231], a[16:19], a[44:47], v[228:231]
    v_mfma_f32_16x16x32_bf16 v[136:139], a[20:23], a[32:35], v[136:139]
    v_mfma_f32_16x16x32_bf16 v[168:171], a[20:23], a[36:39], v[168:171]
    s_add_u32 s29, s29, 16384
    v_mfma_f32_16x16x32_bf16 v[200:203], a[20:23], a[40:43], v[200:203]
    v_mfma_f32_16x16x32_bf16 v[232:235], a[20:23], a[44:47], v[232:235]
    v_mfma_f32_16x16x32_bf16 v[140:143], a[24:27], a[32:35], v[140:143]
    v_mfma_f32_16x16x32_bf16 v[172:175], a[24:27], a[36:39], v[172:175]
    v_mfma_f32_16x16x32_bf16 v[204:207], a[24:27], a[40:43], v[204:207]
    v_mfma_f32_16x16x32_bf16 v[236:239], a[24:27], a[44:47], v[236:239]
    v_mfma_f32_16x16x32_bf16 v[144:147], a[28:31], a[32:35], v[144:147]
    v_mfma_f32_16x16x32_bf16 v[176:179], a[28:31], a[36:39], v[176:179]
    v_mfma_f32_16x16x32_bf16 v[208:211], a[28:31], a[40:43], v[208:211]
    v_mfma_f32_16x16x32_bf16 v[240:243], a[28:31], a[44:47], v[240:243]
    s_waitcnt lgkmcnt(0)
    v_mfma_f32_16x16x32_bf16 v[100:103], a[48:51], v[32:35], v[100:103]
    ds_read_b128 a[128:131], v1 offset:49152
    v_mfma_f32_16x16x32_bf16 v[104:107], a[52:55], v[32:35], v[104:107]
    ds_read_b128 a[132:135], v2 offset:49152
    v_mfma_f32_16x16x32_bf16 v[116:119], a[48:51], a[80:83], v[116:119]
    ds_read_b128 a[136:139], v3 offset:49152
    v_mfma_f32_16x16x32_bf16 v[120:123], a[52:55], a[80:83], v[120:123]
    ds_read_b128 a[140:143], v4 offset:49152
    v_mfma_f32_16x16x32_bf16 v[124:127], a[56:59], a[80:83], v[124:127]
    ds_read_b128 a[144:147], v1 offset:53248
    v_mfma_f32_16x16x32_bf16 v[128:131], a[60:63], a[80:83], v[128:131]
    ds_read_b128 a[148:151], v2 offset:53248
    v_mfma_f32_16x16x32_bf16 v[132:135], a[64:67], a[80:83], v[132:135]
    ds_read_b128 a[152:155], v3 offset:53248
    v_mfma_f32_16x16x32_bf16 v[136:139], a[68:71], a[80:83], v[136:139]
    ds_read_b128 a[156:159], v4 offset:53248
    v_mfma_f32_16x16x32_bf16 v[140:143], a[72:75], a[80:83], v[140:143]
    v_mfma_f32_16x16x32_bf16 v[144:147], a[76:79], a[80:83], v[144:147]
    v_mfma_f32_16x16x32_bf16 v[148:151], a[48:51], a[84:87], v[148:151]
    ds_write_b128 v58, v[100:103] offset:0
    v_mfma_f32_16x16x32_bf16 v[152:155], a[52:55], a[84:87], v[152:155]
    ds_write_b128 v58, v[104:107] offset:64
    v_mfma_f32_16x16x32_bf16 v[156:159], a[56:59], a[84:87], v[156:159]
    ds_write_b128 v58, v[100:103] offset:512
    v_mfma_f32_16x16x32_bf16 v[160:163], a[60:63], a[84:87], v[160:163]
    ds_write_b128 v58, v[104:107] offset:576
    v_mfma_f32_16x16x32_bf16 v[164:167], a[64:67], a[84:87], v[164:167]
    v_mfma_f32_16x16x32_bf16 v[168:171], a[68:71], a[84:87], v[168:171]
    v_mfma_f32_16x16x32_bf16 v[172:175], a[72:75], a[84:87], v[172:175]
    v_mfma_f32_16x16x32_bf16 v[176:179], a[76:79], a[84:87], v[176:179]
    s_waitcnt lgkmcnt(0)
    s_barrier
    v_mfma_f32_16x16x32_bf16 v[180:183], a[48:51], a[88:91], v[180:183]
    ds_read_b128 v[68:71], v58 offset:0
    v_mfma_f32_16x16x32_bf16 v[184:187], a[52:55], a[88:91], v[184:187]
    ds_read_b128 v[72:75], v58 offset:64
    v_mfma_f32_16x16x32_bf16 v[188:191], a[56:59], a[88:91], v[188:191]
    ds_read_b128 v[76:79], v58 offset:128
    v_mfma_f32_16x16x32_bf16 v[192:195], a[60:63], a[88:91], v[192:195]
    ds_read_b128 v[80:83], v58 offset:192
    v_mfma_f32_16x16x32_bf16 v[196:199], a[64:67], a[88:91], v[196:199]
    ds_read_b128 v[84:87], v58 offset:256
    v_mfma_f32_16x16x32_bf16 v[200:203], a[68:71], a[88:91], v[200:203]
    ds_read_b128 v[88:91], v58 offset:320
    v_mfma_f32_16x16x32_bf16 v[204:207], a[72:75], a[88:91], v[204:207]
    ds_read_b128 v[92:95], v58 offset:384
    v_mfma_f32_16x16x32_bf16 v[208:211], a[76:79], a[88:91], v[208:211]
    ds_read_b128 v[96:99], v58 offset:448
    v_mfma_f32_16x16x32_bf16 v[212:215], a[48:51], a[92:95], v[212:215]
    v_mfma_f32_16x16x32_bf16 v[216:219], a[52:55], a[92:95], v[216:219]
    v_mfma_f32_16x16x32_bf16 v[220:223], a[56:59], a[92:95], v[220:223]
    v_mfma_f32_16x16x32_bf16 v[224:227], a[60:63], a[92:95], v[224:227]
    v_mfma_f32_16x16x32_bf16 v[228:231], a[64:67], a[92:95], v[228:231]
    v_mfma_f32_16x16x32_bf16 v[232:235], a[68:71], a[92:95], v[232:235]
    v_mfma_f32_16x16x32_bf16 v[236:239], a[72:75], a[92:95], v[236:239]
    v_mfma_f32_16x16x32_bf16 v[240:243], a[76:79], a[92:95], v[240:243]
    v_mul_f32 v109, s44, v109
    v_mul_f32 v111, s44, v111
    v_mul_f32 v113, s44, v113
    v_mul_f32 v115, s44, v115
    s_waitcnt lgkmcnt(0)
    ds_read_b128 a[160:163], v1 offset:57344
    ds_read_b128 a[164:167], v2 offset:57344
    ds_read_b128 a[168:171], v3 offset:57344
    ds_read_b128 a[172:175], v4 offset:57344
    ds_read_b128 a[176:179], v1 offset:61440
    ds_read_b128 a[180:183], v2 offset:61440
    ds_read_b128 a[184:187], v3 offset:61440
    ds_read_b128 a[188:191], v4 offset:61440
    v_pk_fma_f32 v[116:117], v[108:109], v[68:69], v[116:117] op_sel_hi:[0,1,1] neg_lo:[1,0,0] neg_hi:[1,0,0]
    v_pk_fma_f32 v[118:119], v[108:109], v[70:71], v[118:119] op_sel_hi:[0,1,1] neg_lo:[1,0,0] neg_hi:[1,0,0]
    v_pk_fma_f32 v[120:121], v[108:109], v[72:73], v[120:121] op_sel_hi:[0,1,1] neg_lo:[1,0,0] neg_hi:[1,0,0]
    v_pk_fma_f32 v[122:123], v[108:109], v[74:75], v[122:123] op_sel_hi:[0,1,1] neg_lo:[1,0,0] neg_hi:[1,0,0]
    v_pk_fma_f32 v[124:125], v[108:109], v[76:77], v[124:125] op_sel_hi:[0,1,1] neg_lo:[1,0,0] neg_hi:[1,0,0]
    v_pk_fma_f32 v[126:127], v[108:109], v[78:79], v[126:127] op_sel_hi:[0,1,1] neg_lo:[1,0,0] neg_hi:[1,0,0]
    v_pk_fma_f32 v[128:129], v[108:109], v[80:81], v[128:129] op_sel_hi:[0,1,1] neg_lo:[1,0,0] neg_hi:[1,0,0]
    v_pk_fma_f32 v[130:131], v[108:109], v[82:83], v[130:131] op_sel_hi:[0,1,1] neg_lo:[1,0,0] neg_hi:[1,0,0]
    v_pk_fma_f32 v[132:133], v[108:109], v[84:85], v[132:133] op_sel_hi:[0,1,1] neg_lo:[1,0,0] neg_hi:[1,0,0]
    v_pk_fma_f32 v[134:135], v[108:109], v[86:87], v[134:135] op_sel_hi:[0,1,1] neg_lo:[1,0,0] neg_hi:[1,0,0]
    v_pk_fma_f32 v[136:137], v[108:109], v[88:89], v[136:137] op_sel_hi:[0,1,1] neg_lo:[1,0,0] neg_hi:[1,0,0]
    v_pk_fma_f32 v[138:139], v[108:109], v[90:91], v[138:139] op_sel_hi:[0,1,1] neg_lo:[1,0,0] neg_hi:[1,0,0]
    v_pk_fma_f32 v[140:141], v[108:109], v[92:93], v[140:141] op_sel_hi:[0,1,1] neg_lo:[1,0,0] neg_hi:[1,0,0]
    v_pk_fma_f32 v[142:143], v[108:109], v[94:95], v[142:143] op_sel_hi:[0,1,1] neg_lo:[1,0,0] neg_hi:[1,0,0]
    v_pk_fma_f32 v[144:145], v[108:109], v[96:97], v[144:145] op_sel_hi:[0,1,1] neg_lo:[1,0,0] neg_hi:[1,0,0]
    v_pk_fma_f32 v[146:147], v[108:109], v[98:99], v[146:147] op_sel_hi:[0,1,1] neg_lo:[1,0,0] neg_hi:[1,0,0]
    v_pk_fma_f32 v[148:149], v[110:111], v[68:69], v[148:149] op_sel_hi:[0,1,1] neg_lo:[1,0,0] neg_hi:[1,0,0]
    v_pk_fma_f32 v[150:151], v[110:111], v[70:71], v[150:151] op_sel_hi:[0,1,1] neg_lo:[1,0,0] neg_hi:[1,0,0]
    v_pk_fma_f32 v[152:153], v[110:111], v[72:73], v[152:153] op_sel_hi:[0,1,1] neg_lo:[1,0,0] neg_hi:[1,0,0]
    v_pk_fma_f32 v[154:155], v[110:111], v[74:75], v[154:155] op_sel_hi:[0,1,1] neg_lo:[1,0,0] neg_hi:[1,0,0]
    v_pk_fma_f32 v[156:157], v[110:111], v[76:77], v[156:157] op_sel_hi:[0,1,1] neg_lo:[1,0,0] neg_hi:[1,0,0]
    v_pk_fma_f32 v[158:159], v[110:111], v[78:79], v[158:159] op_sel_hi:[0,1,1] neg_lo:[1,0,0] neg_hi:[1,0,0]
    v_pk_fma_f32 v[160:161], v[110:111], v[80:81], v[160:161] op_sel_hi:[0,1,1] neg_lo:[1,0,0] neg_hi:[1,0,0]
    v_pk_fma_f32 v[162:163], v[110:111], v[82:83], v[162:163] op_sel_hi:[0,1,1] neg_lo:[1,0,0] neg_hi:[1,0,0]
    v_pk_fma_f32 v[164:165], v[110:111], v[84:85], v[164:165] op_sel_hi:[0,1,1] neg_lo:[1,0,0] neg_hi:[1,0,0]
    v_pk_fma_f32 v[166:167], v[110:111], v[86:87], v[166:167] op_sel_hi:[0,1,1] neg_lo:[1,0,0] neg_hi:[1,0,0]
    v_pk_fma_f32 v[168:169], v[110:111], v[88:89], v[168:169] op_sel_hi:[0,1,1] neg_lo:[1,0,0] neg_hi:[1,0,0]
    v_pk_fma_f32 v[170:171], v[110:111], v[90:91], v[170:171] op_sel_hi:[0,1,1] neg_lo:[1,0,0] neg_hi:[1,0,0]
    v_pk_fma_f32 v[172:173], v[110:111], v[92:93], v[172:173] op_sel_hi:[0,1,1] neg_lo:[1,0,0] neg_hi:[1,0,0]
    v_pk_fma_f32 v[174:175], v[110:111], v[94:95], v[174:175] op_sel_hi:[0,1,1] neg_lo:[1,0,0] neg_hi:[1,0,0]
    v_pk_fma_f32 v[176:177], v[110:111], v[96:97], v[176:177] op_sel_hi:[0,1,1] neg_lo:[1,0,0] neg_hi:[1,0,0]
    v_pk_fma_f32 v[178:179], v[110:111], v[98:99], v[178:179] op_sel_hi:[0,1,1] neg_lo:[1,0,0] neg_hi:[1,0,0]
    v_pk_fma_f32 v[180:181], v[112:113], v[68:69], v[180:181] op_sel_hi:[0,1,1] neg_lo:[1,0,0] neg_hi:[1,0,0]
    v_pk_fma_f32 v[182:183], v[112:113], v[70:71], v[182:183] op_sel_hi:[0,1,1] neg_lo:[1,0,0] neg_hi:[1,0,0]
    v_pk_fma_f32 v[184:185], v[112:113], v[72:73], v[184:185] op_sel_hi:[0,1,1] neg_lo:[1,0,0] neg_hi:[1,0,0]
    v_pk_fma_f32 v[186:187], v[112:113], v[74:75], v[186:187] op_sel_hi:[0,1,1] neg_lo:[1,0,0] neg_hi:[1,0,0]
    v_pk_fma_f32 v[188:189], v[112:113], v[76:77], v[188:189] op_sel_hi:[0,1,1] neg_lo:[1,0,0] neg_hi:[1,0,0]
    v_pk_fma_f32 v[190:191], v[112:113], v[78:79], v[190:191] op_sel_hi:[0,1,1] neg_lo:[1,0,0] neg_hi:[1,0,0]
    v_pk_fma_f32 v[192:193], v[112:113], v[80:81], v[192:193] op_sel_hi:[0,1,1] neg_lo:[1,0,0] neg_hi:[1,0,0]
    v_pk_fma_f32 v[194:195], v[112:113], v[82:83], v[194:195] op_sel_hi:[0,1,1] neg_lo:[1,0,0] neg_hi:[1,0,0]
    v_pk_fma_f32 v[196:197], v[112:113], v[84:85], v[196:197] op_sel_hi:[0,1,1] neg_lo:[1,0,0] neg_hi:[1,0,0]
    v_pk_fma_f32 v[198:199], v[112:113], v[86:87], v[198:199] op_sel_hi:[0,1,1] neg_lo:[1,0,0] neg_hi:[1,0,0]
    v_pk_fma_f32 v[200:201], v[112:113], v[88:89], v[200:201] op_sel_hi:[0,1,1] neg_lo:[1,0,0] neg_hi:[1,0,0]
    v_pk_fma_f32 v[202:203], v[112:113], v[90:91], v[202:203] op_sel_hi:[0,1,1] neg_lo:[1,0,0] neg_hi:[1,0,0]
    v_pk_fma_f32 v[204:205], v[112:113], v[92:93], v[204:205] op_sel_hi:[0,1,1] neg_lo:[1,0,0] neg_hi:[1,0,0]
    v_pk_fma_f32 v[206:207], v[112:113], v[94:95], v[206:207] op_sel_hi:[0,1,1] neg_lo:[1,0,0] neg_hi:[1,0,0]
    v_pk_fma_f32 v[208:209], v[112:113], v[96:97], v[208:209] op_sel_hi:[0,1,1] neg_lo:[1,0,0] neg_hi:[1,0,0]
    v_pk_fma_f32 v[210:211], v[112:113], v[98:99], v[210:211] op_sel_hi:[0,1,1] neg_lo:[1,0,0] neg_hi:[1,0,0]
    v_pk_fma_f32 v[212:213], v[114:115], v[68:69], v[212:213] op_sel_hi:[0,1,1] neg_lo:[1,0,0] neg_hi:[1,0,0]
    v_pk_fma_f32 v[214:215], v[114:115], v[70:71], v[214:215] op_sel_hi:[0,1,1] neg_lo:[1,0,0] neg_hi:[1,0,0]
    v_pk_fma_f32 v[216:217], v[114:115], v[72:73], v[216:217] op_sel_hi:[0,1,1] neg_lo:[1,0,0] neg_hi:[1,0,0]
    v_pk_fma_f32 v[218:219], v[114:115], v[74:75], v[218:219] op_sel_hi:[0,1,1] neg_lo:[1,0,0] neg_hi:[1,0,0]
    v_pk_fma_f32 v[220:221], v[114:115], v[76:77], v[220:221] op_sel_hi:[0,1,1] neg_lo:[1,0,0] neg_hi:[1,0,0]
    v_pk_fma_f32 v[222:223], v[114:115], v[78:79], v[222:223] op_sel_hi:[0,1,1] neg_lo:[1,0,0] neg_hi:[1,0,0]
    v_pk_fma_f32 v[224:225], v[114:115], v[80:81], v[224:225] op_sel_hi:[0,1,1] neg_lo:[1,0,0] neg_hi:[1,0,0]
    v_pk_fma_f32 v[226:227], v[114:115], v[82:83], v[226:227] op_sel_hi:[0,1,1] neg_lo:[1,0,0] neg_hi:[1,0,0]
    v_pk_fma_f32 v[228:229], v[114:115], v[84:85], v[228:229] op_sel_hi:[0,1,1] neg_lo:[1,0,0] neg_hi:[1,0,0]
    v_pk_fma_f32 v[230:231], v[114:115], v[86:87], v[230:231] op_sel_hi:[0,1,1] neg_lo:[1,0,0] neg_hi:[1,0,0]
    v_pk_fma_f32 v[232:233], v[114:115], v[88:89], v[232:233] op_sel_hi:[0,1,1] neg_lo:[1,0,0] neg_hi:[1,0,0]
    v_pk_fma_f32 v[234:235], v[114:115], v[90:91], v[234:235] op_sel_hi:[0,1,1] neg_lo:[1,0,0] neg_hi:[1,0,0]
    v_pk_fma_f32 v[236:237], v[114:115], v[92:93], v[236:237] op_sel_hi:[0,1,1] neg_lo:[1,0,0] neg_hi:[1,0,0]
    v_pk_fma_f32 v[238:239], v[114:115], v[94:95], v[238:239] op_sel_hi:[0,1,1] neg_lo:[1,0,0] neg_hi:[1,0,0]
    v_pk_fma_f32 v[240:241], v[114:115], v[96:97], v[240:241] op_sel_hi:[0,1,1] neg_lo:[1,0,0] neg_hi:[1,0,0]
    v_pk_fma_f32 v[242:243], v[114:115], v[98:99], v[242:243] op_sel_hi:[0,1,1] neg_lo:[1,0,0] neg_hi:[1,0,0]
    v_pk_mul_f32 v[116:117], v[116:117], v[108:109] op_sel:[0,1] op_sel_hi:[1,1]
    v_pk_mul_f32 v[118:119], v[118:119], v[108:109] op_sel:[0,1] op_sel_hi:[1,1]
    v_pk_mul_f32 v[120:121], v[120:121], v[108:109] op_sel:[0,1] op_sel_hi:[1,1]
    v_pk_mul_f32 v[122:123], v[122:123], v[108:109] op_sel:[0,1] op_sel_hi:[1,1]
    v_pk_mul_f32 v[124:125], v[124:125], v[108:109] op_sel:[0,1] op_sel_hi:[1,1]
    v_pk_mul_f32 v[126:127], v[126:127], v[108:109] op_sel:[0,1] op_sel_hi:[1,1]
    v_pk_mul_f32 v[128:129], v[128:129], v[108:109] op_sel:[0,1] op_sel_hi:[1,1]
    v_pk_mul_f32 v[130:131], v[130:131], v[108:109] op_sel:[0,1] op_sel_hi:[1,1]
    v_pk_mul_f32 v[132:133], v[132:133], v[108:109] op_sel:[0,1] op_sel_hi:[1,1]
    v_pk_mul_f32 v[134:135], v[134:135], v[108:109] op_sel:[0,1] op_sel_hi:[1,1]
    v_pk_mul_f32 v[136:137], v[136:137], v[108:109] op_sel:[0,1] op_sel_hi:[1,1]
    v_pk_mul_f32 v[138:139], v[138:139], v[108:109] op_sel:[0,1] op_sel_hi:[1,1]
    v_pk_mul_f32 v[140:141], v[140:141], v[108:109] op_sel:[0,1] op_sel_hi:[1,1]
    v_pk_mul_f32 v[142:143], v[142:143], v[108:109] op_sel:[0,1] op_sel_hi:[1,1]
    v_pk_mul_f32 v[144:145], v[144:145], v[108:109] op_sel:[0,1] op_sel_hi:[1,1]
    v_pk_mul_f32 v[146:147], v[146:147], v[108:109] op_sel:[0,1] op_sel_hi:[1,1]
    v_cvt_pk_bf16_f32 v36, v116, v117
    v_cvt_pk_bf16_f32 v37, v118, v119
    v_cvt_pk_bf16_f32 v38, v120, v121
    v_cvt_pk_bf16_f32 v39, v122, v123
    v_cvt_pk_bf16_f32 v40, v124, v125
    v_cvt_pk_bf16_f32 v41, v126, v127
    v_cvt_pk_bf16_f32 v42, v128, v129
    v_cvt_pk_bf16_f32 v43, v130, v131
    v_cvt_pk_bf16_f32 v44, v132, v133
    v_cvt_pk_bf16_f32 v45, v134, v135
    v_cvt_pk_bf16_f32 v46, v136, v137
    v_cvt_pk_bf16_f32 v47, v138, v139
    v_cvt_pk_bf16_f32 v48, v140, v141
    v_cvt_pk_bf16_f32 v49, v142, v143
    v_cvt_pk_bf16_f32 v50, v144, v145
    v_cvt_pk_bf16_f32 v51, v146, v147
    v_permlane32_swap_b32 v36, v38
    v_permlane32_swap_b32 v37, v39
    v_permlane32_swap_b32 v40, v42
    v_permlane32_swap_b32 v41, v43
    v_permlane32_swap_b32 v44, v46
    v_permlane32_swap_b32 v45, v47
    v_permlane32_swap_b32 v48, v50
    v_permlane32_swap_b32 v49, v51
    v_permlane16_swap_b32 v36, v38
    v_permlane16_swap_b32 v37, v39
    v_permlane16_swap_b32 v40, v42
    v_permlane16_swap_b32 v41, v43
    v_permlane16_swap_b32 v44, v46
    v_permlane16_swap_b32 v45, v47
    v_permlane16_swap_b32 v48, v50
    v_permlane16_swap_b32 v49, v51
    s_nop 1
    v_mfma_f32_16x16x32_bf16 v[116:119], a[128:131], v[36:39], 0
    v_pk_mul_f32 v[148:149], v[148:149], v[110:111] op_sel:[0,1] op_sel_hi:[1,1]
    v_pk_mul_f32 v[150:151], v[150:151], v[110:111] op_sel:[0,1] op_sel_hi:[1,1]
    v_pk_mul_f32 v[152:153], v[152:153], v[110:111] op_sel:[0,1] op_sel_hi:[1,1]
    v_pk_mul_f32 v[154:155], v[154:155], v[110:111] op_sel:[0,1] op_sel_hi:[1,1]
    v_pk_mul_f32 v[156:157], v[156:157], v[110:111] op_sel:[0,1] op_sel_hi:[1,1]
    v_pk_mul_f32 v[158:159], v[158:159], v[110:111] op_sel:[0,1] op_sel_hi:[1,1]
    v_mfma_f32_16x16x32_bf16 v[116:119], a[132:135], v[40:43], v[116:119]
    v_pk_mul_f32 v[160:161], v[160:161], v[110:111] op_sel:[0,1] op_sel_hi:[1,1]
    v_pk_mul_f32 v[162:163], v[162:163], v[110:111] op_sel:[0,1] op_sel_hi:[1,1]
    v_pk_mul_f32 v[164:165], v[164:165], v[110:111] op_sel:[0,1] op_sel_hi:[1,1]
    v_pk_mul_f32 v[166:167], v[166:167], v[110:111] op_sel:[0,1] op_sel_hi:[1,1]
    v_pk_mul_f32 v[168:169], v[168:169], v[110:111] op_sel:[0,1] op_sel_hi:[1,1]
    v_pk_mul_f32 v[170:171], v[170:171], v[110:111] op_sel:[0,1] op_sel_hi:[1,1]
    v_mfma_f32_16x16x32_bf16 v[116:119], a[136:139], v[44:47], v[116:119]
    v_pk_mul_f32 v[172:173], v[172:173], v[110:111] op_sel:[0,1] op_sel_hi:[1,1]
    v_pk_mul_f32 v[174:175], v[174:175], v[110:111] op_sel:[0,1] op_sel_hi:[1,1]
    v_pk_mul_f32 v[176:177], v[176:177], v[110:111] op_sel:[0,1] op_sel_hi:[1,1]
    v_pk_mul_f32 v[178:179], v[178:179], v[110:111] op_sel:[0,1] op_sel_hi:[1,1]
    v_cvt_pk_bf16_f32 v52, v148, v149
    v_cvt_pk_bf16_f32 v53, v150, v151
    v_mfma_f32_16x16x32_bf16 v[116:119], a[140:143], v[48:51], v[116:119]
    v_cvt_pk_bf16_f32 v54, v152, v153
    v_cvt_pk_bf16_f32 v55, v154, v155
    v_cvt_pk_bf16_f32 v56, v156, v157
    v_cvt_pk_bf16_f32 v57, v158, v159
    v_cvt_pk_bf16_f32 v58, v160, v161
    v_cvt_pk_bf16_f32 v59, v162, v163
    v_mfma_f32_16x16x32_bf16 v[132:135], a[144:147], v[36:39], 0
    v_cvt_pk_bf16_f32 v60, v164, v165
    v_cvt_pk_bf16_f32 v61, v166, v167
    v_cvt_pk_bf16_f32 v62, v168, v169
    v_cvt_pk_bf16_f32 v63, v170, v171
    v_cvt_pk_bf16_f32 v64, v172, v173
    v_cvt_pk_bf16_f32 v65, v174, v175
    v_mfma_f32_16x16x32_bf16 v[132:135], a[148:151], v[40:43], v[132:135]
    v_cvt_pk_bf16_f32 v66, v176, v177
    v_cvt_pk_bf16_f32 v67, v178, v179
    v_permlane32_swap_b32 v52, v54
    v_permlane32_swap_b32 v53, v55
    v_permlane32_swap_b32 v56, v58
    v_permlane32_swap_b32 v57, v59
    v_mfma_f32_16x16x32_bf16 v[132:135], a[152:155], v[44:47], v[132:135]
    v_permlane32_swap_b32 v60, v62
    v_permlane32_swap_b32 v61, v63
    v_permlane32_swap_b32 v64, v66
    v_permlane32_swap_b32 v65, v67
    v_permlane16_swap_b32 v52, v54
    v_permlane16_swap_b32 v53, v55
    v_mfma_f32_16x16x32_bf16 v[132:135], a[156:159], v[48:51], v[132:135]
    v_permlane16_swap_b32 v56, v58
    v_permlane16_swap_b32 v57, v59
    v_permlane16_swap_b32 v60, v62
    v_permlane16_swap_b32 v61, v63
    v_permlane16_swap_b32 v64, v66
    v_permlane16_swap_b32 v65, v67
    s_nop 1
    v_mfma_f32_16x16x32_bf16 v[120:123], a[128:131], v[52:55], 0
    v_pk_mul_f32 v[180:181], v[180:181], v[112:113] op_sel:[0,1] op_sel_hi:[1,1]
    v_pk_mul_f32 v[182:183], v[182:183], v[112:113] op_sel:[0,1] op_sel_hi:[1,1]
    v_pk_mul_f32 v[184:185], v[184:185], v[112:113] op_sel:[0,1] op_sel_hi:[1,1]
    v_pk_mul_f32 v[186:187], v[186:187], v[112:113] op_sel:[0,1] op_sel_hi:[1,1]
    v_pk_mul_f32 v[188:189], v[188:189], v[112:113] op_sel:[0,1] op_sel_hi:[1,1]
    v_pk_mul_f32 v[190:191], v[190:191], v[112:113] op_sel:[0,1] op_sel_hi:[1,1]
    v_mfma_f32_16x16x32_bf16 v[120:123], a[132:135], v[56:59], v[120:123]
    v_pk_mul_f32 v[192:193], v[192:193], v[112:113] op_sel:[0,1] op_sel_hi:[1,1]
    v_pk_mul_f32 v[194:195], v[194:195], v[112:113] op_sel:[0,1] op_sel_hi:[1,1]
    v_pk_mul_f32 v[196:197], v[196:197], v[112:113] op_sel:[0,1] op_sel_hi:[1,1]
    v_pk_mul_f32 v[198:199], v[198:199], v[112:113] op_sel:[0,1] op_sel_hi:[1,1]
    v_pk_mul_f32 v[200:201], v[200:201], v[112:113] op_sel:[0,1] op_sel_hi:[1,1]
    v_pk_mul_f32 v[202:203], v[202:203], v[112:113] op_sel:[0,1] op_sel_hi:[1,1]
    v_mfma_f32_16x16x32_bf16 v[120:123], a[136:139], v[60:63], v[120:123]
    v_pk_mul_f32 v[204:205], v[204:205], v[112:113] op_sel:[0,1] op_sel_hi:[1,1]
    v_pk_mul_f32 v[206:207], v[206:207], v[112:113] op_sel:[0,1] op_sel_hi:[1,1]
    v_pk_mul_f32 v[208:209], v[208:209], v[112:113] op_sel:[0,1] op_sel_hi:[1,1]
    v_pk_mul_f32 v[210:211], v[210:211], v[112:113] op_sel:[0,1] op_sel_hi:[1,1]
    v_cvt_pk_bf16_f32 v68, v180, v181
    v_cvt_pk_bf16_f32 v69, v182, v183
    v_mfma_f32_16x16x32_bf16 v[120:123], a[140:143], v[64:67], v[120:123]
    v_cvt_pk_bf16_f32 v70, v184, v185
    v_cvt_pk_bf16_f32 v71, v186, v187
    v_cvt_pk_bf16_f32 v72, v188, v189
    v_cvt_pk_bf16_f32 v73, v190, v191
    v_cvt_pk_bf16_f32 v74, v192, v193
    v_cvt_pk_bf16_f32 v75, v194, v195
    v_mfma_f32_16x16x32_bf16 v[136:139], a[144:147], v[52:55], 0
    v_cvt_pk_bf16_f32 v76, v196, v197
    v_cvt_pk_bf16_f32 v77, v198, v199
    v_cvt_pk_bf16_f32 v78, v200, v201
    v_cvt_pk_bf16_f32 v79, v202, v203
    v_cvt_pk_bf16_f32 v80, v204, v205
    v_cvt_pk_bf16_f32 v81, v206, v207
    v_mfma_f32_16x16x32_bf16 v[136:139], a[148:151], v[56:59], v[136:139]
    v_cvt_pk_bf16_f32 v82, v208, v209
    v_cvt_pk_bf16_f32 v83, v210, v211
    v_permlane32_swap_b32 v68, v70
    v_permlane32_swap_b32 v69, v71
    v_permlane32_swap_b32 v72, v74
    v_permlane32_swap_b32 v73, v75
    v_mfma_f32_16x16x32_bf16 v[136:139], a[152:155], v[60:63], v[136:139]
    v_permlane32_swap_b32 v76, v78
    v_permlane32_swap_b32 v77, v79
    v_permlane32_swap_b32 v80, v82
    v_permlane32_swap_b32 v81, v83
    v_permlane16_swap_b32 v68, v70
    v_permlane16_swap_b32 v69, v71
    v_mfma_f32_16x16x32_bf16 v[136:139], a[156:159], v[64:67], v[136:139]
    v_permlane16_swap_b32 v72, v74
    v_permlane16_swap_b32 v73, v75
    v_permlane16_swap_b32 v76, v78
    v_permlane16_swap_b32 v77, v79
    v_permlane16_swap_b32 v80, v82
    v_permlane16_swap_b32 v81, v83
    s_nop 1
    v_mfma_f32_16x16x32_bf16 v[124:127], a[128:131], v[68:71], 0
    v_pk_mul_f32 v[212:213], v[212:213], v[114:115] op_sel:[0,1] op_sel_hi:[1,1]
    v_pk_mul_f32 v[214:215], v[214:215], v[114:115] op_sel:[0,1] op_sel_hi:[1,1]
    v_pk_mul_f32 v[216:217], v[216:217], v[114:115] op_sel:[0,1] op_sel_hi:[1,1]
    v_pk_mul_f32 v[218:219], v[218:219], v[114:115] op_sel:[0,1] op_sel_hi:[1,1]
    v_pk_mul_f32 v[220:221], v[220:221], v[114:115] op_sel:[0,1] op_sel_hi:[1,1]
    v_pk_mul_f32 v[222:223], v[222:223], v[114:115] op_sel:[0,1] op_sel_hi:[1,1]
    v_mfma_f32_16x16x32_bf16 v[124:127], a[132:135], v[72:75], v[124:127]
    v_pk_mul_f32 v[224:225], v[224:225], v[114:115] op_sel:[0,1] op_sel_hi:[1,1]
    v_pk_mul_f32 v[226:227], v[226:227], v[114:115] op_sel:[0,1] op_sel_hi:[1,1]
    v_pk_mul_f32 v[228:229], v[228:229], v[114:115] op_sel:[0,1] op_sel_hi:[1,1]
    v_pk_mul_f32 v[230:231], v[230:231], v[114:115] op_sel:[0,1] op_sel_hi:[1,1]
    v_pk_mul_f32 v[232:233], v[232:233], v[114:115] op_sel:[0,1] op_sel_hi:[1,1]
    v_pk_mul_f32 v[234:235], v[234:235], v[114:115] op_sel:[0,1] op_sel_hi:[1,1]
    v_mfma_f32_16x16x32_bf16 v[124:127], a[136:139], v[76:79], v[124:127]
    v_pk_mul_f32 v[236:237], v[236:237], v[114:115] op_sel:[0,1] op_sel_hi:[1,1]
    v_pk_mul_f32 v[238:239], v[238:239], v[114:115] op_sel:[0,1] op_sel_hi:[1,1]
    v_pk_mul_f32 v[240:241], v[240:241], v[114:115] op_sel:[0,1] op_sel_hi:[1,1]
    v_pk_mul_f32 v[242:243], v[242:243], v[114:115] op_sel:[0,1] op_sel_hi:[1,1]
    v_cvt_pk_bf16_f32 v84, v212, v213
    v_cvt_pk_bf16_f32 v85, v214, v215
    v_mfma_f32_16x16x32_bf16 v[124:127], a[140:143], v[80:83], v[124:127]
    v_cvt_pk_bf16_f32 v86, v216, v217
    v_cvt_pk_bf16_f32 v87, v218, v219
    v_cvt_pk_bf16_f32 v88, v220, v221
    v_cvt_pk_bf16_f32 v89, v222, v223
    v_cvt_pk_bf16_f32 v90, v224, v225
    v_cvt_pk_bf16_f32 v91, v226, v227
    v_mfma_f32_16x16x32_bf16 v[140:143], a[144:147], v[68:71], 0
    v_cvt_pk_bf16_f32 v92, v228, v229
    v_cvt_pk_bf16_f32 v93, v230, v231
    v_cvt_pk_bf16_f32 v94, v232, v233
    v_cvt_pk_bf16_f32 v95, v234, v235
    v_cvt_pk_bf16_f32 v96, v236, v237
    v_cvt_pk_bf16_f32 v97, v238, v239
    v_mfma_f32_16x16x32_bf16 v[140:143], a[148:151], v[72:75], v[140:143]
    v_cvt_pk_bf16_f32 v98, v240, v241
    v_cvt_pk_bf16_f32 v99, v242, v243
    v_permlane32_swap_b32 v84, v86
    v_permlane32_swap_b32 v85, v87
    v_permlane32_swap_b32 v88, v90
    v_permlane32_swap_b32 v89, v91
    v_mfma_f32_16x16x32_bf16 v[140:143], a[152:155], v[76:79], v[140:143]
    v_permlane32_swap_b32 v92, v94
    v_permlane32_swap_b32 v93, v95
    v_permlane32_swap_b32 v96, v98
    v_permlane32_swap_b32 v97, v99
    v_permlane16_swap_b32 v84, v86
    v_permlane16_swap_b32 v85, v87
    v_mfma_f32_16x16x32_bf16 v[140:143], a[156:159], v[80:83], v[140:143]
    v_permlane16_swap_b32 v88, v90
    v_permlane16_swap_b32 v89, v91
    v_permlane16_swap_b32 v92, v94
    v_permlane16_swap_b32 v93, v95
    v_permlane16_swap_b32 v96, v98
    v_permlane16_swap_b32 v97, v99
    s_nop 1
    v_mfma_f32_16x16x32_bf16 v[128:131], a[128:131], v[84:87], 0
    v_max3_f32 v24, v116, v117, v118
    v_max3_f32 v25, v119, v132, v133
    v_max3_f32 v24, v24, v134, v135
    v_max_f32 v24, v24, v25
    v_mov_b32 v25, v24
    s_nop 1
    v_mfma_f32_16x16x32_bf16 v[128:131], a[132:135], v[88:91], v[128:131]
    v_permlane32_swap_b32 v24, v25
    v_max_f32 v24, v24, v25
    v_mov_b32 v25, v24
    s_nop 1
    v_permlane16_swap_b32 v24, v25
    v_max_f32 v24, v24, v25
    v_mfma_f32_16x16x32_bf16 v[128:131], a[136:139], v[92:95], v[128:131]
    v_sub_f32 v100, 0, v24
    v_sub_f32 v101, 0, v24
    v_sub_f32 v102, 0, v24
    v_sub_f32 v103, 0, v24
    v_sub_f32 v116, v116, v24
    v_sub_f32 v117, v117, v24
    v_mfma_f32_16x16x32_bf16 v[128:131], a[140:143], v[96:99], v[128:131]
    v_sub_f32 v118, v118, v24
    v_sub_f32 v119, v119, v24
    v_sub_f32 v132, v132, v24
    v_sub_f32 v133, v133, v24
    v_sub_f32 v134, v134, v24
    v_sub_f32 v135, v135, v24
    v_mfma_f32_16x16x32_bf16 v[144:147], a[144:147], v[84:87], 0
    v_max3_f32 v26, v120, v121, v122
    v_max3_f32 v27, v123, v136, v137
    v_max3_f32 v26, v26, v138, v139
    v_max_f32 v26, v26, v27
    v_mov_b32 v27, v26
    s_nop 1
    v_mfma_f32_16x16x32_bf16 v[144:147], a[148:151], v[88:91], v[144:147]
    v_permlane32_swap_b32 v26, v27
    v_max_f32 v26, v26, v27
    v_mov_b32 v27, v26
    s_nop 1
    v_permlane16_swap_b32 v26, v27
    v_max_f32 v26, v26, v27
    v_mfma_f32_16x16x32_bf16 v[144:147], a[152:155], v[92:95], v[144:147]
    v_sub_f32 v104, 0, v26
    v_sub_f32 v105, 0, v26
    v_sub_f32 v106, 0, v26
    v_sub_f32 v107, 0, v26
    v_sub_f32 v120, v120, v26
    v_sub_f32 v121, v121, v26
    v_mfma_f32_16x16x32_bf16 v[144:147], a[156:159], v[96:99], v[144:147]
    v_sub_f32 v122, v122, v26
    v_sub_f32 v123, v123, v26
    v_sub_f32 v136, v136, v26
    v_sub_f32 v137, v137, v26
    v_sub_f32 v138, v138, v26
    v_sub_f32 v139, v139, v26
    s_waitcnt vmcnt(8) lgkmcnt(0)
    s_barrier
    v_mfma_f32_16x16x32_bf16 v[148:151], a[160:163], v[36:39], v[100:103]
    s_add_u32 m0, s34, 0
    ds_read_b128 a[128:131], v1 offset:16384
    ds_read_b128 a[132:135], v2 offset:16384
    v_mfma_f32_16x16x32_bf16 v[148:151], a[164:167], v[40:43], v[148:151]
    buffer_load_dwordx4 v13, s[8:11], s28 offen offset:0 lds
    v_max3_f32 v28, v124, v125, v126
    v_max3_f32 v29, v127, v140, v141
    v_mfma_f32_16x16x32_bf16 v[148:151], a[168:171], v[44:47], v[148:151]
    v_max3_f32 v28, v28, v142, v143
    v_max_f32 v28, v28, v29
    v_mov_b32 v29, v28
    v_mfma_f32_16x16x32_bf16 v[148:151], a[172:175], v[48:51], v[148:151]
    s_nop 1
    v_permlane32_swap_b32 v28, v29
    v_max_f32 v28, v28, v29
    v_mov_b32 v29, v28
    v_mfma_f32_16x16x32_bf16 v[152:155], a[160:163], v[52:55], v[104:107]
    s_nop 1
    v_permlane16_swap_b32 v28, v29
    v_max_f32 v28, v28, v29
    v_mfma_f32_16x16x32_bf16 v[152:155], a[164:167], v[56:59], v[152:155]
    v_sub_f32 v108, 0, v28
    v_sub_f32 v109, 0, v28
    v_sub_f32 v110, 0, v28
    v_mfma_f32_16x16x32_bf16 v[152:155], a[168:171], v[60:63], v[152:155]
    v_sub_f32 v111, 0, v28
    v_sub_f32 v124, v124, v28
    v_sub_f32 v125, v125, v28
    v_sub_f32 v126, v126, v28
    v_mfma_f32_16x16x32_bf16 v[152:155], a[172:175], v[64:67], v[152:155]
    v_sub_f32 v127, v127, v28
    v_sub_f32 v140, v140, v28
    v_sub_f32 v141, v141, v28
    v_mfma_f32_16x16x32_bf16 v[164:167], a[176:179], v[36:39], v[100:103]
    v_sub_f32 v142, v142, v28
    v_sub_f32 v143, v143, v28
    v_max3_f32 v30, v128, v129, v130
    v_mfma_f32_16x16x32_bf16 v[164:167], a[180:183], v[40:43], v[164:167]
    v_max3_f32 v31, v131, v144, v145
    v_max3_f32 v30, v30, v146, v147
    v_max_f32 v30, v30, v31
    v_mov_b32 v31, v30
    v_mfma_f32_16x16x32_bf16 v[164:167], a[184:187], v[44:47], v[164:167]
    s_nop 1
    v_permlane32_swap_b32 v30, v31
    v_max_f32 v30, v30, v31
    v_mfma_f32_16x16x32_bf16 v[164:167], a[188:191], v[48:51], v[164:167]
    v_mov_b32 v31, v30
    s_nop 1
    v_permlane16_swap_b32 v30, v31
    v_mfma_f32_16x16x32_bf16 v[168:171], a[176:179], v[52:55], v[104:107]
    v_max_f32 v30, v30, v31
    v_sub_f32 v112, 0, v30
    v_sub_f32 v113, 0, v30
    v_sub_f32 v114, 0, v30
    v_mfma_f32_16x16x32_bf16 v[168:171], a[180:183], v[56:59], v[168:171]
    v_sub_f32 v115, 0, v30
    v_sub_f32 v128, v128, v30
    v_sub_f32 v129, v129, v30
    v_mfma_f32_16x16x32_bf16 v[168:171], a[184:187], v[60:63], v[168:171]
    v_sub_f32 v130, v130, v30
    v_sub_f32 v131, v131, v30
    v_sub_f32 v144, v144, v30
    v_mfma_f32_16x16x32_bf16 v[168:171], a[188:191], v[64:67], v[168:171]
    v_sub_f32 v145, v145, v30
    v_sub_f32 v146, v146, v30
    v_sub_f32 v147, v147, v30
    s_nop 0
    v_mfma_f32_16x16x32_bf16 v[156:159], a[160:163], v[68:71], v[108:111]
    v_mfma_f32_16x16x32_bf16 v[156:159], a[164:167], v[72:75], v[156:159]
    v_mfma_f32_16x16x32_bf16 v[156:159], a[168:171], v[76:79], v[156:159]
    ds_read_b128 a[136:139], v3 offset:16384
    v_mfma_f32_16x16x32_bf16 v[156:159], a[172:175], v[80:83], v[156:159]
    v_mfma_f32_16x16x32_bf16 v[160:163], a[160:163], v[84:87], v[112:115]
    v_mfma_f32_16x16x32_bf16 v[160:163], a[164:167], v[88:91], v[160:163]
    ds_read_b128 a[140:143], v4 offset:16384
    v_mfma_f32_16x16x32_bf16 v[160:163], a[168:171], v[92:95], v[160:163]
    v_mfma_f32_16x16x32_bf16 v[160:163], a[172:175], v[96:99], v[160:163]
    buffer_load_dwordx4 v14, s[8:11], s28 offen offset:1024 lds
    s_waitcnt lgkmcnt(2)
    v_mfma_f32_16x16x32_bf16 v[172:175], a[176:179], v[68:71], v[108:111]
    v_exp_f32 v116, v116
    ds_read_b128 a[144:147], v1 offset:20480
    v_mfma_f32_16x16x32_bf16 v[172:175], a[180:183], v[72:75], v[172:175]
    v_exp_f32 v117, v117
    ds_read_b128 a[148:151], v2 offset:20480
    v_mfma_f32_16x16x32_bf16 v[172:175], a[184:187], v[76:79], v[172:175]
    v_exp_f32 v118, v118
    v_cvt_pk_bf16_f32 v180, v116, v117
    v_mfma_f32_16x16x32_bf16 v[172:175], a[188:191], v[80:83], v[172:175]
    v_exp_f32 v119, v119
    v_mfma_f32_16x16x32_bf16 v[176:179], a[176:179], v[84:87], v[112:115]
    v_exp_f32 v120, v120
    v_cvt_pk_bf16_f32 v181, v118, v119
    v_mfma_f32_16x16x32_bf16 v[176:179], a[180:183], v[88:91], v[176:179]
    v_exp_f32 v121, v121
    v_mfma_f32_16x16x32_bf16 v[176:179], a[184:187], v[92:95], v[176:179]
    v_exp_f32 v122, v122
    buffer_load_dwordx4 v15, s[8:11], s28 offen offset:2048 lds
    v_cvt_pk_bf16_f32 v188, v120, v121
    v_mfma_f32_16x16x32_bf16 v[176:179], a[188:191], v[96:99], v[176:179]
    v_exp_f32 v123, v123
    s_waitcnt lgkmcnt(2)
    v_mfma_f32_16x16x32_bf16 v[116:119], a[128:131], v[36:39], v[100:103]
    v_exp_f32 v124, v124
    ds_read_b128 a[152:155], v3 offset:20480
    v_cvt_pk_bf16_f32 v189, v122, v123
    v_mfma_f32_16x16x32_bf16 v[116:119], a[132:135], v[40:43], v[116:119]
    v_exp_f32 v125, v125
    ds_read_b128 a[156:159], v4 offset:20480
    v_mfma_f32_16x16x32_bf16 v[116:119], a[136:139], v[44:47], v[116:119]
    v_exp_f32 v126, v126
    v_cvt_pk_bf16_f32 v196, v124, v125
    v_mfma_f32_16x16x32_bf16 v[116:119], a[140:143], v[48:51], v[116:119]
    v_exp_f32 v127, v127
    v_mfma_f32_16x16x32_bf16 v[120:123], a[128:131], v[52:55], v[104:107]
    v_exp_f32 v128, v128
    v_cvt_pk_bf16_f32 v197, v126, v127
    v_mfma_f32_16x16x32_bf16 v[120:123], a[132:135], v[56:59], v[120:123]
    v_exp_f32 v129, v129
    v_mfma_f32_16x16x32_bf16 v[120:123], a[136:139], v[60:63], v[120:123]
    v_exp_f32 v130, v130
    buffer_load_dwordx4 v16, s[8:11], s28 offen offset:3072 lds
    v_cvt_pk_bf16_f32 v204, v128, v129
    v_mfma_f32_16x16x32_bf16 v[120:123], a[140:143], v[64:67], v[120:123]
    v_exp_f32 v131, v131
    s_waitcnt lgkmcnt(2)
    v_mfma_f32_16x16x32_bf16 v[124:127], a[128:131], v[68:71], v[108:111]
    v_exp_f32 v132, v132
    ds_read_b128 a[160:163], v1 offset:24576
    v_cvt_pk_bf16_f32 v205, v130, v131
    v_mfma_f32_16x16x32_bf16 v[124:127], a[132:135], v[72:75], v[124:127]
    v_exp_f32 v133, v133
    ds_read_b128 a[164:167], v2 offset:24576
    v_mfma_f32_16x16x32_bf16 v[124:127], a[136:139], v[76:79], v[124:127]
    v_exp_f32 v134, v134
    v_cvt_pk_bf16_f32 v182, v132, v133
    v_mfma_f32_16x16x32_bf16 v[124:127], a[140:143], v[80:83], v[124:127]
    v_exp_f32 v135, v135
    v_mfma_f32_16x16x32_bf16 v[128:131], a[128:131], v[84:87], v[112:115]
    v_exp_f32 v136, v136
    v_cvt_pk_bf16_f32 v183, v134, v135
    v_mfma_f32_16x16x32_bf16 v[128:131], a[132:135], v[88:91], v[128:131]
    v_exp_f32 v137, v137
    v_mfma_f32_16x16x32_bf16 v[128:131], a[136:139], v[92:95], v[128:131]
    s_add_u32 s28, s28, 16384
    s_mov_b32 m0, s31
    v_exp_f32 v138, v138
    buffer_load_dwordx4 v17, s[12:15], s29 offen offset:0 lds
    v_cvt_pk_bf16_f32 v190, v136, v137
    v_mfma_f32_16x16x32_bf16 v[128:131], a[140:143], v[96:99], v[128:131]
    v_exp_f32 v139, v139
    s_waitcnt lgkmcnt(2)
    v_mfma_f32_16x16x32_bf16 v[132:135], a[144:147], v[36:39], v[100:103]
    v_exp_f32 v140, v140
    ds_read_b128 a[168:171], v3 offset:24576
    v_cvt_pk_bf16_f32 v191, v138, v139
    v_mfma_f32_16x16x32_bf16 v[132:135], a[148:151], v[40:43], v[132:135]
    v_exp_f32 v141, v141
    ds_read_b128 a[172:175], v4 offset:24576
    v_mfma_f32_16x16x32_bf16 v[132:135], a[152:155], v[44:47], v[132:135]
    v_exp_f32 v142, v142
    v_cvt_pk_bf16_f32 v198, v140, v141
    v_mfma_f32_16x16x32_bf16 v[132:135], a[156:159], v[48:51], v[132:135]
    v_exp_f32 v143, v143
    v_mfma_f32_16x16x32_bf16 v[136:139], a[144:147], v[52:55], v[104:107]
    v_exp_f32 v144, v144
    v_cvt_pk_bf16_f32 v199, v142, v143
    v_mfma_f32_16x16x32_bf16 v[136:139], a[148:151], v[56:59], v[136:139]
    v_exp_f32 v145, v145
    v_mfma_f32_16x16x32_bf16 v[136:139], a[152:155], v[60:63], v[136:139]
    v_exp_f32 v146, v146
    buffer_load_dwordx4 v18, s[12:15], s29 offen offset:1024 lds
    v_cvt_pk_bf16_f32 v206, v144, v145
    v_mfma_f32_16x16x32_bf16 v[136:139], a[156:159], v[64:67], v[136:139]
    v_exp_f32 v147, v147
    s_waitcnt lgkmcnt(2)
    v_mfma_f32_16x16x32_bf16 v[140:143], a[144:147], v[68:71], v[108:111]
    v_exp_f32 v148, v148
    ds_read_b128 a[176:179], v1 offset:28672
    v_cvt_pk_bf16_f32 v207, v146, v147
    v_mfma_f32_16x16x32_bf16 v[140:143], a[148:151], v[72:75], v[140:143]
    v_exp_f32 v149, v149
    ds_read_b128 a[180:183], v2 offset:28672
    v_mfma_f32_16x16x32_bf16 v[140:143], a[152:155], v[76:79], v[140:143]
    v_exp_f32 v150, v150
    v_cvt_pk_bf16_f32 v184, v148, v149
    v_mfma_f32_16x16x32_bf16 v[140:143], a[156:159], v[80:83], v[140:143]
    v_exp_f32 v151, v151
    v_mfma_f32_16x16x32_bf16 v[144:147], a[144:147], v[84:87], v[112:115]
    v_exp_f32 v152, v152
    v_cvt_pk_bf16_f32 v185, v150, v151
    v_mfma_f32_16x16x32_bf16 v[144:147], a[148:151], v[88:91], v[144:147]
    v_exp_f32 v153, v153
    v_mfma_f32_16x16x32_bf16 v[144:147], a[152:155], v[92:95], v[144:147]
    v_exp_f32 v154, v154
    buffer_load_dwordx4 v17, s[12:15], s29 offen offset:2048 lds
    v_cvt_pk_bf16_f32 v192, v152, v153
    v_mfma_f32_16x16x32_bf16 v[144:147], a[156:159], v[96:99], v[144:147]
    v_exp_f32 v155, v155
    s_waitcnt lgkmcnt(2)
    v_mfma_f32_16x16x32_bf16 v[148:151], a[160:163], v[36:39], v[100:103]
    v_exp_f32 v156, v156
    ds_read_b128 a[184:187], v3 offset:28672
    v_cvt_pk_bf16_f32 v193, v154, v155
    v_mfma_f32_16x16x32_bf16 v[148:151], a[164:167], v[40:43], v[148:151]
    v_exp_f32 v157, v157
    ds_read_b128 a[188:191], v4 offset:28672
    v_mfma_f32_16x16x32_bf16 v[148:151], a[168:171], v[44:47], v[148:151]
    v_exp_f32 v158, v158
    v_cvt_pk_bf16_f32 v200, v156, v157
    v_mfma_f32_16x16x32_bf16 v[148:151], a[172:175], v[48:51], v[148:151]
    v_exp_f32 v159, v159
    v_mfma_f32_16x16x32_bf16 v[152:155], a[160:163], v[52:55], v[104:107]
    v_exp_f32 v160, v160
    v_cvt_pk_bf16_f32 v201, v158, v159
    v_mfma_f32_16x16x32_bf16 v[152:155], a[164:167], v[56:59], v[152:155]
    v_exp_f32 v161, v161
    v_mfma_f32_16x16x32_bf16 v[152:155], a[168:171], v[60:63], v[152:155]
    v_exp_f32 v162, v162
    buffer_load_dwordx4 v18, s[12:15], s29 offen offset:3072 lds
    v_cvt_pk_bf16_f32 v208, v160, v161
    v_mfma_f32_16x16x32_bf16 v[152:155], a[172:175], v[64:67], v[152:155]
    s_add_u32 s29, s29, 16384
    v_exp_f32 v163, v163
    s_waitcnt vmcnt(8) lgkmcnt(2)
    s_barrier
    v_mfma_f32_16x16x32_bf16 v[156:159], a[160:163], v[68:71], v[108:111]
    v_exp_f32 v164, v164
    ds_read_b64_tr_b16 a[192:193], v5 offset:8192
    v_cvt_pk_bf16_f32 v209, v162, v163
    v_mfma_f32_16x16x32_bf16 v[156:159], a[164:167], v[72:75], v[156:159]
    v_exp_f32 v165, v165
    ds_read_b64_tr_b16 a[194:195], v5 offset:12288
    v_mfma_f32_16x16x32_bf16 v[156:159], a[168:171], v[76:79], v[156:159]
    v_exp_f32 v166, v166
    ds_read_b128 a[128:131], v1 offset:32768
    v_cvt_pk_bf16_f32 v186, v164, v165
    v_mfma_f32_16x16x32_bf16 v[156:159], a[172:175], v[80:83], v[156:159]
    v_exp_f32 v167, v167
    ds_read_b64_tr_b16 a[196:197], v5 offset:32768
    v_mfma_f32_16x16x32_bf16 v[160:163], a[160:163], v[84:87], v[112:115]
    v_exp_f32 v168, v168
    ds_read_b64_tr_b16 a[198:199], v5 offset:36864
    v_cvt_pk_bf16_f32 v187, v166, v167
    v_mfma_f32_16x16x32_bf16 v[160:163], a[164:167], v[88:91], v[160:163]
    v_exp_f32 v169, v169
    ds_read_b128 a[132:135], v2 offset:32768
    v_mfma_f32_16x16x32_bf16 v[160:163], a[168:171], v[92:95], v[160:163]
    s_add_u32 m0, s34, 49152
    v_exp_f32 v170, v170
    buffer_load_dwordx4 v13, s[8:11], s28 offen offset:0 lds
    v_cvt_pk_bf16_f32 v194, v168, v169
    v_mfma_f32_16x16x32_bf16 v[160:163], a[172:175], v[96:99], v[160:163]
    v_exp_f32 v171, v171
    s_waitcnt lgkmcnt(6)
    v_mfma_f32_16x16x32_bf16 v[164:167], a[176:179], v[36:39], v[100:103]
    v_exp_f32 v172, v172
    ds_read_b64_tr_b16 a[200:201], v6 offset:8192
    v_cvt_pk_bf16_f32 v195, v170, v171
    v_mfma_f32_16x16x32_bf16 v[164:167], a[180:183], v[40:43], v[164:167]
    v_exp_f32 v173, v173
    ds_read_b64_tr_b16 a[202:203], v6 offset:12288
    v_mfma_f32_16x16x32_bf16 v[164:167], a[184:187], v[44:47], v[164:167]
    v_exp_f32 v174, v174
    ds_read_b128 a[136:139], v3 offset:32768
    v_cvt_pk_bf16_f32 v202, v172, v173
    v_mfma_f32_16x16x32_bf16 v[164:167], a[188:191], v[48:51], v[164:167]
    v_exp_f32 v175, v175
    ds_read_b64_tr_b16 a[204:205], v6 offset:32768
    v_mfma_f32_16x16x32_bf16 v[168:171], a[176:179], v[52:55], v[104:107]
    v_exp_f32 v176, v176
    ds_read_b64_tr_b16 a[206:207], v6 offset:36864
    v_cvt_pk_bf16_f32 v203, v174, v175
    v_mfma_f32_16x16x32_bf16 v[168:171], a[180:183], v[56:59], v[168:171]
    v_exp_f32 v177, v177
    ds_read_b128 a[140:143], v4 offset:32768
    v_mfma_f32_16x16x32_bf16 v[168:171], a[184:187], v[60:63], v[168:171]
    v_exp_f32 v178, v178
    buffer_load_dwordx4 v14, s[8:11], s28 offen offset:1024 lds
    v_cvt_pk_bf16_f32 v210, v176, v177
    v_mfma_f32_16x16x32_bf16 v[168:171], a[188:191], v[64:67], v[168:171]
    v_exp_f32 v179, v179
    s_waitcnt lgkmcnt(6)
    v_mfma_f32_16x16x32_bf16 v[172:175], a[176:179], v[68:71], v[108:111]
    v_exp_f32 v116, v116
    v_mfma_f32_16x16x32_bf16 v[172:175], a[180:183], v[72:75], v[172:175]
    ds_read_b64_tr_b16 a[208:209], v7 offset:8192
    v_cvt_pk_bf16_f32 v211, v178, v179
    v_mfma_f32_16x16x32_bf16 v[172:175], a[184:187], v[76:79], v[172:175]
    v_exp_f32 v117, v117
    v_mfma_f32_16x16x32_bf16 v[172:175], a[188:191], v[80:83], v[172:175]
    ds_read_b64_tr_b16 a[210:211], v7 offset:12288
    v_mfma_f32_16x16x32_bf16 v[176:179], a[176:179], v[84:87], v[112:115]
    v_exp_f32 v118, v118
    v_mfma_f32_16x16x32_bf16 v[176:179], a[180:183], v[88:91], v[176:179]
    ds_read_b128 a[144:147], v1 offset:36864
    v_cvt_pk_bf16_f32 v212, v116, v117
    v_mfma_f32_16x16x32_bf16 v[176:179], a[184:187], v[92:95], v[176:179]
    v_exp_f32 v119, v119
    v_mfma_f32_16x16x32_bf16 v[176:179], a[188:191], v[96:99], v[176:179]
    ds_read_b64_tr_b16 a[212:213], v7 offset:32768
    v_mfma_f32_16x16x32_bf16 a[0:3], a[192:195], v[180:183], 0
    v_exp_f32 v120, v120
    v_mfma_f32_16x16x32_bf16 a[0:3], a[196:199], v[184:187], a[0:3]
    ds_read_b64_tr_b16 a[214:215], v7 offset:36864
    v_cvt_pk_bf16_f32 v213, v118, v119
    v_mfma_f32_16x16x32_bf16 a[4:7], a[192:195], v[188:191], 0
    v_exp_f32 v121, v121
    v_mfma_f32_16x16x32_bf16 a[4:7], a[196:199], v[192:195], a[4:7]
    ds_read_b128 a[148:151], v2 offset:36864
    v_cvt_pk_bf16_f32 v220, v120, v121
    v_mfma_f32_16x16x32_bf16 a[8:11], a[192:195], v[196:199], 0
    v_exp_f32 v122, v122
    v_mfma_f32_16x16x32_bf16 a[8:11], a[196:199], v[200:203], a[8:11]
    buffer_load_dwordx4 v15, s[8:11], s28 offen offset:2048 lds
    v_mfma_f32_16x16x32_bf16 a[12:15], a[192:195], v[204:207], 0
    v_exp_f32 v123, v123
    v_mfma_f32_16x16x32_bf16 a[12:15], a[196:199], v[208:211], a[12:15]
    s_waitcnt lgkmcnt(6)
    v_mfma_f32_16x16x32_bf16 v[116:119], a[128:131], v[36:39], v[100:103]
    v_exp_f32 v124, v124
    v_mfma_f32_16x16x32_bf16 v[116:119], a[132:135], v[40:43], v[116:119]
    ds_read_b64_tr_b16 a[216:217], v8 offset:8192
    v_cvt_pk_bf16_f32 v221, v122, v123
    v_mfma_f32_16x16x32_bf16 v[116:119], a[136:139], v[44:47], v[116:119]
    v_exp_f32 v125, v125
    v_mfma_f32_16x16x32_bf16 v[116:119], a[140:143], v[48:51], v[116:119]
    ds_read_b64_tr_b16 a[218:219], v8 offset:12288
    v_mfma_f32_16x16x32_bf16 v[120:123], a[128:131], v[52:55], v[104:107]
    v_exp_f32 v126, v126
    v_mfma_f32_16x16x32_bf16 v[120:123], a[132:135], v[56:59], v[120:123]
    ds_read_b128 a[152:155], v3 offset:36864
    v_cvt_pk_bf16_f32 v228, v124, v125
    v_mfma_f32_16x16x32_bf16 v[120:123], a[136:139], v[60:63], v[120:123]
    v_exp_f32 v127, v127
    v_mfma_f32_16x16x32_bf16 v[120:123], a[140:143], v[64:67], v[120:123]
    ds_read_b64_tr_b16 a[220:221], v8 offset:32768
    v_mfma_f32_16x16x32_bf16 a[16:19], a[200:203], v[180:183], 0
    v_exp_f32 v128, v128
    v_mfma_f32_16x16x32_bf16 a[16:19], a[204:207], v[184:187], a[16:19]
    ds_read_b64_tr_b16 a[222:223], v8 offset:36864
    v_cvt_pk_bf16_f32 v229, v126, v127
    v_mfma_f32_16x16x32_bf16 a[20:23], a[200:203], v[188:191], 0
    v_exp_f32 v129, v129
    v_mfma_f32_16x16x32_bf16 a[20:23], a[204:207], v[192:195], a[20:23]
    ds_read_b128 a[156:159], v4 offset:36864
    v_mfma_f32_16x16x32_bf16 a[24:27], a[200:203], v[196:199], 0
    v_exp_f32 v130, v130
    v_mfma_f32_16x16x32_bf16 a[24:27], a[204:207], v[200:203], a[24:27]
    v_cvt_pk_bf16_f32 v236, v128, v129
    v_mfma_f32_16x16x32_bf16 a[28:31], a[200:203], v[204:207], 0
    v_exp_f32 v131, v131
    v_mfma_f32_16x16x32_bf16 a[28:31], a[204:207], v[208:211], a[28:31]
    buffer_load_dwordx4 v16, s[8:11], s28 offen offset:3072 lds
    v_smfmac_f32_16x16x64_bf16 a[224:227], v[244:247], v[180:187], v248
    s_waitcnt lgkmcnt(6)
    v_mfma_f32_16x16x32_bf16 v[124:127], a[128:131], v[68:71], v[108:111]
    v_exp_f32 v132, v132
    v_mfma_f32_16x16x32_bf16 v[124:127], a[132:135], v[72:75], v[124:127]
    ds_read_b64_tr_b16 a[192:193], v9 offset:8192
    v_cvt_pk_bf16_f32 v237, v130, v131
    v_mfma_f32_16x16x32_bf16 v[124:127], a[136:139], v[76:79], v[124:127]
    v_exp_f32 v133, v133
    v_mfma_f32_16x16x32_bf16 v[124:127], a[140:143], v[80:83], v[124:127]
    ds_read_b64_tr_b16 a[194:195], v9 offset:12288
    v_mfma_f32_16x16x32_bf16 v[128:131], a[128:131], v[84:87], v[112:115]
    v_exp_f32 v134, v134
    v_mfma_f32_16x16x32_bf16 v[128:131], a[132:135], v[88:91], v[128:131]
    ds_read_b128 a[160:163], v1 offset:40960
    v_cvt_pk_bf16_f32 v214, v132, v133
    v_mfma_f32_16x16x32_bf16 v[128:131], a[136:139], v[92:95], v[128:131]
    v_exp_f32 v135, v135
    v_mfma_f32_16x16x32_bf16 v[128:131], a[140:143], v[96:99], v[128:131]
    ds_read_b64_tr_b16 a[196:197], v9 offset:32768
    v_mfma_f32_16x16x32_bf16 a[32:35], a[208:211], v[180:183], 0
    v_exp_f32 v136, v136
    v_mfma_f32_16x16x32_bf16 a[32:35], a[212:215], v[184:187], a[32:35]
    ds_read_b64_tr_b16 a[198:199], v9 offset:36864
    v_cvt_pk_bf16_f32 v215, v134, v135
    v_mfma_f32_16x16x32_bf16 a[36:39], a[208:211], v[188:191], 0
    v_exp_f32 v137, v137
    v_mfma_f32_16x16x32_bf16 a[36:39], a[212:215], v[192:195], a[36:39]
    ds_read_b128 a[164:167], v2 offset:40960
    v_cvt_pk_bf16_f32 v222, v136, v137
    v_mfma_f32_16x16x32_bf16 a[40:43], a[208:211], v[196:199], 0
    s_add_u32 s28, s28, 16384
    s_mov_b32 m0, s32
    v_exp_f32 v138, v138
    v_mfma_f32_16x16x32_bf16 a[40:43], a[212:215], v[200:203], a[40:43]
    buffer_load_dwordx4 v17, s[12:15], s29 offen offset:0 lds
    v_mfma_f32_16x16x32_bf16 a[44:47], a[208:211], v[204:207], 0
    v_exp_f32 v139, v139
    v_mfma_f32_16x16x32_bf16 a[44:47], a[212:215], v[208:211], a[44:47]
    s_waitcnt lgkmcnt(6)
    v_mfma_f32_16x16x32_bf16 v[132:135], a[144:147], v[36:39], v[100:103]
    v_exp_f32 v140, v140
    v_mfma_f32_16x16x32_bf16 v[132:135], a[148:151], v[40:43], v[132:135]
    ds_read_b64_tr_b16 a[200:201], v10 offset:8192
    v_cvt_pk_bf16_f32 v223, v138, v139
    v_mfma_f32_16x16x32_bf16 v[132:135], a[152:155], v[44:47], v[132:135]
    v_exp_f32 v141, v141
    v_mfma_f32_16x16x32_bf16 v[132:135], a[156:159], v[48:51], v[132:135]
    ds_read_b64_tr_b16 a[202:203], v10 offset:12288
    v_mfma_f32_16x16x32_bf16 v[136:139], a[144:147], v[52:55], v[104:107]
    v_exp_f32 v142, v142
    v_mfma_f32_16x16x32_bf16 v[136:139], a[148:151], v[56:59], v[136:139]
    ds_read_b128 a[168:171], v3 offset:40960
    v_cvt_pk_bf16_f32 v230, v140, v141
    v_mfma_f32_16x16x32_bf16 v[136:139], a[152:155], v[60:63], v[136:139]
    v_exp_f32 v143, v143
    v_mfma_f32_16x16x32_bf16 v[136:139], a[156:159], v[64:67], v[136:139]
    ds_read_b64_tr_b16 a[204:205], v10 offset:32768
    v_mfma_f32_16x16x32_bf16 a[48:51], a[216:219], v[180:183], 0
    v_exp_f32 v144, v144
    v_mfma_f32_16x16x32_bf16 a[48:51], a[220:223], v[184:187], a[48:51]
    ds_read_b64_tr_b16 a[206:207], v10 offset:36864
    v_cvt_pk_bf16_f32 v231, v142, v143
    v_mfma_f32_16x16x32_bf16 a[52:55], a[216:219], v[188:191], 0
    v_exp_f32 v145, v145
    v_mfma_f32_16x16x32_bf16 a[52:55], a[220:223], v[192:195], a[52:55]
    ds_read_b128 a[172:175], v4 offset:40960
    v_mfma_f32_16x16x32_bf16 a[56:59], a[216:219], v[196:199], 0
    v_exp_f32 v146, v146
    v_mfma_f32_16x16x32_bf16 a[56:59], a[220:223], v[200:203], a[56:59]
    v_cvt_pk_bf16_f32 v238, v144, v145
    v_mfma_f32_16x16x32_bf16 a[60:63], a[216:219], v[204:207], 0
    v_exp_f32 v147, v147
    v_mfma_f32_16x16x32_bf16 a[60:63], a[220:223], v[208:211], a[60:63]
    buffer_load_dwordx4 v18, s[12:15], s29 offen offset:1024 lds
    v_smfmac_f32_16x16x64_bf16 a[228:231], v[244:247], v[188:195], v248
    s_waitcnt lgkmcnt(6)
    v_mfma_f32_16x16x32_bf16 v[140:143], a[144:147], v[68:71], v[108:111]
    v_exp_f32 v148, v148
    v_mfma_f32_16x16x32_bf16 v[140:143], a[148:151], v[72:75], v[140:143]
    ds_read_b64_tr_b16 a[208:209], v11 offset:8192
    v_cvt_pk_bf16_f32 v239, v146, v147
    v_mfma_f32_16x16x32_bf16 v[140:143], a[152:155], v[76:79], v[140:143]
    v_exp_f32 v149, v149
    v_mfma_f32_16x16x32_bf16 v[140:143], a[156:159], v[80:83], v[140:143]
    ds_read_b64_tr_b16 a[210:211], v11 offset:12288
    v_mfma_f32_16x16x32_bf16 v[144:147], a[144:147], v[84:87], v[112:115]
    v_exp_f32 v150, v150
    v_mfma_f32_16x16x32_bf16 v[144:147], a[148:151], v[88:91], v[144:147]
    ds_read_b128 a[176:179], v1 offset:45056
    v_cvt_pk_bf16_f32 v216, v148, v149
    v_mfma_f32_16x16x32_bf16 v[144:147], a[152:155], v[92:95], v[144:147]
    v_exp_f32 v151, v151
    v_mfma_f32_16x16x32_bf16 v[144:147], a[156:159], v[96:99], v[144:147]
    ds_read_b64_tr_b16 a[212:213], v11 offset:32768
    v_mfma_f32_16x16x32_bf16 a[64:67], a[192:195], v[180:183], 0
    v_exp_f32 v152, v152
    v_mfma_f32_16x16x32_bf16 a[64:67], a[196:199], v[184:187], a[64:67]
    ds_read_b64_tr_b16 a[214:215], v11 offset:36864
    v_cvt_pk_bf16_f32 v217, v150, v151
    v_mfma_f32_16x16x32_bf16 a[68:71], a[192:195], v[188:191], 0
    v_exp_f32 v153, v153
    v_mfma_f32_16x16x32_bf16 a[68:71], a[196:199], v[192:195], a[68:71]
    ds_read_b128 a[180:183], v2 offset:45056
    v_cvt_pk_bf16_f32 v224, v152, v153
    v_mfma_f32_16x16x32_bf16 a[72:75], a[192:195], v[196:199], 0
    v_exp_f32 v154, v154
    v_mfma_f32_16x16x32_bf16 a[72:75], a[196:199], v[200:203], a[72:75]
    buffer_load_dwordx4 v17, s[12:15], s29 offen offset:2048 lds
    v_mfma_f32_16x16x32_bf16 a[76:79], a[192:195], v[204:207], 0
    v_exp_f32 v155, v155
    v_mfma_f32_16x16x32_bf16 a[76:79], a[196:199], v[208:211], a[76:79]
    s_waitcnt lgkmcnt(6)
    v_mfma_f32_16x16x32_bf16 v[148:151], a[160:163], v[36:39], v[100:103]
    v_exp_f32 v156, v156
    v_mfma_f32_16x16x32_bf16 v[148:151], a[164:167], v[40:43], v[148:151]
    ds_read_b64_tr_b16 a[216:217], v12 offset:8192
    v_cvt_pk_bf16_f32 v225, v154, v155
    v_mfma_f32_16x16x32_bf16 v[148:151], a[168:171], v[44:47], v[148:151]
    v_exp_f32 v157, v157
    v_mfma_f32_16x16x32_bf16 v[148:151], a[172:175], v[48:51], v[148:151]
    ds_read_b64_tr_b16 a[218:219], v12 offset:12288
    v_mfma_f32_16x16x32_bf16 v[152:155], a[160:163], v[52:55], v[104:107]
    v_exp_f32 v158, v158
    v_mfma_f32_16x16x32_bf16 v[152:155], a[164:167], v[56:59], v[152:155]
    ds_read_b128 a[184:187], v3 offset:45056
    v_cvt_pk_bf16_f32 v232, v156, v157
    v_mfma_f32_16x16x32_bf16 v[152:155], a[168:171], v[60:63], v[152:155]
    v_exp_f32 v159, v159
    v_mfma_f32_16x16x32_bf16 v[152:155], a[172:175], v[64:67], v[152:155]
    ds_read_b64_tr_b16 a[220:221], v12 offset:32768
    v_mfma_f32_16x16x32_bf16 a[80:83], a[200:203], v[180:183], 0
    v_exp_f32 v160, v160
    v_mfma_f32_16x16x32_bf16 a[80:83], a[204:207], v[184:187], a[80:83]
    ds_read_b64_tr_b16 a[222:223], v12 offset:36864
    v_cvt_pk_bf16_f32 v233, v158, v159
    v_mfma_f32_16x16x32_bf16 a[84:87], a[200:203], v[188:191], 0
    v_exp_f32 v161, v161
    v_mfma_f32_16x16x32_bf16 a[84:87], a[204:207], v[192:195], a[84:87]
    ds_read_b128 a[188:191], v4 offset:45056
    v_mfma_f32_16x16x32_bf16 a[88:91], a[200:203], v[196:199], 0
    v_exp_f32 v162, v162
    v_mfma_f32_16x16x32_bf16 a[88:91], a[204:207], v[200:203], a[88:91]
    v_cvt_pk_bf16_f32 v240, v160, v161
    v_mfma_f32_16x16x32_bf16 a[92:95], a[200:203], v[204:207], 0
    v_exp_f32 v163, v163
    v_mfma_f32_16x16x32_bf16 a[92:95], a[204:207], v[208:211], a[92:95]
    buffer_load_dwordx4 v18, s[12:15], s29 offen offset:3072 lds
    v_smfmac_f32_16x16x64_bf16 a[232:235], v[244:247], v[196:203], v248
    s_waitcnt vmcnt(8) lgkmcnt(6)
    s_barrier
    s_add_u32 s29, s29, 16384
    v_mfma_f32_16x16x32_bf16 v[156:159], a[160:163], v[68:71], v[108:111]
    v_exp_f32 v164, v164
    v_mfma_f32_16x16x32_bf16 v[156:159], a[164:167], v[72:75], v[156:159]
    ds_read_b64_tr_b16 a[192:193], v5 offset:16384
    v_cvt_pk_bf16_f32 v241, v162, v163
    v_mfma_f32_16x16x32_bf16 v[156:159], a[168:171], v[76:79], v[156:159]
    v_exp_f32 v165, v165
    v_mfma_f32_16x16x32_bf16 v[156:159], a[172:175], v[80:83], v[156:159]
    ds_read_b64_tr_b16 a[194:195], v5 offset:20480
    v_mfma_f32_16x16x32_bf16 v[160:163], a[160:163], v[84:87], v[112:115]
    v_exp_f32 v166, v166
    v_mfma_f32_16x16x32_bf16 v[160:163], a[164:167], v[88:91], v[160:163]
    ds_read_b128 a[128:131], v1 offset:0
    v_cvt_pk_bf16_f32 v218, v164, v165
    v_mfma_f32_16x16x32_bf16 v[160:163], a[168:171], v[92:95], v[160:163]
    v_exp_f32 v167, v167
    v_mfma_f32_16x16x32_bf16 v[160:163], a[172:175], v[96:99], v[160:163]
    ds_read_b64_tr_b16 a[196:197], v5 offset:40960
    v_mfma_f32_16x16x32_bf16 a[96:99], a[208:211], v[180:183], 0
    v_exp_f32 v168, v168
    v_mfma_f32_16x16x32_bf16 a[96:99], a[212:215], v[184:187], a[96:99]
    ds_read_b64_tr_b16 a[198:199], v5 offset:45056
    v_cvt_pk_bf16_f32 v219, v166, v167
    v_mfma_f32_16x16x32_bf16 a[100:103], a[208:211], v[188:191], 0
    v_exp_f32 v169, v169
    v_mfma_f32_16x16x32_bf16 a[100:103], a[212:215], v[192:195], a[100:103]
    ds_read_b128 a[132:135], v2 offset:0
    v_cvt_pk_bf16_f32 v226, v168, v169
    v_mfma_f32_16x16x32_bf16 a[104:107], a[208:211], v[196:199], 0
    s_add_u32 m0, s34, 16384
    v_exp_f32 v170, v170
    v_mfma_f32_16x16x32_bf16 a[104:107], a[212:215], v[200:203], a[104:107]
    buffer_load_dwordx4 v13, s[8:11], s28 offen offset:0 lds
    v_mfma_f32_16x16x32_bf16 a[108:111], a[208:211], v[204:207], 0
    v_exp_f32 v171, v171
    v_mfma_f32_16x16x32_bf16 a[108:111], a[212:215], v[208:211], a[108:111]
    s_waitcnt lgkmcnt(6)
    v_mfma_f32_16x16x32_bf16 v[164:167], a[176:179], v[36:39], v[100:103]
    v_exp_f32 v172, v172
    v_mfma_f32_16x16x32_bf16 v[164:167], a[180:183], v[40:43], v[164:167]
    ds_read_b64_tr_b16 a[200:201], v6 offset:16384
    v_cvt_pk_bf16_f32 v227, v170, v171
    v_mfma_f32_16x16x32_bf16 v[164:167], a[184:187], v[44:47], v[164:167]
    v_exp_f32 v173, v173
    v_mfma_f32_16x16x32_bf16 v[164:167], a[188:191], v[48:51], v[164:167]
    ds_read_b64_tr_b16 a[202:203], v6 offset:20480
    v_mfma_f32_16x16x32_bf16 v[168:171], a[176:179], v[52:55], v[104:107]
    v_exp_f32 v174, v174
    v_mfma_f32_16x16x32_bf16 v[168:171], a[180:183], v[56:59], v[168:171]
    ds_read_b128 a[136:139], v3 offset:0
    v_cvt_pk_bf16_f32 v234, v172, v173
    v_mfma_f32_16x16x32_bf16 v[168:171], a[184:187], v[60:63], v[168:171]
    v_exp_f32 v175, v175
    v_mfma_f32_16x16x32_bf16 v[168:171], a[188:191], v[64:67], v[168:171]
    ds_read_b64_tr_b16 a[204:205], v6 offset:40960
    v_mfma_f32_16x16x32_bf16 a[112:115], a[216:219], v[180:183], 0
    v_exp_f32 v176, v176
    v_mfma_f32_16x16x32_bf16 a[112:115], a[220:223], v[184:187], a[112:115]
    ds_read_b64_tr_b16 a[206:207], v6 offset:45056
    v_cvt_pk_bf16_f32 v235, v174, v175
    v_mfma_f32_16x16x32_bf16 a[116:119], a[216:219], v[188:191], 0
    v_exp_f32 v177, v177
    v_mfma_f32_16x16x32_bf16 a[116:119], a[220:223], v[192:195], a[116:119]
    ds_read_b128 a[140:143], v4 offset:0
    v_mfma_f32_16x16x32_bf16 a[120:123], a[216:219], v[196:199], 0
    v_exp_f32 v178, v178
    v_mfma_f32_16x16x32_bf16 a[120:123], a[220:223], v[200:203], a[120:123]
    v_cvt_pk_bf16_f32 v242, v176, v177
    v_mfma_f32_16x16x32_bf16 a[124:127], a[216:219], v[204:207], 0
    v_exp_f32 v179, v179
    v_mfma_f32_16x16x32_bf16 a[124:127], a[220:223], v[208:211], a[124:127]
    buffer_load_dwordx4 v14, s[8:11], s28 offen offset:1024 lds
    v_smfmac_f32_16x16x64_bf16 a[236:239], v[244:247], v[204:211], v248
    s_waitcnt lgkmcnt(6)
    s_mov_b32 s35, 6
.p2align 6
L_attn_loop:
    v_mfma_f32_16x16x32_bf16 v[172:175], a[176:179], v[68:71], v[108:111]
    v_exp_f32 v116, v116
    v_mfma_f32_16x16x32_bf16 v[172:175], a[180:183], v[72:75], v[172:175]
    ds_read_b64_tr_b16 a[208:209], v7 offset:16384
    v_cvt_pk_bf16_f32 v243, v178, v179
    v_mfma_f32_16x16x32_bf16 v[172:175], a[184:187], v[76:79], v[172:175]
    v_exp_f32 v117, v117
    v_mfma_f32_16x16x32_bf16 v[172:175], a[188:191], v[80:83], v[172:175]
    ds_read_b64_tr_b16 a[210:211], v7 offset:20480
    v_mfma_f32_16x16x32_bf16 v[176:179], a[176:179], v[84:87], v[112:115]
    v_exp_f32 v118, v118
    v_mfma_f32_16x16x32_bf16 v[176:179], a[180:183], v[88:91], v[176:179]
    ds_read_b128 a[144:147], v1 offset:4096
    v_cvt_pk_bf16_f32 v180, v116, v117
    v_mfma_f32_16x16x32_bf16 v[176:179], a[184:187], v[92:95], v[176:179]
    v_exp_f32 v119, v119
    v_mfma_f32_16x16x32_bf16 v[176:179], a[188:191], v[96:99], v[176:179]
    ds_read_b64_tr_b16 a[212:213], v7 offset:40960
    v_mfma_f32_16x16x32_bf16 a[0:3], a[192:195], v[212:215], a[0:3]
    v_exp_f32 v120, v120
    v_mfma_f32_16x16x32_bf16 a[0:3], a[196:199], v[216:219], a[0:3]
    ds_read_b64_tr_b16 a[214:215], v7 offset:45056
    v_cvt_pk_bf16_f32 v181, v118, v119
    v_mfma_f32_16x16x32_bf16 a[4:7], a[192:195], v[220:223], a[4:7]
    v_exp_f32 v121, v121
    v_mfma_f32_16x16x32_bf16 a[4:7], a[196:199], v[224:227], a[4:7]
    ds_read_b128 a[148:151], v2 offset:4096
    v_cvt_pk_bf16_f32 v188, v120, v121
    v_mfma_f32_16x16x32_bf16 a[8:11], a[192:195], v[228:231], a[8:11]
    v_exp_f32 v122, v122
    v_mfma_f32_16x16x32_bf16 a[8:11], a[196:199], v[232:235], a[8:11]
    buffer_load_dwordx4 v15, s[8:11], s28 offen offset:2048 lds
    v_mfma_f32_16x16x32_bf16 a[12:15], a[192:195], v[236:239], a[12:15]
    v_exp_f32 v123, v123
    v_mfma_f32_16x16x32_bf16 a[12:15], a[196:199], v[240:243], a[12:15]
    s_waitcnt lgkmcnt(6)
    v_mfma_f32_16x16x32_bf16 v[116:119], a[128:131], v[36:39], v[100:103]
    v_exp_f32 v124, v124
    v_mfma_f32_16x16x32_bf16 v[116:119], a[132:135], v[40:43], v[116:119]
    ds_read_b64_tr_b16 a[216:217], v8 offset:16384
    v_cvt_pk_bf16_f32 v189, v122, v123
    v_mfma_f32_16x16x32_bf16 v[116:119], a[136:139], v[44:47], v[116:119]
    v_exp_f32 v125, v125
    v_mfma_f32_16x16x32_bf16 v[116:119], a[140:143], v[48:51], v[116:119]
    ds_read_b64_tr_b16 a[218:219], v8 offset:20480
    v_mfma_f32_16x16x32_bf16 v[120:123], a[128:131], v[52:55], v[104:107]
    v_exp_f32 v126, v126
    v_mfma_f32_16x16x32_bf16 v[120:123], a[132:135], v[56:59], v[120:123]
    ds_read_b128 a[152:155], v3 offset:4096
    v_cvt_pk_bf16_f32 v196, v124, v125
    v_mfma_f32_16x16x32_bf16 v[120:123], a[136:139], v[60:63], v[120:123]
    v_exp_f32 v127, v127
    v_mfma_f32_16x16x32_bf16 v[120:123], a[140:143], v[64:67], v[120:123]
    ds_read_b64_tr_b16 a[220:221], v8 offset:40960
    v_mfma_f32_16x16x32_bf16 a[16:19], a[200:203], v[212:215], a[16:19]
    v_exp_f32 v128, v128
    v_mfma_f32_16x16x32_bf16 a[16:19], a[204:207], v[216:219], a[16:19]
    ds_read_b64_tr_b16 a[222:223], v8 offset:45056
    v_cvt_pk_bf16_f32 v197, v126, v127
    v_mfma_f32_16x16x32_bf16 a[20:23], a[200:203], v[220:223], a[20:23]
    v_exp_f32 v129, v129
    v_mfma_f32_16x16x32_bf16 a[20:23], a[204:207], v[224:227], a[20:23]
    ds_read_b128 a[156:159], v4 offset:4096
    v_mfma_f32_16x16x32_bf16 a[24:27], a[200:203], v[228:231], a[24:27]
    v_exp_f32 v130, v130
    v_mfma_f32_16x16x32_bf16 a[24:27], a[204:207], v[232:235], a[24:27]
    v_cvt_pk_bf16_f32 v204, v128, v129
    v_mfma_f32_16x16x32_bf16 a[28:31], a[200:203], v[236:239], a[28:31]
    v_exp_f32 v131, v131
    v_mfma_f32_16x16x32_bf16 a[28:31], a[204:207], v[240:243], a[28:31]
    buffer_load_dwordx4 v16, s[8:11], s28 offen offset:3072 lds
    v_smfmac_f32_16x16x64_bf16 a[224:227], v[244:247], v[212:219], v248
    s_waitcnt lgkmcnt(6)
    v_mfma_f32_16x16x32_bf16 v[124:127], a[128:131], v[68:71], v[108:111]
    v_exp_f32 v132, v132
    v_mfma_f32_16x16x32_bf16 v[124:127], a[132:135], v[72:75], v[124:127]
    ds_read_b64_tr_b16 a[192:193], v9 offset:16384
    v_cvt_pk_bf16_f32 v205, v130, v131
    v_mfma_f32_16x16x32_bf16 v[124:127], a[136:139], v[76:79], v[124:127]
    v_exp_f32 v133, v133
    v_mfma_f32_16x16x32_bf16 v[124:127], a[140:143], v[80:83], v[124:127]
    ds_read_b64_tr_b16 a[194:195], v9 offset:20480
    v_mfma_f32_16x16x32_bf16 v[128:131], a[128:131], v[84:87], v[112:115]
    v_exp_f32 v134, v134
    v_mfma_f32_16x16x32_bf16 v[128:131], a[132:135], v[88:91], v[128:131]
    ds_read_b128 a[160:163], v1 offset:8192
    v_cvt_pk_bf16_f32 v182, v132, v133
    v_mfma_f32_16x16x32_bf16 v[128:131], a[136:139], v[92:95], v[128:131]
    v_exp_f32 v135, v135
    v_mfma_f32_16x16x32_bf16 v[128:131], a[140:143], v[96:99], v[128:131]
    ds_read_b64_tr_b16 a[196:197], v9 offset:40960
    v_mfma_f32_16x16x32_bf16 a[32:35], a[208:211], v[212:215], a[32:35]
    v_exp_f32 v136, v136
    v_mfma_f32_16x16x32_bf16 a[32:35], a[212:215], v[216:219], a[32:35]
    ds_read_b64_tr_b16 a[198:199], v9 offset:45056
    v_cvt_pk_bf16_f32 v183, v134, v135
    v_mfma_f32_16x16x32_bf16 a[36:39], a[208:211], v[220:223], a[36:39]
    v_exp_f32 v137, v137
    v_mfma_f32_16x16x32_bf16 a[36:39], a[212:215], v[224:227], a[36:39]
    ds_read_b128 a[164:167], v2 offset:8192
    v_cvt_pk_bf16_f32 v190, v136, v137
    v_mfma_f32_16x16x32_bf16 a[40:43], a[208:211], v[228:231], a[40:43]
    s_add_u32 s28, s28, 16384
    s_mov_b32 m0, s33
    v_exp_f32 v138, v138
    v_mfma_f32_16x16x32_bf16 a[40:43], a[212:215], v[232:235], a[40:43]
    buffer_load_dwordx4 v17, s[12:15], s29 offen offset:0 lds
    v_mfma_f32_16x16x32_bf16 a[44:47], a[208:211], v[236:239], a[44:47]
    v_exp_f32 v139, v139
    v_mfma_f32_16x16x32_bf16 a[44:47], a[212:215], v[240:243], a[44:47]
    s_waitcnt lgkmcnt(6)
    v_mfma_f32_16x16x32_bf16 v[132:135], a[144:147], v[36:39], v[100:103]
    v_exp_f32 v140, v140
    v_mfma_f32_16x16x32_bf16 v[132:135], a[148:151], v[40:43], v[132:135]
    ds_read_b64_tr_b16 a[200:201], v10 offset:16384
    v_cvt_pk_bf16_f32 v191, v138, v139
    v_mfma_f32_16x16x32_bf16 v[132:135], a[152:155], v[44:47], v[132:135]
    v_exp_f32 v141, v141
    v_mfma_f32_16x16x32_bf16 v[132:135], a[156:159], v[48:51], v[132:135]
    ds_read_b64_tr_b16 a[202:203], v10 offset:20480
    v_mfma_f32_16x16x32_bf16 v[136:139], a[144:147], v[52:55], v[104:107]
    v_exp_f32 v142, v142
    v_mfma_f32_16x16x32_bf16 v[136:139], a[148:151], v[56:59], v[136:139]
    ds_read_b128 a[168:171], v3 offset:8192
    v_cvt_pk_bf16_f32 v198, v140, v141
    v_mfma_f32_16x16x32_bf16 v[136:139], a[152:155], v[60:63], v[136:139]
    v_exp_f32 v143, v143
    v_mfma_f32_16x16x32_bf16 v[136:139], a[156:159], v[64:67], v[136:139]
    ds_read_b64_tr_b16 a[204:205], v10 offset:40960
    v_mfma_f32_16x16x32_bf16 a[48:51], a[216:219], v[212:215], a[48:51]
    v_exp_f32 v144, v144
    v_mfma_f32_16x16x32_bf16 a[48:51], a[220:223], v[216:219], a[48:51]
    ds_read_b64_tr_b16 a[206:207], v10 offset:45056
    v_cvt_pk_bf16_f32 v199, v142, v143
    v_mfma_f32_16x16x32_bf16 a[52:55], a[216:219], v[220:223], a[52:55]
    v_exp_f32 v145, v145
    v_mfma_f32_16x16x32_bf16 a[52:55], a[220:223], v[224:227], a[52:55]
    ds_read_b128 a[172:175], v4 offset:8192
    v_mfma_f32_16x16x32_bf16 a[56:59], a[216:219], v[228:231], a[56:59]
    v_exp_f32 v146, v146
    v_mfma_f32_16x16x32_bf16 a[56:59], a[220:223], v[232:235], a[56:59]
    v_cvt_pk_bf16_f32 v206, v144, v145
    v_mfma_f32_16x16x32_bf16 a[60:63], a[216:219], v[236:239], a[60:63]
    v_exp_f32 v147, v147
    v_mfma_f32_16x16x32_bf16 a[60:63], a[220:223], v[240:243], a[60:63]
    buffer_load_dwordx4 v18, s[12:15], s29 offen offset:1024 lds
    v_smfmac_f32_16x16x64_bf16 a[228:231], v[244:247], v[220:227], v248
    s_waitcnt lgkmcnt(6)
    v_mfma_f32_16x16x32_bf16 v[140:143], a[144:147], v[68:71], v[108:111]
    v_exp_f32 v148, v148
    v_mfma_f32_16x16x32_bf16 v[140:143], a[148:151], v[72:75], v[140:143]
    ds_read_b64_tr_b16 a[208:209], v11 offset:16384
    v_cvt_pk_bf16_f32 v207, v146, v147
    v_mfma_f32_16x16x32_bf16 v[140:143], a[152:155], v[76:79], v[140:143]
    v_exp_f32 v149, v149
    v_mfma_f32_16x16x32_bf16 v[140:143], a[156:159], v[80:83], v[140:143]
    ds_read_b64_tr_b16 a[210:211], v11 offset:20480
    v_mfma_f32_16x16x32_bf16 v[144:147], a[144:147], v[84:87], v[112:115]
    v_exp_f32 v150, v150
    v_mfma_f32_16x16x32_bf16 v[144:147], a[148:151], v[88:91], v[144:147]
    ds_read_b128 a[176:179], v1 offset:12288
    v_cvt_pk_bf16_f32 v184, v148, v149
    v_mfma_f32_16x16x32_bf16 v[144:147], a[152:155], v[92:95], v[144:147]
    v_exp_f32 v151, v151
    v_mfma_f32_16x16x32_bf16 v[144:147], a[156:159], v[96:99], v[144:147]
    ds_read_b64_tr_b16 a[212:213], v11 offset:40960
    v_mfma_f32_16x16x32_bf16 a[64:67], a[192:195], v[212:215], a[64:67]
    v_exp_f32 v152, v152
    v_mfma_f32_16x16x32_bf16 a[64:67], a[196:199], v[216:219], a[64:67]
    ds_read_b64_tr_b16 a[214:215], v11 offset:45056
    v_cvt_pk_bf16_f32 v185, v150, v151
    v_mfma_f32_16x16x32_bf16 a[68:71], a[192:195], v[220:223], a[68:71]
    v_exp_f32 v153, v153
    v_mfma_f32_16x16x32_bf16 a[68:71], a[196:199], v[224:227], a[68:71]
    ds_read_b128 a[180:183], v2 offset:12288
    v_cvt_pk_bf16_f32 v192, v152, v153
    v_mfma_f32_16x16x32_bf16 a[72:75], a[192:195], v[228:231], a[72:75]
    v_exp_f32 v154, v154
    v_mfma_f32_16x16x32_bf16 a[72:75], a[196:199], v[232:235], a[72:75]
    buffer_load_dwordx4 v17, s[12:15], s29 offen offset:2048 lds
    v_mfma_f32_16x16x32_bf16 a[76:79], a[192:195], v[236:239], a[76:79]
    v_exp_f32 v155, v155
    v_mfma_f32_16x16x32_bf16 a[76:79], a[196:199], v[240:243], a[76:79]
    s_waitcnt lgkmcnt(6)
    v_mfma_f32_16x16x32_bf16 v[148:151], a[160:163], v[36:39], v[100:103]
    v_exp_f32 v156, v156
    v_mfma_f32_16x16x32_bf16 v[148:151], a[164:167], v[40:43], v[148:151]
    ds_read_b64_tr_b16 a[216:217], v12 offset:16384
    v_cvt_pk_bf16_f32 v193, v154, v155
    v_mfma_f32_16x16x32_bf16 v[148:151], a[168:171], v[44:47], v[148:151]
    v_exp_f32 v157, v157
    v_mfma_f32_16x16x32_bf16 v[148:151], a[172:175], v[48:51], v[148:151]
    ds_read_b64_tr_b16 a[218:219], v12 offset:20480
    v_mfma_f32_16x16x32_bf16 v[152:155], a[160:163], v[52:55], v[104:107]
    v_exp_f32 v158, v158
    v_mfma_f32_16x16x32_bf16 v[152:155], a[164:167], v[56:59], v[152:155]
    ds_read_b128 a[184:187], v3 offset:12288
    v_cvt_pk_bf16_f32 v200, v156, v157
    v_mfma_f32_16x16x32_bf16 v[152:155], a[168:171], v[60:63], v[152:155]
    v_exp_f32 v159, v159
    v_mfma_f32_16x16x32_bf16 v[152:155], a[172:175], v[64:67], v[152:155]
    ds_read_b64_tr_b16 a[220:221], v12 offset:40960
    v_mfma_f32_16x16x32_bf16 a[80:83], a[200:203], v[212:215], a[80:83]
    v_exp_f32 v160, v160
    v_mfma_f32_16x16x32_bf16 a[80:83], a[204:207], v[216:219], a[80:83]
    ds_read_b64_tr_b16 a[222:223], v12 offset:45056
    v_cvt_pk_bf16_f32 v201, v158, v159
    v_mfma_f32_16x16x32_bf16 a[84:87], a[200:203], v[220:223], a[84:87]
    v_exp_f32 v161, v161
    v_mfma_f32_16x16x32_bf16 a[84:87], a[204:207], v[224:227], a[84:87]
    ds_read_b128 a[188:191], v4 offset:12288
    v_mfma_f32_16x16x32_bf16 a[88:91], a[200:203], v[228:231], a[88:91]
    v_exp_f32 v162, v162
    v_mfma_f32_16x16x32_bf16 a[88:91], a[204:207], v[232:235], a[88:91]
    v_cvt_pk_bf16_f32 v208, v160, v161
    v_mfma_f32_16x16x32_bf16 a[92:95], a[200:203], v[236:239], a[92:95]
    v_exp_f32 v163, v163
    v_mfma_f32_16x16x32_bf16 a[92:95], a[204:207], v[240:243], a[92:95]
    buffer_load_dwordx4 v18, s[12:15], s29 offen offset:3072 lds
    v_smfmac_f32_16x16x64_bf16 a[232:235], v[244:247], v[228:235], v248
    s_waitcnt vmcnt(8) lgkmcnt(6)
    s_barrier
    s_add_u32 s29, s29, 16384
    v_mfma_f32_16x16x32_bf16 v[156:159], a[160:163], v[68:71], v[108:111]
    v_exp_f32 v164, v164
    v_mfma_f32_16x16x32_bf16 v[156:159], a[164:167], v[72:75], v[156:159]
    ds_read_b64_tr_b16 a[192:193], v5 offset:57344
    v_cvt_pk_bf16_f32 v209, v162, v163
    v_mfma_f32_16x16x32_bf16 v[156:159], a[168:171], v[76:79], v[156:159]
    v_exp_f32 v165, v165
    v_mfma_f32_16x16x32_bf16 v[156:159], a[172:175], v[80:83], v[156:159]
    ds_read_b64_tr_b16 a[194:195], v5 offset:61440
    v_mfma_f32_16x16x32_bf16 v[160:163], a[160:163], v[84:87], v[112:115]
    v_exp_f32 v166, v166
    v_mfma_f32_16x16x32_bf16 v[160:163], a[164:167], v[88:91], v[160:163]
    ds_read_b128 a[128:131], v1 offset:49152
    v_cvt_pk_bf16_f32 v186, v164, v165
    v_mfma_f32_16x16x32_bf16 v[160:163], a[168:171], v[92:95], v[160:163]
    v_exp_f32 v167, v167
    v_mfma_f32_16x16x32_bf16 v[160:163], a[172:175], v[96:99], v[160:163]
    ds_read_b64_tr_b16 a[196:197], v5 offset:0
    v_mfma_f32_16x16x32_bf16 a[96:99], a[208:211], v[212:215], a[96:99]
    v_exp_f32 v168, v168
    v_mfma_f32_16x16x32_bf16 a[96:99], a[212:215], v[216:219], a[96:99]
    ds_read_b64_tr_b16 a[198:199], v5 offset:4096
    v_cvt_pk_bf16_f32 v187, v166, v167
    v_mfma_f32_16x16x32_bf16 a[100:103], a[208:211], v[220:223], a[100:103]
    v_exp_f32 v169, v169
    v_mfma_f32_16x16x32_bf16 a[100:103], a[212:215], v[224:227], a[100:103]
    ds_read_b128 a[132:135], v2 offset:49152
    v_cvt_pk_bf16_f32 v194, v168, v169
    v_mfma_f32_16x16x32_bf16 a[104:107], a[208:211], v[228:231], a[104:107]
    s_add_u32 m0, s34, 32768
    v_exp_f32 v170, v170
    v_mfma_f32_16x16x32_bf16 a[104:107], a[212:215], v[232:235], a[104:107]
    buffer_load_dwordx4 v13, s[8:11], s28 offen offset:0 lds
    v_mfma_f32_16x16x32_bf16 a[108:111], a[208:211], v[236:239], a[108:111]
    v_exp_f32 v171, v171
    v_mfma_f32_16x16x32_bf16 a[108:111], a[212:215], v[240:243], a[108:111]
    s_waitcnt lgkmcnt(6)
    v_mfma_f32_16x16x32_bf16 v[164:167], a[176:179], v[36:39], v[100:103]
    v_exp_f32 v172, v172
    v_mfma_f32_16x16x32_bf16 v[164:167], a[180:183], v[40:43], v[164:167]
    ds_read_b64_tr_b16 a[200:201], v6 offset:57344
    v_cvt_pk_bf16_f32 v195, v170, v171
    v_mfma_f32_16x16x32_bf16 v[164:167], a[184:187], v[44:47], v[164:167]
    v_exp_f32 v173, v173
    v_mfma_f32_16x16x32_bf16 v[164:167], a[188:191], v[48:51], v[164:167]
    ds_read_b64_tr_b16 a[202:203], v6 offset:61440
    v_mfma_f32_16x16x32_bf16 v[168:171], a[176:179], v[52:55], v[104:107]
    v_exp_f32 v174, v174
    v_mfma_f32_16x16x32_bf16 v[168:171], a[180:183], v[56:59], v[168:171]
    ds_read_b128 a[136:139], v3 offset:49152
    v_cvt_pk_bf16_f32 v202, v172, v173
    v_mfma_f32_16x16x32_bf16 v[168:171], a[184:187], v[60:63], v[168:171]
    v_exp_f32 v175, v175
    v_mfma_f32_16x16x32_bf16 v[168:171], a[188:191], v[64:67], v[168:171]
    ds_read_b64_tr_b16 a[204:205], v6 offset:0
    v_mfma_f32_16x16x32_bf16 a[112:115], a[216:219], v[212:215], a[112:115]
    v_exp_f32 v176, v176
    v_mfma_f32_16x16x32_bf16 a[112:115], a[220:223], v[216:219], a[112:115]
    ds_read_b64_tr_b16 a[206:207], v6 offset:4096
    v_cvt_pk_bf16_f32 v203, v174, v175
    v_mfma_f32_16x16x32_bf16 a[116:119], a[216:219], v[220:223], a[116:119]
    v_exp_f32 v177, v177
    v_mfma_f32_16x16x32_bf16 a[116:119], a[220:223], v[224:227], a[116:119]
    ds_read_b128 a[140:143], v4 offset:49152
    v_mfma_f32_16x16x32_bf16 a[120:123], a[216:219], v[228:231], a[120:123]
    v_exp_f32 v178, v178
    v_mfma_f32_16x16x32_bf16 a[120:123], a[220:223], v[232:235], a[120:123]
    v_cvt_pk_bf16_f32 v210, v176, v177
    v_mfma_f32_16x16x32_bf16 a[124:127], a[216:219], v[236:239], a[124:127]
    v_exp_f32 v179, v179
    v_mfma_f32_16x16x32_bf16 a[124:127], a[220:223], v[240:243], a[124:127]
    buffer_load_dwordx4 v14, s[8:11], s28 offen offset:1024 lds
    v_smfmac_f32_16x16x64_bf16 a[236:239], v[244:247], v[236:243], v248
    s_waitcnt lgkmcnt(6)
    v_mfma_f32_16x16x32_bf16 v[172:175], a[176:179], v[68:71], v[108:111]
    v_exp_f32 v116, v116
    v_mfma_f32_16x16x32_bf16 v[172:175], a[180:183], v[72:75], v[172:175]
    ds_read_b64_tr_b16 a[208:209], v7 offset:57344
    v_cvt_pk_bf16_f32 v211, v178, v179
    v_mfma_f32_16x16x32_bf16 v[172:175], a[184:187], v[76:79], v[172:175]
    v_exp_f32 v117, v117
    v_mfma_f32_16x16x32_bf16 v[172:175], a[188:191], v[80:83], v[172:175]
    ds_read_b64_tr_b16 a[210:211], v7 offset:61440
    v_mfma_f32_16x16x32_bf16 v[176:179], a[176:179], v[84:87], v[112:115]
    v_exp_f32 v118, v118
    v_mfma_f32_16x16x32_bf16 v[176:179], a[180:183], v[88:91], v[176:179]
    ds_read_b128 a[144:147], v1 offset:53248
    v_cvt_pk_bf16_f32 v212, v116, v117
    v_mfma_f32_16x16x32_bf16 v[176:179], a[184:187], v[92:95], v[176:179]
    v_exp_f32 v119, v119
    v_mfma_f32_16x16x32_bf16 v[176:179], a[188:191], v[96:99], v[176:179]
    ds_read_b64_tr_b16 a[212:213], v7 offset:0
    v_mfma_f32_16x16x32_bf16 a[0:3], a[192:195], v[180:183], a[0:3]
    v_exp_f32 v120, v120
    v_mfma_f32_16x16x32_bf16 a[0:3], a[196:199], v[184:187], a[0:3]
    ds_read_b64_tr_b16 a[214:215], v7 offset:4096
    v_cvt_pk_bf16_f32 v213, v118, v119
    v_mfma_f32_16x16x32_bf16 a[4:7], a[192:195], v[188:191], a[4:7]
    v_exp_f32 v121, v121
    v_mfma_f32_16x16x32_bf16 a[4:7], a[196:199], v[192:195], a[4:7]
    ds_read_b128 a[148:151], v2 offset:53248
    v_cvt_pk_bf16_f32 v220, v120, v121
    v_mfma_f32_16x16x32_bf16 a[8:11], a[192:195], v[196:199], a[8:11]
    v_exp_f32 v122, v122
    v_mfma_f32_16x16x32_bf16 a[8:11], a[196:199], v[200:203], a[8:11]
    buffer_load_dwordx4 v15, s[8:11], s28 offen offset:2048 lds
    v_mfma_f32_16x16x32_bf16 a[12:15], a[192:195], v[204:207], a[12:15]
    v_exp_f32 v123, v123
    v_mfma_f32_16x16x32_bf16 a[12:15], a[196:199], v[208:211], a[12:15]
    s_waitcnt lgkmcnt(6)
    v_mfma_f32_16x16x32_bf16 v[116:119], a[128:131], v[36:39], v[100:103]
    v_exp_f32 v124, v124
    v_mfma_f32_16x16x32_bf16 v[116:119], a[132:135], v[40:43], v[116:119]
    ds_read_b64_tr_b16 a[216:217], v8 offset:57344
    v_cvt_pk_bf16_f32 v221, v122, v123
    v_mfma_f32_16x16x32_bf16 v[116:119], a[136:139], v[44:47], v[116:119]
    v_exp_f32 v125, v125
    v_mfma_f32_16x16x32_bf16 v[116:119], a[140:143], v[48:51], v[116:119]
    ds_read_b64_tr_b16 a[218:219], v8 offset:61440
    v_mfma_f32_16x16x32_bf16 v[120:123], a[128:131], v[52:55], v[104:107]
    v_exp_f32 v126, v126
    v_mfma_f32_16x16x32_bf16 v[120:123], a[132:135], v[56:59], v[120:123]
    ds_read_b128 a[152:155], v3 offset:53248
    v_cvt_pk_bf16_f32 v228, v124, v125
    v_mfma_f32_16x16x32_bf16 v[120:123], a[136:139], v[60:63], v[120:123]
    v_exp_f32 v127, v127
    v_mfma_f32_16x16x32_bf16 v[120:123], a[140:143], v[64:67], v[120:123]
    ds_read_b64_tr_b16 a[220:221], v8 offset:0
    v_mfma_f32_16x16x32_bf16 a[16:19], a[200:203], v[180:183], a[16:19]
    v_exp_f32 v128, v128
    v_mfma_f32_16x16x32_bf16 a[16:19], a[204:207], v[184:187], a[16:19]
    ds_read_b64_tr_b16 a[222:223], v8 offset:4096
    v_cvt_pk_bf16_f32 v229, v126, v127
    v_mfma_f32_16x16x32_bf16 a[20:23], a[200:203], v[188:191], a[20:23]
    v_exp_f32 v129, v129
    v_mfma_f32_16x16x32_bf16 a[20:23], a[204:207], v[192:195], a[20:23]
    ds_read_b128 a[156:159], v4 offset:53248
    v_mfma_f32_16x16x32_bf16 a[24:27], a[200:203], v[196:199], a[24:27]
    v_exp_f32 v130, v130
    v_mfma_f32_16x16x32_bf16 a[24:27], a[204:207], v[200:203], a[24:27]
    v_cvt_pk_bf16_f32 v236, v128, v129
    v_mfma_f32_16x16x32_bf16 a[28:31], a[200:203], v[204:207], a[28:31]
    v_exp_f32 v131, v131
    v_mfma_f32_16x16x32_bf16 a[28:31], a[204:207], v[208:211], a[28:31]
    buffer_load_dwordx4 v16, s[8:11], s28 offen offset:3072 lds
    v_smfmac_f32_16x16x64_bf16 a[224:227], v[244:247], v[180:187], v248
    s_waitcnt lgkmcnt(6)
    v_mfma_f32_16x16x32_bf16 v[124:127], a[128:131], v[68:71], v[108:111]
    v_exp_f32 v132, v132
    v_mfma_f32_16x16x32_bf16 v[124:127], a[132:135], v[72:75], v[124:127]
    ds_read_b64_tr_b16 a[192:193], v9 offset:57344
    v_cvt_pk_bf16_f32 v237, v130, v131
    v_mfma_f32_16x16x32_bf16 v[124:127], a[136:139], v[76:79], v[124:127]
    v_exp_f32 v133, v133
    v_mfma_f32_16x16x32_bf16 v[124:127], a[140:143], v[80:83], v[124:127]
    ds_read_b64_tr_b16 a[194:195], v9 offset:61440
    v_mfma_f32_16x16x32_bf16 v[128:131], a[128:131], v[84:87], v[112:115]
    v_exp_f32 v134, v134
    v_mfma_f32_16x16x32_bf16 v[128:131], a[132:135], v[88:91], v[128:131]
    ds_read_b128 a[160:163], v1 offset:57344
    v_cvt_pk_bf16_f32 v214, v132, v133
    v_mfma_f32_16x16x32_bf16 v[128:131], a[136:139], v[92:95], v[128:131]
    v_exp_f32 v135, v135
    v_mfma_f32_16x16x32_bf16 v[128:131], a[140:143], v[96:99], v[128:131]
    ds_read_b64_tr_b16 a[196:197], v9 offset:0
    v_mfma_f32_16x16x32_bf16 a[32:35], a[208:211], v[180:183], a[32:35]
    v_exp_f32 v136, v136
    v_mfma_f32_16x16x32_bf16 a[32:35], a[212:215], v[184:187], a[32:35]
    ds_read_b64_tr_b16 a[198:199], v9 offset:4096
    v_cvt_pk_bf16_f32 v215, v134, v135
    v_mfma_f32_16x16x32_bf16 a[36:39], a[208:211], v[188:191], a[36:39]
    v_exp_f32 v137, v137
    v_mfma_f32_16x16x32_bf16 a[36:39], a[212:215], v[192:195], a[36:39]
    ds_read_b128 a[164:167], v2 offset:57344
    v_cvt_pk_bf16_f32 v222, v136, v137
    v_mfma_f32_16x16x32_bf16 a[40:43], a[208:211], v[196:199], a[40:43]
    s_add_u32 s28, s28, 16384
    s_mov_b32 m0, s30
    v_exp_f32 v138, v138
    v_mfma_f32_16x16x32_bf16 a[40:43], a[212:215], v[200:203], a[40:43]
    buffer_load_dwordx4 v17, s[12:15], s29 offen offset:0 lds
    v_mfma_f32_16x16x32_bf16 a[44:47], a[208:211], v[204:207], a[44:47]
    v_exp_f32 v139, v139
    v_mfma_f32_16x16x32_bf16 a[44:47], a[212:215], v[208:211], a[44:47]
    s_waitcnt lgkmcnt(6)
    v_mfma_f32_16x16x32_bf16 v[132:135], a[144:147], v[36:39], v[100:103]
    v_exp_f32 v140, v140
    v_mfma_f32_16x16x32_bf16 v[132:135], a[148:151], v[40:43], v[132:135]
    ds_read_b64_tr_b16 a[200:201], v10 offset:57344
    v_cvt_pk_bf16_f32 v223, v138, v139
    v_mfma_f32_16x16x32_bf16 v[132:135], a[152:155], v[44:47], v[132:135]
    v_exp_f32 v141, v141
    v_mfma_f32_16x16x32_bf16 v[132:135], a[156:159], v[48:51], v[132:135]
    ds_read_b64_tr_b16 a[202:203], v10 offset:61440
    v_mfma_f32_16x16x32_bf16 v[136:139], a[144:147], v[52:55], v[104:107]
    v_exp_f32 v142, v142
    v_mfma_f32_16x16x32_bf16 v[136:139], a[148:151], v[56:59], v[136:139]
    ds_read_b128 a[168:171], v3 offset:57344
    v_cvt_pk_bf16_f32 v230, v140, v141
    v_mfma_f32_16x16x32_bf16 v[136:139], a[152:155], v[60:63], v[136:139]
    v_exp_f32 v143, v143
    v_mfma_f32_16x16x32_bf16 v[136:139], a[156:159], v[64:67], v[136:139]
    ds_read_b64_tr_b16 a[204:205], v10 offset:0
    v_mfma_f32_16x16x32_bf16 a[48:51], a[216:219], v[180:183], a[48:51]
    v_exp_f32 v144, v144
    v_mfma_f32_16x16x32_bf16 a[48:51], a[220:223], v[184:187], a[48:51]
    ds_read_b64_tr_b16 a[206:207], v10 offset:4096
    v_cvt_pk_bf16_f32 v231, v142, v143
    v_mfma_f32_16x16x32_bf16 a[52:55], a[216:219], v[188:191], a[52:55]
    v_exp_f32 v145, v145
    v_mfma_f32_16x16x32_bf16 a[52:55], a[220:223], v[192:195], a[52:55]
    ds_read_b128 a[172:175], v4 offset:57344
    v_mfma_f32_16x16x32_bf16 a[56:59], a[216:219], v[196:199], a[56:59]
    v_exp_f32 v146, v146
    v_mfma_f32_16x16x32_bf16 a[56:59], a[220:223], v[200:203], a[56:59]
    v_cvt_pk_bf16_f32 v238, v144, v145
    v_mfma_f32_16x16x32_bf16 a[60:63], a[216:219], v[204:207], a[60:63]
    v_exp_f32 v147, v147
    v_mfma_f32_16x16x32_bf16 a[60:63], a[220:223], v[208:211], a[60:63]
    buffer_load_dwordx4 v18, s[12:15], s29 offen offset:1024 lds
    v_smfmac_f32_16x16x64_bf16 a[228:231], v[244:247], v[188:195], v248
    s_waitcnt lgkmcnt(6)
    v_mfma_f32_16x16x32_bf16 v[140:143], a[144:147], v[68:71], v[108:111]
    v_exp_f32 v148, v148
    v_mfma_f32_16x16x32_bf16 v[140:143], a[148:151], v[72:75], v[140:143]
    ds_read_b64_tr_b16 a[208:209], v11 offset:57344
    v_cvt_pk_bf16_f32 v239, v146, v147
    v_mfma_f32_16x16x32_bf16 v[140:143], a[152:155], v[76:79], v[140:143]
    v_exp_f32 v149, v149
    v_mfma_f32_16x16x32_bf16 v[140:143], a[156:159], v[80:83], v[140:143]
    ds_read_b64_tr_b16 a[210:211], v11 offset:61440
    v_mfma_f32_16x16x32_bf16 v[144:147], a[144:147], v[84:87], v[112:115]
    v_exp_f32 v150, v150
    v_mfma_f32_16x16x32_bf16 v[144:147], a[148:151], v[88:91], v[144:147]
    ds_read_b128 a[176:179], v1 offset:61440
    v_cvt_pk_bf16_f32 v216, v148, v149
    v_mfma_f32_16x16x32_bf16 v[144:147], a[152:155], v[92:95], v[144:147]
    v_exp_f32 v151, v151
    v_mfma_f32_16x16x32_bf16 v[144:147], a[156:159], v[96:99], v[144:147]
    ds_read_b64_tr_b16 a[212:213], v11 offset:0
    v_mfma_f32_16x16x32_bf16 a[64:67], a[192:195], v[180:183], a[64:67]
    v_exp_f32 v152, v152
    v_mfma_f32_16x16x32_bf16 a[64:67], a[196:199], v[184:187], a[64:67]
    ds_read_b64_tr_b16 a[214:215], v11 offset:4096
    v_cvt_pk_bf16_f32 v217, v150, v151
    v_mfma_f32_16x16x32_bf16 a[68:71], a[192:195], v[188:191], a[68:71]
    v_exp_f32 v153, v153
    v_mfma_f32_16x16x32_bf16 a[68:71], a[196:199], v[192:195], a[68:71]
    ds_read_b128 a[180:183], v2 offset:61440
    v_cvt_pk_bf16_f32 v224, v152, v153
    v_mfma_f32_16x16x32_bf16 a[72:75], a[192:195], v[196:199], a[72:75]
    v_exp_f32 v154, v154
    v_mfma_f32_16x16x32_bf16 a[72:75], a[196:199], v[200:203], a[72:75]
    buffer_load_dwordx4 v17, s[12:15], s29 offen offset:2048 lds
    v_mfma_f32_16x16x32_bf16 a[76:79], a[192:195], v[204:207], a[76:79]
    v_exp_f32 v155, v155
    v_mfma_f32_16x16x32_bf16 a[76:79], a[196:199], v[208:211], a[76:79]
    s_waitcnt lgkmcnt(6)
    v_mfma_f32_16x16x32_bf16 v[148:151], a[160:163], v[36:39], v[100:103]
    v_exp_f32 v156, v156
    v_mfma_f32_16x16x32_bf16 v[148:151], a[164:167], v[40:43], v[148:151]
    ds_read_b64_tr_b16 a[216:217], v12 offset:57344
    v_cvt_pk_bf16_f32 v225, v154, v155
    v_mfma_f32_16x16x32_bf16 v[148:151], a[168:171], v[44:47], v[148:151]
    v_exp_f32 v157, v157
    v_mfma_f32_16x16x32_bf16 v[148:151], a[172:175], v[48:51], v[148:151]
    ds_read_b64_tr_b16 a[218:219], v12 offset:61440
    v_mfma_f32_16x16x32_bf16 v[152:155], a[160:163], v[52:55], v[104:107]
    v_exp_f32 v158, v158
    v_mfma_f32_16x16x32_bf16 v[152:155], a[164:167], v[56:59], v[152:155]
    ds_read_b128 a[184:187], v3 offset:61440
    v_cvt_pk_bf16_f32 v232, v156, v157
    v_mfma_f32_16x16x32_bf16 v[152:155], a[168:171], v[60:63], v[152:155]
    v_exp_f32 v159, v159
    v_mfma_f32_16x16x32_bf16 v[152:155], a[172:175], v[64:67], v[152:155]
    ds_read_b64_tr_b16 a[220:221], v12 offset:0
    v_mfma_f32_16x16x32_bf16 a[80:83], a[200:203], v[180:183], a[80:83]
    v_exp_f32 v160, v160
    v_mfma_f32_16x16x32_bf16 a[80:83], a[204:207], v[184:187], a[80:83]
    ds_read_b64_tr_b16 a[222:223], v12 offset:4096
    v_cvt_pk_bf16_f32 v233, v158, v159
    v_mfma_f32_16x16x32_bf16 a[84:87], a[200:203], v[188:191], a[84:87]
    v_exp_f32 v161, v161
    v_mfma_f32_16x16x32_bf16 a[84:87], a[204:207], v[192:195], a[84:87]
    ds_read_b128 a[188:191], v4 offset:61440
    v_mfma_f32_16x16x32_bf16 a[88:91], a[200:203], v[196:199], a[88:91]
    v_exp_f32 v162, v162
    v_mfma_f32_16x16x32_bf16 a[88:91], a[204:207], v[200:203], a[88:91]
    v_cvt_pk_bf16_f32 v240, v160, v161
    v_mfma_f32_16x16x32_bf16 a[92:95], a[200:203], v[204:207], a[92:95]
    v_exp_f32 v163, v163
    v_mfma_f32_16x16x32_bf16 a[92:95], a[204:207], v[208:211], a[92:95]
    buffer_load_dwordx4 v18, s[12:15], s29 offen offset:3072 lds
    v_smfmac_f32_16x16x64_bf16 a[232:235], v[244:247], v[196:203], v248
    s_waitcnt vmcnt(8) lgkmcnt(6)
    s_barrier
    s_add_u32 s29, s29, 16384
    v_mfma_f32_16x16x32_bf16 v[156:159], a[160:163], v[68:71], v[108:111]
    v_exp_f32 v164, v164
    v_mfma_f32_16x16x32_bf16 v[156:159], a[164:167], v[72:75], v[156:159]
    ds_read_b64_tr_b16 a[192:193], v5 offset:24576
    v_cvt_pk_bf16_f32 v241, v162, v163
    v_mfma_f32_16x16x32_bf16 v[156:159], a[168:171], v[76:79], v[156:159]
    v_exp_f32 v165, v165
    v_mfma_f32_16x16x32_bf16 v[156:159], a[172:175], v[80:83], v[156:159]
    ds_read_b64_tr_b16 a[194:195], v5 offset:28672
    v_mfma_f32_16x16x32_bf16 v[160:163], a[160:163], v[84:87], v[112:115]
    v_exp_f32 v166, v166
    v_mfma_f32_16x16x32_bf16 v[160:163], a[164:167], v[88:91], v[160:163]
    ds_read_b128 a[128:131], v1 offset:16384
    v_cvt_pk_bf16_f32 v218, v164, v165
    v_mfma_f32_16x16x32_bf16 v[160:163], a[168:171], v[92:95], v[160:163]
    v_exp_f32 v167, v167
    v_mfma_f32_16x16x32_bf16 v[160:163], a[172:175], v[96:99], v[160:163]
    ds_read_b64_tr_b16 a[196:197], v5 offset:49152
    v_mfma_f32_16x16x32_bf16 a[96:99], a[208:211], v[180:183], a[96:99]
    v_exp_f32 v168, v168
    v_mfma_f32_16x16x32_bf16 a[96:99], a[212:215], v[184:187], a[96:99]
    ds_read_b64_tr_b16 a[198:199], v5 offset:53248
    v_cvt_pk_bf16_f32 v219, v166, v167
    v_mfma_f32_16x16x32_bf16 a[100:103], a[208:211], v[188:191], a[100:103]
    v_exp_f32 v169, v169
    v_mfma_f32_16x16x32_bf16 a[100:103], a[212:215], v[192:195], a[100:103]
    ds_read_b128 a[132:135], v2 offset:16384
    v_cvt_pk_bf16_f32 v226, v168, v169
    v_mfma_f32_16x16x32_bf16 a[104:107], a[208:211], v[196:199], a[104:107]
    s_add_u32 m0, s34, 0
    v_exp_f32 v170, v170
    v_mfma_f32_16x16x32_bf16 a[104:107], a[212:215], v[200:203], a[104:107]
    buffer_load_dwordx4 v13, s[8:11], s28 offen offset:0 lds
    v_mfma_f32_16x16x32_bf16 a[108:111], a[208:211], v[204:207], a[108:111]
    v_exp_f32 v171, v171
    v_mfma_f32_16x16x32_bf16 a[108:111], a[212:215], v[208:211], a[108:111]
    s_waitcnt lgkmcnt(6)
    v_mfma_f32_16x16x32_bf16 v[164:167], a[176:179], v[36:39], v[100:103]
    v_exp_f32 v172, v172
    v_mfma_f32_16x16x32_bf16 v[164:167], a[180:183], v[40:43], v[164:167]
    ds_read_b64_tr_b16 a[200:201], v6 offset:24576
    v_cvt_pk_bf16_f32 v227, v170, v171
    v_mfma_f32_16x16x32_bf16 v[164:167], a[184:187], v[44:47], v[164:167]
    v_exp_f32 v173, v173
    v_mfma_f32_16x16x32_bf16 v[164:167], a[188:191], v[48:51], v[164:167]
    ds_read_b64_tr_b16 a[202:203], v6 offset:28672
    v_mfma_f32_16x16x32_bf16 v[168:171], a[176:179], v[52:55], v[104:107]
    v_exp_f32 v174, v174
    v_mfma_f32_16x16x32_bf16 v[168:171], a[180:183], v[56:59], v[168:171]
    ds_read_b128 a[136:139], v3 offset:16384
    v_cvt_pk_bf16_f32 v234, v172, v173
    v_mfma_f32_16x16x32_bf16 v[168:171], a[184:187], v[60:63], v[168:171]
    v_exp_f32 v175, v175
    v_mfma_f32_16x16x32_bf16 v[168:171], a[188:191], v[64:67], v[168:171]
    ds_read_b64_tr_b16 a[204:205], v6 offset:49152
    v_mfma_f32_16x16x32_bf16 a[112:115], a[216:219], v[180:183], a[112:115]
    v_exp_f32 v176, v176
    v_mfma_f32_16x16x32_bf16 a[112:115], a[220:223], v[184:187], a[112:115]
    ds_read_b64_tr_b16 a[206:207], v6 offset:53248
    v_cvt_pk_bf16_f32 v235, v174, v175
    v_mfma_f32_16x16x32_bf16 a[116:119], a[216:219], v[188:191], a[116:119]
    v_exp_f32 v177, v177
    v_mfma_f32_16x16x32_bf16 a[116:119], a[220:223], v[192:195], a[116:119]
    ds_read_b128 a[140:143], v4 offset:16384
    v_mfma_f32_16x16x32_bf16 a[120:123], a[216:219], v[196:199], a[120:123]
    v_exp_f32 v178, v178
    v_mfma_f32_16x16x32_bf16 a[120:123], a[220:223], v[200:203], a[120:123]
    v_cvt_pk_bf16_f32 v242, v176, v177
    v_mfma_f32_16x16x32_bf16 a[124:127], a[216:219], v[204:207], a[124:127]
    v_exp_f32 v179, v179
    v_mfma_f32_16x16x32_bf16 a[124:127], a[220:223], v[208:211], a[124:127]
    buffer_load_dwordx4 v14, s[8:11], s28 offen offset:1024 lds
    v_smfmac_f32_16x16x64_bf16 a[236:239], v[244:247], v[204:211], v248
    s_waitcnt lgkmcnt(6)
    v_mfma_f32_16x16x32_bf16 v[172:175], a[176:179], v[68:71], v[108:111]
    v_exp_f32 v116, v116
    v_mfma_f32_16x16x32_bf16 v[172:175], a[180:183], v[72:75], v[172:175]
    ds_read_b64_tr_b16 a[208:209], v7 offset:24576
    v_cvt_pk_bf16_f32 v243, v178, v179
    v_mfma_f32_16x16x32_bf16 v[172:175], a[184:187], v[76:79], v[172:175]
    v_exp_f32 v117, v117
    v_mfma_f32_16x16x32_bf16 v[172:175], a[188:191], v[80:83], v[172:175]
    ds_read_b64_tr_b16 a[210:211], v7 offset:28672
    v_mfma_f32_16x16x32_bf16 v[176:179], a[176:179], v[84:87], v[112:115]
    v_exp_f32 v118, v118
    v_mfma_f32_16x16x32_bf16 v[176:179], a[180:183], v[88:91], v[176:179]
    ds_read_b128 a[144:147], v1 offset:20480
    v_cvt_pk_bf16_f32 v180, v116, v117
    v_mfma_f32_16x16x32_bf16 v[176:179], a[184:187], v[92:95], v[176:179]
    v_exp_f32 v119, v119
    v_mfma_f32_16x16x32_bf16 v[176:179], a[188:191], v[96:99], v[176:179]
    ds_read_b64_tr_b16 a[212:213], v7 offset:49152
    v_mfma_f32_16x16x32_bf16 a[0:3], a[192:195], v[212:215], a[0:3]
    v_exp_f32 v120, v120
    v_mfma_f32_16x16x32_bf16 a[0:3], a[196:199], v[216:219], a[0:3]
    ds_read_b64_tr_b16 a[214:215], v7 offset:53248
    v_cvt_pk_bf16_f32 v181, v118, v119
    v_mfma_f32_16x16x32_bf16 a[4:7], a[192:195], v[220:223], a[4:7]
    v_exp_f32 v121, v121
    v_mfma_f32_16x16x32_bf16 a[4:7], a[196:199], v[224:227], a[4:7]
    ds_read_b128 a[148:151], v2 offset:20480
    v_cvt_pk_bf16_f32 v188, v120, v121
    v_mfma_f32_16x16x32_bf16 a[8:11], a[192:195], v[228:231], a[8:11]
    v_exp_f32 v122, v122
    v_mfma_f32_16x16x32_bf16 a[8:11], a[196:199], v[232:235], a[8:11]
    buffer_load_dwordx4 v15, s[8:11], s28 offen offset:2048 lds
    v_mfma_f32_16x16x32_bf16 a[12:15], a[192:195], v[236:239], a[12:15]
    v_exp_f32 v123, v123
    v_mfma_f32_16x16x32_bf16 a[12:15], a[196:199], v[240:243], a[12:15]
    s_waitcnt lgkmcnt(6)
    v_mfma_f32_16x16x32_bf16 v[116:119], a[128:131], v[36:39], v[100:103]
    v_exp_f32 v124, v124
    v_mfma_f32_16x16x32_bf16 v[116:119], a[132:135], v[40:43], v[116:119]
    ds_read_b64_tr_b16 a[216:217], v8 offset:24576
    v_cvt_pk_bf16_f32 v189, v122, v123
    v_mfma_f32_16x16x32_bf16 v[116:119], a[136:139], v[44:47], v[116:119]
    v_exp_f32 v125, v125
    v_mfma_f32_16x16x32_bf16 v[116:119], a[140:143], v[48:51], v[116:119]
    ds_read_b64_tr_b16 a[218:219], v8 offset:28672
    v_mfma_f32_16x16x32_bf16 v[120:123], a[128:131], v[52:55], v[104:107]
    v_exp_f32 v126, v126
    v_mfma_f32_16x16x32_bf16 v[120:123], a[132:135], v[56:59], v[120:123]
    ds_read_b128 a[152:155], v3 offset:20480
    v_cvt_pk_bf16_f32 v196, v124, v125
    v_mfma_f32_16x16x32_bf16 v[120:123], a[136:139], v[60:63], v[120:123]
    v_exp_f32 v127, v127
    v_mfma_f32_16x16x32_bf16 v[120:123], a[140:143], v[64:67], v[120:123]
    ds_read_b64_tr_b16 a[220:221], v8 offset:49152
    v_mfma_f32_16x16x32_bf16 a[16:19], a[200:203], v[212:215], a[16:19]
    v_exp_f32 v128, v128
    v_mfma_f32_16x16x32_bf16 a[16:19], a[204:207], v[216:219], a[16:19]
    ds_read_b64_tr_b16 a[222:223], v8 offset:53248
    v_cvt_pk_bf16_f32 v197, v126, v127
    v_mfma_f32_16x16x32_bf16 a[20:23], a[200:203], v[220:223], a[20:23]
    v_exp_f32 v129, v129
    v_mfma_f32_16x16x32_bf16 a[20:23], a[204:207], v[224:227], a[20:23]
    ds_read_b128 a[156:159], v4 offset:20480
    v_mfma_f32_16x16x32_bf16 a[24:27], a[200:203], v[228:231], a[24:27]
    v_exp_f32 v130, v130
    v_mfma_f32_16x16x32_bf16 a[24:27], a[204:207], v[232:235], a[24:27]
    v_cvt_pk_bf16_f32 v204, v128, v129
    v_mfma_f32_16x16x32_bf16 a[28:31], a[200:203], v[236:239], a[28:31]
    v_exp_f32 v131, v131
    v_mfma_f32_16x16x32_bf16 a[28:31], a[204:207], v[240:243], a[28:31]
    buffer_load_dwordx4 v16, s[8:11], s28 offen offset:3072 lds
    v_smfmac_f32_16x16x64_bf16 a[224:227], v[244:247], v[212:219], v248
    s_waitcnt lgkmcnt(6)
    v_mfma_f32_16x16x32_bf16 v[124:127], a[128:131], v[68:71], v[108:111]
    v_exp_f32 v132, v132
    v_mfma_f32_16x16x32_bf16 v[124:127], a[132:135], v[72:75], v[124:127]
    ds_read_b64_tr_b16 a[192:193], v9 offset:24576
    v_cvt_pk_bf16_f32 v205, v130, v131
    v_mfma_f32_16x16x32_bf16 v[124:127], a[136:139], v[76:79], v[124:127]
    v_exp_f32 v133, v133
    v_mfma_f32_16x16x32_bf16 v[124:127], a[140:143], v[80:83], v[124:127]
    ds_read_b64_tr_b16 a[194:195], v9 offset:28672
    v_mfma_f32_16x16x32_bf16 v[128:131], a[128:131], v[84:87], v[112:115]
    v_exp_f32 v134, v134
    v_mfma_f32_16x16x32_bf16 v[128:131], a[132:135], v[88:91], v[128:131]
    ds_read_b128 a[160:163], v1 offset:24576
    v_cvt_pk_bf16_f32 v182, v132, v133
    v_mfma_f32_16x16x32_bf16 v[128:131], a[136:139], v[92:95], v[128:131]
    v_exp_f32 v135, v135
    v_mfma_f32_16x16x32_bf16 v[128:131], a[140:143], v[96:99], v[128:131]
    ds_read_b64_tr_b16 a[196:197], v9 offset:49152
    v_mfma_f32_16x16x32_bf16 a[32:35], a[208:211], v[212:215], a[32:35]
    v_exp_f32 v136, v136
    v_mfma_f32_16x16x32_bf16 a[32:35], a[212:215], v[216:219], a[32:35]
    ds_read_b64_tr_b16 a[198:199], v9 offset:53248
    v_cvt_pk_bf16_f32 v183, v134, v135
    v_mfma_f32_16x16x32_bf16 a[36:39], a[208:211], v[220:223], a[36:39]
    v_exp_f32 v137, v137
    v_mfma_f32_16x16x32_bf16 a[36:39], a[212:215], v[224:227], a[36:39]
    ds_read_b128 a[164:167], v2 offset:24576
    v_cvt_pk_bf16_f32 v190, v136, v137
    v_mfma_f32_16x16x32_bf16 a[40:43], a[208:211], v[228:231], a[40:43]
    s_add_u32 s28, s28, 16384
    s_mov_b32 m0, s31
    v_exp_f32 v138, v138
    v_mfma_f32_16x16x32_bf16 a[40:43], a[212:215], v[232:235], a[40:43]
    buffer_load_dwordx4 v17, s[12:15], s29 offen offset:0 lds
    v_mfma_f32_16x16x32_bf16 a[44:47], a[208:211], v[236:239], a[44:47]
    v_exp_f32 v139, v139
    v_mfma_f32_16x16x32_bf16 a[44:47], a[212:215], v[240:243], a[44:47]
    s_waitcnt lgkmcnt(6)
    v_mfma_f32_16x16x32_bf16 v[132:135], a[144:147], v[36:39], v[100:103]
    v_exp_f32 v140, v140
    v_mfma_f32_16x16x32_bf16 v[132:135], a[148:151], v[40:43], v[132:135]
    ds_read_b64_tr_b16 a[200:201], v10 offset:24576
    v_cvt_pk_bf16_f32 v191, v138, v139
    v_mfma_f32_16x16x32_bf16 v[132:135], a[152:155], v[44:47], v[132:135]
    v_exp_f32 v141, v141
    v_mfma_f32_16x16x32_bf16 v[132:135], a[156:159], v[48:51], v[132:135]
    ds_read_b64_tr_b16 a[202:203], v10 offset:28672
    v_mfma_f32_16x16x32_bf16 v[136:139], a[144:147], v[52:55], v[104:107]
    v_exp_f32 v142, v142
    v_mfma_f32_16x16x32_bf16 v[136:139], a[148:151], v[56:59], v[136:139]
    ds_read_b128 a[168:171], v3 offset:24576
    v_cvt_pk_bf16_f32 v198, v140, v141
    v_mfma_f32_16x16x32_bf16 v[136:139], a[152:155], v[60:63], v[136:139]
    v_exp_f32 v143, v143
    v_mfma_f32_16x16x32_bf16 v[136:139], a[156:159], v[64:67], v[136:139]
    ds_read_b64_tr_b16 a[204:205], v10 offset:49152
    v_mfma_f32_16x16x32_bf16 a[48:51], a[216:219], v[212:215], a[48:51]
    v_exp_f32 v144, v144
    v_mfma_f32_16x16x32_bf16 a[48:51], a[220:223], v[216:219], a[48:51]
    ds_read_b64_tr_b16 a[206:207], v10 offset:53248
    v_cvt_pk_bf16_f32 v199, v142, v143
    v_mfma_f32_16x16x32_bf16 a[52:55], a[216:219], v[220:223], a[52:55]
    v_exp_f32 v145, v145
    v_mfma_f32_16x16x32_bf16 a[52:55], a[220:223], v[224:227], a[52:55]
    ds_read_b128 a[172:175], v4 offset:24576
    v_mfma_f32_16x16x32_bf16 a[56:59], a[216:219], v[228:231], a[56:59]
    v_exp_f32 v146, v146
    v_mfma_f32_16x16x32_bf16 a[56:59], a[220:223], v[232:235], a[56:59]
    v_cvt_pk_bf16_f32 v206, v144, v145
    v_mfma_f32_16x16x32_bf16 a[60:63], a[216:219], v[236:239], a[60:63]
    v_exp_f32 v147, v147
    v_mfma_f32_16x16x32_bf16 a[60:63], a[220:223], v[240:243], a[60:63]
    buffer_load_dwordx4 v18, s[12:15], s29 offen offset:1024 lds
    v_smfmac_f32_16x16x64_bf16 a[228:231], v[244:247], v[220:227], v248
    s_waitcnt lgkmcnt(6)
    v_mfma_f32_16x16x32_bf16 v[140:143], a[144:147], v[68:71], v[108:111]
    v_exp_f32 v148, v148
    v_mfma_f32_16x16x32_bf16 v[140:143], a[148:151], v[72:75], v[140:143]
    ds_read_b64_tr_b16 a[208:209], v11 offset:24576
    v_cvt_pk_bf16_f32 v207, v146, v147
    v_mfma_f32_16x16x32_bf16 v[140:143], a[152:155], v[76:79], v[140:143]
    v_exp_f32 v149, v149
    v_mfma_f32_16x16x32_bf16 v[140:143], a[156:159], v[80:83], v[140:143]
    ds_read_b64_tr_b16 a[210:211], v11 offset:28672
    v_mfma_f32_16x16x32_bf16 v[144:147], a[144:147], v[84:87], v[112:115]
    v_exp_f32 v150, v150
    v_mfma_f32_16x16x32_bf16 v[144:147], a[148:151], v[88:91], v[144:147]
    ds_read_b128 a[176:179], v1 offset:28672
    v_cvt_pk_bf16_f32 v184, v148, v149
    v_mfma_f32_16x16x32_bf16 v[144:147], a[152:155], v[92:95], v[144:147]
    v_exp_f32 v151, v151
    v_mfma_f32_16x16x32_bf16 v[144:147], a[156:159], v[96:99], v[144:147]
    ds_read_b64_tr_b16 a[212:213], v11 offset:49152
    v_mfma_f32_16x16x32_bf16 a[64:67], a[192:195], v[212:215], a[64:67]
    v_exp_f32 v152, v152
    v_mfma_f32_16x16x32_bf16 a[64:67], a[196:199], v[216:219], a[64:67]
    ds_read_b64_tr_b16 a[214:215], v11 offset:53248
    v_cvt_pk_bf16_f32 v185, v150, v151
    v_mfma_f32_16x16x32_bf16 a[68:71], a[192:195], v[220:223], a[68:71]
    v_exp_f32 v153, v153
    v_mfma_f32_16x16x32_bf16 a[68:71], a[196:199], v[224:227], a[68:71]
    ds_read_b128 a[180:183], v2 offset:28672
    v_cvt_pk_bf16_f32 v192, v152, v153
    v_mfma_f32_16x16x32_bf16 a[72:75], a[192:195], v[228:231], a[72:75]
    v_exp_f32 v154, v154
    v_mfma_f32_16x16x32_bf16 a[72:75], a[196:199], v[232:235], a[72:75]
    buffer_load_dwordx4 v17, s[12:15], s29 offen offset:2048 lds
    v_mfma_f32_16x16x32_bf16 a[76:79], a[192:195], v[236:239], a[76:79]
    v_exp_f32 v155, v155
    v_mfma_f32_16x16x32_bf16 a[76:79], a[196:199], v[240:243], a[76:79]
    s_waitcnt lgkmcnt(6)
    v_mfma_f32_16x16x32_bf16 v[148:151], a[160:163], v[36:39], v[100:103]
    v_exp_f32 v156, v156
    v_mfma_f32_16x16x32_bf16 v[148:151], a[164:167], v[40:43], v[148:151]
    ds_read_b64_tr_b16 a[216:217], v12 offset:24576
    v_cvt_pk_bf16_f32 v193, v154, v155
    v_mfma_f32_16x16x32_bf16 v[148:151], a[168:171], v[44:47], v[148:151]
    v_exp_f32 v157, v157
    v_mfma_f32_16x16x32_bf16 v[148:151], a[172:175], v[48:51], v[148:151]
    ds_read_b64_tr_b16 a[218:219], v12 offset:28672
    v_mfma_f32_16x16x32_bf16 v[152:155], a[160:163], v[52:55], v[104:107]
    v_exp_f32 v158, v158
    v_mfma_f32_16x16x32_bf16 v[152:155], a[164:167], v[56:59], v[152:155]
    ds_read_b128 a[184:187], v3 offset:28672
    v_cvt_pk_bf16_f32 v200, v156, v157
    v_mfma_f32_16x16x32_bf16 v[152:155], a[168:171], v[60:63], v[152:155]
    v_exp_f32 v159, v159
    v_mfma_f32_16x16x32_bf16 v[152:155], a[172:175], v[64:67], v[152:155]
    ds_read_b64_tr_b16 a[220:221], v12 offset:49152
    v_mfma_f32_16x16x32_bf16 a[80:83], a[200:203], v[212:215], a[80:83]
    v_exp_f32 v160, v160
    v_mfma_f32_16x16x32_bf16 a[80:83], a[204:207], v[216:219], a[80:83]
    ds_read_b64_tr_b16 a[222:223], v12 offset:53248
    v_cvt_pk_bf16_f32 v201, v158, v159
    v_mfma_f32_16x16x32_bf16 a[84:87], a[200:203], v[220:223], a[84:87]
    v_exp_f32 v161, v161
    v_mfma_f32_16x16x32_bf16 a[84:87], a[204:207], v[224:227], a[84:87]
    ds_read_b128 a[188:191], v4 offset:28672
    v_mfma_f32_16x16x32_bf16 a[88:91], a[200:203], v[228:231], a[88:91]
    v_exp_f32 v162, v162
    v_mfma_f32_16x16x32_bf16 a[88:91], a[204:207], v[232:235], a[88:91]
    v_cvt_pk_bf16_f32 v208, v160, v161
    v_mfma_f32_16x16x32_bf16 a[92:95], a[200:203], v[236:239], a[92:95]
    v_exp_f32 v163, v163
    v_mfma_f32_16x16x32_bf16 a[92:95], a[204:207], v[240:243], a[92:95]
    buffer_load_dwordx4 v18, s[12:15], s29 offen offset:3072 lds
    v_smfmac_f32_16x16x64_bf16 a[232:235], v[244:247], v[228:235], v248
    s_waitcnt vmcnt(8) lgkmcnt(6)
    s_barrier
    s_add_u32 s29, s29, 16384
    v_mfma_f32_16x16x32_bf16 v[156:159], a[160:163], v[68:71], v[108:111]
    v_exp_f32 v164, v164
    v_mfma_f32_16x16x32_bf16 v[156:159], a[164:167], v[72:75], v[156:159]
    ds_read_b64_tr_b16 a[192:193], v5 offset:8192
    v_cvt_pk_bf16_f32 v209, v162, v163
    v_mfma_f32_16x16x32_bf16 v[156:159], a[168:171], v[76:79], v[156:159]
    v_exp_f32 v165, v165
    v_mfma_f32_16x16x32_bf16 v[156:159], a[172:175], v[80:83], v[156:159]
    ds_read_b64_tr_b16 a[194:195], v5 offset:12288
    v_mfma_f32_16x16x32_bf16 v[160:163], a[160:163], v[84:87], v[112:115]
    v_exp_f32 v166, v166
    v_mfma_f32_16x16x32_bf16 v[160:163], a[164:167], v[88:91], v[160:163]
    ds_read_b128 a[128:131], v1 offset:32768
    v_cvt_pk_bf16_f32 v186, v164, v165
    v_mfma_f32_16x16x32_bf16 v[160:163], a[168:171], v[92:95], v[160:163]
    v_exp_f32 v167, v167
    v_mfma_f32_16x16x32_bf16 v[160:163], a[172:175], v[96:99], v[160:163]
    ds_read_b64_tr_b16 a[196:197], v5 offset:32768
    v_mfma_f32_16x16x32_bf16 a[96:99], a[208:211], v[212:215], a[96:99]
    v_exp_f32 v168, v168
    v_mfma_f32_16x16x32_bf16 a[96:99], a[212:215], v[216:219], a[96:99]
    ds_read_b64_tr_b16 a[198:199], v5 offset:36864
    v_cvt_pk_bf16_f32 v187, v166, v167
    v_mfma_f32_16x16x32_bf16 a[100:103], a[208:211], v[220:223], a[100:103]
    v_exp_f32 v169, v169
    v_mfma_f32_16x16x32_bf16 a[100:103], a[212:215], v[224:227], a[100:103]
    ds_read_b128 a[132:135], v2 offset:32768
    v_cvt_pk_bf16_f32 v194, v168, v169
    v_mfma_f32_16x16x32_bf16 a[104:107], a[208:211], v[228:231], a[104:107]
    s_add_u32 m0, s34, 49152
    v_exp_f32 v170, v170
    v_mfma_f32_16x16x32_bf16 a[104:107], a[212:215], v[232:235], a[104:107]
    buffer_load_dwordx4 v13, s[8:11], s28 offen offset:0 lds
    v_mfma_f32_16x16x32_bf16 a[108:111], a[208:211], v[236:239], a[108:111]
    v_exp_f32 v171, v171
    v_mfma_f32_16x16x32_bf16 a[108:111], a[212:215], v[240:243], a[108:111]
    s_waitcnt lgkmcnt(6)
    v_mfma_f32_16x16x32_bf16 v[164:167], a[176:179], v[36:39], v[100:103]
    v_exp_f32 v172, v172
    v_mfma_f32_16x16x32_bf16 v[164:167], a[180:183], v[40:43], v[164:167]
    ds_read_b64_tr_b16 a[200:201], v6 offset:8192
    v_cvt_pk_bf16_f32 v195, v170, v171
    v_mfma_f32_16x16x32_bf16 v[164:167], a[184:187], v[44:47], v[164:167]
    v_exp_f32 v173, v173
    v_mfma_f32_16x16x32_bf16 v[164:167], a[188:191], v[48:51], v[164:167]
    ds_read_b64_tr_b16 a[202:203], v6 offset:12288
    v_mfma_f32_16x16x32_bf16 v[168:171], a[176:179], v[52:55], v[104:107]
    v_exp_f32 v174, v174
    v_mfma_f32_16x16x32_bf16 v[168:171], a[180:183], v[56:59], v[168:171]
    ds_read_b128 a[136:139], v3 offset:32768
    v_cvt_pk_bf16_f32 v202, v172, v173
    v_mfma_f32_16x16x32_bf16 v[168:171], a[184:187], v[60:63], v[168:171]
    v_exp_f32 v175, v175
    v_mfma_f32_16x16x32_bf16 v[168:171], a[188:191], v[64:67], v[168:171]
    ds_read_b64_tr_b16 a[204:205], v6 offset:32768
    v_mfma_f32_16x16x32_bf16 a[112:115], a[216:219], v[212:215], a[112:115]
    v_exp_f32 v176, v176
    v_mfma_f32_16x16x32_bf16 a[112:115], a[220:223], v[216:219], a[112:115]
    ds_read_b64_tr_b16 a[206:207], v6 offset:36864
    v_cvt_pk_bf16_f32 v203, v174, v175
    v_mfma_f32_16x16x32_bf16 a[116:119], a[216:219], v[220:223], a[116:119]
    v_exp_f32 v177, v177
    v_mfma_f32_16x16x32_bf16 a[116:119], a[220:223], v[224:227], a[116:119]
    ds_read_b128 a[140:143], v4 offset:32768
    v_mfma_f32_16x16x32_bf16 a[120:123], a[216:219], v[228:231], a[120:123]
    v_exp_f32 v178, v178
    v_mfma_f32_16x16x32_bf16 a[120:123], a[220:223], v[232:235], a[120:123]
    v_cvt_pk_bf16_f32 v210, v176, v177
    v_mfma_f32_16x16x32_bf16 a[124:127], a[216:219], v[236:239], a[124:127]
    v_exp_f32 v179, v179
    v_mfma_f32_16x16x32_bf16 a[124:127], a[220:223], v[240:243], a[124:127]
    buffer_load_dwordx4 v14, s[8:11], s28 offen offset:1024 lds
    v_smfmac_f32_16x16x64_bf16 a[236:239], v[244:247], v[236:243], v248
    s_waitcnt lgkmcnt(6)
    v_mfma_f32_16x16x32_bf16 v[172:175], a[176:179], v[68:71], v[108:111]
    v_exp_f32 v116, v116
    v_mfma_f32_16x16x32_bf16 v[172:175], a[180:183], v[72:75], v[172:175]
    ds_read_b64_tr_b16 a[208:209], v7 offset:8192
    v_cvt_pk_bf16_f32 v211, v178, v179
    v_mfma_f32_16x16x32_bf16 v[172:175], a[184:187], v[76:79], v[172:175]
    v_exp_f32 v117, v117
    v_mfma_f32_16x16x32_bf16 v[172:175], a[188:191], v[80:83], v[172:175]
    ds_read_b64_tr_b16 a[210:211], v7 offset:12288
    v_mfma_f32_16x16x32_bf16 v[176:179], a[176:179], v[84:87], v[112:115]
    v_exp_f32 v118, v118
    v_mfma_f32_16x16x32_bf16 v[176:179], a[180:183], v[88:91], v[176:179]
    ds_read_b128 a[144:147], v1 offset:36864
    v_cvt_pk_bf16_f32 v212, v116, v117
    v_mfma_f32_16x16x32_bf16 v[176:179], a[184:187], v[92:95], v[176:179]
    v_exp_f32 v119, v119
    v_mfma_f32_16x16x32_bf16 v[176:179], a[188:191], v[96:99], v[176:179]
    ds_read_b64_tr_b16 a[212:213], v7 offset:32768
    v_mfma_f32_16x16x32_bf16 a[0:3], a[192:195], v[180:183], a[0:3]
    v_exp_f32 v120, v120
    v_mfma_f32_16x16x32_bf16 a[0:3], a[196:199], v[184:187], a[0:3]
    ds_read_b64_tr_b16 a[214:215], v7 offset:36864
    v_cvt_pk_bf16_f32 v213, v118, v119
    v_mfma_f32_16x16x32_bf16 a[4:7], a[192:195], v[188:191], a[4:7]
    v_exp_f32 v121, v121
    v_mfma_f32_16x16x32_bf16 a[4:7], a[196:199], v[192:195], a[4:7]
    ds_read_b128 a[148:151], v2 offset:36864
    v_cvt_pk_bf16_f32 v220, v120, v121
    v_mfma_f32_16x16x32_bf16 a[8:11], a[192:195], v[196:199], a[8:11]
    v_exp_f32 v122, v122
    v_mfma_f32_16x16x32_bf16 a[8:11], a[196:199], v[200:203], a[8:11]
    buffer_load_dwordx4 v15, s[8:11], s28 offen offset:2048 lds
    v_mfma_f32_16x16x32_bf16 a[12:15], a[192:195], v[204:207], a[12:15]
    v_exp_f32 v123, v123
    v_mfma_f32_16x16x32_bf16 a[12:15], a[196:199], v[208:211], a[12:15]
    s_waitcnt lgkmcnt(6)
    v_mfma_f32_16x16x32_bf16 v[116:119], a[128:131], v[36:39], v[100:103]
    v_exp_f32 v124, v124
    v_mfma_f32_16x16x32_bf16 v[116:119], a[132:135], v[40:43], v[116:119]
    ds_read_b64_tr_b16 a[216:217], v8 offset:8192
    v_cvt_pk_bf16_f32 v221, v122, v123
    v_mfma_f32_16x16x32_bf16 v[116:119], a[136:139], v[44:47], v[116:119]
    v_exp_f32 v125, v125
    v_mfma_f32_16x16x32_bf16 v[116:119], a[140:143], v[48:51], v[116:119]
    ds_read_b64_tr_b16 a[218:219], v8 offset:12288
    v_mfma_f32_16x16x32_bf16 v[120:123], a[128:131], v[52:55], v[104:107]
    v_exp_f32 v126, v126
    v_mfma_f32_16x16x32_bf16 v[120:123], a[132:135], v[56:59], v[120:123]
    ds_read_b128 a[152:155], v3 offset:36864
    v_cvt_pk_bf16_f32 v228, v124, v125
    v_mfma_f32_16x16x32_bf16 v[120:123], a[136:139], v[60:63], v[120:123]
    v_exp_f32 v127, v127
    v_mfma_f32_16x16x32_bf16 v[120:123], a[140:143], v[64:67], v[120:123]
    ds_read_b64_tr_b16 a[220:221], v8 offset:32768
    v_mfma_f32_16x16x32_bf16 a[16:19], a[200:203], v[180:183], a[16:19]
    v_exp_f32 v128, v128
    v_mfma_f32_16x16x32_bf16 a[16:19], a[204:207], v[184:187], a[16:19]
    ds_read_b64_tr_b16 a[222:223], v8 offset:36864
    v_cvt_pk_bf16_f32 v229, v126, v127
    v_mfma_f32_16x16x32_bf16 a[20:23], a[200:203], v[188:191], a[20:23]
    v_exp_f32 v129, v129
    v_mfma_f32_16x16x32_bf16 a[20:23], a[204:207], v[192:195], a[20:23]
    ds_read_b128 a[156:159], v4 offset:36864
    v_mfma_f32_16x16x32_bf16 a[24:27], a[200:203], v[196:199], a[24:27]
    v_exp_f32 v130, v130
    v_mfma_f32_16x16x32_bf16 a[24:27], a[204:207], v[200:203], a[24:27]
    v_cvt_pk_bf16_f32 v236, v128, v129
    v_mfma_f32_16x16x32_bf16 a[28:31], a[200:203], v[204:207], a[28:31]
    v_exp_f32 v131, v131
    v_mfma_f32_16x16x32_bf16 a[28:31], a[204:207], v[208:211], a[28:31]
    buffer_load_dwordx4 v16, s[8:11], s28 offen offset:3072 lds
    v_smfmac_f32_16x16x64_bf16 a[224:227], v[244:247], v[180:187], v248
    s_waitcnt lgkmcnt(6)
    v_mfma_f32_16x16x32_bf16 v[124:127], a[128:131], v[68:71], v[108:111]
    v_exp_f32 v132, v132
    v_mfma_f32_16x16x32_bf16 v[124:127], a[132:135], v[72:75], v[124:127]
    ds_read_b64_tr_b16 a[192:193], v9 offset:8192
    v_cvt_pk_bf16_f32 v237, v130, v131
    v_mfma_f32_16x16x32_bf16 v[124:127], a[136:139], v[76:79], v[124:127]
    v_exp_f32 v133, v133
    v_mfma_f32_16x16x32_bf16 v[124:127], a[140:143], v[80:83], v[124:127]
    ds_read_b64_tr_b16 a[194:195], v9 offset:12288
    v_mfma_f32_16x16x32_bf16 v[128:131], a[128:131], v[84:87], v[112:115]
    v_exp_f32 v134, v134
    v_mfma_f32_16x16x32_bf16 v[128:131], a[132:135], v[88:91], v[128:131]
    ds_read_b128 a[160:163], v1 offset:40960
    v_cvt_pk_bf16_f32 v214, v132, v133
    v_mfma_f32_16x16x32_bf16 v[128:131], a[136:139], v[92:95], v[128:131]
    v_exp_f32 v135, v135
    v_mfma_f32_16x16x32_bf16 v[128:131], a[140:143], v[96:99], v[128:131]
    ds_read_b64_tr_b16 a[196:197], v9 offset:32768
    v_mfma_f32_16x16x32_bf16 a[32:35], a[208:211], v[180:183], a[32:35]
    v_exp_f32 v136, v136
    v_mfma_f32_16x16x32_bf16 a[32:35], a[212:215], v[184:187], a[32:35]
    ds_read_b64_tr_b16 a[198:199], v9 offset:36864
    v_cvt_pk_bf16_f32 v215, v134, v135
    v_mfma_f32_16x16x32_bf16 a[36:39], a[208:211], v[188:191], a[36:39]
    v_exp_f32 v137, v137
    v_mfma_f32_16x16x32_bf16 a[36:39], a[212:215], v[192:195], a[36:39]
    ds_read_b128 a[164:167], v2 offset:40960
    v_cvt_pk_bf16_f32 v222, v136, v137
    v_mfma_f32_16x16x32_bf16 a[40:43], a[208:211], v[196:199], a[40:43]
    s_add_u32 s28, s28, 16384
    s_mov_b32 m0, s32
    v_exp_f32 v138, v138
    v_mfma_f32_16x16x32_bf16 a[40:43], a[212:215], v[200:203], a[40:43]
    buffer_load_dwordx4 v17, s[12:15], s29 offen offset:0 lds
    v_mfma_f32_16x16x32_bf16 a[44:47], a[208:211], v[204:207], a[44:47]
    v_exp_f32 v139, v139
    v_mfma_f32_16x16x32_bf16 a[44:47], a[212:215], v[208:211], a[44:47]
    s_waitcnt lgkmcnt(6)
    v_mfma_f32_16x16x32_bf16 v[132:135], a[144:147], v[36:39], v[100:103]
    v_exp_f32 v140, v140
    v_mfma_f32_16x16x32_bf16 v[132:135], a[148:151], v[40:43], v[132:135]
    ds_read_b64_tr_b16 a[200:201], v10 offset:8192
    v_cvt_pk_bf16_f32 v223, v138, v139
    v_mfma_f32_16x16x32_bf16 v[132:135], a[152:155], v[44:47], v[132:135]
    v_exp_f32 v141, v141
    v_mfma_f32_16x16x32_bf16 v[132:135], a[156:159], v[48:51], v[132:135]
    ds_read_b64_tr_b16 a[202:203], v10 offset:12288
    v_mfma_f32_16x16x32_bf16 v[136:139], a[144:147], v[52:55], v[104:107]
    v_exp_f32 v142, v142
    v_mfma_f32_16x16x32_bf16 v[136:139], a[148:151], v[56:59], v[136:139]
    ds_read_b128 a[168:171], v3 offset:40960
    v_cvt_pk_bf16_f32 v230, v140, v141
    v_mfma_f32_16x16x32_bf16 v[136:139], a[152:155], v[60:63], v[136:139]
    v_exp_f32 v143, v143
    v_mfma_f32_16x16x32_bf16 v[136:139], a[156:159], v[64:67], v[136:139]
    ds_read_b64_tr_b16 a[204:205], v10 offset:32768
    v_mfma_f32_16x16x32_bf16 a[48:51], a[216:219], v[180:183], a[48:51]
    v_exp_f32 v144, v144
    v_mfma_f32_16x16x32_bf16 a[48:51], a[220:223], v[184:187], a[48:51]
    ds_read_b64_tr_b16 a[206:207], v10 offset:36864
    v_cvt_pk_bf16_f32 v231, v142, v143
    v_mfma_f32_16x16x32_bf16 a[52:55], a[216:219], v[188:191], a[52:55]
    v_exp_f32 v145, v145
    v_mfma_f32_16x16x32_bf16 a[52:55], a[220:223], v[192:195], a[52:55]
    ds_read_b128 a[172:175], v4 offset:40960
    v_mfma_f32_16x16x32_bf16 a[56:59], a[216:219], v[196:199], a[56:59]
    v_exp_f32 v146, v146
    v_mfma_f32_16x16x32_bf16 a[56:59], a[220:223], v[200:203], a[56:59]
    v_cvt_pk_bf16_f32 v238, v144, v145
    v_mfma_f32_16x16x32_bf16 a[60:63], a[216:219], v[204:207], a[60:63]
    v_exp_f32 v147, v147
    v_mfma_f32_16x16x32_bf16 a[60:63], a[220:223], v[208:211], a[60:63]
    buffer_load_dwordx4 v18, s[12:15], s29 offen offset:1024 lds
    v_smfmac_f32_16x16x64_bf16 a[228:231], v[244:247], v[188:195], v248
    s_waitcnt lgkmcnt(6)
    v_mfma_f32_16x16x32_bf16 v[140:143], a[144:147], v[68:71], v[108:111]
    v_exp_f32 v148, v148
    v_mfma_f32_16x16x32_bf16 v[140:143], a[148:151], v[72:75], v[140:143]
    ds_read_b64_tr_b16 a[208:209], v11 offset:8192
    v_cvt_pk_bf16_f32 v239, v146, v147
    v_mfma_f32_16x16x32_bf16 v[140:143], a[152:155], v[76:79], v[140:143]
    v_exp_f32 v149, v149
    v_mfma_f32_16x16x32_bf16 v[140:143], a[156:159], v[80:83], v[140:143]
    ds_read_b64_tr_b16 a[210:211], v11 offset:12288
    v_mfma_f32_16x16x32_bf16 v[144:147], a[144:147], v[84:87], v[112:115]
    v_exp_f32 v150, v150
    v_mfma_f32_16x16x32_bf16 v[144:147], a[148:151], v[88:91], v[144:147]
    ds_read_b128 a[176:179], v1 offset:45056
    v_cvt_pk_bf16_f32 v216, v148, v149
    v_mfma_f32_16x16x32_bf16 v[144:147], a[152:155], v[92:95], v[144:147]
    v_exp_f32 v151, v151
    v_mfma_f32_16x16x32_bf16 v[144:147], a[156:159], v[96:99], v[144:147]
    ds_read_b64_tr_b16 a[212:213], v11 offset:32768
    v_mfma_f32_16x16x32_bf16 a[64:67], a[192:195], v[180:183], a[64:67]
    v_exp_f32 v152, v152
    v_mfma_f32_16x16x32_bf16 a[64:67], a[196:199], v[184:187], a[64:67]
    ds_read_b64_tr_b16 a[214:215], v11 offset:36864
    v_cvt_pk_bf16_f32 v217, v150, v151
    v_mfma_f32_16x16x32_bf16 a[68:71], a[192:195], v[188:191], a[68:71]
    v_exp_f32 v153, v153
    v_mfma_f32_16x16x32_bf16 a[68:71], a[196:199], v[192:195], a[68:71]
    ds_read_b128 a[180:183], v2 offset:45056
    v_cvt_pk_bf16_f32 v224, v152, v153
    v_mfma_f32_16x16x32_bf16 a[72:75], a[192:195], v[196:199], a[72:75]
    v_exp_f32 v154, v154
    v_mfma_f32_16x16x32_bf16 a[72:75], a[196:199], v[200:203], a[72:75]
    buffer_load_dwordx4 v17, s[12:15], s29 offen offset:2048 lds
    v_mfma_f32_16x16x32_bf16 a[76:79], a[192:195], v[204:207], a[76:79]
    v_exp_f32 v155, v155
    v_mfma_f32_16x16x32_bf16 a[76:79], a[196:199], v[208:211], a[76:79]
    s_waitcnt lgkmcnt(6)
    v_mfma_f32_16x16x32_bf16 v[148:151], a[160:163], v[36:39], v[100:103]
    v_exp_f32 v156, v156
    v_mfma_f32_16x16x32_bf16 v[148:151], a[164:167], v[40:43], v[148:151]
    ds_read_b64_tr_b16 a[216:217], v12 offset:8192
    v_cvt_pk_bf16_f32 v225, v154, v155
    v_mfma_f32_16x16x32_bf16 v[148:151], a[168:171], v[44:47], v[148:151]
    v_exp_f32 v157, v157
    v_mfma_f32_16x16x32_bf16 v[148:151], a[172:175], v[48:51], v[148:151]
    ds_read_b64_tr_b16 a[218:219], v12 offset:12288
    v_mfma_f32_16x16x32_bf16 v[152:155], a[160:163], v[52:55], v[104:107]
    v_exp_f32 v158, v158
    v_mfma_f32_16x16x32_bf16 v[152:155], a[164:167], v[56:59], v[152:155]
    ds_read_b128 a[184:187], v3 offset:45056
    v_cvt_pk_bf16_f32 v232, v156, v157
    v_mfma_f32_16x16x32_bf16 v[152:155], a[168:171], v[60:63], v[152:155]
    v_exp_f32 v159, v159
    v_mfma_f32_16x16x32_bf16 v[152:155], a[172:175], v[64:67], v[152:155]
    ds_read_b64_tr_b16 a[220:221], v12 offset:32768
    v_mfma_f32_16x16x32_bf16 a[80:83], a[200:203], v[180:183], a[80:83]
    v_exp_f32 v160, v160
    v_mfma_f32_16x16x32_bf16 a[80:83], a[204:207], v[184:187], a[80:83]
    ds_read_b64_tr_b16 a[222:223], v12 offset:36864
    v_cvt_pk_bf16_f32 v233, v158, v159
    v_mfma_f32_16x16x32_bf16 a[84:87], a[200:203], v[188:191], a[84:87]
    v_exp_f32 v161, v161
    v_mfma_f32_16x16x32_bf16 a[84:87], a[204:207], v[192:195], a[84:87]
    ds_read_b128 a[188:191], v4 offset:45056
    v_mfma_f32_16x16x32_bf16 a[88:91], a[200:203], v[196:199], a[88:91]
    v_exp_f32 v162, v162
    v_mfma_f32_16x16x32_bf16 a[88:91], a[204:207], v[200:203], a[88:91]
    v_cvt_pk_bf16_f32 v240, v160, v161
    v_mfma_f32_16x16x32_bf16 a[92:95], a[200:203], v[204:207], a[92:95]
    v_exp_f32 v163, v163
    v_mfma_f32_16x16x32_bf16 a[92:95], a[204:207], v[208:211], a[92:95]
    buffer_load_dwordx4 v18, s[12:15], s29 offen offset:3072 lds
    v_smfmac_f32_16x16x64_bf16 a[232:235], v[244:247], v[196:203], v248
    s_waitcnt vmcnt(8) lgkmcnt(6)
    s_barrier
    s_add_u32 s29, s29, 16384
    v_mfma_f32_16x16x32_bf16 v[156:159], a[160:163], v[68:71], v[108:111]
    v_exp_f32 v164, v164
    v_mfma_f32_16x16x32_bf16 v[156:159], a[164:167], v[72:75], v[156:159]
    ds_read_b64_tr_b16 a[192:193], v5 offset:16384
    v_cvt_pk_bf16_f32 v241, v162, v163
    v_mfma_f32_16x16x32_bf16 v[156:159], a[168:171], v[76:79], v[156:159]
    v_exp_f32 v165, v165
    v_mfma_f32_16x16x32_bf16 v[156:159], a[172:175], v[80:83], v[156:159]
    ds_read_b64_tr_b16 a[194:195], v5 offset:20480
    v_mfma_f32_16x16x32_bf16 v[160:163], a[160:163], v[84:87], v[112:115]
    v_exp_f32 v166, v166
    v_mfma_f32_16x16x32_bf16 v[160:163], a[164:167], v[88:91], v[160:163]
    ds_read_b128 a[128:131], v1 offset:0
    v_cvt_pk_bf16_f32 v218, v164, v165
    v_mfma_f32_16x16x32_bf16 v[160:163], a[168:171], v[92:95], v[160:163]
    v_exp_f32 v167, v167
    v_mfma_f32_16x16x32_bf16 v[160:163], a[172:175], v[96:99], v[160:163]
    ds_read_b64_tr_b16 a[196:197], v5 offset:40960
    v_mfma_f32_16x16x32_bf16 a[96:99], a[208:211], v[180:183], a[96:99]
    v_exp_f32 v168, v168
    v_mfma_f32_16x16x32_bf16 a[96:99], a[212:215], v[184:187], a[96:99]
    ds_read_b64_tr_b16 a[198:199], v5 offset:45056
    v_cvt_pk_bf16_f32 v219, v166, v167
    v_mfma_f32_16x16x32_bf16 a[100:103], a[208:211], v[188:191], a[100:103]
    v_exp_f32 v169, v169
    v_mfma_f32_16x16x32_bf16 a[100:103], a[212:215], v[192:195], a[100:103]
    ds_read_b128 a[132:135], v2 offset:0
    v_cvt_pk_bf16_f32 v226, v168, v169
    v_mfma_f32_16x16x32_bf16 a[104:107], a[208:211], v[196:199], a[104:107]
    s_add_u32 m0, s34, 16384
    v_exp_f32 v170, v170
    v_mfma_f32_16x16x32_bf16 a[104:107], a[212:215], v[200:203], a[104:107]
    buffer_load_dwordx4 v13, s[8:11], s28 offen offset:0 lds
    v_mfma_f32_16x16x32_bf16 a[108:111], a[208:211], v[204:207], a[108:111]
    v_exp_f32 v171, v171
    v_mfma_f32_16x16x32_bf16 a[108:111], a[212:215], v[208:211], a[108:111]
    s_waitcnt lgkmcnt(6)
    v_mfma_f32_16x16x32_bf16 v[164:167], a[176:179], v[36:39], v[100:103]
    v_exp_f32 v172, v172
    v_mfma_f32_16x16x32_bf16 v[164:167], a[180:183], v[40:43], v[164:167]
    ds_read_b64_tr_b16 a[200:201], v6 offset:16384
    v_cvt_pk_bf16_f32 v227, v170, v171
    v_mfma_f32_16x16x32_bf16 v[164:167], a[184:187], v[44:47], v[164:167]
    v_exp_f32 v173, v173
    v_mfma_f32_16x16x32_bf16 v[164:167], a[188:191], v[48:51], v[164:167]
    ds_read_b64_tr_b16 a[202:203], v6 offset:20480
    v_mfma_f32_16x16x32_bf16 v[168:171], a[176:179], v[52:55], v[104:107]
    v_exp_f32 v174, v174
    v_mfma_f32_16x16x32_bf16 v[168:171], a[180:183], v[56:59], v[168:171]
    ds_read_b128 a[136:139], v3 offset:0
    v_cvt_pk_bf16_f32 v234, v172, v173
    v_mfma_f32_16x16x32_bf16 v[168:171], a[184:187], v[60:63], v[168:171]
    v_exp_f32 v175, v175
    v_mfma_f32_16x16x32_bf16 v[168:171], a[188:191], v[64:67], v[168:171]
    ds_read_b64_tr_b16 a[204:205], v6 offset:40960
    v_mfma_f32_16x16x32_bf16 a[112:115], a[216:219], v[180:183], a[112:115]
    v_exp_f32 v176, v176
    v_mfma_f32_16x16x32_bf16 a[112:115], a[220:223], v[184:187], a[112:115]
    ds_read_b64_tr_b16 a[206:207], v6 offset:45056
    v_cvt_pk_bf16_f32 v235, v174, v175
    v_mfma_f32_16x16x32_bf16 a[116:119], a[216:219], v[188:191], a[116:119]
    v_exp_f32 v177, v177
    v_mfma_f32_16x16x32_bf16 a[116:119], a[220:223], v[192:195], a[116:119]
    ds_read_b128 a[140:143], v4 offset:0
    v_mfma_f32_16x16x32_bf16 a[120:123], a[216:219], v[196:199], a[120:123]
    v_exp_f32 v178, v178
    v_mfma_f32_16x16x32_bf16 a[120:123], a[220:223], v[200:203], a[120:123]
    v_cvt_pk_bf16_f32 v242, v176, v177
    v_mfma_f32_16x16x32_bf16 a[124:127], a[216:219], v[204:207], a[124:127]
    v_exp_f32 v179, v179
    v_mfma_f32_16x16x32_bf16 a[124:127], a[220:223], v[208:211], a[124:127]
    buffer_load_dwordx4 v14, s[8:11], s28 offen offset:1024 lds
    v_smfmac_f32_16x16x64_bf16 a[236:239], v[244:247], v[204:211], v248
    s_waitcnt lgkmcnt(6)
    s_sub_u32 s35, s35, 1
    s_cbranch_scc0 L_attn_loop
    v_mfma_f32_16x16x32_bf16 v[172:175], a[176:179], v[68:71], v[108:111]
    v_exp_f32 v116, v116
    v_mfma_f32_16x16x32_bf16 v[172:175], a[180:183], v[72:75], v[172:175]
    ds_read_b64_tr_b16 a[208:209], v7 offset:16384
    v_cvt_pk_bf16_f32 v243, v178, v179
    v_mfma_f32_16x16x32_bf16 v[172:175], a[184:187], v[76:79], v[172:175]
    v_exp_f32 v117, v117
    v_mfma_f32_16x16x32_bf16 v[172:175], a[188:191], v[80:83], v[172:175]
    ds_read_b64_tr_b16 a[210:211], v7 offset:20480
    v_mfma_f32_16x16x32_bf16 v[176:179], a[176:179], v[84:87], v[112:115]
    v_exp_f32 v118, v118
    v_mfma_f32_16x16x32_bf16 v[176:179], a[180:183], v[88:91], v[176:179]
    ds_read_b128 a[144:147], v1 offset:4096
    v_cvt_pk_bf16_f32 v180, v116, v117
    v_mfma_f32_16x16x32_bf16 v[176:179], a[184:187], v[92:95], v[176:179]
    v_exp_f32 v119, v119
    v_mfma_f32_16x16x32_bf16 v[176:179], a[188:191], v[96:99], v[176:179]
    ds_read_b64_tr_b16 a[212:213], v7 offset:40960
    v_mfma_f32_16x16x32_bf16 a[0:3], a[192:195], v[212:215], a[0:3]
    v_exp_f32 v120, v120
    v_mfma_f32_16x16x32_bf16 a[0:3], a[196:199], v[216:219], a[0:3]
    ds_read_b64_tr_b16 a[214:215], v7 offset:45056
    v_cvt_pk_bf16_f32 v181, v118, v119
    v_mfma_f32_16x16x32_bf16 a[4:7], a[192:195], v[220:223], a[4:7]
    v_exp_f32 v121, v121
    v_mfma_f32_16x16x32_bf16 a[4:7], a[196:199], v[224:227], a[4:7]
    ds_read_b128 a[148:151], v2 offset:4096
    v_cvt_pk_bf16_f32 v188, v120, v121
    v_mfma_f32_16x16x32_bf16 a[8:11], a[192:195], v[228:231], a[8:11]
    v_exp_f32 v122, v122
    v_mfma_f32_16x16x32_bf16 a[8:11], a[196:199], v[232:235], a[8:11]
    buffer_load_dwordx4 v15, s[8:11], s28 offen offset:2048 lds
    v_mfma_f32_16x16x32_bf16 a[12:15], a[192:195], v[236:239], a[12:15]
    v_exp_f32 v123, v123
    v_mfma_f32_16x16x32_bf16 a[12:15], a[196:199], v[240:243], a[12:15]
    s_waitcnt lgkmcnt(6)
    v_mfma_f32_16x16x32_bf16 v[116:119], a[128:131], v[36:39], v[100:103]
    v_exp_f32 v124, v124
    v_mfma_f32_16x16x32_bf16 v[116:119], a[132:135], v[40:43], v[116:119]
    ds_read_b64_tr_b16 a[216:217], v8 offset:16384
    v_cvt_pk_bf16_f32 v189, v122, v123
    v_mfma_f32_16x16x32_bf16 v[116:119], a[136:139], v[44:47], v[116:119]
    v_exp_f32 v125, v125
    v_mfma_f32_16x16x32_bf16 v[116:119], a[140:143], v[48:51], v[116:119]
    ds_read_b64_tr_b16 a[218:219], v8 offset:20480
    v_mfma_f32_16x16x32_bf16 v[120:123], a[128:131], v[52:55], v[104:107]
    v_exp_f32 v126, v126
    v_mfma_f32_16x16x32_bf16 v[120:123], a[132:135], v[56:59], v[120:123]
    ds_read_b128 a[152:155], v3 offset:4096
    v_cvt_pk_bf16_f32 v196, v124, v125
    v_mfma_f32_16x16x32_bf16 v[120:123], a[136:139], v[60:63], v[120:123]
    v_exp_f32 v127, v127
    v_mfma_f32_16x16x32_bf16 v[120:123], a[140:143], v[64:67], v[120:123]
    ds_read_b64_tr_b16 a[220:221], v8 offset:40960
    v_mfma_f32_16x16x32_bf16 a[16:19], a[200:203], v[212:215], a[16:19]
    v_exp_f32 v128, v128
    v_mfma_f32_16x16x32_bf16 a[16:19], a[204:207], v[216:219], a[16:19]
    ds_read_b64_tr_b16 a[222:223], v8 offset:45056
    v_cvt_pk_bf16_f32 v197, v126, v127
    v_mfma_f32_16x16x32_bf16 a[20:23], a[200:203], v[220:223], a[20:23]
    v_exp_f32 v129, v129
    v_mfma_f32_16x16x32_bf16 a[20:23], a[204:207], v[224:227], a[20:23]
    ds_read_b128 a[156:159], v4 offset:4096
    v_mfma_f32_16x16x32_bf16 a[24:27], a[200:203], v[228:231], a[24:27]
    v_exp_f32 v130, v130
    v_mfma_f32_16x16x32_bf16 a[24:27], a[204:207], v[232:235], a[24:27]
    v_cvt_pk_bf16_f32 v204, v128, v129
    v_mfma_f32_16x16x32_bf16 a[28:31], a[200:203], v[236:239], a[28:31]
    v_exp_f32 v131, v131
    v_mfma_f32_16x16x32_bf16 a[28:31], a[204:207], v[240:243], a[28:31]
    buffer_load_dwordx4 v16, s[8:11], s28 offen offset:3072 lds
    v_smfmac_f32_16x16x64_bf16 a[224:227], v[244:247], v[212:219], v248
    s_waitcnt lgkmcnt(6)
    v_mfma_f32_16x16x32_bf16 v[124:127], a[128:131], v[68:71], v[108:111]
    v_exp_f32 v132, v132
    v_mfma_f32_16x16x32_bf16 v[124:127], a[132:135], v[72:75], v[124:127]
    ds_read_b64_tr_b16 a[192:193], v9 offset:16384
    v_cvt_pk_bf16_f32 v205, v130, v131
    v_mfma_f32_16x16x32_bf16 v[124:127], a[136:139], v[76:79], v[124:127]
    v_exp_f32 v133, v133
    v_mfma_f32_16x16x32_bf16 v[124:127], a[140:143], v[80:83], v[124:127]
    ds_read_b64_tr_b16 a[194:195], v9 offset:20480
    v_mfma_f32_16x16x32_bf16 v[128:131], a[128:131], v[84:87], v[112:115]
    v_exp_f32 v134, v134
    v_mfma_f32_16x16x32_bf16 v[128:131], a[132:135], v[88:91], v[128:131]
    ds_read_b128 a[160:163], v1 offset:8192
    v_cvt_pk_bf16_f32 v182, v132, v133
    v_mfma_f32_16x16x32_bf16 v[128:131], a[136:139], v[92:95], v[128:131]
    v_exp_f32 v135, v135
    v_mfma_f32_16x16x32_bf16 v[128:131], a[140:143], v[96:99], v[128:131]
    ds_read_b64_tr_b16 a[196:197], v9 offset:40960
    v_mfma_f32_16x16x32_bf16 a[32:35], a[208:211], v[212:215], a[32:35]
    v_exp_f32 v136, v136
    v_mfma_f32_16x16x32_bf16 a[32:35], a[212:215], v[216:219], a[32:35]
    ds_read_b64_tr_b16 a[198:199], v9 offset:45056
    v_cvt_pk_bf16_f32 v183, v134, v135
    v_mfma_f32_16x16x32_bf16 a[36:39], a[208:211], v[220:223], a[36:39]
    v_exp_f32 v137, v137
    v_mfma_f32_16x16x32_bf16 a[36:39], a[212:215], v[224:227], a[36:39]
    ds_read_b128 a[164:167], v2 offset:8192
    v_cvt_pk_bf16_f32 v190, v136, v137
    v_mfma_f32_16x16x32_bf16 a[40:43], a[208:211], v[228:231], a[40:43]
    s_add_u32 s28, s28, 16384
    s_mov_b32 m0, s33
    v_exp_f32 v138, v138
    v_mfma_f32_16x16x32_bf16 a[40:43], a[212:215], v[232:235], a[40:43]
    buffer_load_dwordx4 v17, s[12:15], s29 offen offset:0 lds
    v_mfma_f32_16x16x32_bf16 a[44:47], a[208:211], v[236:239], a[44:47]
    v_exp_f32 v139, v139
    v_mfma_f32_16x16x32_bf16 a[44:47], a[212:215], v[240:243], a[44:47]
    s_waitcnt lgkmcnt(6)
    v_mfma_f32_16x16x32_bf16 v[132:135], a[144:147], v[36:39], v[100:103]
    v_exp_f32 v140, v140
    v_mfma_f32_16x16x32_bf16 v[132:135], a[148:151], v[40:43], v[132:135]
    ds_read_b64_tr_b16 a[200:201], v10 offset:16384
    v_cvt_pk_bf16_f32 v191, v138, v139
    v_mfma_f32_16x16x32_bf16 v[132:135], a[152:155], v[44:47], v[132:135]
    v_exp_f32 v141, v141
    v_mfma_f32_16x16x32_bf16 v[132:135], a[156:159], v[48:51], v[132:135]
    ds_read_b64_tr_b16 a[202:203], v10 offset:20480
    v_mfma_f32_16x16x32_bf16 v[136:139], a[144:147], v[52:55], v[104:107]
    v_exp_f32 v142, v142
    v_mfma_f32_16x16x32_bf16 v[136:139], a[148:151], v[56:59], v[136:139]
    ds_read_b128 a[168:171], v3 offset:8192
    v_cvt_pk_bf16_f32 v198, v140, v141
    v_mfma_f32_16x16x32_bf16 v[136:139], a[152:155], v[60:63], v[136:139]
    v_exp_f32 v143, v143
    v_mfma_f32_16x16x32_bf16 v[136:139], a[156:159], v[64:67], v[136:139]
    ds_read_b64_tr_b16 a[204:205], v10 offset:40960
    v_mfma_f32_16x16x32_bf16 a[48:51], a[216:219], v[212:215], a[48:51]
    v_exp_f32 v144, v144
    v_mfma_f32_16x16x32_bf16 a[48:51], a[220:223], v[216:219], a[48:51]
    ds_read_b64_tr_b16 a[206:207], v10 offset:45056
    v_cvt_pk_bf16_f32 v199, v142, v143
    v_mfma_f32_16x16x32_bf16 a[52:55], a[216:219], v[220:223], a[52:55]
    v_exp_f32 v145, v145
    v_mfma_f32_16x16x32_bf16 a[52:55], a[220:223], v[224:227], a[52:55]
    ds_read_b128 a[172:175], v4 offset:8192
    v_mfma_f32_16x16x32_bf16 a[56:59], a[216:219], v[228:231], a[56:59]
    v_exp_f32 v146, v146
    v_mfma_f32_16x16x32_bf16 a[56:59], a[220:223], v[232:235], a[56:59]
    v_cvt_pk_bf16_f32 v206, v144, v145
    v_mfma_f32_16x16x32_bf16 a[60:63], a[216:219], v[236:239], a[60:63]
    v_exp_f32 v147, v147
    v_mfma_f32_16x16x32_bf16 a[60:63], a[220:223], v[240:243], a[60:63]
    buffer_load_dwordx4 v18, s[12:15], s29 offen offset:1024 lds
    v_smfmac_f32_16x16x64_bf16 a[228:231], v[244:247], v[220:227], v248
    s_waitcnt lgkmcnt(6)
    v_mfma_f32_16x16x32_bf16 v[140:143], a[144:147], v[68:71], v[108:111]
    v_exp_f32 v148, v148
    v_mfma_f32_16x16x32_bf16 v[140:143], a[148:151], v[72:75], v[140:143]
    ds_read_b64_tr_b16 a[208:209], v11 offset:16384
    v_cvt_pk_bf16_f32 v207, v146, v147
    v_mfma_f32_16x16x32_bf16 v[140:143], a[152:155], v[76:79], v[140:143]
    v_exp_f32 v149, v149
    v_mfma_f32_16x16x32_bf16 v[140:143], a[156:159], v[80:83], v[140:143]
    ds_read_b64_tr_b16 a[210:211], v11 offset:20480
    v_mfma_f32_16x16x32_bf16 v[144:147], a[144:147], v[84:87], v[112:115]
    v_exp_f32 v150, v150
    v_mfma_f32_16x16x32_bf16 v[144:147], a[148:151], v[88:91], v[144:147]
    ds_read_b128 a[176:179], v1 offset:12288
    v_cvt_pk_bf16_f32 v184, v148, v149
    v_mfma_f32_16x16x32_bf16 v[144:147], a[152:155], v[92:95], v[144:147]
    v_exp_f32 v151, v151
    v_mfma_f32_16x16x32_bf16 v[144:147], a[156:159], v[96:99], v[144:147]
    ds_read_b64_tr_b16 a[212:213], v11 offset:40960
    v_mfma_f32_16x16x32_bf16 a[64:67], a[192:195], v[212:215], a[64:67]
    v_exp_f32 v152, v152
    v_mfma_f32_16x16x32_bf16 a[64:67], a[196:199], v[216:219], a[64:67]
    ds_read_b64_tr_b16 a[214:215], v11 offset:45056
    v_cvt_pk_bf16_f32 v185, v150, v151
    v_mfma_f32_16x16x32_bf16 a[68:71], a[192:195], v[220:223], a[68:71]
    v_exp_f32 v153, v153
    v_mfma_f32_16x16x32_bf16 a[68:71], a[196:199], v[224:227], a[68:71]
    ds_read_b128 a[180:183], v2 offset:12288
    v_cvt_pk_bf16_f32 v192, v152, v153
    v_mfma_f32_16x16x32_bf16 a[72:75], a[192:195], v[228:231], a[72:75]
    v_exp_f32 v154, v154
    v_mfma_f32_16x16x32_bf16 a[72:75], a[196:199], v[232:235], a[72:75]
    buffer_load_dwordx4 v17, s[12:15], s29 offen offset:2048 lds
    v_mfma_f32_16x16x32_bf16 a[76:79], a[192:195], v[236:239], a[76:79]
    v_exp_f32 v155, v155
    v_mfma_f32_16x16x32_bf16 a[76:79], a[196:199], v[240:243], a[76:79]
    s_waitcnt lgkmcnt(6)
    v_mfma_f32_16x16x32_bf16 v[148:151], a[160:163], v[36:39], v[100:103]
    v_exp_f32 v156, v156
    v_mfma_f32_16x16x32_bf16 v[148:151], a[164:167], v[40:43], v[148:151]
    ds_read_b64_tr_b16 a[216:217], v12 offset:16384
    v_cvt_pk_bf16_f32 v193, v154, v155
    v_mfma_f32_16x16x32_bf16 v[148:151], a[168:171], v[44:47], v[148:151]
    v_exp_f32 v157, v157
    v_mfma_f32_16x16x32_bf16 v[148:151], a[172:175], v[48:51], v[148:151]
    ds_read_b64_tr_b16 a[218:219], v12 offset:20480
    v_mfma_f32_16x16x32_bf16 v[152:155], a[160:163], v[52:55], v[104:107]
    v_exp_f32 v158, v158
    v_mfma_f32_16x16x32_bf16 v[152:155], a[164:167], v[56:59], v[152:155]
    ds_read_b128 a[184:187], v3 offset:12288
    v_cvt_pk_bf16_f32 v200, v156, v157
    v_mfma_f32_16x16x32_bf16 v[152:155], a[168:171], v[60:63], v[152:155]
    v_exp_f32 v159, v159
    v_mfma_f32_16x16x32_bf16 v[152:155], a[172:175], v[64:67], v[152:155]
    ds_read_b64_tr_b16 a[220:221], v12 offset:40960
    v_mfma_f32_16x16x32_bf16 a[80:83], a[200:203], v[212:215], a[80:83]
    v_exp_f32 v160, v160
    v_mfma_f32_16x16x32_bf16 a[80:83], a[204:207], v[216:219], a[80:83]
    ds_read_b64_tr_b16 a[222:223], v12 offset:45056
    v_cvt_pk_bf16_f32 v201, v158, v159
    v_mfma_f32_16x16x32_bf16 a[84:87], a[200:203], v[220:223], a[84:87]
    v_exp_f32 v161, v161
    v_mfma_f32_16x16x32_bf16 a[84:87], a[204:207], v[224:227], a[84:87]
    ds_read_b128 a[188:191], v4 offset:12288
    v_mfma_f32_16x16x32_bf16 a[88:91], a[200:203], v[228:231], a[88:91]
    v_exp_f32 v162, v162
    v_mfma_f32_16x16x32_bf16 a[88:91], a[204:207], v[232:235], a[88:91]
    v_cvt_pk_bf16_f32 v208, v160, v161
    v_mfma_f32_16x16x32_bf16 a[92:95], a[200:203], v[236:239], a[92:95]
    v_exp_f32 v163, v163
    v_mfma_f32_16x16x32_bf16 a[92:95], a[204:207], v[240:243], a[92:95]
    buffer_load_dwordx4 v18, s[12:15], s29 offen offset:3072 lds
    v_smfmac_f32_16x16x64_bf16 a[232:235], v[244:247], v[228:235], v248
    s_waitcnt vmcnt(8) lgkmcnt(6)
    s_barrier
    s_add_u32 s29, s29, 16384
    v_mfma_f32_16x16x32_bf16 v[156:159], a[160:163], v[68:71], v[108:111]
    v_exp_f32 v164, v164
    v_mfma_f32_16x16x32_bf16 v[156:159], a[164:167], v[72:75], v[156:159]
    ds_read_b64_tr_b16 a[192:193], v5 offset:57344
    v_cvt_pk_bf16_f32 v209, v162, v163
    v_mfma_f32_16x16x32_bf16 v[156:159], a[168:171], v[76:79], v[156:159]
    v_exp_f32 v165, v165
    v_mfma_f32_16x16x32_bf16 v[156:159], a[172:175], v[80:83], v[156:159]
    ds_read_b64_tr_b16 a[194:195], v5 offset:61440
    v_mfma_f32_16x16x32_bf16 v[160:163], a[160:163], v[84:87], v[112:115]
    v_exp_f32 v166, v166
    v_mfma_f32_16x16x32_bf16 v[160:163], a[164:167], v[88:91], v[160:163]
    ds_read_b64_tr_b16 a[196:197], v5 offset:0
    v_cvt_pk_bf16_f32 v186, v164, v165
    v_mfma_f32_16x16x32_bf16 v[160:163], a[168:171], v[92:95], v[160:163]
    v_exp_f32 v167, v167
    v_mfma_f32_16x16x32_bf16 v[160:163], a[172:175], v[96:99], v[160:163]
    ds_read_b64_tr_b16 a[198:199], v5 offset:4096
    v_mfma_f32_16x16x32_bf16 a[96:99], a[208:211], v[212:215], a[96:99]
    v_exp_f32 v168, v168
    v_mfma_f32_16x16x32_bf16 a[96:99], a[212:215], v[216:219], a[96:99]
    v_cvt_pk_bf16_f32 v187, v166, v167
    v_mfma_f32_16x16x32_bf16 a[100:103], a[208:211], v[220:223], a[100:103]
    v_exp_f32 v169, v169
    v_mfma_f32_16x16x32_bf16 a[100:103], a[212:215], v[224:227], a[100:103]
    v_mfma_f32_16x16x32_bf16 a[104:107], a[208:211], v[228:231], a[104:107]
    v_exp_f32 v170, v170
    v_mfma_f32_16x16x32_bf16 a[104:107], a[212:215], v[232:235], a[104:107]
    v_cvt_pk_bf16_f32 v194, v168, v169
    v_mfma_f32_16x16x32_bf16 a[108:111], a[208:211], v[236:239], a[108:111]
    v_exp_f32 v171, v171
    v_mfma_f32_16x16x32_bf16 a[108:111], a[212:215], v[240:243], a[108:111]
    s_waitcnt lgkmcnt(4)
    v_mfma_f32_16x16x32_bf16 v[164:167], a[176:179], v[36:39], v[100:103]
    v_exp_f32 v172, v172
    v_mfma_f32_16x16x32_bf16 v[164:167], a[180:183], v[40:43], v[164:167]
    ds_read_b64_tr_b16 a[200:201], v6 offset:57344
    v_cvt_pk_bf16_f32 v195, v170, v171
    v_mfma_f32_16x16x32_bf16 v[164:167], a[184:187], v[44:47], v[164:167]
    v_exp_f32 v173, v173
    v_mfma_f32_16x16x32_bf16 v[164:167], a[188:191], v[48:51], v[164:167]
    ds_read_b64_tr_b16 a[202:203], v6 offset:61440
    v_mfma_f32_16x16x32_bf16 v[168:171], a[176:179], v[52:55], v[104:107]
    v_exp_f32 v174, v174
    v_mfma_f32_16x16x32_bf16 v[168:171], a[180:183], v[56:59], v[168:171]
    ds_read_b64_tr_b16 a[204:205], v6 offset:0
    v_cvt_pk_bf16_f32 v202, v172, v173
    v_mfma_f32_16x16x32_bf16 v[168:171], a[184:187], v[60:63], v[168:171]
    v_exp_f32 v175, v175
    v_mfma_f32_16x16x32_bf16 v[168:171], a[188:191], v[64:67], v[168:171]
    ds_read_b64_tr_b16 a[206:207], v6 offset:4096
    v_mfma_f32_16x16x32_bf16 a[112:115], a[216:219], v[212:215], a[112:115]
    v_exp_f32 v176, v176
    v_mfma_f32_16x16x32_bf16 a[112:115], a[220:223], v[216:219], a[112:115]
    v_cvt_pk_bf16_f32 v203, v174, v175
    v_mfma_f32_16x16x32_bf16 a[116:119], a[216:219], v[220:223], a[116:119]
    v_exp_f32 v177, v177
    v_mfma_f32_16x16x32_bf16 a[116:119], a[220:223], v[224:227], a[116:119]
    v_mfma_f32_16x16x32_bf16 a[120:123], a[216:219], v[228:231], a[120:123]
    v_exp_f32 v178, v178
    v_mfma_f32_16x16x32_bf16 a[120:123], a[220:223], v[232:235], a[120:123]
    v_cvt_pk_bf16_f32 v210, v176, v177
    v_mfma_f32_16x16x32_bf16 a[124:127], a[216:219], v[236:239], a[124:127]
    v_exp_f32 v179, v179
    v_mfma_f32_16x16x32_bf16 a[124:127], a[220:223], v[240:243], a[124:127]
    v_smfmac_f32_16x16x64_bf16 a[236:239], v[244:247], v[236:243], v248
    s_waitcnt lgkmcnt(4)
    v_mfma_f32_16x16x32_bf16 v[172:175], a[176:179], v[68:71], v[108:111]
    v_exp_f32 v116, v116
    v_mfma_f32_16x16x32_bf16 v[172:175], a[180:183], v[72:75], v[172:175]
    ds_read_b64_tr_b16 a[208:209], v7 offset:57344
    v_cvt_pk_bf16_f32 v211, v178, v179
    v_mfma_f32_16x16x32_bf16 v[172:175], a[184:187], v[76:79], v[172:175]
    v_exp_f32 v117, v117
    v_mfma_f32_16x16x32_bf16 v[172:175], a[188:191], v[80:83], v[172:175]
    ds_read_b64_tr_b16 a[210:211], v7 offset:61440
    v_mfma_f32_16x16x32_bf16 v[176:179], a[176:179], v[84:87], v[112:115]
    v_exp_f32 v118, v118
    v_mfma_f32_16x16x32_bf16 v[176:179], a[180:183], v[88:91], v[176:179]
    ds_read_b64_tr_b16 a[212:213], v7 offset:0
    v_cvt_pk_bf16_f32 v212, v116, v117
    v_mfma_f32_16x16x32_bf16 v[176:179], a[184:187], v[92:95], v[176:179]
    v_exp_f32 v119, v119
    v_mfma_f32_16x16x32_bf16 v[176:179], a[188:191], v[96:99], v[176:179]
    ds_read_b64_tr_b16 a[214:215], v7 offset:4096
    v_mfma_f32_16x16x32_bf16 a[0:3], a[192:195], v[180:183], a[0:3]
    v_exp_f32 v120, v120
    v_mfma_f32_16x16x32_bf16 a[0:3], a[196:199], v[184:187], a[0:3]
    v_cvt_pk_bf16_f32 v213, v118, v119
    v_mfma_f32_16x16x32_bf16 a[4:7], a[192:195], v[188:191], a[4:7]
    v_exp_f32 v121, v121
    v_mfma_f32_16x16x32_bf16 a[4:7], a[196:199], v[192:195], a[4:7]
    v_mfma_f32_16x16x32_bf16 a[8:11], a[192:195], v[196:199], a[8:11]
    v_exp_f32 v122, v122
    v_mfma_f32_16x16x32_bf16 a[8:11], a[196:199], v[200:203], a[8:11]
    v_cvt_pk_bf16_f32 v220, v120, v121
    v_mfma_f32_16x16x32_bf16 a[12:15], a[192:195], v[204:207], a[12:15]
    v_exp_f32 v123, v123
    v_mfma_f32_16x16x32_bf16 a[12:15], a[196:199], v[208:211], a[12:15]
    s_waitcnt lgkmcnt(4)
    v_mfma_f32_16x16x32_bf16 a[16:19], a[200:203], v[180:183], a[16:19]
    v_exp_f32 v124, v124
    v_mfma_f32_16x16x32_bf16 a[16:19], a[204:207], v[184:187], a[16:19]
    ds_read_b64_tr_b16 a[216:217], v8 offset:57344
    v_cvt_pk_bf16_f32 v221, v122, v123
    v_exp_f32 v125, v125
    v_mfma_f32_16x16x32_bf16 a[20:23], a[200:203], v[188:191], a[20:23]
    ds_read_b64_tr_b16 a[218:219], v8 offset:61440
    v_exp_f32 v126, v126
    v_mfma_f32_16x16x32_bf16 a[20:23], a[204:207], v[192:195], a[20:23]
    ds_read_b64_tr_b16 a[220:221], v8 offset:0
    v_cvt_pk_bf16_f32 v228, v124, v125
    v_exp_f32 v127, v127
    v_mfma_f32_16x16x32_bf16 a[24:27], a[200:203], v[196:199], a[24:27]
    ds_read_b64_tr_b16 a[222:223], v8 offset:4096
    v_mfma_f32_16x16x32_bf16 a[24:27], a[204:207], v[200:203], a[24:27]
    v_exp_f32 v128, v128
    v_cvt_pk_bf16_f32 v229, v126, v127
    v_mfma_f32_16x16x32_bf16 a[28:31], a[200:203], v[204:207], a[28:31]
    v_exp_f32 v129, v129
    v_mfma_f32_16x16x32_bf16 a[28:31], a[204:207], v[208:211], a[28:31]
    v_exp_f32 v130, v130
    v_cvt_pk_bf16_f32 v236, v128, v129
    v_smfmac_f32_16x16x64_bf16 a[224:227], v[244:247], v[180:187], v248
    v_exp_f32 v131, v131
    s_waitcnt lgkmcnt(4)
    v_mfma_f32_16x16x32_bf16 a[32:35], a[208:211], v[180:183], a[32:35]
    v_exp_f32 v132, v132
    ds_read_b64_tr_b16 a[192:193], v9 offset:57344
    v_cvt_pk_bf16_f32 v237, v130, v131
    v_mfma_f32_16x16x32_bf16 a[32:35], a[212:215], v[184:187], a[32:35]
    v_exp_f32 v133, v133
    ds_read_b64_tr_b16 a[194:195], v9 offset:61440
    v_mfma_f32_16x16x32_bf16 a[36:39], a[208:211], v[188:191], a[36:39]
    v_exp_f32 v134, v134
    ds_read_b64_tr_b16 a[196:197], v9 offset:0
    v_cvt_pk_bf16_f32 v214, v132, v133
    v_mfma_f32_16x16x32_bf16 a[36:39], a[212:215], v[192:195], a[36:39]
    v_exp_f32 v135, v135
    ds_read_b64_tr_b16 a[198:199], v9 offset:4096
    v_mfma_f32_16x16x32_bf16 a[40:43], a[208:211], v[196:199], a[40:43]
    v_exp_f32 v136, v136
    v_cvt_pk_bf16_f32 v215, v134, v135
    v_mfma_f32_16x16x32_bf16 a[40:43], a[212:215], v[200:203], a[40:43]
    v_exp_f32 v137, v137
    v_mfma_f32_16x16x32_bf16 a[44:47], a[208:211], v[204:207], a[44:47]
    v_exp_f32 v138, v138
    v_cvt_pk_bf16_f32 v222, v136, v137
    v_mfma_f32_16x16x32_bf16 a[44:47], a[212:215], v[208:211], a[44:47]
    v_exp_f32 v139, v139
    s_waitcnt lgkmcnt(4)
    v_mfma_f32_16x16x32_bf16 a[48:51], a[216:219], v[180:183], a[48:51]
    v_exp_f32 v140, v140
    v_mfma_f32_16x16x32_bf16 a[48:51], a[220:223], v[184:187], a[48:51]
    ds_read_b64_tr_b16 a[200:201], v10 offset:57344
    v_cvt_pk_bf16_f32 v223, v138, v139
    v_exp_f32 v141, v141
    v_mfma_f32_16x16x32_bf16 a[52:55], a[216:219], v[188:191], a[52:55]
    ds_read_b64_tr_b16 a[202:203], v10 offset:61440
    v_exp_f32 v142, v142
    v_mfma_f32_16x16x32_bf16 a[52:55], a[220:223], v[192:195], a[52:55]
    ds_read_b64_tr_b16 a[204:205], v10 offset:0
    v_cvt_pk_bf16_f32 v230, v140, v141
    v_exp_f32 v143, v143
    v_mfma_f32_16x16x32_bf16 a[56:59], a[216:219], v[196:199], a[56:59]
    ds_read_b64_tr_b16 a[206:207], v10 offset:4096
    v_mfma_f32_16x16x32_bf16 a[56:59], a[220:223], v[200:203], a[56:59]
    v_exp_f32 v144, v144
    v_cvt_pk_bf16_f32 v231, v142, v143
    v_mfma_f32_16x16x32_bf16 a[60:63], a[216:219], v[204:207], a[60:63]
    v_exp_f32 v145, v145
    v_mfma_f32_16x16x32_bf16 a[60:63], a[220:223], v[208:211], a[60:63]
    v_exp_f32 v146, v146
    v_cvt_pk_bf16_f32 v238, v144, v145
    v_smfmac_f32_16x16x64_bf16 a[228:231], v[244:247], v[188:195], v248
    v_exp_f32 v147, v147
    s_waitcnt lgkmcnt(4)
    v_mfma_f32_16x16x32_bf16 a[64:67], a[192:195], v[180:183], a[64:67]
    v_exp_f32 v148, v148
    ds_read_b64_tr_b16 a[208:209], v11 offset:57344
    v_cvt_pk_bf16_f32 v239, v146, v147
    v_mfma_f32_16x16x32_bf16 a[64:67], a[196:199], v[184:187], a[64:67]
    v_exp_f32 v149, v149
    ds_read_b64_tr_b16 a[210:211], v11 offset:61440
    v_mfma_f32_16x16x32_bf16 a[68:71], a[192:195], v[188:191], a[68:71]
    v_exp_f32 v150, v150
    ds_read_b64_tr_b16 a[212:213], v11 offset:0
    v_cvt_pk_bf16_f32 v216, v148, v149
    v_mfma_f32_16x16x32_bf16 a[68:71], a[196:199], v[192:195], a[68:71]
    v_exp_f32 v151, v151
    ds_read_b64_tr_b16 a[214:215], v11 offset:4096
    v_mfma_f32_16x16x32_bf16 a[72:75], a[192:195], v[196:199], a[72:75]
    v_exp_f32 v152, v152
    v_cvt_pk_bf16_f32 v217, v150, v151
    v_mfma_f32_16x16x32_bf16 a[72:75], a[196:199], v[200:203], a[72:75]
    v_exp_f32 v153, v153
    v_mfma_f32_16x16x32_bf16 a[76:79], a[192:195], v[204:207], a[76:79]
    v_exp_f32 v154, v154
    v_cvt_pk_bf16_f32 v224, v152, v153
    v_mfma_f32_16x16x32_bf16 a[76:79], a[196:199], v[208:211], a[76:79]
    v_exp_f32 v155, v155
    s_waitcnt lgkmcnt(4)
    v_mfma_f32_16x16x32_bf16 a[80:83], a[200:203], v[180:183], a[80:83]
    v_exp_f32 v156, v156
    v_mfma_f32_16x16x32_bf16 a[80:83], a[204:207], v[184:187], a[80:83]
    ds_read_b64_tr_b16 a[216:217], v12 offset:57344
    v_cvt_pk_bf16_f32 v225, v154, v155
    v_exp_f32 v157, v157
    v_mfma_f32_16x16x32_bf16 a[84:87], a[200:203], v[188:191], a[84:87]
    ds_read_b64_tr_b16 a[218:219], v12 offset:61440
    v_exp_f32 v158, v158
    v_mfma_f32_16x16x32_bf16 a[84:87], a[204:207], v[192:195], a[84:87]
    ds_read_b64_tr_b16 a[220:221], v12 offset:0
    v_cvt_pk_bf16_f32 v232, v156, v157
    v_exp_f32 v159, v159
    v_mfma_f32_16x16x32_bf16 a[88:91], a[200:203], v[196:199], a[88:91]
    ds_read_b64_tr_b16 a[222:223], v12 offset:4096
    v_mfma_f32_16x16x32_bf16 a[88:91], a[204:207], v[200:203], a[88:91]
    v_exp_f32 v160, v160
    v_cvt_pk_bf16_f32 v233, v158, v159
    v_mfma_f32_16x16x32_bf16 a[92:95], a[200:203], v[204:207], a[92:95]
    v_exp_f32 v161, v161
    v_mfma_f32_16x16x32_bf16 a[92:95], a[204:207], v[208:211], a[92:95]
    v_exp_f32 v162, v162
    v_cvt_pk_bf16_f32 v240, v160, v161
    v_smfmac_f32_16x16x64_bf16 a[232:235], v[244:247], v[196:203], v248
    v_exp_f32 v163, v163
    s_waitcnt vmcnt(0) lgkmcnt(4)
    s_barrier
    v_mfma_f32_16x16x32_bf16 a[96:99], a[208:211], v[180:183], a[96:99]
    v_exp_f32 v164, v164
    ds_read_b64_tr_b16 a[192:193], v5 offset:24576
    v_cvt_pk_bf16_f32 v241, v162, v163
    v_mfma_f32_16x16x32_bf16 a[96:99], a[212:215], v[184:187], a[96:99]
    v_exp_f32 v165, v165
    ds_read_b64_tr_b16 a[194:195], v5 offset:28672
    v_mfma_f32_16x16x32_bf16 a[100:103], a[208:211], v[188:191], a[100:103]
    v_exp_f32 v166, v166
    ds_read_b64_tr_b16 a[196:197], v5 offset:49152
    v_cvt_pk_bf16_f32 v218, v164, v165
    v_mfma_f32_16x16x32_bf16 a[100:103], a[212:215], v[192:195], a[100:103]
    v_exp_f32 v167, v167
    ds_read_b64_tr_b16 a[198:199], v5 offset:53248
    v_mfma_f32_16x16x32_bf16 a[104:107], a[208:211], v[196:199], a[104:107]
    v_exp_f32 v168, v168
    v_cvt_pk_bf16_f32 v219, v166, v167
    v_mfma_f32_16x16x32_bf16 a[104:107], a[212:215], v[200:203], a[104:107]
    v_exp_f32 v169, v169
    v_mfma_f32_16x16x32_bf16 a[108:111], a[208:211], v[204:207], a[108:111]
    v_exp_f32 v170, v170
    v_cvt_pk_bf16_f32 v226, v168, v169
    v_mfma_f32_16x16x32_bf16 a[108:111], a[212:215], v[208:211], a[108:111]
    v_exp_f32 v171, v171
    s_waitcnt lgkmcnt(4)
    v_mfma_f32_16x16x32_bf16 a[112:115], a[216:219], v[180:183], a[112:115]
    v_exp_f32 v172, v172
    v_mfma_f32_16x16x32_bf16 a[112:115], a[220:223], v[184:187], a[112:115]
    ds_read_b64_tr_b16 a[200:201], v6 offset:24576
    v_cvt_pk_bf16_f32 v227, v170, v171
    v_exp_f32 v173, v173
    v_mfma_f32_16x16x32_bf16 a[116:119], a[216:219], v[188:191], a[116:119]
    ds_read_b64_tr_b16 a[202:203], v6 offset:28672
    v_exp_f32 v174, v174
    v_mfma_f32_16x16x32_bf16 a[116:119], a[220:223], v[192:195], a[116:119]
    ds_read_b64_tr_b16 a[204:205], v6 offset:49152
    v_cvt_pk_bf16_f32 v234, v172, v173
    v_exp_f32 v175, v175
    v_mfma_f32_16x16x32_bf16 a[120:123], a[216:219], v[196:199], a[120:123]
    ds_read_b64_tr_b16 a[206:207], v6 offset:53248
    v_mfma_f32_16x16x32_bf16 a[120:123], a[220:223], v[200:203], a[120:123]
    v_exp_f32 v176, v176
    v_cvt_pk_bf16_f32 v235, v174, v175
    v_mfma_f32_16x16x32_bf16 a[124:127], a[216:219], v[204:207], a[124:127]
    v_exp_f32 v177, v177
    v_mfma_f32_16x16x32_bf16 a[124:127], a[220:223], v[208:211], a[124:127]
    v_exp_f32 v178, v178
    v_cvt_pk_bf16_f32 v242, v176, v177
    v_smfmac_f32_16x16x64_bf16 a[236:239], v[244:247], v[204:211], v248
    v_exp_f32 v179, v179
    s_waitcnt lgkmcnt(4)
    v_mfma_f32_16x16x32_bf16 a[0:3], a[192:195], v[212:215], a[0:3]
    ds_read_b64_tr_b16 a[208:209], v7 offset:24576
    v_cvt_pk_bf16_f32 v243, v178, v179
    v_mfma_f32_16x16x32_bf16 a[0:3], a[196:199], v[216:219], a[0:3]
    ds_read_b64_tr_b16 a[210:211], v7 offset:28672
    v_mfma_f32_16x16x32_bf16 a[4:7], a[192:195], v[220:223], a[4:7]
    ds_read_b64_tr_b16 a[212:213], v7 offset:49152
    v_mfma_f32_16x16x32_bf16 a[4:7], a[196:199], v[224:227], a[4:7]
    ds_read_b64_tr_b16 a[214:215], v7 offset:53248
    v_mfma_f32_16x16x32_bf16 a[8:11], a[192:195], v[228:231], a[8:11]
    v_mfma_f32_16x16x32_bf16 a[8:11], a[196:199], v[232:235], a[8:11]
    v_mfma_f32_16x16x32_bf16 a[12:15], a[192:195], v[236:239], a[12:15]
    v_mfma_f32_16x16x32_bf16 a[12:15], a[196:199], v[240:243], a[12:15]
    s_waitcnt lgkmcnt(4)
    v_mfma_f32_16x16x32_bf16 a[16:19], a[200:203], v[212:215], a[16:19]
    v_mfma_f32_16x16x32_bf16 a[16:19], a[204:207], v[216:219], a[16:19]
    ds_read_b64_tr_b16 a[216:217], v8 offset:24576
    v_mfma_f32_16x16x32_bf16 a[20:23], a[200:203], v[220:223], a[20:23]
    ds_read_b64_tr_b16 a[218:219], v8 offset:28672
    v_mfma_f32_16x16x32_bf16 a[20:23], a[204:207], v[224:227], a[20:23]
    ds_read_b64_tr_b16 a[220:221], v8 offset:49152
    v_mfma_f32_16x16x32_bf16 a[24:27], a[200:203], v[228:231], a[24:27]
    ds_read_b64_tr_b16 a[222:223], v8 offset:53248
    v_mfma_f32_16x16x32_bf16 a[24:27], a[204:207], v[232:235], a[24:27]
    v_mfma_f32_16x16x32_bf16 a[28:31], a[200:203], v[236:239], a[28:31]
    v_mfma_f32_16x16x32_bf16 a[28:31], a[204:207], v[240:243], a[28:31]
    v_smfmac_f32_16x16x64_bf16 a[224:227], v[244:247], v[212:219], v248
    s_waitcnt lgkmcnt(4)
    v_mfma_f32_16x16x32_bf16 a[32:35], a[208:211], v[212:215], a[32:35]
    ds_read_b64_tr_b16 a[192:193], v9 offset:24576
    v_mfma_f32_16x16x32_bf16 a[32:35], a[212:215], v[216:219], a[32:35]
    ds_read_b64_tr_b16 a[194:195], v9 offset:28672
    v_mfma_f32_16x16x32_bf16 a[36:39], a[208:211], v[220:223], a[36:39]
    ds_read_b64_tr_b16 a[196:197], v9 offset:49152
    v_mfma_f32_16x16x32_bf16 a[36:39], a[212:215], v[224:227], a[36:39]
    ds_read_b64_tr_b16 a[198:199], v9 offset:53248
    v_mfma_f32_16x16x32_bf16 a[40:43], a[208:211], v[228:231], a[40:43]
    v_mfma_f32_16x16x32_bf16 a[40:43], a[212:215], v[232:235], a[40:43]
    v_mfma_f32_16x16x32_bf16 a[44:47], a[208:211], v[236:239], a[44:47]
    v_mfma_f32_16x16x32_bf16 a[44:47], a[212:215], v[240:243], a[44:47]
    s_waitcnt lgkmcnt(4)
    v_mfma_f32_16x16x32_bf16 a[48:51], a[216:219], v[212:215], a[48:51]
    v_mfma_f32_16x16x32_bf16 a[48:51], a[220:223], v[216:219], a[48:51]
    ds_read_b64_tr_b16 a[200:201], v10 offset:24576
    v_mfma_f32_16x16x32_bf16 a[52:55], a[216:219], v[220:223], a[52:55]
    ds_read_b64_tr_b16 a[202:203], v10 offset:28672
    v_mfma_f32_16x16x32_bf16 a[52:55], a[220:223], v[224:227], a[52:55]
    ds_read_b64_tr_b16 a[204:205], v10 offset:49152
    v_mfma_f32_16x16x32_bf16 a[56:59], a[216:219], v[228:231], a[56:59]
    ds_read_b64_tr_b16 a[206:207], v10 offset:53248
    v_mfma_f32_16x16x32_bf16 a[56:59], a[220:223], v[232:235], a[56:59]
    v_mfma_f32_16x16x32_bf16 a[60:63], a[216:219], v[236:239], a[60:63]
    v_mfma_f32_16x16x32_bf16 a[60:63], a[220:223], v[240:243], a[60:63]
    v_smfmac_f32_16x16x64_bf16 a[228:231], v[244:247], v[220:227], v248
    s_waitcnt lgkmcnt(4)
    v_mfma_f32_16x16x32_bf16 a[64:67], a[192:195], v[212:215], a[64:67]
    ds_read_b64_tr_b16 a[208:209], v11 offset:24576
    v_mfma_f32_16x16x32_bf16 a[64:67], a[196:199], v[216:219], a[64:67]
    ds_read_b64_tr_b16 a[210:211], v11 offset:28672
    v_mfma_f32_16x16x32_bf16 a[68:71], a[192:195], v[220:223], a[68:71]
    ds_read_b64_tr_b16 a[212:213], v11 offset:49152
    v_mfma_f32_16x16x32_bf16 a[68:71], a[196:199], v[224:227], a[68:71]
    ds_read_b64_tr_b16 a[214:215], v11 offset:53248
    v_mfma_f32_16x16x32_bf16 a[72:75], a[192:195], v[228:231], a[72:75]
    v_mfma_f32_16x16x32_bf16 a[72:75], a[196:199], v[232:235], a[72:75]
    v_mfma_f32_16x16x32_bf16 a[76:79], a[192:195], v[236:239], a[76:79]
    v_mfma_f32_16x16x32_bf16 a[76:79], a[196:199], v[240:243], a[76:79]
    s_waitcnt lgkmcnt(4)
    v_mfma_f32_16x16x32_bf16 a[80:83], a[200:203], v[212:215], a[80:83]
    v_mfma_f32_16x16x32_bf16 a[80:83], a[204:207], v[216:219], a[80:83]
    ds_read_b64_tr_b16 a[216:217], v12 offset:24576
    v_mfma_f32_16x16x32_bf16 a[84:87], a[200:203], v[220:223], a[84:87]
    ds_read_b64_tr_b16 a[218:219], v12 offset:28672
    v_mfma_f32_16x16x32_bf16 a[84:87], a[204:207], v[224:227], a[84:87]
    ds_read_b64_tr_b16 a[220:221], v12 offset:49152
    v_mfma_f32_16x16x32_bf16 a[88:91], a[200:203], v[228:231], a[88:91]
    ds_read_b64_tr_b16 a[222:223], v12 offset:53248
    v_mfma_f32_16x16x32_bf16 a[88:91], a[204:207], v[232:235], a[88:91]
    v_mfma_f32_16x16x32_bf16 a[92:95], a[200:203], v[236:239], a[92:95]
    v_mfma_f32_16x16x32_bf16 a[92:95], a[204:207], v[240:243], a[92:95]
    v_smfmac_f32_16x16x64_bf16 a[232:235], v[244:247], v[228:235], v248
    s_waitcnt lgkmcnt(4)
    v_mfma_f32_16x16x32_bf16 a[96:99], a[208:211], v[212:215], a[96:99]
    v_mfma_f32_16x16x32_bf16 a[96:99], a[212:215], v[216:219], a[96:99]
    v_mfma_f32_16x16x32_bf16 a[100:103], a[208:211], v[220:223], a[100:103]
    v_mfma_f32_16x16x32_bf16 a[100:103], a[212:215], v[224:227], a[100:103]
    v_mfma_f32_16x16x32_bf16 a[104:107], a[208:211], v[228:231], a[104:107]
    v_mfma_f32_16x16x32_bf16 a[104:107], a[212:215], v[232:235], a[104:107]
    v_mfma_f32_16x16x32_bf16 a[108:111], a[208:211], v[236:239], a[108:111]
    v_mfma_f32_16x16x32_bf16 a[108:111], a[212:215], v[240:243], a[108:111]
    s_waitcnt lgkmcnt(0)
    v_mfma_f32_16x16x32_bf16 a[112:115], a[216:219], v[212:215], a[112:115]
    v_mfma_f32_16x16x32_bf16 a[112:115], a[220:223], v[216:219], a[112:115]
    v_mfma_f32_16x16x32_bf16 a[116:119], a[216:219], v[220:223], a[116:119]
    v_mfma_f32_16x16x32_bf16 a[116:119], a[220:223], v[224:227], a[116:119]
    v_mfma_f32_16x16x32_bf16 a[120:123], a[216:219], v[228:231], a[120:123]
    v_mfma_f32_16x16x32_bf16 a[120:123], a[220:223], v[232:235], a[120:123]
    v_mfma_f32_16x16x32_bf16 a[124:127], a[216:219], v[236:239], a[124:127]
    v_mfma_f32_16x16x32_bf16 a[124:127], a[220:223], v[240:243], a[124:127]
    v_smfmac_f32_16x16x64_bf16 a[236:239], v[244:247], v[236:243], v248
    s_nop 11
    v_accvgpr_read_b32 v20, a225
    v_accvgpr_read_b32 v21, a229
    v_accvgpr_read_b32 v22, a233
    v_accvgpr_read_b32 v23, a237
    v_accvgpr_read_b32 v24, a224
    v_accvgpr_read_b32 v25, a228
    v_accvgpr_read_b32 v26, a232
    v_accvgpr_read_b32 v27, a236
    v_add_f32 v20, v20, v24
    v_add_f32 v21, v21, v25
    v_add_f32 v22, v22, v26
    v_add_f32 v23, v23, v27
    v_rcp_f32 v24, v20
    v_rcp_f32 v26, v21
    v_rcp_f32 v28, v22
    v_rcp_f32 v30, v23
    v_lshlrev_b32 v32, 4, v19
    v_mov_b32 v25, v24
    v_mov_b32 v27, v26
    v_mov_b32 v29, v28
    v_mov_b32 v31, v30
    s_mov_b32 s40, 0
    v_accvgpr_read_b32 v116, a0
    v_accvgpr_read_b32 v117, a1
    v_accvgpr_read_b32 v118, a2
    v_accvgpr_read_b32 v119, a3
    v_accvgpr_read_b32 v120, a16
    v_accvgpr_read_b32 v121, a17
    v_accvgpr_read_b32 v122, a18
    v_accvgpr_read_b32 v123, a19
    v_pk_mul_f32 v[116:117], v[116:117], v[24:25]
    v_pk_mul_f32 v[118:119], v[118:119], v[24:25]
    v_pk_mul_f32 v[120:121], v[120:121], v[24:25]
    v_pk_mul_f32 v[122:123], v[122:123], v[24:25]
    v_cvt_pk_bf16_f32 v36, v116, v117
    v_cvt_pk_bf16_f32 v37, v118, v119
    v_cvt_pk_bf16_f32 v38, v120, v121
    v_cvt_pk_bf16_f32 v39, v122, v123
    buffer_store_dwordx4 v[36:39], v32, s[24:27], s40 offen offset:0
    v_accvgpr_read_b32 v124, a4
    v_accvgpr_read_b32 v125, a5
    v_accvgpr_read_b32 v126, a6
    v_accvgpr_read_b32 v127, a7
    v_accvgpr_read_b32 v128, a20
    v_accvgpr_read_b32 v129, a21
    v_accvgpr_read_b32 v130, a22
    v_accvgpr_read_b32 v131, a23
    v_pk_mul_f32 v[124:125], v[124:125], v[26:27]
    v_pk_mul_f32 v[126:127], v[126:127], v[26:27]
    v_pk_mul_f32 v[128:129], v[128:129], v[26:27]
    v_pk_mul_f32 v[130:131], v[130:131], v[26:27]
    v_cvt_pk_bf16_f32 v40, v124, v125
    v_cvt_pk_bf16_f32 v41, v126, v127
    v_cvt_pk_bf16_f32 v42, v128, v129
    v_cvt_pk_bf16_f32 v43, v130, v131
    buffer_store_dwordx4 v[40:43], v32, s[24:27], s40 offen offset:1024
    v_accvgpr_read_b32 v132, a8
    v_accvgpr_read_b32 v133, a9
    v_accvgpr_read_b32 v134, a10
    v_accvgpr_read_b32 v135, a11
    v_accvgpr_read_b32 v136, a24
    v_accvgpr_read_b32 v137, a25
    v_accvgpr_read_b32 v138, a26
    v_accvgpr_read_b32 v139, a27
    v_pk_mul_f32 v[132:133], v[132:133], v[28:29]
    v_pk_mul_f32 v[134:135], v[134:135], v[28:29]
    v_pk_mul_f32 v[136:137], v[136:137], v[28:29]
    v_pk_mul_f32 v[138:139], v[138:139], v[28:29]
    v_cvt_pk_bf16_f32 v44, v132, v133
    v_cvt_pk_bf16_f32 v45, v134, v135
    v_cvt_pk_bf16_f32 v46, v136, v137
    v_cvt_pk_bf16_f32 v47, v138, v139
    buffer_store_dwordx4 v[44:47], v32, s[24:27], s40 offen offset:2048
    v_accvgpr_read_b32 v140, a12
    v_accvgpr_read_b32 v141, a13
    v_accvgpr_read_b32 v142, a14
    v_accvgpr_read_b32 v143, a15
    v_accvgpr_read_b32 v144, a28
    v_accvgpr_read_b32 v145, a29
    v_accvgpr_read_b32 v146, a30
    v_accvgpr_read_b32 v147, a31
    v_pk_mul_f32 v[140:141], v[140:141], v[30:31]
    v_pk_mul_f32 v[142:143], v[142:143], v[30:31]
    v_pk_mul_f32 v[144:145], v[144:145], v[30:31]
    v_pk_mul_f32 v[146:147], v[146:147], v[30:31]
    v_cvt_pk_bf16_f32 v48, v140, v141
    v_cvt_pk_bf16_f32 v49, v142, v143
    v_cvt_pk_bf16_f32 v50, v144, v145
    v_cvt_pk_bf16_f32 v51, v146, v147
    buffer_store_dwordx4 v[48:51], v32, s[24:27], s40 offen offset:3072
    s_mov_b32 s40, 4096
    v_accvgpr_read_b32 v116, a32
    v_accvgpr_read_b32 v117, a33
    v_accvgpr_read_b32 v118, a34
    v_accvgpr_read_b32 v119, a35
    v_accvgpr_read_b32 v120, a48
    v_accvgpr_read_b32 v121, a49
    v_accvgpr_read_b32 v122, a50
    v_accvgpr_read_b32 v123, a51
    v_pk_mul_f32 v[116:117], v[116:117], v[24:25]
    v_pk_mul_f32 v[118:119], v[118:119], v[24:25]
    v_pk_mul_f32 v[120:121], v[120:121], v[24:25]
    v_pk_mul_f32 v[122:123], v[122:123], v[24:25]
    v_cvt_pk_bf16_f32 v36, v116, v117
    v_cvt_pk_bf16_f32 v37, v118, v119
    v_cvt_pk_bf16_f32 v38, v120, v121
    v_cvt_pk_bf16_f32 v39, v122, v123
    buffer_store_dwordx4 v[36:39], v32, s[24:27], s40 offen offset:0
    v_accvgpr_read_b32 v124, a36
    v_accvgpr_read_b32 v125, a37
    v_accvgpr_read_b32 v126, a38
    v_accvgpr_read_b32 v127, a39
    v_accvgpr_read_b32 v128, a52
    v_accvgpr_read_b32 v129, a53
    v_accvgpr_read_b32 v130, a54
    v_accvgpr_read_b32 v131, a55
    v_pk_mul_f32 v[124:125], v[124:125], v[26:27]
    v_pk_mul_f32 v[126:127], v[126:127], v[26:27]
    v_pk_mul_f32 v[128:129], v[128:129], v[26:27]
    v_pk_mul_f32 v[130:131], v[130:131], v[26:27]
    v_cvt_pk_bf16_f32 v40, v124, v125
    v_cvt_pk_bf16_f32 v41, v126, v127
    v_cvt_pk_bf16_f32 v42, v128, v129
    v_cvt_pk_bf16_f32 v43, v130, v131
    buffer_store_dwordx4 v[40:43], v32, s[24:27], s40 offen offset:1024
    v_accvgpr_read_b32 v132, a40
    v_accvgpr_read_b32 v133, a41
    v_accvgpr_read_b32 v134, a42
    v_accvgpr_read_b32 v135, a43
    v_accvgpr_read_b32 v136, a56
    v_accvgpr_read_b32 v137, a57
    v_accvgpr_read_b32 v138, a58
    v_accvgpr_read_b32 v139, a59
    v_pk_mul_f32 v[132:133], v[132:133], v[28:29]
    v_pk_mul_f32 v[134:135], v[134:135], v[28:29]
    v_pk_mul_f32 v[136:137], v[136:137], v[28:29]
    v_pk_mul_f32 v[138:139], v[138:139], v[28:29]
    v_cvt_pk_bf16_f32 v44, v132, v133
    v_cvt_pk_bf16_f32 v45, v134, v135
    v_cvt_pk_bf16_f32 v46, v136, v137
    v_cvt_pk_bf16_f32 v47, v138, v139
    buffer_store_dwordx4 v[44:47], v32, s[24:27], s40 offen offset:2048
    v_accvgpr_read_b32 v140, a44
    v_accvgpr_read_b32 v141, a45
    v_accvgpr_read_b32 v142, a46
    v_accvgpr_read_b32 v143, a47
    v_accvgpr_read_b32 v144, a60
    v_accvgpr_read_b32 v145, a61
    v_accvgpr_read_b32 v146, a62
    v_accvgpr_read_b32 v147, a63
    v_pk_mul_f32 v[140:141], v[140:141], v[30:31]
    v_pk_mul_f32 v[142:143], v[142:143], v[30:31]
    v_pk_mul_f32 v[144:145], v[144:145], v[30:31]
    v_pk_mul_f32 v[146:147], v[146:147], v[30:31]
    v_cvt_pk_bf16_f32 v48, v140, v141
    v_cvt_pk_bf16_f32 v49, v142, v143
    v_cvt_pk_bf16_f32 v50, v144, v145
    v_cvt_pk_bf16_f32 v51, v146, v147
    buffer_store_dwordx4 v[48:51], v32, s[24:27], s40 offen offset:3072
    s_mov_b32 s40, 8192
    v_accvgpr_read_b32 v116, a64
    v_accvgpr_read_b32 v117, a65
    v_accvgpr_read_b32 v118, a66
    v_accvgpr_read_b32 v119, a67
    v_accvgpr_read_b32 v120, a80
    v_accvgpr_read_b32 v121, a81
    v_accvgpr_read_b32 v122, a82
    v_accvgpr_read_b32 v123, a83
    v_pk_mul_f32 v[116:117], v[116:117], v[24:25]
    v_pk_mul_f32 v[118:119], v[118:119], v[24:25]
    v_pk_mul_f32 v[120:121], v[120:121], v[24:25]
    v_pk_mul_f32 v[122:123], v[122:123], v[24:25]
    v_cvt_pk_bf16_f32 v36, v116, v117
    v_cvt_pk_bf16_f32 v37, v118, v119
    v_cvt_pk_bf16_f32 v38, v120, v121
    v_cvt_pk_bf16_f32 v39, v122, v123
    buffer_store_dwordx4 v[36:39], v32, s[24:27], s40 offen offset:0
    v_accvgpr_read_b32 v124, a68
    v_accvgpr_read_b32 v125, a69
    v_accvgpr_read_b32 v126, a70
    v_accvgpr_read_b32 v127, a71
    v_accvgpr_read_b32 v128, a84
    v_accvgpr_read_b32 v129, a85
    v_accvgpr_read_b32 v130, a86
    v_accvgpr_read_b32 v131, a87
    v_pk_mul_f32 v[124:125], v[124:125], v[26:27]
    v_pk_mul_f32 v[126:127], v[126:127], v[26:27]
    v_pk_mul_f32 v[128:129], v[128:129], v[26:27]
    v_pk_mul_f32 v[130:131], v[130:131], v[26:27]
    v_cvt_pk_bf16_f32 v40, v124, v125
    v_cvt_pk_bf16_f32 v41, v126, v127
    v_cvt_pk_bf16_f32 v42, v128, v129
    v_cvt_pk_bf16_f32 v43, v130, v131
    buffer_store_dwordx4 v[40:43], v32, s[24:27], s40 offen offset:1024
    v_accvgpr_read_b32 v132, a72
    v_accvgpr_read_b32 v133, a73
    v_accvgpr_read_b32 v134, a74
    v_accvgpr_read_b32 v135, a75
    v_accvgpr_read_b32 v136, a88
    v_accvgpr_read_b32 v137, a89
    v_accvgpr_read_b32 v138, a90
    v_accvgpr_read_b32 v139, a91
    v_pk_mul_f32 v[132:133], v[132:133], v[28:29]
    v_pk_mul_f32 v[134:135], v[134:135], v[28:29]
    v_pk_mul_f32 v[136:137], v[136:137], v[28:29]
    v_pk_mul_f32 v[138:139], v[138:139], v[28:29]
    v_cvt_pk_bf16_f32 v44, v132, v133
    v_cvt_pk_bf16_f32 v45, v134, v135
    v_cvt_pk_bf16_f32 v46, v136, v137
    v_cvt_pk_bf16_f32 v47, v138, v139
    buffer_store_dwordx4 v[44:47], v32, s[24:27], s40 offen offset:2048
    v_accvgpr_read_b32 v140, a76
    v_accvgpr_read_b32 v141, a77
    v_accvgpr_read_b32 v142, a78
    v_accvgpr_read_b32 v143, a79
    v_accvgpr_read_b32 v144, a92
    v_accvgpr_read_b32 v145, a93
    v_accvgpr_read_b32 v146, a94
    v_accvgpr_read_b32 v147, a95
    v_pk_mul_f32 v[140:141], v[140:141], v[30:31]
    v_pk_mul_f32 v[142:143], v[142:143], v[30:31]
    v_pk_mul_f32 v[144:145], v[144:145], v[30:31]
    v_pk_mul_f32 v[146:147], v[146:147], v[30:31]
    v_cvt_pk_bf16_f32 v48, v140, v141
    v_cvt_pk_bf16_f32 v49, v142, v143
    v_cvt_pk_bf16_f32 v50, v144, v145
    v_cvt_pk_bf16_f32 v51, v146, v147
    buffer_store_dwordx4 v[48:51], v32, s[24:27], s40 offen offset:3072
    s_mov_b32 s40, 12288
    v_accvgpr_read_b32 v116, a96
    v_accvgpr_read_b32 v117, a97
    v_accvgpr_read_b32 v118, a98
    v_accvgpr_read_b32 v119, a99
    v_accvgpr_read_b32 v120, a112
    v_accvgpr_read_b32 v121, a113
    v_accvgpr_read_b32 v122, a114
    v_accvgpr_read_b32 v123, a115
    v_pk_mul_f32 v[116:117], v[116:117], v[24:25]
    v_pk_mul_f32 v[118:119], v[118:119], v[24:25]
    v_pk_mul_f32 v[120:121], v[120:121], v[24:25]
    v_pk_mul_f32 v[122:123], v[122:123], v[24:25]
    v_cvt_pk_bf16_f32 v36, v116, v117
    v_cvt_pk_bf16_f32 v37, v118, v119
    v_cvt_pk_bf16_f32 v38, v120, v121
    v_cvt_pk_bf16_f32 v39, v122, v123
    buffer_store_dwordx4 v[36:39], v32, s[24:27], s40 offen offset:0
    v_accvgpr_read_b32 v124, a100
    v_accvgpr_read_b32 v125, a101
    v_accvgpr_read_b32 v126, a102
    v_accvgpr_read_b32 v127, a103
    v_accvgpr_read_b32 v128, a116
    v_accvgpr_read_b32 v129, a117
    v_accvgpr_read_b32 v130, a118
    v_accvgpr_read_b32 v131, a119
    v_pk_mul_f32 v[124:125], v[124:125], v[26:27]
    v_pk_mul_f32 v[126:127], v[126:127], v[26:27]
    v_pk_mul_f32 v[128:129], v[128:129], v[26:27]
    v_pk_mul_f32 v[130:131], v[130:131], v[26:27]
    v_cvt_pk_bf16_f32 v40, v124, v125
    v_cvt_pk_bf16_f32 v41, v126, v127
    v_cvt_pk_bf16_f32 v42, v128, v129
    v_cvt_pk_bf16_f32 v43, v130, v131
    buffer_store_dwordx4 v[40:43], v32, s[24:27], s40 offen offset:1024
    v_accvgpr_read_b32 v132, a104
    v_accvgpr_read_b32 v133, a105
    v_accvgpr_read_b32 v134, a106
    v_accvgpr_read_b32 v135, a107
    v_accvgpr_read_b32 v136, a120
    v_accvgpr_read_b32 v137, a121
    v_accvgpr_read_b32 v138, a122
    v_accvgpr_read_b32 v139, a123
    v_pk_mul_f32 v[132:133], v[132:133], v[28:29]
    v_pk_mul_f32 v[134:135], v[134:135], v[28:29]
    v_pk_mul_f32 v[136:137], v[136:137], v[28:29]
    v_pk_mul_f32 v[138:139], v[138:139], v[28:29]
    v_cvt_pk_bf16_f32 v44, v132, v133
    v_cvt_pk_bf16_f32 v45, v134, v135
    v_cvt_pk_bf16_f32 v46, v136, v137
    v_cvt_pk_bf16_f32 v47, v138, v139
    buffer_store_dwordx4 v[44:47], v32, s[24:27], s40 offen offset:2048
    v_accvgpr_read_b32 v140, a108
    v_accvgpr_read_b32 v141, a109
    v_accvgpr_read_b32 v142, a110
    v_accvgpr_read_b32 v143, a111
    v_accvgpr_read_b32 v144, a124
    v_accvgpr_read_b32 v145, a125
    v_accvgpr_read_b32 v146, a126
    v_accvgpr_read_b32 v147, a127
    v_pk_mul_f32 v[140:141], v[140:141], v[30:31]
    v_pk_mul_f32 v[142:143], v[142:143], v[30:31]
    v_pk_mul_f32 v[144:145], v[144:145], v[30:31]
    v_pk_mul_f32 v[146:147], v[146:147], v[30:31]
    v_cvt_pk_bf16_f32 v48, v140, v141
    v_cvt_pk_bf16_f32 v49, v142, v143
    v_cvt_pk_bf16_f32 v50, v144, v145
    v_cvt_pk_bf16_f32 v51, v146, v147
    buffer_store_dwordx4 v[48:51], v32, s[24:27], s40 offen offset:3072
L_attn_end:
    s_endpgm

.p2align 8
.type ffn_kernel,@function
ffn_kernel:
    s_cmp_ge_u32 s2, 216
    s_cbranch_scc1 L_ffn_end
    s_load_dwordx2 s[40:41], s[0:1], 0
    s_load_dwordx2 s[42:43], s[0:1], 56
    s_load_dwordx4 s[44:47], s[0:1], 64
    s_load_dwordx2 s[48:49], s[0:1], 96
    v_lshrrev_b32 v2, 6, v0
    v_and_b32 v1, 63, v0
    s_nop 0
    v_readfirstlane_b32 s5, v2
    s_waitcnt lgkmcnt(0)
    s_mov_b32 s8, s40
    s_mov_b32 s9, s41
    s_mov_b32 s10, 0x280000
    s_mov_b32 s11, 0x20000
    s_mov_b32 s12, s42
    s_mov_b32 s13, s43
    s_mov_b32 s14, 0x21c000
    s_mov_b32 s15, 0x20000
    s_mov_b32 s16, s44
    s_mov_b32 s17, s45
    s_mov_b32 s18, 0x21c000
    s_mov_b32 s19, 0x20000
    s_mov_b32 s20, s46
    s_mov_b32 s21, s47
    s_mov_b32 s22, 0x21c000
    s_mov_b32 s23, 0x20000
    s_mov_b32 s24, s48
    s_mov_b32 s25, s49
    s_mov_b32 s26, 0x2000000
    s_mov_b32 s27, 0x20000
    s_lshl_b32 s30, s5, 11
    s_add_u32 s30, s30, 0x288000
    v_lshlrev_b32 v12, 4, v1
    buffer_load_dwordx4 v[4:7], v12, s[24:27], s30 offen offset:0
    buffer_load_dwordx4 v[8:11], v12, s[24:27], s30 offen offset:1024
    v_mul_u32_u24 v24, 3456, v1
    s_lshl_b32 s30, s2, 4
    v_add_u32 v24, s30, v24
    v_lshlrev_b32 v25, 4, v1
    s_and_b32 s30, s5, 1
    s_mul_i32 s31, s30, 1105920
    s_mul_i32 s30, s5, 5120
    s_add_u32 s30, s30, 0
    s_cmp_ge_u32 s5, 2
    s_cselect_b32 s12, s16, s12
    s_cselect_b32 s13, s17, s13
    s_add_u32 m0, s30, 0
    s_add_u32 s32, s31, 0
    buffer_load_dwordx4 v24, s[12:15], s32 offen lds
    s_add_u32 m0, s30, 1024
    s_add_u32 s32, s31, 221184
    buffer_load_dwordx4 v24, s[12:15], s32 offen lds
    s_add_u32 m0, s30, 2048
    s_add_u32 s32, s31, 442368
    buffer_load_dwordx4 v24, s[12:15], s32 offen lds
    s_add_u32 m0, s30, 3072
    s_add_u32 s32, s31, 663552
    buffer_load_dwordx4 v24, s[12:15], s32 offen lds
    s_add_u32 m0, s30, 4096
    s_add_u32 s32, s31, 884736
    buffer_load_dwordx4 v24, s[12:15], s32 offen lds
    s_mul_i32 s30, s5, 3072
    s_mul_i32 s31, s2, 10240
    s_add_u32 m0, s30, 20480
    s_add_u32 s31, s31, s30
    buffer_load_dwordx4 v25, s[20:23], s31 offen offset:0 lds
    buffer_load_dwordx4 v25, s[20:23], s31 offen offset:1024 lds
    buffer_load_dwordx4 v25, s[20:23], s31 offen offset:2048 lds
    s_waitcnt vmcnt(8)
    s_mov_b32 s30, -1
    v_sub_u32 v12, s30, v4
    v_sub_u32 v13, s30, v5
    v_sub_u32 v14, s30, v6
    v_sub_u32 v15, s30, v7
    v_sub_u32 v16, s30, v8
    v_sub_u32 v17, s30, v9
    v_sub_u32 v18, s30, v10
    v_sub_u32 v19, s30, v11
    v_min3_u32 v12, v12, v13, v14
    v_min3_u32 v12, v12, v15, v16
    v_min3_u32 v12, v12, v17, v18
    v_min_u32 v12, v12, v19
    s_nop 1
    v_min_u32_dpp v12, v12, v12 row_shr:1 row_mask:0xf bank_mask:0xf
    s_nop 1
    v_min_u32_dpp v12, v12, v12 row_shr:2 row_mask:0xf bank_mask:0xf
    s_nop 1
    v_min_u32_dpp v12, v12, v12 row_shr:4 row_mask:0xf bank_mask:0xf
    s_nop 1
    v_min_u32_dpp v12, v12, v12 row_shr:8 row_mask:0xf bank_mask:0xf
    s_nop 1
    v_min_u32_dpp v12, v12, v12 row_bcast:15 row_mask:0xa bank_mask:0xf
    s_nop 1
    v_min_u32_dpp v12, v12, v12 row_bcast:31 row_mask:0xc bank_mask:0xf
    s_nop 0
    v_readlane_b32 s56, v12, 63
    s_nop 0
    s_sub_u32 s56, s30, s56
    s_sub_u32 s30, s56, 1
    v_sub_u32 v12, s30, v4
    v_sub_u32 v13, s30, v5
    v_sub_u32 v14, s30, v6
    v_sub_u32 v15, s30, v7
    v_sub_u32 v16, s30, v8
    v_sub_u32 v17, s30, v9
    v_sub_u32 v18, s30, v10
    v_sub_u32 v19, s30, v11
    v_min3_u32 v12, v12, v13, v14
    v_min3_u32 v12, v12, v15, v16
    v_min3_u32 v12, v12, v17, v18
    v_min_u32 v12, v12, v19
    s_nop 1
    v_min_u32_dpp v12, v12, v12 row_shr:1 row_mask:0xf bank_mask:0xf
    s_nop 1
    v_min_u32_dpp v12, v12, v12 row_shr:2 row_mask:0xf bank_mask:0xf
    s_nop 1
    v_min_u32_dpp v12, v12, v12 row_shr:4 row_mask:0xf bank_mask:0xf
    s_nop 1
    v_min_u32_dpp v12, v12, v12 row_shr:8 row_mask:0xf bank_mask:0xf
    s_nop 1
    v_min_u32_dpp v12, v12, v12 row_bcast:15 row_mask:0xa bank_mask:0xf
    s_nop 1
    v_min_u32_dpp v12, v12, v12 row_bcast:31 row_mask:0xc bank_mask:0xf
    s_nop 0
    v_readlane_b32 s57, v12, 63
    s_nop 0
    s_sub_u32 s57, s30, s57
    s_sub_u32 s30, s57, 1
    v_sub_u32 v12, s30, v4
    v_sub_u32 v13, s30, v5
    v_sub_u32 v14, s30, v6
    v_sub_u32 v15, s30, v7
    v_sub_u32 v16, s30, v8
    v_sub_u32 v17, s30, v9
    v_sub_u32 v18, s30, v10
    v_sub_u32 v19, s30, v11
    v_min3_u32 v12, v12, v13, v14
    v_min3_u32 v12, v12, v15, v16
    v_min3_u32 v12, v12, v17, v18
    v_min_u32 v12, v12, v19
    s_nop 1
    v_min_u32_dpp v12, v12, v12 row_shr:1 row_mask:0xf bank_mask:0xf
    s_nop 1
    v_min_u32_dpp v12, v12, v12 row_shr:2 row_mask:0xf bank_mask:0xf
    s_nop 1
    v_min_u32_dpp v12, v12, v12 row_shr:4 row_mask:0xf bank_mask:0xf
    s_nop 1
    v_min_u32_dpp v12, v12, v12 row_shr:8 row_mask:0xf bank_mask:0xf
    s_nop 1
    v_min_u32_dpp v12, v12, v12 row_bcast:15 row_mask:0xa bank_mask:0xf
    s_nop 1
    v_min_u32_dpp v12, v12, v12 row_bcast:31 row_mask:0xc bank_mask:0xf
    s_nop 0
    v_readlane_b32 s58, v12, 63
    s_nop 0
    s_sub_u32 s58, s30, s58
    s_sub_u32 s30, s58, 1
    v_sub_u32 v12, s30, v4
    v_sub_u32 v13, s30, v5
    v_sub_u32 v14, s30, v6
    v_sub_u32 v15, s30, v7
    v_sub_u32 v16, s30, v8
    v_sub_u32 v17, s30, v9
    v_sub_u32 v18, s30, v10
    v_sub_u32 v19, s30, v11
    v_min3_u32 v12, v12, v13, v14
    v_min3_u32 v12, v12, v15, v16
    v_min3_u32 v12, v12, v17, v18
    v_min_u32 v12, v12, v19
    s_nop 1
    v_min_u32_dpp v12, v12, v12 row_shr:1 row_mask:0xf bank_mask:0xf
    s_nop 1
    v_min_u32_dpp v12, v12, v12 row_shr:2 row_mask:0xf bank_mask:0xf
    s_nop 1
    v_min_u32_dpp v12, v12, v12 row_shr:4 row_mask:0xf bank_mask:0xf
    s_nop 1
    v_min_u32_dpp v12, v12, v12 row_shr:8 row_mask:0xf bank_mask:0xf
    s_nop 1
    v_min_u32_dpp v12, v12, v12 row_bcast:15 row_mask:0xa bank_mask:0xf
    s_nop 1
    v_min_u32_dpp v12, v12, v12 row_bcast:31 row_mask:0xc bank_mask:0xf
    s_nop 0
    v_readlane_b32 s59, v12, 63
    s_nop 0
    s_sub_u32 s59, s30, s59
    s_sub_u32 s30, s59, 1
    v_sub_u32 v12, s30, v4
    v_sub_u32 v13, s30, v5
    v_sub_u32 v14, s30, v6
    v_sub_u32 v15, s30, v7
    v_sub_u32 v16, s30, v8
    v_sub_u32 v17, s30, v9
    v_sub_u32 v18, s30, v10
    v_sub_u32 v19, s30, v11
    v_min3_u32 v12, v12, v13, v14
    v_min3_u32 v12, v12, v15, v16
    v_min3_u32 v12, v12, v17, v18
    v_min_u32 v12, v12, v19
    s_nop 1
    v_min_u32_dpp v12, v12, v12 row_shr:1 row_mask:0xf bank_mask:0xf
    s_nop 1
    v_min_u32_dpp v12, v12, v12 row_shr:2 row_mask:0xf bank_mask:0xf
    s_nop 1
    v_min_u32_dpp v12, v12, v12 row_shr:4 row_mask:0xf bank_mask:0xf
    s_nop 1
    v_min_u32_dpp v12, v12, v12 row_shr:8 row_mask:0xf bank_mask:0xf
    s_nop 1
    v_min_u32_dpp v12, v12, v12 row_bcast:15 row_mask:0xa bank_mask:0xf
    s_nop 1
    v_min_u32_dpp v12, v12, v12 row_bcast:31 row_mask:0xc bank_mask:0xf
    s_nop 0
    v_readlane_b32 s60, v12, 63
    s_nop 0
    s_sub_u32 s60, s30, s60
    s_sub_u32 s30, s60, 1
    v_sub_u32 v12, s30, v4
    v_sub_u32 v13, s30, v5
    v_sub_u32 v14, s30, v6
    v_sub_u32 v15, s30, v7
    v_sub_u32 v16, s30, v8
    v_sub_u32 v17, s30, v9
    v_sub_u32 v18, s30, v10
    v_sub_u32 v19, s30, v11
    v_min3_u32 v12, v12, v13, v14
    v_min3_u32 v12, v12, v15, v16
    v_min3_u32 v12, v12, v17, v18
    v_min_u32 v12, v12, v19
    s_nop 1
    v_min_u32_dpp v12, v12, v12 row_shr:1 row_mask:0xf bank_mask:0xf
    s_nop 1
    v_min_u32_dpp v12, v12, v12 row_shr:2 row_mask:0xf bank_mask:0xf
    s_nop 1
    v_min_u32_dpp v12, v12, v12 row_shr:4 row_mask:0xf bank_mask:0xf
    s_nop 1
    v_min_u32_dpp v12, v12, v12 row_shr:8 row_mask:0xf bank_mask:0xf
    s_nop 1
    v_min_u32_dpp v12, v12, v12 row_bcast:15 row_mask:0xa bank_mask:0xf
    s_nop 1
    v_min_u32_dpp v12, v12, v12 row_bcast:31 row_mask:0xc bank_mask:0xf
    s_nop 0
    v_readlane_b32 s61, v12, 63
    s_nop 0
    s_sub_u32 s61, s30, s61
    s_sub_u32 s30, s61, 1
    v_sub_u32 v12, s30, v4
    v_sub_u32 v13, s30, v5
    v_sub_u32 v14, s30, v6
    v_sub_u32 v15, s30, v7
    v_sub_u32 v16, s30, v8
    v_sub_u32 v17, s30, v9
    v_sub_u32 v18, s30, v10
    v_sub_u32 v19, s30, v11
    v_min3_u32 v12, v12, v13, v14
    v_min3_u32 v12, v12, v15, v16
    v_min3_u32 v12, v12, v17, v18
    v_min_u32 v12, v12, v19
    s_nop 1
    v_min_u32_dpp v12, v12, v12 row_shr:1 row_mask:0xf bank_mask:0xf
    s_nop 1
    v_min_u32_dpp v12, v12, v12 row_shr:2 row_mask:0xf bank_mask:0xf
    s_nop 1
    v_min_u32_dpp v12, v12, v12 row_shr:4 row_mask:0xf bank_mask:0xf
    s_nop 1
    v_min_u32_dpp v12, v12, v12 row_shr:8 row_mask:0xf bank_mask:0xf
    s_nop 1
    v_min_u32_dpp v12, v12, v12 row_bcast:15 row_mask:0xa bank_mask:0xf
    s_nop 1
    v_min_u32_dpp v12, v12, v12 row_bcast:31 row_mask:0xc bank_mask:0xf
    s_nop 0
    v_readlane_b32 s62, v12, 63
    s_nop 0
    s_sub_u32 s62, s30, s62
    s_sub_u32 s30, s62, 1
    v_sub_u32 v12, s30, v4
    v_sub_u32 v13, s30, v5
    v_sub_u32 v14, s30, v6
    v_sub_u32 v15, s30, v7
    v_sub_u32 v16, s30, v8
    v_sub_u32 v17, s30, v9
    v_sub_u32 v18, s30, v10
    v_sub_u32 v19, s30, v11
    v_min3_u32 v12, v12, v13, v14
    v_min3_u32 v12, v12, v15, v16
    v_min3_u32 v12, v12, v17, v18
    v_min_u32 v12, v12, v19
    s_nop 1
    v_min_u32_dpp v12, v12, v12 row_shr:1 row_mask:0xf bank_mask:0xf
    s_nop 1
    v_min_u32_dpp v12, v12, v12 row_shr:2 row_mask:0xf bank_mask:0xf
    s_nop 1
    v_min_u32_dpp v12, v12, v12 row_shr:4 row_mask:0xf bank_mask:0xf
    s_nop 1
    v_min_u32_dpp v12, v12, v12 row_shr:8 row_mask:0xf bank_mask:0xf
    s_nop 1
    v_min_u32_dpp v12, v12, v12 row_bcast:15 row_mask:0xa bank_mask:0xf
    s_nop 1
    v_min_u32_dpp v12, v12, v12 row_bcast:31 row_mask:0xc bank_mask:0xf
    s_nop 0
    v_readlane_b32 s63, v12, 63
    s_nop 0
    s_sub_u32 s63, s30, s63
    s_sub_u32 s30, s63, 1
    v_mov_b32 v4, s56
    v_writelane_b32 v4, s57, 1
    v_writelane_b32 v4, s58, 2
    v_writelane_b32 v4, s59, 3
    v_writelane_b32 v4, s60, 4
    v_writelane_b32 v4, s61, 5
    v_writelane_b32 v4, s62, 6
    v_writelane_b32 v4, s63, 7
    s_lshl_b32 s30, s5, 5
    s_add_u32 s30, s30, 32768
    v_and_b32 v5, 7, v1
    v_lshl_add_u32 v5, v5, 2, s30
    s_mov_b64 exec, 0xff
    ds_write_b32 v5, v4
    s_mov_b64 exec, -1
    s_waitcnt vmcnt(0) lgkmcnt(0)
    s_barrier
    v_and_b32 v5, 31, v1
    v_lshlrev_b32 v5, 2, v5
    v_add_u32 v5, 32768, v5
    ds_read_b32 v4, v5
    s_waitcnt lgkmcnt(0)
    s_mov_b32 s30, -1
    v_sub_u32 v5, s30, v4
    s_nop 1
    v_min_u32_dpp v5, v5, v5 row_shr:1 row_mask:0xf bank_mask:0xf
    s_nop 1
    v_min_u32_dpp v5, v5, v5 row_shr:2 row_mask:0xf bank_mask:0xf
    s_nop 1
    v_min_u32_dpp v5, v5, v5 row_shr:4 row_mask:0xf bank_mask:0xf
    s_nop 1
    v_min_u32_dpp v5, v5, v5 row_shr:8 row_mask:0xf bank_mask:0xf
    s_nop 1
    v_min_u32_dpp v5, v5, v5 row_bcast:15 row_mask:0xa bank_mask:0xf
    s_nop 1
    v_min_u32_dpp v5, v5, v5 row_bcast:31 row_mask:0xc bank_mask:0xf
    s_nop 0
    v_readlane_b32 s56, v5, 63
    s_nop 0
    s_sub_u32 s56, s30, s56
    s_sub_u32 s30, s56, 1
    v_sub_u32 v5, s30, v4
    s_nop 1
    v_min_u32_dpp v5, v5, v5 row_shr:1 row_mask:0xf bank_mask:0xf
    s_nop 1
    v_min_u32_dpp v5, v5, v5 row_shr:2 row_mask:0xf bank_mask:0xf
    s_nop 1
    v_min_u32_dpp v5, v5, v5 row_shr:4 row_mask:0xf bank_mask:0xf
    s_nop 1
    v_min_u32_dpp v5, v5, v5 row_shr:8 row_mask:0xf bank_mask:0xf
    s_nop 1
    v_min_u32_dpp v5, v5, v5 row_bcast:15 row_mask:0xa bank_mask:0xf
    s_nop 1
    v_min_u32_dpp v5, v5, v5 row_bcast:31 row_mask:0xc bank_mask:0xf
    s_nop 0
    v_readlane_b32 s57, v5, 63
    s_nop 0
    s_sub_u32 s57, s30, s57
    s_sub_u32 s30, s57, 1
    v_sub_u32 v5, s30, v4
    s_nop 1
    v_min_u32_dpp v5, v5, v5 row_shr:1 row_mask:0xf bank_mask:0xf
    s_nop 1
    v_min_u32_dpp v5, v5, v5 row_shr:2 row_mask:0xf bank_mask:0xf
    s_nop 1
    v_min_u32_dpp v5, v5, v5 row_shr:4 row_mask:0xf bank_mask:0xf
    s_nop 1
    v_min_u32_dpp v5, v5, v5 row_shr:8 row_mask:0xf bank_mask:0xf
    s_nop 1
    v_min_u32_dpp v5, v5, v5 row_bcast:15 row_mask:0xa bank_mask:0xf
    s_nop 1
    v_min_u32_dpp v5, v5, v5 row_bcast:31 row_mask:0xc bank_mask:0xf
    s_nop 0
    v_readlane_b32 s58, v5, 63
    s_nop 0
    s_sub_u32 s58, s30, s58
    s_sub_u32 s30, s58, 1
    v_sub_u32 v5, s30, v4
    s_nop 1
    v_min_u32_dpp v5, v5, v5 row_shr:1 row_mask:0xf bank_mask:0xf
    s_nop 1
    v_min_u32_dpp v5, v5, v5 row_shr:2 row_mask:0xf bank_mask:0xf
    s_nop 1
    v_min_u32_dpp v5, v5, v5 row_shr:4 row_mask:0xf bank_mask:0xf
    s_nop 1
    v_min_u32_dpp v5, v5, v5 row_shr:8 row_mask:0xf bank_mask:0xf
    s_nop 1
    v_min_u32_dpp v5, v5, v5 row_bcast:15 row_mask:0xa bank_mask:0xf
    s_nop 1
    v_min_u32_dpp v5, v5, v5 row_bcast:31 row_mask:0xc bank_mask:0xf
    s_nop 0
    v_readlane_b32 s59, v5, 63
    s_nop 0
    s_sub_u32 s59, s30, s59
    s_sub_u32 s30, s59, 1
    v_sub_u32 v5, s30, v4
    s_nop 1
    v_min_u32_dpp v5, v5, v5 row_shr:1 row_mask:0xf bank_mask:0xf
    s_nop 1
    v_min_u32_dpp v5, v5, v5 row_shr:2 row_mask:0xf bank_mask:0xf
    s_nop 1
    v_min_u32_dpp v5, v5, v5 row_shr:4 row_mask:0xf bank_mask:0xf
    s_nop 1
    v_min_u32_dpp v5, v5, v5 row_shr:8 row_mask:0xf bank_mask:0xf
    s_nop 1
    v_min_u32_dpp v5, v5, v5 row_bcast:15 row_mask:0xa bank_mask:0xf
    s_nop 1
    v_min_u32_dpp v5, v5, v5 row_bcast:31 row_mask:0xc bank_mask:0xf
    s_nop 0
    v_readlane_b32 s60, v5, 63
    s_nop 0
    s_sub_u32 s60, s30, s60
    s_sub_u32 s30, s60, 1
    v_sub_u32 v5, s30, v4
    s_nop 1
    v_min_u32_dpp v5, v5, v5 row_shr:1 row_mask:0xf bank_mask:0xf
    s_nop 1
    v_min_u32_dpp v5, v5, v5 row_shr:2 row_mask:0xf bank_mask:0xf
    s_nop 1
    v_min_u32_dpp v5, v5, v5 row_shr:4 row_mask:0xf bank_mask:0xf
    s_nop 1
    v_min_u32_dpp v5, v5, v5 row_shr:8 row_mask:0xf bank_mask:0xf
    s_nop 1
    v_min_u32_dpp v5, v5, v5 row_bcast:15 row_mask:0xa bank_mask:0xf
    s_nop 1
    v_min_u32_dpp v5, v5, v5 row_bcast:31 row_mask:0xc bank_mask:0xf
    s_nop 0
    v_readlane_b32 s61, v5, 63
    s_nop 0
    s_sub_u32 s61, s30, s61
    s_sub_u32 s30, s61, 1
    v_sub_u32 v5, s30, v4
    s_nop 1
    v_min_u32_dpp v5, v5, v5 row_shr:1 row_mask:0xf bank_mask:0xf
    s_nop 1
    v_min_u32_dpp v5, v5, v5 row_shr:2 row_mask:0xf bank_mask:0xf
    s_nop 1
    v_min_u32_dpp v5, v5, v5 row_shr:4 row_mask:0xf bank_mask:0xf
    s_nop 1
    v_min_u32_dpp v5, v5, v5 row_shr:8 row_mask:0xf bank_mask:0xf
    s_nop 1
    v_min_u32_dpp v5, v5, v5 row_bcast:15 row_mask:0xa bank_mask:0xf
    s_nop 1
    v_min_u32_dpp v5, v5, v5 row_bcast:31 row_mask:0xc bank_mask:0xf
    s_nop 0
    v_readlane_b32 s62, v5, 63
    s_nop 0
    s_sub_u32 s62, s30, s62
    s_sub_u32 s30, s62, 1
    v_sub_u32 v5, s30, v4
    s_nop 1
    v_min_u32_dpp v5, v5, v5 row_shr:1 row_mask:0xf bank_mask:0xf
    s_nop 1
    v_min_u32_dpp v5, v5, v5 row_shr:2 row_mask:0xf bank_mask:0xf
    s_nop 1
    v_min_u32_dpp v5, v5, v5 row_shr:4 row_mask:0xf bank_mask:0xf
    s_nop 1
    v_min_u32_dpp v5, v5, v5 row_shr:8 row_mask:0xf bank_mask:0xf
    s_nop 1
    v_min_u32_dpp v5, v5, v5 row_bcast:15 row_mask:0xa bank_mask:0xf
    s_nop 1
    v_min_u32_dpp v5, v5, v5 row_bcast:31 row_mask:0xc bank_mask:0xf
    s_nop 0
    v_readlane_b32 s63, v5, 63
    s_nop 0
    s_sub_u32 s63, s30, s63
    s_sub_u32 s30, s63, 1
    v_mov_b32 v26, s56
    v_writelane_b32 v26, s57, 1
    v_writelane_b32 v26, s58, 2
    v_writelane_b32 v26, s59, 3
    v_writelane_b32 v26, s60, 4
    v_writelane_b32 v26, s61, 5
    v_writelane_b32 v26, s62, 6
    v_writelane_b32 v26, s63, 7
    v_and_b32 v27, 7, v1
    v_lshlrev_b32 v27, 2, v27
    ds_bpermute_b32 v26, v27, v26
    v_lshrrev_b32 v27, 4, v1
    s_mul_i32 s30, s5, 320
    s_mov_b32 s31, 0x280000
    s_waitcnt lgkmcnt(0)
    v_not_b32 v26, v26
    v_and_b32 v26, 0x7ff, v26
    v_lshlrev_b32 v28, 3, v26
    v_mul_u32_u24 v26, 1280, v26
    v_lshl_add_u32 v26, v27, 4, v26
    buffer_load_dwordx2 v[24:25], v28, s[24:27], s31 offen
    buffer_load_dwordx4 v[4:7], v26, s[8:11], s30 offen offset:0
    buffer_load_dwordx4 v[8:11], v26, s[8:11], s30 offen offset:64
    buffer_load_dwordx4 v[12:15], v26, s[8:11], s30 offen offset:128
    buffer_load_dwordx4 v[16:19], v26, s[8:11], s30 offen offset:192
    buffer_load_dwordx4 v[20:23], v26, s[8:11], s30 offen offset:256
    v_lshrrev_b32 v26, 4, v1
    v_bfe_u32 v27, v1, 2, 2
    v_lshl_add_u32 v26, v26, 3, v27
    v_lshlrev_b32 v26, 4, v26
    v_and_b32 v27, 1, v1
    v_lshl_add_u32 v26, v27, 3, v26
    v_bfe_u32 v27, v1, 1, 1
    v_mul_u32_u24 v27, 10240, v27
    s_mul_i32 s30, s5, 2560
    s_add_u32 s30, s30, 0
    v_add3_u32 v26, v26, v27, s30
    ds_read_b64_tr_b16 v[32:33], v26 offset:0
    ds_read_b64_tr_b16 v[34:35], v26 offset:64
    ds_read_b64_tr_b16 v[36:37], v26 offset:512
    ds_read_b64_tr_b16 v[38:39], v26 offset:576
    ds_read_b64_tr_b16 v[40:41], v26 offset:1024
    ds_read_b64_tr_b16 v[42:43], v26 offset:1088
    ds_read_b64_tr_b16 v[44:45], v26 offset:1536
    ds_read_b64_tr_b16 v[46:47], v26 offset:1600
    ds_read_b64_tr_b16 v[48:49], v26 offset:2048
    ds_read_b64_tr_b16 v[50:51], v26 offset:2112
    v_and_b32 v27, 8, v1
    v_cmp_eq_u32 vcc, 0, v27
    v_mov_b32 v28, 0x3f803f80
    s_lshl_b32 s30, s5, 10
    v_lshlrev_b32 v29, 4, v1
    v_add_u32 v29, 33024, v29
    v_add_u32 v30, s30, v29
    s_waitcnt vmcnt(0)
    v_cndmask_b32 v4, v28, v4, vcc
    v_cndmask_b32 v5, v28, v5, vcc
    v_cndmask_b32 v6, v28, v6, vcc
    v_cndmask_b32 v7, v28, v7, vcc
    v_cndmask_b32 v8, v28, v8, vcc
    v_cndmask_b32 v9, v28, v9, vcc
    v_cndmask_b32 v10, v28, v10, vcc
    v_cndmask_b32 v11, v28, v11, vcc
    v_cndmask_b32 v12, v28, v12, vcc
    v_cndmask_b32 v13, v28, v13, vcc
    v_cndmask_b32 v14, v28, v14, vcc
    v_cndmask_b32 v15, v28, v15, vcc
    v_cndmask_b32 v16, v28, v16, vcc
    v_cndmask_b32 v17, v28, v17, vcc
    v_cndmask_b32 v18, v28, v18, vcc
    v_cndmask_b32 v19, v28, v19, vcc
    v_cndmask_b32 v20, v28, v20, vcc
    v_cndmask_b32 v21, v28, v21, vcc
    v_cndmask_b32 v22, v28, v22, vcc
    v_cndmask_b32 v23, v28, v23, vcc
    s_waitcnt lgkmcnt(0)
    s_nop 0
    v_mfma_f32_16x16x32_bf16 v[52:55], v[32:35], v[4:7], 0
    v_mfma_f32_16x16x32_bf16 v[52:55], v[36:39], v[8:11], v[52:55]
    v_mfma_f32_16x16x32_bf16 v[52:55], v[40:43], v[12:15], v[52:55]
    v_mfma_f32_16x16x32_bf16 v[52:55], v[44:47], v[16:19], v[52:55]
    v_mfma_f32_16x16x32_bf16 v[52:55], v[48:51], v[20:23], v[52:55]
    s_nop 7
    ds_write_b128 v30, v[52:55]
    s_waitcnt lgkmcnt(0)
    s_barrier
    ds_read_b128 v[4:7], v29 offset:0
    ds_read_b128 v[8:11], v29 offset:1024
    ds_read_b128 v[12:15], v29 offset:2048
    ds_read_b128 v[16:19], v29 offset:3072
    v_bfe_u32 v26, v1, 2, 3
    v_mul_u32_u24 v26, 1280, v26
    v_and_b32 v27, 3, v1
    v_lshl_add_u32 v26, v27, 3, v26
    s_mul_i32 s30, s5, 320
    v_add_u32 v26, s30, v26
    v_add_u32 v26, 20480, v26
    ds_read_b64_tr_b16 v[32:33], v26 offset:0
    ds_read_b64_tr_b16 v[34:35], v26 offset:32
    ds_read_b64_tr_b16 v[36:37], v26 offset:64
    ds_read_b64_tr_b16 v[38:39], v26 offset:96
    ds_read_b64_tr_b16 v[40:41], v26 offset:128
    ds_read_b64_tr_b16 v[42:43], v26 offset:160
    ds_read_b64_tr_b16 v[44:45], v26 offset:192
    ds_read_b64_tr_b16 v[46:47], v26 offset:224
    ds_read_b64_tr_b16 v[48:49], v26 offset:256
    ds_read_b64_tr_b16 v[50:51], v26 offset:288
    s_waitcnt lgkmcnt(10)
    v_add_f32 v4, v4, v8
    v_add_f32 v5, v5, v9
    v_add_f32 v6, v6, v10
    v_add_f32 v7, v7, v11
    v_add_f32 v4, v4, v12
    v_add_f32 v5, v5, v13
    v_add_f32 v6, v6, v14
    v_add_f32 v7, v7, v15
    v_add_f32 v4, v4, v16
    v_add_f32 v5, v5, v17
    v_add_f32 v6, v6, v18
    v_add_f32 v7, v7, v19
    s_nop 0
    v_mov_b32_dpp v8, v4 row_newbcast:8 row_mask:0xf bank_mask:0xf
    v_mov_b32_dpp v9, v5 row_newbcast:8 row_mask:0xf bank_mask:0xf
    v_mov_b32_dpp v10, v6 row_newbcast:8 row_mask:0xf bank_mask:0xf
    v_mov_b32_dpp v11, v7 row_newbcast:8 row_mask:0xf bank_mask:0xf
    v_fma_f32 v4, -v24, v8, v4
    v_fma_f32 v5, -v24, v9, v5
    v_fma_f32 v6, -v24, v10, v6
    v_fma_f32 v7, -v24, v11, v7
    v_mul_f32 v4, v4, v25
    v_mul_f32 v5, v5, v25
    v_mul_f32 v6, v6, v25
    v_mul_f32 v7, v7, v25
    v_cvt_pk_bf16_f32 v8, v4, v5
    v_cvt_pk_bf16_f32 v9, v6, v7
    v_lshlrev_b32 v4, 16, v8
    v_and_b32 v5, 0xffff0000, v8
    v_lshlrev_b32 v6, 16, v9
    v_and_b32 v7, 0xffff0000, v9
    v_mov_b32 v12, v4
    v_mov_b32 v13, v5
    v_mov_b32 v14, v6
    v_mov_b32 v15, v7
    s_nop 0
    v_permlane32_swap_b32 v4, v12
    v_permlane32_swap_b32 v5, v13
    v_permlane32_swap_b32 v6, v14
    v_permlane32_swap_b32 v7, v15
    v_mul_f32 v8, 0xbfb8aa3b, v4
    v_mul_f32 v9, 0xbfb8aa3b, v5
    v_mul_f32 v10, 0xbfb8aa3b, v6
    v_mul_f32 v11, 0xbfb8aa3b, v7
    v_exp_f32 v8, v8
    v_exp_f32 v9, v9
    v_exp_f32 v10, v10
    v_exp_f32 v11, v11
    v_add_f32 v8, 1.0, v8
    v_add_f32 v9, 1.0, v9
    v_add_f32 v10, 1.0, v10
    v_add_f32 v11, 1.0, v11
    v_rcp_f32 v8, v8
    v_rcp_f32 v9, v9
    v_rcp_f32 v10, v10
    v_rcp_f32 v11, v11
    v_mul_f32 v4, v4, v8
    v_mul_f32 v5, v5, v9
    v_mul_f32 v6, v6, v10
    v_mul_f32 v7, v7, v11
    v_cvt_pk_bf16_f32 v8, v4, v5
    v_cvt_pk_bf16_f32 v9, v6, v7
    v_lshlrev_b32 v4, 16, v8
    v_and_b32 v5, 0xffff0000, v8
    v_lshlrev_b32 v6, 16, v9
    v_and_b32 v7, 0xffff0000, v9
    v_mul_f32 v4, v4, v12
    v_mul_f32 v5, v5, v13
    v_mul_f32 v6, v6, v14
    v_mul_f32 v7, v7, v15
    v_cmp_gt_u32 vcc, 32, v1
    v_cvt_pk_bf16_f32 v20, v4, v5
    v_cvt_pk_bf16_f32 v21, v6, v7
    v_cndmask_b32 v20, 0, v20, vcc
    v_cndmask_b32 v21, 0, v21, vcc
    v_and_b32 v26, 15, v1
    v_cmp_gt_u32 vcc, 8, v26
    v_mul_u32_u24 v26, 2560, v26
    v_lshrrev_b32 v27, 4, v1
    v_lshl_add_u32 v26, v27, 4, v26
    s_mul_i32 s31, s2, 20480
    s_lshl_b32 s30, s30, 1
    s_add_u32 s30, s30, s31
    s_add_u32 s30, s30, 0x1a00000
    s_waitcnt lgkmcnt(0)
    v_mfma_f32_16x16x16_bf16 v[52:55], v[32:33], v[20:21], 0
    v_mfma_f32_16x16x16_bf16 v[56:59], v[34:35], v[20:21], 0
    v_mfma_f32_16x16x16_bf16 v[60:63], v[36:37], v[20:21], 0
    v_mfma_f32_16x16x16_bf16 v[64:67], v[38:39], v[20:21], 0
    v_mfma_f32_16x16x16_bf16 v[68:71], v[40:41], v[20:21], 0
    v_mfma_f32_16x16x16_bf16 v[72:75], v[42:43], v[20:21], 0
    v_mfma_f32_16x16x16_bf16 v[76:79], v[44:45], v[20:21], 0
    v_mfma_f32_16x16x16_bf16 v[80:83], v[46:47], v[20:21], 0
    v_mfma_f32_16x16x16_bf16 v[84:87], v[48:49], v[20:21], 0
    v_mfma_f32_16x16x16_bf16 v[88:91], v[50:51], v[20:21], 0
    s_mov_b64 exec, vcc
    s_nop 6
    buffer_store_dwordx4 v[52:55], v26, s[24:27], s30 offen offset:0
    buffer_store_dwordx4 v[56:59], v26, s[24:27], s30 offen offset:64
    buffer_store_dwordx4 v[60:63], v26, s[24:27], s30 offen offset:128
    buffer_store_dwordx4 v[64:67], v26, s[24:27], s30 offen offset:192
    buffer_store_dwordx4 v[68:71], v26, s[24:27], s30 offen offset:256
    buffer_store_dwordx4 v[72:75], v26, s[24:27], s30 offen offset:320
    buffer_store_dwordx4 v[76:79], v26, s[24:27], s30 offen offset:384
    buffer_store_dwordx4 v[80:83], v26, s[24:27], s30 offen offset:448
    buffer_store_dwordx4 v[84:87], v26, s[24:27], s30 offen offset:512
    buffer_store_dwordx4 v[88:91], v26, s[24:27], s30 offen offset:576
    s_mov_b64 exec, -1
    s_cmp_lg_u32 s2, 0
    s_cbranch_scc1 L_ffn_end
    v_mov_b32 v100, s56
    v_writelane_b32 v100, s57, 1
    v_writelane_b32 v100, s58, 2
    v_writelane_b32 v100, s59, 3
    v_writelane_b32 v100, s60, 4
    v_writelane_b32 v100, s61, 5
    v_writelane_b32 v100, s62, 6
    v_writelane_b32 v100, s63, 7
    v_lshlrev_b32 v101, 2, v1
    s_mov_b32 s30, 0x28c000
    s_mov_b64 exec, 0xff
    buffer_store_dword v100, v101, s[24:27], s30 offen
L_ffn_end:
    s_endpgm

.p2align 8
.type oproj_kernel,@function
oproj_kernel:
    s_cmp_ge_u32 s2, 256
    s_cbranch_scc1 L_oproj_end
    s_load_dwordx2 s[48:49], s[0:1], 0
    s_load_dwordx2 s[50:51], s[0:1], 80
    s_load_dwordx2 s[52:53], s[0:1], 96
    v_lshrrev_b32 v2, 6, v0
    v_and_b32 v1, 63, v0
    s_nop 0
    v_readfirstlane_b32 s5, v2
    s_waitcnt lgkmcnt(0)
    s_add_u32 s54, s52, 0x28c000
    s_addc_u32 s55, s53, 0
    s_load_dwordx8 s[56:63], s[54:55], 0
    s_and_b32 s32, s2, 7
    s_lshl_b32 s32, s32, 2
    s_bfe_u32 s33, s2, 0x20003
    s_add_u32 s36, s32, s33
    s_lshr_b32 s37, s2, 5
    s_lshl_b32 s32, s36, 19
    s_add_u32 s32, s32, 0x400000
    s_add_u32 s8, s52, s32
    s_addc_u32 s9, s53, 0
    s_mov_b32 s10, 0x80000
    s_mov_b32 s11, 0x20000
    s_mul_i32 s32, s37, 655360
    s_add_u32 s32, s32, 0x1400000
    s_add_u32 s12, s52, s32
    s_addc_u32 s13, s53, 0
    s_mov_b32 s14, 0xa0000
    s_mov_b32 s15, 0x20000
    s_mov_b32 s16, s48
    s_mov_b32 s17, s49
    s_mov_b32 s18, 0x280000
    s_mov_b32 s19, 0x20000
    s_mov_b32 s20, s50
    s_mov_b32 s21, s51
    s_mov_b32 s22, 0x280000
    s_mov_b32 s23, 0x20000
    s_mov_b32 s24, s52
    s_mov_b32 s25, s53
    s_mov_b32 s26, 0x2000000
    s_mov_b32 s27, 0x20000
    v_lshlrev_b32 v100, 4, v1
    s_mul_i32 s32, s5, 5120
    v_add_u32 v28, s32, v100
    v_add_u32 v29, 4096, v28
    s_add_u32 s32, s5, 0
    s_and_b32 s32, s32, 3
    s_lshl_b32 s33, s5, 2
    s_add_u32 s33, s33, s32
    s_lshl_b32 s33, s33, 10
    v_add_u32 v24, s33, v100
    s_mul_i32 s32, s32, 15360
    s_add_u32 s32, s32, 0
    v_add_u32 v34, s32, v100
    s_add_u32 s32, s5, 1
    s_and_b32 s32, s32, 3
    s_lshl_b32 s33, s5, 2
    s_add_u32 s33, s33, s32
    s_lshl_b32 s33, s33, 10
    v_add_u32 v25, s33, v100
    s_mul_i32 s32, s32, 15360
    s_add_u32 s32, s32, 0
    v_add_u32 v31, s32, v100
    s_add_u32 s32, s5, 2
    s_and_b32 s32, s32, 3
    s_lshl_b32 s33, s5, 2
    s_add_u32 s33, s33, s32
    s_lshl_b32 s33, s33, 10
    v_add_u32 v26, s33, v100
    s_mul_i32 s32, s32, 15360
    s_add_u32 s32, s32, 5120
    v_add_u32 v32, s32, v100
    s_add_u32 s32, s5, 3
    s_and_b32 s32, s32, 3
    s_lshl_b32 s33, s5, 2
    s_add_u32 s33, s33, s32
    s_lshl_b32 s33, s33, 10
    v_add_u32 v27, s33, v100
    s_mul_i32 s32, s32, 15360
    s_add_u32 s32, s32, 10240
    v_add_u32 v33, s32, v100
    s_lshl_b32 s32, s36, 2
    s_add_u32 s32, s32, s5
    s_lshl_b32 s32, s32, 4
    v_and_b32 v35, 15, v1
    v_add_u32 v35, s32, v35
    v_mul_u32_u24 v30, 1280, v35
    v_lshrrev_b32 v100, 4, v1
    v_lshl_add_u32 v30, v100, 3, v30
    s_mul_i32 s32, s37, 160
    v_add_u32 v30, s32, v30
    v_lshlrev_b32 v100, 3, v35
    s_mov_b32 s32, 0x280000
    buffer_load_dwordx2 v[36:37], v100, s[24:27], s32 offen
    buffer_load_dwordx2 v[80:81], v30, s[16:19], 0 offen offset:0
    buffer_load_dwordx2 v[82:83], v30, s[16:19], 0 offen offset:32
    buffer_load_dwordx2 v[84:85], v30, s[16:19], 0 offen offset:64
    buffer_load_dwordx2 v[86:87], v30, s[16:19], 0 offen offset:96
    buffer_load_dwordx2 v[88:89], v30, s[16:19], 0 offen offset:128
    s_mov_b32 s39, 0
    buffer_load_dwordx4 a[16:19], v28, s[12:15], s39 offen offset:0
    buffer_load_dwordx4 a[20:23], v28, s[12:15], s39 offen offset:1024
    buffer_load_dwordx4 a[24:27], v28, s[12:15], s39 offen offset:2048
    buffer_load_dwordx4 a[28:31], v28, s[12:15], s39 offen offset:3072
    buffer_load_dwordx4 a[32:35], v29, s[12:15], s39 offen offset:0
    s_mov_b32 s39, 20480
    buffer_load_dwordx4 a[52:55], v28, s[12:15], s39 offen offset:0
    buffer_load_dwordx4 a[56:59], v28, s[12:15], s39 offen offset:1024
    buffer_load_dwordx4 a[60:63], v28, s[12:15], s39 offen offset:2048
    buffer_load_dwordx4 a[64:67], v28, s[12:15], s39 offen offset:3072
    buffer_load_dwordx4 a[68:71], v29, s[12:15], s39 offen offset:0
    s_mov_b32 s38, 0
    buffer_load_dwordx4 a[0:3], v24, s[8:11], s38 offen
    buffer_load_dwordx4 a[4:7], v25, s[8:11], s38 offen
    buffer_load_dwordx4 a[8:11], v26, s[8:11], s38 offen
    buffer_load_dwordx4 a[12:15], v27, s[8:11], s38 offen
    s_mov_b32 s38, 16384
    buffer_load_dwordx4 a[36:39], v24, s[8:11], s38 offen
    buffer_load_dwordx4 a[40:43], v25, s[8:11], s38 offen
    buffer_load_dwordx4 a[44:47], v26, s[8:11], s38 offen
    buffer_load_dwordx4 a[48:51], v27, s[8:11], s38 offen
    s_mov_b32 s39, 40960
    buffer_load_dwordx4 a[88:91], v28, s[12:15], s39 offen offset:0
    buffer_load_dwordx4 a[92:95], v28, s[12:15], s39 offen offset:1024
    buffer_load_dwordx4 a[96:99], v28, s[12:15], s39 offen offset:2048
    buffer_load_dwordx4 a[100:103], v28, s[12:15], s39 offen offset:3072
    buffer_load_dwordx4 a[104:107], v29, s[12:15], s39 offen offset:0
    s_mov_b32 s39, 61440
    buffer_load_dwordx4 a[124:127], v28, s[12:15], s39 offen offset:0
    buffer_load_dwordx4 a[128:131], v28, s[12:15], s39 offen offset:1024
    buffer_load_dwordx4 a[132:135], v28, s[12:15], s39 offen offset:2048
    buffer_load_dwordx4 a[136:139], v28, s[12:15], s39 offen offset:3072
    buffer_load_dwordx4 a[140:143], v29, s[12:15], s39 offen offset:0
    s_mov_b32 s38, 32768
    buffer_load_dwordx4 a[72:75], v24, s[8:11], s38 offen
    buffer_load_dwordx4 a[76:79], v25, s[8:11], s38 offen
    buffer_load_dwordx4 a[80:83], v26, s[8:11], s38 offen
    buffer_load_dwordx4 a[84:87], v27, s[8:11], s38 offen
    s_mov_b32 s38, 49152
    buffer_load_dwordx4 a[108:111], v24, s[8:11], s38 offen
    buffer_load_dwordx4 a[112:115], v25, s[8:11], s38 offen
    buffer_load_dwordx4 a[116:119], v26, s[8:11], s38 offen
    buffer_load_dwordx4 a[120:123], v27, s[8:11], s38 offen
    s_waitcnt vmcnt(36) lgkmcnt(0)
    v_lshlrev_b32 v40, 16, v80
    v_and_b32 v41, 0xffff0000, v80
    v_lshlrev_b32 v42, 16, v81
    v_and_b32 v43, 0xffff0000, v81
    v_lshlrev_b32 v44, 16, v82
    v_and_b32 v45, 0xffff0000, v82
    v_lshlrev_b32 v46, 16, v83
    v_and_b32 v47, 0xffff0000, v83
    v_lshlrev_b32 v48, 16, v84
    v_and_b32 v49, 0xffff0000, v84
    v_lshlrev_b32 v50, 16, v85
    v_and_b32 v51, 0xffff0000, v85
    v_lshlrev_b32 v52, 16, v86
    v_and_b32 v53, 0xffff0000, v86
    v_lshlrev_b32 v54, 16, v87
    v_and_b32 v55, 0xffff0000, v87
    v_lshlrev_b32 v56, 16, v88
    v_and_b32 v57, 0xffff0000, v88
    v_lshlrev_b32 v58, 16, v89
    v_and_b32 v59, 0xffff0000, v89
    v_sub_f32 v60, v40, v36
    v_sub_f32 v61, v41, v36
    v_sub_f32 v62, v42, v36
    v_sub_f32 v63, v43, v36
    v_sub_f32 v64, v44, v36
    v_sub_f32 v65, v45, v36
    v_sub_f32 v66, v46, v36
    v_sub_f32 v67, v47, v36
    v_sub_f32 v68, v48, v36
    v_sub_f32 v69, v49, v36
    v_sub_f32 v70, v50, v36
    v_sub_f32 v71, v51, v36
    v_sub_f32 v72, v52, v36
    v_sub_f32 v73, v53, v36
    v_sub_f32 v74, v54, v36
    v_sub_f32 v75, v55, v36
    v_sub_f32 v76, v56, v36
    v_sub_f32 v77, v57, v36
    v_sub_f32 v78, v58, v36
    v_sub_f32 v79, v59, v36
    v_cvt_pk_bf16_f32 v100, v60, v61
    v_cvt_pk_bf16_f32 v101, v62, v63
    v_cvt_pk_bf16_f32 v102, v64, v65
    v_cvt_pk_bf16_f32 v103, v66, v67
    v_cvt_pk_bf16_f32 v104, v68, v69
    v_cvt_pk_bf16_f32 v105, v70, v71
    v_cvt_pk_bf16_f32 v106, v72, v73
    v_cvt_pk_bf16_f32 v107, v74, v75
    v_cvt_pk_bf16_f32 v108, v76, v77
    v_cvt_pk_bf16_f32 v109, v78, v79
    v_lshlrev_b32 v60, 16, v100
    v_and_b32 v61, 0xffff0000, v100
    v_lshlrev_b32 v62, 16, v101
    v_and_b32 v63, 0xffff0000, v101
    v_lshlrev_b32 v64, 16, v102
    v_and_b32 v65, 0xffff0000, v102
    v_lshlrev_b32 v66, 16, v103
    v_and_b32 v67, 0xffff0000, v103
    v_lshlrev_b32 v68, 16, v104
    v_and_b32 v69, 0xffff0000, v104
    v_lshlrev_b32 v70, 16, v105
    v_and_b32 v71, 0xffff0000, v105
    v_lshlrev_b32 v72, 16, v106
    v_and_b32 v73, 0xffff0000, v106
    v_lshlrev_b32 v74, 16, v107
    v_and_b32 v75, 0xffff0000, v107
    v_lshlrev_b32 v76, 16, v108
    v_and_b32 v77, 0xffff0000, v108
    v_lshlrev_b32 v78, 16, v109
    v_and_b32 v79, 0xffff0000, v109
    v_mul_f32 v60, v60, v37
    v_mul_f32 v61, v61, v37
    v_mul_f32 v62, v62, v37
    v_mul_f32 v63, v63, v37
    v_mul_f32 v64, v64, v37
    v_mul_f32 v65, v65, v37
    v_mul_f32 v66, v66, v37
    v_mul_f32 v67, v67, v37
    v_mul_f32 v68, v68, v37
    v_mul_f32 v69, v69, v37
    v_mul_f32 v70, v70, v37
    v_mul_f32 v71, v71, v37
    v_mul_f32 v72, v72, v37
    v_mul_f32 v73, v73, v37
    v_mul_f32 v74, v74, v37
    v_mul_f32 v75, v75, v37
    v_mul_f32 v76, v76, v37
    v_mul_f32 v77, v77, v37
    v_mul_f32 v78, v78, v37
    v_mul_f32 v79, v79, v37
    v_cvt_pk_bf16_f32 v100, v60, v61
    v_cvt_pk_bf16_f32 v101, v62, v63
    v_cvt_pk_bf16_f32 v102, v64, v65
    v_cvt_pk_bf16_f32 v103, v66, v67
    v_cvt_pk_bf16_f32 v104, v68, v69
    v_cvt_pk_bf16_f32 v105, v70, v71
    v_cvt_pk_bf16_f32 v106, v72, v73
    v_cvt_pk_bf16_f32 v107, v74, v75
    v_cvt_pk_bf16_f32 v108, v76, v77
    v_cvt_pk_bf16_f32 v109, v78, v79
    v_lshlrev_b32 v60, 16, v100
    v_and_b32 v61, 0xffff0000, v100
    v_lshlrev_b32 v62, 16, v101
    v_and_b32 v63, 0xffff0000, v101
    v_lshlrev_b32 v64, 16, v102
    v_and_b32 v65, 0xffff0000, v102
    v_lshlrev_b32 v66, 16, v103
    v_and_b32 v67, 0xffff0000, v103
    v_lshlrev_b32 v68, 16, v104
    v_and_b32 v69, 0xffff0000, v104
    v_lshlrev_b32 v70, 16, v105
    v_and_b32 v71, 0xffff0000, v105
    v_lshlrev_b32 v72, 16, v106
    v_and_b32 v73, 0xffff0000, v106
    v_lshlrev_b32 v74, 16, v107
    v_and_b32 v75, 0xffff0000, v107
    v_lshlrev_b32 v76, 16, v108
    v_and_b32 v77, 0xffff0000, v108
    v_lshlrev_b32 v78, 16, v109
    v_and_b32 v79, 0xffff0000, v109
    v_mov_b32 v80, v60
    v_mov_b32 v81, v61
    v_mov_b32 v82, v62
    v_mov_b32 v83, v63
    v_mov_b32 v84, v64
    v_mov_b32 v85, v65
    v_mov_b32 v86, v66
    v_mov_b32 v87, v67
    v_mov_b32 v88, v68
    v_mov_b32 v89, v69
    v_mov_b32 v90, v70
    v_mov_b32 v91, v71
    v_mov_b32 v92, v72
    v_mov_b32 v93, v73
    v_mov_b32 v94, v74
    v_mov_b32 v95, v75
    v_mov_b32 v96, v76
    v_mov_b32 v97, v77
    v_mov_b32 v98, v78
    v_mov_b32 v99, v79
    v_mul_f32 v100, 0xbfb8aa3b, v80
    v_mul_f32 v101, 0xbfb8aa3b, v81
    v_mul_f32 v102, 0xbfb8aa3b, v82
    v_mul_f32 v103, 0xbfb8aa3b, v83
    v_mul_f32 v104, 0xbfb8aa3b, v84
    v_mul_f32 v105, 0xbfb8aa3b, v85
    v_mul_f32 v106, 0xbfb8aa3b, v86
    v_mul_f32 v107, 0xbfb8aa3b, v87
    v_mul_f32 v108, 0xbfb8aa3b, v88
    v_mul_f32 v109, 0xbfb8aa3b, v89
    v_mul_f32 v110, 0xbfb8aa3b, v90
    v_mul_f32 v111, 0xbfb8aa3b, v91
    v_mul_f32 v112, 0xbfb8aa3b, v92
    v_mul_f32 v113, 0xbfb8aa3b, v93
    v_mul_f32 v114, 0xbfb8aa3b, v94
    v_mul_f32 v115, 0xbfb8aa3b, v95
    v_mul_f32 v116, 0xbfb8aa3b, v96
    v_mul_f32 v117, 0xbfb8aa3b, v97
    v_mul_f32 v118, 0xbfb8aa3b, v98
    v_mul_f32 v119, 0xbfb8aa3b, v99
    v_exp_f32 v100, v100
    v_exp_f32 v101, v101
    v_exp_f32 v102, v102
    v_exp_f32 v103, v103
    v_exp_f32 v104, v104
    v_exp_f32 v105, v105
    v_exp_f32 v106, v106
    v_exp_f32 v107, v107
    v_exp_f32 v108, v108
    v_exp_f32 v109, v109
    v_exp_f32 v110, v110
    v_exp_f32 v111, v111
    v_exp_f32 v112, v112
    v_exp_f32 v113, v113
    v_exp_f32 v114, v114
    v_exp_f32 v115, v115
    v_exp_f32 v116, v116
    v_exp_f32 v117, v117
    v_exp_f32 v118, v118
    v_exp_f32 v119, v119
    v_add_f32 v100, 1.0, v100
    v_add_f32 v101, 1.0, v101
    v_add_f32 v102, 1.0, v102
    v_add_f32 v103, 1.0, v103
    v_add_f32 v104, 1.0, v104
    v_add_f32 v105, 1.0, v105
    v_add_f32 v106, 1.0, v106
    v_add_f32 v107, 1.0, v107
    v_add_f32 v108, 1.0, v108
    v_add_f32 v109, 1.0, v109
    v_add_f32 v110, 1.0, v110
    v_add_f32 v111, 1.0, v111
    v_add_f32 v112, 1.0, v112
    v_add_f32 v113, 1.0, v113
    v_add_f32 v114, 1.0, v114
    v_add_f32 v115, 1.0, v115
    v_add_f32 v116, 1.0, v116
    v_add_f32 v117, 1.0, v117
    v_add_f32 v118, 1.0, v118
    v_add_f32 v119, 1.0, v119
    v_rcp_f32 v100, v100
    v_rcp_f32 v101, v101
    v_rcp_f32 v102, v102
    v_rcp_f32 v103, v103
    v_rcp_f32 v104, v104
    v_rcp_f32 v105, v105
    v_rcp_f32 v106, v106
    v_rcp_f32 v107, v107
    v_rcp_f32 v108, v108
    v_rcp_f32 v109, v109
    v_rcp_f32 v110, v110
    v_rcp_f32 v111, v111
    v_rcp_f32 v112, v112
    v_rcp_f32 v113, v113
    v_rcp_f32 v114, v114
    v_rcp_f32 v115, v115
    v_rcp_f32 v116, v116
    v_rcp_f32 v117, v117
    v_rcp_f32 v118, v118
    v_rcp_f32 v119, v119
    v_mul_f32 v80, v80, v100
    v_mul_f32 v81, v81, v101
    v_mul_f32 v82, v82, v102
    v_mul_f32 v83, v83, v103
    v_mul_f32 v84, v84, v104
    v_mul_f32 v85, v85, v105
    v_mul_f32 v86, v86, v106
    v_mul_f32 v87, v87, v107
    v_mul_f32 v88, v88, v108
    v_mul_f32 v89, v89, v109
    v_mul_f32 v90, v90, v110
    v_mul_f32 v91, v91, v111
    v_mul_f32 v92, v92, v112
    v_mul_f32 v93, v93, v113
    v_mul_f32 v94, v94, v114
    v_mul_f32 v95, v95, v115
    v_mul_f32 v96, v96, v116
    v_mul_f32 v97, v97, v117
    v_mul_f32 v98, v98, v118
    v_mul_f32 v99, v99, v119
    v_cvt_pk_bf16_f32 v100, v80, v81
    v_cvt_pk_bf16_f32 v101, v82, v83
    v_cvt_pk_bf16_f32 v102, v84, v85
    v_cvt_pk_bf16_f32 v103, v86, v87
    v_cvt_pk_bf16_f32 v104, v88, v89
    v_cvt_pk_bf16_f32 v105, v90, v91
    v_cvt_pk_bf16_f32 v106, v92, v93
    v_cvt_pk_bf16_f32 v107, v94, v95
    v_cvt_pk_bf16_f32 v108, v96, v97
    v_cvt_pk_bf16_f32 v109, v98, v99
    v_lshlrev_b32 v80, 16, v100
    v_and_b32 v81, 0xffff0000, v100
    v_lshlrev_b32 v82, 16, v101
    v_and_b32 v83, 0xffff0000, v101
    v_lshlrev_b32 v84, 16, v102
    v_and_b32 v85, 0xffff0000, v102
    v_lshlrev_b32 v86, 16, v103
    v_and_b32 v87, 0xffff0000, v103
    v_lshlrev_b32 v88, 16, v104
    v_and_b32 v89, 0xffff0000, v104
    v_lshlrev_b32 v90, 16, v105
    v_and_b32 v91, 0xffff0000, v105
    v_lshlrev_b32 v92, 16, v106
    v_and_b32 v93, 0xffff0000, v106
    v_lshlrev_b32 v94, 16, v107
    v_and_b32 v95, 0xffff0000, v107
    v_lshlrev_b32 v96, 16, v108
    v_and_b32 v97, 0xffff0000, v108
    v_lshlrev_b32 v98, 16, v109
    v_and_b32 v99, 0xffff0000, v109
    s_waitcnt vmcnt(18)
    v_mfma_f32_16x16x32_bf16 v[160:163], a[16:19], a[0:3], 0
    s_mov_b32 s38, 65536
    buffer_load_dwordx4 a[144:147], v24, s[8:11], s38 offen
    v_mfma_f32_16x16x32_bf16 v[160:163], a[52:55], a[36:39], v[160:163]
    v_mfma_f32_16x16x32_bf16 v[180:183], a[16:19], a[4:7], 0
    buffer_load_dwordx4 a[148:151], v25, s[8:11], s38 offen
    v_mfma_f32_16x16x32_bf16 v[180:183], a[52:55], a[40:43], v[180:183]
    v_mfma_f32_16x16x32_bf16 v[200:203], a[16:19], a[8:11], 0
    buffer_load_dwordx4 a[152:155], v26, s[8:11], s38 offen
    v_mfma_f32_16x16x32_bf16 v[200:203], a[52:55], a[44:47], v[200:203]
    v_mfma_f32_16x16x32_bf16 v[220:223], a[16:19], a[12:15], 0
    buffer_load_dwordx4 a[156:159], v27, s[8:11], s38 offen
    v_mfma_f32_16x16x32_bf16 v[220:223], a[52:55], a[48:51], v[220:223]
    v_mfma_f32_16x16x32_bf16 v[164:167], a[20:23], a[0:3], 0
    s_mov_b32 s38, 81920
    buffer_load_dwordx4 a[180:183], v24, s[8:11], s38 offen
    v_mfma_f32_16x16x32_bf16 v[164:167], a[56:59], a[36:39], v[164:167]
    v_mfma_f32_16x16x32_bf16 v[184:187], a[20:23], a[4:7], 0
    buffer_load_dwordx4 a[184:187], v25, s[8:11], s38 offen
    v_mfma_f32_16x16x32_bf16 v[184:187], a[56:59], a[40:43], v[184:187]
    v_mfma_f32_16x16x32_bf16 v[204:207], a[20:23], a[8:11], 0
    buffer_load_dwordx4 a[188:191], v26, s[8:11], s38 offen
    v_mfma_f32_16x16x32_bf16 v[204:207], a[56:59], a[44:47], v[204:207]
    v_mfma_f32_16x16x32_bf16 v[224:227], a[20:23], a[12:15], 0
    buffer_load_dwordx4 a[192:195], v27, s[8:11], s38 offen
    v_mfma_f32_16x16x32_bf16 v[224:227], a[56:59], a[48:51], v[224:227]
    v_mfma_f32_16x16x32_bf16 v[168:171], a[24:27], a[0:3], 0
    s_mov_b32 s39, 81920
    buffer_load_dwordx4 a[160:163], v28, s[12:15], s39 offen offset:0
    v_mfma_f32_16x16x32_bf16 v[168:171], a[60:63], a[36:39], v[168:171]
    v_mfma_f32_16x16x32_bf16 v[188:191], a[24:27], a[4:7], 0
    buffer_load_dwordx4 a[164:167], v28, s[12:15], s39 offen offset:1024
    v_mfma_f32_16x16x32_bf16 v[188:191], a[60:63], a[40:43], v[188:191]
    v_mfma_f32_16x16x32_bf16 v[208:211], a[24:27], a[8:11], 0
    buffer_load_dwordx4 a[168:171], v28, s[12:15], s39 offen offset:2048
    v_mfma_f32_16x16x32_bf16 v[208:211], a[60:63], a[44:47], v[208:211]
    v_mfma_f32_16x16x32_bf16 v[228:231], a[24:27], a[12:15], 0
    buffer_load_dwordx4 a[172:175], v28, s[12:15], s39 offen offset:3072
    v_mfma_f32_16x16x32_bf16 v[228:231], a[60:63], a[48:51], v[228:231]
    v_mfma_f32_16x16x32_bf16 v[172:175], a[28:31], a[0:3], 0
    buffer_load_dwordx4 a[176:179], v29, s[12:15], s39 offen offset:0
    v_mfma_f32_16x16x32_bf16 v[172:175], a[64:67], a[36:39], v[172:175]
    v_mfma_f32_16x16x32_bf16 v[192:195], a[28:31], a[4:7], 0
    s_mov_b32 s39, 102400
    buffer_load_dwordx4 a[196:199], v28, s[12:15], s39 offen offset:0
    v_mfma_f32_16x16x32_bf16 v[192:195], a[64:67], a[40:43], v[192:195]
    v_mfma_f32_16x16x32_bf16 v[212:215], a[28:31], a[8:11], 0
    buffer_load_dwordx4 a[200:203], v28, s[12:15], s39 offen offset:1024
    v_mfma_f32_16x16x32_bf16 v[212:215], a[64:67], a[44:47], v[212:215]
    v_mfma_f32_16x16x32_bf16 v[232:235], a[28:31], a[12:15], 0
    buffer_load_dwordx4 a[204:207], v28, s[12:15], s39 offen offset:2048
    v_mfma_f32_16x16x32_bf16 v[232:235], a[64:67], a[48:51], v[232:235]
    v_mfma_f32_16x16x32_bf16 v[176:179], a[32:35], a[0:3], 0
    buffer_load_dwordx4 a[208:211], v28, s[12:15], s39 offen offset:3072
    v_mfma_f32_16x16x32_bf16 v[176:179], a[68:71], a[36:39], v[176:179]
    v_mfma_f32_16x16x32_bf16 v[196:199], a[32:35], a[4:7], 0
    buffer_load_dwordx4 a[212:215], v29, s[12:15], s39 offen offset:0
    v_mfma_f32_16x16x32_bf16 v[196:199], a[68:71], a[40:43], v[196:199]
    v_mfma_f32_16x16x32_bf16 v[216:219], a[32:35], a[8:11], 0
    v_mfma_f32_16x16x32_bf16 v[216:219], a[68:71], a[44:47], v[216:219]
    v_mfma_f32_16x16x32_bf16 v[236:239], a[32:35], a[12:15], 0
    v_mfma_f32_16x16x32_bf16 v[236:239], a[68:71], a[48:51], v[236:239]
    s_waitcnt vmcnt(18)
    v_mfma_f32_16x16x32_bf16 v[160:163], a[88:91], a[72:75], v[160:163]
    s_mov_b32 s38, 98304
    buffer_load_dwordx4 a[0:3], v24, s[8:11], s38 offen
    v_mfma_f32_16x16x32_bf16 v[160:163], a[124:127], a[108:111], v[160:163]
    v_mfma_f32_16x16x32_bf16 v[180:183], a[88:91], a[76:79], v[180:183]
    buffer_load_dwordx4 a[4:7], v25, s[8:11], s38 offen
    v_mfma_f32_16x16x32_bf16 v[180:183], a[124:127], a[112:115], v[180:183]
    v_mfma_f32_16x16x32_bf16 v[200:203], a[88:91], a[80:83], v[200:203]
    buffer_load_dwordx4 a[8:11], v26, s[8:11], s38 offen
    v_mfma_f32_16x16x32_bf16 v[200:203], a[124:127], a[116:119], v[200:203]
    v_mfma_f32_16x16x32_bf16 v[220:223], a[88:91], a[84:87], v[220:223]
    buffer_load_dwordx4 a[12:15], v27, s[8:11], s38 offen
    v_mfma_f32_16x16x32_bf16 v[220:223], a[124:127], a[120:123], v[220:223]
    v_mfma_f32_16x16x32_bf16 v[164:167], a[92:95], a[72:75], v[164:167]
    s_mov_b32 s38, 114688
    buffer_load_dwordx4 a[36:39], v24, s[8:11], s38 offen
    v_mfma_f32_16x16x32_bf16 v[164:167], a[128:131], a[108:111], v[164:167]
    v_mfma_f32_16x16x32_bf16 v[184:187], a[92:95], a[76:79], v[184:187]
    buffer_load_dwordx4 a[40:43], v25, s[8:11], s38 offen
    v_mfma_f32_16x16x32_bf16 v[184:187], a[128:131], a[112:115], v[184:187]
    v_mfma_f32_16x16x32_bf16 v[204:207], a[92:95], a[80:83], v[204:207]
    buffer_load_dwordx4 a[44:47], v26, s[8:11], s38 offen
    v_mfma_f32_16x16x32_bf16 v[204:207], a[128:131], a[116:119], v[204:207]
    v_mfma_f32_16x16x32_bf16 v[224:227], a[92:95], a[84:87], v[224:227]
    buffer_load_dwordx4 a[48:51], v27, s[8:11], s38 offen
    v_mfma_f32_16x16x32_bf16 v[224:227], a[128:131], a[120:123], v[224:227]
    v_mfma_f32_16x16x32_bf16 v[168:171], a[96:99], a[72:75], v[168:171]
    s_mov_b32 s39, 122880
    buffer_load_dwordx4 a[16:19], v28, s[12:15], s39 offen offset:0
    v_mfma_f32_16x16x32_bf16 v[168:171], a[132:135], a[108:111], v[168:171]
    v_mfma_f32_16x16x32_bf16 v[188:191], a[96:99], a[76:79], v[188:191]
    buffer_load_dwordx4 a[20:23], v28, s[12:15], s39 offen offset:1024
    v_mfma_f32_16x16x32_bf16 v[188:191], a[132:135], a[112:115], v[188:191]
    v_mfma_f32_16x16x32_bf16 v[208:211], a[96:99], a[80:83], v[208:211]
    buffer_load_dwordx4 a[24:27], v28, s[12:15], s39 offen offset:2048
    v_mfma_f32_16x16x32_bf16 v[208:211], a[132:135], a[116:119], v[208:211]
    v_mfma_f32_16x16x32_bf16 v[228:231], a[96:99], a[84:87], v[228:231]
    buffer_load_dwordx4 a[28:31], v28, s[12:15], s39 offen offset:3072
    v_mfma_f32_16x16x32_bf16 v[228:231], a[132:135], a[120:123], v[228:231]
    v_mfma_f32_16x16x32_bf16 v[172:175], a[100:103], a[72:75], v[172:175]
    buffer_load_dwordx4 a[32:35], v29, s[12:15], s39 offen offset:0
    v_mfma_f32_16x16x32_bf16 v[172:175], a[136:139], a[108:111], v[172:175]
    v_mfma_f32_16x16x32_bf16 v[192:195], a[100:103], a[76:79], v[192:195]
    s_mov_b32 s39, 143360
    buffer_load_dwordx4 a[52:55], v28, s[12:15], s39 offen offset:0
    v_mfma_f32_16x16x32_bf16 v[192:195], a[136:139], a[112:115], v[192:195]
    v_mfma_f32_16x16x32_bf16 v[212:215], a[100:103], a[80:83], v[212:215]
    buffer_load_dwordx4 a[56:59], v28, s[12:15], s39 offen offset:1024
    v_mfma_f32_16x16x32_bf16 v[212:215], a[136:139], a[116:119], v[212:215]
    v_mfma_f32_16x16x32_bf16 v[232:235], a[100:103], a[84:87], v[232:235]
    buffer_load_dwordx4 a[60:63], v28, s[12:15], s39 offen offset:2048
    v_mfma_f32_16x16x32_bf16 v[232:235], a[136:139], a[120:123], v[232:235]
    v_mfma_f32_16x16x32_bf16 v[176:179], a[104:107], a[72:75], v[176:179]
    buffer_load_dwordx4 a[64:67], v28, s[12:15], s39 offen offset:3072
    v_mfma_f32_16x16x32_bf16 v[176:179], a[140:143], a[108:111], v[176:179]
    v_mfma_f32_16x16x32_bf16 v[196:199], a[104:107], a[76:79], v[196:199]
    buffer_load_dwordx4 a[68:71], v29, s[12:15], s39 offen offset:0
    v_mfma_f32_16x16x32_bf16 v[196:199], a[140:143], a[112:115], v[196:199]
    v_mfma_f32_16x16x32_bf16 v[216:219], a[104:107], a[80:83], v[216:219]
    v_mfma_f32_16x16x32_bf16 v[216:219], a[140:143], a[116:119], v[216:219]
    v_mfma_f32_16x16x32_bf16 v[236:239], a[104:107], a[84:87], v[236:239]
    v_mfma_f32_16x16x32_bf16 v[236:239], a[140:143], a[120:123], v[236:239]
    s_waitcnt vmcnt(18)
    v_mfma_f32_16x16x32_bf16 v[160:163], a[160:163], a[144:147], v[160:163]
    s_mov_b32 s38, 131072
    buffer_load_dwordx4 a[72:75], v24, s[8:11], s38 offen
    v_mfma_f32_16x16x32_bf16 v[160:163], a[196:199], a[180:183], v[160:163]
    v_mfma_f32_16x16x32_bf16 v[180:183], a[160:163], a[148:151], v[180:183]
    buffer_load_dwordx4 a[76:79], v25, s[8:11], s38 offen
    v_mfma_f32_16x16x32_bf16 v[180:183], a[196:199], a[184:187], v[180:183]
    v_mfma_f32_16x16x32_bf16 v[200:203], a[160:163], a[152:155], v[200:203]
    buffer_load_dwordx4 a[80:83], v26, s[8:11], s38 offen
    v_mfma_f32_16x16x32_bf16 v[200:203], a[196:199], a[188:191], v[200:203]
    v_mfma_f32_16x16x32_bf16 v[220:223], a[160:163], a[156:159], v[220:223]
    buffer_load_dwordx4 a[84:87], v27, s[8:11], s38 offen
    v_mfma_f32_16x16x32_bf16 v[220:223], a[196:199], a[192:195], v[220:223]
    v_mfma_f32_16x16x32_bf16 v[164:167], a[164:167], a[144:147], v[164:167]
    s_mov_b32 s38, 147456
    buffer_load_dwordx4 a[108:111], v24, s[8:11], s38 offen
    v_mfma_f32_16x16x32_bf16 v[164:167], a[200:203], a[180:183], v[164:167]
    v_mfma_f32_16x16x32_bf16 v[184:187], a[164:167], a[148:151], v[184:187]
    buffer_load_dwordx4 a[112:115], v25, s[8:11], s38 offen
    v_mfma_f32_16x16x32_bf16 v[184:187], a[200:203], a[184:187], v[184:187]
    v_mfma_f32_16x16x32_bf16 v[204:207], a[164:167], a[152:155], v[204:207]
    buffer_load_dwordx4 a[116:119], v26, s[8:11], s38 offen
    v_mfma_f32_16x16x32_bf16 v[204:207], a[200:203], a[188:191], v[204:207]
    v_mfma_f32_16x16x32_bf16 v[224:227], a[164:167], a[156:159], v[224:227]
    buffer_load_dwordx4 a[120:123], v27, s[8:11], s38 offen
    v_mfma_f32_16x16x32_bf16 v[224:227], a[200:203], a[192:195], v[224:227]
    v_mfma_f32_16x16x32_bf16 v[168:171], a[168:171], a[144:147], v[168:171]
    s_mov_b32 s39, 163840
    buffer_load_dwordx4 a[88:91], v28, s[12:15], s39 offen offset:0
    v_mfma_f32_16x16x32_bf16 v[168:171], a[204:207], a[180:183], v[168:171]
    v_mfma_f32_16x16x32_bf16 v[188:191], a[168:171], a[148:151], v[188:191]
    buffer_load_dwordx4 a[92:95], v28, s[12:15], s39 offen offset:1024
    v_mfma_f32_16x16x32_bf16 v[188:191], a[204:207], a[184:187], v[188:191]
    v_mfma_f32_16x16x32_bf16 v[208:211], a[168:171], a[152:155], v[208:211]
    buffer_load_dwordx4 a[96:99], v28, s[12:15], s39 offen offset:2048
    v_mfma_f32_16x16x32_bf16 v[208:211], a[204:207], a[188:191], v[208:211]
    v_mfma_f32_16x16x32_bf16 v[228:231], a[168:171], a[156:159], v[228:231]
    buffer_load_dwordx4 a[100:103], v28, s[12:15], s39 offen offset:3072
    v_mfma_f32_16x16x32_bf16 v[228:231], a[204:207], a[192:195], v[228:231]
    v_mfma_f32_16x16x32_bf16 v[172:175], a[172:175], a[144:147], v[172:175]
    buffer_load_dwordx4 a[104:107], v29, s[12:15], s39 offen offset:0
    v_mfma_f32_16x16x32_bf16 v[172:175], a[208:211], a[180:183], v[172:175]
    v_mfma_f32_16x16x32_bf16 v[192:195], a[172:175], a[148:151], v[192:195]
    s_mov_b32 s39, 184320
    buffer_load_dwordx4 a[124:127], v28, s[12:15], s39 offen offset:0
    v_mfma_f32_16x16x32_bf16 v[192:195], a[208:211], a[184:187], v[192:195]
    v_mfma_f32_16x16x32_bf16 v[212:215], a[172:175], a[152:155], v[212:215]
    buffer_load_dwordx4 a[128:131], v28, s[12:15], s39 offen offset:1024
    v_mfma_f32_16x16x32_bf16 v[212:215], a[208:211], a[188:191], v[212:215]
    v_mfma_f32_16x16x32_bf16 v[232:235], a[172:175], a[156:159], v[232:235]
    buffer_load_dwordx4 a[132:135], v28, s[12:15], s39 offen offset:2048
    v_mfma_f32_16x16x32_bf16 v[232:235], a[208:211], a[192:195], v[232:235]
    v_mfma_f32_16x16x32_bf16 v[176:179], a[176:179], a[144:147], v[176:179]
    buffer_load_dwordx4 a[136:139], v28, s[12:15], s39 offen offset:3072
    v_mfma_f32_16x16x32_bf16 v[176:179], a[212:215], a[180:183], v[176:179]
    v_mfma_f32_16x16x32_bf16 v[196:199], a[176:179], a[148:151], v[196:199]
    buffer_load_dwordx4 a[140:143], v29, s[12:15], s39 offen offset:0
    v_mfma_f32_16x16x32_bf16 v[196:199], a[212:215], a[184:187], v[196:199]
    v_mfma_f32_16x16x32_bf16 v[216:219], a[176:179], a[152:155], v[216:219]
    v_mfma_f32_16x16x32_bf16 v[216:219], a[212:215], a[188:191], v[216:219]
    v_mfma_f32_16x16x32_bf16 v[236:239], a[176:179], a[156:159], v[236:239]
    v_mfma_f32_16x16x32_bf16 v[236:239], a[212:215], a[192:195], v[236:239]
    s_waitcnt vmcnt(18)
    v_mfma_f32_16x16x32_bf16 v[160:163], a[16:19], a[0:3], v[160:163]
    s_mov_b32 s38, 163840
    buffer_load_dwordx4 a[144:147], v24, s[8:11], s38 offen
    v_mfma_f32_16x16x32_bf16 v[160:163], a[52:55], a[36:39], v[160:163]
    v_mfma_f32_16x16x32_bf16 v[180:183], a[16:19], a[4:7], v[180:183]
    buffer_load_dwordx4 a[148:151], v25, s[8:11], s38 offen
    v_mfma_f32_16x16x32_bf16 v[180:183], a[52:55], a[40:43], v[180:183]
    v_mfma_f32_16x16x32_bf16 v[200:203], a[16:19], a[8:11], v[200:203]
    buffer_load_dwordx4 a[152:155], v26, s[8:11], s38 offen
    v_mfma_f32_16x16x32_bf16 v[200:203], a[52:55], a[44:47], v[200:203]
    v_mfma_f32_16x16x32_bf16 v[220:223], a[16:19], a[12:15], v[220:223]
    buffer_load_dwordx4 a[156:159], v27, s[8:11], s38 offen
    v_mfma_f32_16x16x32_bf16 v[220:223], a[52:55], a[48:51], v[220:223]
    v_mfma_f32_16x16x32_bf16 v[164:167], a[20:23], a[0:3], v[164:167]
    s_mov_b32 s38, 180224
    buffer_load_dwordx4 a[180:183], v24, s[8:11], s38 offen
    v_mfma_f32_16x16x32_bf16 v[164:167], a[56:59], a[36:39], v[164:167]
    v_mfma_f32_16x16x32_bf16 v[184:187], a[20:23], a[4:7], v[184:187]
    buffer_load_dwordx4 a[184:187], v25, s[8:11], s38 offen
    v_mfma_f32_16x16x32_bf16 v[184:187], a[56:59], a[40:43], v[184:187]
    v_mfma_f32_16x16x32_bf16 v[204:207], a[20:23], a[8:11], v[204:207]
    buffer_load_dwordx4 a[188:191], v26, s[8:11], s38 offen
    v_mfma_f32_16x16x32_bf16 v[204:207], a[56:59], a[44:47], v[204:207]
    v_mfma_f32_16x16x32_bf16 v[224:227], a[20:23], a[12:15], v[224:227]
    buffer_load_dwordx4 a[192:195], v27, s[8:11], s38 offen
    v_mfma_f32_16x16x32_bf16 v[224:227], a[56:59], a[48:51], v[224:227]
    v_mfma_f32_16x16x32_bf16 v[168:171], a[24:27], a[0:3], v[168:171]
    s_mov_b32 s39, 204800
    buffer_load_dwordx4 a[160:163], v28, s[12:15], s39 offen offset:0
    v_mfma_f32_16x16x32_bf16 v[168:171], a[60:63], a[36:39], v[168:171]
    v_mfma_f32_16x16x32_bf16 v[188:191], a[24:27], a[4:7], v[188:191]
    buffer_load_dwordx4 a[164:167], v28, s[12:15], s39 offen offset:1024
    v_mfma_f32_16x16x32_bf16 v[188:191], a[60:63], a[40:43], v[188:191]
    v_mfma_f32_16x16x32_bf16 v[208:211], a[24:27], a[8:11], v[208:211]
    buffer_load_dwordx4 a[168:171], v28, s[12:15], s39 offen offset:2048
    v_mfma_f32_16x16x32_bf16 v[208:211], a[60:63], a[44:47], v[208:211]
    v_mfma_f32_16x16x32_bf16 v[228:231], a[24:27], a[12:15], v[228:231]
    buffer_load_dwordx4 a[172:175], v28, s[12:15], s39 offen offset:3072
    v_mfma_f32_16x16x32_bf16 v[228:231], a[60:63], a[48:51], v[228:231]
    v_mfma_f32_16x16x32_bf16 v[172:175], a[28:31], a[0:3], v[172:175]
    buffer_load_dwordx4 a[176:179], v29, s[12:15], s39 offen offset:0
    v_mfma_f32_16x16x32_bf16 v[172:175], a[64:67], a[36:39], v[172:175]
    v_mfma_f32_16x16x32_bf16 v[192:195], a[28:31], a[4:7], v[192:195]
    s_mov_b32 s39, 225280
    buffer_load_dwordx4 a[196:199], v28, s[12:15], s39 offen offset:0
    v_mfma_f32_16x16x32_bf16 v[192:195], a[64:67], a[40:43], v[192:195]
    v_mfma_f32_16x16x32_bf16 v[212:215], a[28:31], a[8:11], v[212:215]
    buffer_load_dwordx4 a[200:203], v28, s[12:15], s39 offen offset:1024
    v_mfma_f32_16x16x32_bf16 v[212:215], a[64:67], a[44:47], v[212:215]
    v_mfma_f32_16x16x32_bf16 v[232:235], a[28:31], a[12:15], v[232:235]
    buffer_load_dwordx4 a[204:207], v28, s[12:15], s39 offen offset:2048
    v_mfma_f32_16x16x32_bf16 v[232:235], a[64:67], a[48:51], v[232:235]
    v_mfma_f32_16x16x32_bf16 v[176:179], a[32:35], a[0:3], v[176:179]
    buffer_load_dwordx4 a[208:211], v28, s[12:15], s39 offen offset:3072
    v_mfma_f32_16x16x32_bf16 v[176:179], a[68:71], a[36:39], v[176:179]
    v_mfma_f32_16x16x32_bf16 v[196:199], a[32:35], a[4:7], v[196:199]
    buffer_load_dwordx4 a[212:215], v29, s[12:15], s39 offen offset:0
    v_mfma_f32_16x16x32_bf16 v[196:199], a[68:71], a[40:43], v[196:199]
    v_mfma_f32_16x16x32_bf16 v[216:219], a[32:35], a[8:11], v[216:219]
    v_mfma_f32_16x16x32_bf16 v[216:219], a[68:71], a[44:47], v[216:219]
    v_mfma_f32_16x16x32_bf16 v[236:239], a[32:35], a[12:15], v[236:239]
    v_mfma_f32_16x16x32_bf16 v[236:239], a[68:71], a[48:51], v[236:239]
    s_waitcnt vmcnt(18)
    v_mfma_f32_16x16x32_bf16 v[160:163], a[88:91], a[72:75], v[160:163]
    s_mov_b32 s38, 196608
    buffer_load_dwordx4 a[0:3], v24, s[8:11], s38 offen
    v_mfma_f32_16x16x32_bf16 v[160:163], a[124:127], a[108:111], v[160:163]
    v_mfma_f32_16x16x32_bf16 v[180:183], a[88:91], a[76:79], v[180:183]
    buffer_load_dwordx4 a[4:7], v25, s[8:11], s38 offen
    v_mfma_f32_16x16x32_bf16 v[180:183], a[124:127], a[112:115], v[180:183]
    v_mfma_f32_16x16x32_bf16 v[200:203], a[88:91], a[80:83], v[200:203]
    buffer_load_dwordx4 a[8:11], v26, s[8:11], s38 offen
    v_mfma_f32_16x16x32_bf16 v[200:203], a[124:127], a[116:119], v[200:203]
    v_mfma_f32_16x16x32_bf16 v[220:223], a[88:91], a[84:87], v[220:223]
    buffer_load_dwordx4 a[12:15], v27, s[8:11], s38 offen
    v_mfma_f32_16x16x32_bf16 v[220:223], a[124:127], a[120:123], v[220:223]
    v_mfma_f32_16x16x32_bf16 v[164:167], a[92:95], a[72:75], v[164:167]
    s_mov_b32 s38, 212992
    buffer_load_dwordx4 a[36:39], v24, s[8:11], s38 offen
    v_mfma_f32_16x16x32_bf16 v[164:167], a[128:131], a[108:111], v[164:167]
    v_mfma_f32_16x16x32_bf16 v[184:187], a[92:95], a[76:79], v[184:187]
    buffer_load_dwordx4 a[40:43], v25, s[8:11], s38 offen
    v_mfma_f32_16x16x32_bf16 v[184:187], a[128:131], a[112:115], v[184:187]
    v_mfma_f32_16x16x32_bf16 v[204:207], a[92:95], a[80:83], v[204:207]
    buffer_load_dwordx4 a[44:47], v26, s[8:11], s38 offen
    v_mfma_f32_16x16x32_bf16 v[204:207], a[128:131], a[116:119], v[204:207]
    v_mfma_f32_16x16x32_bf16 v[224:227], a[92:95], a[84:87], v[224:227]
    buffer_load_dwordx4 a[48:51], v27, s[8:11], s38 offen
    v_mfma_f32_16x16x32_bf16 v[224:227], a[128:131], a[120:123], v[224:227]
    v_mfma_f32_16x16x32_bf16 v[168:171], a[96:99], a[72:75], v[168:171]
    s_mov_b32 s39, 245760
    buffer_load_dwordx4 a[16:19], v28, s[12:15], s39 offen offset:0
    v_mfma_f32_16x16x32_bf16 v[168:171], a[132:135], a[108:111], v[168:171]
    v_mfma_f32_16x16x32_bf16 v[188:191], a[96:99], a[76:79], v[188:191]
    buffer_load_dwordx4 a[20:23], v28, s[12:15], s39 offen offset:1024
    v_mfma_f32_16x16x32_bf16 v[188:191], a[132:135], a[112:115], v[188:191]
    v_mfma_f32_16x16x32_bf16 v[208:211], a[96:99], a[80:83], v[208:211]
    buffer_load_dwordx4 a[24:27], v28, s[12:15], s39 offen offset:2048
    v_mfma_f32_16x16x32_bf16 v[208:211], a[132:135], a[116:119], v[208:211]
    v_mfma_f32_16x16x32_bf16 v[228:231], a[96:99], a[84:87], v[228:231]
    buffer_load_dwordx4 a[28:31], v28, s[12:15], s39 offen offset:3072
    v_mfma_f32_16x16x32_bf16 v[228:231], a[132:135], a[120:123], v[228:231]
    v_mfma_f32_16x16x32_bf16 v[172:175], a[100:103], a[72:75], v[172:175]
    buffer_load_dwordx4 a[32:35], v29, s[12:15], s39 offen offset:0
    v_mfma_f32_16x16x32_bf16 v[172:175], a[136:139], a[108:111], v[172:175]
    v_mfma_f32_16x16x32_bf16 v[192:195], a[100:103], a[76:79], v[192:195]
    s_mov_b32 s39, 266240
    buffer_load_dwordx4 a[52:55], v28, s[12:15], s39 offen offset:0
    v_mfma_f32_16x16x32_bf16 v[192:195], a[136:139], a[112:115], v[192:195]
    v_mfma_f32_16x16x32_bf16 v[212:215], a[100:103], a[80:83], v[212:215]
    buffer_load_dwordx4 a[56:59], v28, s[12:15], s39 offen offset:1024
    v_mfma_f32_16x16x32_bf16 v[212:215], a[136:139], a[116:119], v[212:215]
    v_mfma_f32_16x16x32_bf16 v[232:235], a[100:103], a[84:87], v[232:235]
    buffer_load_dwordx4 a[60:63], v28, s[12:15], s39 offen offset:2048
    v_mfma_f32_16x16x32_bf16 v[232:235], a[136:139], a[120:123], v[232:235]
    v_mfma_f32_16x16x32_bf16 v[176:179], a[104:107], a[72:75], v[176:179]
    buffer_load_dwordx4 a[64:67], v28, s[12:15], s39 offen offset:3072
    v_mfma_f32_16x16x32_bf16 v[176:179], a[140:143], a[108:111], v[176:179]
    v_mfma_f32_16x16x32_bf16 v[196:199], a[104:107], a[76:79], v[196:199]
    buffer_load_dwordx4 a[68:71], v29, s[12:15], s39 offen offset:0
    v_mfma_f32_16x16x32_bf16 v[196:199], a[140:143], a[112:115], v[196:199]
    v_mfma_f32_16x16x32_bf16 v[216:219], a[104:107], a[80:83], v[216:219]
    v_mfma_f32_16x16x32_bf16 v[216:219], a[140:143], a[116:119], v[216:219]
    v_mfma_f32_16x16x32_bf16 v[236:239], a[104:107], a[84:87], v[236:239]
    v_mfma_f32_16x16x32_bf16 v[236:239], a[140:143], a[120:123], v[236:239]
    s_waitcnt vmcnt(18)
    v_mfma_f32_16x16x32_bf16 v[160:163], a[160:163], a[144:147], v[160:163]
    s_mov_b32 s38, 229376
    buffer_load_dwordx4 a[72:75], v24, s[8:11], s38 offen
    v_mfma_f32_16x16x32_bf16 v[160:163], a[196:199], a[180:183], v[160:163]
    v_mfma_f32_16x16x32_bf16 v[180:183], a[160:163], a[148:151], v[180:183]
    buffer_load_dwordx4 a[76:79], v25, s[8:11], s38 offen
    v_mfma_f32_16x16x32_bf16 v[180:183], a[196:199], a[184:187], v[180:183]
    v_mfma_f32_16x16x32_bf16 v[200:203], a[160:163], a[152:155], v[200:203]
    buffer_load_dwordx4 a[80:83], v26, s[8:11], s38 offen
    v_mfma_f32_16x16x32_bf16 v[200:203], a[196:199], a[188:191], v[200:203]
    v_mfma_f32_16x16x32_bf16 v[220:223], a[160:163], a[156:159], v[220:223]
    buffer_load_dwordx4 a[84:87], v27, s[8:11], s38 offen
    v_mfma_f32_16x16x32_bf16 v[220:223], a[196:199], a[192:195], v[220:223]
    v_mfma_f32_16x16x32_bf16 v[164:167], a[164:167], a[144:147], v[164:167]
    s_mov_b32 s38, 245760
    buffer_load_dwordx4 a[108:111], v24, s[8:11], s38 offen
    v_mfma_f32_16x16x32_bf16 v[164:167], a[200:203], a[180:183], v[164:167]
    v_mfma_f32_16x16x32_bf16 v[184:187], a[164:167], a[148:151], v[184:187]
    buffer_load_dwordx4 a[112:115], v25, s[8:11], s38 offen
    v_mfma_f32_16x16x32_bf16 v[184:187], a[200:203], a[184:187], v[184:187]
    v_mfma_f32_16x16x32_bf16 v[204:207], a[164:167], a[152:155], v[204:207]
    buffer_load_dwordx4 a[116:119], v26, s[8:11], s38 offen
    v_mfma_f32_16x16x32_bf16 v[204:207], a[200:203], a[188:191], v[204:207]
    v_mfma_f32_16x16x32_bf16 v[224:227], a[164:167], a[156:159], v[224:227]
    buffer_load_dwordx4 a[120:123], v27, s[8:11], s38 offen
    v_mfma_f32_16x16x32_bf16 v[224:227], a[200:203], a[192:195], v[224:227]
    v_mfma_f32_16x16x32_bf16 v[168:171], a[168:171], a[144:147], v[168:171]
    s_mov_b32 s39, 286720
    buffer_load_dwordx4 a[88:91], v28, s[12:15], s39 offen offset:0
    v_mfma_f32_16x16x32_bf16 v[168:171], a[204:207], a[180:183], v[168:171]
    v_mfma_f32_16x16x32_bf16 v[188:191], a[168:171], a[148:151], v[188:191]
    buffer_load_dwordx4 a[92:95], v28, s[12:15], s39 offen offset:1024
    v_mfma_f32_16x16x32_bf16 v[188:191], a[204:207], a[184:187], v[188:191]
    v_mfma_f32_16x16x32_bf16 v[208:211], a[168:171], a[152:155], v[208:211]
    buffer_load_dwordx4 a[96:99], v28, s[12:15], s39 offen offset:2048
    v_mfma_f32_16x16x32_bf16 v[208:211], a[204:207], a[188:191], v[208:211]
    v_mfma_f32_16x16x32_bf16 v[228:231], a[168:171], a[156:159], v[228:231]
    buffer_load_dwordx4 a[100:103], v28, s[12:15], s39 offen offset:3072
    v_mfma_f32_16x16x32_bf16 v[228:231], a[204:207], a[192:195], v[228:231]
    v_mfma_f32_16x16x32_bf16 v[172:175], a[172:175], a[144:147], v[172:175]
    buffer_load_dwordx4 a[104:107], v29, s[12:15], s39 offen offset:0
    v_mfma_f32_16x16x32_bf16 v[172:175], a[208:211], a[180:183], v[172:175]
    v_mfma_f32_16x16x32_bf16 v[192:195], a[172:175], a[148:151], v[192:195]
    s_mov_b32 s39, 307200
    buffer_load_dwordx4 a[124:127], v28, s[12:15], s39 offen offset:0
    v_mfma_f32_16x16x32_bf16 v[192:195], a[208:211], a[184:187], v[192:195]
    v_mfma_f32_16x16x32_bf16 v[212:215], a[172:175], a[152:155], v[212:215]
    buffer_load_dwordx4 a[128:131], v28, s[12:15], s39 offen offset:1024
    v_mfma_f32_16x16x32_bf16 v[212:215], a[208:211], a[188:191], v[212:215]
    v_mfma_f32_16x16x32_bf16 v[232:235], a[172:175], a[156:159], v[232:235]
    buffer_load_dwordx4 a[132:135], v28, s[12:15], s39 offen offset:2048
    v_mfma_f32_16x16x32_bf16 v[232:235], a[208:211], a[192:195], v[232:235]
    v_mfma_f32_16x16x32_bf16 v[176:179], a[176:179], a[144:147], v[176:179]
    buffer_load_dwordx4 a[136:139], v28, s[12:15], s39 offen offset:3072
    v_mfma_f32_16x16x32_bf16 v[176:179], a[212:215], a[180:183], v[176:179]
    v_mfma_f32_16x16x32_bf16 v[196:199], a[176:179], a[148:151], v[196:199]
    buffer_load_dwordx4 a[140:143], v29, s[12:15], s39 offen offset:0
    v_mfma_f32_16x16x32_bf16 v[196:199], a[212:215], a[184:187], v[196:199]
    v_mfma_f32_16x16x32_bf16 v[216:219], a[176:179], a[152:155], v[216:219]
    v_mfma_f32_16x16x32_bf16 v[216:219], a[212:215], a[188:191], v[216:219]
    v_mfma_f32_16x16x32_bf16 v[236:239], a[176:179], a[156:159], v[236:239]
    v_mfma_f32_16x16x32_bf16 v[236:239], a[212:215], a[192:195], v[236:239]
    s_waitcnt vmcnt(18)
    v_mfma_f32_16x16x32_bf16 v[160:163], a[16:19], a[0:3], v[160:163]
    s_mov_b32 s38, 262144
    buffer_load_dwordx4 a[144:147], v24, s[8:11], s38 offen
    v_mfma_f32_16x16x32_bf16 v[160:163], a[52:55], a[36:39], v[160:163]
    v_mfma_f32_16x16x32_bf16 v[180:183], a[16:19], a[4:7], v[180:183]
    buffer_load_dwordx4 a[148:151], v25, s[8:11], s38 offen
    v_mfma_f32_16x16x32_bf16 v[180:183], a[52:55], a[40:43], v[180:183]
    v_mfma_f32_16x16x32_bf16 v[200:203], a[16:19], a[8:11], v[200:203]
    buffer_load_dwordx4 a[152:155], v26, s[8:11], s38 offen
    v_mfma_f32_16x16x32_bf16 v[200:203], a[52:55], a[44:47], v[200:203]
    v_mfma_f32_16x16x32_bf16 v[220:223], a[16:19], a[12:15], v[220:223]
    buffer_load_dwordx4 a[156:159], v27, s[8:11], s38 offen
    v_mfma_f32_16x16x32_bf16 v[220:223], a[52:55], a[48:51], v[220:223]
    v_mfma_f32_16x16x32_bf16 v[164:167], a[20:23], a[0:3], v[164:167]
    s_mov_b32 s38, 278528
    buffer_load_dwordx4 a[180:183], v24, s[8:11], s38 offen
    v_mfma_f32_16x16x32_bf16 v[164:167], a[56:59], a[36:39], v[164:167]
    v_mfma_f32_16x16x32_bf16 v[184:187], a[20:23], a[4:7], v[184:187]
    buffer_load_dwordx4 a[184:187], v25, s[8:11], s38 offen
    v_mfma_f32_16x16x32_bf16 v[184:187], a[56:59], a[40:43], v[184:187]
    v_mfma_f32_16x16x32_bf16 v[204:207], a[20:23], a[8:11], v[204:207]
    buffer_load_dwordx4 a[188:191], v26, s[8:11], s38 offen
    v_mfma_f32_16x16x32_bf16 v[204:207], a[56:59], a[44:47], v[204:207]
    v_mfma_f32_16x16x32_bf16 v[224:227], a[20:23], a[12:15], v[224:227]
    buffer_load_dwordx4 a[192:195], v27, s[8:11], s38 offen
    v_mfma_f32_16x16x32_bf16 v[224:227], a[56:59], a[48:51], v[224:227]
    v_mfma_f32_16x16x32_bf16 v[168:171], a[24:27], a[0:3], v[168:171]
    s_mov_b32 s39, 327680
    buffer_load_dwordx4 a[160:163], v28, s[12:15], s39 offen offset:0
    v_mfma_f32_16x16x32_bf16 v[168:171], a[60:63], a[36:39], v[168:171]
    v_mfma_f32_16x16x32_bf16 v[188:191], a[24:27], a[4:7], v[188:191]
    buffer_load_dwordx4 a[164:167], v28, s[12:15], s39 offen offset:1024
    v_mfma_f32_16x16x32_bf16 v[188:191], a[60:63], a[40:43], v[188:191]
    v_mfma_f32_16x16x32_bf16 v[208:211], a[24:27], a[8:11], v[208:211]
    buffer_load_dwordx4 a[168:171], v28, s[12:15], s39 offen offset:2048
    v_mfma_f32_16x16x32_bf16 v[208:211], a[60:63], a[44:47], v[208:211]
    v_mfma_f32_16x16x32_bf16 v[228:231], a[24:27], a[12:15], v[228:231]
    buffer_load_dwordx4 a[172:175], v28, s[12:15], s39 offen offset:3072
    v_mfma_f32_16x16x32_bf16 v[228:231], a[60:63], a[48:51], v[228:231]
    v_mfma_f32_16x16x32_bf16 v[172:175], a[28:31], a[0:3], v[172:175]
    buffer_load_dwordx4 a[176:179], v29, s[12:15], s39 offen offset:0
    v_mfma_f32_16x16x32_bf16 v[172:175], a[64:67], a[36:39], v[172:175]
    v_mfma_f32_16x16x32_bf16 v[192:195], a[28:31], a[4:7], v[192:195]
    s_mov_b32 s39, 348160
    buffer_load_dwordx4 a[196:199], v28, s[12:15], s39 offen offset:0
    v_mfma_f32_16x16x32_bf16 v[192:195], a[64:67], a[40:43], v[192:195]
    v_mfma_f32_16x16x32_bf16 v[212:215], a[28:31], a[8:11], v[212:215]
    buffer_load_dwordx4 a[200:203], v28, s[12:15], s39 offen offset:1024
    v_mfma_f32_16x16x32_bf16 v[212:215], a[64:67], a[44:47], v[212:215]
    v_mfma_f32_16x16x32_bf16 v[232:235], a[28:31], a[12:15], v[232:235]
    buffer_load_dwordx4 a[204:207], v28, s[12:15], s39 offen offset:2048
    v_mfma_f32_16x16x32_bf16 v[232:235], a[64:67], a[48:51], v[232:235]
    v_mfma_f32_16x16x32_bf16 v[176:179], a[32:35], a[0:3], v[176:179]
    buffer_load_dwordx4 a[208:211], v28, s[12:15], s39 offen offset:3072
    v_mfma_f32_16x16x32_bf16 v[176:179], a[68:71], a[36:39], v[176:179]
    v_mfma_f32_16x16x32_bf16 v[196:199], a[32:35], a[4:7], v[196:199]
    buffer_load_dwordx4 a[212:215], v29, s[12:15], s39 offen offset:0
    v_mfma_f32_16x16x32_bf16 v[196:199], a[68:71], a[40:43], v[196:199]
    v_mfma_f32_16x16x32_bf16 v[216:219], a[32:35], a[8:11], v[216:219]
    v_mfma_f32_16x16x32_bf16 v[216:219], a[68:71], a[44:47], v[216:219]
    v_mfma_f32_16x16x32_bf16 v[236:239], a[32:35], a[12:15], v[236:239]
    v_mfma_f32_16x16x32_bf16 v[236:239], a[68:71], a[48:51], v[236:239]
    s_waitcnt vmcnt(18)
    v_mfma_f32_16x16x32_bf16 v[160:163], a[88:91], a[72:75], v[160:163]
    s_mov_b32 s38, 294912
    buffer_load_dwordx4 a[0:3], v24, s[8:11], s38 offen
    v_mfma_f32_16x16x32_bf16 v[160:163], a[124:127], a[108:111], v[160:163]
    v_mfma_f32_16x16x32_bf16 v[180:183], a[88:91], a[76:79], v[180:183]
    buffer_load_dwordx4 a[4:7], v25, s[8:11], s38 offen
    v_mfma_f32_16x16x32_bf16 v[180:183], a[124:127], a[112:115], v[180:183]
    v_mfma_f32_16x16x32_bf16 v[200:203], a[88:91], a[80:83], v[200:203]
    buffer_load_dwordx4 a[8:11], v26, s[8:11], s38 offen
    v_mfma_f32_16x16x32_bf16 v[200:203], a[124:127], a[116:119], v[200:203]
    v_mfma_f32_16x16x32_bf16 v[220:223], a[88:91], a[84:87], v[220:223]
    buffer_load_dwordx4 a[12:15], v27, s[8:11], s38 offen
    v_mfma_f32_16x16x32_bf16 v[220:223], a[124:127], a[120:123], v[220:223]
    v_mfma_f32_16x16x32_bf16 v[164:167], a[92:95], a[72:75], v[164:167]
    s_mov_b32 s38, 311296
    buffer_load_dwordx4 a[36:39], v24, s[8:11], s38 offen
    v_mfma_f32_16x16x32_bf16 v[164:167], a[128:131], a[108:111], v[164:167]
    v_mfma_f32_16x16x32_bf16 v[184:187], a[92:95], a[76:79], v[184:187]
    buffer_load_dwordx4 a[40:43], v25, s[8:11], s38 offen
    v_mfma_f32_16x16x32_bf16 v[184:187], a[128:131], a[112:115], v[184:187]
    v_mfma_f32_16x16x32_bf16 v[204:207], a[92:95], a[80:83], v[204:207]
    buffer_load_dwordx4 a[44:47], v26, s[8:11], s38 offen
    v_mfma_f32_16x16x32_bf16 v[204:207], a[128:131], a[116:119], v[204:207]
    v_mfma_f32_16x16x32_bf16 v[224:227], a[92:95], a[84:87], v[224:227]
    buffer_load_dwordx4 a[48:51], v27, s[8:11], s38 offen
    v_mfma_f32_16x16x32_bf16 v[224:227], a[128:131], a[120:123], v[224:227]
    v_mfma_f32_16x16x32_bf16 v[168:171], a[96:99], a[72:75], v[168:171]
    s_mov_b32 s39, 368640
    buffer_load_dwordx4 a[16:19], v28, s[12:15], s39 offen offset:0
    v_mfma_f32_16x16x32_bf16 v[168:171], a[132:135], a[108:111], v[168:171]
    v_mfma_f32_16x16x32_bf16 v[188:191], a[96:99], a[76:79], v[188:191]
    buffer_load_dwordx4 a[20:23], v28, s[12:15], s39 offen offset:1024
    v_mfma_f32_16x16x32_bf16 v[188:191], a[132:135], a[112:115], v[188:191]
    v_mfma_f32_16x16x32_bf16 v[208:211], a[96:99], a[80:83], v[208:211]
    buffer_load_dwordx4 a[24:27], v28, s[12:15], s39 offen offset:2048
    v_mfma_f32_16x16x32_bf16 v[208:211], a[132:135], a[116:119], v[208:211]
    v_mfma_f32_16x16x32_bf16 v[228:231], a[96:99], a[84:87], v[228:231]
    buffer_load_dwordx4 a[28:31], v28, s[12:15], s39 offen offset:3072
    v_mfma_f32_16x16x32_bf16 v[228:231], a[132:135], a[120:123], v[228:231]
    v_mfma_f32_16x16x32_bf16 v[172:175], a[100:103], a[72:75], v[172:175]
    buffer_load_dwordx4 a[32:35], v29, s[12:15], s39 offen offset:0
    v_mfma_f32_16x16x32_bf16 v[172:175], a[136:139], a[108:111], v[172:175]
    v_mfma_f32_16x16x32_bf16 v[192:195], a[100:103], a[76:79], v[192:195]
    s_mov_b32 s39, 389120
    buffer_load_dwordx4 a[52:55], v28, s[12:15], s39 offen offset:0
    v_mfma_f32_16x16x32_bf16 v[192:195], a[136:139], a[112:115], v[192:195]
    v_mfma_f32_16x16x32_bf16 v[212:215], a[100:103], a[80:83], v[212:215]
    buffer_load_dwordx4 a[56:59], v28, s[12:15], s39 offen offset:1024
    v_mfma_f32_16x16x32_bf16 v[212:215], a[136:139], a[116:119], v[212:215]
    v_mfma_f32_16x16x32_bf16 v[232:235], a[100:103], a[84:87], v[232:235]
    buffer_load_dwordx4 a[60:63], v28, s[12:15], s39 offen offset:2048
    v_mfma_f32_16x16x32_bf16 v[232:235], a[136:139], a[120:123], v[232:235]
    v_mfma_f32_16x16x32_bf16 v[176:179], a[104:107], a[72:75], v[176:179]
    buffer_load_dwordx4 a[64:67], v28, s[12:15], s39 offen offset:3072
    v_mfma_f32_16x16x32_bf16 v[176:179], a[140:143], a[108:111], v[176:179]
    v_mfma_f32_16x16x32_bf16 v[196:199], a[104:107], a[76:79], v[196:199]
    buffer_load_dwordx4 a[68:71], v29, s[12:15], s39 offen offset:0
    v_mfma_f32_16x16x32_bf16 v[196:199], a[140:143], a[112:115], v[196:199]
    v_mfma_f32_16x16x32_bf16 v[216:219], a[104:107], a[80:83], v[216:219]
    v_mfma_f32_16x16x32_bf16 v[216:219], a[140:143], a[116:119], v[216:219]
    v_mfma_f32_16x16x32_bf16 v[236:239], a[104:107], a[84:87], v[236:239]
    v_mfma_f32_16x16x32_bf16 v[236:239], a[140:143], a[120:123], v[236:239]
    s_waitcnt vmcnt(18)
    v_mfma_f32_16x16x32_bf16 v[160:163], a[160:163], a[144:147], v[160:163]
    s_mov_b32 s38, 327680
    buffer_load_dwordx4 a[72:75], v24, s[8:11], s38 offen
    v_mfma_f32_16x16x32_bf16 v[160:163], a[196:199], a[180:183], v[160:163]
    v_mfma_f32_16x16x32_bf16 v[180:183], a[160:163], a[148:151], v[180:183]
    buffer_load_dwordx4 a[76:79], v25, s[8:11], s38 offen
    v_mfma_f32_16x16x32_bf16 v[180:183], a[196:199], a[184:187], v[180:183]
    v_mfma_f32_16x16x32_bf16 v[200:203], a[160:163], a[152:155], v[200:203]
    buffer_load_dwordx4 a[80:83], v26, s[8:11], s38 offen
    v_mfma_f32_16x16x32_bf16 v[200:203], a[196:199], a[188:191], v[200:203]
    v_mfma_f32_16x16x32_bf16 v[220:223], a[160:163], a[156:159], v[220:223]
    buffer_load_dwordx4 a[84:87], v27, s[8:11], s38 offen
    v_mfma_f32_16x16x32_bf16 v[220:223], a[196:199], a[192:195], v[220:223]
    v_mfma_f32_16x16x32_bf16 v[164:167], a[164:167], a[144:147], v[164:167]
    s_mov_b32 s38, 344064
    buffer_load_dwordx4 a[108:111], v24, s[8:11], s38 offen
    v_mfma_f32_16x16x32_bf16 v[164:167], a[200:203], a[180:183], v[164:167]
    v_mfma_f32_16x16x32_bf16 v[184:187], a[164:167], a[148:151], v[184:187]
    buffer_load_dwordx4 a[112:115], v25, s[8:11], s38 offen
    v_mfma_f32_16x16x32_bf16 v[184:187], a[200:203], a[184:187], v[184:187]
    v_mfma_f32_16x16x32_bf16 v[204:207], a[164:167], a[152:155], v[204:207]
    buffer_load_dwordx4 a[116:119], v26, s[8:11], s38 offen
    v_mfma_f32_16x16x32_bf16 v[204:207], a[200:203], a[188:191], v[204:207]
    v_mfma_f32_16x16x32_bf16 v[224:227], a[164:167], a[156:159], v[224:227]
    buffer_load_dwordx4 a[120:123], v27, s[8:11], s38 offen
    v_mfma_f32_16x16x32_bf16 v[224:227], a[200:203], a[192:195], v[224:227]
    v_mfma_f32_16x16x32_bf16 v[168:171], a[168:171], a[144:147], v[168:171]
    s_mov_b32 s39, 409600
    buffer_load_dwordx4 a[88:91], v28, s[12:15], s39 offen offset:0
    v_mfma_f32_16x16x32_bf16 v[168:171], a[204:207], a[180:183], v[168:171]
    v_mfma_f32_16x16x32_bf16 v[188:191], a[168:171], a[148:151], v[188:191]
    buffer_load_dwordx4 a[92:95], v28, s[12:15], s39 offen offset:1024
    v_mfma_f32_16x16x32_bf16 v[188:191], a[204:207], a[184:187], v[188:191]
    v_mfma_f32_16x16x32_bf16 v[208:211], a[168:171], a[152:155], v[208:211]
    buffer_load_dwordx4 a[96:99], v28, s[12:15], s39 offen offset:2048
    v_mfma_f32_16x16x32_bf16 v[208:211], a[204:207], a[188:191], v[208:211]
    v_mfma_f32_16x16x32_bf16 v[228:231], a[168:171], a[156:159], v[228:231]
    buffer_load_dwordx4 a[100:103], v28, s[12:15], s39 offen offset:3072
    v_mfma_f32_16x16x32_bf16 v[228:231], a[204:207], a[192:195], v[228:231]
    v_mfma_f32_16x16x32_bf16 v[172:175], a[172:175], a[144:147], v[172:175]
    buffer_load_dwordx4 a[104:107], v29, s[12:15], s39 offen offset:0
    v_mfma_f32_16x16x32_bf16 v[172:175], a[208:211], a[180:183], v[172:175]
    v_mfma_f32_16x16x32_bf16 v[192:195], a[172:175], a[148:151], v[192:195]
    s_mov_b32 s39, 430080
    buffer_load_dwordx4 a[124:127], v28, s[12:15], s39 offen offset:0
    v_mfma_f32_16x16x32_bf16 v[192:195], a[208:211], a[184:187], v[192:195]
    v_mfma_f32_16x16x32_bf16 v[212:215], a[172:175], a[152:155], v[212:215]
    buffer_load_dwordx4 a[128:131], v28, s[12:15], s39 offen offset:1024
    v_mfma_f32_16x16x32_bf16 v[212:215], a[208:211], a[188:191], v[212:215]
    v_mfma_f32_16x16x32_bf16 v[232:235], a[172:175], a[156:159], v[232:235]
    buffer_load_dwordx4 a[132:135], v28, s[12:15], s39 offen offset:2048
    v_mfma_f32_16x16x32_bf16 v[232:235], a[208:211], a[192:195], v[232:235]
    v_mfma_f32_16x16x32_bf16 v[176:179], a[176:179], a[144:147], v[176:179]
    buffer_load_dwordx4 a[136:139], v28, s[12:15], s39 offen offset:3072
    v_mfma_f32_16x16x32_bf16 v[176:179], a[212:215], a[180:183], v[176:179]
    v_mfma_f32_16x16x32_bf16 v[196:199], a[176:179], a[148:151], v[196:199]
    buffer_load_dwordx4 a[140:143], v29, s[12:15], s39 offen offset:0
    v_mfma_f32_16x16x32_bf16 v[196:199], a[212:215], a[184:187], v[196:199]
    v_mfma_f32_16x16x32_bf16 v[216:219], a[176:179], a[152:155], v[216:219]
    v_mfma_f32_16x16x32_bf16 v[216:219], a[212:215], a[188:191], v[216:219]
    v_mfma_f32_16x16x32_bf16 v[236:239], a[176:179], a[156:159], v[236:239]
    v_mfma_f32_16x16x32_bf16 v[236:239], a[212:215], a[192:195], v[236:239]
    s_waitcnt vmcnt(18)
    v_mfma_f32_16x16x32_bf16 v[160:163], a[16:19], a[0:3], v[160:163]
    s_mov_b32 s38, 360448
    buffer_load_dwordx4 a[144:147], v24, s[8:11], s38 offen
    v_mfma_f32_16x16x32_bf16 v[160:163], a[52:55], a[36:39], v[160:163]
    v_mfma_f32_16x16x32_bf16 v[180:183], a[16:19], a[4:7], v[180:183]
    buffer_load_dwordx4 a[148:151], v25, s[8:11], s38 offen
    v_mfma_f32_16x16x32_bf16 v[180:183], a[52:55], a[40:43], v[180:183]
    v_mfma_f32_16x16x32_bf16 v[200:203], a[16:19], a[8:11], v[200:203]
    buffer_load_dwordx4 a[152:155], v26, s[8:11], s38 offen
    v_mfma_f32_16x16x32_bf16 v[200:203], a[52:55], a[44:47], v[200:203]
    v_mfma_f32_16x16x32_bf16 v[220:223], a[16:19], a[12:15], v[220:223]
    buffer_load_dwordx4 a[156:159], v27, s[8:11], s38 offen
    v_mfma_f32_16x16x32_bf16 v[220:223], a[52:55], a[48:51], v[220:223]
    v_mfma_f32_16x16x32_bf16 v[164:167], a[20:23], a[0:3], v[164:167]
    s_mov_b32 s38, 376832
    buffer_load_dwordx4 a[180:183], v24, s[8:11], s38 offen
    v_mfma_f32_16x16x32_bf16 v[164:167], a[56:59], a[36:39], v[164:167]
    v_mfma_f32_16x16x32_bf16 v[184:187], a[20:23], a[4:7], v[184:187]
    buffer_load_dwordx4 a[184:187], v25, s[8:11], s38 offen
    v_mfma_f32_16x16x32_bf16 v[184:187], a[56:59], a[40:43], v[184:187]
    v_mfma_f32_16x16x32_bf16 v[204:207], a[20:23], a[8:11], v[204:207]
    buffer_load_dwordx4 a[188:191], v26, s[8:11], s38 offen
    v_mfma_f32_16x16x32_bf16 v[204:207], a[56:59], a[44:47], v[204:207]
    v_mfma_f32_16x16x32_bf16 v[224:227], a[20:23], a[12:15], v[224:227]
    buffer_load_dwordx4 a[192:195], v27, s[8:11], s38 offen
    v_mfma_f32_16x16x32_bf16 v[224:227], a[56:59], a[48:51], v[224:227]
    v_mfma_f32_16x16x32_bf16 v[168:171], a[24:27], a[0:3], v[168:171]
    s_mov_b32 s39, 450560
    buffer_load_dwordx4 a[160:163], v28, s[12:15], s39 offen offset:0
    v_mfma_f32_16x16x32_bf16 v[168:171], a[60:63], a[36:39], v[168:171]
    v_mfma_f32_16x16x32_bf16 v[188:191], a[24:27], a[4:7], v[188:191]
    buffer_load_dwordx4 a[164:167], v28, s[12:15], s39 offen offset:1024
    v_mfma_f32_16x16x32_bf16 v[188:191], a[60:63], a[40:43], v[188:191]
    v_mfma_f32_16x16x32_bf16 v[208:211], a[24:27], a[8:11], v[208:211]
    buffer_load_dwordx4 a[168:171], v28, s[12:15], s39 offen offset:2048
    v_mfma_f32_16x16x32_bf16 v[208:211], a[60:63], a[44:47], v[208:211]
    v_mfma_f32_16x16x32_bf16 v[228:231], a[24:27], a[12:15], v[228:231]
    buffer_load_dwordx4 a[172:175], v28, s[12:15], s39 offen offset:3072
    v_mfma_f32_16x16x32_bf16 v[228:231], a[60:63], a[48:51], v[228:231]
    v_mfma_f32_16x16x32_bf16 v[172:175], a[28:31], a[0:3], v[172:175]
    buffer_load_dwordx4 a[176:179], v29, s[12:15], s39 offen offset:0
    v_mfma_f32_16x16x32_bf16 v[172:175], a[64:67], a[36:39], v[172:175]
    v_mfma_f32_16x16x32_bf16 v[192:195], a[28:31], a[4:7], v[192:195]
    s_mov_b32 s39, 471040
    buffer_load_dwordx4 a[196:199], v28, s[12:15], s39 offen offset:0
    v_mfma_f32_16x16x32_bf16 v[192:195], a[64:67], a[40:43], v[192:195]
    v_mfma_f32_16x16x32_bf16 v[212:215], a[28:31], a[8:11], v[212:215]
    buffer_load_dwordx4 a[200:203], v28, s[12:15], s39 offen offset:1024
    v_mfma_f32_16x16x32_bf16 v[212:215], a[64:67], a[44:47], v[212:215]
    v_mfma_f32_16x16x32_bf16 v[232:235], a[28:31], a[12:15], v[232:235]
    buffer_load_dwordx4 a[204:207], v28, s[12:15], s39 offen offset:2048
    v_mfma_f32_16x16x32_bf16 v[232:235], a[64:67], a[48:51], v[232:235]
    v_mfma_f32_16x16x32_bf16 v[176:179], a[32:35], a[0:3], v[176:179]
    buffer_load_dwordx4 a[208:211], v28, s[12:15], s39 offen offset:3072
    v_mfma_f32_16x16x32_bf16 v[176:179], a[68:71], a[36:39], v[176:179]
    v_mfma_f32_16x16x32_bf16 v[196:199], a[32:35], a[4:7], v[196:199]
    buffer_load_dwordx4 a[212:215], v29, s[12:15], s39 offen offset:0
    v_mfma_f32_16x16x32_bf16 v[196:199], a[68:71], a[40:43], v[196:199]
    v_mfma_f32_16x16x32_bf16 v[216:219], a[32:35], a[8:11], v[216:219]
    v_mfma_f32_16x16x32_bf16 v[216:219], a[68:71], a[44:47], v[216:219]
    v_mfma_f32_16x16x32_bf16 v[236:239], a[32:35], a[12:15], v[236:239]
    v_mfma_f32_16x16x32_bf16 v[236:239], a[68:71], a[48:51], v[236:239]
    s_waitcnt vmcnt(18)
    v_mfma_f32_16x16x32_bf16 v[160:163], a[88:91], a[72:75], v[160:163]
    s_mov_b32 s38, 393216
    buffer_load_dwordx4 a[0:3], v24, s[8:11], s38 offen
    v_mfma_f32_16x16x32_bf16 v[160:163], a[124:127], a[108:111], v[160:163]
    v_mfma_f32_16x16x32_bf16 v[180:183], a[88:91], a[76:79], v[180:183]
    buffer_load_dwordx4 a[4:7], v25, s[8:11], s38 offen
    v_mfma_f32_16x16x32_bf16 v[180:183], a[124:127], a[112:115], v[180:183]
    v_mfma_f32_16x16x32_bf16 v[200:203], a[88:91], a[80:83], v[200:203]
    buffer_load_dwordx4 a[8:11], v26, s[8:11], s38 offen
    v_mfma_f32_16x16x32_bf16 v[200:203], a[124:127], a[116:119], v[200:203]
    v_mfma_f32_16x16x32_bf16 v[220:223], a[88:91], a[84:87], v[220:223]
    buffer_load_dwordx4 a[12:15], v27, s[8:11], s38 offen
    v_mfma_f32_16x16x32_bf16 v[220:223], a[124:127], a[120:123], v[220:223]
    v_mfma_f32_16x16x32_bf16 v[164:167], a[92:95], a[72:75], v[164:167]
    s_mov_b32 s38, 409600
    buffer_load_dwordx4 a[36:39], v24, s[8:11], s38 offen
    v_mfma_f32_16x16x32_bf16 v[164:167], a[128:131], a[108:111], v[164:167]
    v_mfma_f32_16x16x32_bf16 v[184:187], a[92:95], a[76:79], v[184:187]
    buffer_load_dwordx4 a[40:43], v25, s[8:11], s38 offen
    v_mfma_f32_16x16x32_bf16 v[184:187], a[128:131], a[112:115], v[184:187]
    v_mfma_f32_16x16x32_bf16 v[204:207], a[92:95], a[80:83], v[204:207]
    buffer_load_dwordx4 a[44:47], v26, s[8:11], s38 offen
    v_mfma_f32_16x16x32_bf16 v[204:207], a[128:131], a[116:119], v[204:207]
    v_mfma_f32_16x16x32_bf16 v[224:227], a[92:95], a[84:87], v[224:227]
    buffer_load_dwordx4 a[48:51], v27, s[8:11], s38 offen
    v_mfma_f32_16x16x32_bf16 v[224:227], a[128:131], a[120:123], v[224:227]
    v_mfma_f32_16x16x32_bf16 v[168:171], a[96:99], a[72:75], v[168:171]
    s_mov_b32 s39, 491520
    buffer_load_dwordx4 a[16:19], v28, s[12:15], s39 offen offset:0
    v_mfma_f32_16x16x32_bf16 v[168:171], a[132:135], a[108:111], v[168:171]
    v_mfma_f32_16x16x32_bf16 v[188:191], a[96:99], a[76:79], v[188:191]
    buffer_load_dwordx4 a[20:23], v28, s[12:15], s39 offen offset:1024
    v_mfma_f32_16x16x32_bf16 v[188:191], a[132:135], a[112:115], v[188:191]
    v_mfma_f32_16x16x32_bf16 v[208:211], a[96:99], a[80:83], v[208:211]
    buffer_load_dwordx4 a[24:27], v28, s[12:15], s39 offen offset:2048
    v_mfma_f32_16x16x32_bf16 v[208:211], a[132:135], a[116:119], v[208:211]
    v_mfma_f32_16x16x32_bf16 v[228:231], a[96:99], a[84:87], v[228:231]
    buffer_load_dwordx4 a[28:31], v28, s[12:15], s39 offen offset:3072
    v_mfma_f32_16x16x32_bf16 v[228:231], a[132:135], a[120:123], v[228:231]
    v_mfma_f32_16x16x32_bf16 v[172:175], a[100:103], a[72:75], v[172:175]
    buffer_load_dwordx4 a[32:35], v29, s[12:15], s39 offen offset:0
    v_mfma_f32_16x16x32_bf16 v[172:175], a[136:139], a[108:111], v[172:175]
    v_mfma_f32_16x16x32_bf16 v[192:195], a[100:103], a[76:79], v[192:195]
    s_mov_b32 s39, 512000
    buffer_load_dwordx4 a[52:55], v28, s[12:15], s39 offen offset:0
    v_mfma_f32_16x16x32_bf16 v[192:195], a[136:139], a[112:115], v[192:195]
    v_mfma_f32_16x16x32_bf16 v[212:215], a[100:103], a[80:83], v[212:215]
    buffer_load_dwordx4 a[56:59], v28, s[12:15], s39 offen offset:1024
    v_mfma_f32_16x16x32_bf16 v[212:215], a[136:139], a[116:119], v[212:215]
    v_mfma_f32_16x16x32_bf16 v[232:235], a[100:103], a[84:87], v[232:235]
    buffer_load_dwordx4 a[60:63], v28, s[12:15], s39 offen offset:2048
    v_mfma_f32_16x16x32_bf16 v[232:235], a[136:139], a[120:123], v[232:235]
    v_mfma_f32_16x16x32_bf16 v[176:179], a[104:107], a[72:75], v[176:179]
    buffer_load_dwordx4 a[64:67], v28, s[12:15], s39 offen offset:3072
    v_mfma_f32_16x16x32_bf16 v[176:179], a[140:143], a[108:111], v[176:179]
    v_mfma_f32_16x16x32_bf16 v[196:199], a[104:107], a[76:79], v[196:199]
    buffer_load_dwordx4 a[68:71], v29, s[12:15], s39 offen offset:0
    v_mfma_f32_16x16x32_bf16 v[196:199], a[140:143], a[112:115], v[196:199]
    v_mfma_f32_16x16x32_bf16 v[216:219], a[104:107], a[80:83], v[216:219]
    v_mfma_f32_16x16x32_bf16 v[216:219], a[140:143], a[116:119], v[216:219]
    v_mfma_f32_16x16x32_bf16 v[236:239], a[104:107], a[84:87], v[236:239]
    v_mfma_f32_16x16x32_bf16 v[236:239], a[140:143], a[120:123], v[236:239]
    s_waitcnt vmcnt(18)
    v_mfma_f32_16x16x32_bf16 v[160:163], a[160:163], a[144:147], v[160:163]
    s_mov_b32 s38, 425984
    buffer_load_dwordx4 a[72:75], v24, s[8:11], s38 offen
    v_mfma_f32_16x16x32_bf16 v[160:163], a[196:199], a[180:183], v[160:163]
    v_mfma_f32_16x16x32_bf16 v[180:183], a[160:163], a[148:151], v[180:183]
    buffer_load_dwordx4 a[76:79], v25, s[8:11], s38 offen
    v_mfma_f32_16x16x32_bf16 v[180:183], a[196:199], a[184:187], v[180:183]
    v_mfma_f32_16x16x32_bf16 v[200:203], a[160:163], a[152:155], v[200:203]
    buffer_load_dwordx4 a[80:83], v26, s[8:11], s38 offen
    v_mfma_f32_16x16x32_bf16 v[200:203], a[196:199], a[188:191], v[200:203]
    v_mfma_f32_16x16x32_bf16 v[220:223], a[160:163], a[156:159], v[220:223]
    buffer_load_dwordx4 a[84:87], v27, s[8:11], s38 offen
    v_mfma_f32_16x16x32_bf16 v[220:223], a[196:199], a[192:195], v[220:223]
    v_mfma_f32_16x16x32_bf16 v[164:167], a[164:167], a[144:147], v[164:167]
    s_mov_b32 s38, 442368
    buffer_load_dwordx4 a[108:111], v24, s[8:11], s38 offen
    v_mfma_f32_16x16x32_bf16 v[164:167], a[200:203], a[180:183], v[164:167]
    v_mfma_f32_16x16x32_bf16 v[184:187], a[164:167], a[148:151], v[184:187]
    buffer_load_dwordx4 a[112:115], v25, s[8:11], s38 offen
    v_mfma_f32_16x16x32_bf16 v[184:187], a[200:203], a[184:187], v[184:187]
    v_mfma_f32_16x16x32_bf16 v[204:207], a[164:167], a[152:155], v[204:207]
    buffer_load_dwordx4 a[116:119], v26, s[8:11], s38 offen
    v_mfma_f32_16x16x32_bf16 v[204:207], a[200:203], a[188:191], v[204:207]
    v_mfma_f32_16x16x32_bf16 v[224:227], a[164:167], a[156:159], v[224:227]
    buffer_load_dwordx4 a[120:123], v27, s[8:11], s38 offen
    v_mfma_f32_16x16x32_bf16 v[224:227], a[200:203], a[192:195], v[224:227]
    v_mfma_f32_16x16x32_bf16 v[168:171], a[168:171], a[144:147], v[168:171]
    s_mov_b32 s39, 532480
    buffer_load_dwordx4 a[88:91], v28, s[12:15], s39 offen offset:0
    v_mfma_f32_16x16x32_bf16 v[168:171], a[204:207], a[180:183], v[168:171]
    v_mfma_f32_16x16x32_bf16 v[188:191], a[168:171], a[148:151], v[188:191]
    buffer_load_dwordx4 a[92:95], v28, s[12:15], s39 offen offset:1024
    v_mfma_f32_16x16x32_bf16 v[188:191], a[204:207], a[184:187], v[188:191]
    v_mfma_f32_16x16x32_bf16 v[208:211], a[168:171], a[152:155], v[208:211]
    buffer_load_dwordx4 a[96:99], v28, s[12:15], s39 offen offset:2048
    v_mfma_f32_16x16x32_bf16 v[208:211], a[204:207], a[188:191], v[208:211]
    v_mfma_f32_16x16x32_bf16 v[228:231], a[168:171], a[156:159], v[228:231]
    buffer_load_dwordx4 a[100:103], v28, s[12:15], s39 offen offset:3072
    v_mfma_f32_16x16x32_bf16 v[228:231], a[204:207], a[192:195], v[228:231]
    v_mfma_f32_16x16x32_bf16 v[172:175], a[172:175], a[144:147], v[172:175]
    buffer_load_dwordx4 a[104:107], v29, s[12:15], s39 offen offset:0
    v_mfma_f32_16x16x32_bf16 v[172:175], a[208:211], a[180:183], v[172:175]
    v_mfma_f32_16x16x32_bf16 v[192:195], a[172:175], a[148:151], v[192:195]
    s_mov_b32 s39, 552960
    buffer_load_dwordx4 a[124:127], v28, s[12:15], s39 offen offset:0
    v_mfma_f32_16x16x32_bf16 v[192:195], a[208:211], a[184:187], v[192:195]
    v_mfma_f32_16x16x32_bf16 v[212:215], a[172:175], a[152:155], v[212:215]
    buffer_load_dwordx4 a[128:131], v28, s[12:15], s39 offen offset:1024
    v_mfma_f32_16x16x32_bf16 v[212:215], a[208:211], a[188:191], v[212:215]
    v_mfma_f32_16x16x32_bf16 v[232:235], a[172:175], a[156:159], v[232:235]
    buffer_load_dwordx4 a[132:135], v28, s[12:15], s39 offen offset:2048
    v_mfma_f32_16x16x32_bf16 v[232:235], a[208:211], a[192:195], v[232:235]
    v_mfma_f32_16x16x32_bf16 v[176:179], a[176:179], a[144:147], v[176:179]
    buffer_load_dwordx4 a[136:139], v28, s[12:15], s39 offen offset:3072
    v_mfma_f32_16x16x32_bf16 v[176:179], a[212:215], a[180:183], v[176:179]
    v_mfma_f32_16x16x32_bf16 v[196:199], a[176:179], a[148:151], v[196:199]
    buffer_load_dwordx4 a[140:143], v29, s[12:15], s39 offen offset:0
    v_mfma_f32_16x16x32_bf16 v[196:199], a[212:215], a[184:187], v[196:199]
    v_mfma_f32_16x16x32_bf16 v[216:219], a[176:179], a[152:155], v[216:219]
    v_mfma_f32_16x16x32_bf16 v[216:219], a[212:215], a[188:191], v[216:219]
    v_mfma_f32_16x16x32_bf16 v[236:239], a[176:179], a[156:159], v[236:239]
    v_mfma_f32_16x16x32_bf16 v[236:239], a[212:215], a[192:195], v[236:239]
    s_waitcnt vmcnt(18)
    v_mfma_f32_16x16x32_bf16 v[160:163], a[16:19], a[0:3], v[160:163]
    s_mov_b32 s38, 458752
    buffer_load_dwordx4 a[144:147], v24, s[8:11], s38 offen
    v_mfma_f32_16x16x32_bf16 v[160:163], a[52:55], a[36:39], v[160:163]
    v_mfma_f32_16x16x32_bf16 v[180:183], a[16:19], a[4:7], v[180:183]
    buffer_load_dwordx4 a[148:151], v25, s[8:11], s38 offen
    v_mfma_f32_16x16x32_bf16 v[180:183], a[52:55], a[40:43], v[180:183]
    v_mfma_f32_16x16x32_bf16 v[200:203], a[16:19], a[8:11], v[200:203]
    buffer_load_dwordx4 a[152:155], v26, s[8:11], s38 offen
    v_mfma_f32_16x16x32_bf16 v[200:203], a[52:55], a[44:47], v[200:203]
    v_mfma_f32_16x16x32_bf16 v[220:223], a[16:19], a[12:15], v[220:223]
    buffer_load_dwordx4 a[156:159], v27, s[8:11], s38 offen
    v_mfma_f32_16x16x32_bf16 v[220:223], a[52:55], a[48:51], v[220:223]
    v_mfma_f32_16x16x32_bf16 v[164:167], a[20:23], a[0:3], v[164:167]
    s_mov_b32 s38, 475136
    buffer_load_dwordx4 a[180:183], v24, s[8:11], s38 offen
    v_mfma_f32_16x16x32_bf16 v[164:167], a[56:59], a[36:39], v[164:167]
    v_mfma_f32_16x16x32_bf16 v[184:187], a[20:23], a[4:7], v[184:187]
    buffer_load_dwordx4 a[184:187], v25, s[8:11], s38 offen
    v_mfma_f32_16x16x32_bf16 v[184:187], a[56:59], a[40:43], v[184:187]
    v_mfma_f32_16x16x32_bf16 v[204:207], a[20:23], a[8:11], v[204:207]
    buffer_load_dwordx4 a[188:191], v26, s[8:11], s38 offen
    v_mfma_f32_16x16x32_bf16 v[204:207], a[56:59], a[44:47], v[204:207]
    v_mfma_f32_16x16x32_bf16 v[224:227], a[20:23], a[12:15], v[224:227]
    buffer_load_dwordx4 a[192:195], v27, s[8:11], s38 offen
    v_mfma_f32_16x16x32_bf16 v[224:227], a[56:59], a[48:51], v[224:227]
    v_mfma_f32_16x16x32_bf16 v[168:171], a[24:27], a[0:3], v[168:171]
    s_mov_b32 s39, 573440
    buffer_load_dwordx4 a[160:163], v28, s[12:15], s39 offen offset:0
    v_mfma_f32_16x16x32_bf16 v[168:171], a[60:63], a[36:39], v[168:171]
    v_mfma_f32_16x16x32_bf16 v[188:191], a[24:27], a[4:7], v[188:191]
    buffer_load_dwordx4 a[164:167], v28, s[12:15], s39 offen offset:1024
    v_mfma_f32_16x16x32_bf16 v[188:191], a[60:63], a[40:43], v[188:191]
    v_mfma_f32_16x16x32_bf16 v[208:211], a[24:27], a[8:11], v[208:211]
    buffer_load_dwordx4 a[168:171], v28, s[12:15], s39 offen offset:2048
    v_mfma_f32_16x16x32_bf16 v[208:211], a[60:63], a[44:47], v[208:211]
    v_mfma_f32_16x16x32_bf16 v[228:231], a[24:27], a[12:15], v[228:231]
    buffer_load_dwordx4 a[172:175], v28, s[12:15], s39 offen offset:3072
    v_mfma_f32_16x16x32_bf16 v[228:231], a[60:63], a[48:51], v[228:231]
    v_mfma_f32_16x16x32_bf16 v[172:175], a[28:31], a[0:3], v[172:175]
    buffer_load_dwordx4 a[176:179], v29, s[12:15], s39 offen offset:0
    v_mfma_f32_16x16x32_bf16 v[172:175], a[64:67], a[36:39], v[172:175]
    v_mfma_f32_16x16x32_bf16 v[192:195], a[28:31], a[4:7], v[192:195]
    s_mov_b32 s39, 593920
    buffer_load_dwordx4 a[196:199], v28, s[12:15], s39 offen offset:0
    v_mfma_f32_16x16x32_bf16 v[192:195], a[64:67], a[40:43], v[192:195]
    v_mfma_f32_16x16x32_bf16 v[212:215], a[28:31], a[8:11], v[212:215]
    buffer_load_dwordx4 a[200:203], v28, s[12:15], s39 offen offset:1024
    v_mfma_f32_16x16x32_bf16 v[212:215], a[64:67], a[44:47], v[212:215]
    v_mfma_f32_16x16x32_bf16 v[232:235], a[28:31], a[12:15], v[232:235]
    buffer_load_dwordx4 a[204:207], v28, s[12:15], s39 offen offset:2048
    v_mfma_f32_16x16x32_bf16 v[232:235], a[64:67], a[48:51], v[232:235]
    v_mfma_f32_16x16x32_bf16 v[176:179], a[32:35], a[0:3], v[176:179]
    buffer_load_dwordx4 a[208:211], v28, s[12:15], s39 offen offset:3072
    v_mfma_f32_16x16x32_bf16 v[176:179], a[68:71], a[36:39], v[176:179]
    v_mfma_f32_16x16x32_bf16 v[196:199], a[32:35], a[4:7], v[196:199]
    buffer_load_dwordx4 a[212:215], v29, s[12:15], s39 offen offset:0
    v_mfma_f32_16x16x32_bf16 v[196:199], a[68:71], a[40:43], v[196:199]
    v_mfma_f32_16x16x32_bf16 v[216:219], a[32:35], a[8:11], v[216:219]
    v_mfma_f32_16x16x32_bf16 v[216:219], a[68:71], a[44:47], v[216:219]
    v_mfma_f32_16x16x32_bf16 v[236:239], a[32:35], a[12:15], v[236:239]
    v_mfma_f32_16x16x32_bf16 v[236:239], a[68:71], a[48:51], v[236:239]
    s_waitcnt vmcnt(18)
    v_mfma_f32_16x16x32_bf16 v[160:163], a[88:91], a[72:75], v[160:163]
    s_mov_b32 s38, 491520
    buffer_load_dwordx4 a[0:3], v24, s[8:11], s38 offen
    v_mfma_f32_16x16x32_bf16 v[160:163], a[124:127], a[108:111], v[160:163]
    v_mfma_f32_16x16x32_bf16 v[180:183], a[88:91], a[76:79], v[180:183]
    buffer_load_dwordx4 a[4:7], v25, s[8:11], s38 offen
    v_mfma_f32_16x16x32_bf16 v[180:183], a[124:127], a[112:115], v[180:183]
    v_mfma_f32_16x16x32_bf16 v[200:203], a[88:91], a[80:83], v[200:203]
    buffer_load_dwordx4 a[8:11], v26, s[8:11], s38 offen
    v_mfma_f32_16x16x32_bf16 v[200:203], a[124:127], a[116:119], v[200:203]
    v_mfma_f32_16x16x32_bf16 v[220:223], a[88:91], a[84:87], v[220:223]
    buffer_load_dwordx4 a[12:15], v27, s[8:11], s38 offen
    v_mfma_f32_16x16x32_bf16 v[220:223], a[124:127], a[120:123], v[220:223]
    v_mfma_f32_16x16x32_bf16 v[164:167], a[92:95], a[72:75], v[164:167]
    s_mov_b32 s38, 507904
    buffer_load_dwordx4 a[36:39], v24, s[8:11], s38 offen
    v_mfma_f32_16x16x32_bf16 v[164:167], a[128:131], a[108:111], v[164:167]
    v_mfma_f32_16x16x32_bf16 v[184:187], a[92:95], a[76:79], v[184:187]
    buffer_load_dwordx4 a[40:43], v25, s[8:11], s38 offen
    v_mfma_f32_16x16x32_bf16 v[184:187], a[128:131], a[112:115], v[184:187]
    v_mfma_f32_16x16x32_bf16 v[204:207], a[92:95], a[80:83], v[204:207]
    buffer_load_dwordx4 a[44:47], v26, s[8:11], s38 offen
    v_mfma_f32_16x16x32_bf16 v[204:207], a[128:131], a[116:119], v[204:207]
    v_mfma_f32_16x16x32_bf16 v[224:227], a[92:95], a[84:87], v[224:227]
    buffer_load_dwordx4 a[48:51], v27, s[8:11], s38 offen
    v_mfma_f32_16x16x32_bf16 v[224:227], a[128:131], a[120:123], v[224:227]
    v_mfma_f32_16x16x32_bf16 v[168:171], a[96:99], a[72:75], v[168:171]
    s_mov_b32 s39, 614400
    buffer_load_dwordx4 a[16:19], v28, s[12:15], s39 offen offset:0
    v_mfma_f32_16x16x32_bf16 v[168:171], a[132:135], a[108:111], v[168:171]
    v_mfma_f32_16x16x32_bf16 v[188:191], a[96:99], a[76:79], v[188:191]
    buffer_load_dwordx4 a[20:23], v28, s[12:15], s39 offen offset:1024
    v_mfma_f32_16x16x32_bf16 v[188:191], a[132:135], a[112:115], v[188:191]
    v_mfma_f32_16x16x32_bf16 v[208:211], a[96:99], a[80:83], v[208:211]
    buffer_load_dwordx4 a[24:27], v28, s[12:15], s39 offen offset:2048
    v_mfma_f32_16x16x32_bf16 v[208:211], a[132:135], a[116:119], v[208:211]
    v_mfma_f32_16x16x32_bf16 v[228:231], a[96:99], a[84:87], v[228:231]
    buffer_load_dwordx4 a[28:31], v28, s[12:15], s39 offen offset:3072
    v_mfma_f32_16x16x32_bf16 v[228:231], a[132:135], a[120:123], v[228:231]
    v_mfma_f32_16x16x32_bf16 v[172:175], a[100:103], a[72:75], v[172:175]
    buffer_load_dwordx4 a[32:35], v29, s[12:15], s39 offen offset:0
    v_mfma_f32_16x16x32_bf16 v[172:175], a[136:139], a[108:111], v[172:175]
    v_mfma_f32_16x16x32_bf16 v[192:195], a[100:103], a[76:79], v[192:195]
    s_mov_b32 s39, 634880
    buffer_load_dwordx4 a[52:55], v28, s[12:15], s39 offen offset:0
    v_mfma_f32_16x16x32_bf16 v[192:195], a[136:139], a[112:115], v[192:195]
    v_mfma_f32_16x16x32_bf16 v[212:215], a[100:103], a[80:83], v[212:215]
    buffer_load_dwordx4 a[56:59], v28, s[12:15], s39 offen offset:1024
    v_mfma_f32_16x16x32_bf16 v[212:215], a[136:139], a[116:119], v[212:215]
    v_mfma_f32_16x16x32_bf16 v[232:235], a[100:103], a[84:87], v[232:235]
    buffer_load_dwordx4 a[60:63], v28, s[12:15], s39 offen offset:2048
    v_mfma_f32_16x16x32_bf16 v[232:235], a[136:139], a[120:123], v[232:235]
    v_mfma_f32_16x16x32_bf16 v[176:179], a[104:107], a[72:75], v[176:179]
    buffer_load_dwordx4 a[64:67], v28, s[12:15], s39 offen offset:3072
    v_mfma_f32_16x16x32_bf16 v[176:179], a[140:143], a[108:111], v[176:179]
    v_mfma_f32_16x16x32_bf16 v[196:199], a[104:107], a[76:79], v[196:199]
    buffer_load_dwordx4 a[68:71], v29, s[12:15], s39 offen offset:0
    v_mfma_f32_16x16x32_bf16 v[196:199], a[140:143], a[112:115], v[196:199]
    v_mfma_f32_16x16x32_bf16 v[216:219], a[104:107], a[80:83], v[216:219]
    v_mfma_f32_16x16x32_bf16 v[216:219], a[140:143], a[116:119], v[216:219]
    v_mfma_f32_16x16x32_bf16 v[236:239], a[104:107], a[84:87], v[236:239]
    v_mfma_f32_16x16x32_bf16 v[236:239], a[140:143], a[120:123], v[236:239]
    s_waitcnt vmcnt(18)
    v_mfma_f32_16x16x32_bf16 v[160:163], a[160:163], a[144:147], v[160:163]
    v_mfma_f32_16x16x32_bf16 v[160:163], a[196:199], a[180:183], v[160:163]
    v_mfma_f32_16x16x32_bf16 v[180:183], a[160:163], a[148:151], v[180:183]
    v_mfma_f32_16x16x32_bf16 v[180:183], a[196:199], a[184:187], v[180:183]
    v_mfma_f32_16x16x32_bf16 v[200:203], a[160:163], a[152:155], v[200:203]
    v_mfma_f32_16x16x32_bf16 v[200:203], a[196:199], a[188:191], v[200:203]
    v_mfma_f32_16x16x32_bf16 v[220:223], a[160:163], a[156:159], v[220:223]
    v_mfma_f32_16x16x32_bf16 v[220:223], a[196:199], a[192:195], v[220:223]
    v_mfma_f32_16x16x32_bf16 v[164:167], a[164:167], a[144:147], v[164:167]
    v_mfma_f32_16x16x32_bf16 v[164:167], a[200:203], a[180:183], v[164:167]
    v_mfma_f32_16x16x32_bf16 v[184:187], a[164:167], a[148:151], v[184:187]
    v_mfma_f32_16x16x32_bf16 v[184:187], a[200:203], a[184:187], v[184:187]
    v_mfma_f32_16x16x32_bf16 v[204:207], a[164:167], a[152:155], v[204:207]
    v_mfma_f32_16x16x32_bf16 v[204:207], a[200:203], a[188:191], v[204:207]
    v_mfma_f32_16x16x32_bf16 v[224:227], a[164:167], a[156:159], v[224:227]
    v_mfma_f32_16x16x32_bf16 v[224:227], a[200:203], a[192:195], v[224:227]
    v_mfma_f32_16x16x32_bf16 v[168:171], a[168:171], a[144:147], v[168:171]
    v_mfma_f32_16x16x32_bf16 v[168:171], a[204:207], a[180:183], v[168:171]
    v_mfma_f32_16x16x32_bf16 v[188:191], a[168:171], a[148:151], v[188:191]
    v_mfma_f32_16x16x32_bf16 v[188:191], a[204:207], a[184:187], v[188:191]
    v_mfma_f32_16x16x32_bf16 v[208:211], a[168:171], a[152:155], v[208:211]
    v_mfma_f32_16x16x32_bf16 v[208:211], a[204:207], a[188:191], v[208:211]
    v_mfma_f32_16x16x32_bf16 v[228:231], a[168:171], a[156:159], v[228:231]
    v_mfma_f32_16x16x32_bf16 v[228:231], a[204:207], a[192:195], v[228:231]
    v_mfma_f32_16x16x32_bf16 v[172:175], a[172:175], a[144:147], v[172:175]
    v_mfma_f32_16x16x32_bf16 v[172:175], a[208:211], a[180:183], v[172:175]
    v_mfma_f32_16x16x32_bf16 v[192:195], a[172:175], a[148:151], v[192:195]
    v_mfma_f32_16x16x32_bf16 v[192:195], a[208:211], a[184:187], v[192:195]
    v_mfma_f32_16x16x32_bf16 v[212:215], a[172:175], a[152:155], v[212:215]
    v_mfma_f32_16x16x32_bf16 v[212:215], a[208:211], a[188:191], v[212:215]
    v_mfma_f32_16x16x32_bf16 v[232:235], a[172:175], a[156:159], v[232:235]
    v_mfma_f32_16x16x32_bf16 v[232:235], a[208:211], a[192:195], v[232:235]
    v_mfma_f32_16x16x32_bf16 v[176:179], a[176:179], a[144:147], v[176:179]
    v_mfma_f32_16x16x32_bf16 v[176:179], a[212:215], a[180:183], v[176:179]
    v_mfma_f32_16x16x32_bf16 v[196:199], a[176:179], a[148:151], v[196:199]
    v_mfma_f32_16x16x32_bf16 v[196:199], a[212:215], a[184:187], v[196:199]
    v_mfma_f32_16x16x32_bf16 v[216:219], a[176:179], a[152:155], v[216:219]
    v_mfma_f32_16x16x32_bf16 v[216:219], a[212:215], a[188:191], v[216:219]
    v_mfma_f32_16x16x32_bf16 v[236:239], a[176:179], a[156:159], v[236:239]
    v_mfma_f32_16x16x32_bf16 v[236:239], a[212:215], a[192:195], v[236:239]
    s_waitcnt vmcnt(0)
    v_mfma_f32_16x16x32_bf16 v[160:163], a[16:19], a[0:3], v[160:163]
    v_mfma_f32_16x16x32_bf16 v[160:163], a[52:55], a[36:39], v[160:163]
    v_mfma_f32_16x16x32_bf16 v[180:183], a[16:19], a[4:7], v[180:183]
    v_mfma_f32_16x16x32_bf16 v[180:183], a[52:55], a[40:43], v[180:183]
    v_mfma_f32_16x16x32_bf16 v[200:203], a[16:19], a[8:11], v[200:203]
    v_mfma_f32_16x16x32_bf16 v[200:203], a[52:55], a[44:47], v[200:203]
    v_mfma_f32_16x16x32_bf16 v[220:223], a[16:19], a[12:15], v[220:223]
    v_mfma_f32_16x16x32_bf16 v[220:223], a[52:55], a[48:51], v[220:223]
    v_mfma_f32_16x16x32_bf16 v[164:167], a[20:23], a[0:3], v[164:167]
    v_mfma_f32_16x16x32_bf16 v[164:167], a[56:59], a[36:39], v[164:167]
    v_mfma_f32_16x16x32_bf16 v[184:187], a[20:23], a[4:7], v[184:187]
    v_mfma_f32_16x16x32_bf16 v[184:187], a[56:59], a[40:43], v[184:187]
    v_mfma_f32_16x16x32_bf16 v[204:207], a[20:23], a[8:11], v[204:207]
    v_mfma_f32_16x16x32_bf16 v[204:207], a[56:59], a[44:47], v[204:207]
    v_mfma_f32_16x16x32_bf16 v[224:227], a[20:23], a[12:15], v[224:227]
    v_mfma_f32_16x16x32_bf16 v[224:227], a[56:59], a[48:51], v[224:227]
    v_mfma_f32_16x16x32_bf16 v[168:171], a[24:27], a[0:3], v[168:171]
    v_mfma_f32_16x16x32_bf16 v[168:171], a[60:63], a[36:39], v[168:171]
    v_mfma_f32_16x16x32_bf16 v[188:191], a[24:27], a[4:7], v[188:191]
    v_mfma_f32_16x16x32_bf16 v[188:191], a[60:63], a[40:43], v[188:191]
    v_mfma_f32_16x16x32_bf16 v[208:211], a[24:27], a[8:11], v[208:211]
    v_mfma_f32_16x16x32_bf16 v[208:211], a[60:63], a[44:47], v[208:211]
    v_mfma_f32_16x16x32_bf16 v[228:231], a[24:27], a[12:15], v[228:231]
    v_mfma_f32_16x16x32_bf16 v[228:231], a[60:63], a[48:51], v[228:231]
    v_mfma_f32_16x16x32_bf16 v[172:175], a[28:31], a[0:3], v[172:175]
    v_mfma_f32_16x16x32_bf16 v[172:175], a[64:67], a[36:39], v[172:175]
    v_mfma_f32_16x16x32_bf16 v[192:195], a[28:31], a[4:7], v[192:195]
    v_mfma_f32_16x16x32_bf16 v[192:195], a[64:67], a[40:43], v[192:195]
    v_mfma_f32_16x16x32_bf16 v[212:215], a[28:31], a[8:11], v[212:215]
    v_mfma_f32_16x16x32_bf16 v[212:215], a[64:67], a[44:47], v[212:215]
    v_mfma_f32_16x16x32_bf16 v[232:235], a[28:31], a[12:15], v[232:235]
    v_mfma_f32_16x16x32_bf16 v[232:235], a[64:67], a[48:51], v[232:235]
    v_mfma_f32_16x16x32_bf16 v[176:179], a[32:35], a[0:3], v[176:179]
    v_mfma_f32_16x16x32_bf16 v[176:179], a[68:71], a[36:39], v[176:179]
    v_mfma_f32_16x16x32_bf16 v[196:199], a[32:35], a[4:7], v[196:199]
    v_mfma_f32_16x16x32_bf16 v[196:199], a[68:71], a[40:43], v[196:199]
    v_mfma_f32_16x16x32_bf16 v[216:219], a[32:35], a[8:11], v[216:219]
    v_mfma_f32_16x16x32_bf16 v[216:219], a[68:71], a[44:47], v[216:219]
    v_mfma_f32_16x16x32_bf16 v[236:239], a[32:35], a[12:15], v[236:239]
    v_mfma_f32_16x16x32_bf16 v[236:239], a[68:71], a[48:51], v[236:239]
    s_nop 3
    ds_write_b128 v31, v[180:183] offset:0
    ds_write_b128 v31, v[184:187] offset:1024
    ds_write_b128 v31, v[188:191] offset:2048
    ds_write_b128 v31, v[192:195] offset:3072
    ds_write_b128 v31, v[196:199] offset:4096
    ds_write_b128 v32, v[200:203] offset:0
    ds_write_b128 v32, v[204:207] offset:1024
    ds_write_b128 v32, v[208:211] offset:2048
    ds_write_b128 v32, v[212:215] offset:3072
    ds_write_b128 v32, v[216:219] offset:4096
    ds_write_b128 v33, v[220:223] offset:0
    ds_write_b128 v33, v[224:227] offset:1024
    ds_write_b128 v33, v[228:231] offset:2048
    ds_write_b128 v33, v[232:235] offset:3072
    ds_write_b128 v33, v[236:239] offset:4096
    s_waitcnt lgkmcnt(0)
    s_barrier
    v_and_b32 v120, 15, v1
    s_lshl_b32 s32, s5, 4
    v_add_u32 v120, s32, v120
    v_mul_u32_u24 v120, 20480, v120
    v_lshrrev_b32 v121, 4, v1
    v_lshlrev_b32 v121, 4, v121
    s_mul_i32 s32, s37, 320
    v_add3_u32 v28, v120, v121, s32
    s_mul_i32 s32, s5, 320
    s_add_u32 s32, s32, 61440
    v_add_u32 v29, s32, v121
    v_add_u32 v24, 61440, v121
    s_add_u32 s12, s52, 0x1a00000
    s_addc_u32 s13, s53, 0
    s_mov_b32 s14, 0x438000
    s_mov_b32 s15, 0x20000
    s_mov_b32 s38, 0
L_routed:
    s_not_b32 s32, s56
    s_and_b32 s34, s32, 0x7ff
    s_lshr_b32 s32, s34, 6
    s_cmp_lg_u32 s32, s36
    s_cbranch_scc1 L_routed_next
    s_add_u32 s32, s38, 0
    buffer_load_dwordx4 a[0:3], v28, s[12:15], s32 offen offset:0
    buffer_load_dwordx4 a[4:7], v28, s[12:15], s32 offen offset:64
    buffer_load_dwordx4 a[8:11], v28, s[12:15], s32 offen offset:128
    buffer_load_dwordx4 a[12:15], v28, s[12:15], s32 offen offset:192
    buffer_load_dwordx4 a[16:19], v28, s[12:15], s32 offen offset:256
    s_add_u32 s32, s38, 1310720
    buffer_load_dwordx4 a[20:23], v28, s[12:15], s32 offen offset:0
    buffer_load_dwordx4 a[24:27], v28, s[12:15], s32 offen offset:64
    buffer_load_dwordx4 a[28:31], v28, s[12:15], s32 offen offset:128
    buffer_load_dwordx4 a[32:35], v28, s[12:15], s32 offen offset:192
    buffer_load_dwordx4 a[36:39], v28, s[12:15], s32 offen offset:256
    s_add_u32 s32, s38, 2621440
    buffer_load_dwordx4 a[40:43], v28, s[12:15], s32 offen offset:0
    buffer_load_dwordx4 a[44:47], v28, s[12:15], s32 offen offset:64
    buffer_load_dwordx4 a[48:51], v28, s[12:15], s32 offen offset:128
    buffer_load_dwordx4 a[52:55], v28, s[12:15], s32 offen offset:192
    buffer_load_dwordx4 a[56:59], v28, s[12:15], s32 offen offset:256
    s_add_u32 s32, s38, 3932160
    buffer_load_dwordx4 a[60:63], v28, s[12:15], s32 offen offset:0
    buffer_load_dwordx4 a[64:67], v28, s[12:15], s32 offen offset:64
    buffer_load_dwordx4 a[68:71], v28, s[12:15], s32 offen offset:128
    buffer_load_dwordx4 a[72:75], v28, s[12:15], s32 offen offset:192
    buffer_load_dwordx4 a[76:79], v28, s[12:15], s32 offen offset:256
    s_and_b32 s32, s56, 0xffff0000
    s_ashr_i32 s33, s32, 31
    s_andn2_b32 s33, 0x7fff0000, s33
    s_or_b32 s33, s33, 0x80000000
    s_xor_b32 s32, s32, s33
    v_mov_b32 v120, 0xbfb8aa3b
    v_mul_f32 v120, s32, v120
    v_exp_f32 v120, v120
    s_nop 0
    v_add_f32 v120, 1.0, v120
    v_rcp_f32 v120, v120
    s_nop 0
    v_cvt_pk_bf16_f32 v120, v120, v120
    v_lshlrev_b32 v36, 16, v120
    s_waitcnt vmcnt(0)
    v_accvgpr_read_b32 v100, a0
    v_accvgpr_read_b32 v101, a1
    v_accvgpr_read_b32 v102, a2
    v_accvgpr_read_b32 v103, a3
    v_accvgpr_read_b32 v104, a4
    v_accvgpr_read_b32 v105, a5
    v_accvgpr_read_b32 v106, a6
    v_accvgpr_read_b32 v107, a7
    v_accvgpr_read_b32 v108, a8
    v_accvgpr_read_b32 v109, a9
    v_accvgpr_read_b32 v110, a10
    v_accvgpr_read_b32 v111, a11
    v_accvgpr_read_b32 v112, a12
    v_accvgpr_read_b32 v113, a13
    v_accvgpr_read_b32 v114, a14
    v_accvgpr_read_b32 v115, a15
    v_accvgpr_read_b32 v116, a16
    v_accvgpr_read_b32 v117, a17
    v_accvgpr_read_b32 v118, a18
    v_accvgpr_read_b32 v119, a19
    v_accvgpr_read_b32 v120, a20
    v_accvgpr_read_b32 v121, a21
    v_accvgpr_read_b32 v122, a22
    v_accvgpr_read_b32 v123, a23
    v_accvgpr_read_b32 v124, a24
    v_accvgpr_read_b32 v125, a25
    v_accvgpr_read_b32 v126, a26
    v_accvgpr_read_b32 v127, a27
    v_accvgpr_read_b32 v128, a28
    v_accvgpr_read_b32 v129, a29
    v_accvgpr_read_b32 v130, a30
    v_accvgpr_read_b32 v131, a31
    v_accvgpr_read_b32 v132, a32
    v_accvgpr_read_b32 v133, a33
    v_accvgpr_read_b32 v134, a34
    v_accvgpr_read_b32 v135, a35
    v_accvgpr_read_b32 v136, a36
    v_accvgpr_read_b32 v137, a37
    v_accvgpr_read_b32 v138, a38
    v_accvgpr_read_b32 v139, a39
    v_add_f32 v100, v100, v120
    v_add_f32 v101, v101, v121
    v_add_f32 v102, v102, v122
    v_add_f32 v103, v103, v123
    v_add_f32 v104, v104, v124
    v_add_f32 v105, v105, v125
    v_add_f32 v106, v106, v126
    v_add_f32 v107, v107, v127
    v_add_f32 v108, v108, v128
    v_add_f32 v109, v109, v129
    v_add_f32 v110, v110, v130
    v_add_f32 v111, v111, v131
    v_add_f32 v112, v112, v132
    v_add_f32 v113, v113, v133
    v_add_f32 v114, v114, v134
    v_add_f32 v115, v115, v135
    v_add_f32 v116, v116, v136
    v_add_f32 v117, v117, v137
    v_add_f32 v118, v118, v138
    v_add_f32 v119, v119, v139
    v_accvgpr_read_b32 v120, a40
    v_accvgpr_read_b32 v121, a41
    v_accvgpr_read_b32 v122, a42
    v_accvgpr_read_b32 v123, a43
    v_accvgpr_read_b32 v124, a44
    v_accvgpr_read_b32 v125, a45
    v_accvgpr_read_b32 v126, a46
    v_accvgpr_read_b32 v127, a47
    v_accvgpr_read_b32 v128, a48
    v_accvgpr_read_b32 v129, a49
    v_accvgpr_read_b32 v130, a50
    v_accvgpr_read_b32 v131, a51
    v_accvgpr_read_b32 v132, a52
    v_accvgpr_read_b32 v133, a53
    v_accvgpr_read_b32 v134, a54
    v_accvgpr_read_b32 v135, a55
    v_accvgpr_read_b32 v136, a56
    v_accvgpr_read_b32 v137, a57
    v_accvgpr_read_b32 v138, a58
    v_accvgpr_read_b32 v139, a59
    v_add_f32 v100, v100, v120
    v_add_f32 v101, v101, v121
    v_add_f32 v102, v102, v122
    v_add_f32 v103, v103, v123
    v_add_f32 v104, v104, v124
    v_add_f32 v105, v105, v125
    v_add_f32 v106, v106, v126
    v_add_f32 v107, v107, v127
    v_add_f32 v108, v108, v128
    v_add_f32 v109, v109, v129
    v_add_f32 v110, v110, v130
    v_add_f32 v111, v111, v131
    v_add_f32 v112, v112, v132
    v_add_f32 v113, v113, v133
    v_add_f32 v114, v114, v134
    v_add_f32 v115, v115, v135
    v_add_f32 v116, v116, v136
    v_add_f32 v117, v117, v137
    v_add_f32 v118, v118, v138
    v_add_f32 v119, v119, v139
    v_accvgpr_read_b32 v120, a60
    v_accvgpr_read_b32 v121, a61
    v_accvgpr_read_b32 v122, a62
    v_accvgpr_read_b32 v123, a63
    v_accvgpr_read_b32 v124, a64
    v_accvgpr_read_b32 v125, a65
    v_accvgpr_read_b32 v126, a66
    v_accvgpr_read_b32 v127, a67
    v_accvgpr_read_b32 v128, a68
    v_accvgpr_read_b32 v129, a69
    v_accvgpr_read_b32 v130, a70
    v_accvgpr_read_b32 v131, a71
    v_accvgpr_read_b32 v132, a72
    v_accvgpr_read_b32 v133, a73
    v_accvgpr_read_b32 v134, a74
    v_accvgpr_read_b32 v135, a75
    v_accvgpr_read_b32 v136, a76
    v_accvgpr_read_b32 v137, a77
    v_accvgpr_read_b32 v138, a78
    v_accvgpr_read_b32 v139, a79
    v_add_f32 v100, v100, v120
    v_add_f32 v101, v101, v121
    v_add_f32 v102, v102, v122
    v_add_f32 v103, v103, v123
    v_add_f32 v104, v104, v124
    v_add_f32 v105, v105, v125
    v_add_f32 v106, v106, v126
    v_add_f32 v107, v107, v127
    v_add_f32 v108, v108, v128
    v_add_f32 v109, v109, v129
    v_add_f32 v110, v110, v130
    v_add_f32 v111, v111, v131
    v_add_f32 v112, v112, v132
    v_add_f32 v113, v113, v133
    v_add_f32 v114, v114, v134
    v_add_f32 v115, v115, v135
    v_add_f32 v116, v116, v136
    v_add_f32 v117, v117, v137
    v_add_f32 v118, v118, v138
    v_add_f32 v119, v119, v139
    v_add_f32_dpp v100, v100, v100 quad_perm:[1,0,3,2] row_mask:0xf bank_mask:0xf
    v_add_f32_dpp v101, v101, v101 quad_perm:[1,0,3,2] row_mask:0xf bank_mask:0xf
    v_add_f32_dpp v102, v102, v102 quad_perm:[1,0,3,2] row_mask:0xf bank_mask:0xf
    v_add_f32_dpp v103, v103, v103 quad_perm:[1,0,3,2] row_mask:0xf bank_mask:0xf
    v_add_f32_dpp v104, v104, v104 quad_perm:[1,0,3,2] row_mask:0xf bank_mask:0xf
    v_add_f32_dpp v105, v105, v105 quad_perm:[1,0,3,2] row_mask:0xf bank_mask:0xf
    v_add_f32_dpp v106, v106, v106 quad_perm:[1,0,3,2] row_mask:0xf bank_mask:0xf
    v_add_f32_dpp v107, v107, v107 quad_perm:[1,0,3,2] row_mask:0xf bank_mask:0xf
    v_add_f32_dpp v108, v108, v108 quad_perm:[1,0,3,2] row_mask:0xf bank_mask:0xf
    v_add_f32_dpp v109, v109, v109 quad_perm:[1,0,3,2] row_mask:0xf bank_mask:0xf
    v_add_f32_dpp v110, v110, v110 quad_perm:[1,0,3,2] row_mask:0xf bank_mask:0xf
    v_add_f32_dpp v111, v111, v111 quad_perm:[1,0,3,2] row_mask:0xf bank_mask:0xf
    v_add_f32_dpp v112, v112, v112 quad_perm:[1,0,3,2] row_mask:0xf bank_mask:0xf
    v_add_f32_dpp v113, v113, v113 quad_perm:[1,0,3,2] row_mask:0xf bank_mask:0xf
    v_add_f32_dpp v114, v114, v114 quad_perm:[1,0,3,2] row_mask:0xf bank_mask:0xf
    v_add_f32_dpp v115, v115, v115 quad_perm:[1,0,3,2] row_mask:0xf bank_mask:0xf
    v_add_f32_dpp v116, v116, v116 quad_perm:[1,0,3,2] row_mask:0xf bank_mask:0xf
    v_add_f32_dpp v117, v117, v117 quad_perm:[1,0,3,2] row_mask:0xf bank_mask:0xf
    v_add_f32_dpp v118, v118, v118 quad_perm:[1,0,3,2] row_mask:0xf bank_mask:0xf
    v_add_f32_dpp v119, v119, v119 quad_perm:[1,0,3,2] row_mask:0xf bank_mask:0xf
    v_add_f32_dpp v100, v100, v100 quad_perm:[2,3,0,1] row_mask:0xf bank_mask:0xf
    v_add_f32_dpp v101, v101, v101 quad_perm:[2,3,0,1] row_mask:0xf bank_mask:0xf
    v_add_f32_dpp v102, v102, v102 quad_perm:[2,3,0,1] row_mask:0xf bank_mask:0xf
    v_add_f32_dpp v103, v103, v103 quad_perm:[2,3,0,1] row_mask:0xf bank_mask:0xf
    v_add_f32_dpp v104, v104, v104 quad_perm:[2,3,0,1] row_mask:0xf bank_mask:0xf
    v_add_f32_dpp v105, v105, v105 quad_perm:[2,3,0,1] row_mask:0xf bank_mask:0xf
    v_add_f32_dpp v106, v106, v106 quad_perm:[2,3,0,1] row_mask:0xf bank_mask:0xf
    v_add_f32_dpp v107, v107, v107 quad_perm:[2,3,0,1] row_mask:0xf bank_mask:0xf
    v_add_f32_dpp v108, v108, v108 quad_perm:[2,3,0,1] row_mask:0xf bank_mask:0xf
    v_add_f32_dpp v109, v109, v109 quad_perm:[2,3,0,1] row_mask:0xf bank_mask:0xf
    v_add_f32_dpp v110, v110, v110 quad_perm:[2,3,0,1] row_mask:0xf bank_mask:0xf
    v_add_f32_dpp v111, v111, v111 quad_perm:[2,3,0,1] row_mask:0xf bank_mask:0xf
    v_add_f32_dpp v112, v112, v112 quad_perm:[2,3,0,1] row_mask:0xf bank_mask:0xf
    v_add_f32_dpp v113, v113, v113 quad_perm:[2,3,0,1] row_mask:0xf bank_mask:0xf
    v_add_f32_dpp v114, v114, v114 quad_perm:[2,3,0,1] row_mask:0xf bank_mask:0xf
    v_add_f32_dpp v115, v115, v115 quad_perm:[2,3,0,1] row_mask:0xf bank_mask:0xf
    v_add_f32_dpp v116, v116, v116 quad_perm:[2,3,0,1] row_mask:0xf bank_mask:0xf
    v_add_f32_dpp v117, v117, v117 quad_perm:[2,3,0,1] row_mask:0xf bank_mask:0xf
    v_add_f32_dpp v118, v118, v118 quad_perm:[2,3,0,1] row_mask:0xf bank_mask:0xf
    v_add_f32_dpp v119, v119, v119 quad_perm:[2,3,0,1] row_mask:0xf bank_mask:0xf
    v_add_f32_dpp v100, v100, v100 row_half_mirror row_mask:0xf bank_mask:0xf
    v_add_f32_dpp v101, v101, v101 row_half_mirror row_mask:0xf bank_mask:0xf
    v_add_f32_dpp v102, v102, v102 row_half_mirror row_mask:0xf bank_mask:0xf
    v_add_f32_dpp v103, v103, v103 row_half_mirror row_mask:0xf bank_mask:0xf
    v_add_f32_dpp v104, v104, v104 row_half_mirror row_mask:0xf bank_mask:0xf
    v_add_f32_dpp v105, v105, v105 row_half_mirror row_mask:0xf bank_mask:0xf
    v_add_f32_dpp v106, v106, v106 row_half_mirror row_mask:0xf bank_mask:0xf
    v_add_f32_dpp v107, v107, v107 row_half_mirror row_mask:0xf bank_mask:0xf
    v_add_f32_dpp v108, v108, v108 row_half_mirror row_mask:0xf bank_mask:0xf
    v_add_f32_dpp v109, v109, v109 row_half_mirror row_mask:0xf bank_mask:0xf
    v_add_f32_dpp v110, v110, v110 row_half_mirror row_mask:0xf bank_mask:0xf
    v_add_f32_dpp v111, v111, v111 row_half_mirror row_mask:0xf bank_mask:0xf
    v_add_f32_dpp v112, v112, v112 row_half_mirror row_mask:0xf bank_mask:0xf
    v_add_f32_dpp v113, v113, v113 row_half_mirror row_mask:0xf bank_mask:0xf
    v_add_f32_dpp v114, v114, v114 row_half_mirror row_mask:0xf bank_mask:0xf
    v_add_f32_dpp v115, v115, v115 row_half_mirror row_mask:0xf bank_mask:0xf
    v_add_f32_dpp v116, v116, v116 row_half_mirror row_mask:0xf bank_mask:0xf
    v_add_f32_dpp v117, v117, v117 row_half_mirror row_mask:0xf bank_mask:0xf
    v_add_f32_dpp v118, v118, v118 row_half_mirror row_mask:0xf bank_mask:0xf
    v_add_f32_dpp v119, v119, v119 row_half_mirror row_mask:0xf bank_mask:0xf
    v_add_f32_dpp v100, v100, v100 row_mirror row_mask:0xf bank_mask:0xf
    v_add_f32_dpp v101, v101, v101 row_mirror row_mask:0xf bank_mask:0xf
    v_add_f32_dpp v102, v102, v102 row_mirror row_mask:0xf bank_mask:0xf
    v_add_f32_dpp v103, v103, v103 row_mirror row_mask:0xf bank_mask:0xf
    v_add_f32_dpp v104, v104, v104 row_mirror row_mask:0xf bank_mask:0xf
    v_add_f32_dpp v105, v105, v105 row_mirror row_mask:0xf bank_mask:0xf
    v_add_f32_dpp v106, v106, v106 row_mirror row_mask:0xf bank_mask:0xf
    v_add_f32_dpp v107, v107, v107 row_mirror row_mask:0xf bank_mask:0xf
    v_add_f32_dpp v108, v108, v108 row_mirror row_mask:0xf bank_mask:0xf
    v_add_f32_dpp v109, v109, v109 row_mirror row_mask:0xf bank_mask:0xf
    v_add_f32_dpp v110, v110, v110 row_mirror row_mask:0xf bank_mask:0xf
    v_add_f32_dpp v111, v111, v111 row_mirror row_mask:0xf bank_mask:0xf
    v_add_f32_dpp v112, v112, v112 row_mirror row_mask:0xf bank_mask:0xf
    v_add_f32_dpp v113, v113, v113 row_mirror row_mask:0xf bank_mask:0xf
    v_add_f32_dpp v114, v114, v114 row_mirror row_mask:0xf bank_mask:0xf
    v_add_f32_dpp v115, v115, v115 row_mirror row_mask:0xf bank_mask:0xf
    v_add_f32_dpp v116, v116, v116 row_mirror row_mask:0xf bank_mask:0xf
    v_add_f32_dpp v117, v117, v117 row_mirror row_mask:0xf bank_mask:0xf
    v_add_f32_dpp v118, v118, v118 row_mirror row_mask:0xf bank_mask:0xf
    v_add_f32_dpp v119, v119, v119 row_mirror row_mask:0xf bank_mask:0xf
    ds_write_b128 v29, v[100:103] offset:0
    ds_write_b128 v29, v[104:107] offset:64
    ds_write_b128 v29, v[108:111] offset:128
    ds_write_b128 v29, v[112:115] offset:192
    ds_write_b128 v29, v[116:119] offset:256
    s_waitcnt lgkmcnt(0)
    s_barrier
    ds_read_b128 v[100:103], v24 offset:0
    ds_read_b128 v[104:107], v24 offset:64
    ds_read_b128 v[108:111], v24 offset:128
    ds_read_b128 v[112:115], v24 offset:192
    ds_read_b128 v[116:119], v24 offset:256
    s_waitcnt lgkmcnt(0)
    ds_read_b128 v[120:123], v24 offset:320
    ds_read_b128 v[124:127], v24 offset:384
    ds_read_b128 v[128:131], v24 offset:448
    ds_read_b128 v[132:135], v24 offset:512
    ds_read_b128 v[136:139], v24 offset:576
    s_waitcnt lgkmcnt(0)
    v_add_f32 v100, v100, v120
    v_add_f32 v101, v101, v121
    v_add_f32 v102, v102, v122
    v_add_f32 v103, v103, v123
    v_add_f32 v104, v104, v124
    v_add_f32 v105, v105, v125
    v_add_f32 v106, v106, v126
    v_add_f32 v107, v107, v127
    v_add_f32 v108, v108, v128
    v_add_f32 v109, v109, v129
    v_add_f32 v110, v110, v130
    v_add_f32 v111, v111, v131
    v_add_f32 v112, v112, v132
    v_add_f32 v113, v113, v133
    v_add_f32 v114, v114, v134
    v_add_f32 v115, v115, v135
    v_add_f32 v116, v116, v136
    v_add_f32 v117, v117, v137
    v_add_f32 v118, v118, v138
    v_add_f32 v119, v119, v139
    ds_read_b128 v[120:123], v24 offset:640
    ds_read_b128 v[124:127], v24 offset:704
    ds_read_b128 v[128:131], v24 offset:768
    ds_read_b128 v[132:135], v24 offset:832
    ds_read_b128 v[136:139], v24 offset:896
    s_waitcnt lgkmcnt(0)
    v_add_f32 v100, v100, v120
    v_add_f32 v101, v101, v121
    v_add_f32 v102, v102, v122
    v_add_f32 v103, v103, v123
    v_add_f32 v104, v104, v124
    v_add_f32 v105, v105, v125
    v_add_f32 v106, v106, v126
    v_add_f32 v107, v107, v127
    v_add_f32 v108, v108, v128
    v_add_f32 v109, v109, v129
    v_add_f32 v110, v110, v130
    v_add_f32 v111, v111, v131
    v_add_f32 v112, v112, v132
    v_add_f32 v113, v113, v133
    v_add_f32 v114, v114, v134
    v_add_f32 v115, v115, v135
    v_add_f32 v116, v116, v136
    v_add_f32 v117, v117, v137
    v_add_f32 v118, v118, v138
    v_add_f32 v119, v119, v139
    ds_read_b128 v[120:123], v24 offset:960
    ds_read_b128 v[124:127], v24 offset:1024
    ds_read_b128 v[128:131], v24 offset:1088
    ds_read_b128 v[132:135], v24 offset:1152
    ds_read_b128 v[136:139], v24 offset:1216
    s_waitcnt lgkmcnt(0)
    v_add_f32 v100, v100, v120
    v_add_f32 v101, v101, v121
    v_add_f32 v102, v102, v122
    v_add_f32 v103, v103, v123
    v_add_f32 v104, v104, v124
    v_add_f32 v105, v105, v125
    v_add_f32 v106, v106, v126
    v_add_f32 v107, v107, v127
    v_add_f32 v108, v108, v128
    v_add_f32 v109, v109, v129
    v_add_f32 v110, v110, v130
    v_add_f32 v111, v111, v131
    v_add_f32 v112, v112, v132
    v_add_f32 v113, v113, v133
    v_add_f32 v114, v114, v134
    v_add_f32 v115, v115, v135
    v_add_f32 v116, v116, v136
    v_add_f32 v117, v117, v137
    v_add_f32 v118, v118, v138
    v_add_f32 v119, v119, v139
    s_barrier
    v_cvt_pk_bf16_f32 v120, v100, v101
    v_cvt_pk_bf16_f32 v121, v102, v103
    v_cvt_pk_bf16_f32 v122, v104, v105
    v_cvt_pk_bf16_f32 v123, v106, v107
    v_cvt_pk_bf16_f32 v124, v108, v109
    v_cvt_pk_bf16_f32 v125, v110, v111
    v_cvt_pk_bf16_f32 v126, v112, v113
    v_cvt_pk_bf16_f32 v127, v114, v115
    v_cvt_pk_bf16_f32 v128, v116, v117
    v_cvt_pk_bf16_f32 v129, v118, v119
    v_lshlrev_b32 v100, 16, v120
    v_and_b32 v101, 0xffff0000, v120
    v_lshlrev_b32 v102, 16, v121
    v_and_b32 v103, 0xffff0000, v121
    v_lshlrev_b32 v104, 16, v122
    v_and_b32 v105, 0xffff0000, v122
    v_lshlrev_b32 v106, 16, v123
    v_and_b32 v107, 0xffff0000, v123
    v_lshlrev_b32 v108, 16, v124
    v_and_b32 v109, 0xffff0000, v124
    v_lshlrev_b32 v110, 16, v125
    v_and_b32 v111, 0xffff0000, v125
    v_lshlrev_b32 v112, 16, v126
    v_and_b32 v113, 0xffff0000, v126
    v_lshlrev_b32 v114, 16, v127
    v_and_b32 v115, 0xffff0000, v127
    v_lshlrev_b32 v116, 16, v128
    v_and_b32 v117, 0xffff0000, v128
    v_lshlrev_b32 v118, 16, v129
    v_and_b32 v119, 0xffff0000, v129
    v_mul_f32 v100, v100, v36
    v_mul_f32 v101, v101, v36
    v_mul_f32 v102, v102, v36
    v_mul_f32 v103, v103, v36
    v_mul_f32 v104, v104, v36
    v_mul_f32 v105, v105, v36
    v_mul_f32 v106, v106, v36
    v_mul_f32 v107, v107, v36
    v_mul_f32 v108, v108, v36
    v_mul_f32 v109, v109, v36
    v_mul_f32 v110, v110, v36
    v_mul_f32 v111, v111, v36
    v_mul_f32 v112, v112, v36
    v_mul_f32 v113, v113, v36
    v_mul_f32 v114, v114, v36
    v_mul_f32 v115, v115, v36
    v_mul_f32 v116, v116, v36
    v_mul_f32 v117, v117, v36
    v_mul_f32 v118, v118, v36
    v_mul_f32 v119, v119, v36
    v_cvt_pk_bf16_f32 v120, v100, v101
    v_cvt_pk_bf16_f32 v121, v102, v103
    v_cvt_pk_bf16_f32 v122, v104, v105
    v_cvt_pk_bf16_f32 v123, v106, v107
    v_cvt_pk_bf16_f32 v124, v108, v109
    v_cvt_pk_bf16_f32 v125, v110, v111
    v_cvt_pk_bf16_f32 v126, v112, v113
    v_cvt_pk_bf16_f32 v127, v114, v115
    v_cvt_pk_bf16_f32 v128, v116, v117
    v_cvt_pk_bf16_f32 v129, v118, v119
    v_lshlrev_b32 v100, 16, v120
    v_and_b32 v101, 0xffff0000, v120
    v_lshlrev_b32 v102, 16, v121
    v_and_b32 v103, 0xffff0000, v121
    v_lshlrev_b32 v104, 16, v122
    v_and_b32 v105, 0xffff0000, v122
    v_lshlrev_b32 v106, 16, v123
    v_and_b32 v107, 0xffff0000, v123
    v_lshlrev_b32 v108, 16, v124
    v_and_b32 v109, 0xffff0000, v124
    v_lshlrev_b32 v110, 16, v125
    v_and_b32 v111, 0xffff0000, v125
    v_lshlrev_b32 v112, 16, v126
    v_and_b32 v113, 0xffff0000, v126
    v_lshlrev_b32 v114, 16, v127
    v_and_b32 v115, 0xffff0000, v127
    v_lshlrev_b32 v116, 16, v128
    v_and_b32 v117, 0xffff0000, v128
    v_lshlrev_b32 v118, 16, v129
    v_and_b32 v119, 0xffff0000, v129
    v_add_f32 v100, v100, v60
    v_add_f32 v101, v101, v61
    v_add_f32 v102, v102, v62
    v_add_f32 v103, v103, v63
    v_add_f32 v104, v104, v64
    v_add_f32 v105, v105, v65
    v_add_f32 v106, v106, v66
    v_add_f32 v107, v107, v67
    v_add_f32 v108, v108, v68
    v_add_f32 v109, v109, v69
    v_add_f32 v110, v110, v70
    v_add_f32 v111, v111, v71
    v_add_f32 v112, v112, v72
    v_add_f32 v113, v113, v73
    v_add_f32 v114, v114, v74
    v_add_f32 v115, v115, v75
    v_add_f32 v116, v116, v76
    v_add_f32 v117, v117, v77
    v_add_f32 v118, v118, v78
    v_add_f32 v119, v119, v79
    v_cvt_pk_bf16_f32 v120, v100, v101
    v_cvt_pk_bf16_f32 v121, v102, v103
    v_cvt_pk_bf16_f32 v122, v104, v105
    v_cvt_pk_bf16_f32 v123, v106, v107
    v_cvt_pk_bf16_f32 v124, v108, v109
    v_cvt_pk_bf16_f32 v125, v110, v111
    v_cvt_pk_bf16_f32 v126, v112, v113
    v_cvt_pk_bf16_f32 v127, v114, v115
    v_cvt_pk_bf16_f32 v128, v116, v117
    v_cvt_pk_bf16_f32 v129, v118, v119
    v_lshlrev_b32 v100, 16, v120
    v_and_b32 v101, 0xffff0000, v120
    v_lshlrev_b32 v102, 16, v121
    v_and_b32 v103, 0xffff0000, v121
    v_lshlrev_b32 v104, 16, v122
    v_and_b32 v105, 0xffff0000, v122
    v_lshlrev_b32 v106, 16, v123
    v_and_b32 v107, 0xffff0000, v123
    v_lshlrev_b32 v108, 16, v124
    v_and_b32 v109, 0xffff0000, v124
    v_lshlrev_b32 v110, 16, v125
    v_and_b32 v111, 0xffff0000, v125
    v_lshlrev_b32 v112, 16, v126
    v_and_b32 v113, 0xffff0000, v126
    v_lshlrev_b32 v114, 16, v127
    v_and_b32 v115, 0xffff0000, v127
    v_lshlrev_b32 v116, 16, v128
    v_and_b32 v117, 0xffff0000, v128
    v_lshlrev_b32 v118, 16, v129
    v_and_b32 v119, 0xffff0000, v129
    v_mul_f32 v120, 0xbfb8aa3b, v100
    v_mul_f32 v121, 0xbfb8aa3b, v101
    v_mul_f32 v122, 0xbfb8aa3b, v102
    v_mul_f32 v123, 0xbfb8aa3b, v103
    v_mul_f32 v124, 0xbfb8aa3b, v104
    v_mul_f32 v125, 0xbfb8aa3b, v105
    v_mul_f32 v126, 0xbfb8aa3b, v106
    v_mul_f32 v127, 0xbfb8aa3b, v107
    v_mul_f32 v128, 0xbfb8aa3b, v108
    v_mul_f32 v129, 0xbfb8aa3b, v109
    v_mul_f32 v130, 0xbfb8aa3b, v110
    v_mul_f32 v131, 0xbfb8aa3b, v111
    v_mul_f32 v132, 0xbfb8aa3b, v112
    v_mul_f32 v133, 0xbfb8aa3b, v113
    v_mul_f32 v134, 0xbfb8aa3b, v114
    v_mul_f32 v135, 0xbfb8aa3b, v115
    v_mul_f32 v136, 0xbfb8aa3b, v116
    v_mul_f32 v137, 0xbfb8aa3b, v117
    v_mul_f32 v138, 0xbfb8aa3b, v118
    v_mul_f32 v139, 0xbfb8aa3b, v119
    v_exp_f32 v120, v120
    v_exp_f32 v121, v121
    v_exp_f32 v122, v122
    v_exp_f32 v123, v123
    v_exp_f32 v124, v124
    v_exp_f32 v125, v125
    v_exp_f32 v126, v126
    v_exp_f32 v127, v127
    v_exp_f32 v128, v128
    v_exp_f32 v129, v129
    v_exp_f32 v130, v130
    v_exp_f32 v131, v131
    v_exp_f32 v132, v132
    v_exp_f32 v133, v133
    v_exp_f32 v134, v134
    v_exp_f32 v135, v135
    v_exp_f32 v136, v136
    v_exp_f32 v137, v137
    v_exp_f32 v138, v138
    v_exp_f32 v139, v139
    v_add_f32 v120, 1.0, v120
    v_add_f32 v121, 1.0, v121
    v_add_f32 v122, 1.0, v122
    v_add_f32 v123, 1.0, v123
    v_add_f32 v124, 1.0, v124
    v_add_f32 v125, 1.0, v125
    v_add_f32 v126, 1.0, v126
    v_add_f32 v127, 1.0, v127
    v_add_f32 v128, 1.0, v128
    v_add_f32 v129, 1.0, v129
    v_add_f32 v130, 1.0, v130
    v_add_f32 v131, 1.0, v131
    v_add_f32 v132, 1.0, v132
    v_add_f32 v133, 1.0, v133
    v_add_f32 v134, 1.0, v134
    v_add_f32 v135, 1.0, v135
    v_add_f32 v136, 1.0, v136
    v_add_f32 v137, 1.0, v137
    v_add_f32 v138, 1.0, v138
    v_add_f32 v139, 1.0, v139
    v_rcp_f32 v120, v120
    v_rcp_f32 v121, v121
    v_rcp_f32 v122, v122
    v_rcp_f32 v123, v123
    v_rcp_f32 v124, v124
    v_rcp_f32 v125, v125
    v_rcp_f32 v126, v126
    v_rcp_f32 v127, v127
    v_rcp_f32 v128, v128
    v_rcp_f32 v129, v129
    v_rcp_f32 v130, v130
    v_rcp_f32 v131, v131
    v_rcp_f32 v132, v132
    v_rcp_f32 v133, v133
    v_rcp_f32 v134, v134
    v_rcp_f32 v135, v135
    v_rcp_f32 v136, v136
    v_rcp_f32 v137, v137
    v_rcp_f32 v138, v138
    v_rcp_f32 v139, v139
    v_mul_f32 v100, v100, v120
    v_mul_f32 v101, v101, v121
    v_mul_f32 v102, v102, v122
    v_mul_f32 v103, v103, v123
    v_mul_f32 v104, v104, v124
    v_mul_f32 v105, v105, v125
    v_mul_f32 v106, v106, v126
    v_mul_f32 v107, v107, v127
    v_mul_f32 v108, v108, v128
    v_mul_f32 v109, v109, v129
    v_mul_f32 v110, v110, v130
    v_mul_f32 v111, v111, v131
    v_mul_f32 v112, v112, v132
    v_mul_f32 v113, v113, v133
    v_mul_f32 v114, v114, v134
    v_mul_f32 v115, v115, v135
    v_mul_f32 v116, v116, v136
    v_mul_f32 v117, v117, v137
    v_mul_f32 v118, v118, v138
    v_mul_f32 v119, v119, v139
    v_cvt_pk_bf16_f32 v120, v100, v101
    v_cvt_pk_bf16_f32 v121, v102, v103
    v_cvt_pk_bf16_f32 v122, v104, v105
    v_cvt_pk_bf16_f32 v123, v106, v107
    v_cvt_pk_bf16_f32 v124, v108, v109
    v_cvt_pk_bf16_f32 v125, v110, v111
    v_cvt_pk_bf16_f32 v126, v112, v113
    v_cvt_pk_bf16_f32 v127, v114, v115
    v_cvt_pk_bf16_f32 v128, v116, v117
    v_cvt_pk_bf16_f32 v129, v118, v119
    v_lshlrev_b32 v100, 16, v120
    v_and_b32 v101, 0xffff0000, v120
    v_lshlrev_b32 v102, 16, v121
    v_and_b32 v103, 0xffff0000, v121
    v_lshlrev_b32 v104, 16, v122
    v_and_b32 v105, 0xffff0000, v122
    v_lshlrev_b32 v106, 16, v123
    v_and_b32 v107, 0xffff0000, v123
    v_lshlrev_b32 v108, 16, v124
    v_and_b32 v109, 0xffff0000, v124
    v_lshlrev_b32 v110, 16, v125
    v_and_b32 v111, 0xffff0000, v125
    v_lshlrev_b32 v112, 16, v126
    v_and_b32 v113, 0xffff0000, v126
    v_lshlrev_b32 v114, 16, v127
    v_and_b32 v115, 0xffff0000, v127
    v_lshlrev_b32 v116, 16, v128
    v_and_b32 v117, 0xffff0000, v128
    v_lshlrev_b32 v118, 16, v129
    v_and_b32 v119, 0xffff0000, v129
    v_cmp_eq_u32 vcc, s34, v35
    s_nop 1
    v_cndmask_b32 v80, v80, v100, vcc
    v_cndmask_b32 v81, v81, v101, vcc
    v_cndmask_b32 v82, v82, v102, vcc
    v_cndmask_b32 v83, v83, v103, vcc
    v_cndmask_b32 v84, v84, v104, vcc
    v_cndmask_b32 v85, v85, v105, vcc
    v_cndmask_b32 v86, v86, v106, vcc
    v_cndmask_b32 v87, v87, v107, vcc
    v_cndmask_b32 v88, v88, v108, vcc
    v_cndmask_b32 v89, v89, v109, vcc
    v_cndmask_b32 v90, v90, v110, vcc
    v_cndmask_b32 v91, v91, v111, vcc
    v_cndmask_b32 v92, v92, v112, vcc
    v_cndmask_b32 v93, v93, v113, vcc
    v_cndmask_b32 v94, v94, v114, vcc
    v_cndmask_b32 v95, v95, v115, vcc
    v_cndmask_b32 v96, v96, v116, vcc
    v_cndmask_b32 v97, v97, v117, vcc
    v_cndmask_b32 v98, v98, v118, vcc
    v_cndmask_b32 v99, v99, v119, vcc
L_routed_next:
    s_mov_b32 s56, s57
    s_mov_b32 s57, s58
    s_mov_b32 s58, s59
    s_mov_b32 s59, s60
    s_mov_b32 s60, s61
    s_mov_b32 s61, s62
    s_mov_b32 s62, s63
    s_add_u32 s38, s38, 2560
    s_cmp_lt_u32 s38, 20480
    s_cbranch_scc1 L_routed
    ds_read_b128 v[180:183], v34 offset:0
    ds_read_b128 v[184:187], v34 offset:1024
    ds_read_b128 v[188:191], v34 offset:2048
    ds_read_b128 v[192:195], v34 offset:3072
    ds_read_b128 v[196:199], v34 offset:4096
    ds_read_b128 v[200:203], v34 offset:5120
    ds_read_b128 v[204:207], v34 offset:6144
    ds_read_b128 v[208:211], v34 offset:7168
    ds_read_b128 v[212:215], v34 offset:8192
    ds_read_b128 v[216:219], v34 offset:9216
    ds_read_b128 v[220:223], v34 offset:10240
    ds_read_b128 v[224:227], v34 offset:11264
    ds_read_b128 v[228:231], v34 offset:12288
    ds_read_b128 v[232:235], v34 offset:13312
    ds_read_b128 v[236:239], v34 offset:14336
    s_waitcnt lgkmcnt(10)
    v_add_f32 v160, v160, v180
    v_add_f32 v161, v161, v181
    v_add_f32 v162, v162, v182
    v_add_f32 v163, v163, v183
    v_add_f32 v164, v164, v184
    v_add_f32 v165, v165, v185
    v_add_f32 v166, v166, v186
    v_add_f32 v167, v167, v187
    v_add_f32 v168, v168, v188
    v_add_f32 v169, v169, v189
    v_add_f32 v170, v170, v190
    v_add_f32 v171, v171, v191
    v_add_f32 v172, v172, v192
    v_add_f32 v173, v173, v193
    v_add_f32 v174, v174, v194
    v_add_f32 v175, v175, v195
    v_add_f32 v176, v176, v196
    v_add_f32 v177, v177, v197
    v_add_f32 v178, v178, v198
    v_add_f32 v179, v179, v199
    s_waitcnt lgkmcnt(5)
    v_add_f32 v160, v160, v200
    v_add_f32 v161, v161, v201
    v_add_f32 v162, v162, v202
    v_add_f32 v163, v163, v203
    v_add_f32 v164, v164, v204
    v_add_f32 v165, v165, v205
    v_add_f32 v166, v166, v206
    v_add_f32 v167, v167, v207
    v_add_f32 v168, v168, v208
    v_add_f32 v169, v169, v209
    v_add_f32 v170, v170, v210
    v_add_f32 v171, v171, v211
    v_add_f32 v172, v172, v212
    v_add_f32 v173, v173, v213
    v_add_f32 v174, v174, v214
    v_add_f32 v175, v175, v215
    v_add_f32 v176, v176, v216
    v_add_f32 v177, v177, v217
    v_add_f32 v178, v178, v218
    v_add_f32 v179, v179, v219
    s_waitcnt lgkmcnt(0)
    v_add_f32 v160, v160, v220
    v_add_f32 v161, v161, v221
    v_add_f32 v162, v162, v222
    v_add_f32 v163, v163, v223
    v_add_f32 v164, v164, v224
    v_add_f32 v165, v165, v225
    v_add_f32 v166, v166, v226
    v_add_f32 v167, v167, v227
    v_add_f32 v168, v168, v228
    v_add_f32 v169, v169, v229
    v_add_f32 v170, v170, v230
    v_add_f32 v171, v171, v231
    v_add_f32 v172, v172, v232
    v_add_f32 v173, v173, v233
    v_add_f32 v174, v174, v234
    v_add_f32 v175, v175, v235
    v_add_f32 v176, v176, v236
    v_add_f32 v177, v177, v237
    v_add_f32 v178, v178, v238
    v_add_f32 v179, v179, v239
    v_cvt_pk_bf16_f32 v100, v160, v161
    v_cvt_pk_bf16_f32 v101, v162, v163
    v_cvt_pk_bf16_f32 v102, v164, v165
    v_cvt_pk_bf16_f32 v103, v166, v167
    v_cvt_pk_bf16_f32 v104, v168, v169
    v_cvt_pk_bf16_f32 v105, v170, v171
    v_cvt_pk_bf16_f32 v106, v172, v173
    v_cvt_pk_bf16_f32 v107, v174, v175
    v_cvt_pk_bf16_f32 v108, v176, v177
    v_cvt_pk_bf16_f32 v109, v178, v179
    v_lshlrev_b32 v160, 16, v100
    v_and_b32 v161, 0xffff0000, v100
    v_lshlrev_b32 v162, 16, v101
    v_and_b32 v163, 0xffff0000, v101
    v_lshlrev_b32 v164, 16, v102
    v_and_b32 v165, 0xffff0000, v102
    v_lshlrev_b32 v166, 16, v103
    v_and_b32 v167, 0xffff0000, v103
    v_lshlrev_b32 v168, 16, v104
    v_and_b32 v169, 0xffff0000, v104
    v_lshlrev_b32 v170, 16, v105
    v_and_b32 v171, 0xffff0000, v105
    v_lshlrev_b32 v172, 16, v106
    v_and_b32 v173, 0xffff0000, v106
    v_lshlrev_b32 v174, 16, v107
    v_and_b32 v175, 0xffff0000, v107
    v_lshlrev_b32 v176, 16, v108
    v_and_b32 v177, 0xffff0000, v108
    v_lshlrev_b32 v178, 16, v109
    v_and_b32 v179, 0xffff0000, v109
    v_mul_f32 v160, v160, v80
    v_mul_f32 v161, v161, v81
    v_mul_f32 v162, v162, v82
    v_mul_f32 v163, v163, v83
    v_mul_f32 v164, v164, v84
    v_mul_f32 v165, v165, v85
    v_mul_f32 v166, v166, v86
    v_mul_f32 v167, v167, v87
    v_mul_f32 v168, v168, v88
    v_mul_f32 v169, v169, v89
    v_mul_f32 v170, v170, v90
    v_mul_f32 v171, v171, v91
    v_mul_f32 v172, v172, v92
    v_mul_f32 v173, v173, v93
    v_mul_f32 v174, v174, v94
    v_mul_f32 v175, v175, v95
    v_mul_f32 v176, v176, v96
    v_mul_f32 v177, v177, v97
    v_mul_f32 v178, v178, v98
    v_mul_f32 v179, v179, v99
    v_cvt_pk_bf16_f32 v100, v160, v161
    v_cvt_pk_bf16_f32 v101, v162, v163
    v_cvt_pk_bf16_f32 v102, v164, v165
    v_cvt_pk_bf16_f32 v103, v166, v167
    v_cvt_pk_bf16_f32 v104, v168, v169
    v_cvt_pk_bf16_f32 v105, v170, v171
    v_cvt_pk_bf16_f32 v106, v172, v173
    v_cvt_pk_bf16_f32 v107, v174, v175
    v_cvt_pk_bf16_f32 v108, v176, v177
    v_cvt_pk_bf16_f32 v109, v178, v179
    v_lshlrev_b32 v160, 16, v100
    v_and_b32 v161, 0xffff0000, v100
    v_lshlrev_b32 v162, 16, v101
    v_and_b32 v163, 0xffff0000, v101
    v_lshlrev_b32 v164, 16, v102
    v_and_b32 v165, 0xffff0000, v102
    v_lshlrev_b32 v166, 16, v103
    v_and_b32 v167, 0xffff0000, v103
    v_lshlrev_b32 v168, 16, v104
    v_and_b32 v169, 0xffff0000, v104
    v_lshlrev_b32 v170, 16, v105
    v_and_b32 v171, 0xffff0000, v105
    v_lshlrev_b32 v172, 16, v106
    v_and_b32 v173, 0xffff0000, v106
    v_lshlrev_b32 v174, 16, v107
    v_and_b32 v175, 0xffff0000, v107
    v_lshlrev_b32 v176, 16, v108
    v_and_b32 v177, 0xffff0000, v108
    v_lshlrev_b32 v178, 16, v109
    v_and_b32 v179, 0xffff0000, v109
    v_add_f32 v160, v160, v40
    v_add_f32 v161, v161, v41
    v_add_f32 v162, v162, v42
    v_add_f32 v163, v163, v43
    v_add_f32 v164, v164, v44
    v_add_f32 v165, v165, v45
    v_add_f32 v166, v166, v46
    v_add_f32 v167, v167, v47
    v_add_f32 v168, v168, v48
    v_add_f32 v169, v169, v49
    v_add_f32 v170, v170, v50
    v_add_f32 v171, v171, v51
    v_add_f32 v172, v172, v52
    v_add_f32 v173, v173, v53
    v_add_f32 v174, v174, v54
    v_add_f32 v175, v175, v55
    v_add_f32 v176, v176, v56
    v_add_f32 v177, v177, v57
    v_add_f32 v178, v178, v58
    v_add_f32 v179, v179, v59
    v_cvt_pk_bf16_f32 v100, v160, v161
    v_cvt_pk_bf16_f32 v101, v162, v163
    v_cvt_pk_bf16_f32 v102, v164, v165
    v_cvt_pk_bf16_f32 v103, v166, v167
    v_cvt_pk_bf16_f32 v104, v168, v169
    v_cvt_pk_bf16_f32 v105, v170, v171
    v_cvt_pk_bf16_f32 v106, v172, v173
    v_cvt_pk_bf16_f32 v107, v174, v175
    v_cvt_pk_bf16_f32 v108, v176, v177
    v_cvt_pk_bf16_f32 v109, v178, v179
    buffer_store_dwordx2 v[100:101], v30, s[20:23], 0 offen offset:0
    buffer_store_dwordx2 v[102:103], v30, s[20:23], 0 offen offset:32
    buffer_store_dwordx2 v[104:105], v30, s[20:23], 0 offen offset:64
    buffer_store_dwordx2 v[106:107], v30, s[20:23], 0 offen offset:96
    buffer_store_dwordx2 v[108:109], v30, s[20:23], 0 offen offset:128
L_oproj_end:
    s_endpgm

.section .rodata,"a"
.p2align 6
.amdhsa_kernel ln_kernel
  .amdhsa_next_free_vgpr 96
  .amdhsa_next_free_sgpr 64
  .amdhsa_accum_offset 96
  .amdhsa_group_segment_fixed_size 0
  .amdhsa_kernarg_size 104
  .amdhsa_user_sgpr_count 2
  .amdhsa_user_sgpr_kernarg_segment_ptr 1
  .amdhsa_system_sgpr_workgroup_id_x 1
  .amdhsa_float_denorm_mode_32 3
.end_amdhsa_kernel
.p2align 6
.amdhsa_kernel attn_kernel
  .amdhsa_next_free_vgpr 512
  .amdhsa_next_free_sgpr 100
  .amdhsa_accum_offset 256
  .amdhsa_group_segment_fixed_size 0
  .amdhsa_kernarg_size 104
  .amdhsa_user_sgpr_count 2
  .amdhsa_user_sgpr_kernarg_segment_ptr 1
  .amdhsa_system_sgpr_workgroup_id_x 1
  .amdhsa_float_denorm_mode_32 3
.end_amdhsa_kernel
.p2align 6
.amdhsa_kernel ffn_kernel
  .amdhsa_next_free_vgpr 128
  .amdhsa_next_free_sgpr 80
  .amdhsa_accum_offset 128
  .amdhsa_group_segment_fixed_size 0
  .amdhsa_kernarg_size 104
  .amdhsa_user_sgpr_count 2
  .amdhsa_user_sgpr_kernarg_segment_ptr 1
  .amdhsa_system_sgpr_workgroup_id_x 1
  .amdhsa_float_denorm_mode_32 3
.end_amdhsa_kernel
.p2align 6
.amdhsa_kernel oproj_kernel
  .amdhsa_next_free_vgpr 512
  .amdhsa_next_free_sgpr 100
  .amdhsa_accum_offset 256
  .amdhsa_group_segment_fixed_size 0
  .amdhsa_kernarg_size 104
  .amdhsa_user_sgpr_count 2
  .amdhsa_user_sgpr_kernarg_segment_ptr 1
  .amdhsa_system_sgpr_workgroup_id_x 1
  .amdhsa_float_denorm_mode_32 3
.end_amdhsa_kernel
```

```asm
; @launch grid=(256,1,1) block=(256,1,1) lds=163840
.amdgcn_target "amdgcn-amd-amdhsa--gfx950"
.text
.globl recurrent_scan__mha_block_cached__moe_arch_mod__prompt_kernel
.p2align 8
.type recurrent_scan__mha_block_cached__moe_arch_mod__prompt_kernel,@function
recurrent_scan__mha_block_cached__moe_arch_mod__prompt_kernel:
    s_cmp_ge_u32 s2, 256
    s_cbranch_scc1 L_end
    s_load_dwordx16 s[48:63], s[0:1], 0
    s_load_dwordx8 s[64:71], s[0:1], 64
    s_load_dwordx2 s[72:73], s[0:1], 96
    v_lshrrev_b32 v116, 6, v0
    v_and_b32 v19, 63, v0
    s_and_b32 s40, s2, 7
    v_readfirstlane_b32 s5, v116
    s_lshl_b32 s40, s40, 2
    s_bfe_u32 s41, s2, 0x20003
    s_add_u32 s3, s40, s41
    s_lshr_b32 s4, s2, 5
    s_lshl_b32 s74, s4, 5
    s_add_u32 s6, s74, s3
    v_lshrrev_b32 v118, 4, v19
    v_and_b32 v117, 15, v19
    v_lshlrev_b32 v119, 1, v118
    v_xor_b32 v119, v117, v119
    s_lshl_b32 s42, s5, 4
    v_add_u32 v120, s42, v118
    v_lshlrev_b32 v121, 4, v119
    v_xor_b32 v122, 0x80, v121
    v_lshl_add_u32 v123, v120, 13, v121
    v_lshl_add_u32 v116, v120, 13, v122
    v_add_u32 v44, 0, v123
    v_add_u32 v45, 31744, v123
    v_add_u32 v46, 63488, v116
    v_add_u32 v47, 95232, v116
    v_lshl_add_u32 v17, v120, 8, v121
    v_lshl_add_u32 v18, v120, 8, v122
    v_xor_b32 v117, v117, v118
    v_xor_b32 v121, 0, v117
    v_lshlrev_b32 v121, 4, v121
    v_lshl_add_u32 v13, v120, 8, v121
    v_xor_b32 v121, 4, v117
    v_lshlrev_b32 v121, 4, v121
    v_lshl_add_u32 v14, v120, 8, v121
    v_xor_b32 v121, 8, v117
    v_lshlrev_b32 v121, 4, v121
    v_lshl_add_u32 v15, v120, 8, v121
    v_xor_b32 v121, 12, v117
    v_lshlrev_b32 v121, 4, v121
    v_lshl_add_u32 v16, v120, 8, v121
    v_lshrrev_b32 v116, 3, v19
    v_and_b32 v117, 7, v19
    v_xor_b32 v117, v117, v118
    v_mul_u32_u24 v116, 1280, v116
    s_mul_i32 s42, s5, 81920
    v_lshl_add_u32 v119, v117, 4, v116
    v_xor_b32 v117, 4, v117
    v_lshl_add_u32 v120, v117, 4, v116
    v_add_u32 v119, s42, v119
    v_add_u32 v120, s42, v120
    v_add_u32 v36, 0, v119
    v_add_u32 v37, 9216, v120
    v_add_u32 v38, 18432, v119
    v_add_u32 v39, 27648, v120
    v_add_u32 v40, 40960, v119
    v_add_u32 v41, 50176, v120
    v_add_u32 v42, 59392, v119
    v_add_u32 v43, 68608, v120
    s_lshl_b32 s43, s6, 2
    s_add_u32 s75, s43, 0x290000
    s_add_u32 s43, s43, s5
    s_lshl_b32 s43, s43, 1
    s_mul_i32 s38, s5, 24576
    s_lshl_b32 s40, s5, 12
    s_add_u32 s39, s40, 98304
    s_mov_b32 s34, s39
    s_mov_b32 s28, 0
    s_mov_b32 s29, 0
    s_waitcnt lgkmcnt(0)
    s_mov_b32 s88, s48
    s_mov_b32 s89, s49
    s_mov_b32 s90, 0x280000
    s_mov_b32 s91, 0x20000
    s_mov_b32 s92, s60
    s_mov_b32 s93, s61
    s_mov_b32 s94, 0x500
    s_mov_b32 s95, 0x20000
    v_lshrrev_b32 v108, 5, v19
    v_add_u32 v108, s43, v108
    v_and_b32 v110, 31, v19
    v_lshlrev_b32 v110, 3, v110
    v_mul_u32_u24 v109, 1280, v108
    v_add_u32 v109, v109, v110
    buffer_load_dwordx2 v[60:61], v109, s[88:91], 0 offen offset:0
    buffer_load_dwordx2 v[62:63], v109, s[88:91], 0 offen offset:256
    buffer_load_dwordx2 v[64:65], v109, s[88:91], 0 offen offset:512
    buffer_load_dwordx2 v[66:67], v109, s[88:91], 0 offen offset:768
    buffer_load_dwordx2 v[68:69], v109, s[88:91], 0 offen offset:1024
    buffer_load_dwordx2 v[70:71], v110, s[92:95], 0 offen offset:0
    buffer_load_dwordx2 v[72:73], v110, s[92:95], 0 offen offset:256
    buffer_load_dwordx2 v[74:75], v110, s[92:95], 0 offen offset:512
    buffer_load_dwordx2 v[76:77], v110, s[92:95], 0 offen offset:768
    buffer_load_dwordx2 v[78:79], v110, s[92:95], 0 offen offset:1024
    s_lshl_b32 s40, s3, 8
    s_add_u32 s20, s54, s40
    s_addc_u32 s21, s55, 0
    s_mov_b32 s22, 0x4fe100
    s_mov_b32 s23, 0x20000
    s_mul_i32 s40, s4, 327680
    s_add_u32 s16, s48, s40
    s_addc_u32 s17, s49, 0
    s_mov_b32 s18, 0x50000
    s_mov_b32 s19, 0x20000
    s_add_u32 m0, s39, 0
    s_mov_b32 s37, 0
    buffer_load_dwordx4 v44, s[20:23], s37 offen offset:0 lds
    buffer_load_dwordx4 v45, s[20:23], s37 offen offset:1024 lds
    buffer_load_dwordx4 v46, s[20:23], s37 offen offset:2048 lds
    buffer_load_dwordx4 v47, s[20:23], s37 offen offset:3072 lds
    s_add_u32 m0, s38, 0
    s_mov_b32 s36, 0
    buffer_load_dwordx4 v36, s[16:19], s36 offen offset:0 lds
    buffer_load_dwordx4 v37, s[16:19], s36 offen offset:1024 lds
    buffer_load_dwordx4 v38, s[16:19], s36 offen offset:2048 lds
    buffer_load_dwordx4 v39, s[16:19], s36 offen offset:3072 lds
    s_add_u32 m0, s38, 4096
    s_nop 0
    buffer_load_dwordx4 v40, s[16:19], s36 offen offset:0 lds
    buffer_load_dwordx4 v41, s[16:19], s36 offen offset:1024 lds
    buffer_load_dwordx4 v42, s[16:19], s36 offen offset:2048 lds
    buffer_load_dwordx4 v43, s[16:19], s36 offen offset:3072 lds
    s_add_u32 m0, s39, 16384
    s_mov_b32 s37, 524288
    buffer_load_dwordx4 v44, s[20:23], s37 offen offset:0 lds
    buffer_load_dwordx4 v45, s[20:23], s37 offen offset:1024 lds
    buffer_load_dwordx4 v46, s[20:23], s37 offen offset:2048 lds
    buffer_load_dwordx4 v47, s[20:23], s37 offen offset:3072 lds
    s_add_u32 m0, s38, 8192
    s_mov_b32 s36, 128
    buffer_load_dwordx4 v36, s[16:19], s36 offen offset:0 lds
    buffer_load_dwordx4 v37, s[16:19], s36 offen offset:1024 lds
    buffer_load_dwordx4 v38, s[16:19], s36 offen offset:2048 lds
    buffer_load_dwordx4 v39, s[16:19], s36 offen offset:3072 lds
    s_add_u32 m0, s38, 12288
    s_nop 0
    buffer_load_dwordx4 v40, s[16:19], s36 offen offset:0 lds
    buffer_load_dwordx4 v41, s[16:19], s36 offen offset:1024 lds
    buffer_load_dwordx4 v42, s[16:19], s36 offen offset:2048 lds
    buffer_load_dwordx4 v43, s[16:19], s36 offen offset:3072 lds
    s_add_u32 m0, s39, 32768
    s_mov_b32 s37, 1048576
    buffer_load_dwordx4 v44, s[20:23], s37 offen offset:0 lds
    buffer_load_dwordx4 v45, s[20:23], s37 offen offset:1024 lds
    buffer_load_dwordx4 v46, s[20:23], s37 offen offset:2048 lds
    buffer_load_dwordx4 v47, s[20:23], s37 offen offset:3072 lds
    s_add_u32 m0, s38, 16384
    s_mov_b32 s36, 256
    buffer_load_dwordx4 v36, s[16:19], s36 offen offset:0 lds
    buffer_load_dwordx4 v37, s[16:19], s36 offen offset:1024 lds
    buffer_load_dwordx4 v38, s[16:19], s36 offen offset:2048 lds
    buffer_load_dwordx4 v39, s[16:19], s36 offen offset:3072 lds
    s_add_u32 m0, s38, 20480
    s_nop 0
    buffer_load_dwordx4 v40, s[16:19], s36 offen offset:0 lds
    buffer_load_dwordx4 v41, s[16:19], s36 offen offset:1024 lds
    buffer_load_dwordx4 v42, s[16:19], s36 offen offset:2048 lds
    buffer_load_dwordx4 v43, s[16:19], s36 offen offset:3072 lds
    s_lshl_b32 s40, s3, 19
    s_add_u32 s8, s50, s40
    s_addc_u32 s9, s51, 0
    s_mov_b32 s10, 0x80000
    s_mov_b32 s11, 0x20000
    s_add_u32 s12, s52, s40
    s_addc_u32 s13, s53, 0
    s_mov_b32 s14, 0x80000
    s_mov_b32 s15, 0x20000
    s_add_u32 m0, s34, 49152
    s_nop 0
    buffer_load_dwordx4 v13, s[8:11], s28 offen offset:0 lds
    buffer_load_dwordx4 v14, s[8:11], s28 offen offset:1024 lds
    buffer_load_dwordx4 v15, s[8:11], s28 offen offset:2048 lds
    buffer_load_dwordx4 v16, s[8:11], s28 offen offset:3072 lds
    s_add_u32 s28, s28, 16384
    s_and_b32 s40, s5, 1
    s_lshl_b32 s40, s40, 12
    s_cmp_ge_u32 s5, 2
    s_cselect_b32 s30, 32, 8
    s_cselect_b32 s31, 40, 16
    s_cselect_b32 s32, 0, 56
    s_cselect_b32 s33, 48, 24
    s_lshl_b32 s30, s30, 10
    s_add_u32 s30, s30, s40
    s_lshl_b32 s31, s31, 10
    s_add_u32 s31, s31, s40
    s_lshl_b32 s32, s32, 10
    s_add_u32 s32, s32, s40
    s_lshl_b32 s33, s33, 10
    s_add_u32 s33, s33, s40
    s_mov_b32 s44, 0x3e0293ee
    s_mov_b32 s45, 4096
    s_mov_b32 s86, 0
    s_mov_b32 s76, s72
    s_mov_b32 s77, s73
    s_mov_b32 s78, 0x2000000
    s_mov_b32 s79, 0x20000
    s_mov_b32 s92, s70
    s_mov_b32 s93, s71
    s_mov_b32 s94, 0x100
    s_mov_b32 s95, 0x20000
    s_mov_b32 s96, s56
    s_mov_b32 s97, s57
    s_mov_b32 s98, 0x500000
    s_mov_b32 s99, 0x20000
    s_lshl_b32 s41, s4, 2
    s_add_u32 s41, s41, s5
    s_lshl_b32 s40, s41, 5
    s_add_u32 s40, s40, s3
    s_lshl_b32 s40, s40, 14
    s_add_u32 s40, s40, 0x400000
    s_add_u32 s24, s72, s40
    s_addc_u32 s25, s73, 0
    s_mov_b32 s26, 0x4000
    s_mov_b32 s27, 0x20000
    s_lshl_b32 s40, s41, 5
    s_add_u32 s40, s40, s3
    s_lshl_b32 s40, s40, 2
    s_add_u32 s58, s40, 0x290400
    s_lshl_b32 s40, s6, 2
    s_add_u32 s40, s40, s5
    s_lshl_b32 s40, s40, 2
    s_add_u32 s59, s40, 0x291400
    s_lshl_b32 s41, s41, 9
    s_add_u32 s46, s41, 0x280000
    v_lshrrev_b32 v116, 4, v19
    v_and_b32 v117, 15, v19
    v_lshlrev_b32 v59, 3, v117
    v_xor_b32 v118, v116, v117
    v_lshlrev_b32 v119, 8, v117
    v_add_u32 v119, 98304, v119
    s_add_u32 s41, s5, 0
    s_and_b32 s41, s41, 3
    s_lshl_b32 s41, s41, 2
    v_xor_b32 v120, s41, v118
    v_lshl_add_u32 v1, v120, 4, v119
    s_add_u32 s41, s5, 1
    s_and_b32 s41, s41, 3
    s_lshl_b32 s41, s41, 2
    v_xor_b32 v120, s41, v118
    v_lshl_add_u32 v2, v120, 4, v119
    s_add_u32 s41, s5, 2
    s_and_b32 s41, s41, 3
    s_lshl_b32 s41, s41, 2
    v_xor_b32 v120, s41, v118
    v_lshl_add_u32 v3, v120, 4, v119
    s_add_u32 s41, s5, 3
    s_and_b32 s41, s41, 3
    s_lshl_b32 s41, s41, 2
    v_xor_b32 v120, s41, v118
    v_lshl_add_u32 v4, v120, 4, v119
    v_lshrrev_b32 v118, 1, v117
    v_xor_b32 v118, v116, v118
    v_lshlrev_b32 v119, 7, v117
    v_add_u32 v119, s38, v119
    v_xor_b32 v120, 0, v118
    v_lshl_add_u32 v48, v120, 4, v119
    v_xor_b32 v120, 4, v118
    v_lshl_add_u32 v49, v120, 4, v119
    v_bfe_u32 v118, v19, 2, 2
    v_bfe_u32 v119, v19, 2, 3
    v_and_b32 v120, 3, v19
    v_lshlrev_b32 v120, 3, v120
    v_lshl_add_u32 v121, v116, 2, v118
    v_lshl_add_u32 v121, v121, 8, v120
    v_lshl_add_u32 v122, v116, 3, v118
    v_lshl_add_u32 v122, v122, 8, v120
    v_add_u32 v122, 98304, v122
    v_xor_b32 v123, 0, v119
    v_lshl_add_u32 v5, v123, 5, v121
    v_xor_b32 v123, 1, v119
    v_lshl_add_u32 v6, v123, 5, v121
    v_xor_b32 v123, 2, v119
    v_lshl_add_u32 v7, v123, 5, v121
    v_xor_b32 v123, 3, v119
    v_lshl_add_u32 v8, v123, 5, v121
    v_xor_b32 v123, 4, v119
    v_lshl_add_u32 v9, v123, 5, v121
    v_xor_b32 v123, 5, v119
    v_lshl_add_u32 v10, v123, 5, v121
    v_xor_b32 v123, 6, v119
    v_lshl_add_u32 v11, v123, 5, v121
    v_xor_b32 v123, 7, v119
    v_lshl_add_u32 v12, v123, 5, v121
    s_lshl_b32 s42, s5, 1
    s_add_u32 s41, s42, 0
    s_and_b32 s41, s41, 7
    v_xor_b32 v123, s41, v119
    v_lshl_add_u32 v50, v123, 5, v122
    s_add_u32 s41, s42, 1
    s_and_b32 s41, s41, 7
    v_xor_b32 v123, s41, v119
    v_lshl_add_u32 v51, v123, 5, v122
    s_add_u32 s41, s42, 2
    s_and_b32 s41, s41, 7
    v_xor_b32 v123, s41, v119
    v_lshl_add_u32 v52, v123, 5, v122
    s_add_u32 s41, s42, 3
    s_and_b32 s41, s41, 7
    v_xor_b32 v123, s41, v119
    v_lshl_add_u32 v53, v123, 5, v122
    s_add_u32 s41, s42, 4
    s_and_b32 s41, s41, 7
    v_xor_b32 v123, s41, v119
    v_lshl_add_u32 v54, v123, 5, v122
    s_add_u32 s41, s42, 5
    s_and_b32 s41, s41, 7
    v_xor_b32 v123, s41, v119
    v_lshl_add_u32 v55, v123, 5, v122
    s_add_u32 s41, s42, 6
    s_and_b32 s41, s41, 7
    v_xor_b32 v123, s41, v119
    v_lshl_add_u32 v56, v123, 5, v122
    s_add_u32 s41, s42, 7
    s_and_b32 s41, s41, 7
    v_xor_b32 v123, s41, v119
    v_lshl_add_u32 v57, v123, 5, v122
    s_lshl_b32 s41, s5, 7
    s_add_u32 s41, s41, 65536
    v_lshl_add_u32 v58, v116, 4, s41
    v_mov_b32 v32, 0x3f803f80
    v_mov_b32 v33, 0x3f803f80
    v_mov_b32 v34, 0x3f803f80
    v_mov_b32 v35, 0x3f803f80
    v_and_b32 v120, 1, v19
    v_cmp_eq_u32 vcc, 0, v120
    v_mov_b32 v121, 0x44444444
    v_mov_b32 v122, 0xeeeeeeee
    v_cndmask_b32 v248, v122, v121, vcc
    v_and_b32 v120, 2, v19
    v_cmp_eq_u32 vcc, 0, v120
    v_mov_b32 v27, 1
    v_mov_b32 v28, 0
    v_cndmask_b32 v244, 0, v32, vcc
    v_cndmask_b32 v245, 0, v32, vcc
    v_cndmask_b32 v246, 0, v32, vcc
    v_cndmask_b32 v247, 0, v32, vcc
    v_accvgpr_write_b32 a224, 0
    v_accvgpr_write_b32 a225, 0
    v_accvgpr_write_b32 a226, 0
    v_accvgpr_write_b32 a227, 0
    v_accvgpr_write_b32 a228, 0
    v_accvgpr_write_b32 a229, 0
    v_accvgpr_write_b32 a230, 0
    v_accvgpr_write_b32 a231, 0
    v_accvgpr_write_b32 a232, 0
    v_accvgpr_write_b32 a233, 0
    v_accvgpr_write_b32 a234, 0
    v_accvgpr_write_b32 a235, 0
    v_accvgpr_write_b32 a236, 0
    v_accvgpr_write_b32 a237, 0
    v_accvgpr_write_b32 a238, 0
    v_accvgpr_write_b32 a239, 0
    s_lshr_b32 s40, s6, 1
    s_and_b32 s41, s6, 1
    s_lshl_b32 s41, s41, 2
    s_add_u32 s41, s41, s5
    s_mul_i32 s47, s5, 5120
    s_add_u32 s47, s47, 65536
    s_mul_i32 s42, s40, 40960
    s_mul_i32 s43, s41, 160
    s_add_u32 s42, s42, s43
    v_add_u32 v25, 0, v19
    v_mul_u32_u24 v26, 6554, v25
    v_lshrrev_b32 v26, 16, v26
    v_mul_u32_u24 v20, 1120, v26
    v_lshl_add_u32 v20, v25, 4, v20
    v_add_u32 v20, s42, v20
    v_add_u32 v25, 64, v19
    v_mul_u32_u24 v26, 6554, v25
    v_lshrrev_b32 v26, 16, v26
    v_mul_u32_u24 v21, 1120, v26
    v_lshl_add_u32 v21, v25, 4, v21
    v_add_u32 v21, s42, v21
    v_add_u32 v25, 128, v19
    v_mul_u32_u24 v26, 6554, v25
    v_lshrrev_b32 v26, 16, v26
    v_mul_u32_u24 v22, 1120, v26
    v_lshl_add_u32 v22, v25, 4, v22
    v_add_u32 v22, s42, v22
    v_add_u32 v25, 192, v19
    v_mul_u32_u24 v26, 6554, v25
    v_lshrrev_b32 v26, 16, v26
    v_mul_u32_u24 v23, 1120, v26
    v_lshl_add_u32 v23, v25, 4, v23
    v_add_u32 v23, s42, v23
    v_add_u32 v25, 256, v19
    v_mul_u32_u24 v26, 6554, v25
    v_lshrrev_b32 v26, 16, v26
    v_mul_u32_u24 v24, 1120, v26
    v_lshl_add_u32 v24, v25, 4, v24
    v_add_u32 v24, s42, v24
    v_lshrrev_b32 v25, 2, v19
    v_mul_u32_u24 v25, 160, v25
    v_and_b32 v26, 3, v19
    v_lshl_add_u32 v25, v26, 3, v25
    v_add_u32 v25, s47, v25
    s_lshl_b32 s42, s41, 7
    s_add_u32 s42, s42, s40
    s_mul_i32 s42, s42, 5120
    s_add_u32 s42, s42, 0x1400000
    v_lshlrev_b32 v26, 4, v19
    v_add_u32 v26, s42, v26
    s_mov_b64 exec, 1
    buffer_store_dword v28, off, s[76:79], s75 sc1
    buffer_store_dword v28, off, s[76:79], s58 sc1
    buffer_store_dword v28, off, s[76:79], s59 sc1
    s_mov_b64 exec, -1
    s_waitcnt vmcnt(31)
    s_barrier
    ds_read_b64_tr_b16 a[0:1], v50 offset:0
    ds_read_b64_tr_b16 a[2:3], v50 offset:1024
    ds_read_b128 a[32:35], v48 offset:0
    ds_read_b128 a[36:39], v48 offset:2048
    ds_read_b128 a[40:43], v48 offset:4096
    ds_read_b128 a[44:47], v48 offset:6144
    ds_read_b64_tr_b16 a[4:5], v51 offset:0
    ds_read_b64_tr_b16 a[6:7], v51 offset:1024
    ds_read_b64_tr_b16 a[8:9], v52 offset:0
    ds_read_b64_tr_b16 a[10:11], v52 offset:1024
    ds_read_b64_tr_b16 a[12:13], v53 offset:0
    ds_read_b64_tr_b16 a[14:15], v53 offset:1024
    ds_read_b64_tr_b16 a[16:17], v54 offset:0
    ds_read_b64_tr_b16 a[18:19], v54 offset:1024
    ds_read_b64_tr_b16 a[20:21], v55 offset:0
    ds_read_b64_tr_b16 a[22:23], v55 offset:1024
    ds_read_b64_tr_b16 a[24:25], v56 offset:0
    ds_read_b64_tr_b16 a[26:27], v56 offset:1024
    ds_read_b64_tr_b16 a[28:29], v57 offset:0
    ds_read_b64_tr_b16 a[30:31], v57 offset:1024
    s_waitcnt lgkmcnt(0)
    v_mfma_f32_16x16x32_bf16 v[100:103], a[0:3], v[32:35], 0
    ds_read_b64_tr_b16 a[48:49], v50 offset:8192
    v_mfma_f32_16x16x32_bf16 v[104:107], a[4:7], v[32:35], 0
    ds_read_b64_tr_b16 a[50:51], v50 offset:9216
    v_mfma_f32_16x16x32_bf16 v[116:119], a[0:3], a[32:35], 0
    ds_read_b128 a[80:83], v49 offset:0
    v_mfma_f32_16x16x32_bf16 v[148:151], a[0:3], a[36:39], 0
    ds_read_b128 a[84:87], v49 offset:2048
    v_mfma_f32_16x16x32_bf16 v[180:183], a[0:3], a[40:43], 0
    ds_read_b128 a[88:91], v49 offset:4096
    v_mfma_f32_16x16x32_bf16 v[212:215], a[0:3], a[44:47], 0
    ds_read_b128 a[92:95], v49 offset:6144
    v_mfma_f32_16x16x32_bf16 v[120:123], a[4:7], a[32:35], 0
    ds_read_b64_tr_b16 a[52:53], v51 offset:8192
    v_mfma_f32_16x16x32_bf16 v[152:155], a[4:7], a[36:39], 0
    ds_read_b64_tr_b16 a[54:55], v51 offset:9216
    v_mfma_f32_16x16x32_bf16 v[184:187], a[4:7], a[40:43], 0
    ds_read_b64_tr_b16 a[56:57], v52 offset:8192
    v_mfma_f32_16x16x32_bf16 v[216:219], a[4:7], a[44:47], 0
    ds_read_b64_tr_b16 a[58:59], v52 offset:9216
    v_mfma_f32_16x16x32_bf16 v[124:127], a[8:11], a[32:35], 0
    ds_read_b64_tr_b16 a[60:61], v53 offset:8192
    v_mfma_f32_16x16x32_bf16 v[156:159], a[8:11], a[36:39], 0
    ds_read_b64_tr_b16 a[62:63], v53 offset:9216
    v_mfma_f32_16x16x32_bf16 v[188:191], a[8:11], a[40:43], 0
    ds_read_b64_tr_b16 a[64:65], v54 offset:8192
    v_mfma_f32_16x16x32_bf16 v[220:223], a[8:11], a[44:47], 0
    ds_read_b64_tr_b16 a[66:67], v54 offset:9216
    v_mfma_f32_16x16x32_bf16 v[128:131], a[12:15], a[32:35], 0
    ds_read_b64_tr_b16 a[68:69], v55 offset:8192
    v_mfma_f32_16x16x32_bf16 v[160:163], a[12:15], a[36:39], 0
    ds_read_b64_tr_b16 a[70:71], v55 offset:9216
    v_mfma_f32_16x16x32_bf16 v[192:195], a[12:15], a[40:43], 0
    ds_read_b64_tr_b16 a[72:73], v56 offset:8192
    v_mfma_f32_16x16x32_bf16 v[224:227], a[12:15], a[44:47], 0
    ds_read_b64_tr_b16 a[74:75], v56 offset:9216
    v_mfma_f32_16x16x32_bf16 v[132:135], a[16:19], a[32:35], 0
    ds_read_b64_tr_b16 a[76:77], v57 offset:8192
    v_mfma_f32_16x16x32_bf16 v[164:167], a[16:19], a[36:39], 0
    ds_read_b64_tr_b16 a[78:79], v57 offset:9216
    v_mfma_f32_16x16x32_bf16 v[196:199], a[16:19], a[40:43], 0
    v_mfma_f32_16x16x32_bf16 v[228:231], a[16:19], a[44:47], 0
    v_mfma_f32_16x16x32_bf16 v[136:139], a[20:23], a[32:35], 0
    v_mfma_f32_16x16x32_bf16 v[168:171], a[20:23], a[36:39], 0
    v_mfma_f32_16x16x32_bf16 v[200:203], a[20:23], a[40:43], 0
    v_mfma_f32_16x16x32_bf16 v[232:235], a[20:23], a[44:47], 0
    v_mfma_f32_16x16x32_bf16 v[140:143], a[24:27], a[32:35], 0
    v_mfma_f32_16x16x32_bf16 v[172:175], a[24:27], a[36:39], 0
    v_mfma_f32_16x16x32_bf16 v[204:207], a[24:27], a[40:43], 0
    v_mfma_f32_16x16x32_bf16 v[236:239], a[24:27], a[44:47], 0
    v_mfma_f32_16x16x32_bf16 v[144:147], a[28:31], a[32:35], 0
    v_mfma_f32_16x16x32_bf16 v[176:179], a[28:31], a[36:39], 0
    v_mfma_f32_16x16x32_bf16 v[208:211], a[28:31], a[40:43], 0
    v_mfma_f32_16x16x32_bf16 v[240:243], a[28:31], a[44:47], 0
    v_lshlrev_b32 v80, 16, v60
    v_and_b32 v81, 0xffff0000, v60
    v_lshlrev_b32 v82, 16, v61
    v_and_b32 v83, 0xffff0000, v61
    v_lshlrev_b32 v84, 16, v62
    v_and_b32 v85, 0xffff0000, v62
    v_lshlrev_b32 v86, 16, v63
    v_and_b32 v87, 0xffff0000, v63
    v_lshlrev_b32 v88, 16, v64
    v_and_b32 v89, 0xffff0000, v64
    v_lshlrev_b32 v90, 16, v65
    v_and_b32 v91, 0xffff0000, v65
    v_lshlrev_b32 v92, 16, v66
    v_and_b32 v93, 0xffff0000, v66
    v_lshlrev_b32 v94, 16, v67
    v_and_b32 v95, 0xffff0000, v67
    v_lshlrev_b32 v96, 16, v68
    v_and_b32 v97, 0xffff0000, v68
    v_lshlrev_b32 v98, 16, v69
    v_and_b32 v99, 0xffff0000, v69
    v_add_f32 v109, v80, v81
    v_add_f32 v110, v82, v83
    v_add_f32 v109, v109, v84
    v_add_f32 v110, v110, v85
    v_add_f32 v109, v109, v86
    v_add_f32 v110, v110, v87
    v_add_f32 v109, v109, v88
    v_add_f32 v110, v110, v89
    v_add_f32 v109, v109, v90
    v_add_f32 v110, v110, v91
    v_add_f32 v109, v109, v92
    v_add_f32 v110, v110, v93
    v_add_f32 v109, v109, v94
    v_add_f32 v110, v110, v95
    v_add_f32 v109, v109, v96
    v_add_f32 v110, v110, v97
    v_add_f32 v109, v109, v98
    v_add_f32 v110, v110, v99
    v_add_f32 v109, v109, v110
    s_nop 1
    v_add_f32_dpp v109, v109, v109 quad_perm:[1,0,3,2] row_mask:0xf bank_mask:0xf
    s_nop 1
    v_add_f32_dpp v109, v109, v109 quad_perm:[2,3,0,1] row_mask:0xf bank_mask:0xf
    s_nop 1
    v_add_f32_dpp v109, v109, v109 row_half_mirror row_mask:0xf bank_mask:0xf
    s_nop 1
    v_add_f32_dpp v109, v109, v109 row_mirror row_mask:0xf bank_mask:0xf
    v_mov_b32 v110, v109
    s_nop 1
    v_permlane16_swap_b32 v109, v110
    v_add_f32 v109, v109, v110
    v_mul_f32 v111, 0x3acccccd, v109
    v_sub_f32 v60, v80, v111
    v_mul_f32 v109, v60, v60
    v_sub_f32 v61, v81, v111
    v_mul_f32 v112, v61, v61
    v_sub_f32 v60, v82, v111
    v_fmac_f32 v109, v60, v60
    v_sub_f32 v61, v83, v111
    v_fmac_f32 v112, v61, v61
    v_sub_f32 v60, v84, v111
    v_fmac_f32 v109, v60, v60
    v_sub_f32 v61, v85, v111
    v_fmac_f32 v112, v61, v61
    v_sub_f32 v60, v86, v111
    v_fmac_f32 v109, v60, v60
    v_sub_f32 v61, v87, v111
    v_fmac_f32 v112, v61, v61
    v_sub_f32 v60, v88, v111
    v_fmac_f32 v109, v60, v60
    v_sub_f32 v61, v89, v111
    v_fmac_f32 v112, v61, v61
    v_sub_f32 v60, v90, v111
    v_fmac_f32 v109, v60, v60
    v_sub_f32 v61, v91, v111
    v_fmac_f32 v112, v61, v61
    v_sub_f32 v60, v92, v111
    v_fmac_f32 v109, v60, v60
    v_sub_f32 v61, v93, v111
    v_fmac_f32 v112, v61, v61
    v_sub_f32 v60, v94, v111
    v_fmac_f32 v109, v60, v60
    v_sub_f32 v61, v95, v111
    v_fmac_f32 v112, v61, v61
    v_sub_f32 v60, v96, v111
    v_fmac_f32 v109, v60, v60
    v_sub_f32 v61, v97, v111
    v_fmac_f32 v112, v61, v61
    v_sub_f32 v60, v98, v111
    v_fmac_f32 v109, v60, v60
    v_sub_f32 v61, v99, v111
    v_fmac_f32 v112, v61, v61
    v_add_f32 v109, v109, v112
    s_nop 1
    v_add_f32_dpp v109, v109, v109 quad_perm:[1,0,3,2] row_mask:0xf bank_mask:0xf
    s_nop 1
    v_add_f32_dpp v109, v109, v109 quad_perm:[2,3,0,1] row_mask:0xf bank_mask:0xf
    s_nop 1
    v_add_f32_dpp v109, v109, v109 row_half_mirror row_mask:0xf bank_mask:0xf
    s_nop 1
    v_add_f32_dpp v109, v109, v109 row_mirror row_mask:0xf bank_mask:0xf
    v_mov_b32 v110, v109
    s_nop 1
    v_permlane16_swap_b32 v109, v110
    v_add_f32 v109, v109, v110
    v_mul_f32 v109, 0x3acccccd, v109
    v_cvt_pk_bf16_f32 v110, v111, v109
    v_lshlrev_b32 v111, 16, v110
    v_and_b32 v109, 0xffff0000, v110
    v_add_f32 v109, 0x3727c5ac, v109
    v_cvt_pk_bf16_f32 v109, v109, v109
    v_lshlrev_b32 v109, 16, v109
    v_sqrt_f32 v109, v109
    v_sub_f32 v80, v80, v111
    v_sub_f32 v81, v81, v111
    v_sub_f32 v82, v82, v111
    v_sub_f32 v83, v83, v111
    v_sub_f32 v84, v84, v111
    v_sub_f32 v85, v85, v111
    v_sub_f32 v86, v86, v111
    v_sub_f32 v87, v87, v111
    v_sub_f32 v88, v88, v111
    v_sub_f32 v89, v89, v111
    v_sub_f32 v90, v90, v111
    v_sub_f32 v91, v91, v111
    v_sub_f32 v92, v92, v111
    v_sub_f32 v93, v93, v111
    v_sub_f32 v94, v94, v111
    v_sub_f32 v95, v95, v111
    v_sub_f32 v96, v96, v111
    v_sub_f32 v97, v97, v111
    v_sub_f32 v98, v98, v111
    v_sub_f32 v99, v99, v111
    v_cvt_pk_bf16_f32 v109, v109, v109
    v_lshlrev_b32 v109, 16, v109
    v_rcp_f32 v112, v109
    v_cvt_pk_bf16_f32 v60, v80, v81
    v_cvt_pk_bf16_f32 v61, v82, v83
    v_cvt_pk_bf16_f32 v62, v84, v85
    v_cvt_pk_bf16_f32 v63, v86, v87
    v_cvt_pk_bf16_f32 v64, v88, v89
    v_cvt_pk_bf16_f32 v65, v90, v91
    v_cvt_pk_bf16_f32 v66, v92, v93
    v_cvt_pk_bf16_f32 v67, v94, v95
    v_cvt_pk_bf16_f32 v68, v96, v97
    v_cvt_pk_bf16_f32 v69, v98, v99
    v_lshlrev_b32 v80, 16, v60
    v_and_b32 v81, 0xffff0000, v60
    v_lshlrev_b32 v82, 16, v61
    v_and_b32 v83, 0xffff0000, v61
    v_lshlrev_b32 v84, 16, v62
    v_and_b32 v85, 0xffff0000, v62
    v_lshlrev_b32 v86, 16, v63
    v_and_b32 v87, 0xffff0000, v63
    v_lshlrev_b32 v88, 16, v64
    v_and_b32 v89, 0xffff0000, v64
    v_lshlrev_b32 v90, 16, v65
    v_and_b32 v91, 0xffff0000, v65
    v_lshlrev_b32 v92, 16, v66
    v_and_b32 v93, 0xffff0000, v66
    v_lshlrev_b32 v94, 16, v67
    v_and_b32 v95, 0xffff0000, v67
    v_lshlrev_b32 v96, 16, v68
    v_and_b32 v97, 0xffff0000, v68
    v_lshlrev_b32 v98, 16, v69
    v_and_b32 v99, 0xffff0000, v69
    v_mul_f32 v80, v80, v112
    v_mul_f32 v81, v81, v112
    v_mul_f32 v82, v82, v112
    v_mul_f32 v83, v83, v112
    v_mul_f32 v84, v84, v112
    v_mul_f32 v85, v85, v112
    v_mul_f32 v86, v86, v112
    v_mul_f32 v87, v87, v112
    v_mul_f32 v88, v88, v112
    v_mul_f32 v89, v89, v112
    v_mul_f32 v90, v90, v112
    v_mul_f32 v91, v91, v112
    v_mul_f32 v92, v92, v112
    v_mul_f32 v93, v93, v112
    v_mul_f32 v94, v94, v112
    v_mul_f32 v95, v95, v112
    v_mul_f32 v96, v96, v112
    v_mul_f32 v97, v97, v112
    v_mul_f32 v98, v98, v112
    v_mul_f32 v99, v99, v112
    v_cvt_pk_bf16_f32 v60, v80, v81
    v_cvt_pk_bf16_f32 v61, v82, v83
    v_cvt_pk_bf16_f32 v62, v84, v85
    v_cvt_pk_bf16_f32 v63, v86, v87
    v_cvt_pk_bf16_f32 v64, v88, v89
    v_cvt_pk_bf16_f32 v65, v90, v91
    v_cvt_pk_bf16_f32 v66, v92, v93
    v_cvt_pk_bf16_f32 v67, v94, v95
    v_cvt_pk_bf16_f32 v68, v96, v97
    v_cvt_pk_bf16_f32 v69, v98, v99
    v_mov_b32 v109, 0
    v_dot2c_f32_bf16 v109, v60, v70
    v_dot2c_f32_bf16 v109, v61, v71
    v_dot2c_f32_bf16 v109, v62, v72
    v_dot2c_f32_bf16 v109, v63, v73
    v_dot2c_f32_bf16 v109, v64, v74
    v_dot2c_f32_bf16 v109, v65, v75
    v_dot2c_f32_bf16 v109, v66, v76
    v_dot2c_f32_bf16 v109, v67, v77
    v_dot2c_f32_bf16 v109, v68, v78
    v_dot2c_f32_bf16 v109, v69, v79
    s_nop 2
    s_nop 1
    v_add_f32_dpp v109, v109, v109 quad_perm:[1,0,3,2] row_mask:0xf bank_mask:0xf
    s_nop 1
    v_add_f32_dpp v109, v109, v109 quad_perm:[2,3,0,1] row_mask:0xf bank_mask:0xf
    s_nop 1
    v_add_f32_dpp v109, v109, v109 row_half_mirror row_mask:0xf bank_mask:0xf
    s_nop 1
    v_add_f32_dpp v109, v109, v109 row_mirror row_mask:0xf bank_mask:0xf
    v_mov_b32 v110, v109
    s_nop 1
    v_permlane16_swap_b32 v109, v110
    v_add_f32 v109, v109, v110
    v_cvt_pk_bf16_f32 v109, v109, v109
    v_lshlrev_b32 v109, 16, v109
    v_ashrrev_i32 v110, 31, v109
    v_or_b32 v110, 0x80000000, v110
    v_xor_b32 v109, v109, v110
    v_and_b32 v109, 0xffff0000, v109
    v_sub_u32 v110, 0xffff, v108
    v_or_b32 v109, v109, v110
    v_mov_b32 v60, v111
    v_mov_b32 v61, v112
    v_lshlrev_b32 v110, 3, v108
    v_lshlrev_b32 v108, 2, v108
    s_mov_b32 s40, 0x280000
    s_mov_b32 s41, 0x288000
    s_mov_b32 exec_lo, 1
    s_mov_b32 exec_hi, 1
    buffer_store_dwordx2 v[60:61], v110, s[76:79], s40 offen sc1
    buffer_store_dword v109, v108, s[76:79], s41 offen sc1
    s_mov_b64 exec, -1
    s_waitcnt vmcnt(21) lgkmcnt(0)
    s_barrier
    v_mfma_f32_16x16x32_bf16 v[100:103], a[48:51], v[32:35], v[100:103]
    ds_read_b64_tr_b16 a[0:1], v50 offset:16384
    v_mfma_f32_16x16x32_bf16 v[104:107], a[52:55], v[32:35], v[104:107]
    ds_read_b64_tr_b16 a[2:3], v50 offset:17408
    v_mfma_f32_16x16x32_bf16 v[116:119], a[48:51], a[80:83], v[116:119]
    ds_read_b128 a[32:35], v48 offset:8192
    v_mfma_f32_16x16x32_bf16 v[148:151], a[48:51], a[84:87], v[148:151]
    ds_read_b128 a[36:39], v48 offset:10240
    v_mfma_f32_16x16x32_bf16 v[180:183], a[48:51], a[88:91], v[180:183]
    ds_read_b128 a[40:43], v48 offset:12288
    v_mfma_f32_16x16x32_bf16 v[212:215], a[48:51], a[92:95], v[212:215]
    ds_read_b128 a[44:47], v48 offset:14336
    v_mfma_f32_16x16x32_bf16 v[120:123], a[52:55], a[80:83], v[120:123]
    ds_read_b64_tr_b16 a[4:5], v51 offset:16384
    v_mfma_f32_16x16x32_bf16 v[152:155], a[52:55], a[84:87], v[152:155]
    ds_read_b64_tr_b16 a[6:7], v51 offset:17408
    v_mfma_f32_16x16x32_bf16 v[184:187], a[52:55], a[88:91], v[184:187]
    ds_read_b64_tr_b16 a[8:9], v52 offset:16384
    v_mfma_f32_16x16x32_bf16 v[216:219], a[52:55], a[92:95], v[216:219]
    ds_read_b64_tr_b16 a[10:11], v52 offset:17408
    v_mfma_f32_16x16x32_bf16 v[124:127], a[56:59], a[80:83], v[124:127]
    ds_read_b64_tr_b16 a[12:13], v53 offset:16384
    v_mfma_f32_16x16x32_bf16 v[156:159], a[56:59], a[84:87], v[156:159]
    ds_read_b64_tr_b16 a[14:15], v53 offset:17408
    v_mfma_f32_16x16x32_bf16 v[188:191], a[56:59], a[88:91], v[188:191]
    ds_read_b64_tr_b16 a[16:17], v54 offset:16384
    v_mfma_f32_16x16x32_bf16 v[220:223], a[56:59], a[92:95], v[220:223]
    ds_read_b64_tr_b16 a[18:19], v54 offset:17408
    v_mfma_f32_16x16x32_bf16 v[128:131], a[60:63], a[80:83], v[128:131]
    ds_read_b64_tr_b16 a[20:21], v55 offset:16384
    v_mfma_f32_16x16x32_bf16 v[160:163], a[60:63], a[84:87], v[160:163]
    ds_read_b64_tr_b16 a[22:23], v55 offset:17408
    v_mfma_f32_16x16x32_bf16 v[192:195], a[60:63], a[88:91], v[192:195]
    ds_read_b64_tr_b16 a[24:25], v56 offset:16384
    v_mfma_f32_16x16x32_bf16 v[224:227], a[60:63], a[92:95], v[224:227]
    ds_read_b64_tr_b16 a[26:27], v56 offset:17408
    v_mfma_f32_16x16x32_bf16 v[132:135], a[64:67], a[80:83], v[132:135]
    ds_read_b64_tr_b16 a[28:29], v57 offset:16384
    v_mfma_f32_16x16x32_bf16 v[164:167], a[64:67], a[84:87], v[164:167]
    ds_read_b64_tr_b16 a[30:31], v57 offset:17408
    v_mfma_f32_16x16x32_bf16 v[196:199], a[64:67], a[88:91], v[196:199]
    v_mfma_f32_16x16x32_bf16 v[228:231], a[64:67], a[92:95], v[228:231]
    v_mfma_f32_16x16x32_bf16 v[136:139], a[68:71], a[80:83], v[136:139]
    s_add_u32 m0, s39, 0
    s_mov_b32 s37, 1572864
    v_mfma_f32_16x16x32_bf16 v[168:171], a[68:71], a[84:87], v[168:171]
    buffer_load_dwordx4 v44, s[20:23], s37 offen offset:0 lds
    v_mfma_f32_16x16x32_bf16 v[200:203], a[68:71], a[88:91], v[200:203]
    v_mfma_f32_16x16x32_bf16 v[232:235], a[68:71], a[92:95], v[232:235]
    buffer_load_dwordx4 v45, s[20:23], s37 offen offset:1024 lds
    v_mfma_f32_16x16x32_bf16 v[140:143], a[72:75], a[80:83], v[140:143]
    v_mfma_f32_16x16x32_bf16 v[172:175], a[72:75], a[84:87], v[172:175]
    buffer_load_dwordx4 v46, s[20:23], s37 offen offset:2048 lds
    v_mfma_f32_16x16x32_bf16 v[204:207], a[72:75], a[88:91], v[204:207]
    v_mfma_f32_16x16x32_bf16 v[236:239], a[72:75], a[92:95], v[236:239]
    buffer_load_dwordx4 v47, s[20:23], s37 offen offset:3072 lds
    v_mfma_f32_16x16x32_bf16 v[144:147], a[76:79], a[80:83], v[144:147]
    s_add_u32 m0, s38, 0
    s_mov_b32 s36, 384
    v_mfma_f32_16x16x32_bf16 v[176:179], a[76:79], a[84:87], v[176:179]
    buffer_load_dwordx4 v36, s[16:19], s36 offen offset:0 lds
    v_mfma_f32_16x16x32_bf16 v[208:211], a[76:79], a[88:91], v[208:211]
    v_mfma_f32_16x16x32_bf16 v[240:243], a[76:79], a[92:95], v[240:243]
    buffer_load_dwordx4 v37, s[16:19], s36 offen offset:1024 lds
    s_waitcnt lgkmcnt(0)
    v_mfma_f32_16x16x32_bf16 v[100:103], a[0:3], v[32:35], v[100:103]
    ds_read_b64_tr_b16 a[48:49], v50 offset:24576
    v_mfma_f32_16x16x32_bf16 v[104:107], a[4:7], v[32:35], v[104:107]
    ds_read_b64_tr_b16 a[50:51], v50 offset:25600
    v_mfma_f32_16x16x32_bf16 v[116:119], a[0:3], a[32:35], v[116:119]
    ds_read_b128 a[80:83], v49 offset:8192
    v_mfma_f32_16x16x32_bf16 v[148:151], a[0:3], a[36:39], v[148:151]
    ds_read_b128 a[84:87], v49 offset:10240
    v_mfma_f32_16x16x32_bf16 v[180:183], a[0:3], a[40:43], v[180:183]
    ds_read_b128 a[88:91], v49 offset:12288
    v_mfma_f32_16x16x32_bf16 v[212:215], a[0:3], a[44:47], v[212:215]
    ds_read_b128 a[92:95], v49 offset:14336
    v_mfma_f32_16x16x32_bf16 v[120:123], a[4:7], a[32:35], v[120:123]
    ds_read_b64_tr_b16 a[52:53], v51 offset:24576
    v_mfma_f32_16x16x32_bf16 v[152:155], a[4:7], a[36:39], v[152:155]
    ds_read_b64_tr_b16 a[54:55], v51 offset:25600
    v_mfma_f32_16x16x32_bf16 v[184:187], a[4:7], a[40:43], v[184:187]
    ds_read_b64_tr_b16 a[56:57], v52 offset:24576
    v_mfma_f32_16x16x32_bf16 v[216:219], a[4:7], a[44:47], v[216:219]
    ds_read_b64_tr_b16 a[58:59], v52 offset:25600
    v_mfma_f32_16x16x32_bf16 v[124:127], a[8:11], a[32:35], v[124:127]
    ds_read_b64_tr_b16 a[60:61], v53 offset:24576
    v_mfma_f32_16x16x32_bf16 v[156:159], a[8:11], a[36:39], v[156:159]
    ds_read_b64_tr_b16 a[62:63], v53 offset:25600
    v_mfma_f32_16x16x32_bf16 v[188:191], a[8:11], a[40:43], v[188:191]
    ds_read_b64_tr_b16 a[64:65], v54 offset:24576
    v_mfma_f32_16x16x32_bf16 v[220:223], a[8:11], a[44:47], v[220:223]
    ds_read_b64_tr_b16 a[66:67], v54 offset:25600
    v_mfma_f32_16x16x32_bf16 v[128:131], a[12:15], a[32:35], v[128:131]
    ds_read_b64_tr_b16 a[68:69], v55 offset:24576
    v_mfma_f32_16x16x32_bf16 v[160:163], a[12:15], a[36:39], v[160:163]
    ds_read_b64_tr_b16 a[70:71], v55 offset:25600
    v_mfma_f32_16x16x32_bf16 v[192:195], a[12:15], a[40:43], v[192:195]
    ds_read_b64_tr_b16 a[72:73], v56 offset:24576
    v_mfma_f32_16x16x32_bf16 v[224:227], a[12:15], a[44:47], v[224:227]
    ds_read_b64_tr_b16 a[74:75], v56 offset:25600
    v_mfma_f32_16x16x32_bf16 v[132:135], a[16:19], a[32:35], v[132:135]
    ds_read_b64_tr_b16 a[76:77], v57 offset:24576
    v_mfma_f32_16x16x32_bf16 v[164:167], a[16:19], a[36:39], v[164:167]
    ds_read_b64_tr_b16 a[78:79], v57 offset:25600
    v_mfma_f32_16x16x32_bf16 v[196:199], a[16:19], a[40:43], v[196:199]
    v_mfma_f32_16x16x32_bf16 v[228:231], a[16:19], a[44:47], v[228:231]
    v_mfma_f32_16x16x32_bf16 v[136:139], a[20:23], a[32:35], v[136:139]
    v_mfma_f32_16x16x32_bf16 v[168:171], a[20:23], a[36:39], v[168:171]
    buffer_load_dwordx4 v38, s[16:19], s36 offen offset:2048 lds
    v_mfma_f32_16x16x32_bf16 v[200:203], a[20:23], a[40:43], v[200:203]
    v_mfma_f32_16x16x32_bf16 v[232:235], a[20:23], a[44:47], v[232:235]
    buffer_load_dwordx4 v39, s[16:19], s36 offen offset:3072 lds
    v_mfma_f32_16x16x32_bf16 v[140:143], a[24:27], a[32:35], v[140:143]
    s_add_u32 m0, s38, 4096
    v_mfma_f32_16x16x32_bf16 v[172:175], a[24:27], a[36:39], v[172:175]
    buffer_load_dwordx4 v40, s[16:19], s36 offen offset:0 lds
    v_mfma_f32_16x16x32_bf16 v[204:207], a[24:27], a[40:43], v[204:207]
    v_mfma_f32_16x16x32_bf16 v[236:239], a[24:27], a[44:47], v[236:239]
    buffer_load_dwordx4 v41, s[16:19], s36 offen offset:1024 lds
    v_mfma_f32_16x16x32_bf16 v[144:147], a[28:31], a[32:35], v[144:147]
    v_mfma_f32_16x16x32_bf16 v[176:179], a[28:31], a[36:39], v[176:179]
    buffer_load_dwordx4 v42, s[16:19], s36 offen offset:2048 lds
    v_mfma_f32_16x16x32_bf16 v[208:211], a[28:31], a[40:43], v[208:211]
    v_mfma_f32_16x16x32_bf16 v[240:243], a[28:31], a[44:47], v[240:243]
    buffer_load_dwordx4 v43, s[16:19], s36 offen offset:3072 lds
    s_waitcnt vmcnt(21) lgkmcnt(0)
    s_barrier
    v_mfma_f32_16x16x32_bf16 v[100:103], a[48:51], v[32:35], v[100:103]
    ds_read_b64_tr_b16 a[0:1], v50 offset:32768
    v_mfma_f32_16x16x32_bf16 v[104:107], a[52:55], v[32:35], v[104:107]
    ds_read_b64_tr_b16 a[2:3], v50 offset:33792
    v_mfma_f32_16x16x32_bf16 v[116:119], a[48:51], a[80:83], v[116:119]
    ds_read_b128 a[32:35], v48 offset:16384
    v_mfma_f32_16x16x32_bf16 v[148:151], a[48:51], a[84:87], v[148:151]
    ds_read_b128 a[36:39], v48 offset:18432
    v_mfma_f32_16x16x32_bf16 v[180:183], a[48:51], a[88:91], v[180:183]
    ds_read_b128 a[40:43], v48 offset:20480
    v_mfma_f32_16x16x32_bf16 v[212:215], a[48:51], a[92:95], v[212:215]
    ds_read_b128 a[44:47], v48 offset:22528
    v_mfma_f32_16x16x32_bf16 v[120:123], a[52:55], a[80:83], v[120:123]
    ds_read_b64_tr_b16 a[4:5], v51 offset:32768
    v_mfma_f32_16x16x32_bf16 v[152:155], a[52:55], a[84:87], v[152:155]
    ds_read_b64_tr_b16 a[6:7], v51 offset:33792
    v_mfma_f32_16x16x32_bf16 v[184:187], a[52:55], a[88:91], v[184:187]
    ds_read_b64_tr_b16 a[8:9], v52 offset:32768
    v_mfma_f32_16x16x32_bf16 v[216:219], a[52:55], a[92:95], v[216:219]
    ds_read_b64_tr_b16 a[10:11], v52 offset:33792
    v_mfma_f32_16x16x32_bf16 v[124:127], a[56:59], a[80:83], v[124:127]
    ds_read_b64_tr_b16 a[12:13], v53 offset:32768
    v_mfma_f32_16x16x32_bf16 v[156:159], a[56:59], a[84:87], v[156:159]
    ds_read_b64_tr_b16 a[14:15], v53 offset:33792
    v_mfma_f32_16x16x32_bf16 v[188:191], a[56:59], a[88:91], v[188:191]
    ds_read_b64_tr_b16 a[16:17], v54 offset:32768
    v_mfma_f32_16x16x32_bf16 v[220:223], a[56:59], a[92:95], v[220:223]
    ds_read_b64_tr_b16 a[18:19], v54 offset:33792
    v_mfma_f32_16x16x32_bf16 v[128:131], a[60:63], a[80:83], v[128:131]
    ds_read_b64_tr_b16 a[20:21], v55 offset:32768
    v_mfma_f32_16x16x32_bf16 v[160:163], a[60:63], a[84:87], v[160:163]
    ds_read_b64_tr_b16 a[22:23], v55 offset:33792
    v_mfma_f32_16x16x32_bf16 v[192:195], a[60:63], a[88:91], v[192:195]
    ds_read_b64_tr_b16 a[24:25], v56 offset:32768
    v_mfma_f32_16x16x32_bf16 v[224:227], a[60:63], a[92:95], v[224:227]
    ds_read_b64_tr_b16 a[26:27], v56 offset:33792
    v_mfma_f32_16x16x32_bf16 v[132:135], a[64:67], a[80:83], v[132:135]
    ds_read_b64_tr_b16 a[28:29], v57 offset:32768
    v_mfma_f32_16x16x32_bf16 v[164:167], a[64:67], a[84:87], v[164:167]
    ds_read_b64_tr_b16 a[30:31], v57 offset:33792
    v_mfma_f32_16x16x32_bf16 v[196:199], a[64:67], a[88:91], v[196:199]
    v_mfma_f32_16x16x32_bf16 v[228:231], a[64:67], a[92:95], v[228:231]
    v_mfma_f32_16x16x32_bf16 v[136:139], a[68:71], a[80:83], v[136:139]
    s_add_u32 m0, s39, 16384
    s_mov_b32 s37, 2097152
    v_mfma_f32_16x16x32_bf16 v[168:171], a[68:71], a[84:87], v[168:171]
    buffer_load_dwordx4 v44, s[20:23], s37 offen offset:0 lds
    v_mfma_f32_16x16x32_bf16 v[200:203], a[68:71], a[88:91], v[200:203]
    v_mfma_f32_16x16x32_bf16 v[232:235], a[68:71], a[92:95], v[232:235]
    buffer_load_dwordx4 v45, s[20:23], s37 offen offset:1024 lds
    v_mfma_f32_16x16x32_bf16 v[140:143], a[72:75], a[80:83], v[140:143]
    v_mfma_f32_16x16x32_bf16 v[172:175], a[72:75], a[84:87], v[172:175]
    buffer_load_dwordx4 v46, s[20:23], s37 offen offset:2048 lds
    v_mfma_f32_16x16x32_bf16 v[204:207], a[72:75], a[88:91], v[204:207]
    v_mfma_f32_16x16x32_bf16 v[236:239], a[72:75], a[92:95], v[236:239]
    buffer_load_dwordx4 v47, s[20:23], s37 offen offset:3072 lds
    v_mfma_f32_16x16x32_bf16 v[144:147], a[76:79], a[80:83], v[144:147]
    s_add_u32 m0, s38, 8192
    s_mov_b32 s36, 512
    v_mfma_f32_16x16x32_bf16 v[176:179], a[76:79], a[84:87], v[176:179]
    buffer_load_dwordx4 v36, s[16:19], s36 offen offset:0 lds
    v_mfma_f32_16x16x32_bf16 v[208:211], a[76:79], a[88:91], v[208:211]
    v_mfma_f32_16x16x32_bf16 v[240:243], a[76:79], a[92:95], v[240:243]
    buffer_load_dwordx4 v37, s[16:19], s36 offen offset:1024 lds
    s_waitcnt lgkmcnt(0)
    v_mfma_f32_16x16x32_bf16 v[100:103], a[0:3], v[32:35], v[100:103]
    ds_read_b64_tr_b16 a[48:49], v50 offset:40960
    v_mfma_f32_16x16x32_bf16 v[104:107], a[4:7], v[32:35], v[104:107]
    ds_read_b64_tr_b16 a[50:51], v50 offset:41984
    v_mfma_f32_16x16x32_bf16 v[116:119], a[0:3], a[32:35], v[116:119]
    ds_read_b128 a[80:83], v49 offset:16384
    v_mfma_f32_16x16x32_bf16 v[148:151], a[0:3], a[36:39], v[148:151]
    ds_read_b128 a[84:87], v49 offset:18432
    v_mfma_f32_16x16x32_bf16 v[180:183], a[0:3], a[40:43], v[180:183]
    ds_read_b128 a[88:91], v49 offset:20480
    v_mfma_f32_16x16x32_bf16 v[212:215], a[0:3], a[44:47], v[212:215]
    ds_read_b128 a[92:95], v49 offset:22528
    v_mfma_f32_16x16x32_bf16 v[120:123], a[4:7], a[32:35], v[120:123]
    ds_read_b64_tr_b16 a[52:53], v51 offset:40960
    v_mfma_f32_16x16x32_bf16 v[152:155], a[4:7], a[36:39], v[152:155]
    ds_read_b64_tr_b16 a[54:55], v51 offset:41984
    v_mfma_f32_16x16x32_bf16 v[184:187], a[4:7], a[40:43], v[184:187]
    ds_read_b64_tr_b16 a[56:57], v52 offset:40960
    v_mfma_f32_16x16x32_bf16 v[216:219], a[4:7], a[44:47], v[216:219]
    ds_read_b64_tr_b16 a[58:59], v52 offset:41984
    v_mfma_f32_16x16x32_bf16 v[124:127], a[8:11], a[32:35], v[124:127]
    ds_read_b64_tr_b16 a[60:61], v53 offset:40960
    v_mfma_f32_16x16x32_bf16 v[156:159], a[8:11], a[36:39], v[156:159]
    ds_read_b64_tr_b16 a[62:63], v53 offset:41984
    v_mfma_f32_16x16x32_bf16 v[188:191], a[8:11], a[40:43], v[188:191]
    ds_read_b64_tr_b16 a[64:65], v54 offset:40960
    v_mfma_f32_16x16x32_bf16 v[220:223], a[8:11], a[44:47], v[220:223]
    ds_read_b64_tr_b16 a[66:67], v54 offset:41984
    v_mfma_f32_16x16x32_bf16 v[128:131], a[12:15], a[32:35], v[128:131]
    ds_read_b64_tr_b16 a[68:69], v55 offset:40960
    v_mfma_f32_16x16x32_bf16 v[160:163], a[12:15], a[36:39], v[160:163]
    ds_read_b64_tr_b16 a[70:71], v55 offset:41984
    v_mfma_f32_16x16x32_bf16 v[192:195], a[12:15], a[40:43], v[192:195]
    ds_read_b64_tr_b16 a[72:73], v56 offset:40960
    v_mfma_f32_16x16x32_bf16 v[224:227], a[12:15], a[44:47], v[224:227]
    ds_read_b64_tr_b16 a[74:75], v56 offset:41984
    v_mfma_f32_16x16x32_bf16 v[132:135], a[16:19], a[32:35], v[132:135]
    ds_read_b64_tr_b16 a[76:77], v57 offset:40960
    v_mfma_f32_16x16x32_bf16 v[164:167], a[16:19], a[36:39], v[164:167]
    ds_read_b64_tr_b16 a[78:79], v57 offset:41984
    v_mfma_f32_16x16x32_bf16 v[196:199], a[16:19], a[40:43], v[196:199]
    v_mfma_f32_16x16x32_bf16 v[228:231], a[16:19], a[44:47], v[228:231]
    v_mfma_f32_16x16x32_bf16 v[136:139], a[20:23], a[32:35], v[136:139]
    v_mfma_f32_16x16x32_bf16 v[168:171], a[20:23], a[36:39], v[168:171]
    buffer_load_dwordx4 v38, s[16:19], s36 offen offset:2048 lds
    v_mfma_f32_16x16x32_bf16 v[200:203], a[20:23], a[40:43], v[200:203]
    v_mfma_f32_16x16x32_bf16 v[232:235], a[20:23], a[44:47], v[232:235]
    buffer_load_dwordx4 v39, s[16:19], s36 offen offset:3072 lds
    v_mfma_f32_16x16x32_bf16 v[140:143], a[24:27], a[32:35], v[140:143]
    s_add_u32 m0, s38, 12288
    v_mfma_f32_16x16x32_bf16 v[172:175], a[24:27], a[36:39], v[172:175]
    buffer_load_dwordx4 v40, s[16:19], s36 offen offset:0 lds
    v_mfma_f32_16x16x32_bf16 v[204:207], a[24:27], a[40:43], v[204:207]
    v_mfma_f32_16x16x32_bf16 v[236:239], a[24:27], a[44:47], v[236:239]
    buffer_load_dwordx4 v41, s[16:19], s36 offen offset:1024 lds
    v_mfma_f32_16x16x32_bf16 v[144:147], a[28:31], a[32:35], v[144:147]
    v_mfma_f32_16x16x32_bf16 v[176:179], a[28:31], a[36:39], v[176:179]
    buffer_load_dwordx4 v42, s[16:19], s36 offen offset:2048 lds
    v_mfma_f32_16x16x32_bf16 v[208:211], a[28:31], a[40:43], v[208:211]
    v_mfma_f32_16x16x32_bf16 v[240:243], a[28:31], a[44:47], v[240:243]
    buffer_load_dwordx4 v43, s[16:19], s36 offen offset:3072 lds
    s_waitcnt vmcnt(12) lgkmcnt(0)
    s_barrier
    s_cmp_lg_u32 s5, 0
    s_cbranch_scc1 L_signalled
    s_mov_b64 exec, 1
    buffer_atomic_add v27, off, s[92:95], s74 sc1
    s_mov_b64 exec, -1
L_signalled:
    v_mfma_f32_16x16x32_bf16 v[100:103], a[48:51], v[32:35], v[100:103]
    ds_read_b64_tr_b16 a[0:1], v50 offset:0
    v_mfma_f32_16x16x32_bf16 v[104:107], a[52:55], v[32:35], v[104:107]
    ds_read_b64_tr_b16 a[2:3], v50 offset:1024
    v_mfma_f32_16x16x32_bf16 v[116:119], a[48:51], a[80:83], v[116:119]
    ds_read_b128 a[32:35], v48 offset:0
    v_mfma_f32_16x16x32_bf16 v[148:151], a[48:51], a[84:87], v[148:151]
    ds_read_b128 a[36:39], v48 offset:2048
    v_mfma_f32_16x16x32_bf16 v[180:183], a[48:51], a[88:91], v[180:183]
    ds_read_b128 a[40:43], v48 offset:4096
    v_mfma_f32_16x16x32_bf16 v[212:215], a[48:51], a[92:95], v[212:215]
    ds_read_b128 a[44:47], v48 offset:6144
    v_mfma_f32_16x16x32_bf16 v[120:123], a[52:55], a[80:83], v[120:123]
    ds_read_b64_tr_b16 a[4:5], v51 offset:0
    v_mfma_f32_16x16x32_bf16 v[152:155], a[52:55], a[84:87], v[152:155]
    ds_read_b64_tr_b16 a[6:7], v51 offset:1024
    v_mfma_f32_16x16x32_bf16 v[184:187], a[52:55], a[88:91], v[184:187]
    ds_read_b64_tr_b16 a[8:9], v52 offset:0
    v_mfma_f32_16x16x32_bf16 v[216:219], a[52:55], a[92:95], v[216:219]
    ds_read_b64_tr_b16 a[10:11], v52 offset:1024
    v_mfma_f32_16x16x32_bf16 v[124:127], a[56:59], a[80:83], v[124:127]
    ds_read_b64_tr_b16 a[12:13], v53 offset:0
    v_mfma_f32_16x16x32_bf16 v[156:159], a[56:59], a[84:87], v[156:159]
    ds_read_b64_tr_b16 a[14:15], v53 offset:1024
    v_mfma_f32_16x16x32_bf16 v[188:191], a[56:59], a[88:91], v[188:191]
    ds_read_b64_tr_b16 a[16:17], v54 offset:0
    v_mfma_f32_16x16x32_bf16 v[220:223], a[56:59], a[92:95], v[220:223]
    ds_read_b64_tr_b16 a[18:19], v54 offset:1024
    v_mfma_f32_16x16x32_bf16 v[128:131], a[60:63], a[80:83], v[128:131]
    ds_read_b64_tr_b16 a[20:21], v55 offset:0
    v_mfma_f32_16x16x32_bf16 v[160:163], a[60:63], a[84:87], v[160:163]
    ds_read_b64_tr_b16 a[22:23], v55 offset:1024
    v_mfma_f32_16x16x32_bf16 v[192:195], a[60:63], a[88:91], v[192:195]
    ds_read_b64_tr_b16 a[24:25], v56 offset:0
    v_mfma_f32_16x16x32_bf16 v[224:227], a[60:63], a[92:95], v[224:227]
    ds_read_b64_tr_b16 a[26:27], v56 offset:1024
    v_mfma_f32_16x16x32_bf16 v[132:135], a[64:67], a[80:83], v[132:135]
    ds_read_b64_tr_b16 a[28:29], v57 offset:0
    v_mfma_f32_16x16x32_bf16 v[164:167], a[64:67], a[84:87], v[164:167]
    ds_read_b64_tr_b16 a[30:31], v57 offset:1024
    v_mfma_f32_16x16x32_bf16 v[196:199], a[64:67], a[88:91], v[196:199]
    v_mfma_f32_16x16x32_bf16 v[228:231], a[64:67], a[92:95], v[228:231]
    v_mfma_f32_16x16x32_bf16 v[136:139], a[68:71], a[80:83], v[136:139]
    s_add_u32 m0, s39, 32768
    s_mov_b32 s37, 2621440
    v_mfma_f32_16x16x32_bf16 v[168:171], a[68:71], a[84:87], v[168:171]
    buffer_load_dwordx4 v44, s[20:23], s37 offen offset:0 lds
    v_mfma_f32_16x16x32_bf16 v[200:203], a[68:71], a[88:91], v[200:203]
    v_mfma_f32_16x16x32_bf16 v[232:235], a[68:71], a[92:95], v[232:235]
    buffer_load_dwordx4 v45, s[20:23], s37 offen offset:1024 lds
    v_mfma_f32_16x16x32_bf16 v[140:143], a[72:75], a[80:83], v[140:143]
    v_mfma_f32_16x16x32_bf16 v[172:175], a[72:75], a[84:87], v[172:175]
    buffer_load_dwordx4 v46, s[20:23], s37 offen offset:2048 lds
    v_mfma_f32_16x16x32_bf16 v[204:207], a[72:75], a[88:91], v[204:207]
    v_mfma_f32_16x16x32_bf16 v[236:239], a[72:75], a[92:95], v[236:239]
    buffer_load_dwordx4 v47, s[20:23], s37 offen offset:3072 lds
    v_mfma_f32_16x16x32_bf16 v[144:147], a[76:79], a[80:83], v[144:147]
    s_add_u32 m0, s38, 16384
    s_mov_b32 s36, 640
    v_mfma_f32_16x16x32_bf16 v[176:179], a[76:79], a[84:87], v[176:179]
    buffer_load_dwordx4 v36, s[16:19], s36 offen offset:0 lds
    v_mfma_f32_16x16x32_bf16 v[208:211], a[76:79], a[88:91], v[208:211]
    v_mfma_f32_16x16x32_bf16 v[240:243], a[76:79], a[92:95], v[240:243]
    buffer_load_dwordx4 v37, s[16:19], s36 offen offset:1024 lds
    s_waitcnt lgkmcnt(0)
    v_mfma_f32_16x16x32_bf16 v[100:103], a[0:3], v[32:35], v[100:103]
    ds_read_b64_tr_b16 a[48:49], v50 offset:8192
    v_mfma_f32_16x16x32_bf16 v[104:107], a[4:7], v[32:35], v[104:107]
    ds_read_b64_tr_b16 a[50:51], v50 offset:9216
    v_mfma_f32_16x16x32_bf16 v[116:119], a[0:3], a[32:35], v[116:119]
    ds_read_b128 a[80:83], v49 offset:0
    v_mfma_f32_16x16x32_bf16 v[148:151], a[0:3], a[36:39], v[148:151]
    ds_read_b128 a[84:87], v49 offset:2048
    v_mfma_f32_16x16x32_bf16 v[180:183], a[0:3], a[40:43], v[180:183]
    ds_read_b128 a[88:91], v49 offset:4096
    v_mfma_f32_16x16x32_bf16 v[212:215], a[0:3], a[44:47], v[212:215]
    ds_read_b128 a[92:95], v49 offset:6144
    v_mfma_f32_16x16x32_bf16 v[120:123], a[4:7], a[32:35], v[120:123]
    ds_read_b64_tr_b16 a[52:53], v51 offset:8192
    v_mfma_f32_16x16x32_bf16 v[152:155], a[4:7], a[36:39], v[152:155]
    ds_read_b64_tr_b16 a[54:55], v51 offset:9216
    v_mfma_f32_16x16x32_bf16 v[184:187], a[4:7], a[40:43], v[184:187]
    ds_read_b64_tr_b16 a[56:57], v52 offset:8192
    v_mfma_f32_16x16x32_bf16 v[216:219], a[4:7], a[44:47], v[216:219]
    ds_read_b64_tr_b16 a[58:59], v52 offset:9216
    v_mfma_f32_16x16x32_bf16 v[124:127], a[8:11], a[32:35], v[124:127]
    ds_read_b64_tr_b16 a[60:61], v53 offset:8192
    v_mfma_f32_16x16x32_bf16 v[156:159], a[8:11], a[36:39], v[156:159]
    ds_read_b64_tr_b16 a[62:63], v53 offset:9216
    v_mfma_f32_16x16x32_bf16 v[188:191], a[8:11], a[40:43], v[188:191]
    ds_read_b64_tr_b16 a[64:65], v54 offset:8192
    v_mfma_f32_16x16x32_bf16 v[220:223], a[8:11], a[44:47], v[220:223]
    ds_read_b64_tr_b16 a[66:67], v54 offset:9216
    v_mfma_f32_16x16x32_bf16 v[128:131], a[12:15], a[32:35], v[128:131]
    ds_read_b64_tr_b16 a[68:69], v55 offset:8192
    v_mfma_f32_16x16x32_bf16 v[160:163], a[12:15], a[36:39], v[160:163]
    ds_read_b64_tr_b16 a[70:71], v55 offset:9216
    v_mfma_f32_16x16x32_bf16 v[192:195], a[12:15], a[40:43], v[192:195]
    ds_read_b64_tr_b16 a[72:73], v56 offset:8192
    v_mfma_f32_16x16x32_bf16 v[224:227], a[12:15], a[44:47], v[224:227]
    ds_read_b64_tr_b16 a[74:75], v56 offset:9216
    v_mfma_f32_16x16x32_bf16 v[132:135], a[16:19], a[32:35], v[132:135]
    ds_read_b64_tr_b16 a[76:77], v57 offset:8192
    v_mfma_f32_16x16x32_bf16 v[164:167], a[16:19], a[36:39], v[164:167]
    ds_read_b64_tr_b16 a[78:79], v57 offset:9216
    v_mfma_f32_16x16x32_bf16 v[196:199], a[16:19], a[40:43], v[196:199]
    v_mfma_f32_16x16x32_bf16 v[228:231], a[16:19], a[44:47], v[228:231]
    v_mfma_f32_16x16x32_bf16 v[136:139], a[20:23], a[32:35], v[136:139]
    v_mfma_f32_16x16x32_bf16 v[168:171], a[20:23], a[36:39], v[168:171]
    buffer_load_dwordx4 v38, s[16:19], s36 offen offset:2048 lds
    v_mfma_f32_16x16x32_bf16 v[200:203], a[20:23], a[40:43], v[200:203]
    v_mfma_f32_16x16x32_bf16 v[232:235], a[20:23], a[44:47], v[232:235]
    buffer_load_dwordx4 v39, s[16:19], s36 offen offset:3072 lds
    v_mfma_f32_16x16x32_bf16 v[140:143], a[24:27], a[32:35], v[140:143]
    s_add_u32 m0, s38, 20480
    v_mfma_f32_16x16x32_bf16 v[172:175], a[24:27], a[36:39], v[172:175]
    buffer_load_dwordx4 v40, s[16:19], s36 offen offset:0 lds
    v_mfma_f32_16x16x32_bf16 v[204:207], a[24:27], a[40:43], v[204:207]
    v_mfma_f32_16x16x32_bf16 v[236:239], a[24:27], a[44:47], v[236:239]
    buffer_load_dwordx4 v41, s[16:19], s36 offen offset:1024 lds
    v_mfma_f32_16x16x32_bf16 v[144:147], a[28:31], a[32:35], v[144:147]
    v_mfma_f32_16x16x32_bf16 v[176:179], a[28:31], a[36:39], v[176:179]
    buffer_load_dwordx4 v42, s[16:19], s36 offen offset:2048 lds
    v_mfma_f32_16x16x32_bf16 v[208:211], a[28:31], a[40:43], v[208:211]
    v_mfma_f32_16x16x32_bf16 v[240:243], a[28:31], a[44:47], v[240:243]
    buffer_load_dwordx4 v43, s[16:19], s36 offen offset:3072 lds
    s_waitcnt vmcnt(12) lgkmcnt(0)
    s_barrier
    v_mfma_f32_16x16x32_bf16 v[100:103], a[48:51], v[32:35], v[100:103]
    ds_read_b64_tr_b16 a[0:1], v50 offset:16384
    v_mfma_f32_16x16x32_bf16 v[104:107], a[52:55], v[32:35], v[104:107]
    ds_read_b64_tr_b16 a[2:3], v50 offset:17408
    v_mfma_f32_16x16x32_bf16 v[116:119], a[48:51], a[80:83], v[116:119]
    ds_read_b128 a[32:35], v48 offset:8192
    v_mfma_f32_16x16x32_bf16 v[148:151], a[48:51], a[84:87], v[148:151]
    ds_read_b128 a[36:39], v48 offset:10240
    v_mfma_f32_16x16x32_bf16 v[180:183], a[48:51], a[88:91], v[180:183]
    ds_read_b128 a[40:43], v48 offset:12288
    v_mfma_f32_16x16x32_bf16 v[212:215], a[48:51], a[92:95], v[212:215]
    ds_read_b128 a[44:47], v48 offset:14336
    v_mfma_f32_16x16x32_bf16 v[120:123], a[52:55], a[80:83], v[120:123]
    ds_read_b64_tr_b16 a[4:5], v51 offset:16384
    v_mfma_f32_16x16x32_bf16 v[152:155], a[52:55], a[84:87], v[152:155]
    ds_read_b64_tr_b16 a[6:7], v51 offset:17408
    v_mfma_f32_16x16x32_bf16 v[184:187], a[52:55], a[88:91], v[184:187]
    ds_read_b64_tr_b16 a[8:9], v52 offset:16384
    v_mfma_f32_16x16x32_bf16 v[216:219], a[52:55], a[92:95], v[216:219]
    ds_read_b64_tr_b16 a[10:11], v52 offset:17408
    v_mfma_f32_16x16x32_bf16 v[124:127], a[56:59], a[80:83], v[124:127]
    ds_read_b64_tr_b16 a[12:13], v53 offset:16384
    v_mfma_f32_16x16x32_bf16 v[156:159], a[56:59], a[84:87], v[156:159]
    ds_read_b64_tr_b16 a[14:15], v53 offset:17408
    v_mfma_f32_16x16x32_bf16 v[188:191], a[56:59], a[88:91], v[188:191]
    ds_read_b64_tr_b16 a[16:17], v54 offset:16384
    v_mfma_f32_16x16x32_bf16 v[220:223], a[56:59], a[92:95], v[220:223]
    ds_read_b64_tr_b16 a[18:19], v54 offset:17408
    v_mfma_f32_16x16x32_bf16 v[128:131], a[60:63], a[80:83], v[128:131]
    ds_read_b64_tr_b16 a[20:21], v55 offset:16384
    v_mfma_f32_16x16x32_bf16 v[160:163], a[60:63], a[84:87], v[160:163]
    ds_read_b64_tr_b16 a[22:23], v55 offset:17408
    v_mfma_f32_16x16x32_bf16 v[192:195], a[60:63], a[88:91], v[192:195]
    ds_read_b64_tr_b16 a[24:25], v56 offset:16384
    v_mfma_f32_16x16x32_bf16 v[224:227], a[60:63], a[92:95], v[224:227]
    ds_read_b64_tr_b16 a[26:27], v56 offset:17408
    v_mfma_f32_16x16x32_bf16 v[132:135], a[64:67], a[80:83], v[132:135]
    ds_read_b64_tr_b16 a[28:29], v57 offset:16384
    v_mfma_f32_16x16x32_bf16 v[164:167], a[64:67], a[84:87], v[164:167]
    ds_read_b64_tr_b16 a[30:31], v57 offset:17408
    v_mfma_f32_16x16x32_bf16 v[196:199], a[64:67], a[88:91], v[196:199]
    v_mfma_f32_16x16x32_bf16 v[228:231], a[64:67], a[92:95], v[228:231]
    v_mfma_f32_16x16x32_bf16 v[136:139], a[68:71], a[80:83], v[136:139]
    s_add_u32 m0, s39, 0
    s_mov_b32 s37, 3145728
    v_mfma_f32_16x16x32_bf16 v[168:171], a[68:71], a[84:87], v[168:171]
    buffer_load_dwordx4 v44, s[20:23], s37 offen offset:0 lds
    v_mfma_f32_16x16x32_bf16 v[200:203], a[68:71], a[88:91], v[200:203]
    v_mfma_f32_16x16x32_bf16 v[232:235], a[68:71], a[92:95], v[232:235]
    buffer_load_dwordx4 v45, s[20:23], s37 offen offset:1024 lds
    v_mfma_f32_16x16x32_bf16 v[140:143], a[72:75], a[80:83], v[140:143]
    v_mfma_f32_16x16x32_bf16 v[172:175], a[72:75], a[84:87], v[172:175]
    buffer_load_dwordx4 v46, s[20:23], s37 offen offset:2048 lds
    v_mfma_f32_16x16x32_bf16 v[204:207], a[72:75], a[88:91], v[204:207]
    v_mfma_f32_16x16x32_bf16 v[236:239], a[72:75], a[92:95], v[236:239]
    buffer_load_dwordx4 v47, s[20:23], s37 offen offset:3072 lds
    v_mfma_f32_16x16x32_bf16 v[144:147], a[76:79], a[80:83], v[144:147]
    s_add_u32 m0, s38, 0
    s_mov_b32 s36, 768
    v_mfma_f32_16x16x32_bf16 v[176:179], a[76:79], a[84:87], v[176:179]
    buffer_load_dwordx4 v36, s[16:19], s36 offen offset:0 lds
    v_mfma_f32_16x16x32_bf16 v[208:211], a[76:79], a[88:91], v[208:211]
    v_mfma_f32_16x16x32_bf16 v[240:243], a[76:79], a[92:95], v[240:243]
    buffer_load_dwordx4 v37, s[16:19], s36 offen offset:1024 lds
    s_waitcnt lgkmcnt(0)
    v_mfma_f32_16x16x32_bf16 v[100:103], a[0:3], v[32:35], v[100:103]
    ds_read_b64_tr_b16 a[48:49], v50 offset:24576
    v_mfma_f32_16x16x32_bf16 v[104:107], a[4:7], v[32:35], v[104:107]
    ds_read_b64_tr_b16 a[50:51], v50 offset:25600
    v_mfma_f32_16x16x32_bf16 v[116:119], a[0:3], a[32:35], v[116:119]
    ds_read_b128 a[80:83], v49 offset:8192
    v_mfma_f32_16x16x32_bf16 v[148:151], a[0:3], a[36:39], v[148:151]
    ds_read_b128 a[84:87], v49 offset:10240
    v_mfma_f32_16x16x32_bf16 v[180:183], a[0:3], a[40:43], v[180:183]
    ds_read_b128 a[88:91], v49 offset:12288
    v_mfma_f32_16x16x32_bf16 v[212:215], a[0:3], a[44:47], v[212:215]
    ds_read_b128 a[92:95], v49 offset:14336
    v_mfma_f32_16x16x32_bf16 v[120:123], a[4:7], a[32:35], v[120:123]
    ds_read_b64_tr_b16 a[52:53], v51 offset:24576
    v_mfma_f32_16x16x32_bf16 v[152:155], a[4:7], a[36:39], v[152:155]
    ds_read_b64_tr_b16 a[54:55], v51 offset:25600
    v_mfma_f32_16x16x32_bf16 v[184:187], a[4:7], a[40:43], v[184:187]
    ds_read_b64_tr_b16 a[56:57], v52 offset:24576
    v_mfma_f32_16x16x32_bf16 v[216:219], a[4:7], a[44:47], v[216:219]
    ds_read_b64_tr_b16 a[58:59], v52 offset:25600
    v_mfma_f32_16x16x32_bf16 v[124:127], a[8:11], a[32:35], v[124:127]
    ds_read_b64_tr_b16 a[60:61], v53 offset:24576
    v_mfma_f32_16x16x32_bf16 v[156:159], a[8:11], a[36:39], v[156:159]
    ds_read_b64_tr_b16 a[62:63], v53 offset:25600
    v_mfma_f32_16x16x32_bf16 v[188:191], a[8:11], a[40:43], v[188:191]
    ds_read_b64_tr_b16 a[64:65], v54 offset:24576
    v_mfma_f32_16x16x32_bf16 v[220:223], a[8:11], a[44:47], v[220:223]
    ds_read_b64_tr_b16 a[66:67], v54 offset:25600
    v_mfma_f32_16x16x32_bf16 v[128:131], a[12:15], a[32:35], v[128:131]
    ds_read_b64_tr_b16 a[68:69], v55 offset:24576
    v_mfma_f32_16x16x32_bf16 v[160:163], a[12:15], a[36:39], v[160:163]
    ds_read_b64_tr_b16 a[70:71], v55 offset:25600
    v_mfma_f32_16x16x32_bf16 v[192:195], a[12:15], a[40:43], v[192:195]
    ds_read_b64_tr_b16 a[72:73], v56 offset:24576
    v_mfma_f32_16x16x32_bf16 v[224:227], a[12:15], a[44:47], v[224:227]
    ds_read_b64_tr_b16 a[74:75], v56 offset:25600
    v_mfma_f32_16x16x32_bf16 v[132:135], a[16:19], a[32:35], v[132:135]
    ds_read_b64_tr_b16 a[76:77], v57 offset:24576
    v_mfma_f32_16x16x32_bf16 v[164:167], a[16:19], a[36:39], v[164:167]
    ds_read_b64_tr_b16 a[78:79], v57 offset:25600
    v_mfma_f32_16x16x32_bf16 v[196:199], a[16:19], a[40:43], v[196:199]
    v_mfma_f32_16x16x32_bf16 v[228:231], a[16:19], a[44:47], v[228:231]
    v_mfma_f32_16x16x32_bf16 v[136:139], a[20:23], a[32:35], v[136:139]
    v_mfma_f32_16x16x32_bf16 v[168:171], a[20:23], a[36:39], v[168:171]
    buffer_load_dwordx4 v38, s[16:19], s36 offen offset:2048 lds
    v_mfma_f32_16x16x32_bf16 v[200:203], a[20:23], a[40:43], v[200:203]
    v_mfma_f32_16x16x32_bf16 v[232:235], a[20:23], a[44:47], v[232:235]
    buffer_load_dwordx4 v39, s[16:19], s36 offen offset:3072 lds
    v_mfma_f32_16x16x32_bf16 v[140:143], a[24:27], a[32:35], v[140:143]
    s_add_u32 m0, s38, 4096
    v_mfma_f32_16x16x32_bf16 v[172:175], a[24:27], a[36:39], v[172:175]
    buffer_load_dwordx4 v40, s[16:19], s36 offen offset:0 lds
    v_mfma_f32_16x16x32_bf16 v[204:207], a[24:27], a[40:43], v[204:207]
    v_mfma_f32_16x16x32_bf16 v[236:239], a[24:27], a[44:47], v[236:239]
    buffer_load_dwordx4 v41, s[16:19], s36 offen offset:1024 lds
    v_mfma_f32_16x16x32_bf16 v[144:147], a[28:31], a[32:35], v[144:147]
    v_mfma_f32_16x16x32_bf16 v[176:179], a[28:31], a[36:39], v[176:179]
    buffer_load_dwordx4 v42, s[16:19], s36 offen offset:2048 lds
    v_mfma_f32_16x16x32_bf16 v[208:211], a[28:31], a[40:43], v[208:211]
    v_mfma_f32_16x16x32_bf16 v[240:243], a[28:31], a[44:47], v[240:243]
    buffer_load_dwordx4 v43, s[16:19], s36 offen offset:3072 lds
    s_waitcnt vmcnt(12) lgkmcnt(0)
    s_barrier
    v_mfma_f32_16x16x32_bf16 v[100:103], a[48:51], v[32:35], v[100:103]
    ds_read_b64_tr_b16 a[0:1], v50 offset:32768
    v_mfma_f32_16x16x32_bf16 v[104:107], a[52:55], v[32:35], v[104:107]
    ds_read_b64_tr_b16 a[2:3], v50 offset:33792
    v_mfma_f32_16x16x32_bf16 v[116:119], a[48:51], a[80:83], v[116:119]
    ds_read_b128 a[32:35], v48 offset:16384
    v_mfma_f32_16x16x32_bf16 v[148:151], a[48:51], a[84:87], v[148:151]
    ds_read_b128 a[36:39], v48 offset:18432
    v_mfma_f32_16x16x32_bf16 v[180:183], a[48:51], a[88:91], v[180:183]
    ds_read_b128 a[40:43], v48 offset:20480
    v_mfma_f32_16x16x32_bf16 v[212:215], a[48:51], a[92:95], v[212:215]
    ds_read_b128 a[44:47], v48 offset:22528
    v_mfma_f32_16x16x32_bf16 v[120:123], a[52:55], a[80:83], v[120:123]
    ds_read_b64_tr_b16 a[4:5], v51 offset:32768
    v_mfma_f32_16x16x32_bf16 v[152:155], a[52:55], a[84:87], v[152:155]
    ds_read_b64_tr_b16 a[6:7], v51 offset:33792
    v_mfma_f32_16x16x32_bf16 v[184:187], a[52:55], a[88:91], v[184:187]
    ds_read_b64_tr_b16 a[8:9], v52 offset:32768
    v_mfma_f32_16x16x32_bf16 v[216:219], a[52:55], a[92:95], v[216:219]
    ds_read_b64_tr_b16 a[10:11], v52 offset:33792
    v_mfma_f32_16x16x32_bf16 v[124:127], a[56:59], a[80:83], v[124:127]
    ds_read_b64_tr_b16 a[12:13], v53 offset:32768
    v_mfma_f32_16x16x32_bf16 v[156:159], a[56:59], a[84:87], v[156:159]
    ds_read_b64_tr_b16 a[14:15], v53 offset:33792
    v_mfma_f32_16x16x32_bf16 v[188:191], a[56:59], a[88:91], v[188:191]
    ds_read_b64_tr_b16 a[16:17], v54 offset:32768
    v_mfma_f32_16x16x32_bf16 v[220:223], a[56:59], a[92:95], v[220:223]
    ds_read_b64_tr_b16 a[18:19], v54 offset:33792
    v_mfma_f32_16x16x32_bf16 v[128:131], a[60:63], a[80:83], v[128:131]
    ds_read_b64_tr_b16 a[20:21], v55 offset:32768
    v_mfma_f32_16x16x32_bf16 v[160:163], a[60:63], a[84:87], v[160:163]
    ds_read_b64_tr_b16 a[22:23], v55 offset:33792
    v_mfma_f32_16x16x32_bf16 v[192:195], a[60:63], a[88:91], v[192:195]
    ds_read_b64_tr_b16 a[24:25], v56 offset:32768
    v_mfma_f32_16x16x32_bf16 v[224:227], a[60:63], a[92:95], v[224:227]
    ds_read_b64_tr_b16 a[26:27], v56 offset:33792
    v_mfma_f32_16x16x32_bf16 v[132:135], a[64:67], a[80:83], v[132:135]
    ds_read_b64_tr_b16 a[28:29], v57 offset:32768
    v_mfma_f32_16x16x32_bf16 v[164:167], a[64:67], a[84:87], v[164:167]
    ds_read_b64_tr_b16 a[30:31], v57 offset:33792
    v_mfma_f32_16x16x32_bf16 v[196:199], a[64:67], a[88:91], v[196:199]
    v_mfma_f32_16x16x32_bf16 v[228:231], a[64:67], a[92:95], v[228:231]
    v_mfma_f32_16x16x32_bf16 v[136:139], a[68:71], a[80:83], v[136:139]
    s_add_u32 m0, s39, 16384
    s_mov_b32 s37, 3670016
    v_mfma_f32_16x16x32_bf16 v[168:171], a[68:71], a[84:87], v[168:171]
    buffer_load_dwordx4 v44, s[20:23], s37 offen offset:0 lds
    v_mfma_f32_16x16x32_bf16 v[200:203], a[68:71], a[88:91], v[200:203]
    v_mfma_f32_16x16x32_bf16 v[232:235], a[68:71], a[92:95], v[232:235]
    buffer_load_dwordx4 v45, s[20:23], s37 offen offset:1024 lds
    v_mfma_f32_16x16x32_bf16 v[140:143], a[72:75], a[80:83], v[140:143]
    v_mfma_f32_16x16x32_bf16 v[172:175], a[72:75], a[84:87], v[172:175]
    buffer_load_dwordx4 v46, s[20:23], s37 offen offset:2048 lds
    v_mfma_f32_16x16x32_bf16 v[204:207], a[72:75], a[88:91], v[204:207]
    v_mfma_f32_16x16x32_bf16 v[236:239], a[72:75], a[92:95], v[236:239]
    buffer_load_dwordx4 v47, s[20:23], s37 offen offset:3072 lds
    v_mfma_f32_16x16x32_bf16 v[144:147], a[76:79], a[80:83], v[144:147]
    s_add_u32 m0, s38, 8192
    s_mov_b32 s36, 896
    v_mfma_f32_16x16x32_bf16 v[176:179], a[76:79], a[84:87], v[176:179]
    buffer_load_dwordx4 v36, s[16:19], s36 offen offset:0 lds
    v_mfma_f32_16x16x32_bf16 v[208:211], a[76:79], a[88:91], v[208:211]
    v_mfma_f32_16x16x32_bf16 v[240:243], a[76:79], a[92:95], v[240:243]
    buffer_load_dwordx4 v37, s[16:19], s36 offen offset:1024 lds
    s_waitcnt lgkmcnt(0)
    v_mfma_f32_16x16x32_bf16 v[100:103], a[0:3], v[32:35], v[100:103]
    ds_read_b64_tr_b16 a[48:49], v50 offset:40960
    v_mfma_f32_16x16x32_bf16 v[104:107], a[4:7], v[32:35], v[104:107]
    ds_read_b64_tr_b16 a[50:51], v50 offset:41984
    v_mfma_f32_16x16x32_bf16 v[116:119], a[0:3], a[32:35], v[116:119]
    ds_read_b128 a[80:83], v49 offset:16384
    v_mfma_f32_16x16x32_bf16 v[148:151], a[0:3], a[36:39], v[148:151]
    ds_read_b128 a[84:87], v49 offset:18432
    v_mfma_f32_16x16x32_bf16 v[180:183], a[0:3], a[40:43], v[180:183]
    ds_read_b128 a[88:91], v49 offset:20480
    v_mfma_f32_16x16x32_bf16 v[212:215], a[0:3], a[44:47], v[212:215]
    ds_read_b128 a[92:95], v49 offset:22528
    v_mfma_f32_16x16x32_bf16 v[120:123], a[4:7], a[32:35], v[120:123]
    ds_read_b64_tr_b16 a[52:53], v51 offset:40960
    v_mfma_f32_16x16x32_bf16 v[152:155], a[4:7], a[36:39], v[152:155]
    ds_read_b64_tr_b16 a[54:55], v51 offset:41984
    v_mfma_f32_16x16x32_bf16 v[184:187], a[4:7], a[40:43], v[184:187]
    ds_read_b64_tr_b16 a[56:57], v52 offset:40960
    v_mfma_f32_16x16x32_bf16 v[216:219], a[4:7], a[44:47], v[216:219]
    ds_read_b64_tr_b16 a[58:59], v52 offset:41984
    v_mfma_f32_16x16x32_bf16 v[124:127], a[8:11], a[32:35], v[124:127]
    ds_read_b64_tr_b16 a[60:61], v53 offset:40960
    v_mfma_f32_16x16x32_bf16 v[156:159], a[8:11], a[36:39], v[156:159]
    ds_read_b64_tr_b16 a[62:63], v53 offset:41984
    v_mfma_f32_16x16x32_bf16 v[188:191], a[8:11], a[40:43], v[188:191]
    ds_read_b64_tr_b16 a[64:65], v54 offset:40960
    v_mfma_f32_16x16x32_bf16 v[220:223], a[8:11], a[44:47], v[220:223]
    ds_read_b64_tr_b16 a[66:67], v54 offset:41984
    v_mfma_f32_16x16x32_bf16 v[128:131], a[12:15], a[32:35], v[128:131]
    ds_read_b64_tr_b16 a[68:69], v55 offset:40960
    v_mfma_f32_16x16x32_bf16 v[160:163], a[12:15], a[36:39], v[160:163]
    ds_read_b64_tr_b16 a[70:71], v55 offset:41984
    v_mfma_f32_16x16x32_bf16 v[192:195], a[12:15], a[40:43], v[192:195]
    ds_read_b64_tr_b16 a[72:73], v56 offset:40960
    v_mfma_f32_16x16x32_bf16 v[224:227], a[12:15], a[44:47], v[224:227]
    ds_read_b64_tr_b16 a[74:75], v56 offset:41984
    v_mfma_f32_16x16x32_bf16 v[132:135], a[16:19], a[32:35], v[132:135]
    ds_read_b64_tr_b16 a[76:77], v57 offset:40960
    v_mfma_f32_16x16x32_bf16 v[164:167], a[16:19], a[36:39], v[164:167]
    ds_read_b64_tr_b16 a[78:79], v57 offset:41984
    v_mfma_f32_16x16x32_bf16 v[196:199], a[16:19], a[40:43], v[196:199]
    v_mfma_f32_16x16x32_bf16 v[228:231], a[16:19], a[44:47], v[228:231]
    v_mfma_f32_16x16x32_bf16 v[136:139], a[20:23], a[32:35], v[136:139]
    v_mfma_f32_16x16x32_bf16 v[168:171], a[20:23], a[36:39], v[168:171]
    buffer_load_dwordx4 v38, s[16:19], s36 offen offset:2048 lds
    v_mfma_f32_16x16x32_bf16 v[200:203], a[20:23], a[40:43], v[200:203]
    v_mfma_f32_16x16x32_bf16 v[232:235], a[20:23], a[44:47], v[232:235]
    buffer_load_dwordx4 v39, s[16:19], s36 offen offset:3072 lds
    v_mfma_f32_16x16x32_bf16 v[140:143], a[24:27], a[32:35], v[140:143]
    s_add_u32 m0, s38, 12288
    v_mfma_f32_16x16x32_bf16 v[172:175], a[24:27], a[36:39], v[172:175]
    buffer_load_dwordx4 v40, s[16:19], s36 offen offset:0 lds
    v_mfma_f32_16x16x32_bf16 v[204:207], a[24:27], a[40:43], v[204:207]
    v_mfma_f32_16x16x32_bf16 v[236:239], a[24:27], a[44:47], v[236:239]
    buffer_load_dwordx4 v41, s[16:19], s36 offen offset:1024 lds
    v_mfma_f32_16x16x32_bf16 v[144:147], a[28:31], a[32:35], v[144:147]
    v_mfma_f32_16x16x32_bf16 v[176:179], a[28:31], a[36:39], v[176:179]
    buffer_load_dwordx4 v42, s[16:19], s36 offen offset:2048 lds
    v_mfma_f32_16x16x32_bf16 v[208:211], a[28:31], a[40:43], v[208:211]
    v_mfma_f32_16x16x32_bf16 v[240:243], a[28:31], a[44:47], v[240:243]
    buffer_load_dwordx4 v43, s[16:19], s36 offen offset:3072 lds
    s_waitcnt vmcnt(12) lgkmcnt(0)
    s_barrier
    v_mfma_f32_16x16x32_bf16 v[100:103], a[48:51], v[32:35], v[100:103]
    ds_read_b64_tr_b16 a[0:1], v50 offset:0
    v_mfma_f32_16x16x32_bf16 v[104:107], a[52:55], v[32:35], v[104:107]
    ds_read_b64_tr_b16 a[2:3], v50 offset:1024
    v_mfma_f32_16x16x32_bf16 v[116:119], a[48:51], a[80:83], v[116:119]
    ds_read_b128 a[32:35], v48 offset:0
    v_mfma_f32_16x16x32_bf16 v[148:151], a[48:51], a[84:87], v[148:151]
    ds_read_b128 a[36:39], v48 offset:2048
    v_mfma_f32_16x16x32_bf16 v[180:183], a[48:51], a[88:91], v[180:183]
    ds_read_b128 a[40:43], v48 offset:4096
    v_mfma_f32_16x16x32_bf16 v[212:215], a[48:51], a[92:95], v[212:215]
    ds_read_b128 a[44:47], v48 offset:6144
    v_mfma_f32_16x16x32_bf16 v[120:123], a[52:55], a[80:83], v[120:123]
    ds_read_b64_tr_b16 a[4:5], v51 offset:0
    v_mfma_f32_16x16x32_bf16 v[152:155], a[52:55], a[84:87], v[152:155]
    ds_read_b64_tr_b16 a[6:7], v51 offset:1024
    v_mfma_f32_16x16x32_bf16 v[184:187], a[52:55], a[88:91], v[184:187]
    ds_read_b64_tr_b16 a[8:9], v52 offset:0
    v_mfma_f32_16x16x32_bf16 v[216:219], a[52:55], a[92:95], v[216:219]
    ds_read_b64_tr_b16 a[10:11], v52 offset:1024
    v_mfma_f32_16x16x32_bf16 v[124:127], a[56:59], a[80:83], v[124:127]
    ds_read_b64_tr_b16 a[12:13], v53 offset:0
    v_mfma_f32_16x16x32_bf16 v[156:159], a[56:59], a[84:87], v[156:159]
    ds_read_b64_tr_b16 a[14:15], v53 offset:1024
    v_mfma_f32_16x16x32_bf16 v[188:191], a[56:59], a[88:91], v[188:191]
    ds_read_b64_tr_b16 a[16:17], v54 offset:0
    v_mfma_f32_16x16x32_bf16 v[220:223], a[56:59], a[92:95], v[220:223]
    ds_read_b64_tr_b16 a[18:19], v54 offset:1024
    v_mfma_f32_16x16x32_bf16 v[128:131], a[60:63], a[80:83], v[128:131]
    ds_read_b64_tr_b16 a[20:21], v55 offset:0
    v_mfma_f32_16x16x32_bf16 v[160:163], a[60:63], a[84:87], v[160:163]
    ds_read_b64_tr_b16 a[22:23], v55 offset:1024
    v_mfma_f32_16x16x32_bf16 v[192:195], a[60:63], a[88:91], v[192:195]
    ds_read_b64_tr_b16 a[24:25], v56 offset:0
    v_mfma_f32_16x16x32_bf16 v[224:227], a[60:63], a[92:95], v[224:227]
    ds_read_b64_tr_b16 a[26:27], v56 offset:1024
    v_mfma_f32_16x16x32_bf16 v[132:135], a[64:67], a[80:83], v[132:135]
    ds_read_b64_tr_b16 a[28:29], v57 offset:0
    v_mfma_f32_16x16x32_bf16 v[164:167], a[64:67], a[84:87], v[164:167]
    ds_read_b64_tr_b16 a[30:31], v57 offset:1024
    v_mfma_f32_16x16x32_bf16 v[196:199], a[64:67], a[88:91], v[196:199]
    v_mfma_f32_16x16x32_bf16 v[228:231], a[64:67], a[92:95], v[228:231]
    v_mfma_f32_16x16x32_bf16 v[136:139], a[68:71], a[80:83], v[136:139]
    s_add_u32 m0, s39, 32768
    s_mov_b32 s37, 4194304
    v_mfma_f32_16x16x32_bf16 v[168:171], a[68:71], a[84:87], v[168:171]
    buffer_load_dwordx4 v44, s[20:23], s37 offen offset:0 lds
    v_mfma_f32_16x16x32_bf16 v[200:203], a[68:71], a[88:91], v[200:203]
    v_mfma_f32_16x16x32_bf16 v[232:235], a[68:71], a[92:95], v[232:235]
    buffer_load_dwordx4 v45, s[20:23], s37 offen offset:1024 lds
    v_mfma_f32_16x16x32_bf16 v[140:143], a[72:75], a[80:83], v[140:143]
    v_mfma_f32_16x16x32_bf16 v[172:175], a[72:75], a[84:87], v[172:175]
    buffer_load_dwordx4 v46, s[20:23], s37 offen offset:2048 lds
    v_mfma_f32_16x16x32_bf16 v[204:207], a[72:75], a[88:91], v[204:207]
    v_mfma_f32_16x16x32_bf16 v[236:239], a[72:75], a[92:95], v[236:239]
    buffer_load_dwordx4 v47, s[20:23], s37 offen offset:3072 lds
    v_mfma_f32_16x16x32_bf16 v[144:147], a[76:79], a[80:83], v[144:147]
    s_add_u32 m0, s38, 16384
    s_mov_b32 s36, 1024
    v_mfma_f32_16x16x32_bf16 v[176:179], a[76:79], a[84:87], v[176:179]
    buffer_load_dwordx4 v36, s[16:19], s36 offen offset:0 lds
    v_mfma_f32_16x16x32_bf16 v[208:211], a[76:79], a[88:91], v[208:211]
    v_mfma_f32_16x16x32_bf16 v[240:243], a[76:79], a[92:95], v[240:243]
    buffer_load_dwordx4 v37, s[16:19], s36 offen offset:1024 lds
    s_waitcnt lgkmcnt(0)
    v_mfma_f32_16x16x32_bf16 v[100:103], a[0:3], v[32:35], v[100:103]
    ds_read_b64_tr_b16 a[48:49], v50 offset:8192
    v_mfma_f32_16x16x32_bf16 v[104:107], a[4:7], v[32:35], v[104:107]
    ds_read_b64_tr_b16 a[50:51], v50 offset:9216
    v_mfma_f32_16x16x32_bf16 v[116:119], a[0:3], a[32:35], v[116:119]
    ds_read_b128 a[80:83], v49 offset:0
    v_mfma_f32_16x16x32_bf16 v[148:151], a[0:3], a[36:39], v[148:151]
    ds_read_b128 a[84:87], v49 offset:2048
    v_mfma_f32_16x16x32_bf16 v[180:183], a[0:3], a[40:43], v[180:183]
    ds_read_b128 a[88:91], v49 offset:4096
    v_mfma_f32_16x16x32_bf16 v[212:215], a[0:3], a[44:47], v[212:215]
    ds_read_b128 a[92:95], v49 offset:6144
    v_mfma_f32_16x16x32_bf16 v[120:123], a[4:7], a[32:35], v[120:123]
    ds_read_b64_tr_b16 a[52:53], v51 offset:8192
    v_mfma_f32_16x16x32_bf16 v[152:155], a[4:7], a[36:39], v[152:155]
    ds_read_b64_tr_b16 a[54:55], v51 offset:9216
    v_mfma_f32_16x16x32_bf16 v[184:187], a[4:7], a[40:43], v[184:187]
    ds_read_b64_tr_b16 a[56:57], v52 offset:8192
    v_mfma_f32_16x16x32_bf16 v[216:219], a[4:7], a[44:47], v[216:219]
    ds_read_b64_tr_b16 a[58:59], v52 offset:9216
    v_mfma_f32_16x16x32_bf16 v[124:127], a[8:11], a[32:35], v[124:127]
    ds_read_b64_tr_b16 a[60:61], v53 offset:8192
    v_mfma_f32_16x16x32_bf16 v[156:159], a[8:11], a[36:39], v[156:159]
    ds_read_b64_tr_b16 a[62:63], v53 offset:9216
    v_mfma_f32_16x16x32_bf16 v[188:191], a[8:11], a[40:43], v[188:191]
    ds_read_b64_tr_b16 a[64:65], v54 offset:8192
    v_mfma_f32_16x16x32_bf16 v[220:223], a[8:11], a[44:47], v[220:223]
    ds_read_b64_tr_b16 a[66:67], v54 offset:9216
    v_mfma_f32_16x16x32_bf16 v[128:131], a[12:15], a[32:35], v[128:131]
    ds_read_b64_tr_b16 a[68:69], v55 offset:8192
    v_mfma_f32_16x16x32_bf16 v[160:163], a[12:15], a[36:39], v[160:163]
    ds_read_b64_tr_b16 a[70:71], v55 offset:9216
    v_mfma_f32_16x16x32_bf16 v[192:195], a[12:15], a[40:43], v[192:195]
    ds_read_b64_tr_b16 a[72:73], v56 offset:8192
    v_mfma_f32_16x16x32_bf16 v[224:227], a[12:15], a[44:47], v[224:227]
    ds_read_b64_tr_b16 a[74:75], v56 offset:9216
    v_mfma_f32_16x16x32_bf16 v[132:135], a[16:19], a[32:35], v[132:135]
    ds_read_b64_tr_b16 a[76:77], v57 offset:8192
    v_mfma_f32_16x16x32_bf16 v[164:167], a[16:19], a[36:39], v[164:167]
    ds_read_b64_tr_b16 a[78:79], v57 offset:9216
    v_mfma_f32_16x16x32_bf16 v[196:199], a[16:19], a[40:43], v[196:199]
    v_mfma_f32_16x16x32_bf16 v[228:231], a[16:19], a[44:47], v[228:231]
    v_mfma_f32_16x16x32_bf16 v[136:139], a[20:23], a[32:35], v[136:139]
    v_mfma_f32_16x16x32_bf16 v[168:171], a[20:23], a[36:39], v[168:171]
    buffer_load_dwordx4 v38, s[16:19], s36 offen offset:2048 lds
    v_mfma_f32_16x16x32_bf16 v[200:203], a[20:23], a[40:43], v[200:203]
    v_mfma_f32_16x16x32_bf16 v[232:235], a[20:23], a[44:47], v[232:235]
    buffer_load_dwordx4 v39, s[16:19], s36 offen offset:3072 lds
    v_mfma_f32_16x16x32_bf16 v[140:143], a[24:27], a[32:35], v[140:143]
    s_add_u32 m0, s38, 20480
    v_mfma_f32_16x16x32_bf16 v[172:175], a[24:27], a[36:39], v[172:175]
    buffer_load_dwordx4 v40, s[16:19], s36 offen offset:0 lds
    v_mfma_f32_16x16x32_bf16 v[204:207], a[24:27], a[40:43], v[204:207]
    v_mfma_f32_16x16x32_bf16 v[236:239], a[24:27], a[44:47], v[236:239]
    buffer_load_dwordx4 v41, s[16:19], s36 offen offset:1024 lds
    v_mfma_f32_16x16x32_bf16 v[144:147], a[28:31], a[32:35], v[144:147]
    v_mfma_f32_16x16x32_bf16 v[176:179], a[28:31], a[36:39], v[176:179]
    buffer_load_dwordx4 v42, s[16:19], s36 offen offset:2048 lds
    v_mfma_f32_16x16x32_bf16 v[208:211], a[28:31], a[40:43], v[208:211]
    v_mfma_f32_16x16x32_bf16 v[240:243], a[28:31], a[44:47], v[240:243]
    buffer_load_dwordx4 v43, s[16:19], s36 offen offset:3072 lds
    s_waitcnt vmcnt(12) lgkmcnt(0)
    s_barrier
    v_mfma_f32_16x16x32_bf16 v[100:103], a[48:51], v[32:35], v[100:103]
    ds_read_b64_tr_b16 a[0:1], v50 offset:16384
    v_mfma_f32_16x16x32_bf16 v[104:107], a[52:55], v[32:35], v[104:107]
    ds_read_b64_tr_b16 a[2:3], v50 offset:17408
    v_mfma_f32_16x16x32_bf16 v[116:119], a[48:51], a[80:83], v[116:119]
    ds_read_b128 a[32:35], v48 offset:8192
    v_mfma_f32_16x16x32_bf16 v[148:151], a[48:51], a[84:87], v[148:151]
    ds_read_b128 a[36:39], v48 offset:10240
    v_mfma_f32_16x16x32_bf16 v[180:183], a[48:51], a[88:91], v[180:183]
    ds_read_b128 a[40:43], v48 offset:12288
    v_mfma_f32_16x16x32_bf16 v[212:215], a[48:51], a[92:95], v[212:215]
    ds_read_b128 a[44:47], v48 offset:14336
    v_mfma_f32_16x16x32_bf16 v[120:123], a[52:55], a[80:83], v[120:123]
    ds_read_b64_tr_b16 a[4:5], v51 offset:16384
    v_mfma_f32_16x16x32_bf16 v[152:155], a[52:55], a[84:87], v[152:155]
    ds_read_b64_tr_b16 a[6:7], v51 offset:17408
    v_mfma_f32_16x16x32_bf16 v[184:187], a[52:55], a[88:91], v[184:187]
    ds_read_b64_tr_b16 a[8:9], v52 offset:16384
    v_mfma_f32_16x16x32_bf16 v[216:219], a[52:55], a[92:95], v[216:219]
    ds_read_b64_tr_b16 a[10:11], v52 offset:17408
    v_mfma_f32_16x16x32_bf16 v[124:127], a[56:59], a[80:83], v[124:127]
    ds_read_b64_tr_b16 a[12:13], v53 offset:16384
    v_mfma_f32_16x16x32_bf16 v[156:159], a[56:59], a[84:87], v[156:159]
    ds_read_b64_tr_b16 a[14:15], v53 offset:17408
    v_mfma_f32_16x16x32_bf16 v[188:191], a[56:59], a[88:91], v[188:191]
    ds_read_b64_tr_b16 a[16:17], v54 offset:16384
    v_mfma_f32_16x16x32_bf16 v[220:223], a[56:59], a[92:95], v[220:223]
    ds_read_b64_tr_b16 a[18:19], v54 offset:17408
    v_mfma_f32_16x16x32_bf16 v[128:131], a[60:63], a[80:83], v[128:131]
    ds_read_b64_tr_b16 a[20:21], v55 offset:16384
    v_mfma_f32_16x16x32_bf16 v[160:163], a[60:63], a[84:87], v[160:163]
    ds_read_b64_tr_b16 a[22:23], v55 offset:17408
    v_mfma_f32_16x16x32_bf16 v[192:195], a[60:63], a[88:91], v[192:195]
    ds_read_b64_tr_b16 a[24:25], v56 offset:16384
    v_mfma_f32_16x16x32_bf16 v[224:227], a[60:63], a[92:95], v[224:227]
    ds_read_b64_tr_b16 a[26:27], v56 offset:17408
    v_mfma_f32_16x16x32_bf16 v[132:135], a[64:67], a[80:83], v[132:135]
    ds_read_b64_tr_b16 a[28:29], v57 offset:16384
    v_mfma_f32_16x16x32_bf16 v[164:167], a[64:67], a[84:87], v[164:167]
    ds_read_b64_tr_b16 a[30:31], v57 offset:17408
    v_mfma_f32_16x16x32_bf16 v[196:199], a[64:67], a[88:91], v[196:199]
    v_mfma_f32_16x16x32_bf16 v[228:231], a[64:67], a[92:95], v[228:231]
    v_mfma_f32_16x16x32_bf16 v[136:139], a[68:71], a[80:83], v[136:139]
    s_add_u32 m0, s39, 0
    s_mov_b32 s37, 4718592
    v_mfma_f32_16x16x32_bf16 v[168:171], a[68:71], a[84:87], v[168:171]
    buffer_load_dwordx4 v44, s[20:23], s37 offen offset:0 lds
    v_mfma_f32_16x16x32_bf16 v[200:203], a[68:71], a[88:91], v[200:203]
    v_mfma_f32_16x16x32_bf16 v[232:235], a[68:71], a[92:95], v[232:235]
    buffer_load_dwordx4 v45, s[20:23], s37 offen offset:1024 lds
    v_mfma_f32_16x16x32_bf16 v[140:143], a[72:75], a[80:83], v[140:143]
    v_mfma_f32_16x16x32_bf16 v[172:175], a[72:75], a[84:87], v[172:175]
    buffer_load_dwordx4 v46, s[20:23], s37 offen offset:2048 lds
    v_mfma_f32_16x16x32_bf16 v[204:207], a[72:75], a[88:91], v[204:207]
    v_mfma_f32_16x16x32_bf16 v[236:239], a[72:75], a[92:95], v[236:239]
    buffer_load_dwordx4 v47, s[20:23], s37 offen offset:3072 lds
    v_mfma_f32_16x16x32_bf16 v[144:147], a[76:79], a[80:83], v[144:147]
    s_add_u32 m0, s38, 0
    s_mov_b32 s36, 1152
    v_mfma_f32_16x16x32_bf16 v[176:179], a[76:79], a[84:87], v[176:179]
    buffer_load_dwordx4 v36, s[16:19], s36 offen offset:0 lds
    v_mfma_f32_16x16x32_bf16 v[208:211], a[76:79], a[88:91], v[208:211]
    v_mfma_f32_16x16x32_bf16 v[240:243], a[76:79], a[92:95], v[240:243]
    buffer_load_dwordx4 v37, s[16:19], s36 offen offset:1024 lds
    s_waitcnt lgkmcnt(0)
    v_mfma_f32_16x16x32_bf16 v[100:103], a[0:3], v[32:35], v[100:103]
    ds_read_b64_tr_b16 a[48:49], v50 offset:24576
    v_mfma_f32_16x16x32_bf16 v[104:107], a[4:7], v[32:35], v[104:107]
    ds_read_b64_tr_b16 a[50:51], v50 offset:25600
    v_mfma_f32_16x16x32_bf16 v[116:119], a[0:3], a[32:35], v[116:119]
    ds_read_b128 a[80:83], v49 offset:8192
    v_mfma_f32_16x16x32_bf16 v[148:151], a[0:3], a[36:39], v[148:151]
    ds_read_b128 a[84:87], v49 offset:10240
    v_mfma_f32_16x16x32_bf16 v[180:183], a[0:3], a[40:43], v[180:183]
    ds_read_b128 a[88:91], v49 offset:12288
    v_mfma_f32_16x16x32_bf16 v[212:215], a[0:3], a[44:47], v[212:215]
    ds_read_b128 a[92:95], v49 offset:14336
    v_mfma_f32_16x16x32_bf16 v[120:123], a[4:7], a[32:35], v[120:123]
    ds_read_b64_tr_b16 a[52:53], v51 offset:24576
    v_mfma_f32_16x16x32_bf16 v[152:155], a[4:7], a[36:39], v[152:155]
    ds_read_b64_tr_b16 a[54:55], v51 offset:25600
    v_mfma_f32_16x16x32_bf16 v[184:187], a[4:7], a[40:43], v[184:187]
    ds_read_b64_tr_b16 a[56:57], v52 offset:24576
    v_mfma_f32_16x16x32_bf16 v[216:219], a[4:7], a[44:47], v[216:219]
    ds_read_b64_tr_b16 a[58:59], v52 offset:25600
    v_mfma_f32_16x16x32_bf16 v[124:127], a[8:11], a[32:35], v[124:127]
    ds_read_b64_tr_b16 a[60:61], v53 offset:24576
    v_mfma_f32_16x16x32_bf16 v[156:159], a[8:11], a[36:39], v[156:159]
    ds_read_b64_tr_b16 a[62:63], v53 offset:25600
    v_mfma_f32_16x16x32_bf16 v[188:191], a[8:11], a[40:43], v[188:191]
    ds_read_b64_tr_b16 a[64:65], v54 offset:24576
    v_mfma_f32_16x16x32_bf16 v[220:223], a[8:11], a[44:47], v[220:223]
    ds_read_b64_tr_b16 a[66:67], v54 offset:25600
    v_mfma_f32_16x16x32_bf16 v[128:131], a[12:15], a[32:35], v[128:131]
    ds_read_b64_tr_b16 a[68:69], v55 offset:24576
    v_mfma_f32_16x16x32_bf16 v[160:163], a[12:15], a[36:39], v[160:163]
    ds_read_b64_tr_b16 a[70:71], v55 offset:25600
    v_mfma_f32_16x16x32_bf16 v[192:195], a[12:15], a[40:43], v[192:195]
    ds_read_b64_tr_b16 a[72:73], v56 offset:24576
    v_mfma_f32_16x16x32_bf16 v[224:227], a[12:15], a[44:47], v[224:227]
    ds_read_b64_tr_b16 a[74:75], v56 offset:25600
    v_mfma_f32_16x16x32_bf16 v[132:135], a[16:19], a[32:35], v[132:135]
    ds_read_b64_tr_b16 a[76:77], v57 offset:24576
    v_mfma_f32_16x16x32_bf16 v[164:167], a[16:19], a[36:39], v[164:167]
    ds_read_b64_tr_b16 a[78:79], v57 offset:25600
    v_mfma_f32_16x16x32_bf16 v[196:199], a[16:19], a[40:43], v[196:199]
    v_mfma_f32_16x16x32_bf16 v[228:231], a[16:19], a[44:47], v[228:231]
    v_mfma_f32_16x16x32_bf16 v[136:139], a[20:23], a[32:35], v[136:139]
    buffer_load_dword v252, off, s[92:95], s74 sc1
    v_mfma_f32_16x16x32_bf16 v[168:171], a[20:23], a[36:39], v[168:171]
    buffer_load_dwordx4 v38, s[16:19], s36 offen offset:2048 lds
    v_mfma_f32_16x16x32_bf16 v[200:203], a[20:23], a[40:43], v[200:203]
    v_mfma_f32_16x16x32_bf16 v[232:235], a[20:23], a[44:47], v[232:235]
    buffer_load_dwordx4 v39, s[16:19], s36 offen offset:3072 lds
    v_mfma_f32_16x16x32_bf16 v[140:143], a[24:27], a[32:35], v[140:143]
    s_add_u32 m0, s38, 4096
    v_mfma_f32_16x16x32_bf16 v[172:175], a[24:27], a[36:39], v[172:175]
    buffer_load_dwordx4 v40, s[16:19], s36 offen offset:0 lds
    v_mfma_f32_16x16x32_bf16 v[204:207], a[24:27], a[40:43], v[204:207]
    v_mfma_f32_16x16x32_bf16 v[236:239], a[24:27], a[44:47], v[236:239]
    buffer_load_dwordx4 v41, s[16:19], s36 offen offset:1024 lds
    v_mfma_f32_16x16x32_bf16 v[144:147], a[28:31], a[32:35], v[144:147]
    v_mfma_f32_16x16x32_bf16 v[176:179], a[28:31], a[36:39], v[176:179]
    buffer_load_dwordx4 v42, s[16:19], s36 offen offset:2048 lds
    v_mfma_f32_16x16x32_bf16 v[208:211], a[28:31], a[40:43], v[208:211]
    v_mfma_f32_16x16x32_bf16 v[240:243], a[28:31], a[44:47], v[240:243]
    buffer_load_dwordx4 v43, s[16:19], s36 offen offset:3072 lds
    s_waitcnt vmcnt(13) lgkmcnt(0)
    s_barrier
    v_mfma_f32_16x16x32_bf16 v[100:103], a[48:51], v[32:35], v[100:103]
    ds_read_b64_tr_b16 a[0:1], v50 offset:32768
    v_mfma_f32_16x16x32_bf16 v[104:107], a[52:55], v[32:35], v[104:107]
    ds_read_b64_tr_b16 a[2:3], v50 offset:33792
    v_mfma_f32_16x16x32_bf16 v[116:119], a[48:51], a[80:83], v[116:119]
    ds_read_b128 a[32:35], v48 offset:16384
    v_mfma_f32_16x16x32_bf16 v[148:151], a[48:51], a[84:87], v[148:151]
    ds_read_b128 a[36:39], v48 offset:18432
    v_mfma_f32_16x16x32_bf16 v[180:183], a[48:51], a[88:91], v[180:183]
    ds_read_b128 a[40:43], v48 offset:20480
    v_mfma_f32_16x16x32_bf16 v[212:215], a[48:51], a[92:95], v[212:215]
    ds_read_b128 a[44:47], v48 offset:22528
    v_mfma_f32_16x16x32_bf16 v[120:123], a[52:55], a[80:83], v[120:123]
    ds_read_b64_tr_b16 a[4:5], v51 offset:32768
    v_mfma_f32_16x16x32_bf16 v[152:155], a[52:55], a[84:87], v[152:155]
    ds_read_b64_tr_b16 a[6:7], v51 offset:33792
    v_mfma_f32_16x16x32_bf16 v[184:187], a[52:55], a[88:91], v[184:187]
    ds_read_b64_tr_b16 a[8:9], v52 offset:32768
    v_mfma_f32_16x16x32_bf16 v[216:219], a[52:55], a[92:95], v[216:219]
    ds_read_b64_tr_b16 a[10:11], v52 offset:33792
    v_mfma_f32_16x16x32_bf16 v[124:127], a[56:59], a[80:83], v[124:127]
    ds_read_b64_tr_b16 a[12:13], v53 offset:32768
    v_mfma_f32_16x16x32_bf16 v[156:159], a[56:59], a[84:87], v[156:159]
    ds_read_b64_tr_b16 a[14:15], v53 offset:33792
    v_mfma_f32_16x16x32_bf16 v[188:191], a[56:59], a[88:91], v[188:191]
    ds_read_b64_tr_b16 a[16:17], v54 offset:32768
    v_mfma_f32_16x16x32_bf16 v[220:223], a[56:59], a[92:95], v[220:223]
    ds_read_b64_tr_b16 a[18:19], v54 offset:33792
    v_mfma_f32_16x16x32_bf16 v[128:131], a[60:63], a[80:83], v[128:131]
    ds_read_b64_tr_b16 a[20:21], v55 offset:32768
    v_mfma_f32_16x16x32_bf16 v[160:163], a[60:63], a[84:87], v[160:163]
    ds_read_b64_tr_b16 a[22:23], v55 offset:33792
    v_mfma_f32_16x16x32_bf16 v[192:195], a[60:63], a[88:91], v[192:195]
    ds_read_b64_tr_b16 a[24:25], v56 offset:32768
    v_mfma_f32_16x16x32_bf16 v[224:227], a[60:63], a[92:95], v[224:227]
    ds_read_b64_tr_b16 a[26:27], v56 offset:33792
    v_mfma_f32_16x16x32_bf16 v[132:135], a[64:67], a[80:83], v[132:135]
    ds_read_b64_tr_b16 a[28:29], v57 offset:32768
    v_mfma_f32_16x16x32_bf16 v[164:167], a[64:67], a[84:87], v[164:167]
    ds_read_b64_tr_b16 a[30:31], v57 offset:33792
    v_mfma_f32_16x16x32_bf16 v[196:199], a[64:67], a[88:91], v[196:199]
    v_mfma_f32_16x16x32_bf16 v[228:231], a[64:67], a[92:95], v[228:231]
    v_mfma_f32_16x16x32_bf16 v[136:139], a[68:71], a[80:83], v[136:139]
    s_add_u32 m0, s34, 16384
    v_mfma_f32_16x16x32_bf16 v[168:171], a[68:71], a[84:87], v[168:171]
    buffer_load_dwordx4 v13, s[8:11], s28 offen offset:0 lds
    v_mfma_f32_16x16x32_bf16 v[200:203], a[68:71], a[88:91], v[200:203]
    v_mfma_f32_16x16x32_bf16 v[232:235], a[68:71], a[92:95], v[232:235]
    buffer_load_dwordx4 v14, s[8:11], s28 offen offset:1024 lds
    v_mfma_f32_16x16x32_bf16 v[140:143], a[72:75], a[80:83], v[140:143]
    v_mfma_f32_16x16x32_bf16 v[172:175], a[72:75], a[84:87], v[172:175]
    buffer_load_dwordx4 v15, s[8:11], s28 offen offset:2048 lds
    v_mfma_f32_16x16x32_bf16 v[204:207], a[72:75], a[88:91], v[204:207]
    v_mfma_f32_16x16x32_bf16 v[236:239], a[72:75], a[92:95], v[236:239]
    buffer_load_dwordx4 v16, s[8:11], s28 offen offset:3072 lds
    v_mfma_f32_16x16x32_bf16 v[144:147], a[76:79], a[80:83], v[144:147]
    s_add_u32 s28, s28, 16384
    v_mfma_f32_16x16x32_bf16 v[176:179], a[76:79], a[84:87], v[176:179]
    v_mfma_f32_16x16x32_bf16 v[208:211], a[76:79], a[88:91], v[208:211]
    v_mfma_f32_16x16x32_bf16 v[240:243], a[76:79], a[92:95], v[240:243]
    s_waitcnt lgkmcnt(0)
    v_mfma_f32_16x16x32_bf16 v[100:103], a[0:3], v[32:35], v[100:103]
    ds_read_b64_tr_b16 a[48:49], v50 offset:40960
    v_mfma_f32_16x16x32_bf16 v[104:107], a[4:7], v[32:35], v[104:107]
    ds_read_b64_tr_b16 a[50:51], v50 offset:41984
    v_mfma_f32_16x16x32_bf16 v[116:119], a[0:3], a[32:35], v[116:119]
    ds_read_b128 a[80:83], v49 offset:16384
    v_mfma_f32_16x16x32_bf16 v[148:151], a[0:3], a[36:39], v[148:151]
    ds_read_b128 a[84:87], v49 offset:18432
    v_mfma_f32_16x16x32_bf16 v[180:183], a[0:3], a[40:43], v[180:183]
    ds_read_b128 a[88:91], v49 offset:20480
    v_mfma_f32_16x16x32_bf16 v[212:215], a[0:3], a[44:47], v[212:215]
    ds_read_b128 a[92:95], v49 offset:22528
    v_mfma_f32_16x16x32_bf16 v[120:123], a[4:7], a[32:35], v[120:123]
    ds_read_b64_tr_b16 a[52:53], v51 offset:40960
    v_mfma_f32_16x16x32_bf16 v[152:155], a[4:7], a[36:39], v[152:155]
    ds_read_b64_tr_b16 a[54:55], v51 offset:41984
    v_mfma_f32_16x16x32_bf16 v[184:187], a[4:7], a[40:43], v[184:187]
    ds_read_b64_tr_b16 a[56:57], v52 offset:40960
    v_mfma_f32_16x16x32_bf16 v[216:219], a[4:7], a[44:47], v[216:219]
    ds_read_b64_tr_b16 a[58:59], v52 offset:41984
    v_mfma_f32_16x16x32_bf16 v[124:127], a[8:11], a[32:35], v[124:127]
    ds_read_b64_tr_b16 a[60:61], v53 offset:40960
    v_mfma_f32_16x16x32_bf16 v[156:159], a[8:11], a[36:39], v[156:159]
    ds_read_b64_tr_b16 a[62:63], v53 offset:41984
    v_mfma_f32_16x16x32_bf16 v[188:191], a[8:11], a[40:43], v[188:191]
    ds_read_b64_tr_b16 a[64:65], v54 offset:40960
    v_mfma_f32_16x16x32_bf16 v[220:223], a[8:11], a[44:47], v[220:223]
    ds_read_b64_tr_b16 a[66:67], v54 offset:41984
    v_mfma_f32_16x16x32_bf16 v[128:131], a[12:15], a[32:35], v[128:131]
    ds_read_b64_tr_b16 a[68:69], v55 offset:40960
    v_mfma_f32_16x16x32_bf16 v[160:163], a[12:15], a[36:39], v[160:163]
    ds_read_b64_tr_b16 a[70:71], v55 offset:41984
    v_mfma_f32_16x16x32_bf16 v[192:195], a[12:15], a[40:43], v[192:195]
    ds_read_b64_tr_b16 a[72:73], v56 offset:40960
    v_mfma_f32_16x16x32_bf16 v[224:227], a[12:15], a[44:47], v[224:227]
    ds_read_b64_tr_b16 a[74:75], v56 offset:41984
    v_mfma_f32_16x16x32_bf16 v[132:135], a[16:19], a[32:35], v[132:135]
    ds_read_b64_tr_b16 a[76:77], v57 offset:40960
    v_mfma_f32_16x16x32_bf16 v[164:167], a[16:19], a[36:39], v[164:167]
    ds_read_b64_tr_b16 a[78:79], v57 offset:41984
    v_mfma_f32_16x16x32_bf16 v[196:199], a[16:19], a[40:43], v[196:199]
    v_mfma_f32_16x16x32_bf16 v[228:231], a[16:19], a[44:47], v[228:231]
    s_waitcnt vmcnt(10)
    v_cmp_ne_u32 vcc, 32, v252
    s_and_b64 vcc, vcc, exec
    s_cbranch_scc1 L_spin_rows
L_back_rows:
    buffer_load_dwordx2 v[108:109], v59, s[76:79], s46 offen offset:0 sc1
    buffer_load_dwordx2 v[110:111], v59, s[76:79], s46 offen offset:128 sc1
    buffer_load_dwordx2 v[112:113], v59, s[76:79], s46 offen offset:256 sc1
    buffer_load_dwordx2 v[114:115], v59, s[76:79], s46 offen offset:384 sc1
    v_mfma_f32_16x16x32_bf16 v[136:139], a[20:23], a[32:35], v[136:139]
    v_mfma_f32_16x16x32_bf16 v[168:171], a[20:23], a[36:39], v[168:171]
    v_mfma_f32_16x16x32_bf16 v[200:203], a[20:23], a[40:43], v[200:203]
    v_mfma_f32_16x16x32_bf16 v[232:235], a[20:23], a[44:47], v[232:235]
    v_mfma_f32_16x16x32_bf16 v[140:143], a[24:27], a[32:35], v[140:143]
    v_mfma_f32_16x16x32_bf16 v[172:175], a[24:27], a[36:39], v[172:175]
    v_mfma_f32_16x16x32_bf16 v[204:207], a[24:27], a[40:43], v[204:207]
    v_mfma_f32_16x16x32_bf16 v[236:239], a[24:27], a[44:47], v[236:239]
    v_mfma_f32_16x16x32_bf16 v[144:147], a[28:31], a[32:35], v[144:147]
    v_mfma_f32_16x16x32_bf16 v[176:179], a[28:31], a[36:39], v[176:179]
    v_mfma_f32_16x16x32_bf16 v[208:211], a[28:31], a[40:43], v[208:211]
    v_mfma_f32_16x16x32_bf16 v[240:243], a[28:31], a[44:47], v[240:243]
    s_waitcnt vmcnt(8) lgkmcnt(0)
    s_barrier
    v_mfma_f32_16x16x32_bf16 v[100:103], a[48:51], v[32:35], v[100:103]
    ds_read_b64_tr_b16 a[0:1], v50 offset:0
    v_mfma_f32_16x16x32_bf16 v[104:107], a[52:55], v[32:35], v[104:107]
    ds_read_b64_tr_b16 a[2:3], v50 offset:1024
    v_mfma_f32_16x16x32_bf16 v[116:119], a[48:51], a[80:83], v[116:119]
    ds_read_b128 a[32:35], v48 offset:0
    v_mfma_f32_16x16x32_bf16 v[148:151], a[48:51], a[84:87], v[148:151]
    ds_read_b128 a[36:39], v48 offset:2048
    v_mfma_f32_16x16x32_bf16 v[180:183], a[48:51], a[88:91], v[180:183]
    ds_read_b128 a[40:43], v48 offset:4096
    v_mfma_f32_16x16x32_bf16 v[212:215], a[48:51], a[92:95], v[212:215]
    ds_read_b128 a[44:47], v48 offset:6144
    v_mfma_f32_16x16x32_bf16 v[120:123], a[52:55], a[80:83], v[120:123]
    ds_read_b64_tr_b16 a[4:5], v51 offset:0
    v_mfma_f32_16x16x32_bf16 v[152:155], a[52:55], a[84:87], v[152:155]
    ds_read_b64_tr_b16 a[6:7], v51 offset:1024
    v_mfma_f32_16x16x32_bf16 v[184:187], a[52:55], a[88:91], v[184:187]
    ds_read_b64_tr_b16 a[8:9], v52 offset:0
    v_mfma_f32_16x16x32_bf16 v[216:219], a[52:55], a[92:95], v[216:219]
    ds_read_b64_tr_b16 a[10:11], v52 offset:1024
    v_mfma_f32_16x16x32_bf16 v[124:127], a[56:59], a[80:83], v[124:127]
    ds_read_b64_tr_b16 a[12:13], v53 offset:0
    v_mfma_f32_16x16x32_bf16 v[156:159], a[56:59], a[84:87], v[156:159]
    ds_read_b64_tr_b16 a[14:15], v53 offset:1024
    v_mfma_f32_16x16x32_bf16 v[188:191], a[56:59], a[88:91], v[188:191]
    ds_read_b64_tr_b16 a[16:17], v54 offset:0
    v_mfma_f32_16x16x32_bf16 v[220:223], a[56:59], a[92:95], v[220:223]
    ds_read_b64_tr_b16 a[18:19], v54 offset:1024
    v_mfma_f32_16x16x32_bf16 v[128:131], a[60:63], a[80:83], v[128:131]
    ds_read_b64_tr_b16 a[20:21], v55 offset:0
    v_mfma_f32_16x16x32_bf16 v[160:163], a[60:63], a[84:87], v[160:163]
    ds_read_b64_tr_b16 a[22:23], v55 offset:1024
    v_mfma_f32_16x16x32_bf16 v[192:195], a[60:63], a[88:91], v[192:195]
    ds_read_b64_tr_b16 a[24:25], v56 offset:0
    v_mfma_f32_16x16x32_bf16 v[224:227], a[60:63], a[92:95], v[224:227]
    ds_read_b64_tr_b16 a[26:27], v56 offset:1024
    v_mfma_f32_16x16x32_bf16 v[132:135], a[64:67], a[80:83], v[132:135]
    ds_read_b64_tr_b16 a[28:29], v57 offset:0
    v_mfma_f32_16x16x32_bf16 v[164:167], a[64:67], a[84:87], v[164:167]
    ds_read_b64_tr_b16 a[30:31], v57 offset:1024
    v_mfma_f32_16x16x32_bf16 v[196:199], a[64:67], a[88:91], v[196:199]
    v_mfma_f32_16x16x32_bf16 v[228:231], a[64:67], a[92:95], v[228:231]
    v_mfma_f32_16x16x32_bf16 v[136:139], a[68:71], a[80:83], v[136:139]
    s_add_u32 m0, s34, 32768
    v_mfma_f32_16x16x32_bf16 v[168:171], a[68:71], a[84:87], v[168:171]
    buffer_load_dwordx4 v13, s[8:11], s28 offen offset:0 lds
    v_mfma_f32_16x16x32_bf16 v[200:203], a[68:71], a[88:91], v[200:203]
    v_mfma_f32_16x16x32_bf16 v[232:235], a[68:71], a[92:95], v[232:235]
    buffer_load_dwordx4 v14, s[8:11], s28 offen offset:1024 lds
    v_mfma_f32_16x16x32_bf16 v[140:143], a[72:75], a[80:83], v[140:143]
    v_mfma_f32_16x16x32_bf16 v[172:175], a[72:75], a[84:87], v[172:175]
    buffer_load_dwordx4 v15, s[8:11], s28 offen offset:2048 lds
    v_mfma_f32_16x16x32_bf16 v[204:207], a[72:75], a[88:91], v[204:207]
    v_mfma_f32_16x16x32_bf16 v[236:239], a[72:75], a[92:95], v[236:239]
    buffer_load_dwordx4 v16, s[8:11], s28 offen offset:3072 lds
    v_mfma_f32_16x16x32_bf16 v[144:147], a[76:79], a[80:83], v[144:147]
    s_add_u32 s28, s28, 16384
    s_mov_b32 m0, s30
    v_mfma_f32_16x16x32_bf16 v[176:179], a[76:79], a[84:87], v[176:179]
    buffer_load_dwordx4 v17, s[12:15], s29 offen offset:0 lds
    v_mfma_f32_16x16x32_bf16 v[208:211], a[76:79], a[88:91], v[208:211]
    v_mfma_f32_16x16x32_bf16 v[240:243], a[76:79], a[92:95], v[240:243]
    buffer_load_dwordx4 v18, s[12:15], s29 offen offset:1024 lds
    s_waitcnt lgkmcnt(0)
    v_mfma_f32_16x16x32_bf16 v[100:103], a[0:3], v[32:35], v[100:103]
    ds_read_b64_tr_b16 a[48:49], v50 offset:8192
    v_mfma_f32_16x16x32_bf16 v[104:107], a[4:7], v[32:35], v[104:107]
    ds_read_b64_tr_b16 a[50:51], v50 offset:9216
    v_mfma_f32_16x16x32_bf16 v[116:119], a[0:3], a[32:35], v[116:119]
    ds_read_b128 a[80:83], v49 offset:0
    v_mfma_f32_16x16x32_bf16 v[148:151], a[0:3], a[36:39], v[148:151]
    ds_read_b128 a[84:87], v49 offset:2048
    v_mfma_f32_16x16x32_bf16 v[180:183], a[0:3], a[40:43], v[180:183]
    ds_read_b128 a[88:91], v49 offset:4096
    v_mfma_f32_16x16x32_bf16 v[212:215], a[0:3], a[44:47], v[212:215]
    ds_read_b128 a[92:95], v49 offset:6144
    v_mfma_f32_16x16x32_bf16 v[120:123], a[4:7], a[32:35], v[120:123]
    ds_read_b64_tr_b16 a[52:53], v51 offset:8192
    v_mfma_f32_16x16x32_bf16 v[152:155], a[4:7], a[36:39], v[152:155]
    ds_read_b64_tr_b16 a[54:55], v51 offset:9216
    v_mfma_f32_16x16x32_bf16 v[184:187], a[4:7], a[40:43], v[184:187]
    ds_read_b64_tr_b16 a[56:57], v52 offset:8192
    v_mfma_f32_16x16x32_bf16 v[216:219], a[4:7], a[44:47], v[216:219]
    ds_read_b64_tr_b16 a[58:59], v52 offset:9216
    v_mfma_f32_16x16x32_bf16 v[124:127], a[8:11], a[32:35], v[124:127]
    ds_read_b64_tr_b16 a[60:61], v53 offset:8192
    v_mfma_f32_16x16x32_bf16 v[156:159], a[8:11], a[36:39], v[156:159]
    ds_read_b64_tr_b16 a[62:63], v53 offset:9216
    v_mfma_f32_16x16x32_bf16 v[188:191], a[8:11], a[40:43], v[188:191]
    ds_read_b64_tr_b16 a[64:65], v54 offset:8192
    v_mfma_f32_16x16x32_bf16 v[220:223], a[8:11], a[44:47], v[220:223]
    ds_read_b64_tr_b16 a[66:67], v54 offset:9216
    v_mfma_f32_16x16x32_bf16 v[128:131], a[12:15], a[32:35], v[128:131]
    ds_read_b64_tr_b16 a[68:69], v55 offset:8192
    v_mfma_f32_16x16x32_bf16 v[160:163], a[12:15], a[36:39], v[160:163]
    ds_read_b64_tr_b16 a[70:71], v55 offset:9216
    v_mfma_f32_16x16x32_bf16 v[192:195], a[12:15], a[40:43], v[192:195]
    ds_read_b64_tr_b16 a[72:73], v56 offset:8192
    v_mfma_f32_16x16x32_bf16 v[224:227], a[12:15], a[44:47], v[224:227]
    ds_read_b64_tr_b16 a[74:75], v56 offset:9216
    v_mfma_f32_16x16x32_bf16 v[132:135], a[16:19], a[32:35], v[132:135]
    ds_read_b64_tr_b16 a[76:77], v57 offset:8192
    v_mfma_f32_16x16x32_bf16 v[164:167], a[16:19], a[36:39], v[164:167]
    ds_read_b64_tr_b16 a[78:79], v57 offset:9216
    v_mfma_f32_16x16x32_bf16 v[196:199], a[16:19], a[40:43], v[196:199]
    v_mfma_f32_16x16x32_bf16 v[228:231], a[16:19], a[44:47], v[228:231]
    v_mfma_f32_16x16x32_bf16 v[136:139], a[20:23], a[32:35], v[136:139]
    v_mfma_f32_16x16x32_bf16 v[168:171], a[20:23], a[36:39], v[168:171]
    buffer_load_dwordx4 v17, s[12:15], s29 offen offset:2048 lds
    v_mfma_f32_16x16x32_bf16 v[200:203], a[20:23], a[40:43], v[200:203]
    v_mfma_f32_16x16x32_bf16 v[232:235], a[20:23], a[44:47], v[232:235]
    buffer_load_dwordx4 v18, s[12:15], s29 offen offset:3072 lds
    v_mfma_f32_16x16x32_bf16 v[140:143], a[24:27], a[32:35], v[140:143]
    s_add_u32 s29, s29, 16384
    v_mfma_f32_16x16x32_bf16 v[172:175], a[24:27], a[36:39], v[172:175]
    v_mfma_f32_16x16x32_bf16 v[204:207], a[24:27], a[40:43], v[204:207]
    v_mfma_f32_16x16x32_bf16 v[236:239], a[24:27], a[44:47], v[236:239]
    v_mfma_f32_16x16x32_bf16 v[144:147], a[28:31], a[32:35], v[144:147]
    v_mfma_f32_16x16x32_bf16 v[176:179], a[28:31], a[36:39], v[176:179]
    v_mfma_f32_16x16x32_bf16 v[208:211], a[28:31], a[40:43], v[208:211]
    v_mfma_f32_16x16x32_bf16 v[240:243], a[28:31], a[44:47], v[240:243]
    s_waitcnt lgkmcnt(0)
    v_mfma_f32_16x16x32_bf16 v[100:103], a[48:51], v[32:35], v[100:103]
    ds_read_b128 a[128:131], v1 offset:49152
    v_mfma_f32_16x16x32_bf16 v[104:107], a[52:55], v[32:35], v[104:107]
    ds_read_b128 a[132:135], v2 offset:49152
    v_mfma_f32_16x16x32_bf16 v[116:119], a[48:51], a[80:83], v[116:119]
    ds_read_b128 a[136:139], v3 offset:49152
    v_mfma_f32_16x16x32_bf16 v[120:123], a[52:55], a[80:83], v[120:123]
    ds_read_b128 a[140:143], v4 offset:49152
    v_mfma_f32_16x16x32_bf16 v[124:127], a[56:59], a[80:83], v[124:127]
    ds_read_b128 a[144:147], v1 offset:53248
    v_mfma_f32_16x16x32_bf16 v[128:131], a[60:63], a[80:83], v[128:131]
    ds_read_b128 a[148:151], v2 offset:53248
    v_mfma_f32_16x16x32_bf16 v[132:135], a[64:67], a[80:83], v[132:135]
    ds_read_b128 a[152:155], v3 offset:53248
    v_mfma_f32_16x16x32_bf16 v[136:139], a[68:71], a[80:83], v[136:139]
    ds_read_b128 a[156:159], v4 offset:53248
    v_mfma_f32_16x16x32_bf16 v[140:143], a[72:75], a[80:83], v[140:143]
    v_mfma_f32_16x16x32_bf16 v[144:147], a[76:79], a[80:83], v[144:147]
    v_mfma_f32_16x16x32_bf16 v[148:151], a[48:51], a[84:87], v[148:151]
    ds_write_b128 v58, v[100:103] offset:0
    v_mfma_f32_16x16x32_bf16 v[152:155], a[52:55], a[84:87], v[152:155]
    ds_write_b128 v58, v[104:107] offset:64
    v_mfma_f32_16x16x32_bf16 v[156:159], a[56:59], a[84:87], v[156:159]
    ds_write_b128 v58, v[100:103] offset:512
    v_mfma_f32_16x16x32_bf16 v[160:163], a[60:63], a[84:87], v[160:163]
    ds_write_b128 v58, v[104:107] offset:576
    v_mfma_f32_16x16x32_bf16 v[164:167], a[64:67], a[84:87], v[164:167]
    v_mfma_f32_16x16x32_bf16 v[168:171], a[68:71], a[84:87], v[168:171]
    v_mfma_f32_16x16x32_bf16 v[172:175], a[72:75], a[84:87], v[172:175]
    v_mfma_f32_16x16x32_bf16 v[176:179], a[76:79], a[84:87], v[176:179]
    s_waitcnt lgkmcnt(0)
    s_barrier
    v_mfma_f32_16x16x32_bf16 v[180:183], a[48:51], a[88:91], v[180:183]
    ds_read_b128 v[68:71], v58 offset:0
    v_mfma_f32_16x16x32_bf16 v[184:187], a[52:55], a[88:91], v[184:187]
    ds_read_b128 v[72:75], v58 offset:64
    v_mfma_f32_16x16x32_bf16 v[188:191], a[56:59], a[88:91], v[188:191]
    ds_read_b128 v[76:79], v58 offset:128
    v_mfma_f32_16x16x32_bf16 v[192:195], a[60:63], a[88:91], v[192:195]
    ds_read_b128 v[80:83], v58 offset:192
    v_mfma_f32_16x16x32_bf16 v[196:199], a[64:67], a[88:91], v[196:199]
    ds_read_b128 v[84:87], v58 offset:256
    v_mfma_f32_16x16x32_bf16 v[200:203], a[68:71], a[88:91], v[200:203]
    ds_read_b128 v[88:91], v58 offset:320
    v_mfma_f32_16x16x32_bf16 v[204:207], a[72:75], a[88:91], v[204:207]
    ds_read_b128 v[92:95], v58 offset:384
    v_mfma_f32_16x16x32_bf16 v[208:211], a[76:79], a[88:91], v[208:211]
    ds_read_b128 v[96:99], v58 offset:448
    v_mfma_f32_16x16x32_bf16 v[212:215], a[48:51], a[92:95], v[212:215]
    v_mfma_f32_16x16x32_bf16 v[216:219], a[52:55], a[92:95], v[216:219]
    v_mfma_f32_16x16x32_bf16 v[220:223], a[56:59], a[92:95], v[220:223]
    v_mfma_f32_16x16x32_bf16 v[224:227], a[60:63], a[92:95], v[224:227]
    v_mfma_f32_16x16x32_bf16 v[228:231], a[64:67], a[92:95], v[228:231]
    v_mfma_f32_16x16x32_bf16 v[232:235], a[68:71], a[92:95], v[232:235]
    v_mfma_f32_16x16x32_bf16 v[236:239], a[72:75], a[92:95], v[236:239]
    v_mfma_f32_16x16x32_bf16 v[240:243], a[76:79], a[92:95], v[240:243]
    s_waitcnt vmcnt(8) lgkmcnt(0)
    v_mul_f32 v109, s44, v109
    v_mul_f32 v111, s44, v111
    v_mul_f32 v113, s44, v113
    v_mul_f32 v115, s44, v115
    ds_read_b128 a[160:163], v1 offset:57344
    ds_read_b128 a[164:167], v2 offset:57344
    ds_read_b128 a[168:171], v3 offset:57344
    ds_read_b128 a[172:175], v4 offset:57344
    ds_read_b128 a[176:179], v1 offset:61440
    ds_read_b128 a[180:183], v2 offset:61440
    ds_read_b128 a[184:187], v3 offset:61440
    ds_read_b128 a[188:191], v4 offset:61440
    v_pk_fma_f32 v[116:117], v[108:109], v[68:69], v[116:117] op_sel_hi:[0,1,1] neg_lo:[1,0,0] neg_hi:[1,0,0]
    v_pk_fma_f32 v[118:119], v[108:109], v[70:71], v[118:119] op_sel_hi:[0,1,1] neg_lo:[1,0,0] neg_hi:[1,0,0]
    v_pk_fma_f32 v[120:121], v[108:109], v[72:73], v[120:121] op_sel_hi:[0,1,1] neg_lo:[1,0,0] neg_hi:[1,0,0]
    v_pk_fma_f32 v[122:123], v[108:109], v[74:75], v[122:123] op_sel_hi:[0,1,1] neg_lo:[1,0,0] neg_hi:[1,0,0]
    v_pk_fma_f32 v[124:125], v[108:109], v[76:77], v[124:125] op_sel_hi:[0,1,1] neg_lo:[1,0,0] neg_hi:[1,0,0]
    v_pk_fma_f32 v[126:127], v[108:109], v[78:79], v[126:127] op_sel_hi:[0,1,1] neg_lo:[1,0,0] neg_hi:[1,0,0]
    v_pk_fma_f32 v[128:129], v[108:109], v[80:81], v[128:129] op_sel_hi:[0,1,1] neg_lo:[1,0,0] neg_hi:[1,0,0]
    v_pk_fma_f32 v[130:131], v[108:109], v[82:83], v[130:131] op_sel_hi:[0,1,1] neg_lo:[1,0,0] neg_hi:[1,0,0]
    v_pk_fma_f32 v[132:133], v[108:109], v[84:85], v[132:133] op_sel_hi:[0,1,1] neg_lo:[1,0,0] neg_hi:[1,0,0]
    v_pk_fma_f32 v[134:135], v[108:109], v[86:87], v[134:135] op_sel_hi:[0,1,1] neg_lo:[1,0,0] neg_hi:[1,0,0]
    v_pk_fma_f32 v[136:137], v[108:109], v[88:89], v[136:137] op_sel_hi:[0,1,1] neg_lo:[1,0,0] neg_hi:[1,0,0]
    v_pk_fma_f32 v[138:139], v[108:109], v[90:91], v[138:139] op_sel_hi:[0,1,1] neg_lo:[1,0,0] neg_hi:[1,0,0]
    v_pk_fma_f32 v[140:141], v[108:109], v[92:93], v[140:141] op_sel_hi:[0,1,1] neg_lo:[1,0,0] neg_hi:[1,0,0]
    v_pk_fma_f32 v[142:143], v[108:109], v[94:95], v[142:143] op_sel_hi:[0,1,1] neg_lo:[1,0,0] neg_hi:[1,0,0]
    v_pk_fma_f32 v[144:145], v[108:109], v[96:97], v[144:145] op_sel_hi:[0,1,1] neg_lo:[1,0,0] neg_hi:[1,0,0]
    v_pk_fma_f32 v[146:147], v[108:109], v[98:99], v[146:147] op_sel_hi:[0,1,1] neg_lo:[1,0,0] neg_hi:[1,0,0]
    v_pk_fma_f32 v[148:149], v[110:111], v[68:69], v[148:149] op_sel_hi:[0,1,1] neg_lo:[1,0,0] neg_hi:[1,0,0]
    v_pk_fma_f32 v[150:151], v[110:111], v[70:71], v[150:151] op_sel_hi:[0,1,1] neg_lo:[1,0,0] neg_hi:[1,0,0]
    v_pk_fma_f32 v[152:153], v[110:111], v[72:73], v[152:153] op_sel_hi:[0,1,1] neg_lo:[1,0,0] neg_hi:[1,0,0]
    v_pk_fma_f32 v[154:155], v[110:111], v[74:75], v[154:155] op_sel_hi:[0,1,1] neg_lo:[1,0,0] neg_hi:[1,0,0]
    v_pk_fma_f32 v[156:157], v[110:111], v[76:77], v[156:157] op_sel_hi:[0,1,1] neg_lo:[1,0,0] neg_hi:[1,0,0]
    v_pk_fma_f32 v[158:159], v[110:111], v[78:79], v[158:159] op_sel_hi:[0,1,1] neg_lo:[1,0,0] neg_hi:[1,0,0]
    v_pk_fma_f32 v[160:161], v[110:111], v[80:81], v[160:161] op_sel_hi:[0,1,1] neg_lo:[1,0,0] neg_hi:[1,0,0]
    v_pk_fma_f32 v[162:163], v[110:111], v[82:83], v[162:163] op_sel_hi:[0,1,1] neg_lo:[1,0,0] neg_hi:[1,0,0]
    v_pk_fma_f32 v[164:165], v[110:111], v[84:85], v[164:165] op_sel_hi:[0,1,1] neg_lo:[1,0,0] neg_hi:[1,0,0]
    v_pk_fma_f32 v[166:167], v[110:111], v[86:87], v[166:167] op_sel_hi:[0,1,1] neg_lo:[1,0,0] neg_hi:[1,0,0]
    v_pk_fma_f32 v[168:169], v[110:111], v[88:89], v[168:169] op_sel_hi:[0,1,1] neg_lo:[1,0,0] neg_hi:[1,0,0]
    v_pk_fma_f32 v[170:171], v[110:111], v[90:91], v[170:171] op_sel_hi:[0,1,1] neg_lo:[1,0,0] neg_hi:[1,0,0]
    v_pk_fma_f32 v[172:173], v[110:111], v[92:93], v[172:173] op_sel_hi:[0,1,1] neg_lo:[1,0,0] neg_hi:[1,0,0]
    v_pk_fma_f32 v[174:175], v[110:111], v[94:95], v[174:175] op_sel_hi:[0,1,1] neg_lo:[1,0,0] neg_hi:[1,0,0]
    v_pk_fma_f32 v[176:177], v[110:111], v[96:97], v[176:177] op_sel_hi:[0,1,1] neg_lo:[1,0,0] neg_hi:[1,0,0]
    v_pk_fma_f32 v[178:179], v[110:111], v[98:99], v[178:179] op_sel_hi:[0,1,1] neg_lo:[1,0,0] neg_hi:[1,0,0]
    v_pk_fma_f32 v[180:181], v[112:113], v[68:69], v[180:181] op_sel_hi:[0,1,1] neg_lo:[1,0,0] neg_hi:[1,0,0]
    v_pk_fma_f32 v[182:183], v[112:113], v[70:71], v[182:183] op_sel_hi:[0,1,1] neg_lo:[1,0,0] neg_hi:[1,0,0]
    v_pk_fma_f32 v[184:185], v[112:113], v[72:73], v[184:185] op_sel_hi:[0,1,1] neg_lo:[1,0,0] neg_hi:[1,0,0]
    v_pk_fma_f32 v[186:187], v[112:113], v[74:75], v[186:187] op_sel_hi:[0,1,1] neg_lo:[1,0,0] neg_hi:[1,0,0]
    v_pk_fma_f32 v[188:189], v[112:113], v[76:77], v[188:189] op_sel_hi:[0,1,1] neg_lo:[1,0,0] neg_hi:[1,0,0]
    v_pk_fma_f32 v[190:191], v[112:113], v[78:79], v[190:191] op_sel_hi:[0,1,1] neg_lo:[1,0,0] neg_hi:[1,0,0]
    v_pk_fma_f32 v[192:193], v[112:113], v[80:81], v[192:193] op_sel_hi:[0,1,1] neg_lo:[1,0,0] neg_hi:[1,0,0]
    v_pk_fma_f32 v[194:195], v[112:113], v[82:83], v[194:195] op_sel_hi:[0,1,1] neg_lo:[1,0,0] neg_hi:[1,0,0]
    v_pk_fma_f32 v[196:197], v[112:113], v[84:85], v[196:197] op_sel_hi:[0,1,1] neg_lo:[1,0,0] neg_hi:[1,0,0]
    v_pk_fma_f32 v[198:199], v[112:113], v[86:87], v[198:199] op_sel_hi:[0,1,1] neg_lo:[1,0,0] neg_hi:[1,0,0]
    v_pk_fma_f32 v[200:201], v[112:113], v[88:89], v[200:201] op_sel_hi:[0,1,1] neg_lo:[1,0,0] neg_hi:[1,0,0]
    v_pk_fma_f32 v[202:203], v[112:113], v[90:91], v[202:203] op_sel_hi:[0,1,1] neg_lo:[1,0,0] neg_hi:[1,0,0]
    v_pk_fma_f32 v[204:205], v[112:113], v[92:93], v[204:205] op_sel_hi:[0,1,1] neg_lo:[1,0,0] neg_hi:[1,0,0]
    v_pk_fma_f32 v[206:207], v[112:113], v[94:95], v[206:207] op_sel_hi:[0,1,1] neg_lo:[1,0,0] neg_hi:[1,0,0]
    v_pk_fma_f32 v[208:209], v[112:113], v[96:97], v[208:209] op_sel_hi:[0,1,1] neg_lo:[1,0,0] neg_hi:[1,0,0]
    v_pk_fma_f32 v[210:211], v[112:113], v[98:99], v[210:211] op_sel_hi:[0,1,1] neg_lo:[1,0,0] neg_hi:[1,0,0]
    v_pk_fma_f32 v[212:213], v[114:115], v[68:69], v[212:213] op_sel_hi:[0,1,1] neg_lo:[1,0,0] neg_hi:[1,0,0]
    v_pk_fma_f32 v[214:215], v[114:115], v[70:71], v[214:215] op_sel_hi:[0,1,1] neg_lo:[1,0,0] neg_hi:[1,0,0]
    v_pk_fma_f32 v[216:217], v[114:115], v[72:73], v[216:217] op_sel_hi:[0,1,1] neg_lo:[1,0,0] neg_hi:[1,0,0]
    v_pk_fma_f32 v[218:219], v[114:115], v[74:75], v[218:219] op_sel_hi:[0,1,1] neg_lo:[1,0,0] neg_hi:[1,0,0]
    v_pk_fma_f32 v[220:221], v[114:115], v[76:77], v[220:221] op_sel_hi:[0,1,1] neg_lo:[1,0,0] neg_hi:[1,0,0]
    v_pk_fma_f32 v[222:223], v[114:115], v[78:79], v[222:223] op_sel_hi:[0,1,1] neg_lo:[1,0,0] neg_hi:[1,0,0]
    v_pk_fma_f32 v[224:225], v[114:115], v[80:81], v[224:225] op_sel_hi:[0,1,1] neg_lo:[1,0,0] neg_hi:[1,0,0]
    v_pk_fma_f32 v[226:227], v[114:115], v[82:83], v[226:227] op_sel_hi:[0,1,1] neg_lo:[1,0,0] neg_hi:[1,0,0]
    v_pk_fma_f32 v[228:229], v[114:115], v[84:85], v[228:229] op_sel_hi:[0,1,1] neg_lo:[1,0,0] neg_hi:[1,0,0]
    v_pk_fma_f32 v[230:231], v[114:115], v[86:87], v[230:231] op_sel_hi:[0,1,1] neg_lo:[1,0,0] neg_hi:[1,0,0]
    v_pk_fma_f32 v[232:233], v[114:115], v[88:89], v[232:233] op_sel_hi:[0,1,1] neg_lo:[1,0,0] neg_hi:[1,0,0]
    v_pk_fma_f32 v[234:235], v[114:115], v[90:91], v[234:235] op_sel_hi:[0,1,1] neg_lo:[1,0,0] neg_hi:[1,0,0]
    v_pk_fma_f32 v[236:237], v[114:115], v[92:93], v[236:237] op_sel_hi:[0,1,1] neg_lo:[1,0,0] neg_hi:[1,0,0]
    v_pk_fma_f32 v[238:239], v[114:115], v[94:95], v[238:239] op_sel_hi:[0,1,1] neg_lo:[1,0,0] neg_hi:[1,0,0]
    v_pk_fma_f32 v[240:241], v[114:115], v[96:97], v[240:241] op_sel_hi:[0,1,1] neg_lo:[1,0,0] neg_hi:[1,0,0]
    v_pk_fma_f32 v[242:243], v[114:115], v[98:99], v[242:243] op_sel_hi:[0,1,1] neg_lo:[1,0,0] neg_hi:[1,0,0]
    v_pk_mul_f32 v[116:117], v[116:117], v[108:109] op_sel:[0,1] op_sel_hi:[1,1]
    v_pk_mul_f32 v[118:119], v[118:119], v[108:109] op_sel:[0,1] op_sel_hi:[1,1]
    v_pk_mul_f32 v[120:121], v[120:121], v[108:109] op_sel:[0,1] op_sel_hi:[1,1]
    v_pk_mul_f32 v[122:123], v[122:123], v[108:109] op_sel:[0,1] op_sel_hi:[1,1]
    v_pk_mul_f32 v[124:125], v[124:125], v[108:109] op_sel:[0,1] op_sel_hi:[1,1]
    v_pk_mul_f32 v[126:127], v[126:127], v[108:109] op_sel:[0,1] op_sel_hi:[1,1]
    v_pk_mul_f32 v[128:129], v[128:129], v[108:109] op_sel:[0,1] op_sel_hi:[1,1]
    v_pk_mul_f32 v[130:131], v[130:131], v[108:109] op_sel:[0,1] op_sel_hi:[1,1]
    v_pk_mul_f32 v[132:133], v[132:133], v[108:109] op_sel:[0,1] op_sel_hi:[1,1]
    v_pk_mul_f32 v[134:135], v[134:135], v[108:109] op_sel:[0,1] op_sel_hi:[1,1]
    v_pk_mul_f32 v[136:137], v[136:137], v[108:109] op_sel:[0,1] op_sel_hi:[1,1]
    v_pk_mul_f32 v[138:139], v[138:139], v[108:109] op_sel:[0,1] op_sel_hi:[1,1]
    v_pk_mul_f32 v[140:141], v[140:141], v[108:109] op_sel:[0,1] op_sel_hi:[1,1]
    v_pk_mul_f32 v[142:143], v[142:143], v[108:109] op_sel:[0,1] op_sel_hi:[1,1]
    v_pk_mul_f32 v[144:145], v[144:145], v[108:109] op_sel:[0,1] op_sel_hi:[1,1]
    v_pk_mul_f32 v[146:147], v[146:147], v[108:109] op_sel:[0,1] op_sel_hi:[1,1]
    v_cvt_pk_bf16_f32 v36, v116, v117
    v_cvt_pk_bf16_f32 v37, v118, v119
    v_cvt_pk_bf16_f32 v38, v120, v121
    v_cvt_pk_bf16_f32 v39, v122, v123
    v_cvt_pk_bf16_f32 v40, v124, v125
    v_cvt_pk_bf16_f32 v41, v126, v127
    v_cvt_pk_bf16_f32 v42, v128, v129
    v_cvt_pk_bf16_f32 v43, v130, v131
    v_cvt_pk_bf16_f32 v44, v132, v133
    v_cvt_pk_bf16_f32 v45, v134, v135
    v_cvt_pk_bf16_f32 v46, v136, v137
    v_cvt_pk_bf16_f32 v47, v138, v139
    v_cvt_pk_bf16_f32 v48, v140, v141
    v_cvt_pk_bf16_f32 v49, v142, v143
    v_cvt_pk_bf16_f32 v50, v144, v145
    v_cvt_pk_bf16_f32 v51, v146, v147
    v_permlane32_swap_b32 v36, v38
    v_permlane32_swap_b32 v37, v39
    v_permlane32_swap_b32 v40, v42
    v_permlane32_swap_b32 v41, v43
    v_permlane32_swap_b32 v44, v46
    v_permlane32_swap_b32 v45, v47
    v_permlane32_swap_b32 v48, v50
    v_permlane32_swap_b32 v49, v51
    v_permlane16_swap_b32 v36, v38
    v_permlane16_swap_b32 v37, v39
    v_permlane16_swap_b32 v40, v42
    v_permlane16_swap_b32 v41, v43
    v_permlane16_swap_b32 v44, v46
    v_permlane16_swap_b32 v45, v47
    v_permlane16_swap_b32 v48, v50
    v_permlane16_swap_b32 v49, v51
    s_nop 1
    v_mfma_f32_16x16x32_bf16 v[116:119], a[128:131], v[36:39], 0
    v_pk_mul_f32 v[148:149], v[148:149], v[110:111] op_sel:[0,1] op_sel_hi:[1,1]
    v_pk_mul_f32 v[150:151], v[150:151], v[110:111] op_sel:[0,1] op_sel_hi:[1,1]
    v_pk_mul_f32 v[152:153], v[152:153], v[110:111] op_sel:[0,1] op_sel_hi:[1,1]
    v_pk_mul_f32 v[154:155], v[154:155], v[110:111] op_sel:[0,1] op_sel_hi:[1,1]
    v_pk_mul_f32 v[156:157], v[156:157], v[110:111] op_sel:[0,1] op_sel_hi:[1,1]
    v_pk_mul_f32 v[158:159], v[158:159], v[110:111] op_sel:[0,1] op_sel_hi:[1,1]
    v_mfma_f32_16x16x32_bf16 v[116:119], a[132:135], v[40:43], v[116:119]
    v_pk_mul_f32 v[160:161], v[160:161], v[110:111] op_sel:[0,1] op_sel_hi:[1,1]
    v_pk_mul_f32 v[162:163], v[162:163], v[110:111] op_sel:[0,1] op_sel_hi:[1,1]
    v_pk_mul_f32 v[164:165], v[164:165], v[110:111] op_sel:[0,1] op_sel_hi:[1,1]
    v_pk_mul_f32 v[166:167], v[166:167], v[110:111] op_sel:[0,1] op_sel_hi:[1,1]
    v_pk_mul_f32 v[168:169], v[168:169], v[110:111] op_sel:[0,1] op_sel_hi:[1,1]
    v_pk_mul_f32 v[170:171], v[170:171], v[110:111] op_sel:[0,1] op_sel_hi:[1,1]
    v_mfma_f32_16x16x32_bf16 v[116:119], a[136:139], v[44:47], v[116:119]
    v_pk_mul_f32 v[172:173], v[172:173], v[110:111] op_sel:[0,1] op_sel_hi:[1,1]
    v_pk_mul_f32 v[174:175], v[174:175], v[110:111] op_sel:[0,1] op_sel_hi:[1,1]
    v_pk_mul_f32 v[176:177], v[176:177], v[110:111] op_sel:[0,1] op_sel_hi:[1,1]
    v_pk_mul_f32 v[178:179], v[178:179], v[110:111] op_sel:[0,1] op_sel_hi:[1,1]
    v_cvt_pk_bf16_f32 v52, v148, v149
    v_cvt_pk_bf16_f32 v53, v150, v151
    v_mfma_f32_16x16x32_bf16 v[116:119], a[140:143], v[48:51], v[116:119]
    v_cvt_pk_bf16_f32 v54, v152, v153
    v_cvt_pk_bf16_f32 v55, v154, v155
    v_cvt_pk_bf16_f32 v56, v156, v157
    v_cvt_pk_bf16_f32 v57, v158, v159
    v_cvt_pk_bf16_f32 v58, v160, v161
    v_cvt_pk_bf16_f32 v59, v162, v163
    v_mfma_f32_16x16x32_bf16 v[132:135], a[144:147], v[36:39], 0
    v_cvt_pk_bf16_f32 v60, v164, v165
    v_cvt_pk_bf16_f32 v61, v166, v167
    v_cvt_pk_bf16_f32 v62, v168, v169
    v_cvt_pk_bf16_f32 v63, v170, v171
    v_cvt_pk_bf16_f32 v64, v172, v173
    v_cvt_pk_bf16_f32 v65, v174, v175
    v_mfma_f32_16x16x32_bf16 v[132:135], a[148:151], v[40:43], v[132:135]
    v_cvt_pk_bf16_f32 v66, v176, v177
    v_cvt_pk_bf16_f32 v67, v178, v179
    v_permlane32_swap_b32 v52, v54
    v_permlane32_swap_b32 v53, v55
    v_permlane32_swap_b32 v56, v58
    v_permlane32_swap_b32 v57, v59
    v_mfma_f32_16x16x32_bf16 v[132:135], a[152:155], v[44:47], v[132:135]
    v_permlane32_swap_b32 v60, v62
    v_permlane32_swap_b32 v61, v63
    v_permlane32_swap_b32 v64, v66
    v_permlane32_swap_b32 v65, v67
    v_permlane16_swap_b32 v52, v54
    v_permlane16_swap_b32 v53, v55
    v_mfma_f32_16x16x32_bf16 v[132:135], a[156:159], v[48:51], v[132:135]
    v_permlane16_swap_b32 v56, v58
    v_permlane16_swap_b32 v57, v59
    v_permlane16_swap_b32 v60, v62
    v_permlane16_swap_b32 v61, v63
    v_permlane16_swap_b32 v64, v66
    v_permlane16_swap_b32 v65, v67
    s_nop 1
    v_mfma_f32_16x16x32_bf16 v[120:123], a[128:131], v[52:55], 0
    v_pk_mul_f32 v[180:181], v[180:181], v[112:113] op_sel:[0,1] op_sel_hi:[1,1]
    v_pk_mul_f32 v[182:183], v[182:183], v[112:113] op_sel:[0,1] op_sel_hi:[1,1]
    v_pk_mul_f32 v[184:185], v[184:185], v[112:113] op_sel:[0,1] op_sel_hi:[1,1]
    v_pk_mul_f32 v[186:187], v[186:187], v[112:113] op_sel:[0,1] op_sel_hi:[1,1]
    v_pk_mul_f32 v[188:189], v[188:189], v[112:113] op_sel:[0,1] op_sel_hi:[1,1]
    v_pk_mul_f32 v[190:191], v[190:191], v[112:113] op_sel:[0,1] op_sel_hi:[1,1]
    v_mfma_f32_16x16x32_bf16 v[120:123], a[132:135], v[56:59], v[120:123]
    v_pk_mul_f32 v[192:193], v[192:193], v[112:113] op_sel:[0,1] op_sel_hi:[1,1]
    v_pk_mul_f32 v[194:195], v[194:195], v[112:113] op_sel:[0,1] op_sel_hi:[1,1]
    v_pk_mul_f32 v[196:197], v[196:197], v[112:113] op_sel:[0,1] op_sel_hi:[1,1]
    v_pk_mul_f32 v[198:199], v[198:199], v[112:113] op_sel:[0,1] op_sel_hi:[1,1]
    v_pk_mul_f32 v[200:201], v[200:201], v[112:113] op_sel:[0,1] op_sel_hi:[1,1]
    v_pk_mul_f32 v[202:203], v[202:203], v[112:113] op_sel:[0,1] op_sel_hi:[1,1]
    v_mfma_f32_16x16x32_bf16 v[120:123], a[136:139], v[60:63], v[120:123]
    v_pk_mul_f32 v[204:205], v[204:205], v[112:113] op_sel:[0,1] op_sel_hi:[1,1]
    v_pk_mul_f32 v[206:207], v[206:207], v[112:113] op_sel:[0,1] op_sel_hi:[1,1]
    v_pk_mul_f32 v[208:209], v[208:209], v[112:113] op_sel:[0,1] op_sel_hi:[1,1]
    v_pk_mul_f32 v[210:211], v[210:211], v[112:113] op_sel:[0,1] op_sel_hi:[1,1]
    v_cvt_pk_bf16_f32 v68, v180, v181
    v_cvt_pk_bf16_f32 v69, v182, v183
    v_mfma_f32_16x16x32_bf16 v[120:123], a[140:143], v[64:67], v[120:123]
    v_cvt_pk_bf16_f32 v70, v184, v185
    v_cvt_pk_bf16_f32 v71, v186, v187
    v_cvt_pk_bf16_f32 v72, v188, v189
    v_cvt_pk_bf16_f32 v73, v190, v191
    v_cvt_pk_bf16_f32 v74, v192, v193
    v_cvt_pk_bf16_f32 v75, v194, v195
    v_mfma_f32_16x16x32_bf16 v[136:139], a[144:147], v[52:55], 0
    v_cvt_pk_bf16_f32 v76, v196, v197
    v_cvt_pk_bf16_f32 v77, v198, v199
    v_cvt_pk_bf16_f32 v78, v200, v201
    v_cvt_pk_bf16_f32 v79, v202, v203
    v_cvt_pk_bf16_f32 v80, v204, v205
    v_cvt_pk_bf16_f32 v81, v206, v207
    v_mfma_f32_16x16x32_bf16 v[136:139], a[148:151], v[56:59], v[136:139]
    v_cvt_pk_bf16_f32 v82, v208, v209
    v_cvt_pk_bf16_f32 v83, v210, v211
    v_permlane32_swap_b32 v68, v70
    v_permlane32_swap_b32 v69, v71
    v_permlane32_swap_b32 v72, v74
    v_permlane32_swap_b32 v73, v75
    v_mfma_f32_16x16x32_bf16 v[136:139], a[152:155], v[60:63], v[136:139]
    v_permlane32_swap_b32 v76, v78
    v_permlane32_swap_b32 v77, v79
    v_permlane32_swap_b32 v80, v82
    v_permlane32_swap_b32 v81, v83
    v_permlane16_swap_b32 v68, v70
    v_permlane16_swap_b32 v69, v71
    v_mfma_f32_16x16x32_bf16 v[136:139], a[156:159], v[64:67], v[136:139]
    v_permlane16_swap_b32 v72, v74
    v_permlane16_swap_b32 v73, v75
    v_permlane16_swap_b32 v76, v78
    v_permlane16_swap_b32 v77, v79
    v_permlane16_swap_b32 v80, v82
    v_permlane16_swap_b32 v81, v83
    s_nop 1
    v_mfma_f32_16x16x32_bf16 v[124:127], a[128:131], v[68:71], 0
    v_pk_mul_f32 v[212:213], v[212:213], v[114:115] op_sel:[0,1] op_sel_hi:[1,1]
    v_pk_mul_f32 v[214:215], v[214:215], v[114:115] op_sel:[0,1] op_sel_hi:[1,1]
    v_pk_mul_f32 v[216:217], v[216:217], v[114:115] op_sel:[0,1] op_sel_hi:[1,1]
    v_pk_mul_f32 v[218:219], v[218:219], v[114:115] op_sel:[0,1] op_sel_hi:[1,1]
    v_pk_mul_f32 v[220:221], v[220:221], v[114:115] op_sel:[0,1] op_sel_hi:[1,1]
    v_pk_mul_f32 v[222:223], v[222:223], v[114:115] op_sel:[0,1] op_sel_hi:[1,1]
    v_mfma_f32_16x16x32_bf16 v[124:127], a[132:135], v[72:75], v[124:127]
    v_pk_mul_f32 v[224:225], v[224:225], v[114:115] op_sel:[0,1] op_sel_hi:[1,1]
    v_pk_mul_f32 v[226:227], v[226:227], v[114:115] op_sel:[0,1] op_sel_hi:[1,1]
    v_pk_mul_f32 v[228:229], v[228:229], v[114:115] op_sel:[0,1] op_sel_hi:[1,1]
    v_pk_mul_f32 v[230:231], v[230:231], v[114:115] op_sel:[0,1] op_sel_hi:[1,1]
    v_pk_mul_f32 v[232:233], v[232:233], v[114:115] op_sel:[0,1] op_sel_hi:[1,1]
    v_pk_mul_f32 v[234:235], v[234:235], v[114:115] op_sel:[0,1] op_sel_hi:[1,1]
    v_mfma_f32_16x16x32_bf16 v[124:127], a[136:139], v[76:79], v[124:127]
    v_pk_mul_f32 v[236:237], v[236:237], v[114:115] op_sel:[0,1] op_sel_hi:[1,1]
    v_pk_mul_f32 v[238:239], v[238:239], v[114:115] op_sel:[0,1] op_sel_hi:[1,1]
    v_pk_mul_f32 v[240:241], v[240:241], v[114:115] op_sel:[0,1] op_sel_hi:[1,1]
    v_pk_mul_f32 v[242:243], v[242:243], v[114:115] op_sel:[0,1] op_sel_hi:[1,1]
    v_cvt_pk_bf16_f32 v84, v212, v213
    v_cvt_pk_bf16_f32 v85, v214, v215
    v_mfma_f32_16x16x32_bf16 v[124:127], a[140:143], v[80:83], v[124:127]
    v_cvt_pk_bf16_f32 v86, v216, v217
    v_cvt_pk_bf16_f32 v87, v218, v219
    v_cvt_pk_bf16_f32 v88, v220, v221
    v_cvt_pk_bf16_f32 v89, v222, v223
    v_cvt_pk_bf16_f32 v90, v224, v225
    v_cvt_pk_bf16_f32 v91, v226, v227
    v_mfma_f32_16x16x32_bf16 v[140:143], a[144:147], v[68:71], 0
    v_cvt_pk_bf16_f32 v92, v228, v229
    v_cvt_pk_bf16_f32 v93, v230, v231
    v_cvt_pk_bf16_f32 v94, v232, v233
    v_cvt_pk_bf16_f32 v95, v234, v235
    v_cvt_pk_bf16_f32 v96, v236, v237
    v_cvt_pk_bf16_f32 v97, v238, v239
    v_mfma_f32_16x16x32_bf16 v[140:143], a[148:151], v[72:75], v[140:143]
    v_cvt_pk_bf16_f32 v98, v240, v241
    v_cvt_pk_bf16_f32 v99, v242, v243
    v_permlane32_swap_b32 v84, v86
    v_permlane32_swap_b32 v85, v87
    v_permlane32_swap_b32 v88, v90
    v_permlane32_swap_b32 v89, v91
    v_mfma_f32_16x16x32_bf16 v[140:143], a[152:155], v[76:79], v[140:143]
    v_permlane32_swap_b32 v92, v94
    v_permlane32_swap_b32 v93, v95
    v_permlane32_swap_b32 v96, v98
    v_permlane32_swap_b32 v97, v99
    v_permlane16_swap_b32 v84, v86
    v_permlane16_swap_b32 v85, v87
    v_mfma_f32_16x16x32_bf16 v[140:143], a[156:159], v[80:83], v[140:143]
    v_permlane16_swap_b32 v88, v90
    v_permlane16_swap_b32 v89, v91
    v_permlane16_swap_b32 v92, v94
    v_permlane16_swap_b32 v93, v95
    v_permlane16_swap_b32 v96, v98
    v_permlane16_swap_b32 v97, v99
    s_nop 1
    v_mfma_f32_16x16x32_bf16 v[128:131], a[128:131], v[84:87], 0
    v_max3_f32 v28, v116, v117, v118
    v_max3_f32 v29, v119, v132, v133
    v_max3_f32 v28, v28, v134, v135
    v_max_f32 v28, v28, v29
    v_mov_b32 v29, v28
    s_nop 1
    v_mfma_f32_16x16x32_bf16 v[128:131], a[132:135], v[88:91], v[128:131]
    v_permlane32_swap_b32 v28, v29
    v_max_f32 v28, v28, v29
    v_mov_b32 v29, v28
    s_nop 1
    v_permlane16_swap_b32 v28, v29
    v_max_f32 v28, v28, v29
    v_mfma_f32_16x16x32_bf16 v[128:131], a[136:139], v[92:95], v[128:131]
    v_sub_f32 v100, 0, v28
    v_sub_f32 v101, 0, v28
    v_sub_f32 v102, 0, v28
    v_sub_f32 v103, 0, v28
    v_sub_f32 v116, v116, v28
    v_sub_f32 v117, v117, v28
    v_mfma_f32_16x16x32_bf16 v[128:131], a[140:143], v[96:99], v[128:131]
    v_sub_f32 v118, v118, v28
    v_sub_f32 v119, v119, v28
    v_sub_f32 v132, v132, v28
    v_sub_f32 v133, v133, v28
    v_sub_f32 v134, v134, v28
    v_sub_f32 v135, v135, v28
    v_mfma_f32_16x16x32_bf16 v[144:147], a[144:147], v[84:87], 0
    v_max3_f32 v30, v120, v121, v122
    v_max3_f32 v31, v123, v136, v137
    v_max3_f32 v30, v30, v138, v139
    v_max_f32 v30, v30, v31
    v_mov_b32 v31, v30
    s_nop 1
    v_mfma_f32_16x16x32_bf16 v[144:147], a[148:151], v[88:91], v[144:147]
    v_permlane32_swap_b32 v30, v31
    v_max_f32 v30, v30, v31
    v_mov_b32 v31, v30
    s_nop 1
    v_permlane16_swap_b32 v30, v31
    v_max_f32 v30, v30, v31
    v_mfma_f32_16x16x32_bf16 v[144:147], a[152:155], v[92:95], v[144:147]
    v_sub_f32 v104, 0, v30
    v_sub_f32 v105, 0, v30
    v_sub_f32 v106, 0, v30
    v_sub_f32 v107, 0, v30
    v_sub_f32 v120, v120, v30
    v_sub_f32 v121, v121, v30
    v_mfma_f32_16x16x32_bf16 v[144:147], a[156:159], v[96:99], v[144:147]
    v_sub_f32 v122, v122, v30
    v_sub_f32 v123, v123, v30
    v_sub_f32 v136, v136, v30
    v_sub_f32 v137, v137, v30
    v_sub_f32 v138, v138, v30
    v_sub_f32 v139, v139, v30
    s_waitcnt vmcnt(12) lgkmcnt(0)
    s_barrier
    v_and_b32 v253, 7, v19
    v_lshlrev_b32 v253, 5, v253
    buffer_load_dword v252, v253, s[92:95], 0 offen sc1
    v_mfma_f32_16x16x32_bf16 v[148:151], a[160:163], v[36:39], v[100:103]
    s_add_u32 m0, s34, 0
    ds_read_b128 a[128:131], v1 offset:16384
    ds_read_b128 a[132:135], v2 offset:16384
    v_mfma_f32_16x16x32_bf16 v[148:151], a[164:167], v[40:43], v[148:151]
    buffer_load_dwordx4 v13, s[8:11], s28 offen offset:0 lds
    v_max3_f32 v32, v124, v125, v126
    v_max3_f32 v33, v127, v140, v141
    v_mfma_f32_16x16x32_bf16 v[148:151], a[168:171], v[44:47], v[148:151]
    v_max3_f32 v32, v32, v142, v143
    v_max_f32 v32, v32, v33
    v_mov_b32 v33, v32
    v_mfma_f32_16x16x32_bf16 v[148:151], a[172:175], v[48:51], v[148:151]
    s_nop 1
    v_permlane32_swap_b32 v32, v33
    v_max_f32 v32, v32, v33
    v_mov_b32 v33, v32
    v_mfma_f32_16x16x32_bf16 v[152:155], a[160:163], v[52:55], v[104:107]
    s_nop 1
    v_permlane16_swap_b32 v32, v33
    v_max_f32 v32, v32, v33
    v_mfma_f32_16x16x32_bf16 v[152:155], a[164:167], v[56:59], v[152:155]
    v_sub_f32 v108, 0, v32
    v_sub_f32 v109, 0, v32
    v_sub_f32 v110, 0, v32
    v_mfma_f32_16x16x32_bf16 v[152:155], a[168:171], v[60:63], v[152:155]
    v_sub_f32 v111, 0, v32
    v_sub_f32 v124, v124, v32
    v_sub_f32 v125, v125, v32
    v_sub_f32 v126, v126, v32
    v_mfma_f32_16x16x32_bf16 v[152:155], a[172:175], v[64:67], v[152:155]
    v_sub_f32 v127, v127, v32
    v_sub_f32 v140, v140, v32
    v_sub_f32 v141, v141, v32
    v_mfma_f32_16x16x32_bf16 v[164:167], a[176:179], v[36:39], v[100:103]
    v_sub_f32 v142, v142, v32
    v_sub_f32 v143, v143, v32
    v_max3_f32 v34, v128, v129, v130
    v_mfma_f32_16x16x32_bf16 v[164:167], a[180:183], v[40:43], v[164:167]
    v_max3_f32 v35, v131, v144, v145
    v_max3_f32 v34, v34, v146, v147
    v_max_f32 v34, v34, v35
    v_mov_b32 v35, v34
    v_mfma_f32_16x16x32_bf16 v[164:167], a[184:187], v[44:47], v[164:167]
    s_nop 1
    v_permlane32_swap_b32 v34, v35
    v_max_f32 v34, v34, v35
    v_mfma_f32_16x16x32_bf16 v[164:167], a[188:191], v[48:51], v[164:167]
    v_mov_b32 v35, v34
    s_nop 1
    v_permlane16_swap_b32 v34, v35
    v_mfma_f32_16x16x32_bf16 v[168:171], a[176:179], v[52:55], v[104:107]
    v_max_f32 v34, v34, v35
    v_sub_f32 v112, 0, v34
    v_sub_f32 v113, 0, v34
    v_sub_f32 v114, 0, v34
    v_mfma_f32_16x16x32_bf16 v[168:171], a[180:183], v[56:59], v[168:171]
    v_sub_f32 v115, 0, v34
    v_sub_f32 v128, v128, v34
    v_sub_f32 v129, v129, v34
    v_mfma_f32_16x16x32_bf16 v[168:171], a[184:187], v[60:63], v[168:171]
    v_sub_f32 v130, v130, v34
    v_sub_f32 v131, v131, v34
    v_sub_f32 v144, v144, v34
    v_mfma_f32_16x16x32_bf16 v[168:171], a[188:191], v[64:67], v[168:171]
    v_sub_f32 v145, v145, v34
    v_sub_f32 v146, v146, v34
    v_sub_f32 v147, v147, v34
    s_nop 0
    v_mfma_f32_16x16x32_bf16 v[156:159], a[160:163], v[68:71], v[108:111]
    v_mfma_f32_16x16x32_bf16 v[156:159], a[164:167], v[72:75], v[156:159]
    v_mfma_f32_16x16x32_bf16 v[156:159], a[168:171], v[76:79], v[156:159]
    ds_read_b128 a[136:139], v3 offset:16384
    v_mfma_f32_16x16x32_bf16 v[156:159], a[172:175], v[80:83], v[156:159]
    v_mfma_f32_16x16x32_bf16 v[160:163], a[160:163], v[84:87], v[112:115]
    v_mfma_f32_16x16x32_bf16 v[160:163], a[164:167], v[88:91], v[160:163]
    ds_read_b128 a[140:143], v4 offset:16384
    v_mfma_f32_16x16x32_bf16 v[160:163], a[168:171], v[92:95], v[160:163]
    v_mfma_f32_16x16x32_bf16 v[160:163], a[172:175], v[96:99], v[160:163]
    buffer_load_dwordx4 v14, s[8:11], s28 offen offset:1024 lds
    s_waitcnt lgkmcnt(2)
    v_mfma_f32_16x16x32_bf16 v[172:175], a[176:179], v[68:71], v[108:111]
    v_exp_f32 v116, v116
    ds_read_b128 a[144:147], v1 offset:20480
    v_mfma_f32_16x16x32_bf16 v[172:175], a[180:183], v[72:75], v[172:175]
    v_exp_f32 v117, v117
    ds_read_b128 a[148:151], v2 offset:20480
    s_mov_b32 s43, m0
    s_add_u32 m0, s47, 0
    s_nop 0
    buffer_load_dwordx4 v20, s[96:99], 0 offen lds
    s_mov_b32 m0, s43
    v_mfma_f32_16x16x32_bf16 v[172:175], a[184:187], v[76:79], v[172:175]
    v_exp_f32 v118, v118
    v_cvt_pk_bf16_f32 v180, v116, v117
    v_mfma_f32_16x16x32_bf16 v[172:175], a[188:191], v[80:83], v[172:175]
    v_exp_f32 v119, v119
    v_mfma_f32_16x16x32_bf16 v[176:179], a[176:179], v[84:87], v[112:115]
    v_exp_f32 v120, v120
    v_cvt_pk_bf16_f32 v181, v118, v119
    v_mfma_f32_16x16x32_bf16 v[176:179], a[180:183], v[88:91], v[176:179]
    v_exp_f32 v121, v121
    v_mfma_f32_16x16x32_bf16 v[176:179], a[184:187], v[92:95], v[176:179]
    v_exp_f32 v122, v122
    buffer_load_dwordx4 v15, s[8:11], s28 offen offset:2048 lds
    v_cvt_pk_bf16_f32 v188, v120, v121
    v_mfma_f32_16x16x32_bf16 v[176:179], a[188:191], v[96:99], v[176:179]
    v_exp_f32 v123, v123
    s_waitcnt lgkmcnt(2)
    v_mfma_f32_16x16x32_bf16 v[116:119], a[128:131], v[36:39], v[100:103]
    v_exp_f32 v124, v124
    ds_read_b128 a[152:155], v3 offset:20480
    v_cvt_pk_bf16_f32 v189, v122, v123
    v_mfma_f32_16x16x32_bf16 v[116:119], a[132:135], v[40:43], v[116:119]
    v_exp_f32 v125, v125
    ds_read_b128 a[156:159], v4 offset:20480
    s_mov_b32 s43, m0
    s_add_u32 m0, s47, 1024
    s_nop 0
    buffer_load_dwordx4 v21, s[96:99], 0 offen lds
    s_mov_b32 m0, s43
    v_mfma_f32_16x16x32_bf16 v[116:119], a[136:139], v[44:47], v[116:119]
    v_exp_f32 v126, v126
    v_cvt_pk_bf16_f32 v196, v124, v125
    v_mfma_f32_16x16x32_bf16 v[116:119], a[140:143], v[48:51], v[116:119]
    v_exp_f32 v127, v127
    v_mfma_f32_16x16x32_bf16 v[120:123], a[128:131], v[52:55], v[104:107]
    v_exp_f32 v128, v128
    v_cvt_pk_bf16_f32 v197, v126, v127
    v_mfma_f32_16x16x32_bf16 v[120:123], a[132:135], v[56:59], v[120:123]
    v_exp_f32 v129, v129
    v_mfma_f32_16x16x32_bf16 v[120:123], a[136:139], v[60:63], v[120:123]
    v_exp_f32 v130, v130
    buffer_load_dwordx4 v16, s[8:11], s28 offen offset:3072 lds
    v_cvt_pk_bf16_f32 v204, v128, v129
    v_mfma_f32_16x16x32_bf16 v[120:123], a[140:143], v[64:67], v[120:123]
    v_exp_f32 v131, v131
    s_waitcnt lgkmcnt(2)
    v_mfma_f32_16x16x32_bf16 v[124:127], a[128:131], v[68:71], v[108:111]
    v_exp_f32 v132, v132
    ds_read_b128 a[160:163], v1 offset:24576
    v_cvt_pk_bf16_f32 v205, v130, v131
    v_mfma_f32_16x16x32_bf16 v[124:127], a[132:135], v[72:75], v[124:127]
    v_exp_f32 v133, v133
    ds_read_b128 a[164:167], v2 offset:24576
    s_mov_b32 s43, m0
    s_add_u32 m0, s47, 2048
    s_nop 0
    buffer_load_dwordx4 v22, s[96:99], 0 offen lds
    s_mov_b32 m0, s43
    v_mfma_f32_16x16x32_bf16 v[124:127], a[136:139], v[76:79], v[124:127]
    v_exp_f32 v134, v134
    v_cvt_pk_bf16_f32 v182, v132, v133
    v_mfma_f32_16x16x32_bf16 v[124:127], a[140:143], v[80:83], v[124:127]
    v_exp_f32 v135, v135
    v_mfma_f32_16x16x32_bf16 v[128:131], a[128:131], v[84:87], v[112:115]
    v_exp_f32 v136, v136
    v_cvt_pk_bf16_f32 v183, v134, v135
    v_mfma_f32_16x16x32_bf16 v[128:131], a[132:135], v[88:91], v[128:131]
    v_exp_f32 v137, v137
    v_mfma_f32_16x16x32_bf16 v[128:131], a[136:139], v[92:95], v[128:131]
    s_add_u32 s28, s28, 16384
    s_mov_b32 m0, s31
    v_exp_f32 v138, v138
    buffer_load_dwordx4 v17, s[12:15], s29 offen offset:0 lds
    v_cvt_pk_bf16_f32 v190, v136, v137
    v_mfma_f32_16x16x32_bf16 v[128:131], a[140:143], v[96:99], v[128:131]
    v_exp_f32 v139, v139
    s_waitcnt lgkmcnt(2)
    v_mfma_f32_16x16x32_bf16 v[132:135], a[144:147], v[36:39], v[100:103]
    v_exp_f32 v140, v140
    ds_read_b128 a[168:171], v3 offset:24576
    v_cvt_pk_bf16_f32 v191, v138, v139
    v_mfma_f32_16x16x32_bf16 v[132:135], a[148:151], v[40:43], v[132:135]
    v_exp_f32 v141, v141
    ds_read_b128 a[172:175], v4 offset:24576
    s_mov_b32 s43, m0
    s_add_u32 m0, s47, 3072
    s_nop 0
    buffer_load_dwordx4 v23, s[96:99], 0 offen lds
    s_mov_b32 m0, s43
    v_mfma_f32_16x16x32_bf16 v[132:135], a[152:155], v[44:47], v[132:135]
    v_exp_f32 v142, v142
    v_cvt_pk_bf16_f32 v198, v140, v141
    v_mfma_f32_16x16x32_bf16 v[132:135], a[156:159], v[48:51], v[132:135]
    v_exp_f32 v143, v143
    v_mfma_f32_16x16x32_bf16 v[136:139], a[144:147], v[52:55], v[104:107]
    v_exp_f32 v144, v144
    v_cvt_pk_bf16_f32 v199, v142, v143
    v_mfma_f32_16x16x32_bf16 v[136:139], a[148:151], v[56:59], v[136:139]
    v_exp_f32 v145, v145
    v_mfma_f32_16x16x32_bf16 v[136:139], a[152:155], v[60:63], v[136:139]
    v_exp_f32 v146, v146
    buffer_load_dwordx4 v18, s[12:15], s29 offen offset:1024 lds
    v_cvt_pk_bf16_f32 v206, v144, v145
    v_mfma_f32_16x16x32_bf16 v[136:139], a[156:159], v[64:67], v[136:139]
    v_exp_f32 v147, v147
    s_waitcnt lgkmcnt(2)
    v_mfma_f32_16x16x32_bf16 v[140:143], a[144:147], v[68:71], v[108:111]
    v_exp_f32 v148, v148
    ds_read_b128 a[176:179], v1 offset:28672
    v_cvt_pk_bf16_f32 v207, v146, v147
    v_mfma_f32_16x16x32_bf16 v[140:143], a[148:151], v[72:75], v[140:143]
    v_exp_f32 v149, v149
    ds_read_b128 a[180:183], v2 offset:28672
    s_mov_b32 s43, m0
    s_add_u32 m0, s47, 4096
    s_nop 0
    buffer_load_dwordx4 v24, s[96:99], 0 offen lds
    s_mov_b32 m0, s43
    v_mfma_f32_16x16x32_bf16 v[140:143], a[152:155], v[76:79], v[140:143]
    v_exp_f32 v150, v150
    v_cvt_pk_bf16_f32 v184, v148, v149
    v_mfma_f32_16x16x32_bf16 v[140:143], a[156:159], v[80:83], v[140:143]
    v_exp_f32 v151, v151
    s_waitcnt vmcnt(11)
    v_cmp_ne_u32 vcc, 32, v252
    s_and_b64 vcc, vcc, exec
    s_cbranch_scc1 L_spin_all
L_back_all:
    s_lshl_b32 s40, s5, 11
    s_add_u32 s40, s40, 0x288000
    v_lshlrev_b32 v253, 4, v19
    buffer_load_dwordx4 v[28:31], v253, s[76:79], s40 offen offset:0 sc1
    buffer_load_dwordx4 v[32:35], v253, s[76:79], s40 offen offset:1024 sc1
    v_mfma_f32_16x16x32_bf16 v[144:147], a[144:147], v[84:87], v[112:115]
    v_exp_f32 v152, v152
    v_cvt_pk_bf16_f32 v185, v150, v151
    v_mfma_f32_16x16x32_bf16 v[144:147], a[148:151], v[88:91], v[144:147]
    v_exp_f32 v153, v153
    v_mfma_f32_16x16x32_bf16 v[144:147], a[152:155], v[92:95], v[144:147]
    v_exp_f32 v154, v154
    buffer_load_dwordx4 v17, s[12:15], s29 offen offset:2048 lds
    v_cvt_pk_bf16_f32 v192, v152, v153
    v_mfma_f32_16x16x32_bf16 v[144:147], a[156:159], v[96:99], v[144:147]
    v_exp_f32 v155, v155
    s_waitcnt lgkmcnt(2)
    v_mfma_f32_16x16x32_bf16 v[148:151], a[160:163], v[36:39], v[100:103]
    v_exp_f32 v156, v156
    ds_read_b128 a[184:187], v3 offset:28672
    v_cvt_pk_bf16_f32 v193, v154, v155
    v_mfma_f32_16x16x32_bf16 v[148:151], a[164:167], v[40:43], v[148:151]
    v_exp_f32 v157, v157
    ds_read_b128 a[188:191], v4 offset:28672
    v_mfma_f32_16x16x32_bf16 v[148:151], a[168:171], v[44:47], v[148:151]
    v_exp_f32 v158, v158
    v_cvt_pk_bf16_f32 v200, v156, v157
    v_mfma_f32_16x16x32_bf16 v[148:151], a[172:175], v[48:51], v[148:151]
    v_exp_f32 v159, v159
    v_mfma_f32_16x16x32_bf16 v[152:155], a[160:163], v[52:55], v[104:107]
    v_exp_f32 v160, v160
    v_cvt_pk_bf16_f32 v201, v158, v159
    v_mfma_f32_16x16x32_bf16 v[152:155], a[164:167], v[56:59], v[152:155]
    v_exp_f32 v161, v161
    v_mfma_f32_16x16x32_bf16 v[152:155], a[168:171], v[60:63], v[152:155]
    v_exp_f32 v162, v162
    buffer_load_dwordx4 v18, s[12:15], s29 offen offset:3072 lds
    v_cvt_pk_bf16_f32 v208, v160, v161
    v_mfma_f32_16x16x32_bf16 v[152:155], a[172:175], v[64:67], v[152:155]
    s_add_u32 s29, s29, 16384
    v_exp_f32 v163, v163
    s_waitcnt vmcnt(16) lgkmcnt(2)
    s_barrier
    v_mfma_f32_16x16x32_bf16 v[156:159], a[160:163], v[68:71], v[108:111]
    v_exp_f32 v164, v164
    ds_read_b64_tr_b16 a[192:193], v5 offset:8192
    v_cvt_pk_bf16_f32 v209, v162, v163
    v_mfma_f32_16x16x32_bf16 v[156:159], a[164:167], v[72:75], v[156:159]
    v_exp_f32 v165, v165
    ds_read_b64_tr_b16 a[194:195], v5 offset:12288
    v_mfma_f32_16x16x32_bf16 v[156:159], a[168:171], v[76:79], v[156:159]
    v_exp_f32 v166, v166
    ds_read_b128 a[128:131], v1 offset:32768
    v_cvt_pk_bf16_f32 v186, v164, v165
    v_mfma_f32_16x16x32_bf16 v[156:159], a[172:175], v[80:83], v[156:159]
    v_exp_f32 v167, v167
    ds_read_b64_tr_b16 a[196:197], v5 offset:32768
    v_mfma_f32_16x16x32_bf16 v[160:163], a[160:163], v[84:87], v[112:115]
    v_exp_f32 v168, v168
    ds_read_b64_tr_b16 a[198:199], v5 offset:36864
    v_cvt_pk_bf16_f32 v187, v166, v167
    v_mfma_f32_16x16x32_bf16 v[160:163], a[164:167], v[88:91], v[160:163]
    v_exp_f32 v169, v169
    ds_read_b128 a[132:135], v2 offset:32768
    v_mfma_f32_16x16x32_bf16 v[160:163], a[168:171], v[92:95], v[160:163]
    s_add_u32 m0, s34, 49152
    v_exp_f32 v170, v170
    buffer_load_dwordx4 v13, s[8:11], s28 offen offset:0 lds
    v_cvt_pk_bf16_f32 v194, v168, v169
    v_mfma_f32_16x16x32_bf16 v[160:163], a[172:175], v[96:99], v[160:163]
    v_exp_f32 v171, v171
    s_waitcnt lgkmcnt(6)
    v_mfma_f32_16x16x32_bf16 v[164:167], a[176:179], v[36:39], v[100:103]
    v_exp_f32 v172, v172
    ds_read_b64_tr_b16 a[200:201], v6 offset:8192
    v_cvt_pk_bf16_f32 v195, v170, v171
    v_mfma_f32_16x16x32_bf16 v[164:167], a[180:183], v[40:43], v[164:167]
    v_exp_f32 v173, v173
    ds_read_b64_tr_b16 a[202:203], v6 offset:12288
    v_mfma_f32_16x16x32_bf16 v[164:167], a[184:187], v[44:47], v[164:167]
    v_exp_f32 v174, v174
    ds_read_b128 a[136:139], v3 offset:32768
    v_cvt_pk_bf16_f32 v202, v172, v173
    v_mfma_f32_16x16x32_bf16 v[164:167], a[188:191], v[48:51], v[164:167]
    v_exp_f32 v175, v175
    ds_read_b64_tr_b16 a[204:205], v6 offset:32768
    v_mfma_f32_16x16x32_bf16 v[168:171], a[176:179], v[52:55], v[104:107]
    v_exp_f32 v176, v176
    ds_read_b64_tr_b16 a[206:207], v6 offset:36864
    v_cvt_pk_bf16_f32 v203, v174, v175
    v_mfma_f32_16x16x32_bf16 v[168:171], a[180:183], v[56:59], v[168:171]
    v_exp_f32 v177, v177
    ds_read_b128 a[140:143], v4 offset:32768
    v_mfma_f32_16x16x32_bf16 v[168:171], a[184:187], v[60:63], v[168:171]
    v_exp_f32 v178, v178
    buffer_load_dwordx4 v14, s[8:11], s28 offen offset:1024 lds
    v_cvt_pk_bf16_f32 v210, v176, v177
    v_mfma_f32_16x16x32_bf16 v[168:171], a[188:191], v[64:67], v[168:171]
    v_exp_f32 v179, v179
    s_waitcnt lgkmcnt(6)
    v_mfma_f32_16x16x32_bf16 v[172:175], a[176:179], v[68:71], v[108:111]
    v_exp_f32 v116, v116
    v_mfma_f32_16x16x32_bf16 v[172:175], a[180:183], v[72:75], v[172:175]
    ds_read_b64_tr_b16 a[208:209], v7 offset:8192
    v_cvt_pk_bf16_f32 v211, v178, v179
    v_mfma_f32_16x16x32_bf16 v[172:175], a[184:187], v[76:79], v[172:175]
    v_exp_f32 v117, v117
    v_mfma_f32_16x16x32_bf16 v[172:175], a[188:191], v[80:83], v[172:175]
    ds_read_b64_tr_b16 a[210:211], v7 offset:12288
    s_mov_b32 s16, s62
    s_mov_b32 s17, s63
    s_mov_b32 s18, 0x21c000
    s_mov_b32 s19, 0x20000
    s_mov_b32 s20, s64
    s_mov_b32 s21, s65
    s_mov_b32 s22, 0x21c000
    s_mov_b32 s23, 0x20000
    s_mov_b32 s96, s66
    s_mov_b32 s97, s67
    s_mov_b32 s98, 0x21c000
    s_mov_b32 s99, 0x20000
    v_mfma_f32_16x16x32_bf16 v[176:179], a[176:179], v[84:87], v[112:115]
    v_exp_f32 v118, v118
    v_mfma_f32_16x16x32_bf16 v[176:179], a[180:183], v[88:91], v[176:179]
    ds_read_b128 a[144:147], v1 offset:36864
    v_cvt_pk_bf16_f32 v212, v116, v117
    v_mfma_f32_16x16x32_bf16 v[176:179], a[184:187], v[92:95], v[176:179]
    v_exp_f32 v119, v119
    v_mfma_f32_16x16x32_bf16 v[176:179], a[188:191], v[96:99], v[176:179]
    ds_read_b64_tr_b16 a[212:213], v7 offset:32768
    v_mul_u32_u24 v24, 3456, v19
    s_lshl_b32 s40, s6, 4
    v_add_u32 v24, s40, v24
    s_cmp_ge_u32 s5, 2
    s_cselect_b32 s16, s20, s16
    s_cselect_b32 s17, s21, s17
    s_cmp_ge_u32 s6, 216
    s_cselect_b32 s18, 0, s18
    s_and_b32 s40, s5, 1
    s_mul_i32 s37, s40, 1105920
    s_mul_i32 s38, s5, 5120
    s_add_u32 s38, s38, 65536
    s_mov_b32 s36, s5
    v_mfma_f32_16x16x32_bf16 a[0:3], a[192:195], v[180:183], 0
    v_exp_f32 v120, v120
    v_mfma_f32_16x16x32_bf16 a[0:3], a[196:199], v[184:187], a[0:3]
    ds_read_b64_tr_b16 a[214:215], v7 offset:36864
    v_cvt_pk_bf16_f32 v213, v118, v119
    v_mfma_f32_16x16x32_bf16 a[4:7], a[192:195], v[188:191], 0
    v_exp_f32 v121, v121
    v_mfma_f32_16x16x32_bf16 a[4:7], a[196:199], v[192:195], a[4:7]
    ds_read_b128 a[148:151], v2 offset:36864
    v_cvt_pk_bf16_f32 v220, v120, v121
    v_mfma_f32_16x16x32_bf16 a[8:11], a[192:195], v[196:199], 0
    v_exp_f32 v122, v122
    v_mfma_f32_16x16x32_bf16 a[8:11], a[196:199], v[200:203], a[8:11]
    buffer_load_dwordx4 v15, s[8:11], s28 offen offset:2048 lds
    v_mfma_f32_16x16x32_bf16 a[12:15], a[192:195], v[204:207], 0
    v_exp_f32 v123, v123
    v_mfma_f32_16x16x32_bf16 a[12:15], a[196:199], v[208:211], a[12:15]
    s_waitcnt lgkmcnt(6)
    v_mfma_f32_16x16x32_bf16 v[116:119], a[128:131], v[36:39], v[100:103]
    v_exp_f32 v124, v124
    s_waitcnt vmcnt(5)
    v_mfma_f32_16x16x32_bf16 v[116:119], a[132:135], v[40:43], v[116:119]
    s_mov_b32 s42, -1
    ds_read_b64_tr_b16 a[216:217], v8 offset:8192
    v_cvt_pk_bf16_f32 v221, v122, v123
    v_sub_u32 v20, s42, v28
    v_mfma_f32_16x16x32_bf16 v[116:119], a[136:139], v[44:47], v[116:119]
    v_exp_f32 v125, v125
    v_sub_u32 v21, s42, v29
    v_mfma_f32_16x16x32_bf16 v[116:119], a[140:143], v[48:51], v[116:119]
    ds_read_b64_tr_b16 a[218:219], v8 offset:12288
    s_waitcnt vmcnt(7)
    ds_read_b64_tr_b16 a[240:241], v25 offset:0
    ds_read_b64_tr_b16 a[242:243], v25 offset:2560
    v_sub_u32 v22, s42, v30
    v_min3_u32 v20, v20, v21, v22
    v_mfma_f32_16x16x32_bf16 v[120:123], a[128:131], v[52:55], v[104:107]
    v_exp_f32 v126, v126
    v_sub_u32 v21, s42, v31
    v_sub_u32 v22, s42, v32
    v_mfma_f32_16x16x32_bf16 v[120:123], a[132:135], v[56:59], v[120:123]
    ds_read_b128 a[152:155], v3 offset:36864
    v_cvt_pk_bf16_f32 v228, v124, v125
    v_min3_u32 v20, v20, v21, v22
    v_mfma_f32_16x16x32_bf16 v[120:123], a[136:139], v[60:63], v[120:123]
    v_exp_f32 v127, v127
    v_sub_u32 v21, s42, v33
    v_sub_u32 v22, s42, v34
    v_mfma_f32_16x16x32_bf16 v[120:123], a[140:143], v[64:67], v[120:123]
    ds_read_b64_tr_b16 a[220:221], v8 offset:32768
    ds_read_b64_tr_b16 a[244:245], v25 offset:32
    ds_read_b64_tr_b16 a[246:247], v25 offset:2592
    v_min3_u32 v20, v20, v21, v22
    v_sub_u32 v21, s42, v35
    v_mfma_f32_16x16x32_bf16 a[16:19], a[200:203], v[180:183], 0
    v_exp_f32 v128, v128
    v_min_u32 v20, v20, v21
    v_mfma_f32_16x16x32_bf16 a[16:19], a[204:207], v[184:187], a[16:19]
    ds_read_b64_tr_b16 a[222:223], v8 offset:36864
    v_cvt_pk_bf16_f32 v229, v126, v127
    v_min_u32_dpp v20, v20, v20 row_shr:1 row_mask:0xf bank_mask:0xf
    s_nop 1
    v_min_u32_dpp v20, v20, v20 row_shr:2 row_mask:0xf bank_mask:0xf
    v_mfma_f32_16x16x32_bf16 a[20:23], a[200:203], v[188:191], 0
    v_exp_f32 v129, v129
    v_min_u32_dpp v20, v20, v20 row_shr:4 row_mask:0xf bank_mask:0xf
    v_mfma_f32_16x16x32_bf16 a[20:23], a[204:207], v[192:195], a[20:23]
    ds_read_b128 a[156:159], v4 offset:36864
    v_min_u32_dpp v20, v20, v20 row_shr:8 row_mask:0xf bank_mask:0xf
    s_nop 1
    v_min_u32_dpp v20, v20, v20 row_bcast:15 row_mask:0xa bank_mask:0xf
    v_mfma_f32_16x16x32_bf16 a[24:27], a[200:203], v[196:199], 0
    v_exp_f32 v130, v130
    v_min_u32_dpp v20, v20, v20 row_bcast:31 row_mask:0xc bank_mask:0xf
    s_nop 0
    v_readlane_b32 s50, v20, 63
    v_mfma_f32_16x16x32_bf16 a[24:27], a[204:207], v[200:203], a[24:27]
    s_sub_u32 s50, s42, s50
    v_cvt_pk_bf16_f32 v236, v128, v129
    v_mfma_f32_16x16x32_bf16 a[28:31], a[200:203], v[204:207], 0
    s_sub_u32 s42, s50, 1
    v_exp_f32 v131, v131
    v_sub_u32 v20, s42, v28
    v_mfma_f32_16x16x32_bf16 a[28:31], a[204:207], v[208:211], a[28:31]
    buffer_load_dwordx4 v16, s[8:11], s28 offen offset:3072 lds
    v_sub_u32 v21, s42, v29
    v_sub_u32 v22, s42, v30
    v_smfmac_f32_16x16x64_bf16 a[224:227], v[244:247], v[180:187], v248
    s_waitcnt lgkmcnt(6)
    v_mfma_f32_16x16x32_bf16 v[124:127], a[128:131], v[68:71], v[108:111]
    v_exp_f32 v132, v132
    v_min3_u32 v20, v20, v21, v22
    v_mfma_f32_16x16x32_bf16 v[124:127], a[132:135], v[72:75], v[124:127]
    ds_read_b64_tr_b16 a[192:193], v9 offset:8192
    v_cvt_pk_bf16_f32 v237, v130, v131
    v_sub_u32 v21, s42, v31
    v_sub_u32 v22, s42, v32
    v_mfma_f32_16x16x32_bf16 v[124:127], a[136:139], v[76:79], v[124:127]
    v_exp_f32 v133, v133
    v_min3_u32 v20, v20, v21, v22
    v_mfma_f32_16x16x32_bf16 v[124:127], a[140:143], v[80:83], v[124:127]
    ds_read_b64_tr_b16 a[194:195], v9 offset:12288
    ds_read_b64_tr_b16 a[248:249], v25 offset:64
    ds_read_b64_tr_b16 a[250:251], v25 offset:2624
    v_sub_u32 v21, s42, v33
    v_sub_u32 v22, s42, v34
    v_mfma_f32_16x16x32_bf16 v[128:131], a[128:131], v[84:87], v[112:115]
    v_exp_f32 v134, v134
    v_min3_u32 v20, v20, v21, v22
    v_sub_u32 v21, s42, v35
    v_mfma_f32_16x16x32_bf16 v[128:131], a[132:135], v[88:91], v[128:131]
    ds_read_b128 a[160:163], v1 offset:40960
    v_cvt_pk_bf16_f32 v214, v132, v133
    v_min_u32 v20, v20, v21
    v_mfma_f32_16x16x32_bf16 v[128:131], a[136:139], v[92:95], v[128:131]
    v_exp_f32 v135, v135
    v_min_u32_dpp v20, v20, v20 row_shr:1 row_mask:0xf bank_mask:0xf
    s_nop 1
    v_min_u32_dpp v20, v20, v20 row_shr:2 row_mask:0xf bank_mask:0xf
    v_mfma_f32_16x16x32_bf16 v[128:131], a[140:143], v[96:99], v[128:131]
    ds_read_b64_tr_b16 a[196:197], v9 offset:32768
    ds_read_b64_tr_b16 a[252:253], v25 offset:96
    ds_read_b64_tr_b16 a[254:255], v25 offset:2656
    v_min_u32_dpp v20, v20, v20 row_shr:4 row_mask:0xf bank_mask:0xf
    s_nop 1
    v_min_u32_dpp v20, v20, v20 row_shr:8 row_mask:0xf bank_mask:0xf
    v_mfma_f32_16x16x32_bf16 a[32:35], a[208:211], v[180:183], 0
    v_exp_f32 v136, v136
    v_min_u32_dpp v20, v20, v20 row_bcast:15 row_mask:0xa bank_mask:0xf
    v_mfma_f32_16x16x32_bf16 a[32:35], a[212:215], v[184:187], a[32:35]
    ds_read_b64_tr_b16 a[198:199], v9 offset:36864
    v_cvt_pk_bf16_f32 v215, v134, v135
    v_min_u32_dpp v20, v20, v20 row_bcast:31 row_mask:0xc bank_mask:0xf
    s_nop 0
    v_readlane_b32 s51, v20, 63
    v_mfma_f32_16x16x32_bf16 a[36:39], a[208:211], v[188:191], 0
    s_sub_u32 s51, s42, s51
    v_exp_f32 v137, v137
    v_mfma_f32_16x16x32_bf16 a[36:39], a[212:215], v[192:195], a[36:39]
    s_sub_u32 s42, s51, 1
    ds_read_b128 a[164:167], v2 offset:40960
    v_cvt_pk_bf16_f32 v222, v136, v137
    v_sub_u32 v20, s42, v28
    v_mfma_f32_16x16x32_bf16 a[40:43], a[208:211], v[196:199], 0
    s_add_u32 s28, s28, 16384
    s_mov_b32 m0, s32
    v_exp_f32 v138, v138
    v_sub_u32 v21, s42, v29
    v_sub_u32 v22, s42, v30
    v_mfma_f32_16x16x32_bf16 a[40:43], a[212:215], v[200:203], a[40:43]
    buffer_load_dwordx4 v17, s[12:15], s29 offen offset:0 lds
    v_min3_u32 v20, v20, v21, v22
    v_mfma_f32_16x16x32_bf16 a[44:47], a[208:211], v[204:207], 0
    v_exp_f32 v139, v139
    v_sub_u32 v21, s42, v31
    v_sub_u32 v22, s42, v32
    v_mfma_f32_16x16x32_bf16 a[44:47], a[212:215], v[208:211], a[44:47]
    s_waitcnt lgkmcnt(6)
    v_min3_u32 v20, v20, v21, v22
    v_sub_u32 v21, s42, v33
    v_mfma_f32_16x16x32_bf16 v[132:135], a[144:147], v[36:39], v[100:103]
    v_exp_f32 v140, v140
    v_sub_u32 v22, s42, v34
    v_mfma_f32_16x16x32_bf16 v[132:135], a[148:151], v[40:43], v[132:135]
    ds_read_b64_tr_b16 a[200:201], v10 offset:8192
    v_cvt_pk_bf16_f32 v223, v138, v139
    v_min3_u32 v20, v20, v21, v22
    v_sub_u32 v21, s42, v35
    v_mfma_f32_16x16x32_bf16 v[132:135], a[152:155], v[44:47], v[132:135]
    v_exp_f32 v141, v141
    v_min_u32 v20, v20, v21
    v_mfma_f32_16x16x32_bf16 v[132:135], a[156:159], v[48:51], v[132:135]
    ds_read_b64_tr_b16 a[202:203], v10 offset:12288
    ds_read_b64_tr_b16 v[252:253], v25 offset:128
    ds_read_b64_tr_b16 v[254:255], v25 offset:2688
    v_min_u32_dpp v20, v20, v20 row_shr:1 row_mask:0xf bank_mask:0xf
    s_nop 1
    v_min_u32_dpp v20, v20, v20 row_shr:2 row_mask:0xf bank_mask:0xf
    v_mfma_f32_16x16x32_bf16 v[136:139], a[144:147], v[52:55], v[104:107]
    v_exp_f32 v142, v142
    v_min_u32_dpp v20, v20, v20 row_shr:4 row_mask:0xf bank_mask:0xf
    s_nop 1
    v_min_u32_dpp v20, v20, v20 row_shr:8 row_mask:0xf bank_mask:0xf
    v_mfma_f32_16x16x32_bf16 v[136:139], a[148:151], v[56:59], v[136:139]
    ds_read_b128 a[168:171], v3 offset:40960
    v_cvt_pk_bf16_f32 v230, v140, v141
    v_min_u32_dpp v20, v20, v20 row_bcast:15 row_mask:0xa bank_mask:0xf
    v_mfma_f32_16x16x32_bf16 v[136:139], a[152:155], v[60:63], v[136:139]
    v_exp_f32 v143, v143
    v_min_u32_dpp v20, v20, v20 row_bcast:31 row_mask:0xc bank_mask:0xf
    s_nop 0
    v_readlane_b32 s52, v20, 63
    v_mfma_f32_16x16x32_bf16 v[136:139], a[156:159], v[64:67], v[136:139]
    s_sub_u32 s52, s42, s52
    ds_read_b64_tr_b16 a[204:205], v10 offset:32768
    s_sub_u32 s42, s52, 1
    v_mfma_f32_16x16x32_bf16 a[48:51], a[216:219], v[180:183], 0
    v_exp_f32 v144, v144
    v_sub_u32 v20, s42, v28
    v_mfma_f32_16x16x32_bf16 a[48:51], a[220:223], v[184:187], a[48:51]
    ds_read_b64_tr_b16 a[206:207], v10 offset:36864
    v_cvt_pk_bf16_f32 v231, v142, v143
    v_sub_u32 v21, s42, v29
    v_sub_u32 v22, s42, v30
    v_mfma_f32_16x16x32_bf16 a[52:55], a[216:219], v[188:191], 0
    v_exp_f32 v145, v145
    v_min3_u32 v20, v20, v21, v22
    v_mfma_f32_16x16x32_bf16 a[52:55], a[220:223], v[192:195], a[52:55]
    ds_read_b128 a[172:175], v4 offset:40960
    v_sub_u32 v21, s42, v31
    v_sub_u32 v22, s42, v32
    v_mfma_f32_16x16x32_bf16 a[56:59], a[216:219], v[196:199], 0
    v_exp_f32 v146, v146
    v_min3_u32 v20, v20, v21, v22
    v_sub_u32 v21, s42, v33
    v_mfma_f32_16x16x32_bf16 a[56:59], a[220:223], v[200:203], a[56:59]
    v_cvt_pk_bf16_f32 v238, v144, v145
    v_sub_u32 v22, s42, v34
    v_mfma_f32_16x16x32_bf16 a[60:63], a[216:219], v[204:207], 0
    v_exp_f32 v147, v147
    v_min3_u32 v20, v20, v21, v22
    v_sub_u32 v21, s42, v35
    v_mfma_f32_16x16x32_bf16 a[60:63], a[220:223], v[208:211], a[60:63]
    buffer_load_dwordx4 v18, s[12:15], s29 offen offset:1024 lds
    v_min_u32 v20, v20, v21
    s_nop 1
    v_min_u32_dpp v20, v20, v20 row_shr:1 row_mask:0xf bank_mask:0xf
    v_smfmac_f32_16x16x64_bf16 a[228:231], v[244:247], v[188:195], v248
    s_waitcnt lgkmcnt(6)
    v_mfma_f32_16x16x32_bf16 v[140:143], a[144:147], v[68:71], v[108:111]
    v_exp_f32 v148, v148
    v_min_u32_dpp v20, v20, v20 row_shr:2 row_mask:0xf bank_mask:0xf
    v_mfma_f32_16x16x32_bf16 v[140:143], a[148:151], v[72:75], v[140:143]
    ds_read_b64_tr_b16 a[208:209], v11 offset:8192
    v_cvt_pk_bf16_f32 v239, v146, v147
    v_min_u32_dpp v20, v20, v20 row_shr:4 row_mask:0xf bank_mask:0xf
    s_nop 1
    v_min_u32_dpp v20, v20, v20 row_shr:8 row_mask:0xf bank_mask:0xf
    v_mfma_f32_16x16x32_bf16 v[140:143], a[152:155], v[76:79], v[140:143]
    v_exp_f32 v149, v149
    v_min_u32_dpp v20, v20, v20 row_bcast:15 row_mask:0xa bank_mask:0xf
    v_mfma_f32_16x16x32_bf16 v[140:143], a[156:159], v[80:83], v[140:143]
    ds_read_b64_tr_b16 a[210:211], v11 offset:12288
    v_min_u32_dpp v20, v20, v20 row_bcast:31 row_mask:0xc bank_mask:0xf
    s_nop 0
    v_readlane_b32 s53, v20, 63
    v_mfma_f32_16x16x32_bf16 v[144:147], a[144:147], v[84:87], v[112:115]
    s_sub_u32 s53, s42, s53
    v_exp_f32 v150, v150
    s_sub_u32 s42, s53, 1
    v_mfma_f32_16x16x32_bf16 v[144:147], a[148:151], v[88:91], v[144:147]
    ds_read_b128 a[176:179], v1 offset:45056
    v_cvt_pk_bf16_f32 v216, v148, v149
    v_sub_u32 v20, s42, v28
    v_mfma_f32_16x16x32_bf16 v[144:147], a[152:155], v[92:95], v[144:147]
    v_exp_f32 v151, v151
    v_sub_u32 v21, s42, v29
    v_sub_u32 v22, s42, v30
    v_mfma_f32_16x16x32_bf16 v[144:147], a[156:159], v[96:99], v[144:147]
    ds_read_b64_tr_b16 a[212:213], v11 offset:32768
    v_min3_u32 v20, v20, v21, v22
    v_sub_u32 v21, s42, v31
    v_mfma_f32_16x16x32_bf16 a[64:67], a[192:195], v[180:183], 0
    v_exp_f32 v152, v152
    v_sub_u32 v22, s42, v32
    v_mfma_f32_16x16x32_bf16 a[64:67], a[196:199], v[184:187], a[64:67]
    ds_read_b64_tr_b16 a[214:215], v11 offset:36864
    v_cvt_pk_bf16_f32 v217, v150, v151
    v_min3_u32 v20, v20, v21, v22
    v_sub_u32 v21, s42, v33
    v_mfma_f32_16x16x32_bf16 a[68:71], a[192:195], v[188:191], 0
    v_exp_f32 v153, v153
    v_sub_u32 v22, s42, v34
    v_mfma_f32_16x16x32_bf16 a[68:71], a[196:199], v[192:195], a[68:71]
    ds_read_b128 a[180:183], v2 offset:45056
    v_cvt_pk_bf16_f32 v224, v152, v153
    v_min3_u32 v20, v20, v21, v22
    v_sub_u32 v21, s42, v35
    v_mfma_f32_16x16x32_bf16 a[72:75], a[192:195], v[196:199], 0
    v_exp_f32 v154, v154
    v_min_u32 v20, v20, v21
    s_nop 1
    v_min_u32_dpp v20, v20, v20 row_shr:1 row_mask:0xf bank_mask:0xf
    v_mfma_f32_16x16x32_bf16 a[72:75], a[196:199], v[200:203], a[72:75]
    buffer_load_dwordx4 v17, s[12:15], s29 offen offset:2048 lds
    v_min_u32_dpp v20, v20, v20 row_shr:2 row_mask:0xf bank_mask:0xf
    v_mfma_f32_16x16x32_bf16 a[76:79], a[192:195], v[204:207], 0
    v_exp_f32 v155, v155
    v_min_u32_dpp v20, v20, v20 row_shr:4 row_mask:0xf bank_mask:0xf
    s_nop 1
    v_min_u32_dpp v20, v20, v20 row_shr:8 row_mask:0xf bank_mask:0xf
    v_mfma_f32_16x16x32_bf16 a[76:79], a[196:199], v[208:211], a[76:79]
    s_waitcnt lgkmcnt(6)
    v_min_u32_dpp v20, v20, v20 row_bcast:15 row_mask:0xa bank_mask:0xf
    s_nop 1
    v_min_u32_dpp v20, v20, v20 row_bcast:31 row_mask:0xc bank_mask:0xf
    v_mfma_f32_16x16x32_bf16 v[148:151], a[160:163], v[36:39], v[100:103]
    v_exp_f32 v156, v156
    v_readlane_b32 s54, v20, 63
    v_mfma_f32_16x16x32_bf16 v[148:151], a[164:167], v[40:43], v[148:151]
    s_sub_u32 s54, s42, s54
    ds_read_b64_tr_b16 a[216:217], v12 offset:8192
    v_cvt_pk_bf16_f32 v225, v154, v155
    s_sub_u32 s42, s54, 1
    v_mfma_f32_16x16x32_bf16 v[148:151], a[168:171], v[44:47], v[148:151]
    v_exp_f32 v157, v157
    v_sub_u32 v20, s42, v28
    v_mfma_f32_16x16x32_bf16 v[148:151], a[172:175], v[48:51], v[148:151]
    ds_read_b64_tr_b16 a[218:219], v12 offset:12288
    buffer_store_dwordx4 a[240:243], v26, s[76:79], 0 offen offset:0 sc1
    v_sub_u32 v21, s42, v29
    v_sub_u32 v22, s42, v30
    v_mfma_f32_16x16x32_bf16 v[152:155], a[160:163], v[52:55], v[104:107]
    v_exp_f32 v158, v158
    v_min3_u32 v20, v20, v21, v22
    v_sub_u32 v21, s42, v31
    v_mfma_f32_16x16x32_bf16 v[152:155], a[164:167], v[56:59], v[152:155]
    ds_read_b128 a[184:187], v3 offset:45056
    v_cvt_pk_bf16_f32 v232, v156, v157
    v_sub_u32 v22, s42, v32
    v_mfma_f32_16x16x32_bf16 v[152:155], a[168:171], v[60:63], v[152:155]
    v_exp_f32 v159, v159
    v_min3_u32 v20, v20, v21, v22
    v_sub_u32 v21, s42, v33
    v_mfma_f32_16x16x32_bf16 v[152:155], a[172:175], v[64:67], v[152:155]
    ds_read_b64_tr_b16 a[220:221], v12 offset:32768
    buffer_store_dwordx4 a[244:247], v26, s[76:79], 0 offen offset:1024 sc1
    v_sub_u32 v22, s42, v34
    v_min3_u32 v20, v20, v21, v22
    v_mfma_f32_16x16x32_bf16 a[80:83], a[200:203], v[180:183], 0
    v_exp_f32 v160, v160
    v_sub_u32 v21, s42, v35
    v_mfma_f32_16x16x32_bf16 a[80:83], a[204:207], v[184:187], a[80:83]
    ds_read_b64_tr_b16 a[222:223], v12 offset:36864
    v_cvt_pk_bf16_f32 v233, v158, v159
    v_min_u32 v20, v20, v21
    s_nop 1
    v_min_u32_dpp v20, v20, v20 row_shr:1 row_mask:0xf bank_mask:0xf
    v_mfma_f32_16x16x32_bf16 a[84:87], a[200:203], v[188:191], 0
    v_exp_f32 v161, v161
    v_min_u32_dpp v20, v20, v20 row_shr:2 row_mask:0xf bank_mask:0xf
    v_mfma_f32_16x16x32_bf16 a[84:87], a[204:207], v[192:195], a[84:87]
    ds_read_b128 a[188:191], v4 offset:45056
    v_min_u32_dpp v20, v20, v20 row_shr:4 row_mask:0xf bank_mask:0xf
    s_nop 1
    v_min_u32_dpp v20, v20, v20 row_shr:8 row_mask:0xf bank_mask:0xf
    v_mfma_f32_16x16x32_bf16 a[88:91], a[200:203], v[196:199], 0
    v_exp_f32 v162, v162
    v_min_u32_dpp v20, v20, v20 row_bcast:15 row_mask:0xa bank_mask:0xf
    s_nop 1
    v_min_u32_dpp v20, v20, v20 row_bcast:31 row_mask:0xc bank_mask:0xf
    v_mfma_f32_16x16x32_bf16 a[88:91], a[204:207], v[200:203], a[88:91]
    v_cvt_pk_bf16_f32 v240, v160, v161
    v_readlane_b32 s55, v20, 63
    v_mfma_f32_16x16x32_bf16 a[92:95], a[200:203], v[204:207], 0
    s_sub_u32 s55, s42, s55
    v_exp_f32 v163, v163
    s_sub_u32 s42, s55, 1
    v_mfma_f32_16x16x32_bf16 a[92:95], a[204:207], v[208:211], a[92:95]
    buffer_load_dwordx4 v18, s[12:15], s29 offen offset:3072 lds
    v_sub_u32 v20, s42, v28
    v_sub_u32 v21, s42, v29
    v_smfmac_f32_16x16x64_bf16 a[232:235], v[244:247], v[196:203], v248
    s_waitcnt vmcnt(10) lgkmcnt(6)
    s_barrier
    s_add_u32 s29, s29, 16384
    v_mfma_f32_16x16x32_bf16 v[156:159], a[160:163], v[68:71], v[108:111]
    v_exp_f32 v164, v164
    v_sub_u32 v22, s42, v30
    v_mfma_f32_16x16x32_bf16 v[156:159], a[164:167], v[72:75], v[156:159]
    ds_read_b64_tr_b16 a[192:193], v5 offset:16384
    v_cvt_pk_bf16_f32 v241, v162, v163
    v_min3_u32 v20, v20, v21, v22
    v_sub_u32 v21, s42, v31
    v_mfma_f32_16x16x32_bf16 v[156:159], a[168:171], v[76:79], v[156:159]
    v_exp_f32 v165, v165
    v_sub_u32 v22, s42, v32
    v_mfma_f32_16x16x32_bf16 v[156:159], a[172:175], v[80:83], v[156:159]
    ds_read_b64_tr_b16 a[194:195], v5 offset:20480
    buffer_store_dwordx4 a[248:251], v26, s[76:79], 0 offen offset:2048 sc1
    v_min3_u32 v20, v20, v21, v22
    v_sub_u32 v21, s42, v33
    v_mfma_f32_16x16x32_bf16 v[160:163], a[160:163], v[84:87], v[112:115]
    v_exp_f32 v166, v166
    v_sub_u32 v22, s42, v34
    v_min3_u32 v20, v20, v21, v22
    v_mfma_f32_16x16x32_bf16 v[160:163], a[164:167], v[88:91], v[160:163]
    ds_read_b128 a[128:131], v1 offset:0
    v_cvt_pk_bf16_f32 v218, v164, v165
    v_sub_u32 v21, s42, v35
    v_mfma_f32_16x16x32_bf16 v[160:163], a[168:171], v[92:95], v[160:163]
    v_exp_f32 v167, v167
    v_min_u32 v20, v20, v21
    s_nop 1
    v_min_u32_dpp v20, v20, v20 row_shr:1 row_mask:0xf bank_mask:0xf
    v_mfma_f32_16x16x32_bf16 v[160:163], a[172:175], v[96:99], v[160:163]
    ds_read_b64_tr_b16 a[196:197], v5 offset:40960
    buffer_store_dwordx4 a[252:255], v26, s[76:79], 0 offen offset:3072 sc1
    buffer_store_dwordx4 v[252:255], v26, s[76:79], s45 offen offset:0 sc1
    v_min_u32_dpp v20, v20, v20 row_shr:2 row_mask:0xf bank_mask:0xf
    s_nop 1
    v_min_u32_dpp v20, v20, v20 row_shr:4 row_mask:0xf bank_mask:0xf
    v_mfma_f32_16x16x32_bf16 a[96:99], a[208:211], v[180:183], 0
    v_exp_f32 v168, v168
    v_min_u32_dpp v20, v20, v20 row_shr:8 row_mask:0xf bank_mask:0xf
    v_mfma_f32_16x16x32_bf16 a[96:99], a[212:215], v[184:187], a[96:99]
    ds_read_b64_tr_b16 a[198:199], v5 offset:45056
    v_cvt_pk_bf16_f32 v219, v166, v167
    v_min_u32_dpp v20, v20, v20 row_bcast:15 row_mask:0xa bank_mask:0xf
    s_nop 1
    v_min_u32_dpp v20, v20, v20 row_bcast:31 row_mask:0xc bank_mask:0xf
    v_mfma_f32_16x16x32_bf16 a[100:103], a[208:211], v[188:191], 0
    v_exp_f32 v169, v169
    v_readlane_b32 s56, v20, 63
    v_mfma_f32_16x16x32_bf16 a[100:103], a[212:215], v[192:195], a[100:103]
    s_sub_u32 s56, s42, s56
    ds_read_b128 a[132:135], v2 offset:0
    v_cvt_pk_bf16_f32 v226, v168, v169
    s_sub_u32 s42, s56, 1
    v_mfma_f32_16x16x32_bf16 a[104:107], a[208:211], v[196:199], 0
    s_add_u32 m0, s34, 16384
    v_exp_f32 v170, v170
    v_sub_u32 v20, s42, v28
    v_sub_u32 v21, s42, v29
    v_mfma_f32_16x16x32_bf16 a[104:107], a[212:215], v[200:203], a[104:107]
    buffer_load_dwordx4 v13, s[8:11], s28 offen offset:0 lds
    v_sub_u32 v22, s42, v30
    v_mfma_f32_16x16x32_bf16 a[108:111], a[208:211], v[204:207], 0
    v_exp_f32 v171, v171
    v_min3_u32 v20, v20, v21, v22
    v_sub_u32 v21, s42, v31
    v_mfma_f32_16x16x32_bf16 a[108:111], a[212:215], v[208:211], a[108:111]
    s_waitcnt lgkmcnt(6)
    v_sub_u32 v22, s42, v32
    v_min3_u32 v20, v20, v21, v22
    v_mfma_f32_16x16x32_bf16 v[164:167], a[176:179], v[36:39], v[100:103]
    v_exp_f32 v172, v172
    v_sub_u32 v21, s42, v33
    v_mfma_f32_16x16x32_bf16 v[164:167], a[180:183], v[40:43], v[164:167]
    ds_read_b64_tr_b16 a[200:201], v6 offset:16384
    v_cvt_pk_bf16_f32 v227, v170, v171
    v_sub_u32 v22, s42, v34
    v_min3_u32 v20, v20, v21, v22
    v_mfma_f32_16x16x32_bf16 v[164:167], a[184:187], v[44:47], v[164:167]
    v_exp_f32 v173, v173
    v_sub_u32 v21, s42, v35
    v_mfma_f32_16x16x32_bf16 v[164:167], a[188:191], v[48:51], v[164:167]
    ds_read_b64_tr_b16 a[202:203], v6 offset:20480
    v_min_u32 v20, v20, v21
    s_nop 1
    v_min_u32_dpp v20, v20, v20 row_shr:1 row_mask:0xf bank_mask:0xf
    v_mfma_f32_16x16x32_bf16 v[168:171], a[176:179], v[52:55], v[104:107]
    v_exp_f32 v174, v174
    v_min_u32_dpp v20, v20, v20 row_shr:2 row_mask:0xf bank_mask:0xf
    s_nop 1
    v_min_u32_dpp v20, v20, v20 row_shr:4 row_mask:0xf bank_mask:0xf
    v_mfma_f32_16x16x32_bf16 v[168:171], a[180:183], v[56:59], v[168:171]
    ds_read_b128 a[136:139], v3 offset:0
    v_cvt_pk_bf16_f32 v234, v172, v173
    v_min_u32_dpp v20, v20, v20 row_shr:8 row_mask:0xf bank_mask:0xf
    v_mfma_f32_16x16x32_bf16 v[168:171], a[184:187], v[60:63], v[168:171]
    v_exp_f32 v175, v175
    v_min_u32_dpp v20, v20, v20 row_bcast:15 row_mask:0xa bank_mask:0xf
    s_nop 1
    v_min_u32_dpp v20, v20, v20 row_bcast:31 row_mask:0xc bank_mask:0xf
    v_mfma_f32_16x16x32_bf16 v[168:171], a[188:191], v[64:67], v[168:171]
    ds_read_b64_tr_b16 a[204:205], v6 offset:40960
    v_readlane_b32 s57, v20, 63
    s_sub_u32 s57, s42, s57
    v_mfma_f32_16x16x32_bf16 a[112:115], a[216:219], v[180:183], 0
    s_sub_u32 s42, s57, 1
    v_exp_f32 v176, v176
    v_mfma_f32_16x16x32_bf16 a[112:115], a[220:223], v[184:187], a[112:115]
    ds_read_b64_tr_b16 a[206:207], v6 offset:45056
    v_cvt_pk_bf16_f32 v235, v174, v175
    v_mov_b32 v20, s50
    v_writelane_b32 v20, s51, 1
    v_mfma_f32_16x16x32_bf16 a[116:119], a[216:219], v[188:191], 0
    v_exp_f32 v177, v177
    v_writelane_b32 v20, s52, 2
    v_mfma_f32_16x16x32_bf16 a[116:119], a[220:223], v[192:195], a[116:119]
    ds_read_b128 a[140:143], v4 offset:0
    v_writelane_b32 v20, s53, 3
    v_writelane_b32 v20, s54, 4
    v_mfma_f32_16x16x32_bf16 a[120:123], a[216:219], v[196:199], 0
    v_exp_f32 v178, v178
    v_writelane_b32 v20, s55, 5
    v_writelane_b32 v20, s56, 6
    v_mfma_f32_16x16x32_bf16 a[120:123], a[220:223], v[200:203], a[120:123]
    v_cvt_pk_bf16_f32 v242, v176, v177
    v_writelane_b32 v20, s57, 7
    v_mfma_f32_16x16x32_bf16 a[124:127], a[216:219], v[204:207], 0
    s_lshl_b32 s42, s5, 8
    v_exp_f32 v179, v179
    s_add_u32 s42, s42, 86016
    v_mfma_f32_16x16x32_bf16 a[124:127], a[220:223], v[208:211], a[124:127]
    buffer_load_dwordx4 v14, s[8:11], s28 offen offset:1024 lds
    v_lshl_add_u32 v21, v19, 2, s42
    ds_write_b32 v21, v20
    v_smfmac_f32_16x16x64_bf16 a[236:239], v[244:247], v[204:211], v248
    s_waitcnt lgkmcnt(6)
    s_mov_b32 s35, 6
.p2align 6
L_attn_loop:
    v_mfma_f32_16x16x32_bf16 v[172:175], a[176:179], v[68:71], v[108:111]
    v_exp_f32 v116, v116
    v_mfma_f32_16x16x32_bf16 v[172:175], a[180:183], v[72:75], v[172:175]
    ds_read_b64_tr_b16 a[208:209], v7 offset:16384
    v_cvt_pk_bf16_f32 v243, v178, v179
    v_mfma_f32_16x16x32_bf16 v[172:175], a[184:187], v[76:79], v[172:175]
    v_exp_f32 v117, v117
    v_mfma_f32_16x16x32_bf16 v[172:175], a[188:191], v[80:83], v[172:175]
    ds_read_b64_tr_b16 a[210:211], v7 offset:20480
    v_mfma_f32_16x16x32_bf16 v[176:179], a[176:179], v[84:87], v[112:115]
    v_exp_f32 v118, v118
    v_mfma_f32_16x16x32_bf16 v[176:179], a[180:183], v[88:91], v[176:179]
    ds_read_b128 a[144:147], v1 offset:4096
    v_cvt_pk_bf16_f32 v180, v116, v117
    v_mfma_f32_16x16x32_bf16 v[176:179], a[184:187], v[92:95], v[176:179]
    v_exp_f32 v119, v119
    v_mfma_f32_16x16x32_bf16 v[176:179], a[188:191], v[96:99], v[176:179]
    ds_read_b64_tr_b16 a[212:213], v7 offset:40960
    v_mfma_f32_16x16x32_bf16 a[0:3], a[192:195], v[212:215], a[0:3]
    v_exp_f32 v120, v120
    v_mfma_f32_16x16x32_bf16 a[0:3], a[196:199], v[216:219], a[0:3]
    ds_read_b64_tr_b16 a[214:215], v7 offset:45056
    v_cvt_pk_bf16_f32 v181, v118, v119
    v_mfma_f32_16x16x32_bf16 a[4:7], a[192:195], v[220:223], a[4:7]
    v_exp_f32 v121, v121
    v_mfma_f32_16x16x32_bf16 a[4:7], a[196:199], v[224:227], a[4:7]
    ds_read_b128 a[148:151], v2 offset:4096
    v_cvt_pk_bf16_f32 v188, v120, v121
    v_mfma_f32_16x16x32_bf16 a[8:11], a[192:195], v[228:231], a[8:11]
    v_exp_f32 v122, v122
    v_mfma_f32_16x16x32_bf16 a[8:11], a[196:199], v[232:235], a[8:11]
    buffer_load_dwordx4 v15, s[8:11], s28 offen offset:2048 lds
    v_mfma_f32_16x16x32_bf16 a[12:15], a[192:195], v[236:239], a[12:15]
    v_exp_f32 v123, v123
    v_mfma_f32_16x16x32_bf16 a[12:15], a[196:199], v[240:243], a[12:15]
    s_waitcnt lgkmcnt(6)
    v_mfma_f32_16x16x32_bf16 v[116:119], a[128:131], v[36:39], v[100:103]
    v_exp_f32 v124, v124
    v_mfma_f32_16x16x32_bf16 v[116:119], a[132:135], v[40:43], v[116:119]
    ds_read_b64_tr_b16 a[216:217], v8 offset:16384
    v_cvt_pk_bf16_f32 v189, v122, v123
    v_mfma_f32_16x16x32_bf16 v[116:119], a[136:139], v[44:47], v[116:119]
    v_exp_f32 v125, v125
    v_mfma_f32_16x16x32_bf16 v[116:119], a[140:143], v[48:51], v[116:119]
    ds_read_b64_tr_b16 a[218:219], v8 offset:20480
    v_mfma_f32_16x16x32_bf16 v[120:123], a[128:131], v[52:55], v[104:107]
    v_exp_f32 v126, v126
    v_mfma_f32_16x16x32_bf16 v[120:123], a[132:135], v[56:59], v[120:123]
    ds_read_b128 a[152:155], v3 offset:4096
    v_cvt_pk_bf16_f32 v196, v124, v125
    v_mfma_f32_16x16x32_bf16 v[120:123], a[136:139], v[60:63], v[120:123]
    v_exp_f32 v127, v127
    v_mfma_f32_16x16x32_bf16 v[120:123], a[140:143], v[64:67], v[120:123]
    ds_read_b64_tr_b16 a[220:221], v8 offset:40960
    v_mfma_f32_16x16x32_bf16 a[16:19], a[200:203], v[212:215], a[16:19]
    v_exp_f32 v128, v128
    v_mfma_f32_16x16x32_bf16 a[16:19], a[204:207], v[216:219], a[16:19]
    ds_read_b64_tr_b16 a[222:223], v8 offset:45056
    v_cvt_pk_bf16_f32 v197, v126, v127
    v_mfma_f32_16x16x32_bf16 a[20:23], a[200:203], v[220:223], a[20:23]
    v_exp_f32 v129, v129
    v_mfma_f32_16x16x32_bf16 a[20:23], a[204:207], v[224:227], a[20:23]
    ds_read_b128 a[156:159], v4 offset:4096
    v_mfma_f32_16x16x32_bf16 a[24:27], a[200:203], v[228:231], a[24:27]
    v_exp_f32 v130, v130
    v_mfma_f32_16x16x32_bf16 a[24:27], a[204:207], v[232:235], a[24:27]
    v_cvt_pk_bf16_f32 v204, v128, v129
    v_mfma_f32_16x16x32_bf16 a[28:31], a[200:203], v[236:239], a[28:31]
    v_exp_f32 v131, v131
    v_mfma_f32_16x16x32_bf16 a[28:31], a[204:207], v[240:243], a[28:31]
    buffer_load_dwordx4 v16, s[8:11], s28 offen offset:3072 lds
    v_smfmac_f32_16x16x64_bf16 a[224:227], v[244:247], v[212:219], v248
    s_waitcnt lgkmcnt(6)
    v_mfma_f32_16x16x32_bf16 v[124:127], a[128:131], v[68:71], v[108:111]
    v_exp_f32 v132, v132
    v_mfma_f32_16x16x32_bf16 v[124:127], a[132:135], v[72:75], v[124:127]
    ds_read_b64_tr_b16 a[192:193], v9 offset:16384
    v_cvt_pk_bf16_f32 v205, v130, v131
    v_mfma_f32_16x16x32_bf16 v[124:127], a[136:139], v[76:79], v[124:127]
    v_exp_f32 v133, v133
    v_mfma_f32_16x16x32_bf16 v[124:127], a[140:143], v[80:83], v[124:127]
    ds_read_b64_tr_b16 a[194:195], v9 offset:20480
    s_cmp_eq_u32 s36, 0
    s_cbranch_scc1 L_site0
L_site_back0:
    v_mfma_f32_16x16x32_bf16 v[128:131], a[128:131], v[84:87], v[112:115]
    v_exp_f32 v134, v134
    v_mfma_f32_16x16x32_bf16 v[128:131], a[132:135], v[88:91], v[128:131]
    ds_read_b128 a[160:163], v1 offset:8192
    v_cvt_pk_bf16_f32 v182, v132, v133
    v_mfma_f32_16x16x32_bf16 v[128:131], a[136:139], v[92:95], v[128:131]
    v_exp_f32 v135, v135
    v_mfma_f32_16x16x32_bf16 v[128:131], a[140:143], v[96:99], v[128:131]
    ds_read_b64_tr_b16 a[196:197], v9 offset:40960
    v_mfma_f32_16x16x32_bf16 a[32:35], a[208:211], v[212:215], a[32:35]
    v_exp_f32 v136, v136
    v_mfma_f32_16x16x32_bf16 a[32:35], a[212:215], v[216:219], a[32:35]
    ds_read_b64_tr_b16 a[198:199], v9 offset:45056
    v_cvt_pk_bf16_f32 v183, v134, v135
    v_mfma_f32_16x16x32_bf16 a[36:39], a[208:211], v[220:223], a[36:39]
    v_exp_f32 v137, v137
    v_mfma_f32_16x16x32_bf16 a[36:39], a[212:215], v[224:227], a[36:39]
    ds_read_b128 a[164:167], v2 offset:8192
    v_cvt_pk_bf16_f32 v190, v136, v137
    v_mfma_f32_16x16x32_bf16 a[40:43], a[208:211], v[228:231], a[40:43]
    s_add_u32 s28, s28, 16384
    s_mov_b32 m0, s33
    v_exp_f32 v138, v138
    v_mfma_f32_16x16x32_bf16 a[40:43], a[212:215], v[232:235], a[40:43]
    buffer_load_dwordx4 v17, s[12:15], s29 offen offset:0 lds
    v_mfma_f32_16x16x32_bf16 a[44:47], a[208:211], v[236:239], a[44:47]
    v_exp_f32 v139, v139
    v_mfma_f32_16x16x32_bf16 a[44:47], a[212:215], v[240:243], a[44:47]
    s_waitcnt lgkmcnt(6)
    v_mfma_f32_16x16x32_bf16 v[132:135], a[144:147], v[36:39], v[100:103]
    v_exp_f32 v140, v140
    v_mfma_f32_16x16x32_bf16 v[132:135], a[148:151], v[40:43], v[132:135]
    ds_read_b64_tr_b16 a[200:201], v10 offset:16384
    v_cvt_pk_bf16_f32 v191, v138, v139
    v_mfma_f32_16x16x32_bf16 v[132:135], a[152:155], v[44:47], v[132:135]
    v_exp_f32 v141, v141
    v_mfma_f32_16x16x32_bf16 v[132:135], a[156:159], v[48:51], v[132:135]
    ds_read_b64_tr_b16 a[202:203], v10 offset:20480
    v_mfma_f32_16x16x32_bf16 v[136:139], a[144:147], v[52:55], v[104:107]
    v_exp_f32 v142, v142
    v_mfma_f32_16x16x32_bf16 v[136:139], a[148:151], v[56:59], v[136:139]
    ds_read_b128 a[168:171], v3 offset:8192
    v_cvt_pk_bf16_f32 v198, v140, v141
    v_mfma_f32_16x16x32_bf16 v[136:139], a[152:155], v[60:63], v[136:139]
    v_exp_f32 v143, v143
    v_mfma_f32_16x16x32_bf16 v[136:139], a[156:159], v[64:67], v[136:139]
    ds_read_b64_tr_b16 a[204:205], v10 offset:40960
    v_mfma_f32_16x16x32_bf16 a[48:51], a[216:219], v[212:215], a[48:51]
    v_exp_f32 v144, v144
    v_mfma_f32_16x16x32_bf16 a[48:51], a[220:223], v[216:219], a[48:51]
    ds_read_b64_tr_b16 a[206:207], v10 offset:45056
    v_cvt_pk_bf16_f32 v199, v142, v143
    v_mfma_f32_16x16x32_bf16 a[52:55], a[216:219], v[220:223], a[52:55]
    v_exp_f32 v145, v145
    v_mfma_f32_16x16x32_bf16 a[52:55], a[220:223], v[224:227], a[52:55]
    ds_read_b128 a[172:175], v4 offset:8192
    v_mfma_f32_16x16x32_bf16 a[56:59], a[216:219], v[228:231], a[56:59]
    v_exp_f32 v146, v146
    v_mfma_f32_16x16x32_bf16 a[56:59], a[220:223], v[232:235], a[56:59]
    v_cvt_pk_bf16_f32 v206, v144, v145
    v_mfma_f32_16x16x32_bf16 a[60:63], a[216:219], v[236:239], a[60:63]
    v_exp_f32 v147, v147
    v_mfma_f32_16x16x32_bf16 a[60:63], a[220:223], v[240:243], a[60:63]
    buffer_load_dwordx4 v18, s[12:15], s29 offen offset:1024 lds
    v_smfmac_f32_16x16x64_bf16 a[228:231], v[244:247], v[220:227], v248
    s_waitcnt lgkmcnt(6)
    v_mfma_f32_16x16x32_bf16 v[140:143], a[144:147], v[68:71], v[108:111]
    v_exp_f32 v148, v148
    v_mfma_f32_16x16x32_bf16 v[140:143], a[148:151], v[72:75], v[140:143]
    ds_read_b64_tr_b16 a[208:209], v11 offset:16384
    v_cvt_pk_bf16_f32 v207, v146, v147
    v_mfma_f32_16x16x32_bf16 v[140:143], a[152:155], v[76:79], v[140:143]
    v_exp_f32 v149, v149
    v_mfma_f32_16x16x32_bf16 v[140:143], a[156:159], v[80:83], v[140:143]
    ds_read_b64_tr_b16 a[210:211], v11 offset:20480
    v_mfma_f32_16x16x32_bf16 v[144:147], a[144:147], v[84:87], v[112:115]
    v_exp_f32 v150, v150
    v_mfma_f32_16x16x32_bf16 v[144:147], a[148:151], v[88:91], v[144:147]
    ds_read_b128 a[176:179], v1 offset:12288
    v_cvt_pk_bf16_f32 v184, v148, v149
    v_mfma_f32_16x16x32_bf16 v[144:147], a[152:155], v[92:95], v[144:147]
    v_exp_f32 v151, v151
    v_mfma_f32_16x16x32_bf16 v[144:147], a[156:159], v[96:99], v[144:147]
    ds_read_b64_tr_b16 a[212:213], v11 offset:40960
    v_mfma_f32_16x16x32_bf16 a[64:67], a[192:195], v[212:215], a[64:67]
    v_exp_f32 v152, v152
    v_mfma_f32_16x16x32_bf16 a[64:67], a[196:199], v[216:219], a[64:67]
    ds_read_b64_tr_b16 a[214:215], v11 offset:45056
    v_cvt_pk_bf16_f32 v185, v150, v151
    v_mfma_f32_16x16x32_bf16 a[68:71], a[192:195], v[220:223], a[68:71]
    v_exp_f32 v153, v153
    v_mfma_f32_16x16x32_bf16 a[68:71], a[196:199], v[224:227], a[68:71]
    ds_read_b128 a[180:183], v2 offset:12288
    v_cvt_pk_bf16_f32 v192, v152, v153
    v_mfma_f32_16x16x32_bf16 a[72:75], a[192:195], v[228:231], a[72:75]
    v_exp_f32 v154, v154
    v_mfma_f32_16x16x32_bf16 a[72:75], a[196:199], v[232:235], a[72:75]
    buffer_load_dwordx4 v17, s[12:15], s29 offen offset:2048 lds
    v_mfma_f32_16x16x32_bf16 a[76:79], a[192:195], v[236:239], a[76:79]
    v_exp_f32 v155, v155
    v_mfma_f32_16x16x32_bf16 a[76:79], a[196:199], v[240:243], a[76:79]
    s_waitcnt lgkmcnt(6)
    v_mfma_f32_16x16x32_bf16 v[148:151], a[160:163], v[36:39], v[100:103]
    v_exp_f32 v156, v156
    v_mfma_f32_16x16x32_bf16 v[148:151], a[164:167], v[40:43], v[148:151]
    ds_read_b64_tr_b16 a[216:217], v12 offset:16384
    v_cvt_pk_bf16_f32 v193, v154, v155
    v_mfma_f32_16x16x32_bf16 v[148:151], a[168:171], v[44:47], v[148:151]
    v_exp_f32 v157, v157
    v_mfma_f32_16x16x32_bf16 v[148:151], a[172:175], v[48:51], v[148:151]
    ds_read_b64_tr_b16 a[218:219], v12 offset:20480
    v_mfma_f32_16x16x32_bf16 v[152:155], a[160:163], v[52:55], v[104:107]
    v_exp_f32 v158, v158
    v_mfma_f32_16x16x32_bf16 v[152:155], a[164:167], v[56:59], v[152:155]
    ds_read_b128 a[184:187], v3 offset:12288
    v_cvt_pk_bf16_f32 v200, v156, v157
    v_mfma_f32_16x16x32_bf16 v[152:155], a[168:171], v[60:63], v[152:155]
    v_exp_f32 v159, v159
    v_mfma_f32_16x16x32_bf16 v[152:155], a[172:175], v[64:67], v[152:155]
    ds_read_b64_tr_b16 a[220:221], v12 offset:40960
    v_mfma_f32_16x16x32_bf16 a[80:83], a[200:203], v[212:215], a[80:83]
    v_exp_f32 v160, v160
    v_mfma_f32_16x16x32_bf16 a[80:83], a[204:207], v[216:219], a[80:83]
    ds_read_b64_tr_b16 a[222:223], v12 offset:45056
    v_cvt_pk_bf16_f32 v201, v158, v159
    v_mfma_f32_16x16x32_bf16 a[84:87], a[200:203], v[220:223], a[84:87]
    v_exp_f32 v161, v161
    v_mfma_f32_16x16x32_bf16 a[84:87], a[204:207], v[224:227], a[84:87]
    ds_read_b128 a[188:191], v4 offset:12288
    v_mfma_f32_16x16x32_bf16 a[88:91], a[200:203], v[228:231], a[88:91]
    v_exp_f32 v162, v162
    v_mfma_f32_16x16x32_bf16 a[88:91], a[204:207], v[232:235], a[88:91]
    v_cvt_pk_bf16_f32 v208, v160, v161
    v_mfma_f32_16x16x32_bf16 a[92:95], a[200:203], v[236:239], a[92:95]
    v_exp_f32 v163, v163
    v_mfma_f32_16x16x32_bf16 a[92:95], a[204:207], v[240:243], a[92:95]
    buffer_load_dwordx4 v18, s[12:15], s29 offen offset:3072 lds
    v_smfmac_f32_16x16x64_bf16 a[232:235], v[244:247], v[228:235], v248
    s_waitcnt vmcnt(8) lgkmcnt(6)
    s_barrier
    s_add_u32 s29, s29, 16384
    v_mfma_f32_16x16x32_bf16 v[156:159], a[160:163], v[68:71], v[108:111]
    v_exp_f32 v164, v164
    v_mfma_f32_16x16x32_bf16 v[156:159], a[164:167], v[72:75], v[156:159]
    ds_read_b64_tr_b16 a[192:193], v5 offset:57344
    v_cvt_pk_bf16_f32 v209, v162, v163
    v_mfma_f32_16x16x32_bf16 v[156:159], a[168:171], v[76:79], v[156:159]
    v_exp_f32 v165, v165
    v_mfma_f32_16x16x32_bf16 v[156:159], a[172:175], v[80:83], v[156:159]
    ds_read_b64_tr_b16 a[194:195], v5 offset:61440
    v_mfma_f32_16x16x32_bf16 v[160:163], a[160:163], v[84:87], v[112:115]
    v_exp_f32 v166, v166
    v_mfma_f32_16x16x32_bf16 v[160:163], a[164:167], v[88:91], v[160:163]
    ds_read_b128 a[128:131], v1 offset:49152
    v_cvt_pk_bf16_f32 v186, v164, v165
    v_mfma_f32_16x16x32_bf16 v[160:163], a[168:171], v[92:95], v[160:163]
    v_exp_f32 v167, v167
    v_mfma_f32_16x16x32_bf16 v[160:163], a[172:175], v[96:99], v[160:163]
    ds_read_b64_tr_b16 a[196:197], v5 offset:0
    v_mfma_f32_16x16x32_bf16 a[96:99], a[208:211], v[212:215], a[96:99]
    v_exp_f32 v168, v168
    v_mfma_f32_16x16x32_bf16 a[96:99], a[212:215], v[216:219], a[96:99]
    ds_read_b64_tr_b16 a[198:199], v5 offset:4096
    v_cvt_pk_bf16_f32 v187, v166, v167
    v_mfma_f32_16x16x32_bf16 a[100:103], a[208:211], v[220:223], a[100:103]
    v_exp_f32 v169, v169
    v_mfma_f32_16x16x32_bf16 a[100:103], a[212:215], v[224:227], a[100:103]
    ds_read_b128 a[132:135], v2 offset:49152
    v_cvt_pk_bf16_f32 v194, v168, v169
    v_mfma_f32_16x16x32_bf16 a[104:107], a[208:211], v[228:231], a[104:107]
    s_add_u32 m0, s34, 32768
    v_exp_f32 v170, v170
    v_mfma_f32_16x16x32_bf16 a[104:107], a[212:215], v[232:235], a[104:107]
    buffer_load_dwordx4 v13, s[8:11], s28 offen offset:0 lds
    v_mfma_f32_16x16x32_bf16 a[108:111], a[208:211], v[236:239], a[108:111]
    v_exp_f32 v171, v171
    v_mfma_f32_16x16x32_bf16 a[108:111], a[212:215], v[240:243], a[108:111]
    s_waitcnt lgkmcnt(6)
    v_mfma_f32_16x16x32_bf16 v[164:167], a[176:179], v[36:39], v[100:103]
    v_exp_f32 v172, v172
    v_mfma_f32_16x16x32_bf16 v[164:167], a[180:183], v[40:43], v[164:167]
    ds_read_b64_tr_b16 a[200:201], v6 offset:57344
    v_cvt_pk_bf16_f32 v195, v170, v171
    v_mfma_f32_16x16x32_bf16 v[164:167], a[184:187], v[44:47], v[164:167]
    v_exp_f32 v173, v173
    v_mfma_f32_16x16x32_bf16 v[164:167], a[188:191], v[48:51], v[164:167]
    ds_read_b64_tr_b16 a[202:203], v6 offset:61440
    v_mfma_f32_16x16x32_bf16 v[168:171], a[176:179], v[52:55], v[104:107]
    v_exp_f32 v174, v174
    v_mfma_f32_16x16x32_bf16 v[168:171], a[180:183], v[56:59], v[168:171]
    ds_read_b128 a[136:139], v3 offset:49152
    v_cvt_pk_bf16_f32 v202, v172, v173
    v_mfma_f32_16x16x32_bf16 v[168:171], a[184:187], v[60:63], v[168:171]
    v_exp_f32 v175, v175
    v_mfma_f32_16x16x32_bf16 v[168:171], a[188:191], v[64:67], v[168:171]
    ds_read_b64_tr_b16 a[204:205], v6 offset:0
    v_mfma_f32_16x16x32_bf16 a[112:115], a[216:219], v[212:215], a[112:115]
    v_exp_f32 v176, v176
    v_mfma_f32_16x16x32_bf16 a[112:115], a[220:223], v[216:219], a[112:115]
    ds_read_b64_tr_b16 a[206:207], v6 offset:4096
    v_cvt_pk_bf16_f32 v203, v174, v175
    v_mfma_f32_16x16x32_bf16 a[116:119], a[216:219], v[220:223], a[116:119]
    v_exp_f32 v177, v177
    v_mfma_f32_16x16x32_bf16 a[116:119], a[220:223], v[224:227], a[116:119]
    ds_read_b128 a[140:143], v4 offset:49152
    v_mfma_f32_16x16x32_bf16 a[120:123], a[216:219], v[228:231], a[120:123]
    v_exp_f32 v178, v178
    v_mfma_f32_16x16x32_bf16 a[120:123], a[220:223], v[232:235], a[120:123]
    v_cvt_pk_bf16_f32 v210, v176, v177
    v_mfma_f32_16x16x32_bf16 a[124:127], a[216:219], v[236:239], a[124:127]
    v_exp_f32 v179, v179
    v_mfma_f32_16x16x32_bf16 a[124:127], a[220:223], v[240:243], a[124:127]
    buffer_load_dwordx4 v14, s[8:11], s28 offen offset:1024 lds
    v_smfmac_f32_16x16x64_bf16 a[236:239], v[244:247], v[236:243], v248
    s_waitcnt lgkmcnt(6)
    v_mfma_f32_16x16x32_bf16 v[172:175], a[176:179], v[68:71], v[108:111]
    v_exp_f32 v116, v116
    v_mfma_f32_16x16x32_bf16 v[172:175], a[180:183], v[72:75], v[172:175]
    ds_read_b64_tr_b16 a[208:209], v7 offset:57344
    v_cvt_pk_bf16_f32 v211, v178, v179
    v_mfma_f32_16x16x32_bf16 v[172:175], a[184:187], v[76:79], v[172:175]
    v_exp_f32 v117, v117
    v_mfma_f32_16x16x32_bf16 v[172:175], a[188:191], v[80:83], v[172:175]
    ds_read_b64_tr_b16 a[210:211], v7 offset:61440
    v_mfma_f32_16x16x32_bf16 v[176:179], a[176:179], v[84:87], v[112:115]
    v_exp_f32 v118, v118
    v_mfma_f32_16x16x32_bf16 v[176:179], a[180:183], v[88:91], v[176:179]
    ds_read_b128 a[144:147], v1 offset:53248
    v_cvt_pk_bf16_f32 v212, v116, v117
    v_mfma_f32_16x16x32_bf16 v[176:179], a[184:187], v[92:95], v[176:179]
    v_exp_f32 v119, v119
    v_mfma_f32_16x16x32_bf16 v[176:179], a[188:191], v[96:99], v[176:179]
    ds_read_b64_tr_b16 a[212:213], v7 offset:0
    v_mfma_f32_16x16x32_bf16 a[0:3], a[192:195], v[180:183], a[0:3]
    v_exp_f32 v120, v120
    v_mfma_f32_16x16x32_bf16 a[0:3], a[196:199], v[184:187], a[0:3]
    ds_read_b64_tr_b16 a[214:215], v7 offset:4096
    v_cvt_pk_bf16_f32 v213, v118, v119
    v_mfma_f32_16x16x32_bf16 a[4:7], a[192:195], v[188:191], a[4:7]
    v_exp_f32 v121, v121
    v_mfma_f32_16x16x32_bf16 a[4:7], a[196:199], v[192:195], a[4:7]
    ds_read_b128 a[148:151], v2 offset:53248
    v_cvt_pk_bf16_f32 v220, v120, v121
    v_mfma_f32_16x16x32_bf16 a[8:11], a[192:195], v[196:199], a[8:11]
    v_exp_f32 v122, v122
    v_mfma_f32_16x16x32_bf16 a[8:11], a[196:199], v[200:203], a[8:11]
    buffer_load_dwordx4 v15, s[8:11], s28 offen offset:2048 lds
    v_mfma_f32_16x16x32_bf16 a[12:15], a[192:195], v[204:207], a[12:15]
    v_exp_f32 v123, v123
    v_mfma_f32_16x16x32_bf16 a[12:15], a[196:199], v[208:211], a[12:15]
    s_waitcnt lgkmcnt(6)
    v_mfma_f32_16x16x32_bf16 v[116:119], a[128:131], v[36:39], v[100:103]
    v_exp_f32 v124, v124
    v_mfma_f32_16x16x32_bf16 v[116:119], a[132:135], v[40:43], v[116:119]
    ds_read_b64_tr_b16 a[216:217], v8 offset:57344
    v_cvt_pk_bf16_f32 v221, v122, v123
    v_mfma_f32_16x16x32_bf16 v[116:119], a[136:139], v[44:47], v[116:119]
    v_exp_f32 v125, v125
    v_mfma_f32_16x16x32_bf16 v[116:119], a[140:143], v[48:51], v[116:119]
    ds_read_b64_tr_b16 a[218:219], v8 offset:61440
    v_mfma_f32_16x16x32_bf16 v[120:123], a[128:131], v[52:55], v[104:107]
    v_exp_f32 v126, v126
    v_mfma_f32_16x16x32_bf16 v[120:123], a[132:135], v[56:59], v[120:123]
    ds_read_b128 a[152:155], v3 offset:53248
    v_cvt_pk_bf16_f32 v228, v124, v125
    v_mfma_f32_16x16x32_bf16 v[120:123], a[136:139], v[60:63], v[120:123]
    v_exp_f32 v127, v127
    v_mfma_f32_16x16x32_bf16 v[120:123], a[140:143], v[64:67], v[120:123]
    ds_read_b64_tr_b16 a[220:221], v8 offset:0
    v_mfma_f32_16x16x32_bf16 a[16:19], a[200:203], v[180:183], a[16:19]
    v_exp_f32 v128, v128
    v_mfma_f32_16x16x32_bf16 a[16:19], a[204:207], v[184:187], a[16:19]
    ds_read_b64_tr_b16 a[222:223], v8 offset:4096
    v_cvt_pk_bf16_f32 v229, v126, v127
    v_mfma_f32_16x16x32_bf16 a[20:23], a[200:203], v[188:191], a[20:23]
    v_exp_f32 v129, v129
    v_mfma_f32_16x16x32_bf16 a[20:23], a[204:207], v[192:195], a[20:23]
    ds_read_b128 a[156:159], v4 offset:53248
    v_mfma_f32_16x16x32_bf16 a[24:27], a[200:203], v[196:199], a[24:27]
    v_exp_f32 v130, v130
    v_mfma_f32_16x16x32_bf16 a[24:27], a[204:207], v[200:203], a[24:27]
    v_cvt_pk_bf16_f32 v236, v128, v129
    v_mfma_f32_16x16x32_bf16 a[28:31], a[200:203], v[204:207], a[28:31]
    v_exp_f32 v131, v131
    v_mfma_f32_16x16x32_bf16 a[28:31], a[204:207], v[208:211], a[28:31]
    buffer_load_dwordx4 v16, s[8:11], s28 offen offset:3072 lds
    v_smfmac_f32_16x16x64_bf16 a[224:227], v[244:247], v[180:187], v248
    s_waitcnt lgkmcnt(6)
    v_mfma_f32_16x16x32_bf16 v[124:127], a[128:131], v[68:71], v[108:111]
    v_exp_f32 v132, v132
    v_mfma_f32_16x16x32_bf16 v[124:127], a[132:135], v[72:75], v[124:127]
    ds_read_b64_tr_b16 a[192:193], v9 offset:57344
    v_cvt_pk_bf16_f32 v237, v130, v131
    v_mfma_f32_16x16x32_bf16 v[124:127], a[136:139], v[76:79], v[124:127]
    v_exp_f32 v133, v133
    v_mfma_f32_16x16x32_bf16 v[124:127], a[140:143], v[80:83], v[124:127]
    ds_read_b64_tr_b16 a[194:195], v9 offset:61440
    s_cmp_eq_u32 s36, 1
    s_cbranch_scc1 L_site1
L_site_back1:
    v_mfma_f32_16x16x32_bf16 v[128:131], a[128:131], v[84:87], v[112:115]
    v_exp_f32 v134, v134
    v_mfma_f32_16x16x32_bf16 v[128:131], a[132:135], v[88:91], v[128:131]
    ds_read_b128 a[160:163], v1 offset:57344
    v_cvt_pk_bf16_f32 v214, v132, v133
    v_mfma_f32_16x16x32_bf16 v[128:131], a[136:139], v[92:95], v[128:131]
    v_exp_f32 v135, v135
    v_mfma_f32_16x16x32_bf16 v[128:131], a[140:143], v[96:99], v[128:131]
    ds_read_b64_tr_b16 a[196:197], v9 offset:0
    v_mfma_f32_16x16x32_bf16 a[32:35], a[208:211], v[180:183], a[32:35]
    v_exp_f32 v136, v136
    v_mfma_f32_16x16x32_bf16 a[32:35], a[212:215], v[184:187], a[32:35]
    ds_read_b64_tr_b16 a[198:199], v9 offset:4096
    v_cvt_pk_bf16_f32 v215, v134, v135
    v_mfma_f32_16x16x32_bf16 a[36:39], a[208:211], v[188:191], a[36:39]
    v_exp_f32 v137, v137
    v_mfma_f32_16x16x32_bf16 a[36:39], a[212:215], v[192:195], a[36:39]
    ds_read_b128 a[164:167], v2 offset:57344
    v_cvt_pk_bf16_f32 v222, v136, v137
    v_mfma_f32_16x16x32_bf16 a[40:43], a[208:211], v[196:199], a[40:43]
    s_add_u32 s28, s28, 16384
    s_mov_b32 m0, s30
    v_exp_f32 v138, v138
    v_mfma_f32_16x16x32_bf16 a[40:43], a[212:215], v[200:203], a[40:43]
    buffer_load_dwordx4 v17, s[12:15], s29 offen offset:0 lds
    v_mfma_f32_16x16x32_bf16 a[44:47], a[208:211], v[204:207], a[44:47]
    v_exp_f32 v139, v139
    v_mfma_f32_16x16x32_bf16 a[44:47], a[212:215], v[208:211], a[44:47]
    s_waitcnt lgkmcnt(6)
    v_mfma_f32_16x16x32_bf16 v[132:135], a[144:147], v[36:39], v[100:103]
    v_exp_f32 v140, v140
    v_mfma_f32_16x16x32_bf16 v[132:135], a[148:151], v[40:43], v[132:135]
    ds_read_b64_tr_b16 a[200:201], v10 offset:57344
    v_cvt_pk_bf16_f32 v223, v138, v139
    v_mfma_f32_16x16x32_bf16 v[132:135], a[152:155], v[44:47], v[132:135]
    v_exp_f32 v141, v141
    v_mfma_f32_16x16x32_bf16 v[132:135], a[156:159], v[48:51], v[132:135]
    ds_read_b64_tr_b16 a[202:203], v10 offset:61440
    v_mfma_f32_16x16x32_bf16 v[136:139], a[144:147], v[52:55], v[104:107]
    v_exp_f32 v142, v142
    v_mfma_f32_16x16x32_bf16 v[136:139], a[148:151], v[56:59], v[136:139]
    ds_read_b128 a[168:171], v3 offset:57344
    v_cvt_pk_bf16_f32 v230, v140, v141
    v_mfma_f32_16x16x32_bf16 v[136:139], a[152:155], v[60:63], v[136:139]
    v_exp_f32 v143, v143
    v_mfma_f32_16x16x32_bf16 v[136:139], a[156:159], v[64:67], v[136:139]
    ds_read_b64_tr_b16 a[204:205], v10 offset:0
    v_mfma_f32_16x16x32_bf16 a[48:51], a[216:219], v[180:183], a[48:51]
    v_exp_f32 v144, v144
    v_mfma_f32_16x16x32_bf16 a[48:51], a[220:223], v[184:187], a[48:51]
    ds_read_b64_tr_b16 a[206:207], v10 offset:4096
    v_cvt_pk_bf16_f32 v231, v142, v143
    v_mfma_f32_16x16x32_bf16 a[52:55], a[216:219], v[188:191], a[52:55]
    v_exp_f32 v145, v145
    v_mfma_f32_16x16x32_bf16 a[52:55], a[220:223], v[192:195], a[52:55]
    ds_read_b128 a[172:175], v4 offset:57344
    v_mfma_f32_16x16x32_bf16 a[56:59], a[216:219], v[196:199], a[56:59]
    v_exp_f32 v146, v146
    v_mfma_f32_16x16x32_bf16 a[56:59], a[220:223], v[200:203], a[56:59]
    v_cvt_pk_bf16_f32 v238, v144, v145
    v_mfma_f32_16x16x32_bf16 a[60:63], a[216:219], v[204:207], a[60:63]
    v_exp_f32 v147, v147
    v_mfma_f32_16x16x32_bf16 a[60:63], a[220:223], v[208:211], a[60:63]
    buffer_load_dwordx4 v18, s[12:15], s29 offen offset:1024 lds
    v_smfmac_f32_16x16x64_bf16 a[228:231], v[244:247], v[188:195], v248
    s_waitcnt lgkmcnt(6)
    v_mfma_f32_16x16x32_bf16 v[140:143], a[144:147], v[68:71], v[108:111]
    v_exp_f32 v148, v148
    v_mfma_f32_16x16x32_bf16 v[140:143], a[148:151], v[72:75], v[140:143]
    ds_read_b64_tr_b16 a[208:209], v11 offset:57344
    v_cvt_pk_bf16_f32 v239, v146, v147
    v_mfma_f32_16x16x32_bf16 v[140:143], a[152:155], v[76:79], v[140:143]
    v_exp_f32 v149, v149
    v_mfma_f32_16x16x32_bf16 v[140:143], a[156:159], v[80:83], v[140:143]
    ds_read_b64_tr_b16 a[210:211], v11 offset:61440
    v_mfma_f32_16x16x32_bf16 v[144:147], a[144:147], v[84:87], v[112:115]
    v_exp_f32 v150, v150
    v_mfma_f32_16x16x32_bf16 v[144:147], a[148:151], v[88:91], v[144:147]
    ds_read_b128 a[176:179], v1 offset:61440
    v_cvt_pk_bf16_f32 v216, v148, v149
    v_mfma_f32_16x16x32_bf16 v[144:147], a[152:155], v[92:95], v[144:147]
    v_exp_f32 v151, v151
    v_mfma_f32_16x16x32_bf16 v[144:147], a[156:159], v[96:99], v[144:147]
    ds_read_b64_tr_b16 a[212:213], v11 offset:0
    v_mfma_f32_16x16x32_bf16 a[64:67], a[192:195], v[180:183], a[64:67]
    v_exp_f32 v152, v152
    v_mfma_f32_16x16x32_bf16 a[64:67], a[196:199], v[184:187], a[64:67]
    ds_read_b64_tr_b16 a[214:215], v11 offset:4096
    v_cvt_pk_bf16_f32 v217, v150, v151
    v_mfma_f32_16x16x32_bf16 a[68:71], a[192:195], v[188:191], a[68:71]
    v_exp_f32 v153, v153
    v_mfma_f32_16x16x32_bf16 a[68:71], a[196:199], v[192:195], a[68:71]
    ds_read_b128 a[180:183], v2 offset:61440
    v_cvt_pk_bf16_f32 v224, v152, v153
    v_mfma_f32_16x16x32_bf16 a[72:75], a[192:195], v[196:199], a[72:75]
    v_exp_f32 v154, v154
    v_mfma_f32_16x16x32_bf16 a[72:75], a[196:199], v[200:203], a[72:75]
    buffer_load_dwordx4 v17, s[12:15], s29 offen offset:2048 lds
    v_mfma_f32_16x16x32_bf16 a[76:79], a[192:195], v[204:207], a[76:79]
    v_exp_f32 v155, v155
    v_mfma_f32_16x16x32_bf16 a[76:79], a[196:199], v[208:211], a[76:79]
    s_waitcnt lgkmcnt(6)
    v_mfma_f32_16x16x32_bf16 v[148:151], a[160:163], v[36:39], v[100:103]
    v_exp_f32 v156, v156
    v_mfma_f32_16x16x32_bf16 v[148:151], a[164:167], v[40:43], v[148:151]
    ds_read_b64_tr_b16 a[216:217], v12 offset:57344
    v_cvt_pk_bf16_f32 v225, v154, v155
    v_mfma_f32_16x16x32_bf16 v[148:151], a[168:171], v[44:47], v[148:151]
    v_exp_f32 v157, v157
    v_mfma_f32_16x16x32_bf16 v[148:151], a[172:175], v[48:51], v[148:151]
    ds_read_b64_tr_b16 a[218:219], v12 offset:61440
    v_mfma_f32_16x16x32_bf16 v[152:155], a[160:163], v[52:55], v[104:107]
    v_exp_f32 v158, v158
    v_mfma_f32_16x16x32_bf16 v[152:155], a[164:167], v[56:59], v[152:155]
    ds_read_b128 a[184:187], v3 offset:61440
    v_cvt_pk_bf16_f32 v232, v156, v157
    v_mfma_f32_16x16x32_bf16 v[152:155], a[168:171], v[60:63], v[152:155]
    v_exp_f32 v159, v159
    v_mfma_f32_16x16x32_bf16 v[152:155], a[172:175], v[64:67], v[152:155]
    ds_read_b64_tr_b16 a[220:221], v12 offset:0
    v_mfma_f32_16x16x32_bf16 a[80:83], a[200:203], v[180:183], a[80:83]
    v_exp_f32 v160, v160
    v_mfma_f32_16x16x32_bf16 a[80:83], a[204:207], v[184:187], a[80:83]
    ds_read_b64_tr_b16 a[222:223], v12 offset:4096
    v_cvt_pk_bf16_f32 v233, v158, v159
    v_mfma_f32_16x16x32_bf16 a[84:87], a[200:203], v[188:191], a[84:87]
    v_exp_f32 v161, v161
    v_mfma_f32_16x16x32_bf16 a[84:87], a[204:207], v[192:195], a[84:87]
    ds_read_b128 a[188:191], v4 offset:61440
    v_mfma_f32_16x16x32_bf16 a[88:91], a[200:203], v[196:199], a[88:91]
    v_exp_f32 v162, v162
    v_mfma_f32_16x16x32_bf16 a[88:91], a[204:207], v[200:203], a[88:91]
    v_cvt_pk_bf16_f32 v240, v160, v161
    v_mfma_f32_16x16x32_bf16 a[92:95], a[200:203], v[204:207], a[92:95]
    v_exp_f32 v163, v163
    v_mfma_f32_16x16x32_bf16 a[92:95], a[204:207], v[208:211], a[92:95]
    buffer_load_dwordx4 v18, s[12:15], s29 offen offset:3072 lds
    v_smfmac_f32_16x16x64_bf16 a[232:235], v[244:247], v[196:203], v248
    s_waitcnt vmcnt(8) lgkmcnt(6)
    s_barrier
    s_add_u32 s29, s29, 16384
    v_mfma_f32_16x16x32_bf16 v[156:159], a[160:163], v[68:71], v[108:111]
    v_exp_f32 v164, v164
    v_mfma_f32_16x16x32_bf16 v[156:159], a[164:167], v[72:75], v[156:159]
    ds_read_b64_tr_b16 a[192:193], v5 offset:24576
    v_cvt_pk_bf16_f32 v241, v162, v163
    v_mfma_f32_16x16x32_bf16 v[156:159], a[168:171], v[76:79], v[156:159]
    v_exp_f32 v165, v165
    v_mfma_f32_16x16x32_bf16 v[156:159], a[172:175], v[80:83], v[156:159]
    ds_read_b64_tr_b16 a[194:195], v5 offset:28672
    v_mfma_f32_16x16x32_bf16 v[160:163], a[160:163], v[84:87], v[112:115]
    v_exp_f32 v166, v166
    v_mfma_f32_16x16x32_bf16 v[160:163], a[164:167], v[88:91], v[160:163]
    ds_read_b128 a[128:131], v1 offset:16384
    v_cvt_pk_bf16_f32 v218, v164, v165
    v_mfma_f32_16x16x32_bf16 v[160:163], a[168:171], v[92:95], v[160:163]
    v_exp_f32 v167, v167
    v_mfma_f32_16x16x32_bf16 v[160:163], a[172:175], v[96:99], v[160:163]
    ds_read_b64_tr_b16 a[196:197], v5 offset:49152
    v_mfma_f32_16x16x32_bf16 a[96:99], a[208:211], v[180:183], a[96:99]
    v_exp_f32 v168, v168
    v_mfma_f32_16x16x32_bf16 a[96:99], a[212:215], v[184:187], a[96:99]
    ds_read_b64_tr_b16 a[198:199], v5 offset:53248
    v_cvt_pk_bf16_f32 v219, v166, v167
    v_mfma_f32_16x16x32_bf16 a[100:103], a[208:211], v[188:191], a[100:103]
    v_exp_f32 v169, v169
    v_mfma_f32_16x16x32_bf16 a[100:103], a[212:215], v[192:195], a[100:103]
    ds_read_b128 a[132:135], v2 offset:16384
    v_cvt_pk_bf16_f32 v226, v168, v169
    v_mfma_f32_16x16x32_bf16 a[104:107], a[208:211], v[196:199], a[104:107]
    s_add_u32 m0, s34, 0
    v_exp_f32 v170, v170
    v_mfma_f32_16x16x32_bf16 a[104:107], a[212:215], v[200:203], a[104:107]
    buffer_load_dwordx4 v13, s[8:11], s28 offen offset:0 lds
    v_mfma_f32_16x16x32_bf16 a[108:111], a[208:211], v[204:207], a[108:111]
    v_exp_f32 v171, v171
    v_mfma_f32_16x16x32_bf16 a[108:111], a[212:215], v[208:211], a[108:111]
    s_waitcnt lgkmcnt(6)
    v_mfma_f32_16x16x32_bf16 v[164:167], a[176:179], v[36:39], v[100:103]
    v_exp_f32 v172, v172
    v_mfma_f32_16x16x32_bf16 v[164:167], a[180:183], v[40:43], v[164:167]
    ds_read_b64_tr_b16 a[200:201], v6 offset:24576
    v_cvt_pk_bf16_f32 v227, v170, v171
    v_mfma_f32_16x16x32_bf16 v[164:167], a[184:187], v[44:47], v[164:167]
    v_exp_f32 v173, v173
    v_mfma_f32_16x16x32_bf16 v[164:167], a[188:191], v[48:51], v[164:167]
    ds_read_b64_tr_b16 a[202:203], v6 offset:28672
    s_mov_b64 exec, 1
    buffer_store_dword v27, off, s[76:79], s75 sc1
    s_mov_b64 exec, -1
    v_mfma_f32_16x16x32_bf16 v[168:171], a[176:179], v[52:55], v[104:107]
    v_exp_f32 v174, v174
    v_mfma_f32_16x16x32_bf16 v[168:171], a[180:183], v[56:59], v[168:171]
    ds_read_b128 a[136:139], v3 offset:16384
    v_cvt_pk_bf16_f32 v234, v172, v173
    v_mfma_f32_16x16x32_bf16 v[168:171], a[184:187], v[60:63], v[168:171]
    v_exp_f32 v175, v175
    v_mfma_f32_16x16x32_bf16 v[168:171], a[188:191], v[64:67], v[168:171]
    ds_read_b64_tr_b16 a[204:205], v6 offset:49152
    v_mfma_f32_16x16x32_bf16 a[112:115], a[216:219], v[180:183], a[112:115]
    v_exp_f32 v176, v176
    v_mfma_f32_16x16x32_bf16 a[112:115], a[220:223], v[184:187], a[112:115]
    ds_read_b64_tr_b16 a[206:207], v6 offset:53248
    v_cvt_pk_bf16_f32 v235, v174, v175
    v_mfma_f32_16x16x32_bf16 a[116:119], a[216:219], v[188:191], a[116:119]
    v_exp_f32 v177, v177
    v_mfma_f32_16x16x32_bf16 a[116:119], a[220:223], v[192:195], a[116:119]
    ds_read_b128 a[140:143], v4 offset:16384
    v_mfma_f32_16x16x32_bf16 a[120:123], a[216:219], v[196:199], a[120:123]
    v_exp_f32 v178, v178
    v_mfma_f32_16x16x32_bf16 a[120:123], a[220:223], v[200:203], a[120:123]
    v_cvt_pk_bf16_f32 v242, v176, v177
    v_mfma_f32_16x16x32_bf16 a[124:127], a[216:219], v[204:207], a[124:127]
    v_exp_f32 v179, v179
    v_mfma_f32_16x16x32_bf16 a[124:127], a[220:223], v[208:211], a[124:127]
    buffer_load_dwordx4 v14, s[8:11], s28 offen offset:1024 lds
    v_smfmac_f32_16x16x64_bf16 a[236:239], v[244:247], v[204:211], v248
    s_waitcnt lgkmcnt(6)
    v_mfma_f32_16x16x32_bf16 v[172:175], a[176:179], v[68:71], v[108:111]
    v_exp_f32 v116, v116
    v_mfma_f32_16x16x32_bf16 v[172:175], a[180:183], v[72:75], v[172:175]
    ds_read_b64_tr_b16 a[208:209], v7 offset:24576
    v_cvt_pk_bf16_f32 v243, v178, v179
    v_mfma_f32_16x16x32_bf16 v[172:175], a[184:187], v[76:79], v[172:175]
    v_exp_f32 v117, v117
    v_mfma_f32_16x16x32_bf16 v[172:175], a[188:191], v[80:83], v[172:175]
    ds_read_b64_tr_b16 a[210:211], v7 offset:28672
    v_mfma_f32_16x16x32_bf16 v[176:179], a[176:179], v[84:87], v[112:115]
    v_exp_f32 v118, v118
    v_mfma_f32_16x16x32_bf16 v[176:179], a[180:183], v[88:91], v[176:179]
    ds_read_b128 a[144:147], v1 offset:20480
    v_cvt_pk_bf16_f32 v180, v116, v117
    v_mfma_f32_16x16x32_bf16 v[176:179], a[184:187], v[92:95], v[176:179]
    v_exp_f32 v119, v119
    v_mfma_f32_16x16x32_bf16 v[176:179], a[188:191], v[96:99], v[176:179]
    ds_read_b64_tr_b16 a[212:213], v7 offset:49152
    v_mfma_f32_16x16x32_bf16 a[0:3], a[192:195], v[212:215], a[0:3]
    v_exp_f32 v120, v120
    v_mfma_f32_16x16x32_bf16 a[0:3], a[196:199], v[216:219], a[0:3]
    ds_read_b64_tr_b16 a[214:215], v7 offset:53248
    v_cvt_pk_bf16_f32 v181, v118, v119
    v_mfma_f32_16x16x32_bf16 a[4:7], a[192:195], v[220:223], a[4:7]
    v_exp_f32 v121, v121
    v_mfma_f32_16x16x32_bf16 a[4:7], a[196:199], v[224:227], a[4:7]
    ds_read_b128 a[148:151], v2 offset:20480
    v_cvt_pk_bf16_f32 v188, v120, v121
    v_mfma_f32_16x16x32_bf16 a[8:11], a[192:195], v[228:231], a[8:11]
    v_exp_f32 v122, v122
    v_mfma_f32_16x16x32_bf16 a[8:11], a[196:199], v[232:235], a[8:11]
    buffer_load_dwordx4 v15, s[8:11], s28 offen offset:2048 lds
    v_mfma_f32_16x16x32_bf16 a[12:15], a[192:195], v[236:239], a[12:15]
    v_exp_f32 v123, v123
    v_mfma_f32_16x16x32_bf16 a[12:15], a[196:199], v[240:243], a[12:15]
    s_waitcnt lgkmcnt(6)
    v_mfma_f32_16x16x32_bf16 v[116:119], a[128:131], v[36:39], v[100:103]
    v_exp_f32 v124, v124
    v_mfma_f32_16x16x32_bf16 v[116:119], a[132:135], v[40:43], v[116:119]
    ds_read_b64_tr_b16 a[216:217], v8 offset:24576
    v_cvt_pk_bf16_f32 v189, v122, v123
    v_mfma_f32_16x16x32_bf16 v[116:119], a[136:139], v[44:47], v[116:119]
    v_exp_f32 v125, v125
    v_mfma_f32_16x16x32_bf16 v[116:119], a[140:143], v[48:51], v[116:119]
    ds_read_b64_tr_b16 a[218:219], v8 offset:28672
    v_mfma_f32_16x16x32_bf16 v[120:123], a[128:131], v[52:55], v[104:107]
    v_exp_f32 v126, v126
    v_mfma_f32_16x16x32_bf16 v[120:123], a[132:135], v[56:59], v[120:123]
    ds_read_b128 a[152:155], v3 offset:20480
    v_cvt_pk_bf16_f32 v196, v124, v125
    v_mfma_f32_16x16x32_bf16 v[120:123], a[136:139], v[60:63], v[120:123]
    v_exp_f32 v127, v127
    v_mfma_f32_16x16x32_bf16 v[120:123], a[140:143], v[64:67], v[120:123]
    ds_read_b64_tr_b16 a[220:221], v8 offset:49152
    v_mfma_f32_16x16x32_bf16 a[16:19], a[200:203], v[212:215], a[16:19]
    v_exp_f32 v128, v128
    v_mfma_f32_16x16x32_bf16 a[16:19], a[204:207], v[216:219], a[16:19]
    ds_read_b64_tr_b16 a[222:223], v8 offset:53248
    v_cvt_pk_bf16_f32 v197, v126, v127
    v_mfma_f32_16x16x32_bf16 a[20:23], a[200:203], v[220:223], a[20:23]
    v_exp_f32 v129, v129
    v_mfma_f32_16x16x32_bf16 a[20:23], a[204:207], v[224:227], a[20:23]
    ds_read_b128 a[156:159], v4 offset:20480
    v_mfma_f32_16x16x32_bf16 a[24:27], a[200:203], v[228:231], a[24:27]
    v_exp_f32 v130, v130
    v_mfma_f32_16x16x32_bf16 a[24:27], a[204:207], v[232:235], a[24:27]
    v_cvt_pk_bf16_f32 v204, v128, v129
    v_mfma_f32_16x16x32_bf16 a[28:31], a[200:203], v[236:239], a[28:31]
    v_exp_f32 v131, v131
    v_mfma_f32_16x16x32_bf16 a[28:31], a[204:207], v[240:243], a[28:31]
    buffer_load_dwordx4 v16, s[8:11], s28 offen offset:3072 lds
    v_smfmac_f32_16x16x64_bf16 a[224:227], v[244:247], v[212:219], v248
    s_waitcnt lgkmcnt(6)
    v_mfma_f32_16x16x32_bf16 v[124:127], a[128:131], v[68:71], v[108:111]
    v_exp_f32 v132, v132
    v_mfma_f32_16x16x32_bf16 v[124:127], a[132:135], v[72:75], v[124:127]
    ds_read_b64_tr_b16 a[192:193], v9 offset:24576
    v_cvt_pk_bf16_f32 v205, v130, v131
    v_mfma_f32_16x16x32_bf16 v[124:127], a[136:139], v[76:79], v[124:127]
    v_exp_f32 v133, v133
    v_mfma_f32_16x16x32_bf16 v[124:127], a[140:143], v[80:83], v[124:127]
    ds_read_b64_tr_b16 a[194:195], v9 offset:28672
    s_cmp_eq_u32 s36, 2
    s_cbranch_scc1 L_site2
L_site_back2:
    v_mfma_f32_16x16x32_bf16 v[128:131], a[128:131], v[84:87], v[112:115]
    v_exp_f32 v134, v134
    v_mfma_f32_16x16x32_bf16 v[128:131], a[132:135], v[88:91], v[128:131]
    ds_read_b128 a[160:163], v1 offset:24576
    v_cvt_pk_bf16_f32 v182, v132, v133
    v_mfma_f32_16x16x32_bf16 v[128:131], a[136:139], v[92:95], v[128:131]
    v_exp_f32 v135, v135
    v_mfma_f32_16x16x32_bf16 v[128:131], a[140:143], v[96:99], v[128:131]
    ds_read_b64_tr_b16 a[196:197], v9 offset:49152
    v_mfma_f32_16x16x32_bf16 a[32:35], a[208:211], v[212:215], a[32:35]
    v_exp_f32 v136, v136
    v_mfma_f32_16x16x32_bf16 a[32:35], a[212:215], v[216:219], a[32:35]
    ds_read_b64_tr_b16 a[198:199], v9 offset:53248
    v_cvt_pk_bf16_f32 v183, v134, v135
    v_mfma_f32_16x16x32_bf16 a[36:39], a[208:211], v[220:223], a[36:39]
    v_exp_f32 v137, v137
    v_mfma_f32_16x16x32_bf16 a[36:39], a[212:215], v[224:227], a[36:39]
    ds_read_b128 a[164:167], v2 offset:24576
    v_cvt_pk_bf16_f32 v190, v136, v137
    v_mfma_f32_16x16x32_bf16 a[40:43], a[208:211], v[228:231], a[40:43]
    s_add_u32 s28, s28, 16384
    s_mov_b32 m0, s31
    v_exp_f32 v138, v138
    v_mfma_f32_16x16x32_bf16 a[40:43], a[212:215], v[232:235], a[40:43]
    buffer_load_dwordx4 v17, s[12:15], s29 offen offset:0 lds
    v_mfma_f32_16x16x32_bf16 a[44:47], a[208:211], v[236:239], a[44:47]
    v_exp_f32 v139, v139
    v_mfma_f32_16x16x32_bf16 a[44:47], a[212:215], v[240:243], a[44:47]
    s_waitcnt lgkmcnt(6)
    v_mfma_f32_16x16x32_bf16 v[132:135], a[144:147], v[36:39], v[100:103]
    v_exp_f32 v140, v140
    v_mfma_f32_16x16x32_bf16 v[132:135], a[148:151], v[40:43], v[132:135]
    ds_read_b64_tr_b16 a[200:201], v10 offset:24576
    v_cvt_pk_bf16_f32 v191, v138, v139
    v_mfma_f32_16x16x32_bf16 v[132:135], a[152:155], v[44:47], v[132:135]
    v_exp_f32 v141, v141
    v_mfma_f32_16x16x32_bf16 v[132:135], a[156:159], v[48:51], v[132:135]
    ds_read_b64_tr_b16 a[202:203], v10 offset:28672
    v_mfma_f32_16x16x32_bf16 v[136:139], a[144:147], v[52:55], v[104:107]
    v_exp_f32 v142, v142
    v_mfma_f32_16x16x32_bf16 v[136:139], a[148:151], v[56:59], v[136:139]
    ds_read_b128 a[168:171], v3 offset:24576
    v_cvt_pk_bf16_f32 v198, v140, v141
    v_mfma_f32_16x16x32_bf16 v[136:139], a[152:155], v[60:63], v[136:139]
    v_exp_f32 v143, v143
    v_mfma_f32_16x16x32_bf16 v[136:139], a[156:159], v[64:67], v[136:139]
    ds_read_b64_tr_b16 a[204:205], v10 offset:49152
    v_mfma_f32_16x16x32_bf16 a[48:51], a[216:219], v[212:215], a[48:51]
    v_exp_f32 v144, v144
    v_mfma_f32_16x16x32_bf16 a[48:51], a[220:223], v[216:219], a[48:51]
    ds_read_b64_tr_b16 a[206:207], v10 offset:53248
    v_cvt_pk_bf16_f32 v199, v142, v143
    v_mfma_f32_16x16x32_bf16 a[52:55], a[216:219], v[220:223], a[52:55]
    v_exp_f32 v145, v145
    v_mfma_f32_16x16x32_bf16 a[52:55], a[220:223], v[224:227], a[52:55]
    ds_read_b128 a[172:175], v4 offset:24576
    v_mfma_f32_16x16x32_bf16 a[56:59], a[216:219], v[228:231], a[56:59]
    v_exp_f32 v146, v146
    v_mfma_f32_16x16x32_bf16 a[56:59], a[220:223], v[232:235], a[56:59]
    v_cvt_pk_bf16_f32 v206, v144, v145
    v_mfma_f32_16x16x32_bf16 a[60:63], a[216:219], v[236:239], a[60:63]
    v_exp_f32 v147, v147
    v_mfma_f32_16x16x32_bf16 a[60:63], a[220:223], v[240:243], a[60:63]
    buffer_load_dwordx4 v18, s[12:15], s29 offen offset:1024 lds
    v_smfmac_f32_16x16x64_bf16 a[228:231], v[244:247], v[220:227], v248
    s_waitcnt lgkmcnt(6)
    v_mfma_f32_16x16x32_bf16 v[140:143], a[144:147], v[68:71], v[108:111]
    v_exp_f32 v148, v148
    v_mfma_f32_16x16x32_bf16 v[140:143], a[148:151], v[72:75], v[140:143]
    ds_read_b64_tr_b16 a[208:209], v11 offset:24576
    v_cvt_pk_bf16_f32 v207, v146, v147
    v_mfma_f32_16x16x32_bf16 v[140:143], a[152:155], v[76:79], v[140:143]
    v_exp_f32 v149, v149
    v_mfma_f32_16x16x32_bf16 v[140:143], a[156:159], v[80:83], v[140:143]
    ds_read_b64_tr_b16 a[210:211], v11 offset:28672
    v_mfma_f32_16x16x32_bf16 v[144:147], a[144:147], v[84:87], v[112:115]
    v_exp_f32 v150, v150
    v_mfma_f32_16x16x32_bf16 v[144:147], a[148:151], v[88:91], v[144:147]
    ds_read_b128 a[176:179], v1 offset:28672
    v_cvt_pk_bf16_f32 v184, v148, v149
    v_mfma_f32_16x16x32_bf16 v[144:147], a[152:155], v[92:95], v[144:147]
    v_exp_f32 v151, v151
    v_mfma_f32_16x16x32_bf16 v[144:147], a[156:159], v[96:99], v[144:147]
    ds_read_b64_tr_b16 a[212:213], v11 offset:49152
    v_mfma_f32_16x16x32_bf16 a[64:67], a[192:195], v[212:215], a[64:67]
    v_exp_f32 v152, v152
    v_mfma_f32_16x16x32_bf16 a[64:67], a[196:199], v[216:219], a[64:67]
    ds_read_b64_tr_b16 a[214:215], v11 offset:53248
    v_cvt_pk_bf16_f32 v185, v150, v151
    v_mfma_f32_16x16x32_bf16 a[68:71], a[192:195], v[220:223], a[68:71]
    v_exp_f32 v153, v153
    v_mfma_f32_16x16x32_bf16 a[68:71], a[196:199], v[224:227], a[68:71]
    ds_read_b128 a[180:183], v2 offset:28672
    v_cvt_pk_bf16_f32 v192, v152, v153
    v_mfma_f32_16x16x32_bf16 a[72:75], a[192:195], v[228:231], a[72:75]
    v_exp_f32 v154, v154
    v_mfma_f32_16x16x32_bf16 a[72:75], a[196:199], v[232:235], a[72:75]
    buffer_load_dwordx4 v17, s[12:15], s29 offen offset:2048 lds
    v_mfma_f32_16x16x32_bf16 a[76:79], a[192:195], v[236:239], a[76:79]
    v_exp_f32 v155, v155
    v_mfma_f32_16x16x32_bf16 a[76:79], a[196:199], v[240:243], a[76:79]
    s_waitcnt lgkmcnt(6)
    v_mfma_f32_16x16x32_bf16 v[148:151], a[160:163], v[36:39], v[100:103]
    v_exp_f32 v156, v156
    v_mfma_f32_16x16x32_bf16 v[148:151], a[164:167], v[40:43], v[148:151]
    ds_read_b64_tr_b16 a[216:217], v12 offset:24576
    v_cvt_pk_bf16_f32 v193, v154, v155
    v_mfma_f32_16x16x32_bf16 v[148:151], a[168:171], v[44:47], v[148:151]
    v_exp_f32 v157, v157
    v_mfma_f32_16x16x32_bf16 v[148:151], a[172:175], v[48:51], v[148:151]
    ds_read_b64_tr_b16 a[218:219], v12 offset:28672
    v_mfma_f32_16x16x32_bf16 v[152:155], a[160:163], v[52:55], v[104:107]
    v_exp_f32 v158, v158
    v_mfma_f32_16x16x32_bf16 v[152:155], a[164:167], v[56:59], v[152:155]
    ds_read_b128 a[184:187], v3 offset:28672
    v_cvt_pk_bf16_f32 v200, v156, v157
    v_mfma_f32_16x16x32_bf16 v[152:155], a[168:171], v[60:63], v[152:155]
    v_exp_f32 v159, v159
    v_mfma_f32_16x16x32_bf16 v[152:155], a[172:175], v[64:67], v[152:155]
    ds_read_b64_tr_b16 a[220:221], v12 offset:49152
    v_mfma_f32_16x16x32_bf16 a[80:83], a[200:203], v[212:215], a[80:83]
    v_exp_f32 v160, v160
    v_mfma_f32_16x16x32_bf16 a[80:83], a[204:207], v[216:219], a[80:83]
    ds_read_b64_tr_b16 a[222:223], v12 offset:53248
    v_cvt_pk_bf16_f32 v201, v158, v159
    v_mfma_f32_16x16x32_bf16 a[84:87], a[200:203], v[220:223], a[84:87]
    v_exp_f32 v161, v161
    v_mfma_f32_16x16x32_bf16 a[84:87], a[204:207], v[224:227], a[84:87]
    ds_read_b128 a[188:191], v4 offset:28672
    v_mfma_f32_16x16x32_bf16 a[88:91], a[200:203], v[228:231], a[88:91]
    v_exp_f32 v162, v162
    v_mfma_f32_16x16x32_bf16 a[88:91], a[204:207], v[232:235], a[88:91]
    v_cvt_pk_bf16_f32 v208, v160, v161
    v_mfma_f32_16x16x32_bf16 a[92:95], a[200:203], v[236:239], a[92:95]
    v_exp_f32 v163, v163
    v_mfma_f32_16x16x32_bf16 a[92:95], a[204:207], v[240:243], a[92:95]
    buffer_load_dwordx4 v18, s[12:15], s29 offen offset:3072 lds
    v_smfmac_f32_16x16x64_bf16 a[232:235], v[244:247], v[228:235], v248
    s_waitcnt vmcnt(8) lgkmcnt(6)
    s_barrier
    s_add_u32 s29, s29, 16384
    v_mfma_f32_16x16x32_bf16 v[156:159], a[160:163], v[68:71], v[108:111]
    v_exp_f32 v164, v164
    v_mfma_f32_16x16x32_bf16 v[156:159], a[164:167], v[72:75], v[156:159]
    ds_read_b64_tr_b16 a[192:193], v5 offset:8192
    v_cvt_pk_bf16_f32 v209, v162, v163
    v_mfma_f32_16x16x32_bf16 v[156:159], a[168:171], v[76:79], v[156:159]
    v_exp_f32 v165, v165
    v_mfma_f32_16x16x32_bf16 v[156:159], a[172:175], v[80:83], v[156:159]
    ds_read_b64_tr_b16 a[194:195], v5 offset:12288
    v_mfma_f32_16x16x32_bf16 v[160:163], a[160:163], v[84:87], v[112:115]
    v_exp_f32 v166, v166
    v_mfma_f32_16x16x32_bf16 v[160:163], a[164:167], v[88:91], v[160:163]
    ds_read_b128 a[128:131], v1 offset:32768
    v_cvt_pk_bf16_f32 v186, v164, v165
    v_mfma_f32_16x16x32_bf16 v[160:163], a[168:171], v[92:95], v[160:163]
    v_exp_f32 v167, v167
    v_mfma_f32_16x16x32_bf16 v[160:163], a[172:175], v[96:99], v[160:163]
    ds_read_b64_tr_b16 a[196:197], v5 offset:32768
    v_mfma_f32_16x16x32_bf16 a[96:99], a[208:211], v[212:215], a[96:99]
    v_exp_f32 v168, v168
    v_mfma_f32_16x16x32_bf16 a[96:99], a[212:215], v[216:219], a[96:99]
    ds_read_b64_tr_b16 a[198:199], v5 offset:36864
    v_cvt_pk_bf16_f32 v187, v166, v167
    v_mfma_f32_16x16x32_bf16 a[100:103], a[208:211], v[220:223], a[100:103]
    v_exp_f32 v169, v169
    v_mfma_f32_16x16x32_bf16 a[100:103], a[212:215], v[224:227], a[100:103]
    ds_read_b128 a[132:135], v2 offset:32768
    v_cvt_pk_bf16_f32 v194, v168, v169
    v_mfma_f32_16x16x32_bf16 a[104:107], a[208:211], v[228:231], a[104:107]
    s_add_u32 m0, s34, 49152
    v_exp_f32 v170, v170
    v_mfma_f32_16x16x32_bf16 a[104:107], a[212:215], v[232:235], a[104:107]
    buffer_load_dwordx4 v13, s[8:11], s28 offen offset:0 lds
    v_mfma_f32_16x16x32_bf16 a[108:111], a[208:211], v[236:239], a[108:111]
    v_exp_f32 v171, v171
    v_mfma_f32_16x16x32_bf16 a[108:111], a[212:215], v[240:243], a[108:111]
    s_waitcnt lgkmcnt(6)
    v_mfma_f32_16x16x32_bf16 v[164:167], a[176:179], v[36:39], v[100:103]
    v_exp_f32 v172, v172
    v_mfma_f32_16x16x32_bf16 v[164:167], a[180:183], v[40:43], v[164:167]
    ds_read_b64_tr_b16 a[200:201], v6 offset:8192
    v_cvt_pk_bf16_f32 v195, v170, v171
    v_mfma_f32_16x16x32_bf16 v[164:167], a[184:187], v[44:47], v[164:167]
    v_exp_f32 v173, v173
    v_mfma_f32_16x16x32_bf16 v[164:167], a[188:191], v[48:51], v[164:167]
    ds_read_b64_tr_b16 a[202:203], v6 offset:12288
    v_mfma_f32_16x16x32_bf16 v[168:171], a[176:179], v[52:55], v[104:107]
    v_exp_f32 v174, v174
    v_mfma_f32_16x16x32_bf16 v[168:171], a[180:183], v[56:59], v[168:171]
    ds_read_b128 a[136:139], v3 offset:32768
    v_cvt_pk_bf16_f32 v202, v172, v173
    v_mfma_f32_16x16x32_bf16 v[168:171], a[184:187], v[60:63], v[168:171]
    v_exp_f32 v175, v175
    v_mfma_f32_16x16x32_bf16 v[168:171], a[188:191], v[64:67], v[168:171]
    ds_read_b64_tr_b16 a[204:205], v6 offset:32768
    v_mfma_f32_16x16x32_bf16 a[112:115], a[216:219], v[212:215], a[112:115]
    v_exp_f32 v176, v176
    v_mfma_f32_16x16x32_bf16 a[112:115], a[220:223], v[216:219], a[112:115]
    ds_read_b64_tr_b16 a[206:207], v6 offset:36864
    v_cvt_pk_bf16_f32 v203, v174, v175
    v_mfma_f32_16x16x32_bf16 a[116:119], a[216:219], v[220:223], a[116:119]
    v_exp_f32 v177, v177
    v_mfma_f32_16x16x32_bf16 a[116:119], a[220:223], v[224:227], a[116:119]
    ds_read_b128 a[140:143], v4 offset:32768
    v_mfma_f32_16x16x32_bf16 a[120:123], a[216:219], v[228:231], a[120:123]
    v_exp_f32 v178, v178
    v_mfma_f32_16x16x32_bf16 a[120:123], a[220:223], v[232:235], a[120:123]
    v_cvt_pk_bf16_f32 v210, v176, v177
    v_mfma_f32_16x16x32_bf16 a[124:127], a[216:219], v[236:239], a[124:127]
    v_exp_f32 v179, v179
    v_mfma_f32_16x16x32_bf16 a[124:127], a[220:223], v[240:243], a[124:127]
    buffer_load_dwordx4 v14, s[8:11], s28 offen offset:1024 lds
    v_smfmac_f32_16x16x64_bf16 a[236:239], v[244:247], v[236:243], v248
    s_waitcnt lgkmcnt(6)
    v_mfma_f32_16x16x32_bf16 v[172:175], a[176:179], v[68:71], v[108:111]
    v_exp_f32 v116, v116
    v_mfma_f32_16x16x32_bf16 v[172:175], a[180:183], v[72:75], v[172:175]
    ds_read_b64_tr_b16 a[208:209], v7 offset:8192
    v_cvt_pk_bf16_f32 v211, v178, v179
    v_mfma_f32_16x16x32_bf16 v[172:175], a[184:187], v[76:79], v[172:175]
    v_exp_f32 v117, v117
    v_mfma_f32_16x16x32_bf16 v[172:175], a[188:191], v[80:83], v[172:175]
    ds_read_b64_tr_b16 a[210:211], v7 offset:12288
    v_mfma_f32_16x16x32_bf16 v[176:179], a[176:179], v[84:87], v[112:115]
    v_exp_f32 v118, v118
    v_mfma_f32_16x16x32_bf16 v[176:179], a[180:183], v[88:91], v[176:179]
    ds_read_b128 a[144:147], v1 offset:36864
    v_cvt_pk_bf16_f32 v212, v116, v117
    v_mfma_f32_16x16x32_bf16 v[176:179], a[184:187], v[92:95], v[176:179]
    v_exp_f32 v119, v119
    v_mfma_f32_16x16x32_bf16 v[176:179], a[188:191], v[96:99], v[176:179]
    ds_read_b64_tr_b16 a[212:213], v7 offset:32768
    v_mfma_f32_16x16x32_bf16 a[0:3], a[192:195], v[180:183], a[0:3]
    v_exp_f32 v120, v120
    v_mfma_f32_16x16x32_bf16 a[0:3], a[196:199], v[184:187], a[0:3]
    ds_read_b64_tr_b16 a[214:215], v7 offset:36864
    v_cvt_pk_bf16_f32 v213, v118, v119
    v_mfma_f32_16x16x32_bf16 a[4:7], a[192:195], v[188:191], a[4:7]
    v_exp_f32 v121, v121
    v_mfma_f32_16x16x32_bf16 a[4:7], a[196:199], v[192:195], a[4:7]
    ds_read_b128 a[148:151], v2 offset:36864
    v_cvt_pk_bf16_f32 v220, v120, v121
    v_mfma_f32_16x16x32_bf16 a[8:11], a[192:195], v[196:199], a[8:11]
    v_exp_f32 v122, v122
    v_mfma_f32_16x16x32_bf16 a[8:11], a[196:199], v[200:203], a[8:11]
    buffer_load_dwordx4 v15, s[8:11], s28 offen offset:2048 lds
    v_mfma_f32_16x16x32_bf16 a[12:15], a[192:195], v[204:207], a[12:15]
    v_exp_f32 v123, v123
    v_mfma_f32_16x16x32_bf16 a[12:15], a[196:199], v[208:211], a[12:15]
    s_waitcnt lgkmcnt(6)
    v_mfma_f32_16x16x32_bf16 v[116:119], a[128:131], v[36:39], v[100:103]
    v_exp_f32 v124, v124
    v_mfma_f32_16x16x32_bf16 v[116:119], a[132:135], v[40:43], v[116:119]
    ds_read_b64_tr_b16 a[216:217], v8 offset:8192
    v_cvt_pk_bf16_f32 v221, v122, v123
    v_mfma_f32_16x16x32_bf16 v[116:119], a[136:139], v[44:47], v[116:119]
    v_exp_f32 v125, v125
    v_mfma_f32_16x16x32_bf16 v[116:119], a[140:143], v[48:51], v[116:119]
    ds_read_b64_tr_b16 a[218:219], v8 offset:12288
    v_mfma_f32_16x16x32_bf16 v[120:123], a[128:131], v[52:55], v[104:107]
    v_exp_f32 v126, v126
    v_mfma_f32_16x16x32_bf16 v[120:123], a[132:135], v[56:59], v[120:123]
    ds_read_b128 a[152:155], v3 offset:36864
    v_cvt_pk_bf16_f32 v228, v124, v125
    v_mfma_f32_16x16x32_bf16 v[120:123], a[136:139], v[60:63], v[120:123]
    v_exp_f32 v127, v127
    v_mfma_f32_16x16x32_bf16 v[120:123], a[140:143], v[64:67], v[120:123]
    ds_read_b64_tr_b16 a[220:221], v8 offset:32768
    v_mfma_f32_16x16x32_bf16 a[16:19], a[200:203], v[180:183], a[16:19]
    v_exp_f32 v128, v128
    v_mfma_f32_16x16x32_bf16 a[16:19], a[204:207], v[184:187], a[16:19]
    ds_read_b64_tr_b16 a[222:223], v8 offset:36864
    v_cvt_pk_bf16_f32 v229, v126, v127
    v_mfma_f32_16x16x32_bf16 a[20:23], a[200:203], v[188:191], a[20:23]
    v_exp_f32 v129, v129
    v_mfma_f32_16x16x32_bf16 a[20:23], a[204:207], v[192:195], a[20:23]
    ds_read_b128 a[156:159], v4 offset:36864
    v_mfma_f32_16x16x32_bf16 a[24:27], a[200:203], v[196:199], a[24:27]
    v_exp_f32 v130, v130
    v_mfma_f32_16x16x32_bf16 a[24:27], a[204:207], v[200:203], a[24:27]
    v_cvt_pk_bf16_f32 v236, v128, v129
    v_mfma_f32_16x16x32_bf16 a[28:31], a[200:203], v[204:207], a[28:31]
    v_exp_f32 v131, v131
    v_mfma_f32_16x16x32_bf16 a[28:31], a[204:207], v[208:211], a[28:31]
    buffer_load_dwordx4 v16, s[8:11], s28 offen offset:3072 lds
    v_smfmac_f32_16x16x64_bf16 a[224:227], v[244:247], v[180:187], v248
    s_waitcnt lgkmcnt(6)
    v_mfma_f32_16x16x32_bf16 v[124:127], a[128:131], v[68:71], v[108:111]
    v_exp_f32 v132, v132
    v_mfma_f32_16x16x32_bf16 v[124:127], a[132:135], v[72:75], v[124:127]
    ds_read_b64_tr_b16 a[192:193], v9 offset:8192
    v_cvt_pk_bf16_f32 v237, v130, v131
    v_mfma_f32_16x16x32_bf16 v[124:127], a[136:139], v[76:79], v[124:127]
    v_exp_f32 v133, v133
    v_mfma_f32_16x16x32_bf16 v[124:127], a[140:143], v[80:83], v[124:127]
    ds_read_b64_tr_b16 a[194:195], v9 offset:12288
    s_cmp_eq_u32 s36, 3
    s_cbranch_scc1 L_site3
L_site_back3:
    v_mfma_f32_16x16x32_bf16 v[128:131], a[128:131], v[84:87], v[112:115]
    v_exp_f32 v134, v134
    v_mfma_f32_16x16x32_bf16 v[128:131], a[132:135], v[88:91], v[128:131]
    ds_read_b128 a[160:163], v1 offset:40960
    v_cvt_pk_bf16_f32 v214, v132, v133
    v_mfma_f32_16x16x32_bf16 v[128:131], a[136:139], v[92:95], v[128:131]
    v_exp_f32 v135, v135
    v_mfma_f32_16x16x32_bf16 v[128:131], a[140:143], v[96:99], v[128:131]
    ds_read_b64_tr_b16 a[196:197], v9 offset:32768
    v_mfma_f32_16x16x32_bf16 a[32:35], a[208:211], v[180:183], a[32:35]
    v_exp_f32 v136, v136
    v_mfma_f32_16x16x32_bf16 a[32:35], a[212:215], v[184:187], a[32:35]
    ds_read_b64_tr_b16 a[198:199], v9 offset:36864
    v_cvt_pk_bf16_f32 v215, v134, v135
    v_mfma_f32_16x16x32_bf16 a[36:39], a[208:211], v[188:191], a[36:39]
    v_exp_f32 v137, v137
    v_mfma_f32_16x16x32_bf16 a[36:39], a[212:215], v[192:195], a[36:39]
    ds_read_b128 a[164:167], v2 offset:40960
    v_cvt_pk_bf16_f32 v222, v136, v137
    v_mfma_f32_16x16x32_bf16 a[40:43], a[208:211], v[196:199], a[40:43]
    s_add_u32 s28, s28, 16384
    s_mov_b32 m0, s32
    v_exp_f32 v138, v138
    v_mfma_f32_16x16x32_bf16 a[40:43], a[212:215], v[200:203], a[40:43]
    buffer_load_dwordx4 v17, s[12:15], s29 offen offset:0 lds
    v_mfma_f32_16x16x32_bf16 a[44:47], a[208:211], v[204:207], a[44:47]
    v_exp_f32 v139, v139
    v_mfma_f32_16x16x32_bf16 a[44:47], a[212:215], v[208:211], a[44:47]
    s_waitcnt lgkmcnt(6)
    v_mfma_f32_16x16x32_bf16 v[132:135], a[144:147], v[36:39], v[100:103]
    v_exp_f32 v140, v140
    v_mfma_f32_16x16x32_bf16 v[132:135], a[148:151], v[40:43], v[132:135]
    ds_read_b64_tr_b16 a[200:201], v10 offset:8192
    v_cvt_pk_bf16_f32 v223, v138, v139
    v_mfma_f32_16x16x32_bf16 v[132:135], a[152:155], v[44:47], v[132:135]
    v_exp_f32 v141, v141
    v_mfma_f32_16x16x32_bf16 v[132:135], a[156:159], v[48:51], v[132:135]
    ds_read_b64_tr_b16 a[202:203], v10 offset:12288
    v_mfma_f32_16x16x32_bf16 v[136:139], a[144:147], v[52:55], v[104:107]
    v_exp_f32 v142, v142
    v_mfma_f32_16x16x32_bf16 v[136:139], a[148:151], v[56:59], v[136:139]
    ds_read_b128 a[168:171], v3 offset:40960
    v_cvt_pk_bf16_f32 v230, v140, v141
    v_mfma_f32_16x16x32_bf16 v[136:139], a[152:155], v[60:63], v[136:139]
    v_exp_f32 v143, v143
    v_mfma_f32_16x16x32_bf16 v[136:139], a[156:159], v[64:67], v[136:139]
    ds_read_b64_tr_b16 a[204:205], v10 offset:32768
    v_mfma_f32_16x16x32_bf16 a[48:51], a[216:219], v[180:183], a[48:51]
    v_exp_f32 v144, v144
    v_mfma_f32_16x16x32_bf16 a[48:51], a[220:223], v[184:187], a[48:51]
    ds_read_b64_tr_b16 a[206:207], v10 offset:36864
    v_cvt_pk_bf16_f32 v231, v142, v143
    v_mfma_f32_16x16x32_bf16 a[52:55], a[216:219], v[188:191], a[52:55]
    v_exp_f32 v145, v145
    v_mfma_f32_16x16x32_bf16 a[52:55], a[220:223], v[192:195], a[52:55]
    ds_read_b128 a[172:175], v4 offset:40960
    v_mfma_f32_16x16x32_bf16 a[56:59], a[216:219], v[196:199], a[56:59]
    v_exp_f32 v146, v146
    v_mfma_f32_16x16x32_bf16 a[56:59], a[220:223], v[200:203], a[56:59]
    v_cvt_pk_bf16_f32 v238, v144, v145
    v_mfma_f32_16x16x32_bf16 a[60:63], a[216:219], v[204:207], a[60:63]
    v_exp_f32 v147, v147
    v_mfma_f32_16x16x32_bf16 a[60:63], a[220:223], v[208:211], a[60:63]
    buffer_load_dwordx4 v18, s[12:15], s29 offen offset:1024 lds
    v_smfmac_f32_16x16x64_bf16 a[228:231], v[244:247], v[188:195], v248
    s_waitcnt lgkmcnt(6)
    v_mfma_f32_16x16x32_bf16 v[140:143], a[144:147], v[68:71], v[108:111]
    v_exp_f32 v148, v148
    v_mfma_f32_16x16x32_bf16 v[140:143], a[148:151], v[72:75], v[140:143]
    ds_read_b64_tr_b16 a[208:209], v11 offset:8192
    v_cvt_pk_bf16_f32 v239, v146, v147
    v_mfma_f32_16x16x32_bf16 v[140:143], a[152:155], v[76:79], v[140:143]
    v_exp_f32 v149, v149
    v_mfma_f32_16x16x32_bf16 v[140:143], a[156:159], v[80:83], v[140:143]
    ds_read_b64_tr_b16 a[210:211], v11 offset:12288
    v_mfma_f32_16x16x32_bf16 v[144:147], a[144:147], v[84:87], v[112:115]
    v_exp_f32 v150, v150
    v_mfma_f32_16x16x32_bf16 v[144:147], a[148:151], v[88:91], v[144:147]
    ds_read_b128 a[176:179], v1 offset:45056
    v_cvt_pk_bf16_f32 v216, v148, v149
    v_mfma_f32_16x16x32_bf16 v[144:147], a[152:155], v[92:95], v[144:147]
    v_exp_f32 v151, v151
    v_mfma_f32_16x16x32_bf16 v[144:147], a[156:159], v[96:99], v[144:147]
    ds_read_b64_tr_b16 a[212:213], v11 offset:32768
    v_mfma_f32_16x16x32_bf16 a[64:67], a[192:195], v[180:183], a[64:67]
    v_exp_f32 v152, v152
    v_mfma_f32_16x16x32_bf16 a[64:67], a[196:199], v[184:187], a[64:67]
    ds_read_b64_tr_b16 a[214:215], v11 offset:36864
    v_cvt_pk_bf16_f32 v217, v150, v151
    v_mfma_f32_16x16x32_bf16 a[68:71], a[192:195], v[188:191], a[68:71]
    v_exp_f32 v153, v153
    v_mfma_f32_16x16x32_bf16 a[68:71], a[196:199], v[192:195], a[68:71]
    ds_read_b128 a[180:183], v2 offset:45056
    v_cvt_pk_bf16_f32 v224, v152, v153
    v_mfma_f32_16x16x32_bf16 a[72:75], a[192:195], v[196:199], a[72:75]
    v_exp_f32 v154, v154
    v_mfma_f32_16x16x32_bf16 a[72:75], a[196:199], v[200:203], a[72:75]
    buffer_load_dwordx4 v17, s[12:15], s29 offen offset:2048 lds
    v_mfma_f32_16x16x32_bf16 a[76:79], a[192:195], v[204:207], a[76:79]
    v_exp_f32 v155, v155
    v_mfma_f32_16x16x32_bf16 a[76:79], a[196:199], v[208:211], a[76:79]
    s_waitcnt lgkmcnt(6)
    v_mfma_f32_16x16x32_bf16 v[148:151], a[160:163], v[36:39], v[100:103]
    v_exp_f32 v156, v156
    v_mfma_f32_16x16x32_bf16 v[148:151], a[164:167], v[40:43], v[148:151]
    ds_read_b64_tr_b16 a[216:217], v12 offset:8192
    v_cvt_pk_bf16_f32 v225, v154, v155
    v_mfma_f32_16x16x32_bf16 v[148:151], a[168:171], v[44:47], v[148:151]
    v_exp_f32 v157, v157
    v_mfma_f32_16x16x32_bf16 v[148:151], a[172:175], v[48:51], v[148:151]
    ds_read_b64_tr_b16 a[218:219], v12 offset:12288
    v_mfma_f32_16x16x32_bf16 v[152:155], a[160:163], v[52:55], v[104:107]
    v_exp_f32 v158, v158
    v_mfma_f32_16x16x32_bf16 v[152:155], a[164:167], v[56:59], v[152:155]
    ds_read_b128 a[184:187], v3 offset:45056
    v_cvt_pk_bf16_f32 v232, v156, v157
    v_mfma_f32_16x16x32_bf16 v[152:155], a[168:171], v[60:63], v[152:155]
    v_exp_f32 v159, v159
    v_mfma_f32_16x16x32_bf16 v[152:155], a[172:175], v[64:67], v[152:155]
    ds_read_b64_tr_b16 a[220:221], v12 offset:32768
    v_mfma_f32_16x16x32_bf16 a[80:83], a[200:203], v[180:183], a[80:83]
    v_exp_f32 v160, v160
    v_mfma_f32_16x16x32_bf16 a[80:83], a[204:207], v[184:187], a[80:83]
    ds_read_b64_tr_b16 a[222:223], v12 offset:36864
    v_cvt_pk_bf16_f32 v233, v158, v159
    v_mfma_f32_16x16x32_bf16 a[84:87], a[200:203], v[188:191], a[84:87]
    v_exp_f32 v161, v161
    v_mfma_f32_16x16x32_bf16 a[84:87], a[204:207], v[192:195], a[84:87]
    ds_read_b128 a[188:191], v4 offset:45056
    v_mfma_f32_16x16x32_bf16 a[88:91], a[200:203], v[196:199], a[88:91]
    v_exp_f32 v162, v162
    v_mfma_f32_16x16x32_bf16 a[88:91], a[204:207], v[200:203], a[88:91]
    v_cvt_pk_bf16_f32 v240, v160, v161
    v_mfma_f32_16x16x32_bf16 a[92:95], a[200:203], v[204:207], a[92:95]
    v_exp_f32 v163, v163
    v_mfma_f32_16x16x32_bf16 a[92:95], a[204:207], v[208:211], a[92:95]
    buffer_load_dwordx4 v18, s[12:15], s29 offen offset:3072 lds
    v_smfmac_f32_16x16x64_bf16 a[232:235], v[244:247], v[196:203], v248
    s_waitcnt vmcnt(8) lgkmcnt(6)
    s_barrier
    s_add_u32 s29, s29, 16384
    v_mfma_f32_16x16x32_bf16 v[156:159], a[160:163], v[68:71], v[108:111]
    v_exp_f32 v164, v164
    v_mfma_f32_16x16x32_bf16 v[156:159], a[164:167], v[72:75], v[156:159]
    ds_read_b64_tr_b16 a[192:193], v5 offset:16384
    v_cvt_pk_bf16_f32 v241, v162, v163
    v_mfma_f32_16x16x32_bf16 v[156:159], a[168:171], v[76:79], v[156:159]
    v_exp_f32 v165, v165
    v_mfma_f32_16x16x32_bf16 v[156:159], a[172:175], v[80:83], v[156:159]
    ds_read_b64_tr_b16 a[194:195], v5 offset:20480
    v_mfma_f32_16x16x32_bf16 v[160:163], a[160:163], v[84:87], v[112:115]
    v_exp_f32 v166, v166
    v_mfma_f32_16x16x32_bf16 v[160:163], a[164:167], v[88:91], v[160:163]
    ds_read_b128 a[128:131], v1 offset:0
    v_cvt_pk_bf16_f32 v218, v164, v165
    v_mfma_f32_16x16x32_bf16 v[160:163], a[168:171], v[92:95], v[160:163]
    v_exp_f32 v167, v167
    v_mfma_f32_16x16x32_bf16 v[160:163], a[172:175], v[96:99], v[160:163]
    ds_read_b64_tr_b16 a[196:197], v5 offset:40960
    v_mfma_f32_16x16x32_bf16 a[96:99], a[208:211], v[180:183], a[96:99]
    v_exp_f32 v168, v168
    v_mfma_f32_16x16x32_bf16 a[96:99], a[212:215], v[184:187], a[96:99]
    ds_read_b64_tr_b16 a[198:199], v5 offset:45056
    v_cvt_pk_bf16_f32 v219, v166, v167
    v_mfma_f32_16x16x32_bf16 a[100:103], a[208:211], v[188:191], a[100:103]
    v_exp_f32 v169, v169
    v_mfma_f32_16x16x32_bf16 a[100:103], a[212:215], v[192:195], a[100:103]
    ds_read_b128 a[132:135], v2 offset:0
    v_cvt_pk_bf16_f32 v226, v168, v169
    v_mfma_f32_16x16x32_bf16 a[104:107], a[208:211], v[196:199], a[104:107]
    s_add_u32 m0, s34, 16384
    v_exp_f32 v170, v170
    v_mfma_f32_16x16x32_bf16 a[104:107], a[212:215], v[200:203], a[104:107]
    buffer_load_dwordx4 v13, s[8:11], s28 offen offset:0 lds
    v_mfma_f32_16x16x32_bf16 a[108:111], a[208:211], v[204:207], a[108:111]
    v_exp_f32 v171, v171
    v_mfma_f32_16x16x32_bf16 a[108:111], a[212:215], v[208:211], a[108:111]
    s_waitcnt lgkmcnt(6)
    v_mfma_f32_16x16x32_bf16 v[164:167], a[176:179], v[36:39], v[100:103]
    v_exp_f32 v172, v172
    v_mfma_f32_16x16x32_bf16 v[164:167], a[180:183], v[40:43], v[164:167]
    ds_read_b64_tr_b16 a[200:201], v6 offset:16384
    v_cvt_pk_bf16_f32 v227, v170, v171
    v_mfma_f32_16x16x32_bf16 v[164:167], a[184:187], v[44:47], v[164:167]
    v_exp_f32 v173, v173
    v_mfma_f32_16x16x32_bf16 v[164:167], a[188:191], v[48:51], v[164:167]
    ds_read_b64_tr_b16 a[202:203], v6 offset:20480
    v_mfma_f32_16x16x32_bf16 v[168:171], a[176:179], v[52:55], v[104:107]
    v_exp_f32 v174, v174
    v_mfma_f32_16x16x32_bf16 v[168:171], a[180:183], v[56:59], v[168:171]
    ds_read_b128 a[136:139], v3 offset:0
    v_cvt_pk_bf16_f32 v234, v172, v173
    v_mfma_f32_16x16x32_bf16 v[168:171], a[184:187], v[60:63], v[168:171]
    v_exp_f32 v175, v175
    v_mfma_f32_16x16x32_bf16 v[168:171], a[188:191], v[64:67], v[168:171]
    ds_read_b64_tr_b16 a[204:205], v6 offset:40960
    v_mfma_f32_16x16x32_bf16 a[112:115], a[216:219], v[180:183], a[112:115]
    v_exp_f32 v176, v176
    v_mfma_f32_16x16x32_bf16 a[112:115], a[220:223], v[184:187], a[112:115]
    ds_read_b64_tr_b16 a[206:207], v6 offset:45056
    v_cvt_pk_bf16_f32 v235, v174, v175
    v_mfma_f32_16x16x32_bf16 a[116:119], a[216:219], v[188:191], a[116:119]
    v_exp_f32 v177, v177
    v_mfma_f32_16x16x32_bf16 a[116:119], a[220:223], v[192:195], a[116:119]
    ds_read_b128 a[140:143], v4 offset:0
    v_mfma_f32_16x16x32_bf16 a[120:123], a[216:219], v[196:199], a[120:123]
    v_exp_f32 v178, v178
    v_mfma_f32_16x16x32_bf16 a[120:123], a[220:223], v[200:203], a[120:123]
    v_cvt_pk_bf16_f32 v242, v176, v177
    v_mfma_f32_16x16x32_bf16 a[124:127], a[216:219], v[204:207], a[124:127]
    v_exp_f32 v179, v179
    v_mfma_f32_16x16x32_bf16 a[124:127], a[220:223], v[208:211], a[124:127]
    buffer_load_dwordx4 v14, s[8:11], s28 offen offset:1024 lds
    v_smfmac_f32_16x16x64_bf16 a[236:239], v[244:247], v[204:211], v248
    s_waitcnt lgkmcnt(6)
    s_sub_u32 s35, s35, 1
    s_cbranch_scc0 L_attn_loop
    v_mfma_f32_16x16x32_bf16 v[172:175], a[176:179], v[68:71], v[108:111]
    v_exp_f32 v116, v116
    v_mfma_f32_16x16x32_bf16 v[172:175], a[180:183], v[72:75], v[172:175]
    ds_read_b64_tr_b16 a[208:209], v7 offset:16384
    v_cvt_pk_bf16_f32 v243, v178, v179
    v_mfma_f32_16x16x32_bf16 v[172:175], a[184:187], v[76:79], v[172:175]
    v_exp_f32 v117, v117
    v_mfma_f32_16x16x32_bf16 v[172:175], a[188:191], v[80:83], v[172:175]
    ds_read_b64_tr_b16 a[210:211], v7 offset:20480
    v_bfe_u32 v21, v19, 3, 2
    v_lshlrev_b32 v21, 8, v21
    v_and_b32 v20, 7, v19
    v_lshl_add_u32 v21, v20, 2, v21
    v_add_u32 v21, 86016, v21
    ds_read_b32 v20, v21
    v_mfma_f32_16x16x32_bf16 v[176:179], a[176:179], v[84:87], v[112:115]
    v_exp_f32 v118, v118
    v_mfma_f32_16x16x32_bf16 v[176:179], a[180:183], v[88:91], v[176:179]
    ds_read_b128 a[144:147], v1 offset:4096
    v_cvt_pk_bf16_f32 v180, v116, v117
    v_mfma_f32_16x16x32_bf16 v[176:179], a[184:187], v[92:95], v[176:179]
    v_exp_f32 v119, v119
    v_mfma_f32_16x16x32_bf16 v[176:179], a[188:191], v[96:99], v[176:179]
    ds_read_b64_tr_b16 a[212:213], v7 offset:40960
    v_lshlrev_b32 v32, 4, v19
    v_add_u32 v32, 0x290000, v32
    buffer_load_dwordx4 v[28:31], v32, s[76:79], 0 offen sc1
    v_mfma_f32_16x16x32_bf16 a[0:3], a[192:195], v[212:215], a[0:3]
    v_exp_f32 v120, v120
    v_mfma_f32_16x16x32_bf16 a[0:3], a[196:199], v[216:219], a[0:3]
    ds_read_b64_tr_b16 a[214:215], v7 offset:45056
    v_cvt_pk_bf16_f32 v181, v118, v119
    v_mfma_f32_16x16x32_bf16 a[4:7], a[192:195], v[220:223], a[4:7]
    v_exp_f32 v121, v121
    v_mfma_f32_16x16x32_bf16 a[4:7], a[196:199], v[224:227], a[4:7]
    ds_read_b128 a[148:151], v2 offset:4096
    v_cvt_pk_bf16_f32 v188, v120, v121
    v_mfma_f32_16x16x32_bf16 a[8:11], a[192:195], v[228:231], a[8:11]
    s_add_u32 s28, s28, 16384
    s_mov_b32 m0, s33
    v_exp_f32 v122, v122
    v_mfma_f32_16x16x32_bf16 a[8:11], a[196:199], v[232:235], a[8:11]
    buffer_load_dwordx4 v17, s[12:15], s29 offen offset:0 lds
    v_mfma_f32_16x16x32_bf16 a[12:15], a[192:195], v[236:239], a[12:15]
    v_exp_f32 v123, v123
    v_mfma_f32_16x16x32_bf16 a[12:15], a[196:199], v[240:243], a[12:15]
    s_waitcnt lgkmcnt(6)
    v_mfma_f32_16x16x32_bf16 v[116:119], a[128:131], v[36:39], v[100:103]
    v_exp_f32 v124, v124
    v_mfma_f32_16x16x32_bf16 v[116:119], a[132:135], v[40:43], v[116:119]
    ds_read_b64_tr_b16 a[216:217], v8 offset:16384
    v_cvt_pk_bf16_f32 v189, v122, v123
    v_mfma_f32_16x16x32_bf16 v[116:119], a[136:139], v[44:47], v[116:119]
    v_exp_f32 v125, v125
    v_mfma_f32_16x16x32_bf16 v[116:119], a[140:143], v[48:51], v[116:119]
    ds_read_b64_tr_b16 a[218:219], v8 offset:20480
    s_bfe_u32 s40, s2, 0x20001
    s_lshl_b32 s40, s40, 3
    s_bfe_u32 s41, s2, 0x30003
    s_add_u32 s87, s40, s41
    s_and_b32 s40, s2, 1
    s_lshl_b32 s40, s40, 2
    s_lshr_b32 s41, s2, 6
    s_add_u32 s100, s40, s41
    v_mfma_f32_16x16x32_bf16 v[120:123], a[128:131], v[52:55], v[104:107]
    v_exp_f32 v126, v126
    v_mfma_f32_16x16x32_bf16 v[120:123], a[132:135], v[56:59], v[120:123]
    ds_read_b128 a[152:155], v3 offset:4096
    v_cvt_pk_bf16_f32 v196, v124, v125
    v_mfma_f32_16x16x32_bf16 v[120:123], a[136:139], v[60:63], v[120:123]
    v_exp_f32 v127, v127
    v_mfma_f32_16x16x32_bf16 v[120:123], a[140:143], v[64:67], v[120:123]
    ds_read_b64_tr_b16 a[220:221], v8 offset:40960
    v_mfma_f32_16x16x32_bf16 a[16:19], a[200:203], v[212:215], a[16:19]
    v_exp_f32 v128, v128
    v_mfma_f32_16x16x32_bf16 a[16:19], a[204:207], v[216:219], a[16:19]
    ds_read_b64_tr_b16 a[222:223], v8 offset:45056
    v_cvt_pk_bf16_f32 v197, v126, v127
    v_mfma_f32_16x16x32_bf16 a[20:23], a[200:203], v[220:223], a[20:23]
    v_exp_f32 v129, v129
    v_mfma_f32_16x16x32_bf16 a[20:23], a[204:207], v[224:227], a[20:23]
    ds_read_b128 a[156:159], v4 offset:4096
    v_mfma_f32_16x16x32_bf16 a[24:27], a[200:203], v[228:231], a[24:27]
    v_exp_f32 v130, v130
    v_mfma_f32_16x16x32_bf16 a[24:27], a[204:207], v[232:235], a[24:27]
    v_cvt_pk_bf16_f32 v204, v128, v129
    v_mfma_f32_16x16x32_bf16 a[28:31], a[200:203], v[236:239], a[28:31]
    v_exp_f32 v131, v131
    v_mfma_f32_16x16x32_bf16 a[28:31], a[204:207], v[240:243], a[28:31]
    buffer_load_dwordx4 v18, s[12:15], s29 offen offset:1024 lds
    v_smfmac_f32_16x16x64_bf16 a[224:227], v[244:247], v[212:219], v248
    s_waitcnt lgkmcnt(6)
    v_mfma_f32_16x16x32_bf16 v[124:127], a[128:131], v[68:71], v[108:111]
    s_mov_b32 s42, -1
    v_exp_f32 v132, v132
    v_mfma_f32_16x16x32_bf16 v[124:127], a[132:135], v[72:75], v[124:127]
    ds_read_b64_tr_b16 a[192:193], v9 offset:16384
    v_cvt_pk_bf16_f32 v205, v130, v131
    v_mfma_f32_16x16x32_bf16 v[124:127], a[136:139], v[76:79], v[124:127]
    v_exp_f32 v133, v133
    v_sub_u32 v21, s42, v20
    v_mfma_f32_16x16x32_bf16 v[124:127], a[140:143], v[80:83], v[124:127]
    ds_read_b64_tr_b16 a[194:195], v9 offset:20480
    v_min_u32_dpp v21, v21, v21 row_shr:1 row_mask:0xf bank_mask:0xf
    v_mfma_f32_16x16x32_bf16 v[128:131], a[128:131], v[84:87], v[112:115]
    v_exp_f32 v134, v134
    v_min_u32_dpp v21, v21, v21 row_shr:2 row_mask:0xf bank_mask:0xf
    v_mfma_f32_16x16x32_bf16 v[128:131], a[132:135], v[88:91], v[128:131]
    ds_read_b128 a[160:163], v1 offset:8192
    v_cvt_pk_bf16_f32 v182, v132, v133
    v_min_u32_dpp v21, v21, v21 row_shr:4 row_mask:0xf bank_mask:0xf
    v_mfma_f32_16x16x32_bf16 v[128:131], a[136:139], v[92:95], v[128:131]
    v_exp_f32 v135, v135
    v_min_u32_dpp v21, v21, v21 row_shr:8 row_mask:0xf bank_mask:0xf
    v_mfma_f32_16x16x32_bf16 v[128:131], a[140:143], v[96:99], v[128:131]
    ds_read_b64_tr_b16 a[196:197], v9 offset:40960
    v_min_u32_dpp v21, v21, v21 row_bcast:15 row_mask:0xa bank_mask:0xf
    v_mfma_f32_16x16x32_bf16 a[32:35], a[208:211], v[212:215], a[32:35]
    v_exp_f32 v136, v136
    v_min_u32_dpp v21, v21, v21 row_bcast:31 row_mask:0xc bank_mask:0xf
    v_mfma_f32_16x16x32_bf16 a[32:35], a[212:215], v[216:219], a[32:35]
    ds_read_b64_tr_b16 a[198:199], v9 offset:45056
    v_cvt_pk_bf16_f32 v183, v134, v135
    v_readlane_b32 s50, v21, 63
    v_mfma_f32_16x16x32_bf16 a[36:39], a[208:211], v[220:223], a[36:39]
    s_sub_u32 s50, s42, s50
    v_exp_f32 v137, v137
    v_mfma_f32_16x16x32_bf16 a[36:39], a[212:215], v[224:227], a[36:39]
    s_sub_u32 s42, s50, 1
    ds_read_b128 a[164:167], v2 offset:8192
    v_cvt_pk_bf16_f32 v190, v136, v137
    v_mfma_f32_16x16x32_bf16 a[40:43], a[208:211], v[228:231], a[40:43]
    v_exp_f32 v138, v138
    v_sub_u32 v21, s42, v20
    v_mfma_f32_16x16x32_bf16 a[40:43], a[212:215], v[232:235], a[40:43]
    buffer_load_dwordx4 v17, s[12:15], s29 offen offset:2048 lds
    v_mfma_f32_16x16x32_bf16 a[44:47], a[208:211], v[236:239], a[44:47]
    v_exp_f32 v139, v139
    v_min_u32_dpp v21, v21, v21 row_shr:1 row_mask:0xf bank_mask:0xf
    v_mfma_f32_16x16x32_bf16 a[44:47], a[212:215], v[240:243], a[44:47]
    s_waitcnt lgkmcnt(6)
    v_min_u32_dpp v21, v21, v21 row_shr:2 row_mask:0xf bank_mask:0xf
    s_nop 1
    v_min_u32_dpp v21, v21, v21 row_shr:4 row_mask:0xf bank_mask:0xf
    v_mfma_f32_16x16x32_bf16 v[132:135], a[144:147], v[36:39], v[100:103]
    v_exp_f32 v140, v140
    v_mfma_f32_16x16x32_bf16 v[132:135], a[148:151], v[40:43], v[132:135]
    ds_read_b64_tr_b16 a[200:201], v10 offset:16384
    v_cvt_pk_bf16_f32 v191, v138, v139
    v_min_u32_dpp v21, v21, v21 row_shr:8 row_mask:0xf bank_mask:0xf
    v_mfma_f32_16x16x32_bf16 v[132:135], a[152:155], v[44:47], v[132:135]
    v_exp_f32 v141, v141
    v_min_u32_dpp v21, v21, v21 row_bcast:15 row_mask:0xa bank_mask:0xf
    v_mfma_f32_16x16x32_bf16 v[132:135], a[156:159], v[48:51], v[132:135]
    ds_read_b64_tr_b16 a[202:203], v10 offset:20480
    v_min_u32_dpp v21, v21, v21 row_bcast:31 row_mask:0xc bank_mask:0xf
    v_mfma_f32_16x16x32_bf16 v[136:139], a[144:147], v[52:55], v[104:107]
    v_exp_f32 v142, v142
    v_readlane_b32 s51, v21, 63
    v_mfma_f32_16x16x32_bf16 v[136:139], a[148:151], v[56:59], v[136:139]
    s_sub_u32 s51, s42, s51
    ds_read_b128 a[168:171], v3 offset:8192
    v_cvt_pk_bf16_f32 v198, v140, v141
    v_mfma_f32_16x16x32_bf16 v[136:139], a[152:155], v[60:63], v[136:139]
    s_sub_u32 s42, s51, 1
    v_exp_f32 v143, v143
    v_mfma_f32_16x16x32_bf16 v[136:139], a[156:159], v[64:67], v[136:139]
    ds_read_b64_tr_b16 a[204:205], v10 offset:40960
    v_sub_u32 v21, s42, v20
    v_mfma_f32_16x16x32_bf16 a[48:51], a[216:219], v[212:215], a[48:51]
    v_exp_f32 v144, v144
    v_min_u32_dpp v21, v21, v21 row_shr:1 row_mask:0xf bank_mask:0xf
    v_mfma_f32_16x16x32_bf16 a[48:51], a[220:223], v[216:219], a[48:51]
    ds_read_b64_tr_b16 a[206:207], v10 offset:45056
    v_cvt_pk_bf16_f32 v199, v142, v143
    v_min_u32_dpp v21, v21, v21 row_shr:2 row_mask:0xf bank_mask:0xf
    v_mfma_f32_16x16x32_bf16 a[52:55], a[216:219], v[220:223], a[52:55]
    v_exp_f32 v145, v145
    v_min_u32_dpp v21, v21, v21 row_shr:4 row_mask:0xf bank_mask:0xf
    v_mfma_f32_16x16x32_bf16 a[52:55], a[220:223], v[224:227], a[52:55]
    ds_read_b128 a[172:175], v4 offset:8192
    v_min_u32_dpp v21, v21, v21 row_shr:8 row_mask:0xf bank_mask:0xf
    v_mfma_f32_16x16x32_bf16 a[56:59], a[216:219], v[228:231], a[56:59]
    v_exp_f32 v146, v146
    v_mfma_f32_16x16x32_bf16 a[56:59], a[220:223], v[232:235], a[56:59]
    v_cvt_pk_bf16_f32 v206, v144, v145
    v_min_u32_dpp v21, v21, v21 row_bcast:15 row_mask:0xa bank_mask:0xf
    v_mfma_f32_16x16x32_bf16 a[60:63], a[216:219], v[236:239], a[60:63]
    v_exp_f32 v147, v147
    v_min_u32_dpp v21, v21, v21 row_bcast:31 row_mask:0xc bank_mask:0xf
    v_mfma_f32_16x16x32_bf16 a[60:63], a[220:223], v[240:243], a[60:63]
    buffer_load_dwordx4 v18, s[12:15], s29 offen offset:3072 lds
    v_readlane_b32 s52, v21, 63
    v_smfmac_f32_16x16x64_bf16 a[228:231], v[244:247], v[220:227], v248
    s_waitcnt lgkmcnt(6)
    s_add_u32 s29, s29, 16384
    v_mfma_f32_16x16x32_bf16 v[140:143], a[144:147], v[68:71], v[108:111]
    s_sub_u32 s52, s42, s52
    v_exp_f32 v148, v148
    v_mfma_f32_16x16x32_bf16 v[140:143], a[148:151], v[72:75], v[140:143]
    s_sub_u32 s42, s52, 1
    ds_read_b64_tr_b16 a[208:209], v11 offset:16384
    v_cvt_pk_bf16_f32 v207, v146, v147
    v_mfma_f32_16x16x32_bf16 v[140:143], a[152:155], v[76:79], v[140:143]
    v_exp_f32 v149, v149
    v_sub_u32 v21, s42, v20
    v_mfma_f32_16x16x32_bf16 v[140:143], a[156:159], v[80:83], v[140:143]
    ds_read_b64_tr_b16 a[210:211], v11 offset:20480
    v_min_u32_dpp v21, v21, v21 row_shr:1 row_mask:0xf bank_mask:0xf
    v_mfma_f32_16x16x32_bf16 v[144:147], a[144:147], v[84:87], v[112:115]
    v_exp_f32 v150, v150
    v_min_u32_dpp v21, v21, v21 row_shr:2 row_mask:0xf bank_mask:0xf
    v_mfma_f32_16x16x32_bf16 v[144:147], a[148:151], v[88:91], v[144:147]
    ds_read_b128 a[176:179], v1 offset:12288
    v_cvt_pk_bf16_f32 v184, v148, v149
    v_min_u32_dpp v21, v21, v21 row_shr:4 row_mask:0xf bank_mask:0xf
    v_mfma_f32_16x16x32_bf16 v[144:147], a[152:155], v[92:95], v[144:147]
    v_exp_f32 v151, v151
    v_min_u32_dpp v21, v21, v21 row_shr:8 row_mask:0xf bank_mask:0xf
    v_mfma_f32_16x16x32_bf16 v[144:147], a[156:159], v[96:99], v[144:147]
    ds_read_b64_tr_b16 a[212:213], v11 offset:40960
    v_min_u32_dpp v21, v21, v21 row_bcast:15 row_mask:0xa bank_mask:0xf
    v_mfma_f32_16x16x32_bf16 a[64:67], a[192:195], v[212:215], a[64:67]
    v_exp_f32 v152, v152
    v_min_u32_dpp v21, v21, v21 row_bcast:31 row_mask:0xc bank_mask:0xf
    v_mfma_f32_16x16x32_bf16 a[64:67], a[196:199], v[216:219], a[64:67]
    ds_read_b64_tr_b16 a[214:215], v11 offset:45056
    v_cvt_pk_bf16_f32 v185, v150, v151
    v_mfma_f32_16x16x32_bf16 a[68:71], a[192:195], v[220:223], a[68:71]
    v_exp_f32 v153, v153
    v_readlane_b32 s53, v21, 63
    v_mfma_f32_16x16x32_bf16 a[68:71], a[196:199], v[224:227], a[68:71]
    s_sub_u32 s53, s42, s53
    ds_read_b128 a[180:183], v2 offset:12288
    v_mfma_f32_16x16x32_bf16 a[72:75], a[192:195], v[228:231], a[72:75]
    s_sub_u32 s42, s53, 1
    v_exp_f32 v154, v154
    v_mfma_f32_16x16x32_bf16 a[72:75], a[196:199], v[232:235], a[72:75]
    v_cvt_pk_bf16_f32 v192, v152, v153
    v_sub_u32 v21, s42, v20
    v_mfma_f32_16x16x32_bf16 a[76:79], a[192:195], v[236:239], a[76:79]
    v_exp_f32 v155, v155
    v_min_u32_dpp v21, v21, v21 row_shr:1 row_mask:0xf bank_mask:0xf
    v_mfma_f32_16x16x32_bf16 a[76:79], a[196:199], v[240:243], a[76:79]
    s_waitcnt lgkmcnt(6)
    v_min_u32_dpp v21, v21, v21 row_shr:2 row_mask:0xf bank_mask:0xf
    s_nop 1
    v_min_u32_dpp v21, v21, v21 row_shr:4 row_mask:0xf bank_mask:0xf
    v_mfma_f32_16x16x32_bf16 v[148:151], a[160:163], v[36:39], v[100:103]
    v_exp_f32 v156, v156
    v_mfma_f32_16x16x32_bf16 v[148:151], a[164:167], v[40:43], v[148:151]
    ds_read_b64_tr_b16 a[216:217], v12 offset:16384
    v_cvt_pk_bf16_f32 v193, v154, v155
    v_min_u32_dpp v21, v21, v21 row_shr:8 row_mask:0xf bank_mask:0xf
    v_mfma_f32_16x16x32_bf16 v[148:151], a[168:171], v[44:47], v[148:151]
    v_exp_f32 v157, v157
    v_min_u32_dpp v21, v21, v21 row_bcast:15 row_mask:0xa bank_mask:0xf
    v_mfma_f32_16x16x32_bf16 v[148:151], a[172:175], v[48:51], v[148:151]
    ds_read_b64_tr_b16 a[218:219], v12 offset:20480
    v_min_u32_dpp v21, v21, v21 row_bcast:31 row_mask:0xc bank_mask:0xf
    v_mfma_f32_16x16x32_bf16 v[152:155], a[160:163], v[52:55], v[104:107]
    v_exp_f32 v158, v158
    v_readlane_b32 s54, v21, 63
    v_mfma_f32_16x16x32_bf16 v[152:155], a[164:167], v[56:59], v[152:155]
    s_sub_u32 s54, s42, s54
    ds_read_b128 a[184:187], v3 offset:12288
    v_cvt_pk_bf16_f32 v200, v156, v157
    v_mfma_f32_16x16x32_bf16 v[152:155], a[168:171], v[60:63], v[152:155]
    s_sub_u32 s42, s54, 1
    v_exp_f32 v159, v159
    v_mfma_f32_16x16x32_bf16 v[152:155], a[172:175], v[64:67], v[152:155]
    ds_read_b64_tr_b16 a[220:221], v12 offset:40960
    v_sub_u32 v21, s42, v20
    v_mfma_f32_16x16x32_bf16 a[80:83], a[200:203], v[212:215], a[80:83]
    v_exp_f32 v160, v160
    v_mfma_f32_16x16x32_bf16 a[80:83], a[204:207], v[216:219], a[80:83]
    ds_read_b64_tr_b16 a[222:223], v12 offset:45056
    v_cvt_pk_bf16_f32 v201, v158, v159
    v_min_u32_dpp v21, v21, v21 row_shr:1 row_mask:0xf bank_mask:0xf
    v_mfma_f32_16x16x32_bf16 a[84:87], a[200:203], v[220:223], a[84:87]
    v_exp_f32 v161, v161
    v_min_u32_dpp v21, v21, v21 row_shr:2 row_mask:0xf bank_mask:0xf
    v_mfma_f32_16x16x32_bf16 a[84:87], a[204:207], v[224:227], a[84:87]
    ds_read_b128 a[188:191], v4 offset:12288
    v_min_u32_dpp v21, v21, v21 row_shr:4 row_mask:0xf bank_mask:0xf
    v_mfma_f32_16x16x32_bf16 a[88:91], a[200:203], v[228:231], a[88:91]
    v_exp_f32 v162, v162
    v_min_u32_dpp v21, v21, v21 row_shr:8 row_mask:0xf bank_mask:0xf
    v_mfma_f32_16x16x32_bf16 a[88:91], a[204:207], v[232:235], a[88:91]
    v_cvt_pk_bf16_f32 v208, v160, v161
    v_min_u32_dpp v21, v21, v21 row_bcast:15 row_mask:0xa bank_mask:0xf
    v_mfma_f32_16x16x32_bf16 a[92:95], a[200:203], v[236:239], a[92:95]
    v_exp_f32 v163, v163
    v_min_u32_dpp v21, v21, v21 row_bcast:31 row_mask:0xc bank_mask:0xf
    v_mfma_f32_16x16x32_bf16 a[92:95], a[204:207], v[240:243], a[92:95]
    v_readlane_b32 s55, v21, 63
    v_smfmac_f32_16x16x64_bf16 a[232:235], v[244:247], v[228:235], v248
    s_waitcnt vmcnt(7) lgkmcnt(6)
    s_barrier
    v_mfma_f32_16x16x32_bf16 v[156:159], a[160:163], v[68:71], v[108:111]
    s_sub_u32 s55, s42, s55
    v_exp_f32 v164, v164
    v_mfma_f32_16x16x32_bf16 v[156:159], a[164:167], v[72:75], v[156:159]
    s_sub_u32 s42, s55, 1
    ds_read_b64_tr_b16 a[192:193], v5 offset:57344
    v_cvt_pk_bf16_f32 v209, v162, v163
    v_mfma_f32_16x16x32_bf16 v[156:159], a[168:171], v[76:79], v[156:159]
    v_exp_f32 v165, v165
    v_sub_u32 v21, s42, v20
    v_mfma_f32_16x16x32_bf16 v[156:159], a[172:175], v[80:83], v[156:159]
    ds_read_b64_tr_b16 a[194:195], v5 offset:61440
    v_min_u32_dpp v21, v21, v21 row_shr:1 row_mask:0xf bank_mask:0xf
    v_mfma_f32_16x16x32_bf16 v[160:163], a[160:163], v[84:87], v[112:115]
    v_exp_f32 v166, v166
    v_mfma_f32_16x16x32_bf16 v[160:163], a[164:167], v[88:91], v[160:163]
    ds_read_b64_tr_b16 a[196:197], v5 offset:0
    v_cvt_pk_bf16_f32 v186, v164, v165
    v_min_u32_dpp v21, v21, v21 row_shr:2 row_mask:0xf bank_mask:0xf
    v_mfma_f32_16x16x32_bf16 v[160:163], a[168:171], v[92:95], v[160:163]
    v_exp_f32 v167, v167
    v_min_u32_dpp v21, v21, v21 row_shr:4 row_mask:0xf bank_mask:0xf
    v_mfma_f32_16x16x32_bf16 v[160:163], a[172:175], v[96:99], v[160:163]
    ds_read_b64_tr_b16 a[198:199], v5 offset:4096
    v_min_u32_dpp v21, v21, v21 row_shr:8 row_mask:0xf bank_mask:0xf
    v_mfma_f32_16x16x32_bf16 a[96:99], a[208:211], v[212:215], a[96:99]
    v_exp_f32 v168, v168
    v_min_u32_dpp v21, v21, v21 row_bcast:15 row_mask:0xa bank_mask:0xf
    v_mfma_f32_16x16x32_bf16 a[96:99], a[212:215], v[216:219], a[96:99]
    v_cvt_pk_bf16_f32 v187, v166, v167
    v_min_u32_dpp v21, v21, v21 row_bcast:31 row_mask:0xc bank_mask:0xf
    v_mfma_f32_16x16x32_bf16 a[100:103], a[208:211], v[220:223], a[100:103]
    v_exp_f32 v169, v169
    v_readlane_b32 s56, v21, 63
    v_mfma_f32_16x16x32_bf16 a[100:103], a[212:215], v[224:227], a[100:103]
    s_sub_u32 s56, s42, s56
    v_mfma_f32_16x16x32_bf16 a[104:107], a[208:211], v[228:231], a[104:107]
    s_sub_u32 s42, s56, 1
    v_exp_f32 v170, v170
    v_mfma_f32_16x16x32_bf16 a[104:107], a[212:215], v[232:235], a[104:107]
    v_cvt_pk_bf16_f32 v194, v168, v169
    v_sub_u32 v21, s42, v20
    v_mfma_f32_16x16x32_bf16 a[108:111], a[208:211], v[236:239], a[108:111]
    v_exp_f32 v171, v171
    v_min_u32_dpp v21, v21, v21 row_shr:1 row_mask:0xf bank_mask:0xf
    v_mfma_f32_16x16x32_bf16 a[108:111], a[212:215], v[240:243], a[108:111]
    s_waitcnt lgkmcnt(4)
    v_min_u32_dpp v21, v21, v21 row_shr:2 row_mask:0xf bank_mask:0xf
    s_nop 1
    v_min_u32_dpp v21, v21, v21 row_shr:4 row_mask:0xf bank_mask:0xf
    v_mfma_f32_16x16x32_bf16 v[164:167], a[176:179], v[36:39], v[100:103]
    v_exp_f32 v172, v172
    v_mfma_f32_16x16x32_bf16 v[164:167], a[180:183], v[40:43], v[164:167]
    ds_read_b64_tr_b16 a[200:201], v6 offset:57344
    v_cvt_pk_bf16_f32 v195, v170, v171
    v_min_u32_dpp v21, v21, v21 row_shr:8 row_mask:0xf bank_mask:0xf
    v_mfma_f32_16x16x32_bf16 v[164:167], a[184:187], v[44:47], v[164:167]
    v_exp_f32 v173, v173
    v_mfma_f32_16x16x32_bf16 v[164:167], a[188:191], v[48:51], v[164:167]
    ds_read_b64_tr_b16 a[202:203], v6 offset:61440
    s_waitcnt vmcnt(4)
    v_min3_u32 v28, v28, v29, v30
    v_min_u32 v28, v28, v31
    v_cmp_gt_u32 vcc, 1, v28
    s_and_b64 vcc, vcc, exec
    s_cbranch_scc1 L_spin_pack
L_back_pack:
    v_min_u32_dpp v21, v21, v21 row_bcast:15 row_mask:0xa bank_mask:0xf
    v_mfma_f32_16x16x32_bf16 v[168:171], a[176:179], v[52:55], v[104:107]
    v_exp_f32 v174, v174
    v_min_u32_dpp v21, v21, v21 row_bcast:31 row_mask:0xc bank_mask:0xf
    v_mfma_f32_16x16x32_bf16 v[168:171], a[180:183], v[56:59], v[168:171]
    ds_read_b64_tr_b16 a[204:205], v6 offset:0
    v_cvt_pk_bf16_f32 v202, v172, v173
    v_readlane_b32 s57, v21, 63
    v_mfma_f32_16x16x32_bf16 v[168:171], a[184:187], v[60:63], v[168:171]
    s_sub_u32 s57, s42, s57
    v_exp_f32 v175, v175
    v_mfma_f32_16x16x32_bf16 v[168:171], a[188:191], v[64:67], v[168:171]
    s_sub_u32 s42, s57, 1
    ds_read_b64_tr_b16 a[206:207], v6 offset:4096
    v_mov_b32 v249, s50
    v_mfma_f32_16x16x32_bf16 a[112:115], a[216:219], v[212:215], a[112:115]
    v_exp_f32 v176, v176
    v_mfma_f32_16x16x32_bf16 a[112:115], a[220:223], v[216:219], a[112:115]
    v_cvt_pk_bf16_f32 v203, v174, v175
    v_writelane_b32 v249, s51, 1
    v_mfma_f32_16x16x32_bf16 a[116:119], a[216:219], v[220:223], a[116:119]
    v_exp_f32 v177, v177
    v_writelane_b32 v249, s52, 2
    v_mfma_f32_16x16x32_bf16 a[116:119], a[220:223], v[224:227], a[116:119]
    v_writelane_b32 v249, s53, 3
    v_writelane_b32 v249, s54, 4
    v_mfma_f32_16x16x32_bf16 a[120:123], a[216:219], v[228:231], a[120:123]
    v_exp_f32 v178, v178
    v_mfma_f32_16x16x32_bf16 a[120:123], a[220:223], v[232:235], a[120:123]
    v_cvt_pk_bf16_f32 v210, v176, v177
    v_writelane_b32 v249, s55, 5
    v_mfma_f32_16x16x32_bf16 a[124:127], a[216:219], v[236:239], a[124:127]
    v_exp_f32 v179, v179
    v_writelane_b32 v249, s56, 6
    v_mfma_f32_16x16x32_bf16 a[124:127], a[220:223], v[240:243], a[124:127]
    v_writelane_b32 v249, s57, 7
    v_smfmac_f32_16x16x64_bf16 a[236:239], v[244:247], v[236:243], v248
    s_waitcnt lgkmcnt(4)
    v_mfma_f32_16x16x32_bf16 v[172:175], a[176:179], v[68:71], v[108:111]
    v_exp_f32 v116, v116
    v_mfma_f32_16x16x32_bf16 v[172:175], a[180:183], v[72:75], v[172:175]
    ds_read_b64_tr_b16 a[208:209], v7 offset:57344
    v_cvt_pk_bf16_f32 v211, v178, v179
    v_mfma_f32_16x16x32_bf16 v[172:175], a[184:187], v[76:79], v[172:175]
    v_exp_f32 v117, v117
    v_mfma_f32_16x16x32_bf16 v[172:175], a[188:191], v[80:83], v[172:175]
    ds_read_b64_tr_b16 a[210:211], v7 offset:61440
    v_and_b32 v23, 7, v19
    v_lshlrev_b32 v23, 2, v23
    ds_bpermute_b32 v22, v23, v249
    v_mfma_f32_16x16x32_bf16 v[176:179], a[176:179], v[84:87], v[112:115]
    v_exp_f32 v118, v118
    v_mfma_f32_16x16x32_bf16 v[176:179], a[180:183], v[88:91], v[176:179]
    ds_read_b64_tr_b16 a[212:213], v7 offset:0
    v_cvt_pk_bf16_f32 v212, v116, v117
    v_mfma_f32_16x16x32_bf16 v[176:179], a[184:187], v[92:95], v[176:179]
    v_exp_f32 v119, v119
    v_mfma_f32_16x16x32_bf16 v[176:179], a[188:191], v[96:99], v[176:179]
    ds_read_b64_tr_b16 a[214:215], v7 offset:4096
    v_mfma_f32_16x16x32_bf16 a[0:3], a[192:195], v[180:183], a[0:3]
    v_exp_f32 v120, v120
    v_mfma_f32_16x16x32_bf16 a[0:3], a[196:199], v[184:187], a[0:3]
    v_cvt_pk_bf16_f32 v213, v118, v119
    v_mfma_f32_16x16x32_bf16 a[4:7], a[192:195], v[188:191], a[4:7]
    v_exp_f32 v121, v121
    v_mfma_f32_16x16x32_bf16 a[4:7], a[196:199], v[192:195], a[4:7]
    v_mfma_f32_16x16x32_bf16 a[8:11], a[192:195], v[196:199], a[8:11]
    v_exp_f32 v122, v122
    v_mfma_f32_16x16x32_bf16 a[8:11], a[196:199], v[200:203], a[8:11]
    v_cvt_pk_bf16_f32 v220, v120, v121
    v_mfma_f32_16x16x32_bf16 a[12:15], a[192:195], v[204:207], a[12:15]
    v_exp_f32 v123, v123
    v_mfma_f32_16x16x32_bf16 a[12:15], a[196:199], v[208:211], a[12:15]
    s_waitcnt lgkmcnt(4)
    v_mfma_f32_16x16x32_bf16 a[16:19], a[200:203], v[180:183], a[16:19]
    v_exp_f32 v124, v124
    v_mfma_f32_16x16x32_bf16 a[16:19], a[204:207], v[184:187], a[16:19]
    ds_read_b64_tr_b16 a[216:217], v8 offset:57344
    v_cvt_pk_bf16_f32 v221, v122, v123
    v_exp_f32 v125, v125
    v_mfma_f32_16x16x32_bf16 a[20:23], a[200:203], v[188:191], a[20:23]
    ds_read_b64_tr_b16 a[218:219], v8 offset:61440
    v_lshlrev_b32 v25, 4, v19
    s_mul_i32 s40, s5, 3072
    s_mul_i32 s41, s6, 10240
    s_add_u32 m0, s40, 86016
    s_add_u32 s41, s41, s40
    buffer_load_dwordx4 v25, s[96:99], s41 offen offset:0 lds
    buffer_load_dwordx4 v25, s[96:99], s41 offen offset:1024 lds
    buffer_load_dwordx4 v25, s[96:99], s41 offen offset:2048 lds
    v_exp_f32 v126, v126
    v_mfma_f32_16x16x32_bf16 a[20:23], a[204:207], v[192:195], a[20:23]
    ds_read_b64_tr_b16 a[220:221], v8 offset:0
    v_cvt_pk_bf16_f32 v228, v124, v125
    v_exp_f32 v127, v127
    v_mfma_f32_16x16x32_bf16 a[24:27], a[200:203], v[196:199], a[24:27]
    ds_read_b64_tr_b16 a[222:223], v8 offset:4096
    s_mul_i32 s46, s5, 10240
    s_mul_i32 s40, s100, 655360
    s_add_u32 s40, s40, 0x1400000
    s_add_u32 s20, s72, s40
    s_addc_u32 s21, s73, 0
    s_mov_b32 s22, 0xa0000
    s_mov_b32 s23, 0x20000
    s_mul_i32 s40, s5, 5120
    v_lshl_add_u32 v114, v19, 4, s40
    v_add_u32 v115, 4096, v114
    v_mfma_f32_16x16x32_bf16 a[24:27], a[204:207], v[200:203], a[24:27]
    v_exp_f32 v128, v128
    v_cvt_pk_bf16_f32 v229, v126, v127
    v_mfma_f32_16x16x32_bf16 a[28:31], a[200:203], v[204:207], a[28:31]
    v_exp_f32 v129, v129
    v_mfma_f32_16x16x32_bf16 a[28:31], a[204:207], v[208:211], a[28:31]
    v_exp_f32 v130, v130
    v_cvt_pk_bf16_f32 v236, v128, v129
    v_smfmac_f32_16x16x64_bf16 a[224:227], v[244:247], v[180:187], v248
    v_exp_f32 v131, v131
    s_waitcnt lgkmcnt(4)
    v_mfma_f32_16x16x32_bf16 a[32:35], a[208:211], v[180:183], a[32:35]
    v_exp_f32 v132, v132
    ds_read_b64_tr_b16 a[192:193], v9 offset:57344
    v_cvt_pk_bf16_f32 v237, v130, v131
    v_mfma_f32_16x16x32_bf16 a[32:35], a[212:215], v[184:187], a[32:35]
    v_exp_f32 v133, v133
    ds_read_b64_tr_b16 a[194:195], v9 offset:61440
    v_lshrrev_b32 v23, 4, v19
    s_mul_i32 s40, s5, 320
    s_mov_b32 s41, 0x280000
    v_not_b32 v22, v22
    v_and_b32 v22, 0x7ff, v22
    v_lshlrev_b32 v24, 3, v22
    v_mul_u32_u24 v22, 1280, v22
    v_lshl_add_u32 v22, v23, 4, v22
    buffer_load_dwordx2 v[20:21], v24, s[76:79], s41 offen sc1
    buffer_load_dwordx4 a[240:243], v22, s[88:91], s40 offen offset:0
    buffer_load_dwordx4 a[244:247], v22, s[88:91], s40 offen offset:64
    buffer_load_dwordx4 a[248:251], v22, s[88:91], s40 offen offset:128
    buffer_load_dwordx4 a[252:255], v22, s[88:91], s40 offen offset:192
    buffer_load_dwordx4 v[252:255], v22, s[88:91], s40 offen offset:256
    v_mfma_f32_16x16x32_bf16 a[36:39], a[208:211], v[188:191], a[36:39]
    v_exp_f32 v134, v134
    ds_read_b64_tr_b16 a[196:197], v9 offset:0
    v_cvt_pk_bf16_f32 v214, v132, v133
    v_mfma_f32_16x16x32_bf16 a[36:39], a[212:215], v[192:195], a[36:39]
    v_exp_f32 v135, v135
    ds_read_b64_tr_b16 a[198:199], v9 offset:4096
    v_mfma_f32_16x16x32_bf16 a[40:43], a[208:211], v[196:199], a[40:43]
    v_exp_f32 v136, v136
    v_cvt_pk_bf16_f32 v215, v134, v135
    v_mfma_f32_16x16x32_bf16 a[40:43], a[212:215], v[200:203], a[40:43]
    v_exp_f32 v137, v137
    v_mfma_f32_16x16x32_bf16 a[44:47], a[208:211], v[204:207], a[44:47]
    v_exp_f32 v138, v138
    v_cvt_pk_bf16_f32 v222, v136, v137
    v_mfma_f32_16x16x32_bf16 a[44:47], a[212:215], v[208:211], a[44:47]
    v_exp_f32 v139, v139
    s_waitcnt lgkmcnt(4)
    v_mfma_f32_16x16x32_bf16 a[48:51], a[216:219], v[180:183], a[48:51]
    v_exp_f32 v140, v140
    v_mfma_f32_16x16x32_bf16 a[48:51], a[220:223], v[184:187], a[48:51]
    ds_read_b64_tr_b16 a[200:201], v10 offset:57344
    v_cvt_pk_bf16_f32 v223, v138, v139
    v_exp_f32 v141, v141
    v_mfma_f32_16x16x32_bf16 a[52:55], a[216:219], v[188:191], a[52:55]
    ds_read_b64_tr_b16 a[202:203], v10 offset:61440
    s_add_u32 m0, s46, 122880
    s_mov_b32 s45, 286720
    buffer_load_dwordx4 v114, s[20:23], s45 offen offset:0 sc1 lds
    v_exp_f32 v142, v142
    v_mfma_f32_16x16x32_bf16 a[52:55], a[220:223], v[192:195], a[52:55]
    ds_read_b64_tr_b16 a[204:205], v10 offset:0
    v_cvt_pk_bf16_f32 v230, v140, v141
    v_exp_f32 v143, v143
    v_mfma_f32_16x16x32_bf16 a[56:59], a[216:219], v[196:199], a[56:59]
    ds_read_b64_tr_b16 a[206:207], v10 offset:4096
    buffer_load_dwordx4 v114, s[20:23], s45 offen offset:1024 sc1 lds
    v_mfma_f32_16x16x32_bf16 a[56:59], a[220:223], v[200:203], a[56:59]
    v_exp_f32 v144, v144
    v_cvt_pk_bf16_f32 v231, v142, v143
    v_mfma_f32_16x16x32_bf16 a[60:63], a[216:219], v[204:207], a[60:63]
    v_exp_f32 v145, v145
    v_mfma_f32_16x16x32_bf16 a[60:63], a[220:223], v[208:211], a[60:63]
    v_exp_f32 v146, v146
    v_cvt_pk_bf16_f32 v238, v144, v145
    v_smfmac_f32_16x16x64_bf16 a[228:231], v[244:247], v[188:195], v248
    v_exp_f32 v147, v147
    s_waitcnt lgkmcnt(4)
    v_mfma_f32_16x16x32_bf16 a[64:67], a[192:195], v[180:183], a[64:67]
    v_exp_f32 v148, v148
    ds_read_b64_tr_b16 a[208:209], v11 offset:57344
    v_cvt_pk_bf16_f32 v239, v146, v147
    v_mfma_f32_16x16x32_bf16 a[64:67], a[196:199], v[184:187], a[64:67]
    v_exp_f32 v149, v149
    ds_read_b64_tr_b16 a[210:211], v11 offset:61440
    buffer_load_dwordx4 v114, s[20:23], s45 offen offset:2048 sc1 lds
    v_mfma_f32_16x16x32_bf16 a[68:71], a[192:195], v[188:191], a[68:71]
    v_exp_f32 v150, v150
    ds_read_b64_tr_b16 a[212:213], v11 offset:0
    v_cvt_pk_bf16_f32 v216, v148, v149
    v_mfma_f32_16x16x32_bf16 a[68:71], a[196:199], v[192:195], a[68:71]
    v_exp_f32 v151, v151
    ds_read_b64_tr_b16 a[214:215], v11 offset:4096
    buffer_load_dwordx4 v114, s[20:23], s45 offen offset:3072 sc1 lds
    v_mfma_f32_16x16x32_bf16 a[72:75], a[192:195], v[196:199], a[72:75]
    v_exp_f32 v152, v152
    v_cvt_pk_bf16_f32 v217, v150, v151
    v_mfma_f32_16x16x32_bf16 a[72:75], a[196:199], v[200:203], a[72:75]
    v_exp_f32 v153, v153
    v_mfma_f32_16x16x32_bf16 a[76:79], a[192:195], v[204:207], a[76:79]
    v_exp_f32 v154, v154
    v_cvt_pk_bf16_f32 v224, v152, v153
    v_mfma_f32_16x16x32_bf16 a[76:79], a[196:199], v[208:211], a[76:79]
    v_exp_f32 v155, v155
    s_waitcnt lgkmcnt(4)
    v_mfma_f32_16x16x32_bf16 a[80:83], a[200:203], v[180:183], a[80:83]
    v_exp_f32 v156, v156
    v_mfma_f32_16x16x32_bf16 a[80:83], a[204:207], v[184:187], a[80:83]
    ds_read_b64_tr_b16 a[216:217], v12 offset:57344
    v_cvt_pk_bf16_f32 v225, v154, v155
    v_exp_f32 v157, v157
    v_mfma_f32_16x16x32_bf16 a[84:87], a[200:203], v[188:191], a[84:87]
    ds_read_b64_tr_b16 a[218:219], v12 offset:61440
    s_add_u32 m0, s46, 126976
    s_nop 0
    buffer_load_dwordx4 v115, s[20:23], s45 offen offset:0 sc1 lds
    v_exp_f32 v158, v158
    v_mfma_f32_16x16x32_bf16 a[84:87], a[204:207], v[192:195], a[84:87]
    ds_read_b64_tr_b16 a[220:221], v12 offset:0
    v_cvt_pk_bf16_f32 v232, v156, v157
    v_exp_f32 v159, v159
    v_mfma_f32_16x16x32_bf16 a[88:91], a[200:203], v[196:199], a[88:91]
    ds_read_b64_tr_b16 a[222:223], v12 offset:4096
    s_add_u32 m0, s46, 128000
    s_mov_b32 s45, 307200
    buffer_load_dwordx4 v114, s[20:23], s45 offen offset:0 sc1 lds
    v_mfma_f32_16x16x32_bf16 a[88:91], a[204:207], v[200:203], a[88:91]
    v_exp_f32 v160, v160
    v_cvt_pk_bf16_f32 v233, v158, v159
    v_mfma_f32_16x16x32_bf16 a[92:95], a[200:203], v[204:207], a[92:95]
    v_exp_f32 v161, v161
    v_mfma_f32_16x16x32_bf16 a[92:95], a[204:207], v[208:211], a[92:95]
    v_exp_f32 v162, v162
    v_cvt_pk_bf16_f32 v240, v160, v161
    v_smfmac_f32_16x16x64_bf16 a[232:235], v[244:247], v[196:203], v248
    v_exp_f32 v163, v163
    s_waitcnt vmcnt(15) lgkmcnt(4)
    s_barrier
    v_mfma_f32_16x16x32_bf16 a[96:99], a[208:211], v[180:183], a[96:99]
    v_exp_f32 v164, v164
    ds_read_b64_tr_b16 a[192:193], v5 offset:24576
    v_cvt_pk_bf16_f32 v241, v162, v163
    v_mfma_f32_16x16x32_bf16 a[96:99], a[212:215], v[184:187], a[96:99]
    v_exp_f32 v165, v165
    ds_read_b64_tr_b16 a[194:195], v5 offset:28672
    buffer_load_dwordx4 v114, s[20:23], s45 offen offset:1024 sc1 lds
    v_mfma_f32_16x16x32_bf16 a[100:103], a[208:211], v[188:191], a[100:103]
    v_exp_f32 v166, v166
    ds_read_b64_tr_b16 a[196:197], v5 offset:49152
    v_cvt_pk_bf16_f32 v218, v164, v165
    v_mfma_f32_16x16x32_bf16 a[100:103], a[212:215], v[192:195], a[100:103]
    v_exp_f32 v167, v167
    ds_read_b64_tr_b16 a[198:199], v5 offset:53248
    buffer_load_dwordx4 v114, s[20:23], s45 offen offset:2048 sc1 lds
    v_mfma_f32_16x16x32_bf16 a[104:107], a[208:211], v[196:199], a[104:107]
    v_exp_f32 v168, v168
    v_cvt_pk_bf16_f32 v219, v166, v167
    v_mfma_f32_16x16x32_bf16 a[104:107], a[212:215], v[200:203], a[104:107]
    v_exp_f32 v169, v169
    v_mfma_f32_16x16x32_bf16 a[108:111], a[208:211], v[204:207], a[108:111]
    v_exp_f32 v170, v170
    v_cvt_pk_bf16_f32 v226, v168, v169
    v_mfma_f32_16x16x32_bf16 a[108:111], a[212:215], v[208:211], a[108:111]
    v_exp_f32 v171, v171
    s_waitcnt lgkmcnt(4)
    v_mfma_f32_16x16x32_bf16 a[112:115], a[216:219], v[180:183], a[112:115]
    v_exp_f32 v172, v172
    v_mfma_f32_16x16x32_bf16 a[112:115], a[220:223], v[184:187], a[112:115]
    ds_read_b64_tr_b16 a[200:201], v6 offset:24576
    v_cvt_pk_bf16_f32 v227, v170, v171
    v_exp_f32 v173, v173
    v_mfma_f32_16x16x32_bf16 a[116:119], a[216:219], v[188:191], a[116:119]
    ds_read_b64_tr_b16 a[202:203], v6 offset:28672
    buffer_load_dwordx4 v114, s[20:23], s45 offen offset:3072 sc1 lds
    v_exp_f32 v174, v174
    v_mfma_f32_16x16x32_bf16 a[116:119], a[220:223], v[192:195], a[116:119]
    ds_read_b64_tr_b16 a[204:205], v6 offset:49152
    v_cvt_pk_bf16_f32 v234, v172, v173
    v_exp_f32 v175, v175
    v_mfma_f32_16x16x32_bf16 a[120:123], a[216:219], v[196:199], a[120:123]
    ds_read_b64_tr_b16 a[206:207], v6 offset:53248
    s_add_u32 m0, s46, 132096
    s_nop 0
    buffer_load_dwordx4 v115, s[20:23], s45 offen offset:0 sc1 lds
    v_mfma_f32_16x16x32_bf16 a[120:123], a[220:223], v[200:203], a[120:123]
    v_exp_f32 v176, v176
    v_cvt_pk_bf16_f32 v235, v174, v175
    v_mfma_f32_16x16x32_bf16 a[124:127], a[216:219], v[204:207], a[124:127]
    v_exp_f32 v177, v177
    v_mfma_f32_16x16x32_bf16 a[124:127], a[220:223], v[208:211], a[124:127]
    v_exp_f32 v178, v178
    v_cvt_pk_bf16_f32 v242, v176, v177
    v_smfmac_f32_16x16x64_bf16 a[236:239], v[244:247], v[204:211], v248
    v_exp_f32 v179, v179
    s_waitcnt lgkmcnt(4)
    v_mfma_f32_16x16x32_bf16 a[0:3], a[192:195], v[212:215], a[0:3]
    s_lshl_b32 s40, s87, 2
    s_add_u32 s40, s40, s5
    ds_read_b64_tr_b16 a[208:209], v7 offset:24576
    v_cvt_pk_bf16_f32 v243, v178, v179
    v_mfma_f32_16x16x32_bf16 a[0:3], a[196:199], v[216:219], a[0:3]
    s_lshl_b32 s40, s40, 4
    v_and_b32 v35, 15, v19
    v_add_u32 v35, s40, v35
    ds_read_b64_tr_b16 a[210:211], v7 offset:28672
    v_mul_u32_u24 v34, 1280, v35
    v_mfma_f32_16x16x32_bf16 a[4:7], a[192:195], v[220:223], a[4:7]
    v_lshrrev_b32 v116, 4, v19
    v_lshl_add_u32 v34, v116, 3, v34
    s_mul_i32 s40, s100, 160
    ds_read_b64_tr_b16 a[212:213], v7 offset:49152
    v_add_u32 v34, s40, v34
    v_mfma_f32_16x16x32_bf16 a[4:7], a[196:199], v[224:227], a[4:7]
    v_lshlrev_b32 v116, 3, v35
    s_mov_b32 s40, 0x280000
    ds_read_b64_tr_b16 a[214:215], v7 offset:53248
    buffer_load_dwordx2 v[32:33], v116, s[76:79], s40 offen sc1
    v_mfma_f32_16x16x32_bf16 a[8:11], a[192:195], v[228:231], a[8:11]
    buffer_load_dwordx2 v[22:23], v34, s[88:91], 0 offen offset:0
    buffer_load_dwordx2 v[24:25], v34, s[88:91], 0 offen offset:32
    buffer_load_dwordx2 v[26:27], v34, s[88:91], 0 offen offset:64
    buffer_load_dwordx2 v[28:29], v34, s[88:91], 0 offen offset:96
    v_mfma_f32_16x16x32_bf16 a[8:11], a[196:199], v[232:235], a[8:11]
    buffer_load_dwordx2 v[30:31], v34, s[88:91], 0 offen offset:128
    v_mfma_f32_16x16x32_bf16 a[12:15], a[192:195], v[236:239], a[12:15]
    v_mfma_f32_16x16x32_bf16 a[12:15], a[196:199], v[240:243], a[12:15]
    s_waitcnt lgkmcnt(4)
    v_mfma_f32_16x16x32_bf16 a[16:19], a[200:203], v[212:215], a[16:19]
    v_mfma_f32_16x16x32_bf16 a[16:19], a[204:207], v[216:219], a[16:19]
    ds_read_b64_tr_b16 a[216:217], v8 offset:24576
    v_mfma_f32_16x16x32_bf16 a[20:23], a[200:203], v[220:223], a[20:23]
    ds_read_b64_tr_b16 a[218:219], v8 offset:28672
    v_mfma_f32_16x16x32_bf16 a[20:23], a[204:207], v[224:227], a[20:23]
    ds_read_b64_tr_b16 a[220:221], v8 offset:49152
    v_mfma_f32_16x16x32_bf16 a[24:27], a[200:203], v[228:231], a[24:27]
    ds_read_b64_tr_b16 a[222:223], v8 offset:53248
    v_mfma_f32_16x16x32_bf16 a[24:27], a[204:207], v[232:235], a[24:27]
    v_mfma_f32_16x16x32_bf16 a[28:31], a[200:203], v[236:239], a[28:31]
    v_mfma_f32_16x16x32_bf16 a[28:31], a[204:207], v[240:243], a[28:31]
    v_smfmac_f32_16x16x64_bf16 a[224:227], v[244:247], v[212:219], v248
    s_waitcnt lgkmcnt(4)
    v_mfma_f32_16x16x32_bf16 a[32:35], a[208:211], v[212:215], a[32:35]
    ds_read_b64_tr_b16 a[192:193], v9 offset:24576
    v_mfma_f32_16x16x32_bf16 a[32:35], a[212:215], v[216:219], a[32:35]
    ds_read_b64_tr_b16 a[194:195], v9 offset:28672
    v_mfma_f32_16x16x32_bf16 a[36:39], a[208:211], v[220:223], a[36:39]
    ds_read_b64_tr_b16 a[196:197], v9 offset:49152
    v_mfma_f32_16x16x32_bf16 a[36:39], a[212:215], v[224:227], a[36:39]
    ds_read_b64_tr_b16 a[198:199], v9 offset:53248
    v_mfma_f32_16x16x32_bf16 a[40:43], a[208:211], v[228:231], a[40:43]
    v_mfma_f32_16x16x32_bf16 a[40:43], a[212:215], v[232:235], a[40:43]
    v_mfma_f32_16x16x32_bf16 a[44:47], a[208:211], v[236:239], a[44:47]
    v_mfma_f32_16x16x32_bf16 a[44:47], a[212:215], v[240:243], a[44:47]
    s_waitcnt lgkmcnt(4)
    v_mfma_f32_16x16x32_bf16 a[48:51], a[216:219], v[212:215], a[48:51]
    v_mfma_f32_16x16x32_bf16 a[48:51], a[220:223], v[216:219], a[48:51]
    ds_read_b64_tr_b16 a[200:201], v10 offset:24576
    v_mfma_f32_16x16x32_bf16 a[52:55], a[216:219], v[220:223], a[52:55]
    ds_read_b64_tr_b16 a[202:203], v10 offset:28672
    s_mov_b32 s45, 40960
    buffer_load_dwordx4 a[136:139], v114, s[20:23], s45 offen offset:0 sc1
    v_mfma_f32_16x16x32_bf16 a[52:55], a[220:223], v[224:227], a[52:55]
    ds_read_b64_tr_b16 a[204:205], v10 offset:49152
    v_mfma_f32_16x16x32_bf16 a[56:59], a[216:219], v[228:231], a[56:59]
    ds_read_b64_tr_b16 a[206:207], v10 offset:53248
    buffer_load_dwordx4 a[140:143], v114, s[20:23], s45 offen offset:1024 sc1
    v_mfma_f32_16x16x32_bf16 a[56:59], a[220:223], v[232:235], a[56:59]
    v_mfma_f32_16x16x32_bf16 a[60:63], a[216:219], v[236:239], a[60:63]
    v_mfma_f32_16x16x32_bf16 a[60:63], a[220:223], v[240:243], a[60:63]
    v_smfmac_f32_16x16x64_bf16 a[228:231], v[244:247], v[220:227], v248
    s_waitcnt lgkmcnt(4)
    v_mfma_f32_16x16x32_bf16 a[64:67], a[192:195], v[212:215], a[64:67]
    ds_read_b64_tr_b16 a[208:209], v11 offset:24576
    v_mfma_f32_16x16x32_bf16 a[64:67], a[196:199], v[216:219], a[64:67]
    ds_read_b64_tr_b16 a[210:211], v11 offset:28672
    buffer_load_dwordx4 a[144:147], v114, s[20:23], s45 offen offset:2048 sc1
    v_mfma_f32_16x16x32_bf16 a[68:71], a[192:195], v[220:223], a[68:71]
    ds_read_b64_tr_b16 a[212:213], v11 offset:49152
    v_mfma_f32_16x16x32_bf16 a[68:71], a[196:199], v[224:227], a[68:71]
    ds_read_b64_tr_b16 a[214:215], v11 offset:53248
    buffer_load_dwordx4 a[148:151], v114, s[20:23], s45 offen offset:3072 sc1
    v_mfma_f32_16x16x32_bf16 a[72:75], a[192:195], v[228:231], a[72:75]
    v_mfma_f32_16x16x32_bf16 a[72:75], a[196:199], v[232:235], a[72:75]
    v_mfma_f32_16x16x32_bf16 a[76:79], a[192:195], v[236:239], a[76:79]
    v_mfma_f32_16x16x32_bf16 a[76:79], a[196:199], v[240:243], a[76:79]
    s_waitcnt lgkmcnt(4)
    v_mfma_f32_16x16x32_bf16 a[80:83], a[200:203], v[212:215], a[80:83]
    v_mfma_f32_16x16x32_bf16 a[80:83], a[204:207], v[216:219], a[80:83]
    ds_read_b64_tr_b16 a[216:217], v12 offset:24576
    v_mfma_f32_16x16x32_bf16 a[84:87], a[200:203], v[220:223], a[84:87]
    ds_read_b64_tr_b16 a[218:219], v12 offset:28672
    buffer_load_dwordx4 a[152:155], v115, s[20:23], s45 offen offset:0 sc1
    v_mfma_f32_16x16x32_bf16 a[84:87], a[204:207], v[224:227], a[84:87]
    ds_read_b64_tr_b16 a[220:221], v12 offset:49152
    v_mfma_f32_16x16x32_bf16 a[88:91], a[200:203], v[228:231], a[88:91]
    ds_read_b64_tr_b16 a[222:223], v12 offset:53248
    s_mov_b32 s45, 61440
    buffer_load_dwordx4 a[156:159], v114, s[20:23], s45 offen offset:0 sc1
    v_mfma_f32_16x16x32_bf16 a[88:91], a[204:207], v[232:235], a[88:91]
    v_mfma_f32_16x16x32_bf16 a[92:95], a[200:203], v[236:239], a[92:95]
    v_mfma_f32_16x16x32_bf16 a[92:95], a[204:207], v[240:243], a[92:95]
    v_smfmac_f32_16x16x64_bf16 a[232:235], v[244:247], v[228:235], v248
    s_waitcnt lgkmcnt(4)
    v_mfma_f32_16x16x32_bf16 a[96:99], a[208:211], v[212:215], a[96:99]
    v_mfma_f32_16x16x32_bf16 a[96:99], a[212:215], v[216:219], a[96:99]
    buffer_load_dwordx4 a[160:163], v114, s[20:23], s45 offen offset:1024 sc1
    v_mfma_f32_16x16x32_bf16 a[100:103], a[208:211], v[220:223], a[100:103]
    v_mfma_f32_16x16x32_bf16 a[100:103], a[212:215], v[224:227], a[100:103]
    buffer_load_dwordx4 a[164:167], v114, s[20:23], s45 offen offset:2048 sc1
    v_mfma_f32_16x16x32_bf16 a[104:107], a[208:211], v[228:231], a[104:107]
    v_mfma_f32_16x16x32_bf16 a[104:107], a[212:215], v[232:235], a[104:107]
    v_mfma_f32_16x16x32_bf16 a[108:111], a[208:211], v[236:239], a[108:111]
    v_mfma_f32_16x16x32_bf16 a[108:111], a[212:215], v[240:243], a[108:111]
    s_waitcnt lgkmcnt(0)
    v_mfma_f32_16x16x32_bf16 a[112:115], a[216:219], v[212:215], a[112:115]
    v_mfma_f32_16x16x32_bf16 a[112:115], a[220:223], v[216:219], a[112:115]
    v_mfma_f32_16x16x32_bf16 a[116:119], a[216:219], v[220:223], a[116:119]
    buffer_load_dwordx4 a[168:171], v114, s[20:23], s45 offen offset:3072 sc1
    v_mfma_f32_16x16x32_bf16 a[116:119], a[220:223], v[224:227], a[116:119]
    v_mfma_f32_16x16x32_bf16 a[120:123], a[216:219], v[228:231], a[120:123]
    buffer_load_dwordx4 a[172:175], v115, s[20:23], s45 offen offset:0 sc1
    v_mfma_f32_16x16x32_bf16 a[120:123], a[220:223], v[232:235], a[120:123]
    v_mfma_f32_16x16x32_bf16 a[124:127], a[216:219], v[236:239], a[124:127]
    v_mfma_f32_16x16x32_bf16 a[124:127], a[220:223], v[240:243], a[124:127]
    v_smfmac_f32_16x16x64_bf16 a[236:239], v[244:247], v[236:243], v248
    s_nop 7
    v_accvgpr_read_b32 v100, a224
    v_accvgpr_read_b32 v101, a225
    v_accvgpr_read_b32 v102, a228
    v_accvgpr_read_b32 v103, a229
    v_accvgpr_read_b32 v104, a232
    v_accvgpr_read_b32 v105, a233
    v_accvgpr_read_b32 v106, a236
    v_accvgpr_read_b32 v107, a237
    v_add_f32 v100, v100, v101
    v_add_f32 v102, v102, v103
    v_add_f32 v104, v104, v105
    v_add_f32 v106, v106, v107
L_norm:
    v_maximum3_f32 v108, v100, v102, v104
    v_maximum3_f32 v108, v108, v106, v106
    v_mul_f32 v108, 0x6b800000, v108
    v_mov_b32 v109, 0
    v_accvgpr_read_b32 v116, a0
    v_accvgpr_read_b32 v117, a1
    v_accvgpr_read_b32 v118, a2
    v_accvgpr_read_b32 v119, a3
    v_maximum3_f32 v108, v108, |v116|, |v117|
    v_maximum3_f32 v109, v109, |v118|, |v119|
    v_accvgpr_read_b32 v120, a4
    v_accvgpr_read_b32 v121, a5
    v_accvgpr_read_b32 v122, a6
    v_accvgpr_read_b32 v123, a7
    v_maximum3_f32 v108, v108, |v120|, |v121|
    v_maximum3_f32 v109, v109, |v122|, |v123|
    v_accvgpr_read_b32 v124, a8
    v_accvgpr_read_b32 v125, a9
    v_accvgpr_read_b32 v126, a10
    v_accvgpr_read_b32 v127, a11
    v_maximum3_f32 v108, v108, |v124|, |v125|
    v_maximum3_f32 v109, v109, |v126|, |v127|
    v_accvgpr_read_b32 v128, a12
    v_accvgpr_read_b32 v129, a13
    v_accvgpr_read_b32 v130, a14
    v_accvgpr_read_b32 v131, a15
    v_maximum3_f32 v108, v108, |v128|, |v129|
    v_maximum3_f32 v109, v109, |v130|, |v131|
    v_accvgpr_read_b32 v132, a16
    v_accvgpr_read_b32 v133, a17
    v_accvgpr_read_b32 v134, a18
    v_accvgpr_read_b32 v135, a19
    v_maximum3_f32 v108, v108, |v132|, |v133|
    v_maximum3_f32 v109, v109, |v134|, |v135|
    v_accvgpr_read_b32 v136, a20
    v_accvgpr_read_b32 v137, a21
    v_accvgpr_read_b32 v138, a22
    v_accvgpr_read_b32 v139, a23
    v_maximum3_f32 v108, v108, |v136|, |v137|
    v_maximum3_f32 v109, v109, |v138|, |v139|
    v_accvgpr_read_b32 v140, a24
    v_accvgpr_read_b32 v141, a25
    v_accvgpr_read_b32 v142, a26
    v_accvgpr_read_b32 v143, a27
    v_maximum3_f32 v108, v108, |v140|, |v141|
    v_maximum3_f32 v109, v109, |v142|, |v143|
    v_accvgpr_read_b32 v144, a28
    v_accvgpr_read_b32 v145, a29
    v_accvgpr_read_b32 v146, a30
    v_accvgpr_read_b32 v147, a31
    v_maximum3_f32 v108, v108, |v144|, |v145|
    v_maximum3_f32 v109, v109, |v146|, |v147|
    v_accvgpr_read_b32 v148, a32
    v_accvgpr_read_b32 v149, a33
    v_accvgpr_read_b32 v150, a34
    v_accvgpr_read_b32 v151, a35
    v_maximum3_f32 v108, v108, |v148|, |v149|
    v_maximum3_f32 v109, v109, |v150|, |v151|
    v_accvgpr_read_b32 v152, a36
    v_accvgpr_read_b32 v153, a37
    v_accvgpr_read_b32 v154, a38
    v_accvgpr_read_b32 v155, a39
    v_maximum3_f32 v108, v108, |v152|, |v153|
    v_maximum3_f32 v109, v109, |v154|, |v155|
    v_accvgpr_read_b32 v156, a40
    v_accvgpr_read_b32 v157, a41
    v_accvgpr_read_b32 v158, a42
    v_accvgpr_read_b32 v159, a43
    v_maximum3_f32 v108, v108, |v156|, |v157|
    v_maximum3_f32 v109, v109, |v158|, |v159|
    v_accvgpr_read_b32 v160, a44
    v_accvgpr_read_b32 v161, a45
    v_accvgpr_read_b32 v162, a46
    v_accvgpr_read_b32 v163, a47
    v_maximum3_f32 v108, v108, |v160|, |v161|
    v_maximum3_f32 v109, v109, |v162|, |v163|
    v_accvgpr_read_b32 v164, a48
    v_accvgpr_read_b32 v165, a49
    v_accvgpr_read_b32 v166, a50
    v_accvgpr_read_b32 v167, a51
    v_maximum3_f32 v108, v108, |v164|, |v165|
    v_maximum3_f32 v109, v109, |v166|, |v167|
    v_accvgpr_read_b32 v168, a52
    v_accvgpr_read_b32 v169, a53
    v_accvgpr_read_b32 v170, a54
    v_accvgpr_read_b32 v171, a55
    v_maximum3_f32 v108, v108, |v168|, |v169|
    v_maximum3_f32 v109, v109, |v170|, |v171|
    v_accvgpr_read_b32 v172, a56
    v_accvgpr_read_b32 v173, a57
    v_accvgpr_read_b32 v174, a58
    v_accvgpr_read_b32 v175, a59
    v_maximum3_f32 v108, v108, |v172|, |v173|
    v_maximum3_f32 v109, v109, |v174|, |v175|
    v_accvgpr_read_b32 v176, a60
    v_accvgpr_read_b32 v177, a61
    v_accvgpr_read_b32 v178, a62
    v_accvgpr_read_b32 v179, a63
    v_maximum3_f32 v108, v108, |v176|, |v177|
    v_maximum3_f32 v109, v109, |v178|, |v179|
    v_accvgpr_read_b32 v180, a64
    v_accvgpr_read_b32 v181, a65
    v_accvgpr_read_b32 v182, a66
    v_accvgpr_read_b32 v183, a67
    v_maximum3_f32 v108, v108, |v180|, |v181|
    v_maximum3_f32 v109, v109, |v182|, |v183|
    v_accvgpr_read_b32 v184, a68
    v_accvgpr_read_b32 v185, a69
    v_accvgpr_read_b32 v186, a70
    v_accvgpr_read_b32 v187, a71
    v_maximum3_f32 v108, v108, |v184|, |v185|
    v_maximum3_f32 v109, v109, |v186|, |v187|
    v_accvgpr_read_b32 v188, a72
    v_accvgpr_read_b32 v189, a73
    v_accvgpr_read_b32 v190, a74
    v_accvgpr_read_b32 v191, a75
    v_maximum3_f32 v108, v108, |v188|, |v189|
    v_maximum3_f32 v109, v109, |v190|, |v191|
    v_accvgpr_read_b32 v192, a76
    v_accvgpr_read_b32 v193, a77
    v_accvgpr_read_b32 v194, a78
    v_accvgpr_read_b32 v195, a79
    v_maximum3_f32 v108, v108, |v192|, |v193|
    v_maximum3_f32 v109, v109, |v194|, |v195|
    v_accvgpr_read_b32 v196, a80
    v_accvgpr_read_b32 v197, a81
    v_accvgpr_read_b32 v198, a82
    v_accvgpr_read_b32 v199, a83
    v_maximum3_f32 v108, v108, |v196|, |v197|
    v_maximum3_f32 v109, v109, |v198|, |v199|
    v_accvgpr_read_b32 v200, a84
    v_accvgpr_read_b32 v201, a85
    v_accvgpr_read_b32 v202, a86
    v_accvgpr_read_b32 v203, a87
    v_maximum3_f32 v108, v108, |v200|, |v201|
    v_maximum3_f32 v109, v109, |v202|, |v203|
    v_accvgpr_read_b32 v204, a88
    v_accvgpr_read_b32 v205, a89
    v_accvgpr_read_b32 v206, a90
    v_accvgpr_read_b32 v207, a91
    v_maximum3_f32 v108, v108, |v204|, |v205|
    v_maximum3_f32 v109, v109, |v206|, |v207|
    v_accvgpr_read_b32 v208, a92
    v_accvgpr_read_b32 v209, a93
    v_accvgpr_read_b32 v210, a94
    v_accvgpr_read_b32 v211, a95
    v_maximum3_f32 v108, v108, |v208|, |v209|
    v_maximum3_f32 v109, v109, |v210|, |v211|
    v_accvgpr_read_b32 v212, a96
    v_accvgpr_read_b32 v213, a97
    v_accvgpr_read_b32 v214, a98
    v_accvgpr_read_b32 v215, a99
    v_maximum3_f32 v108, v108, |v212|, |v213|
    v_maximum3_f32 v109, v109, |v214|, |v215|
    v_accvgpr_read_b32 v216, a100
    v_accvgpr_read_b32 v217, a101
    v_accvgpr_read_b32 v218, a102
    v_accvgpr_read_b32 v219, a103
    v_maximum3_f32 v108, v108, |v216|, |v217|
    v_maximum3_f32 v109, v109, |v218|, |v219|
    v_accvgpr_read_b32 v220, a104
    v_accvgpr_read_b32 v221, a105
    v_accvgpr_read_b32 v222, a106
    v_accvgpr_read_b32 v223, a107
    v_maximum3_f32 v108, v108, |v220|, |v221|
    v_maximum3_f32 v109, v109, |v222|, |v223|
    v_accvgpr_read_b32 v224, a108
    v_accvgpr_read_b32 v225, a109
    v_accvgpr_read_b32 v226, a110
    v_accvgpr_read_b32 v227, a111
    v_maximum3_f32 v108, v108, |v224|, |v225|
    v_maximum3_f32 v109, v109, |v226|, |v227|
    v_accvgpr_read_b32 v228, a112
    v_accvgpr_read_b32 v229, a113
    v_accvgpr_read_b32 v230, a114
    v_accvgpr_read_b32 v231, a115
    v_maximum3_f32 v108, v108, |v228|, |v229|
    v_maximum3_f32 v109, v109, |v230|, |v231|
    v_accvgpr_read_b32 v232, a116
    v_accvgpr_read_b32 v233, a117
    v_accvgpr_read_b32 v234, a118
    v_accvgpr_read_b32 v235, a119
    v_maximum3_f32 v108, v108, |v232|, |v233|
    v_maximum3_f32 v109, v109, |v234|, |v235|
    v_accvgpr_read_b32 v236, a120
    v_accvgpr_read_b32 v237, a121
    v_accvgpr_read_b32 v238, a122
    v_accvgpr_read_b32 v239, a123
    v_maximum3_f32 v108, v108, |v236|, |v237|
    v_maximum3_f32 v109, v109, |v238|, |v239|
    v_accvgpr_read_b32 v240, a124
    v_accvgpr_read_b32 v241, a125
    v_accvgpr_read_b32 v242, a126
    v_accvgpr_read_b32 v243, a127
    v_maximum3_f32 v108, v108, |v240|, |v241|
    v_maximum3_f32 v109, v109, |v242|, |v243|
    v_rcp_f32 v100, v100
    v_rcp_f32 v102, v102
    v_rcp_f32 v104, v104
    v_rcp_f32 v106, v106
    v_maximum3_f32 v108, v108, v109, v109
    v_cmp_ngt_f32 vcc, 0x7f800000, v108
    v_lshlrev_b32 v110, 4, v19
    s_cbranch_vccnz L_slow
L_publish:
    s_mov_b32 s40, 0
    v_pk_mul_f32 v[116:117], v[116:117], v[100:101] op_sel_hi:[1,0]
    v_pk_mul_f32 v[118:119], v[118:119], v[100:101] op_sel_hi:[1,0]
    v_pk_mul_f32 v[132:133], v[132:133], v[100:101] op_sel_hi:[1,0]
    v_pk_mul_f32 v[134:135], v[134:135], v[100:101] op_sel_hi:[1,0]
    v_cvt_pk_bf16_f32 v36, v116, v117
    v_cvt_pk_bf16_f32 v37, v118, v119
    v_cvt_pk_bf16_f32 v38, v132, v133
    v_cvt_pk_bf16_f32 v39, v134, v135
    buffer_store_dwordx4 v[36:39], v110, s[24:27], s40 offen offset:0 sc1
    v_pk_mul_f32 v[120:121], v[120:121], v[102:103] op_sel_hi:[1,0]
    v_pk_mul_f32 v[122:123], v[122:123], v[102:103] op_sel_hi:[1,0]
    v_pk_mul_f32 v[136:137], v[136:137], v[102:103] op_sel_hi:[1,0]
    v_pk_mul_f32 v[138:139], v[138:139], v[102:103] op_sel_hi:[1,0]
    v_cvt_pk_bf16_f32 v40, v120, v121
    v_cvt_pk_bf16_f32 v41, v122, v123
    v_cvt_pk_bf16_f32 v42, v136, v137
    v_cvt_pk_bf16_f32 v43, v138, v139
    buffer_store_dwordx4 v[40:43], v110, s[24:27], s40 offen offset:1024 sc1
    v_pk_mul_f32 v[124:125], v[124:125], v[104:105] op_sel_hi:[1,0]
    v_pk_mul_f32 v[126:127], v[126:127], v[104:105] op_sel_hi:[1,0]
    v_pk_mul_f32 v[140:141], v[140:141], v[104:105] op_sel_hi:[1,0]
    v_pk_mul_f32 v[142:143], v[142:143], v[104:105] op_sel_hi:[1,0]
    v_cvt_pk_bf16_f32 v44, v124, v125
    v_cvt_pk_bf16_f32 v45, v126, v127
    v_cvt_pk_bf16_f32 v46, v140, v141
    v_cvt_pk_bf16_f32 v47, v142, v143
    buffer_store_dwordx4 v[44:47], v110, s[24:27], s40 offen offset:2048 sc1
    v_pk_mul_f32 v[128:129], v[128:129], v[106:107] op_sel_hi:[1,0]
    v_pk_mul_f32 v[130:131], v[130:131], v[106:107] op_sel_hi:[1,0]
    v_pk_mul_f32 v[144:145], v[144:145], v[106:107] op_sel_hi:[1,0]
    v_pk_mul_f32 v[146:147], v[146:147], v[106:107] op_sel_hi:[1,0]
    v_cvt_pk_bf16_f32 v48, v128, v129
    v_cvt_pk_bf16_f32 v49, v130, v131
    v_cvt_pk_bf16_f32 v50, v144, v145
    v_cvt_pk_bf16_f32 v51, v146, v147
    buffer_store_dwordx4 v[48:51], v110, s[24:27], s40 offen offset:3072 sc1
    s_mov_b32 s40, 4096
    v_pk_mul_f32 v[148:149], v[148:149], v[100:101] op_sel_hi:[1,0]
    v_pk_mul_f32 v[150:151], v[150:151], v[100:101] op_sel_hi:[1,0]
    v_pk_mul_f32 v[164:165], v[164:165], v[100:101] op_sel_hi:[1,0]
    v_pk_mul_f32 v[166:167], v[166:167], v[100:101] op_sel_hi:[1,0]
    v_cvt_pk_bf16_f32 v36, v148, v149
    v_cvt_pk_bf16_f32 v37, v150, v151
    v_cvt_pk_bf16_f32 v38, v164, v165
    v_cvt_pk_bf16_f32 v39, v166, v167
    buffer_store_dwordx4 v[36:39], v110, s[24:27], s40 offen offset:0 sc1
    v_pk_mul_f32 v[152:153], v[152:153], v[102:103] op_sel_hi:[1,0]
    v_pk_mul_f32 v[154:155], v[154:155], v[102:103] op_sel_hi:[1,0]
    v_pk_mul_f32 v[168:169], v[168:169], v[102:103] op_sel_hi:[1,0]
    v_pk_mul_f32 v[170:171], v[170:171], v[102:103] op_sel_hi:[1,0]
    v_cvt_pk_bf16_f32 v40, v152, v153
    v_cvt_pk_bf16_f32 v41, v154, v155
    v_cvt_pk_bf16_f32 v42, v168, v169
    v_cvt_pk_bf16_f32 v43, v170, v171
    buffer_store_dwordx4 v[40:43], v110, s[24:27], s40 offen offset:1024 sc1
    v_pk_mul_f32 v[156:157], v[156:157], v[104:105] op_sel_hi:[1,0]
    v_pk_mul_f32 v[158:159], v[158:159], v[104:105] op_sel_hi:[1,0]
    v_pk_mul_f32 v[172:173], v[172:173], v[104:105] op_sel_hi:[1,0]
    v_pk_mul_f32 v[174:175], v[174:175], v[104:105] op_sel_hi:[1,0]
    v_cvt_pk_bf16_f32 v44, v156, v157
    v_cvt_pk_bf16_f32 v45, v158, v159
    v_cvt_pk_bf16_f32 v46, v172, v173
    v_cvt_pk_bf16_f32 v47, v174, v175
    buffer_store_dwordx4 v[44:47], v110, s[24:27], s40 offen offset:2048 sc1
    v_pk_mul_f32 v[160:161], v[160:161], v[106:107] op_sel_hi:[1,0]
    v_pk_mul_f32 v[162:163], v[162:163], v[106:107] op_sel_hi:[1,0]
    v_pk_mul_f32 v[176:177], v[176:177], v[106:107] op_sel_hi:[1,0]
    v_pk_mul_f32 v[178:179], v[178:179], v[106:107] op_sel_hi:[1,0]
    v_cvt_pk_bf16_f32 v48, v160, v161
    v_cvt_pk_bf16_f32 v49, v162, v163
    v_cvt_pk_bf16_f32 v50, v176, v177
    v_cvt_pk_bf16_f32 v51, v178, v179
    buffer_store_dwordx4 v[48:51], v110, s[24:27], s40 offen offset:3072 sc1
    s_mov_b32 s40, 8192
    v_pk_mul_f32 v[180:181], v[180:181], v[100:101] op_sel_hi:[1,0]
    v_pk_mul_f32 v[182:183], v[182:183], v[100:101] op_sel_hi:[1,0]
    v_pk_mul_f32 v[196:197], v[196:197], v[100:101] op_sel_hi:[1,0]
    v_pk_mul_f32 v[198:199], v[198:199], v[100:101] op_sel_hi:[1,0]
    v_cvt_pk_bf16_f32 v36, v180, v181
    v_cvt_pk_bf16_f32 v37, v182, v183
    v_cvt_pk_bf16_f32 v38, v196, v197
    v_cvt_pk_bf16_f32 v39, v198, v199
    buffer_store_dwordx4 v[36:39], v110, s[24:27], s40 offen offset:0 sc1
    v_pk_mul_f32 v[184:185], v[184:185], v[102:103] op_sel_hi:[1,0]
    v_pk_mul_f32 v[186:187], v[186:187], v[102:103] op_sel_hi:[1,0]
    v_pk_mul_f32 v[200:201], v[200:201], v[102:103] op_sel_hi:[1,0]
    v_pk_mul_f32 v[202:203], v[202:203], v[102:103] op_sel_hi:[1,0]
    v_cvt_pk_bf16_f32 v40, v184, v185
    v_cvt_pk_bf16_f32 v41, v186, v187
    v_cvt_pk_bf16_f32 v42, v200, v201
    v_cvt_pk_bf16_f32 v43, v202, v203
    buffer_store_dwordx4 v[40:43], v110, s[24:27], s40 offen offset:1024 sc1
    v_pk_mul_f32 v[188:189], v[188:189], v[104:105] op_sel_hi:[1,0]
    v_pk_mul_f32 v[190:191], v[190:191], v[104:105] op_sel_hi:[1,0]
    v_pk_mul_f32 v[204:205], v[204:205], v[104:105] op_sel_hi:[1,0]
    v_pk_mul_f32 v[206:207], v[206:207], v[104:105] op_sel_hi:[1,0]
    v_cvt_pk_bf16_f32 v44, v188, v189
    v_cvt_pk_bf16_f32 v45, v190, v191
    v_cvt_pk_bf16_f32 v46, v204, v205
    v_cvt_pk_bf16_f32 v47, v206, v207
    buffer_store_dwordx4 v[44:47], v110, s[24:27], s40 offen offset:2048 sc1
    v_pk_mul_f32 v[192:193], v[192:193], v[106:107] op_sel_hi:[1,0]
    v_pk_mul_f32 v[194:195], v[194:195], v[106:107] op_sel_hi:[1,0]
    v_pk_mul_f32 v[208:209], v[208:209], v[106:107] op_sel_hi:[1,0]
    v_pk_mul_f32 v[210:211], v[210:211], v[106:107] op_sel_hi:[1,0]
    v_cvt_pk_bf16_f32 v48, v192, v193
    v_cvt_pk_bf16_f32 v49, v194, v195
    v_cvt_pk_bf16_f32 v50, v208, v209
    v_cvt_pk_bf16_f32 v51, v210, v211
    buffer_store_dwordx4 v[48:51], v110, s[24:27], s40 offen offset:3072 sc1
    s_mov_b32 s40, 12288
    v_pk_mul_f32 v[212:213], v[212:213], v[100:101] op_sel_hi:[1,0]
    v_pk_mul_f32 v[214:215], v[214:215], v[100:101] op_sel_hi:[1,0]
    v_pk_mul_f32 v[228:229], v[228:229], v[100:101] op_sel_hi:[1,0]
    v_pk_mul_f32 v[230:231], v[230:231], v[100:101] op_sel_hi:[1,0]
    v_cvt_pk_bf16_f32 v36, v212, v213
    v_cvt_pk_bf16_f32 v37, v214, v215
    v_cvt_pk_bf16_f32 v38, v228, v229
    v_cvt_pk_bf16_f32 v39, v230, v231
    buffer_store_dwordx4 v[36:39], v110, s[24:27], s40 offen offset:0 sc1
    v_pk_mul_f32 v[216:217], v[216:217], v[102:103] op_sel_hi:[1,0]
    v_pk_mul_f32 v[218:219], v[218:219], v[102:103] op_sel_hi:[1,0]
    v_pk_mul_f32 v[232:233], v[232:233], v[102:103] op_sel_hi:[1,0]
    v_pk_mul_f32 v[234:235], v[234:235], v[102:103] op_sel_hi:[1,0]
    v_cvt_pk_bf16_f32 v40, v216, v217
    v_cvt_pk_bf16_f32 v41, v218, v219
    v_cvt_pk_bf16_f32 v42, v232, v233
    v_cvt_pk_bf16_f32 v43, v234, v235
    buffer_store_dwordx4 v[40:43], v110, s[24:27], s40 offen offset:1024 sc1
    v_pk_mul_f32 v[220:221], v[220:221], v[104:105] op_sel_hi:[1,0]
    v_pk_mul_f32 v[222:223], v[222:223], v[104:105] op_sel_hi:[1,0]
    v_pk_mul_f32 v[236:237], v[236:237], v[104:105] op_sel_hi:[1,0]
    v_pk_mul_f32 v[238:239], v[238:239], v[104:105] op_sel_hi:[1,0]
    v_cvt_pk_bf16_f32 v44, v220, v221
    v_cvt_pk_bf16_f32 v45, v222, v223
    v_cvt_pk_bf16_f32 v46, v236, v237
    v_cvt_pk_bf16_f32 v47, v238, v239
    buffer_store_dwordx4 v[44:47], v110, s[24:27], s40 offen offset:2048 sc1
    v_pk_mul_f32 v[224:225], v[224:225], v[106:107] op_sel_hi:[1,0]
    v_pk_mul_f32 v[226:227], v[226:227], v[106:107] op_sel_hi:[1,0]
    v_pk_mul_f32 v[240:241], v[240:241], v[106:107] op_sel_hi:[1,0]
    v_pk_mul_f32 v[242:243], v[242:243], v[106:107] op_sel_hi:[1,0]
    v_cvt_pk_bf16_f32 v48, v224, v225
    v_cvt_pk_bf16_f32 v49, v226, v227
    v_cvt_pk_bf16_f32 v50, v240, v241
    v_cvt_pk_bf16_f32 v51, v242, v243
    buffer_store_dwordx4 v[48:51], v110, s[24:27], s40 offen offset:3072 sc1
    v_mov_b32 v16, v114
    v_mov_b32 v17, v115
    v_mov_b32 v3, v249
    v_mov_b32 v2, 1
    s_waitcnt vmcnt(26)
    v_lshlrev_b32 v166, 16, v22
    v_and_b32 v167, 0xffff0000, v22
    v_lshlrev_b32 v168, 16, v23
    v_and_b32 v169, 0xffff0000, v23
    v_lshlrev_b32 v170, 16, v24
    v_and_b32 v171, 0xffff0000, v24
    v_lshlrev_b32 v172, 16, v25
    v_and_b32 v173, 0xffff0000, v25
    v_lshlrev_b32 v174, 16, v26
    v_and_b32 v175, 0xffff0000, v26
    v_lshlrev_b32 v176, 16, v27
    v_and_b32 v177, 0xffff0000, v27
    v_lshlrev_b32 v178, 16, v28
    v_and_b32 v179, 0xffff0000, v28
    v_lshlrev_b32 v180, 16, v29
    v_and_b32 v181, 0xffff0000, v29
    v_lshlrev_b32 v182, 16, v30
    v_and_b32 v183, 0xffff0000, v30
    v_lshlrev_b32 v184, 16, v31
    v_and_b32 v185, 0xffff0000, v31
    v_sub_f32 v166, v166, v32
    v_sub_f32 v167, v167, v32
    v_sub_f32 v168, v168, v32
    v_sub_f32 v169, v169, v32
    v_sub_f32 v170, v170, v32
    v_sub_f32 v171, v171, v32
    v_sub_f32 v172, v172, v32
    v_sub_f32 v173, v173, v32
    v_sub_f32 v174, v174, v32
    v_sub_f32 v175, v175, v32
    v_sub_f32 v176, v176, v32
    v_sub_f32 v177, v177, v32
    v_sub_f32 v178, v178, v32
    v_sub_f32 v179, v179, v32
    v_sub_f32 v180, v180, v32
    v_sub_f32 v181, v181, v32
    v_sub_f32 v182, v182, v32
    v_sub_f32 v183, v183, v32
    v_sub_f32 v184, v184, v32
    v_sub_f32 v185, v185, v32
    v_cvt_pk_bf16_f32 v186, v166, v167
    v_cvt_pk_bf16_f32 v187, v168, v169
    v_cvt_pk_bf16_f32 v188, v170, v171
    v_cvt_pk_bf16_f32 v189, v172, v173
    v_cvt_pk_bf16_f32 v190, v174, v175
    v_cvt_pk_bf16_f32 v191, v176, v177
    v_cvt_pk_bf16_f32 v192, v178, v179
    v_cvt_pk_bf16_f32 v193, v180, v181
    v_cvt_pk_bf16_f32 v194, v182, v183
    v_cvt_pk_bf16_f32 v195, v184, v185
    v_lshlrev_b32 v166, 16, v186
    v_and_b32 v167, 0xffff0000, v186
    v_lshlrev_b32 v168, 16, v187
    v_and_b32 v169, 0xffff0000, v187
    v_lshlrev_b32 v170, 16, v188
    v_and_b32 v171, 0xffff0000, v188
    v_lshlrev_b32 v172, 16, v189
    v_and_b32 v173, 0xffff0000, v189
    v_lshlrev_b32 v174, 16, v190
    v_and_b32 v175, 0xffff0000, v190
    v_lshlrev_b32 v176, 16, v191
    v_and_b32 v177, 0xffff0000, v191
    v_lshlrev_b32 v178, 16, v192
    v_and_b32 v179, 0xffff0000, v192
    v_lshlrev_b32 v180, 16, v193
    v_and_b32 v181, 0xffff0000, v193
    v_lshlrev_b32 v182, 16, v194
    v_and_b32 v183, 0xffff0000, v194
    v_lshlrev_b32 v184, 16, v195
    v_and_b32 v185, 0xffff0000, v195
    v_mul_f32 v166, v166, v33
    v_mul_f32 v167, v167, v33
    v_mul_f32 v168, v168, v33
    v_mul_f32 v169, v169, v33
    v_mul_f32 v170, v170, v33
    v_mul_f32 v171, v171, v33
    v_mul_f32 v172, v172, v33
    v_mul_f32 v173, v173, v33
    v_mul_f32 v174, v174, v33
    v_mul_f32 v175, v175, v33
    s_waitcnt vmcnt(0)
    s_mov_b64 exec, 1
    buffer_store_dword v2, off, s[76:79], s58 sc1
    s_mov_b64 exec, -1
    v_mul_f32 v176, v176, v33
    v_mul_f32 v177, v177, v33
    v_mul_f32 v178, v178, v33
    v_mul_f32 v179, v179, v33
    v_mul_f32 v180, v180, v33
    v_mul_f32 v181, v181, v33
    v_mul_f32 v182, v182, v33
    s_mov_b32 s45, 0
    buffer_load_dwordx4 a[96:99], v16, s[20:23], s45 offen offset:0 sc1
    v_mul_f32 v183, v183, v33
    v_mul_f32 v184, v184, v33
    v_mul_f32 v185, v185, v33
    v_cvt_pk_bf16_f32 v186, v166, v167
    v_cvt_pk_bf16_f32 v187, v168, v169
    v_cvt_pk_bf16_f32 v188, v170, v171
    v_cvt_pk_bf16_f32 v189, v172, v173
    buffer_load_dwordx4 a[100:103], v16, s[20:23], s45 offen offset:1024 sc1
    v_cvt_pk_bf16_f32 v190, v174, v175
    v_cvt_pk_bf16_f32 v191, v176, v177
    v_cvt_pk_bf16_f32 v192, v178, v179
    v_cvt_pk_bf16_f32 v193, v180, v181
    v_cvt_pk_bf16_f32 v194, v182, v183
    v_cvt_pk_bf16_f32 v195, v184, v185
    v_lshlrev_b32 v166, 16, v186
    buffer_load_dwordx4 a[104:107], v16, s[20:23], s45 offen offset:2048 sc1
    v_and_b32 v167, 0xffff0000, v186
    v_lshlrev_b32 v168, 16, v187
    v_and_b32 v169, 0xffff0000, v187
    v_lshlrev_b32 v170, 16, v188
    v_and_b32 v171, 0xffff0000, v188
    v_lshlrev_b32 v172, 16, v189
    v_and_b32 v173, 0xffff0000, v189
    buffer_load_dwordx4 a[108:111], v16, s[20:23], s45 offen offset:3072 sc1
    v_lshlrev_b32 v174, 16, v190
    v_and_b32 v175, 0xffff0000, v190
    v_lshlrev_b32 v176, 16, v191
    v_and_b32 v177, 0xffff0000, v191
    v_lshlrev_b32 v178, 16, v192
    v_and_b32 v179, 0xffff0000, v192
    v_lshlrev_b32 v180, 16, v193
    buffer_load_dwordx4 a[112:115], v17, s[20:23], s45 offen offset:0 sc1
    v_and_b32 v181, 0xffff0000, v193
    v_lshlrev_b32 v182, 16, v194
    v_and_b32 v183, 0xffff0000, v194
    v_lshlrev_b32 v184, 16, v195
    v_and_b32 v185, 0xffff0000, v195
    v_mul_f32 v186, 0xbfb8aa3b, v166
    v_mul_f32 v187, 0xbfb8aa3b, v167
    s_mov_b32 s45, 20480
    buffer_load_dwordx4 a[116:119], v16, s[20:23], s45 offen offset:0 sc1
    v_mul_f32 v188, 0xbfb8aa3b, v168
    v_mul_f32 v189, 0xbfb8aa3b, v169
    v_mul_f32 v190, 0xbfb8aa3b, v170
    v_mul_f32 v191, 0xbfb8aa3b, v171
    v_mul_f32 v192, 0xbfb8aa3b, v172
    v_mul_f32 v193, 0xbfb8aa3b, v173
    v_mul_f32 v194, 0xbfb8aa3b, v174
    buffer_load_dwordx4 a[120:123], v16, s[20:23], s45 offen offset:1024 sc1
    v_mul_f32 v195, 0xbfb8aa3b, v175
    v_mul_f32 v196, 0xbfb8aa3b, v176
    v_mul_f32 v197, 0xbfb8aa3b, v177
    v_mul_f32 v198, 0xbfb8aa3b, v178
    v_mul_f32 v199, 0xbfb8aa3b, v179
    v_mul_f32 v200, 0xbfb8aa3b, v180
    v_mul_f32 v201, 0xbfb8aa3b, v181
    buffer_load_dwordx4 a[124:127], v16, s[20:23], s45 offen offset:2048 sc1
    v_mul_f32 v202, 0xbfb8aa3b, v182
    v_mul_f32 v203, 0xbfb8aa3b, v183
    v_mul_f32 v204, 0xbfb8aa3b, v184
    v_mul_f32 v205, 0xbfb8aa3b, v185
    v_exp_f32 v186, v186
    v_exp_f32 v187, v187
    v_exp_f32 v188, v188
    buffer_load_dwordx4 a[128:131], v16, s[20:23], s45 offen offset:3072 sc1
    v_exp_f32 v189, v189
    v_exp_f32 v190, v190
    v_exp_f32 v191, v191
    v_exp_f32 v192, v192
    v_exp_f32 v193, v193
    v_exp_f32 v194, v194
    v_exp_f32 v195, v195
    buffer_load_dwordx4 a[132:135], v17, s[20:23], s45 offen offset:0 sc1
    v_exp_f32 v196, v196
    v_exp_f32 v197, v197
    v_exp_f32 v198, v198
    v_exp_f32 v199, v199
    v_exp_f32 v200, v200
    v_exp_f32 v201, v201
    v_exp_f32 v202, v202
    s_mov_b32 s45, 81920
    buffer_load_dwordx4 a[176:179], v16, s[20:23], s45 offen offset:0 sc1
    v_exp_f32 v203, v203
    v_exp_f32 v204, v204
    v_exp_f32 v205, v205
    v_add_f32 v186, 1.0, v186
    v_add_f32 v187, 1.0, v187
    v_add_f32 v188, 1.0, v188
    v_add_f32 v189, 1.0, v189
    buffer_load_dwordx4 a[180:183], v16, s[20:23], s45 offen offset:1024 sc1
    v_add_f32 v190, 1.0, v190
    v_add_f32 v191, 1.0, v191
    v_add_f32 v192, 1.0, v192
    v_add_f32 v193, 1.0, v193
    v_add_f32 v194, 1.0, v194
    v_add_f32 v195, 1.0, v195
    v_add_f32 v196, 1.0, v196
    buffer_load_dwordx4 a[184:187], v16, s[20:23], s45 offen offset:2048 sc1
    v_add_f32 v197, 1.0, v197
    v_add_f32 v198, 1.0, v198
    v_add_f32 v199, 1.0, v199
    v_add_f32 v200, 1.0, v200
    v_add_f32 v201, 1.0, v201
    v_add_f32 v202, 1.0, v202
    v_add_f32 v203, 1.0, v203
    buffer_load_dwordx4 a[188:191], v16, s[20:23], s45 offen offset:3072 sc1
    v_add_f32 v204, 1.0, v204
    v_add_f32 v205, 1.0, v205
    v_rcp_f32 v186, v186
    v_rcp_f32 v187, v187
    v_rcp_f32 v188, v188
    v_rcp_f32 v189, v189
    v_rcp_f32 v190, v190
    buffer_load_dwordx4 a[192:195], v17, s[20:23], s45 offen offset:0 sc1
    v_rcp_f32 v191, v191
    v_rcp_f32 v192, v192
    v_rcp_f32 v193, v193
    v_rcp_f32 v194, v194
    v_rcp_f32 v195, v195
    v_rcp_f32 v196, v196
    v_rcp_f32 v197, v197
    s_mov_b32 s45, 102400
    buffer_load_dwordx4 a[196:199], v16, s[20:23], s45 offen offset:0 sc1
    v_rcp_f32 v198, v198
    v_rcp_f32 v199, v199
    v_rcp_f32 v200, v200
    v_rcp_f32 v201, v201
    v_rcp_f32 v202, v202
    v_rcp_f32 v203, v203
    v_rcp_f32 v204, v204
    buffer_load_dwordx4 a[200:203], v16, s[20:23], s45 offen offset:1024 sc1
    v_rcp_f32 v205, v205
    v_mul_f32 v166, v166, v186
    v_mul_f32 v167, v167, v187
    v_mul_f32 v168, v168, v188
    v_mul_f32 v169, v169, v189
    v_mul_f32 v170, v170, v190
    v_mul_f32 v171, v171, v191
    buffer_load_dwordx4 a[204:207], v16, s[20:23], s45 offen offset:2048 sc1
    v_mul_f32 v172, v172, v192
    v_mul_f32 v173, v173, v193
    v_mul_f32 v174, v174, v194
    v_mul_f32 v175, v175, v195
    v_mul_f32 v176, v176, v196
    v_mul_f32 v177, v177, v197
    v_mul_f32 v178, v178, v198
    buffer_load_dwordx4 a[208:211], v16, s[20:23], s45 offen offset:3072 sc1
    v_mul_f32 v179, v179, v199
    v_mul_f32 v180, v180, v200
    v_mul_f32 v181, v181, v201
    v_mul_f32 v182, v182, v202
    v_mul_f32 v183, v183, v203
    v_mul_f32 v184, v184, v204
    v_mul_f32 v185, v185, v205
    buffer_load_dwordx4 a[212:215], v17, s[20:23], s45 offen offset:0 sc1
    v_cvt_pk_bf16_f32 v36, v166, v167
    v_cvt_pk_bf16_f32 v37, v168, v169
    v_cvt_pk_bf16_f32 v38, v170, v171
    v_cvt_pk_bf16_f32 v39, v172, v173
    v_cvt_pk_bf16_f32 v40, v174, v175
    v_cvt_pk_bf16_f32 v41, v176, v177
    v_cvt_pk_bf16_f32 v42, v178, v179
    s_mov_b32 s45, 163840
    buffer_load_dwordx4 v[46:49], v16, s[20:23], s45 offen offset:0 sc1
    v_cvt_pk_bf16_f32 v43, v180, v181
    v_cvt_pk_bf16_f32 v44, v182, v183
    v_cvt_pk_bf16_f32 v45, v184, v185
    v_accvgpr_read_b32 v206, a240
    v_accvgpr_read_b32 v207, a241
    v_accvgpr_read_b32 v208, a242
    v_accvgpr_read_b32 v209, a243
    buffer_load_dwordx4 v[50:53], v16, s[20:23], s45 offen offset:1024 sc1
    v_accvgpr_read_b32 v210, a244
    v_accvgpr_read_b32 v211, a245
    v_accvgpr_read_b32 v212, a246
    v_accvgpr_read_b32 v213, a247
    v_accvgpr_read_b32 v214, a248
    v_accvgpr_read_b32 v215, a249
    v_accvgpr_read_b32 v216, a250
    buffer_load_dwordx4 v[54:57], v16, s[20:23], s45 offen offset:2048 sc1
    v_accvgpr_read_b32 v217, a251
    v_accvgpr_read_b32 v218, a252
    v_accvgpr_read_b32 v219, a253
    v_accvgpr_read_b32 v220, a254
    v_accvgpr_read_b32 v221, a255
    v_mov_b32 v222, v252
    v_mov_b32 v223, v253
    buffer_load_dwordx4 v[58:61], v16, s[20:23], s45 offen offset:3072 sc1
    v_mov_b32 v224, v254
    v_mov_b32 v225, v255
    v_mov_b32 v226, v20
    v_mov_b32 v227, v21
    s_lshl_b32 s40, s87, 19
    s_add_u32 s40, s40, 0x400000
    s_add_u32 s8, s72, s40
    s_addc_u32 s9, s73, 0
    buffer_load_dwordx4 v[62:65], v17, s[20:23], s45 offen offset:0 sc1
    s_mov_b32 s10, 0x80000
    s_mov_b32 s11, 0x20000
    s_mov_b32 s12, s68
    s_mov_b32 s13, s69
    s_mov_b32 s14, 0x280000
    s_mov_b32 s15, 0x20000
    s_mov_b32 s45, 184320
    buffer_load_dwordx4 v[66:69], v16, s[20:23], s45 offen offset:0 sc1
    s_add_u32 s16, s72, 0x1a00000
    s_addc_u32 s17, s73, 0
    s_mov_b32 s18, 0x438000
    s_mov_b32 s19, 0x20000
    s_add_u32 s40, s5, 0
    s_and_b32 s40, s40, 3
    s_lshl_b32 s41, s5, 2
    buffer_load_dwordx4 v[70:73], v16, s[20:23], s45 offen offset:1024 sc1
    s_add_u32 s41, s41, s40
    s_lshl_b32 s41, s41, 10
    v_lshl_add_u32 v4, v19, 4, s41
    s_add_u32 s40, s5, 1
    s_and_b32 s40, s40, 3
    s_lshl_b32 s41, s5, 2
    s_add_u32 s41, s41, s40
    buffer_load_dwordx4 v[74:77], v16, s[20:23], s45 offen offset:2048 sc1
    s_lshl_b32 s41, s41, 10
    v_lshl_add_u32 v5, v19, 4, s41
    s_add_u32 s40, s5, 2
    s_and_b32 s40, s40, 3
    s_lshl_b32 s41, s5, 2
    s_add_u32 s41, s41, s40
    s_lshl_b32 s41, s41, 10
    buffer_load_dwordx4 v[78:81], v16, s[20:23], s45 offen offset:3072 sc1
    v_lshl_add_u32 v6, v19, 4, s41
    s_add_u32 s40, s5, 3
    s_and_b32 s40, s40, 3
    s_lshl_b32 s41, s5, 2
    s_add_u32 s41, s41, s40
    s_lshl_b32 s41, s41, 10
    v_lshl_add_u32 v7, v19, 4, s41
    buffer_load_dwordx4 v[82:85], v17, s[20:23], s45 offen offset:0 sc1
    v_lshl_add_u32 v9, v19, 4, s46
    v_add_u32 v10, 81920, v9
    s_barrier
    v_lshrrev_b32 v228, 4, v19
    v_bfe_u32 v229, v19, 2, 2
    v_lshl_add_u32 v228, v228, 3, v229
    v_lshlrev_b32 v228, 4, v228
    s_mov_b32 s45, 204800
    buffer_load_dwordx4 v[86:89], v16, s[20:23], s45 offen offset:0 sc1
    v_and_b32 v229, 1, v19
    v_lshl_add_u32 v228, v229, 3, v228
    v_bfe_u32 v229, v19, 1, 1
    v_mul_u32_u24 v229, 10240, v229
    s_mul_i32 s40, s5, 2560
    s_add_u32 s40, s40, 65536
    v_add3_u32 v228, v228, v229, s40
    buffer_load_dwordx4 v[90:93], v16, s[20:23], s45 offen offset:1024 sc1
    ds_read_b64_tr_b16 a[0:1], v228 offset:0
    ds_read_b64_tr_b16 a[2:3], v228 offset:64
    ds_read_b64_tr_b16 a[4:5], v228 offset:512
    ds_read_b64_tr_b16 a[6:7], v228 offset:576
    ds_read_b64_tr_b16 a[8:9], v228 offset:1024
    ds_read_b64_tr_b16 a[10:11], v228 offset:1088
    ds_read_b64_tr_b16 a[12:13], v228 offset:1536
    buffer_load_dwordx4 v[94:97], v16, s[20:23], s45 offen offset:2048 sc1
    ds_read_b64_tr_b16 a[14:15], v228 offset:1600
    ds_read_b64_tr_b16 a[16:17], v228 offset:2048
    ds_read_b64_tr_b16 a[18:19], v228 offset:2112
    v_and_b32 v229, 8, v19
    v_cmp_eq_u32 vcc, 0, v229
    v_mov_b32 v230, 0x3f803f80
    s_lshl_b32 s40, s5, 10
    buffer_load_dwordx4 v[98:101], v16, s[20:23], s45 offen offset:3072 sc1
    v_lshlrev_b32 v231, 4, v19
    v_add_u32 v231, 102400, v231
    v_add_u32 v232, s40, v231
    v_cndmask_b32 v206, v230, v206, vcc
    v_cndmask_b32 v207, v230, v207, vcc
    v_cndmask_b32 v208, v230, v208, vcc
    v_cndmask_b32 v209, v230, v209, vcc
    buffer_load_dwordx4 v[102:105], v17, s[20:23], s45 offen offset:0 sc1
    v_cndmask_b32 v210, v230, v210, vcc
    v_cndmask_b32 v211, v230, v211, vcc
    v_cndmask_b32 v212, v230, v212, vcc
    v_cndmask_b32 v213, v230, v213, vcc
    v_cndmask_b32 v214, v230, v214, vcc
    v_cndmask_b32 v215, v230, v215, vcc
    v_cndmask_b32 v216, v230, v216, vcc
    s_mov_b32 s45, 225280
    buffer_load_dwordx4 v[106:109], v16, s[20:23], s45 offen offset:0 sc1
    v_cndmask_b32 v217, v230, v217, vcc
    v_cndmask_b32 v218, v230, v218, vcc
    v_cndmask_b32 v219, v230, v219, vcc
    v_cndmask_b32 v220, v230, v220, vcc
    v_cndmask_b32 v221, v230, v221, vcc
    v_cndmask_b32 v222, v230, v222, vcc
    v_cndmask_b32 v223, v230, v223, vcc
    buffer_load_dwordx4 v[110:113], v16, s[20:23], s45 offen offset:1024 sc1
    v_cndmask_b32 v224, v230, v224, vcc
    v_cndmask_b32 v225, v230, v225, vcc
    s_waitcnt lgkmcnt(0)
    s_nop 0
    v_mfma_f32_16x16x32_bf16 v[234:237], a[0:3], v[206:209], 0
    v_mfma_f32_16x16x32_bf16 v[234:237], a[4:7], v[210:213], v[234:237]
    v_mfma_f32_16x16x32_bf16 v[234:237], a[8:11], v[214:217], v[234:237]
    buffer_load_dwordx4 v[114:117], v16, s[20:23], s45 offen offset:2048 sc1
    v_mfma_f32_16x16x32_bf16 v[234:237], a[12:15], v[218:221], v[234:237]
    v_mfma_f32_16x16x32_bf16 v[234:237], a[16:19], v[222:225], v[234:237]
    s_nop 7
    ds_write_b128 v232, v[234:237]
    s_waitcnt lgkmcnt(0)
    s_barrier
    ds_read_b128 v[206:209], v231 offset:0
    buffer_load_dwordx4 v[118:121], v16, s[20:23], s45 offen offset:3072 sc1
    ds_read_b128 v[210:213], v231 offset:1024
    ds_read_b128 v[214:217], v231 offset:2048
    ds_read_b128 v[218:221], v231 offset:3072
    v_bfe_u32 v228, v19, 2, 3
    v_mul_u32_u24 v228, 1280, v228
    v_and_b32 v229, 3, v19
    v_lshl_add_u32 v228, v229, 3, v228
    buffer_load_dwordx4 v[122:125], v17, s[20:23], s45 offen offset:0 sc1
    s_mul_i32 s40, s5, 320
    v_add_u32 v228, s40, v228
    v_add_u32 v228, 86016, v228
    ds_read_b64_tr_b16 a[0:1], v228 offset:0
    ds_read_b64_tr_b16 a[2:3], v228 offset:32
    ds_read_b64_tr_b16 a[4:5], v228 offset:64
    ds_read_b64_tr_b16 a[6:7], v228 offset:96
    s_mov_b32 s45, 245760
    buffer_load_dwordx4 v[126:129], v16, s[20:23], s45 offen offset:0 sc1
    ds_read_b64_tr_b16 a[8:9], v228 offset:128
    ds_read_b64_tr_b16 a[10:11], v228 offset:160
    ds_read_b64_tr_b16 a[12:13], v228 offset:192
    ds_read_b64_tr_b16 a[14:15], v228 offset:224
    ds_read_b64_tr_b16 a[16:17], v228 offset:256
    ds_read_b64_tr_b16 a[18:19], v228 offset:288
    s_waitcnt lgkmcnt(10)
    buffer_load_dwordx4 v[130:133], v16, s[20:23], s45 offen offset:1024 sc1
    v_add_f32 v206, v206, v210
    v_add_f32 v207, v207, v211
    v_add_f32 v208, v208, v212
    v_add_f32 v209, v209, v213
    v_add_f32 v206, v206, v214
    v_add_f32 v207, v207, v215
    v_add_f32 v208, v208, v216
    buffer_load_dwordx4 v[134:137], v16, s[20:23], s45 offen offset:2048 sc1
    v_add_f32 v209, v209, v217
    v_add_f32 v206, v206, v218
    v_add_f32 v207, v207, v219
    v_add_f32 v208, v208, v220
    v_add_f32 v209, v209, v221
    s_nop 0
    v_mov_b32_dpp v210, v206 row_newbcast:8 row_mask:0xf bank_mask:0xf
    buffer_load_dwordx4 v[138:141], v16, s[20:23], s45 offen offset:3072 sc1
    v_mov_b32_dpp v211, v207 row_newbcast:8 row_mask:0xf bank_mask:0xf
    v_mov_b32_dpp v212, v208 row_newbcast:8 row_mask:0xf bank_mask:0xf
    v_mov_b32_dpp v213, v209 row_newbcast:8 row_mask:0xf bank_mask:0xf
    v_fma_f32 v206, -v226, v210, v206
    v_fma_f32 v207, -v226, v211, v207
    v_fma_f32 v208, -v226, v212, v208
    v_fma_f32 v209, -v226, v213, v209
    buffer_load_dwordx4 v[142:145], v17, s[20:23], s45 offen offset:0 sc1
    v_mul_f32 v206, v206, v227
    v_mul_f32 v207, v207, v227
    v_mul_f32 v208, v208, v227
    v_mul_f32 v209, v209, v227
    v_cvt_pk_bf16_f32 v210, v206, v207
    v_cvt_pk_bf16_f32 v211, v208, v209
    v_lshlrev_b32 v206, 16, v210
    s_mov_b32 s45, 266240
    buffer_load_dwordx4 v[146:149], v16, s[20:23], s45 offen offset:0 sc1
    v_and_b32 v207, 0xffff0000, v210
    v_lshlrev_b32 v208, 16, v211
    v_and_b32 v209, 0xffff0000, v211
    v_mov_b32 v214, v206
    v_mov_b32 v215, v207
    v_mov_b32 v216, v208
    v_mov_b32 v217, v209
    buffer_load_dwordx4 v[150:153], v16, s[20:23], s45 offen offset:1024 sc1
    s_waitcnt lgkmcnt(0)
    s_barrier
    v_permlane32_swap_b32 v206, v214
    v_permlane32_swap_b32 v207, v215
    v_permlane32_swap_b32 v208, v216
    v_permlane32_swap_b32 v209, v217
    v_mul_f32 v210, 0xbfb8aa3b, v206
    buffer_load_dwordx4 v[154:157], v16, s[20:23], s45 offen offset:2048 sc1
    v_mul_f32 v211, 0xbfb8aa3b, v207
    v_mul_f32 v212, 0xbfb8aa3b, v208
    v_mul_f32 v213, 0xbfb8aa3b, v209
    v_exp_f32 v210, v210
    v_exp_f32 v211, v211
    v_exp_f32 v212, v212
    v_exp_f32 v213, v213
    buffer_load_dwordx4 v[158:161], v16, s[20:23], s45 offen offset:3072 sc1
    v_add_f32 v210, 1.0, v210
    v_add_f32 v211, 1.0, v211
    v_add_f32 v212, 1.0, v212
    v_add_f32 v213, 1.0, v213
    v_rcp_f32 v210, v210
    v_rcp_f32 v211, v211
    v_rcp_f32 v212, v212
    buffer_load_dwordx4 v[162:165], v17, s[20:23], s45 offen offset:0 sc1
    v_rcp_f32 v213, v213
    v_mul_f32 v206, v206, v210
    v_mul_f32 v207, v207, v211
    v_mul_f32 v208, v208, v212
    v_mul_f32 v209, v209, v213
    v_cvt_pk_bf16_f32 v210, v206, v207
    v_cvt_pk_bf16_f32 v211, v208, v209
    s_mov_b32 s45, 122880
    buffer_load_dwordx4 a[216:219], v16, s[20:23], s45 offen offset:0 sc1
    v_lshlrev_b32 v206, 16, v210
    v_and_b32 v207, 0xffff0000, v210
    v_lshlrev_b32 v208, 16, v211
    v_and_b32 v209, 0xffff0000, v211
    v_mul_f32 v206, v206, v214
    v_mul_f32 v207, v207, v215
    v_mul_f32 v208, v208, v216
    buffer_load_dwordx4 a[220:223], v16, s[20:23], s45 offen offset:1024 sc1
    v_mul_f32 v209, v209, v217
    v_cmp_gt_u32 vcc, 32, v19
    v_cvt_pk_bf16_f32 v248, v206, v207
    v_cvt_pk_bf16_f32 v249, v208, v209
    v_cndmask_b32 v248, 0, v248, vcc
    v_cndmask_b32 v249, 0, v249, vcc
    v_and_b32 v246, 7, v19
    buffer_load_dwordx4 a[224:227], v16, s[20:23], s45 offen offset:2048 sc1
    v_mul_u32_u24 v246, 2560, v246
    v_lshrrev_b32 v247, 4, v19
    v_lshl_add_u32 v246, v247, 4, v246
    v_and_b32 v247, 8, v19
    v_lshl_add_u32 v246, v247, 3, v246
    s_mul_i32 s41, s6, 20480
    s_lshl_b32 s40, s40, 1
    buffer_load_dwordx4 a[228:231], v16, s[20:23], s45 offen offset:3072 sc1
    s_add_u32 s40, s40, s41
    v_mfma_f32_16x16x16_bf16 v[206:209], a[0:1], v[248:249], 0
    v_mfma_f32_16x16x16_bf16 v[210:213], a[2:3], v[248:249], 0
    v_mfma_f32_16x16x16_bf16 v[214:217], a[4:5], v[248:249], 0
    v_mfma_f32_16x16x16_bf16 v[218:221], a[6:7], v[248:249], 0
    v_mfma_f32_16x16x16_bf16 v[222:225], a[8:9], v[248:249], 0
    v_mfma_f32_16x16x16_bf16 v[226:229], a[10:11], v[248:249], 0
    buffer_load_dwordx4 a[232:235], v17, s[20:23], s45 offen offset:0 sc1
    v_mfma_f32_16x16x16_bf16 v[230:233], a[12:13], v[248:249], 0
    v_mfma_f32_16x16x16_bf16 v[234:237], a[14:15], v[248:249], 0
    v_mfma_f32_16x16x16_bf16 v[238:241], a[16:17], v[248:249], 0
    v_mfma_f32_16x16x16_bf16 v[242:245], a[18:19], v[248:249], 0
    v_mov_b32_dpp v206, v210 row_shr:8 row_mask:0xf bank_mask:0xc
    v_mov_b32_dpp v207, v211 row_shr:8 row_mask:0xf bank_mask:0xc
    v_mov_b32_dpp v208, v212 row_shr:8 row_mask:0xf bank_mask:0xc
    s_mov_b32 s45, 143360
    buffer_load_dwordx4 a[236:239], v16, s[20:23], s45 offen offset:0 sc1
    v_mov_b32_dpp v209, v213 row_shr:8 row_mask:0xf bank_mask:0xc
    buffer_store_dwordx4 v[206:209], v246, s[16:19], s40 offen offset:0 sc1
    v_mov_b32_dpp v214, v218 row_shr:8 row_mask:0xf bank_mask:0xc
    v_mov_b32_dpp v215, v219 row_shr:8 row_mask:0xf bank_mask:0xc
    v_mov_b32_dpp v216, v220 row_shr:8 row_mask:0xf bank_mask:0xc
    v_mov_b32_dpp v217, v221 row_shr:8 row_mask:0xf bank_mask:0xc
    buffer_store_dwordx4 v[214:217], v246, s[16:19], s40 offen offset:128 sc1
    buffer_load_dwordx4 a[240:243], v16, s[20:23], s45 offen offset:1024 sc1
    v_mov_b32_dpp v222, v226 row_shr:8 row_mask:0xf bank_mask:0xc
    v_mov_b32_dpp v223, v227 row_shr:8 row_mask:0xf bank_mask:0xc
    v_mov_b32_dpp v224, v228 row_shr:8 row_mask:0xf bank_mask:0xc
    v_mov_b32_dpp v225, v229 row_shr:8 row_mask:0xf bank_mask:0xc
    buffer_store_dwordx4 v[222:225], v246, s[16:19], s40 offen offset:256 sc1
    v_mov_b32_dpp v230, v234 row_shr:8 row_mask:0xf bank_mask:0xc
    v_mov_b32_dpp v231, v235 row_shr:8 row_mask:0xf bank_mask:0xc
    buffer_load_dwordx4 a[244:247], v16, s[20:23], s45 offen offset:2048 sc1
    v_mov_b32_dpp v232, v236 row_shr:8 row_mask:0xf bank_mask:0xc
    v_mov_b32_dpp v233, v237 row_shr:8 row_mask:0xf bank_mask:0xc
    buffer_store_dwordx4 v[230:233], v246, s[16:19], s40 offen offset:384 sc1
    v_mov_b32_dpp v238, v242 row_shr:8 row_mask:0xf bank_mask:0xc
    v_mov_b32_dpp v239, v243 row_shr:8 row_mask:0xf bank_mask:0xc
    v_mov_b32_dpp v240, v244 row_shr:8 row_mask:0xf bank_mask:0xc
    v_mov_b32_dpp v241, v245 row_shr:8 row_mask:0xf bank_mask:0xc
    buffer_load_dwordx4 a[248:251], v16, s[20:23], s45 offen offset:3072 sc1
    buffer_store_dwordx4 v[238:241], v246, s[16:19], s40 offen offset:512 sc1
    s_mov_b32 s101, 0
    s_not_b32 s40, s50
    s_bfe_u32 s40, s40, 0x50006
    s_cmp_eq_u32 s40, s87
    s_cselect_b32 s40, 1, 0
    s_lshl_b32 s40, s40, 0
    buffer_load_dwordx4 a[252:255], v17, s[20:23], s45 offen offset:0 sc1
    s_or_b32 s101, s101, s40
    s_not_b32 s40, s51
    s_bfe_u32 s40, s40, 0x50006
    s_cmp_eq_u32 s40, s87
    s_cselect_b32 s40, 1, 0
    s_lshl_b32 s40, s40, 1
    s_or_b32 s101, s101, s40
    s_add_u32 m0, s46, 0
    s_mov_b32 s45, 327680
    buffer_load_dwordx4 v16, s[20:23], s45 offen offset:0 sc1 lds
    s_not_b32 s40, s52
    s_bfe_u32 s40, s40, 0x50006
    s_cmp_eq_u32 s40, s87
    s_cselect_b32 s40, 1, 0
    s_lshl_b32 s40, s40, 2
    s_or_b32 s101, s101, s40
    s_not_b32 s40, s53
    buffer_load_dwordx4 v16, s[20:23], s45 offen offset:1024 sc1 lds
    s_bfe_u32 s40, s40, 0x50006
    s_cmp_eq_u32 s40, s87
    s_cselect_b32 s40, 1, 0
    s_lshl_b32 s40, s40, 3
    s_or_b32 s101, s101, s40
    s_not_b32 s40, s54
    s_bfe_u32 s40, s40, 0x50006
    buffer_load_dwordx4 v16, s[20:23], s45 offen offset:2048 sc1 lds
    s_cmp_eq_u32 s40, s87
    s_cselect_b32 s40, 1, 0
    s_lshl_b32 s40, s40, 4
    s_or_b32 s101, s101, s40
    s_not_b32 s40, s55
    s_bfe_u32 s40, s40, 0x50006
    s_cmp_eq_u32 s40, s87
    s_cselect_b32 s40, 1, 0
    buffer_load_dwordx4 v16, s[20:23], s45 offen offset:3072 sc1 lds
    s_lshl_b32 s40, s40, 5
    s_or_b32 s101, s101, s40
    s_not_b32 s40, s56
    s_bfe_u32 s40, s40, 0x50006
    s_cmp_eq_u32 s40, s87
    s_cselect_b32 s40, 1, 0
    s_add_u32 m0, s46, 4096
    s_nop 0
    buffer_load_dwordx4 v17, s[20:23], s45 offen offset:0 sc1 lds
    s_lshl_b32 s40, s40, 6
    s_or_b32 s101, s101, s40
    s_not_b32 s40, s57
    s_bfe_u32 s40, s40, 0x50006
    s_cmp_eq_u32 s40, s87
    s_cselect_b32 s40, 1, 0
    s_lshl_b32 s40, s40, 7
    s_add_u32 m0, s46, 5120
    s_mov_b32 s45, 348160
    buffer_load_dwordx4 v16, s[20:23], s45 offen offset:0 sc1 lds
    s_or_b32 s101, s101, s40
    v_mul_u32_u24 v12, 3277, v19
    v_lshrrev_b32 v12, 16, v12
    v_mul_u32_u24 v13, 20, v12
    v_sub_u32 v13, v19, v13
    v_lshlrev_b32 v13, 4, v13
    s_mul_i32 s40, s5, 3
    buffer_load_dwordx4 v16, s[20:23], s45 offen offset:1024 sc1 lds
    v_add_u32 v12, s40, v12
    v_mul_u32_u24 v11, 368640, v12
    s_mul_i32 s40, s100, 320
    v_add3_u32 v11, v11, v13, s40
    v_cmp_gt_u32 vcc, 60, v19
    v_mul_u32_u24 v12, 320, v12
    v_add_u32 v13, 81920, v13
    buffer_load_dwordx4 v16, s[20:23], s45 offen offset:2048 sc1 lds
    v_cndmask_b32 v11, -1, v11, vcc
    v_add_u32 v12, v12, v13
    v_mov_b32 v14, 86080
    v_cndmask_b32 v12, v14, v12, vcc
    s_lshl_b32 s40, s87, 7
    s_add_u32 s40, s40, 0x290400
    v_and_b32 v1, 31, v19
    buffer_load_dwordx4 v16, s[20:23], s45 offen offset:3072 sc1 lds
    v_lshl_add_u32 v1, v1, 2, s40
    s_add_u32 m0, s46, 9216
    s_nop 0
    buffer_load_dwordx4 v17, s[20:23], s45 offen offset:0 sc1 lds
    buffer_load_dword v252, v1, s[76:79], 0 offen sc1
    s_add_u32 m0, s46, 40960
    s_mov_b32 s45, 368640
    buffer_load_dwordx4 v16, s[20:23], s45 offen offset:0 sc1 lds
    buffer_load_dwordx4 v16, s[20:23], s45 offen offset:1024 sc1 lds
    buffer_load_dwordx4 v16, s[20:23], s45 offen offset:2048 sc1 lds
    buffer_load_dwordx4 v16, s[20:23], s45 offen offset:3072 sc1 lds
    s_add_u32 m0, s46, 45056
    s_nop 0
    buffer_load_dwordx4 v17, s[20:23], s45 offen offset:0 sc1 lds
    s_add_u32 m0, s46, 46080
    s_mov_b32 s45, 389120
    buffer_load_dwordx4 v16, s[20:23], s45 offen offset:0 sc1 lds
    buffer_load_dwordx4 v16, s[20:23], s45 offen offset:1024 sc1 lds
    buffer_load_dwordx4 v16, s[20:23], s45 offen offset:2048 sc1 lds
    buffer_load_dwordx4 v16, s[20:23], s45 offen offset:3072 sc1 lds
    s_add_u32 m0, s46, 50176
    s_nop 0
    buffer_load_dwordx4 v17, s[20:23], s45 offen offset:0 sc1 lds
    s_add_u32 m0, s46, 81920
    s_mov_b32 s45, 409600
    buffer_load_dwordx4 v16, s[20:23], s45 offen offset:0 sc1 lds
    buffer_load_dwordx4 v16, s[20:23], s45 offen offset:1024 sc1 lds
    buffer_load_dwordx4 v16, s[20:23], s45 offen offset:2048 sc1 lds
    buffer_load_dwordx4 v16, s[20:23], s45 offen offset:3072 sc1 lds
    s_add_u32 m0, s46, 86016
    s_nop 0
    buffer_load_dwordx4 v17, s[20:23], s45 offen offset:0 sc1 lds
    s_add_u32 m0, s46, 87040
    s_mov_b32 s45, 430080
    buffer_load_dwordx4 v16, s[20:23], s45 offen offset:0 sc1 lds
    buffer_load_dwordx4 v16, s[20:23], s45 offen offset:1024 sc1 lds
    buffer_load_dwordx4 v16, s[20:23], s45 offen offset:2048 sc1 lds
    buffer_load_dwordx4 v16, s[20:23], s45 offen offset:3072 sc1 lds
    s_add_u32 m0, s46, 91136
    s_nop 0
    buffer_load_dwordx4 v17, s[20:23], s45 offen offset:0 sc1 lds
    s_cmp_lg_u32 s5, 0
    s_cbranch_scc1 L_back_o
    s_waitcnt vmcnt(20)
    v_cmp_ne_u32 vcc, 1, v252
    s_and_b64 vcc, vcc, exec
    s_cbranch_scc1 L_spin_o
L_back_o:
    s_barrier
    s_mov_b32 s44, 0
    buffer_load_dwordx4 a[0:3], v4, s[8:11], s44 offen sc1
    buffer_load_dwordx4 a[4:7], v5, s[8:11], s44 offen sc1
    buffer_load_dwordx4 a[8:11], v6, s[8:11], s44 offen sc1
    buffer_load_dwordx4 a[12:15], v7, s[8:11], s44 offen sc1
    s_mov_b32 s44, 16384
    buffer_load_dwordx4 a[16:19], v4, s[8:11], s44 offen sc1
    buffer_load_dwordx4 a[20:23], v5, s[8:11], s44 offen sc1
    buffer_load_dwordx4 a[24:27], v6, s[8:11], s44 offen sc1
    buffer_load_dwordx4 a[28:31], v7, s[8:11], s44 offen sc1
    s_mov_b32 s44, 32768
    buffer_load_dwordx4 a[32:35], v4, s[8:11], s44 offen sc1
    buffer_load_dwordx4 a[36:39], v5, s[8:11], s44 offen sc1
    buffer_load_dwordx4 a[40:43], v6, s[8:11], s44 offen sc1
    buffer_load_dwordx4 a[44:47], v7, s[8:11], s44 offen sc1
    s_mov_b32 s44, 49152
    buffer_load_dwordx4 a[48:51], v4, s[8:11], s44 offen sc1
    buffer_load_dwordx4 a[52:55], v5, s[8:11], s44 offen sc1
    buffer_load_dwordx4 a[56:59], v6, s[8:11], s44 offen sc1
    buffer_load_dwordx4 a[60:63], v7, s[8:11], s44 offen sc1
    s_waitcnt vmcnt(8)
    v_mfma_f32_16x16x32_bf16 v[166:169], a[96:99], a[0:3], 0
    s_mov_b32 s44, 65536
    buffer_load_dwordx4 a[64:67], v4, s[8:11], s44 offen sc1
    v_mfma_f32_16x16x32_bf16 v[166:169], a[116:119], a[16:19], v[166:169]
    v_mfma_f32_16x16x32_bf16 v[186:189], a[96:99], a[4:7], 0
    v_mfma_f32_16x16x32_bf16 v[186:189], a[116:119], a[20:23], v[186:189]
    v_mfma_f32_16x16x32_bf16 v[206:209], a[96:99], a[8:11], 0
    buffer_load_dwordx4 a[68:71], v5, s[8:11], s44 offen sc1
    v_mfma_f32_16x16x32_bf16 v[206:209], a[116:119], a[24:27], v[206:209]
    v_mfma_f32_16x16x32_bf16 v[226:229], a[96:99], a[12:15], 0
    v_mfma_f32_16x16x32_bf16 v[226:229], a[116:119], a[28:31], v[226:229]
    v_mfma_f32_16x16x32_bf16 v[170:173], a[100:103], a[0:3], 0
    v_mfma_f32_16x16x32_bf16 v[170:173], a[120:123], a[16:19], v[170:173]
    buffer_load_dwordx4 a[72:75], v6, s[8:11], s44 offen sc1
    v_mfma_f32_16x16x32_bf16 v[190:193], a[100:103], a[4:7], 0
    v_mfma_f32_16x16x32_bf16 v[190:193], a[120:123], a[20:23], v[190:193]
    v_mfma_f32_16x16x32_bf16 v[210:213], a[100:103], a[8:11], 0
    v_mfma_f32_16x16x32_bf16 v[210:213], a[120:123], a[24:27], v[210:213]
    v_mfma_f32_16x16x32_bf16 v[230:233], a[100:103], a[12:15], 0
    buffer_load_dwordx4 a[76:79], v7, s[8:11], s44 offen sc1
    v_mfma_f32_16x16x32_bf16 v[230:233], a[120:123], a[28:31], v[230:233]
    v_mfma_f32_16x16x32_bf16 v[174:177], a[104:107], a[0:3], 0
    v_mfma_f32_16x16x32_bf16 v[174:177], a[124:127], a[16:19], v[174:177]
    v_mfma_f32_16x16x32_bf16 v[194:197], a[104:107], a[4:7], 0
    v_mfma_f32_16x16x32_bf16 v[194:197], a[124:127], a[20:23], v[194:197]
    s_mov_b32 s44, 81920
    buffer_load_dwordx4 a[80:83], v4, s[8:11], s44 offen sc1
    v_mfma_f32_16x16x32_bf16 v[214:217], a[104:107], a[8:11], 0
    v_mfma_f32_16x16x32_bf16 v[214:217], a[124:127], a[24:27], v[214:217]
    v_mfma_f32_16x16x32_bf16 v[234:237], a[104:107], a[12:15], 0
    v_mfma_f32_16x16x32_bf16 v[234:237], a[124:127], a[28:31], v[234:237]
    buffer_load_dwordx4 a[84:87], v5, s[8:11], s44 offen sc1
    v_mfma_f32_16x16x32_bf16 v[178:181], a[108:111], a[0:3], 0
    v_mfma_f32_16x16x32_bf16 v[178:181], a[128:131], a[16:19], v[178:181]
    v_mfma_f32_16x16x32_bf16 v[198:201], a[108:111], a[4:7], 0
    v_mfma_f32_16x16x32_bf16 v[198:201], a[128:131], a[20:23], v[198:201]
    v_mfma_f32_16x16x32_bf16 v[218:221], a[108:111], a[8:11], 0
    buffer_load_dwordx4 a[88:91], v6, s[8:11], s44 offen sc1
    v_mfma_f32_16x16x32_bf16 v[218:221], a[128:131], a[24:27], v[218:221]
    v_mfma_f32_16x16x32_bf16 v[238:241], a[108:111], a[12:15], 0
    v_mfma_f32_16x16x32_bf16 v[238:241], a[128:131], a[28:31], v[238:241]
    v_mfma_f32_16x16x32_bf16 v[182:185], a[112:115], a[0:3], 0
    v_mfma_f32_16x16x32_bf16 v[182:185], a[132:135], a[16:19], v[182:185]
    buffer_load_dwordx4 a[92:95], v7, s[8:11], s44 offen sc1
    v_mfma_f32_16x16x32_bf16 v[202:205], a[112:115], a[4:7], 0
    v_mfma_f32_16x16x32_bf16 v[202:205], a[132:135], a[20:23], v[202:205]
    v_mfma_f32_16x16x32_bf16 v[222:225], a[112:115], a[8:11], 0
    v_mfma_f32_16x16x32_bf16 v[222:225], a[132:135], a[24:27], v[222:225]
    v_mfma_f32_16x16x32_bf16 v[242:245], a[112:115], a[12:15], 0
    s_mov_b64 exec, 1
    buffer_store_dword v2, off, s[76:79], s59 sc1
    s_mov_b64 exec, -1
    v_mfma_f32_16x16x32_bf16 v[242:245], a[132:135], a[28:31], v[242:245]
    s_waitcnt vmcnt(9)
    v_mfma_f32_16x16x32_bf16 v[166:169], a[136:139], a[32:35], v[166:169]
    s_mov_b32 s44, 98304
    buffer_load_dwordx4 a[0:3], v4, s[8:11], s44 offen sc1
    v_mfma_f32_16x16x32_bf16 v[166:169], a[156:159], a[48:51], v[166:169]
    v_mfma_f32_16x16x32_bf16 v[186:189], a[136:139], a[36:39], v[186:189]
    buffer_load_dwordx4 a[4:7], v5, s[8:11], s44 offen sc1
    v_mfma_f32_16x16x32_bf16 v[186:189], a[156:159], a[52:55], v[186:189]
    v_mfma_f32_16x16x32_bf16 v[206:209], a[136:139], a[40:43], v[206:209]
    v_mfma_f32_16x16x32_bf16 v[206:209], a[156:159], a[56:59], v[206:209]
    buffer_load_dwordx4 a[8:11], v6, s[8:11], s44 offen sc1
    v_mfma_f32_16x16x32_bf16 v[226:229], a[136:139], a[44:47], v[226:229]
    v_mfma_f32_16x16x32_bf16 v[226:229], a[156:159], a[60:63], v[226:229]
    v_mfma_f32_16x16x32_bf16 v[170:173], a[140:143], a[32:35], v[170:173]
    buffer_load_dwordx4 a[12:15], v7, s[8:11], s44 offen sc1
    v_mfma_f32_16x16x32_bf16 v[170:173], a[160:163], a[48:51], v[170:173]
    v_mfma_f32_16x16x32_bf16 v[190:193], a[140:143], a[36:39], v[190:193]
    v_mfma_f32_16x16x32_bf16 v[190:193], a[160:163], a[52:55], v[190:193]
    s_mov_b32 s44, 114688
    buffer_load_dwordx4 a[16:19], v4, s[8:11], s44 offen sc1
    v_mfma_f32_16x16x32_bf16 v[210:213], a[140:143], a[40:43], v[210:213]
    v_mfma_f32_16x16x32_bf16 v[210:213], a[160:163], a[56:59], v[210:213]
    v_mfma_f32_16x16x32_bf16 v[230:233], a[140:143], a[44:47], v[230:233]
    buffer_load_dwordx4 a[20:23], v5, s[8:11], s44 offen sc1
    v_mfma_f32_16x16x32_bf16 v[230:233], a[160:163], a[60:63], v[230:233]
    v_mfma_f32_16x16x32_bf16 v[174:177], a[144:147], a[32:35], v[174:177]
    v_mfma_f32_16x16x32_bf16 v[174:177], a[164:167], a[48:51], v[174:177]
    buffer_load_dwordx4 a[24:27], v6, s[8:11], s44 offen sc1
    v_mfma_f32_16x16x32_bf16 v[194:197], a[144:147], a[36:39], v[194:197]
    v_mfma_f32_16x16x32_bf16 v[194:197], a[164:167], a[52:55], v[194:197]
    v_mfma_f32_16x16x32_bf16 v[214:217], a[144:147], a[40:43], v[214:217]
    buffer_load_dwordx4 a[28:31], v7, s[8:11], s44 offen sc1
    v_mfma_f32_16x16x32_bf16 v[214:217], a[164:167], a[56:59], v[214:217]
    v_mfma_f32_16x16x32_bf16 v[234:237], a[144:147], a[44:47], v[234:237]
    v_mfma_f32_16x16x32_bf16 v[234:237], a[164:167], a[60:63], v[234:237]
    s_mov_b32 s45, 450560
    buffer_load_dwordx4 a[96:99], v16, s[20:23], s45 offen offset:0 sc1
    v_mfma_f32_16x16x32_bf16 v[178:181], a[148:151], a[32:35], v[178:181]
    v_mfma_f32_16x16x32_bf16 v[178:181], a[168:171], a[48:51], v[178:181]
    v_mfma_f32_16x16x32_bf16 v[198:201], a[148:151], a[36:39], v[198:201]
    buffer_load_dwordx4 a[100:103], v16, s[20:23], s45 offen offset:1024 sc1
    v_mfma_f32_16x16x32_bf16 v[198:201], a[168:171], a[52:55], v[198:201]
    v_mfma_f32_16x16x32_bf16 v[218:221], a[148:151], a[40:43], v[218:221]
    v_mfma_f32_16x16x32_bf16 v[218:221], a[168:171], a[56:59], v[218:221]
    buffer_load_dwordx4 a[104:107], v16, s[20:23], s45 offen offset:2048 sc1
    v_mfma_f32_16x16x32_bf16 v[238:241], a[148:151], a[44:47], v[238:241]
    v_mfma_f32_16x16x32_bf16 v[238:241], a[168:171], a[60:63], v[238:241]
    v_mfma_f32_16x16x32_bf16 v[182:185], a[152:155], a[32:35], v[182:185]
    buffer_load_dwordx4 a[108:111], v16, s[20:23], s45 offen offset:3072 sc1
    v_mfma_f32_16x16x32_bf16 v[182:185], a[172:175], a[48:51], v[182:185]
    v_mfma_f32_16x16x32_bf16 v[202:205], a[152:155], a[36:39], v[202:205]
    v_mfma_f32_16x16x32_bf16 v[202:205], a[172:175], a[52:55], v[202:205]
    buffer_load_dwordx4 a[112:115], v17, s[20:23], s45 offen offset:0 sc1
    v_mfma_f32_16x16x32_bf16 v[222:225], a[152:155], a[40:43], v[222:225]
    v_mfma_f32_16x16x32_bf16 v[222:225], a[172:175], a[56:59], v[222:225]
    v_mfma_f32_16x16x32_bf16 v[242:245], a[152:155], a[44:47], v[242:245]
    v_mfma_f32_16x16x32_bf16 v[242:245], a[172:175], a[60:63], v[242:245]
    s_waitcnt vmcnt(14)
    v_mfma_f32_16x16x32_bf16 v[166:169], a[176:179], a[64:67], v[166:169]
    s_mov_b32 s44, 131072
    buffer_load_dwordx4 a[32:35], v4, s[8:11], s44 offen sc1
    v_mfma_f32_16x16x32_bf16 v[166:169], a[196:199], a[80:83], v[166:169]
    v_mfma_f32_16x16x32_bf16 v[186:189], a[176:179], a[68:71], v[186:189]
    buffer_load_dwordx4 a[36:39], v5, s[8:11], s44 offen sc1
    v_mfma_f32_16x16x32_bf16 v[186:189], a[196:199], a[84:87], v[186:189]
    v_mfma_f32_16x16x32_bf16 v[206:209], a[176:179], a[72:75], v[206:209]
    v_mfma_f32_16x16x32_bf16 v[206:209], a[196:199], a[88:91], v[206:209]
    buffer_load_dwordx4 a[40:43], v6, s[8:11], s44 offen sc1
    v_mfma_f32_16x16x32_bf16 v[226:229], a[176:179], a[76:79], v[226:229]
    v_mfma_f32_16x16x32_bf16 v[226:229], a[196:199], a[92:95], v[226:229]
    v_mfma_f32_16x16x32_bf16 v[170:173], a[180:183], a[64:67], v[170:173]
    buffer_load_dwordx4 a[44:47], v7, s[8:11], s44 offen sc1
    v_mfma_f32_16x16x32_bf16 v[170:173], a[200:203], a[80:83], v[170:173]
    v_mfma_f32_16x16x32_bf16 v[190:193], a[180:183], a[68:71], v[190:193]
    v_mfma_f32_16x16x32_bf16 v[190:193], a[200:203], a[84:87], v[190:193]
    s_mov_b32 s44, 147456
    buffer_load_dwordx4 a[48:51], v4, s[8:11], s44 offen sc1
    v_mfma_f32_16x16x32_bf16 v[210:213], a[180:183], a[72:75], v[210:213]
    v_mfma_f32_16x16x32_bf16 v[210:213], a[200:203], a[88:91], v[210:213]
    v_mfma_f32_16x16x32_bf16 v[230:233], a[180:183], a[76:79], v[230:233]
    buffer_load_dwordx4 a[52:55], v5, s[8:11], s44 offen sc1
    v_mfma_f32_16x16x32_bf16 v[230:233], a[200:203], a[92:95], v[230:233]
    v_mfma_f32_16x16x32_bf16 v[174:177], a[184:187], a[64:67], v[174:177]
    v_mfma_f32_16x16x32_bf16 v[174:177], a[204:207], a[80:83], v[174:177]
    buffer_load_dwordx4 a[56:59], v6, s[8:11], s44 offen sc1
    v_mfma_f32_16x16x32_bf16 v[194:197], a[184:187], a[68:71], v[194:197]
    v_mfma_f32_16x16x32_bf16 v[194:197], a[204:207], a[84:87], v[194:197]
    v_mfma_f32_16x16x32_bf16 v[214:217], a[184:187], a[72:75], v[214:217]
    buffer_load_dwordx4 a[60:63], v7, s[8:11], s44 offen sc1
    v_mfma_f32_16x16x32_bf16 v[214:217], a[204:207], a[88:91], v[214:217]
    v_mfma_f32_16x16x32_bf16 v[234:237], a[184:187], a[76:79], v[234:237]
    v_mfma_f32_16x16x32_bf16 v[234:237], a[204:207], a[92:95], v[234:237]
    s_mov_b32 s45, 471040
    buffer_load_dwordx4 a[116:119], v16, s[20:23], s45 offen offset:0 sc1
    v_mfma_f32_16x16x32_bf16 v[178:181], a[188:191], a[64:67], v[178:181]
    v_mfma_f32_16x16x32_bf16 v[178:181], a[208:211], a[80:83], v[178:181]
    v_mfma_f32_16x16x32_bf16 v[198:201], a[188:191], a[68:71], v[198:201]
    buffer_load_dwordx4 a[120:123], v16, s[20:23], s45 offen offset:1024 sc1
    v_mfma_f32_16x16x32_bf16 v[198:201], a[208:211], a[84:87], v[198:201]
    v_mfma_f32_16x16x32_bf16 v[218:221], a[188:191], a[72:75], v[218:221]
    v_mfma_f32_16x16x32_bf16 v[218:221], a[208:211], a[88:91], v[218:221]
    buffer_load_dwordx4 a[124:127], v16, s[20:23], s45 offen offset:2048 sc1
    v_mfma_f32_16x16x32_bf16 v[238:241], a[188:191], a[76:79], v[238:241]
    v_mfma_f32_16x16x32_bf16 v[238:241], a[208:211], a[92:95], v[238:241]
    v_mfma_f32_16x16x32_bf16 v[182:185], a[192:195], a[64:67], v[182:185]
    buffer_load_dwordx4 a[128:131], v16, s[20:23], s45 offen offset:3072 sc1
    v_mfma_f32_16x16x32_bf16 v[182:185], a[212:215], a[80:83], v[182:185]
    v_mfma_f32_16x16x32_bf16 v[202:205], a[192:195], a[68:71], v[202:205]
    v_mfma_f32_16x16x32_bf16 v[202:205], a[212:215], a[84:87], v[202:205]
    buffer_load_dwordx4 a[132:135], v17, s[20:23], s45 offen offset:0 sc1
    v_mfma_f32_16x16x32_bf16 v[222:225], a[192:195], a[72:75], v[222:225]
    v_mfma_f32_16x16x32_bf16 v[222:225], a[212:215], a[88:91], v[222:225]
    v_mfma_f32_16x16x32_bf16 v[242:245], a[192:195], a[76:79], v[242:245]
    v_mfma_f32_16x16x32_bf16 v[242:245], a[212:215], a[92:95], v[242:245]
    s_waitcnt vmcnt(18)
    v_mfma_f32_16x16x32_bf16 v[166:169], a[216:219], a[0:3], v[166:169]
    s_mov_b32 s44, 163840
    buffer_load_dwordx4 a[64:67], v4, s[8:11], s44 offen sc1
    v_mfma_f32_16x16x32_bf16 v[166:169], a[236:239], a[16:19], v[166:169]
    v_mfma_f32_16x16x32_bf16 v[186:189], a[216:219], a[4:7], v[186:189]
    buffer_load_dwordx4 a[68:71], v5, s[8:11], s44 offen sc1
    v_mfma_f32_16x16x32_bf16 v[186:189], a[236:239], a[20:23], v[186:189]
    v_mfma_f32_16x16x32_bf16 v[206:209], a[216:219], a[8:11], v[206:209]
    v_mfma_f32_16x16x32_bf16 v[206:209], a[236:239], a[24:27], v[206:209]
    buffer_load_dwordx4 a[72:75], v6, s[8:11], s44 offen sc1
    v_mfma_f32_16x16x32_bf16 v[226:229], a[216:219], a[12:15], v[226:229]
    v_mfma_f32_16x16x32_bf16 v[226:229], a[236:239], a[28:31], v[226:229]
    v_mfma_f32_16x16x32_bf16 v[170:173], a[220:223], a[0:3], v[170:173]
    buffer_load_dwordx4 a[76:79], v7, s[8:11], s44 offen sc1
    v_mfma_f32_16x16x32_bf16 v[170:173], a[240:243], a[16:19], v[170:173]
    v_mfma_f32_16x16x32_bf16 v[190:193], a[220:223], a[4:7], v[190:193]
    v_mfma_f32_16x16x32_bf16 v[190:193], a[240:243], a[20:23], v[190:193]
    s_mov_b32 s44, 180224
    buffer_load_dwordx4 a[80:83], v4, s[8:11], s44 offen sc1
    v_mfma_f32_16x16x32_bf16 v[210:213], a[220:223], a[8:11], v[210:213]
    v_mfma_f32_16x16x32_bf16 v[210:213], a[240:243], a[24:27], v[210:213]
    v_mfma_f32_16x16x32_bf16 v[230:233], a[220:223], a[12:15], v[230:233]
    buffer_load_dwordx4 a[84:87], v5, s[8:11], s44 offen sc1
    v_mfma_f32_16x16x32_bf16 v[230:233], a[240:243], a[28:31], v[230:233]
    v_mfma_f32_16x16x32_bf16 v[174:177], a[224:227], a[0:3], v[174:177]
    v_mfma_f32_16x16x32_bf16 v[174:177], a[244:247], a[16:19], v[174:177]
    buffer_load_dwordx4 a[88:91], v6, s[8:11], s44 offen sc1
    v_mfma_f32_16x16x32_bf16 v[194:197], a[224:227], a[4:7], v[194:197]
    v_mfma_f32_16x16x32_bf16 v[194:197], a[244:247], a[20:23], v[194:197]
    v_mfma_f32_16x16x32_bf16 v[214:217], a[224:227], a[8:11], v[214:217]
    buffer_load_dwordx4 a[92:95], v7, s[8:11], s44 offen sc1
    v_mfma_f32_16x16x32_bf16 v[214:217], a[244:247], a[24:27], v[214:217]
    v_mfma_f32_16x16x32_bf16 v[234:237], a[224:227], a[12:15], v[234:237]
    v_mfma_f32_16x16x32_bf16 v[234:237], a[244:247], a[28:31], v[234:237]
    s_mov_b32 s45, 491520
    buffer_load_dwordx4 a[136:139], v16, s[20:23], s45 offen offset:0 sc1
    v_mfma_f32_16x16x32_bf16 v[178:181], a[228:231], a[0:3], v[178:181]
    v_mfma_f32_16x16x32_bf16 v[178:181], a[248:251], a[16:19], v[178:181]
    v_mfma_f32_16x16x32_bf16 v[198:201], a[228:231], a[4:7], v[198:201]
    buffer_load_dwordx4 a[140:143], v16, s[20:23], s45 offen offset:1024 sc1
    v_mfma_f32_16x16x32_bf16 v[198:201], a[248:251], a[20:23], v[198:201]
    v_mfma_f32_16x16x32_bf16 v[218:221], a[228:231], a[8:11], v[218:221]
    v_mfma_f32_16x16x32_bf16 v[218:221], a[248:251], a[24:27], v[218:221]
    buffer_load_dwordx4 a[144:147], v16, s[20:23], s45 offen offset:2048 sc1
    v_mfma_f32_16x16x32_bf16 v[238:241], a[228:231], a[12:15], v[238:241]
    v_mfma_f32_16x16x32_bf16 v[238:241], a[248:251], a[28:31], v[238:241]
    v_mfma_f32_16x16x32_bf16 v[182:185], a[232:235], a[0:3], v[182:185]
    buffer_load_dwordx4 a[148:151], v16, s[20:23], s45 offen offset:3072 sc1
    v_mfma_f32_16x16x32_bf16 v[182:185], a[252:255], a[16:19], v[182:185]
    v_mfma_f32_16x16x32_bf16 v[202:205], a[232:235], a[4:7], v[202:205]
    v_mfma_f32_16x16x32_bf16 v[202:205], a[252:255], a[20:23], v[202:205]
    buffer_load_dwordx4 a[152:155], v17, s[20:23], s45 offen offset:0 sc1
    v_mfma_f32_16x16x32_bf16 v[222:225], a[232:235], a[8:11], v[222:225]
    v_mfma_f32_16x16x32_bf16 v[222:225], a[252:255], a[24:27], v[222:225]
    v_mfma_f32_16x16x32_bf16 v[242:245], a[232:235], a[12:15], v[242:245]
    v_mfma_f32_16x16x32_bf16 v[242:245], a[252:255], a[28:31], v[242:245]
    s_waitcnt vmcnt(18)
    v_mfma_f32_16x16x32_bf16 v[166:169], v[46:49], a[32:35], v[166:169]
    s_mov_b32 s44, 196608
    buffer_load_dwordx4 a[0:3], v4, s[8:11], s44 offen sc1
    v_mfma_f32_16x16x32_bf16 v[166:169], v[66:69], a[48:51], v[166:169]
    v_mfma_f32_16x16x32_bf16 v[186:189], v[46:49], a[36:39], v[186:189]
    buffer_load_dwordx4 a[4:7], v5, s[8:11], s44 offen sc1
    v_mfma_f32_16x16x32_bf16 v[186:189], v[66:69], a[52:55], v[186:189]
    v_mfma_f32_16x16x32_bf16 v[206:209], v[46:49], a[40:43], v[206:209]
    v_mfma_f32_16x16x32_bf16 v[206:209], v[66:69], a[56:59], v[206:209]
    buffer_load_dwordx4 a[8:11], v6, s[8:11], s44 offen sc1
    v_mfma_f32_16x16x32_bf16 v[226:229], v[46:49], a[44:47], v[226:229]
    v_mfma_f32_16x16x32_bf16 v[226:229], v[66:69], a[60:63], v[226:229]
    v_mfma_f32_16x16x32_bf16 v[170:173], v[50:53], a[32:35], v[170:173]
    buffer_load_dwordx4 a[12:15], v7, s[8:11], s44 offen sc1
    v_mfma_f32_16x16x32_bf16 v[170:173], v[70:73], a[48:51], v[170:173]
    v_mfma_f32_16x16x32_bf16 v[190:193], v[50:53], a[36:39], v[190:193]
    v_mfma_f32_16x16x32_bf16 v[190:193], v[70:73], a[52:55], v[190:193]
    s_mov_b32 s44, 212992
    buffer_load_dwordx4 a[16:19], v4, s[8:11], s44 offen sc1
    v_mfma_f32_16x16x32_bf16 v[210:213], v[50:53], a[40:43], v[210:213]
    v_mfma_f32_16x16x32_bf16 v[210:213], v[70:73], a[56:59], v[210:213]
    v_mfma_f32_16x16x32_bf16 v[230:233], v[50:53], a[44:47], v[230:233]
    buffer_load_dwordx4 a[20:23], v5, s[8:11], s44 offen sc1
    v_mfma_f32_16x16x32_bf16 v[230:233], v[70:73], a[60:63], v[230:233]
    v_mfma_f32_16x16x32_bf16 v[174:177], v[54:57], a[32:35], v[174:177]
    v_mfma_f32_16x16x32_bf16 v[174:177], v[74:77], a[48:51], v[174:177]
    buffer_load_dwordx4 a[24:27], v6, s[8:11], s44 offen sc1
    v_mfma_f32_16x16x32_bf16 v[194:197], v[54:57], a[36:39], v[194:197]
    v_mfma_f32_16x16x32_bf16 v[194:197], v[74:77], a[52:55], v[194:197]
    v_mfma_f32_16x16x32_bf16 v[214:217], v[54:57], a[40:43], v[214:217]
    buffer_load_dwordx4 a[28:31], v7, s[8:11], s44 offen sc1
    v_mfma_f32_16x16x32_bf16 v[214:217], v[74:77], a[56:59], v[214:217]
    v_mfma_f32_16x16x32_bf16 v[234:237], v[54:57], a[44:47], v[234:237]
    v_mfma_f32_16x16x32_bf16 v[234:237], v[74:77], a[60:63], v[234:237]
    s_mov_b32 s45, 512000
    buffer_load_dwordx4 a[156:159], v16, s[20:23], s45 offen offset:0 sc1
    v_mfma_f32_16x16x32_bf16 v[178:181], v[58:61], a[32:35], v[178:181]
    v_mfma_f32_16x16x32_bf16 v[178:181], v[78:81], a[48:51], v[178:181]
    v_mfma_f32_16x16x32_bf16 v[198:201], v[58:61], a[36:39], v[198:201]
    buffer_load_dwordx4 a[160:163], v16, s[20:23], s45 offen offset:1024 sc1
    v_mfma_f32_16x16x32_bf16 v[198:201], v[78:81], a[52:55], v[198:201]
    v_mfma_f32_16x16x32_bf16 v[218:221], v[58:61], a[40:43], v[218:221]
    v_mfma_f32_16x16x32_bf16 v[218:221], v[78:81], a[56:59], v[218:221]
    buffer_load_dwordx4 a[164:167], v16, s[20:23], s45 offen offset:2048 sc1
    v_mfma_f32_16x16x32_bf16 v[238:241], v[58:61], a[44:47], v[238:241]
    v_mfma_f32_16x16x32_bf16 v[238:241], v[78:81], a[60:63], v[238:241]
    v_mfma_f32_16x16x32_bf16 v[182:185], v[62:65], a[32:35], v[182:185]
    buffer_load_dwordx4 a[168:171], v16, s[20:23], s45 offen offset:3072 sc1
    v_mfma_f32_16x16x32_bf16 v[182:185], v[82:85], a[48:51], v[182:185]
    v_mfma_f32_16x16x32_bf16 v[202:205], v[62:65], a[36:39], v[202:205]
    v_mfma_f32_16x16x32_bf16 v[202:205], v[82:85], a[52:55], v[202:205]
    buffer_load_dwordx4 a[172:175], v17, s[20:23], s45 offen offset:0 sc1
    v_mfma_f32_16x16x32_bf16 v[222:225], v[62:65], a[40:43], v[222:225]
    v_mfma_f32_16x16x32_bf16 v[222:225], v[82:85], a[56:59], v[222:225]
    v_mfma_f32_16x16x32_bf16 v[242:245], v[62:65], a[44:47], v[242:245]
    v_mfma_f32_16x16x32_bf16 v[242:245], v[82:85], a[60:63], v[242:245]
    s_waitcnt vmcnt(18)
    v_mfma_f32_16x16x32_bf16 v[166:169], v[86:89], a[64:67], v[166:169]
    s_mov_b32 s44, 229376
    buffer_load_dwordx4 a[32:35], v4, s[8:11], s44 offen sc1
    v_mfma_f32_16x16x32_bf16 v[166:169], v[106:109], a[80:83], v[166:169]
    v_mfma_f32_16x16x32_bf16 v[186:189], v[86:89], a[68:71], v[186:189]
    buffer_load_dwordx4 a[36:39], v5, s[8:11], s44 offen sc1
    v_mfma_f32_16x16x32_bf16 v[186:189], v[106:109], a[84:87], v[186:189]
    v_mfma_f32_16x16x32_bf16 v[206:209], v[86:89], a[72:75], v[206:209]
    v_mfma_f32_16x16x32_bf16 v[206:209], v[106:109], a[88:91], v[206:209]
    buffer_load_dwordx4 a[40:43], v6, s[8:11], s44 offen sc1
    v_mfma_f32_16x16x32_bf16 v[226:229], v[86:89], a[76:79], v[226:229]
    v_mfma_f32_16x16x32_bf16 v[226:229], v[106:109], a[92:95], v[226:229]
    v_mfma_f32_16x16x32_bf16 v[170:173], v[90:93], a[64:67], v[170:173]
    buffer_load_dwordx4 a[44:47], v7, s[8:11], s44 offen sc1
    v_mfma_f32_16x16x32_bf16 v[170:173], v[110:113], a[80:83], v[170:173]
    v_mfma_f32_16x16x32_bf16 v[190:193], v[90:93], a[68:71], v[190:193]
    v_mfma_f32_16x16x32_bf16 v[190:193], v[110:113], a[84:87], v[190:193]
    s_mov_b32 s44, 245760
    buffer_load_dwordx4 a[48:51], v4, s[8:11], s44 offen sc1
    v_mfma_f32_16x16x32_bf16 v[210:213], v[90:93], a[72:75], v[210:213]
    v_mfma_f32_16x16x32_bf16 v[210:213], v[110:113], a[88:91], v[210:213]
    v_mfma_f32_16x16x32_bf16 v[230:233], v[90:93], a[76:79], v[230:233]
    buffer_load_dwordx4 a[52:55], v5, s[8:11], s44 offen sc1
    v_mfma_f32_16x16x32_bf16 v[230:233], v[110:113], a[92:95], v[230:233]
    v_mfma_f32_16x16x32_bf16 v[174:177], v[94:97], a[64:67], v[174:177]
    v_mfma_f32_16x16x32_bf16 v[174:177], v[114:117], a[80:83], v[174:177]
    buffer_load_dwordx4 a[56:59], v6, s[8:11], s44 offen sc1
    v_mfma_f32_16x16x32_bf16 v[194:197], v[94:97], a[68:71], v[194:197]
    v_mfma_f32_16x16x32_bf16 v[194:197], v[114:117], a[84:87], v[194:197]
    v_mfma_f32_16x16x32_bf16 v[214:217], v[94:97], a[72:75], v[214:217]
    buffer_load_dwordx4 a[60:63], v7, s[8:11], s44 offen sc1
    v_mfma_f32_16x16x32_bf16 v[214:217], v[114:117], a[88:91], v[214:217]
    v_mfma_f32_16x16x32_bf16 v[234:237], v[94:97], a[76:79], v[234:237]
    v_mfma_f32_16x16x32_bf16 v[234:237], v[114:117], a[92:95], v[234:237]
    s_mov_b32 s45, 532480
    buffer_load_dwordx4 a[176:179], v16, s[20:23], s45 offen offset:0 sc1
    v_mfma_f32_16x16x32_bf16 v[178:181], v[98:101], a[64:67], v[178:181]
    v_mfma_f32_16x16x32_bf16 v[178:181], v[118:121], a[80:83], v[178:181]
    v_mfma_f32_16x16x32_bf16 v[198:201], v[98:101], a[68:71], v[198:201]
    buffer_load_dwordx4 a[180:183], v16, s[20:23], s45 offen offset:1024 sc1
    v_mfma_f32_16x16x32_bf16 v[198:201], v[118:121], a[84:87], v[198:201]
    v_mfma_f32_16x16x32_bf16 v[218:221], v[98:101], a[72:75], v[218:221]
    v_mfma_f32_16x16x32_bf16 v[218:221], v[118:121], a[88:91], v[218:221]
    buffer_load_dwordx4 a[184:187], v16, s[20:23], s45 offen offset:2048 sc1
    v_mfma_f32_16x16x32_bf16 v[238:241], v[98:101], a[76:79], v[238:241]
    v_mfma_f32_16x16x32_bf16 v[238:241], v[118:121], a[92:95], v[238:241]
    v_mfma_f32_16x16x32_bf16 v[182:185], v[102:105], a[64:67], v[182:185]
    buffer_load_dwordx4 a[188:191], v16, s[20:23], s45 offen offset:3072 sc1
    v_mfma_f32_16x16x32_bf16 v[182:185], v[122:125], a[80:83], v[182:185]
    v_mfma_f32_16x16x32_bf16 v[202:205], v[102:105], a[68:71], v[202:205]
    v_mfma_f32_16x16x32_bf16 v[202:205], v[122:125], a[84:87], v[202:205]
    buffer_load_dwordx4 a[192:195], v17, s[20:23], s45 offen offset:0 sc1
    v_mfma_f32_16x16x32_bf16 v[222:225], v[102:105], a[72:75], v[222:225]
    v_mfma_f32_16x16x32_bf16 v[222:225], v[122:125], a[88:91], v[222:225]
    v_mfma_f32_16x16x32_bf16 v[242:245], v[102:105], a[76:79], v[242:245]
    v_mfma_f32_16x16x32_bf16 v[242:245], v[122:125], a[92:95], v[242:245]
    s_waitcnt vmcnt(18)
    v_mfma_f32_16x16x32_bf16 v[166:169], v[126:129], a[0:3], v[166:169]
    s_mov_b32 s44, 262144
    buffer_load_dwordx4 a[64:67], v4, s[8:11], s44 offen sc1
    v_mfma_f32_16x16x32_bf16 v[166:169], v[146:149], a[16:19], v[166:169]
    ds_read_b128 v[86:89], v10 offset:40960
    v_mfma_f32_16x16x32_bf16 v[186:189], v[126:129], a[4:7], v[186:189]
    buffer_load_dwordx4 a[68:71], v5, s[8:11], s44 offen sc1
    v_mfma_f32_16x16x32_bf16 v[186:189], v[146:149], a[20:23], v[186:189]
    v_mfma_f32_16x16x32_bf16 v[206:209], v[126:129], a[8:11], v[206:209]
    ds_read_b128 v[90:93], v10 offset:41984
    v_mfma_f32_16x16x32_bf16 v[206:209], v[146:149], a[24:27], v[206:209]
    buffer_load_dwordx4 a[72:75], v6, s[8:11], s44 offen sc1
    v_mfma_f32_16x16x32_bf16 v[226:229], v[126:129], a[12:15], v[226:229]
    v_mfma_f32_16x16x32_bf16 v[226:229], v[146:149], a[28:31], v[226:229]
    ds_read_b128 v[94:97], v10 offset:43008
    v_mfma_f32_16x16x32_bf16 v[170:173], v[130:133], a[0:3], v[170:173]
    buffer_load_dwordx4 a[76:79], v7, s[8:11], s44 offen sc1
    v_mfma_f32_16x16x32_bf16 v[170:173], v[150:153], a[16:19], v[170:173]
    v_mfma_f32_16x16x32_bf16 v[190:193], v[130:133], a[4:7], v[190:193]
    ds_read_b128 v[98:101], v10 offset:44032
    v_mfma_f32_16x16x32_bf16 v[190:193], v[150:153], a[20:23], v[190:193]
    s_mov_b32 s44, 278528
    buffer_load_dwordx4 a[80:83], v4, s[8:11], s44 offen sc1
    v_mfma_f32_16x16x32_bf16 v[210:213], v[130:133], a[8:11], v[210:213]
    v_mfma_f32_16x16x32_bf16 v[210:213], v[150:153], a[24:27], v[210:213]
    ds_read_b128 v[102:105], v10 offset:45056
    v_mfma_f32_16x16x32_bf16 v[230:233], v[130:133], a[12:15], v[230:233]
    buffer_load_dwordx4 a[84:87], v5, s[8:11], s44 offen sc1
    v_mfma_f32_16x16x32_bf16 v[230:233], v[150:153], a[28:31], v[230:233]
    v_mfma_f32_16x16x32_bf16 v[174:177], v[134:137], a[0:3], v[174:177]
    ds_read_b128 v[106:109], v10 offset:46080
    v_mfma_f32_16x16x32_bf16 v[174:177], v[154:157], a[16:19], v[174:177]
    buffer_load_dwordx4 a[88:91], v6, s[8:11], s44 offen sc1
    v_mfma_f32_16x16x32_bf16 v[194:197], v[134:137], a[4:7], v[194:197]
    v_mfma_f32_16x16x32_bf16 v[194:197], v[154:157], a[20:23], v[194:197]
    ds_read_b128 v[110:113], v10 offset:47104
    v_mfma_f32_16x16x32_bf16 v[214:217], v[134:137], a[8:11], v[214:217]
    buffer_load_dwordx4 a[92:95], v7, s[8:11], s44 offen sc1
    v_mfma_f32_16x16x32_bf16 v[214:217], v[154:157], a[24:27], v[214:217]
    v_mfma_f32_16x16x32_bf16 v[234:237], v[134:137], a[12:15], v[234:237]
    ds_read_b128 v[114:117], v10 offset:48128
    v_mfma_f32_16x16x32_bf16 v[234:237], v[154:157], a[28:31], v[234:237]
    s_mov_b32 s45, 552960
    buffer_load_dwordx4 a[196:199], v16, s[20:23], s45 offen offset:0 sc1
    v_mfma_f32_16x16x32_bf16 v[178:181], v[138:141], a[0:3], v[178:181]
    v_mfma_f32_16x16x32_bf16 v[178:181], v[158:161], a[16:19], v[178:181]
    ds_read_b128 v[118:121], v10 offset:49152
    v_mfma_f32_16x16x32_bf16 v[198:201], v[138:141], a[4:7], v[198:201]
    buffer_load_dwordx4 a[200:203], v16, s[20:23], s45 offen offset:1024 sc1
    v_mfma_f32_16x16x32_bf16 v[198:201], v[158:161], a[20:23], v[198:201]
    v_mfma_f32_16x16x32_bf16 v[218:221], v[138:141], a[8:11], v[218:221]
    ds_read_b128 v[122:125], v10 offset:50176
    v_mfma_f32_16x16x32_bf16 v[218:221], v[158:161], a[24:27], v[218:221]
    buffer_load_dwordx4 a[204:207], v16, s[20:23], s45 offen offset:2048 sc1
    v_mfma_f32_16x16x32_bf16 v[238:241], v[138:141], a[12:15], v[238:241]
    v_mfma_f32_16x16x32_bf16 v[238:241], v[158:161], a[28:31], v[238:241]
    v_mfma_f32_16x16x32_bf16 v[182:185], v[142:145], a[0:3], v[182:185]
    buffer_load_dwordx4 a[208:211], v16, s[20:23], s45 offen offset:3072 sc1
    v_mfma_f32_16x16x32_bf16 v[182:185], v[162:165], a[16:19], v[182:185]
    v_mfma_f32_16x16x32_bf16 v[202:205], v[142:145], a[4:7], v[202:205]
    v_mfma_f32_16x16x32_bf16 v[202:205], v[162:165], a[20:23], v[202:205]
    buffer_load_dwordx4 a[212:215], v17, s[20:23], s45 offen offset:0 sc1
    v_mfma_f32_16x16x32_bf16 v[222:225], v[142:145], a[8:11], v[222:225]
    v_mfma_f32_16x16x32_bf16 v[222:225], v[162:165], a[24:27], v[222:225]
    v_mfma_f32_16x16x32_bf16 v[242:245], v[142:145], a[12:15], v[242:245]
    v_mfma_f32_16x16x32_bf16 v[242:245], v[162:165], a[28:31], v[242:245]
    s_waitcnt vmcnt(18) lgkmcnt(0)
    v_mfma_f32_16x16x32_bf16 v[166:169], v[86:89], a[32:35], v[166:169]
    s_mov_b32 s44, 294912
    buffer_load_dwordx4 a[0:3], v4, s[8:11], s44 offen sc1
    v_mfma_f32_16x16x32_bf16 v[166:169], v[106:109], a[48:51], v[166:169]
    ds_read_b128 v[126:129], v9 offset:0
    v_mfma_f32_16x16x32_bf16 v[186:189], v[86:89], a[36:39], v[186:189]
    buffer_load_dwordx4 a[4:7], v5, s[8:11], s44 offen sc1
    v_mfma_f32_16x16x32_bf16 v[186:189], v[106:109], a[52:55], v[186:189]
    v_mfma_f32_16x16x32_bf16 v[206:209], v[86:89], a[40:43], v[206:209]
    ds_read_b128 v[130:133], v9 offset:1024
    v_mfma_f32_16x16x32_bf16 v[206:209], v[106:109], a[56:59], v[206:209]
    buffer_load_dwordx4 a[8:11], v6, s[8:11], s44 offen sc1
    v_mfma_f32_16x16x32_bf16 v[226:229], v[86:89], a[44:47], v[226:229]
    v_mfma_f32_16x16x32_bf16 v[226:229], v[106:109], a[60:63], v[226:229]
    ds_read_b128 v[134:137], v9 offset:2048
    v_mfma_f32_16x16x32_bf16 v[170:173], v[90:93], a[32:35], v[170:173]
    buffer_load_dwordx4 a[12:15], v7, s[8:11], s44 offen sc1
    v_mfma_f32_16x16x32_bf16 v[170:173], v[110:113], a[48:51], v[170:173]
    v_mfma_f32_16x16x32_bf16 v[190:193], v[90:93], a[36:39], v[190:193]
    ds_read_b128 v[138:141], v9 offset:3072
    v_mfma_f32_16x16x32_bf16 v[190:193], v[110:113], a[52:55], v[190:193]
    s_mov_b32 s44, 311296
    buffer_load_dwordx4 a[16:19], v4, s[8:11], s44 offen sc1
    v_mfma_f32_16x16x32_bf16 v[210:213], v[90:93], a[40:43], v[210:213]
    v_mfma_f32_16x16x32_bf16 v[210:213], v[110:113], a[56:59], v[210:213]
    ds_read_b128 v[142:145], v9 offset:4096
    v_mfma_f32_16x16x32_bf16 v[230:233], v[90:93], a[44:47], v[230:233]
    buffer_load_dwordx4 a[20:23], v5, s[8:11], s44 offen sc1
    v_mfma_f32_16x16x32_bf16 v[230:233], v[110:113], a[60:63], v[230:233]
    v_mfma_f32_16x16x32_bf16 v[174:177], v[94:97], a[32:35], v[174:177]
    ds_read_b128 v[146:149], v9 offset:5120
    v_mfma_f32_16x16x32_bf16 v[174:177], v[114:117], a[48:51], v[174:177]
    buffer_load_dwordx4 a[24:27], v6, s[8:11], s44 offen sc1
    v_mfma_f32_16x16x32_bf16 v[194:197], v[94:97], a[36:39], v[194:197]
    v_mfma_f32_16x16x32_bf16 v[194:197], v[114:117], a[52:55], v[194:197]
    ds_read_b128 v[150:153], v9 offset:6144
    v_mfma_f32_16x16x32_bf16 v[214:217], v[94:97], a[40:43], v[214:217]
    buffer_load_dwordx4 a[28:31], v7, s[8:11], s44 offen sc1
    v_mfma_f32_16x16x32_bf16 v[214:217], v[114:117], a[56:59], v[214:217]
    v_mfma_f32_16x16x32_bf16 v[234:237], v[94:97], a[44:47], v[234:237]
    ds_read_b128 v[154:157], v9 offset:7168
    v_mfma_f32_16x16x32_bf16 v[234:237], v[114:117], a[60:63], v[234:237]
    s_mov_b32 s45, 573440
    buffer_load_dwordx4 a[216:219], v16, s[20:23], s45 offen offset:0 sc1
    v_mfma_f32_16x16x32_bf16 v[178:181], v[98:101], a[32:35], v[178:181]
    v_mfma_f32_16x16x32_bf16 v[178:181], v[118:121], a[48:51], v[178:181]
    ds_read_b128 v[158:161], v9 offset:8192
    v_mfma_f32_16x16x32_bf16 v[198:201], v[98:101], a[36:39], v[198:201]
    buffer_load_dwordx4 a[220:223], v16, s[20:23], s45 offen offset:1024 sc1
    v_mfma_f32_16x16x32_bf16 v[198:201], v[118:121], a[52:55], v[198:201]
    v_mfma_f32_16x16x32_bf16 v[218:221], v[98:101], a[40:43], v[218:221]
    ds_read_b128 v[162:165], v9 offset:9216
    v_mfma_f32_16x16x32_bf16 v[218:221], v[118:121], a[56:59], v[218:221]
    buffer_load_dwordx4 a[224:227], v16, s[20:23], s45 offen offset:2048 sc1
    v_mfma_f32_16x16x32_bf16 v[238:241], v[98:101], a[44:47], v[238:241]
    v_mfma_f32_16x16x32_bf16 v[238:241], v[118:121], a[60:63], v[238:241]
    v_mfma_f32_16x16x32_bf16 v[182:185], v[102:105], a[32:35], v[182:185]
    buffer_load_dwordx4 a[228:231], v16, s[20:23], s45 offen offset:3072 sc1
    v_mfma_f32_16x16x32_bf16 v[182:185], v[122:125], a[48:51], v[182:185]
    v_mfma_f32_16x16x32_bf16 v[202:205], v[102:105], a[36:39], v[202:205]
    v_mfma_f32_16x16x32_bf16 v[202:205], v[122:125], a[52:55], v[202:205]
    buffer_load_dwordx4 a[232:235], v17, s[20:23], s45 offen offset:0 sc1
    v_mfma_f32_16x16x32_bf16 v[222:225], v[102:105], a[40:43], v[222:225]
    v_mfma_f32_16x16x32_bf16 v[222:225], v[122:125], a[56:59], v[222:225]
    v_mfma_f32_16x16x32_bf16 v[242:245], v[102:105], a[44:47], v[242:245]
    v_mfma_f32_16x16x32_bf16 v[242:245], v[122:125], a[60:63], v[242:245]
    s_waitcnt vmcnt(18) lgkmcnt(0)
    v_mfma_f32_16x16x32_bf16 v[166:169], v[126:129], a[64:67], v[166:169]
    s_mov_b32 s44, 327680
    buffer_load_dwordx4 a[32:35], v4, s[8:11], s44 offen sc1
    v_mfma_f32_16x16x32_bf16 v[166:169], v[146:149], a[80:83], v[166:169]
    ds_read_b128 v[86:89], v9 offset:40960
    v_mfma_f32_16x16x32_bf16 v[186:189], v[126:129], a[68:71], v[186:189]
    buffer_load_dwordx4 a[36:39], v5, s[8:11], s44 offen sc1
    v_mfma_f32_16x16x32_bf16 v[186:189], v[146:149], a[84:87], v[186:189]
    v_mfma_f32_16x16x32_bf16 v[206:209], v[126:129], a[72:75], v[206:209]
    ds_read_b128 v[90:93], v9 offset:41984
    v_mfma_f32_16x16x32_bf16 v[206:209], v[146:149], a[88:91], v[206:209]
    buffer_load_dwordx4 a[40:43], v6, s[8:11], s44 offen sc1
    v_mfma_f32_16x16x32_bf16 v[226:229], v[126:129], a[76:79], v[226:229]
    v_mfma_f32_16x16x32_bf16 v[226:229], v[146:149], a[92:95], v[226:229]
    ds_read_b128 v[94:97], v9 offset:43008
    v_mfma_f32_16x16x32_bf16 v[170:173], v[130:133], a[64:67], v[170:173]
    buffer_load_dwordx4 a[44:47], v7, s[8:11], s44 offen sc1
    v_mfma_f32_16x16x32_bf16 v[170:173], v[150:153], a[80:83], v[170:173]
    v_mfma_f32_16x16x32_bf16 v[190:193], v[130:133], a[68:71], v[190:193]
    ds_read_b128 v[98:101], v9 offset:44032
    v_mfma_f32_16x16x32_bf16 v[190:193], v[150:153], a[84:87], v[190:193]
    s_mov_b32 s44, 344064
    buffer_load_dwordx4 a[48:51], v4, s[8:11], s44 offen sc1
    v_mfma_f32_16x16x32_bf16 v[210:213], v[130:133], a[72:75], v[210:213]
    v_mfma_f32_16x16x32_bf16 v[210:213], v[150:153], a[88:91], v[210:213]
    ds_read_b128 v[102:105], v9 offset:45056
    v_mfma_f32_16x16x32_bf16 v[230:233], v[130:133], a[76:79], v[230:233]
    buffer_load_dwordx4 a[52:55], v5, s[8:11], s44 offen sc1
    v_mfma_f32_16x16x32_bf16 v[230:233], v[150:153], a[92:95], v[230:233]
    v_mfma_f32_16x16x32_bf16 v[174:177], v[134:137], a[64:67], v[174:177]
    ds_read_b128 v[106:109], v9 offset:46080
    v_mfma_f32_16x16x32_bf16 v[174:177], v[154:157], a[80:83], v[174:177]
    buffer_load_dwordx4 a[56:59], v6, s[8:11], s44 offen sc1
    v_mfma_f32_16x16x32_bf16 v[194:197], v[134:137], a[68:71], v[194:197]
    v_mfma_f32_16x16x32_bf16 v[194:197], v[154:157], a[84:87], v[194:197]
    ds_read_b128 v[110:113], v9 offset:47104
    v_mfma_f32_16x16x32_bf16 v[214:217], v[134:137], a[72:75], v[214:217]
    buffer_load_dwordx4 a[60:63], v7, s[8:11], s44 offen sc1
    v_mfma_f32_16x16x32_bf16 v[214:217], v[154:157], a[88:91], v[214:217]
    v_mfma_f32_16x16x32_bf16 v[234:237], v[134:137], a[76:79], v[234:237]
    ds_read_b128 v[114:117], v9 offset:48128
    v_mfma_f32_16x16x32_bf16 v[234:237], v[154:157], a[92:95], v[234:237]
    s_mov_b32 s45, 593920
    buffer_load_dwordx4 a[236:239], v16, s[20:23], s45 offen offset:0 sc1
    v_mfma_f32_16x16x32_bf16 v[178:181], v[138:141], a[64:67], v[178:181]
    v_mfma_f32_16x16x32_bf16 v[178:181], v[158:161], a[80:83], v[178:181]
    ds_read_b128 v[118:121], v9 offset:49152
    v_mfma_f32_16x16x32_bf16 v[198:201], v[138:141], a[68:71], v[198:201]
    buffer_load_dwordx4 a[240:243], v16, s[20:23], s45 offen offset:1024 sc1
    v_mfma_f32_16x16x32_bf16 v[198:201], v[158:161], a[84:87], v[198:201]
    v_mfma_f32_16x16x32_bf16 v[218:221], v[138:141], a[72:75], v[218:221]
    ds_read_b128 v[122:125], v9 offset:50176
    v_mfma_f32_16x16x32_bf16 v[218:221], v[158:161], a[88:91], v[218:221]
    buffer_load_dwordx4 a[244:247], v16, s[20:23], s45 offen offset:2048 sc1
    v_mfma_f32_16x16x32_bf16 v[238:241], v[138:141], a[76:79], v[238:241]
    v_mfma_f32_16x16x32_bf16 v[238:241], v[158:161], a[92:95], v[238:241]
    v_mfma_f32_16x16x32_bf16 v[182:185], v[142:145], a[64:67], v[182:185]
    buffer_load_dwordx4 a[248:251], v16, s[20:23], s45 offen offset:3072 sc1
    v_mfma_f32_16x16x32_bf16 v[182:185], v[162:165], a[80:83], v[182:185]
    v_mfma_f32_16x16x32_bf16 v[202:205], v[142:145], a[68:71], v[202:205]
    v_mfma_f32_16x16x32_bf16 v[202:205], v[162:165], a[84:87], v[202:205]
    buffer_load_dwordx4 a[252:255], v17, s[20:23], s45 offen offset:0 sc1
    v_mfma_f32_16x16x32_bf16 v[222:225], v[142:145], a[72:75], v[222:225]
    v_mfma_f32_16x16x32_bf16 v[222:225], v[162:165], a[88:91], v[222:225]
    v_mfma_f32_16x16x32_bf16 v[242:245], v[142:145], a[76:79], v[242:245]
    v_mfma_f32_16x16x32_bf16 v[242:245], v[162:165], a[92:95], v[242:245]
    s_waitcnt vmcnt(18) lgkmcnt(0)
    v_mfma_f32_16x16x32_bf16 v[166:169], v[86:89], a[0:3], v[166:169]
    s_mov_b32 s44, 360448
    buffer_load_dwordx4 a[64:67], v4, s[8:11], s44 offen sc1
    v_mfma_f32_16x16x32_bf16 v[166:169], v[106:109], a[16:19], v[166:169]
    ds_read_b128 v[126:129], v10 offset:0
    v_mfma_f32_16x16x32_bf16 v[186:189], v[86:89], a[4:7], v[186:189]
    buffer_load_dwordx4 a[68:71], v5, s[8:11], s44 offen sc1
    v_mfma_f32_16x16x32_bf16 v[186:189], v[106:109], a[20:23], v[186:189]
    v_mfma_f32_16x16x32_bf16 v[206:209], v[86:89], a[8:11], v[206:209]
    ds_read_b128 v[130:133], v10 offset:1024
    v_mfma_f32_16x16x32_bf16 v[206:209], v[106:109], a[24:27], v[206:209]
    buffer_load_dwordx4 a[72:75], v6, s[8:11], s44 offen sc1
    v_mfma_f32_16x16x32_bf16 v[226:229], v[86:89], a[12:15], v[226:229]
    v_mfma_f32_16x16x32_bf16 v[226:229], v[106:109], a[28:31], v[226:229]
    ds_read_b128 v[134:137], v10 offset:2048
    v_mfma_f32_16x16x32_bf16 v[170:173], v[90:93], a[0:3], v[170:173]
    buffer_load_dwordx4 a[76:79], v7, s[8:11], s44 offen sc1
    v_mfma_f32_16x16x32_bf16 v[170:173], v[110:113], a[16:19], v[170:173]
    v_mfma_f32_16x16x32_bf16 v[190:193], v[90:93], a[4:7], v[190:193]
    ds_read_b128 v[138:141], v10 offset:3072
    v_mfma_f32_16x16x32_bf16 v[190:193], v[110:113], a[20:23], v[190:193]
    s_mov_b32 s44, 376832
    buffer_load_dwordx4 a[80:83], v4, s[8:11], s44 offen sc1
    v_mfma_f32_16x16x32_bf16 v[210:213], v[90:93], a[8:11], v[210:213]
    v_mfma_f32_16x16x32_bf16 v[210:213], v[110:113], a[24:27], v[210:213]
    ds_read_b128 v[142:145], v10 offset:4096
    v_mfma_f32_16x16x32_bf16 v[230:233], v[90:93], a[12:15], v[230:233]
    buffer_load_dwordx4 a[84:87], v5, s[8:11], s44 offen sc1
    v_mfma_f32_16x16x32_bf16 v[230:233], v[110:113], a[28:31], v[230:233]
    v_mfma_f32_16x16x32_bf16 v[174:177], v[94:97], a[0:3], v[174:177]
    ds_read_b128 v[146:149], v10 offset:5120
    v_mfma_f32_16x16x32_bf16 v[174:177], v[114:117], a[16:19], v[174:177]
    buffer_load_dwordx4 a[88:91], v6, s[8:11], s44 offen sc1
    v_mfma_f32_16x16x32_bf16 v[194:197], v[94:97], a[4:7], v[194:197]
    v_mfma_f32_16x16x32_bf16 v[194:197], v[114:117], a[20:23], v[194:197]
    ds_read_b128 v[150:153], v10 offset:6144
    v_mfma_f32_16x16x32_bf16 v[214:217], v[94:97], a[8:11], v[214:217]
    buffer_load_dwordx4 a[92:95], v7, s[8:11], s44 offen sc1
    v_mfma_f32_16x16x32_bf16 v[214:217], v[114:117], a[24:27], v[214:217]
    v_mfma_f32_16x16x32_bf16 v[234:237], v[94:97], a[12:15], v[234:237]
    ds_read_b128 v[154:157], v10 offset:7168
    v_mfma_f32_16x16x32_bf16 v[234:237], v[114:117], a[28:31], v[234:237]
    s_mov_b32 s45, 614400
    buffer_load_dwordx4 v[46:49], v16, s[20:23], s45 offen offset:0 sc1
    v_mfma_f32_16x16x32_bf16 v[178:181], v[98:101], a[0:3], v[178:181]
    v_mfma_f32_16x16x32_bf16 v[178:181], v[118:121], a[16:19], v[178:181]
    ds_read_b128 v[158:161], v10 offset:8192
    v_mfma_f32_16x16x32_bf16 v[198:201], v[98:101], a[4:7], v[198:201]
    buffer_load_dwordx4 v[50:53], v16, s[20:23], s45 offen offset:1024 sc1
    v_mfma_f32_16x16x32_bf16 v[198:201], v[118:121], a[20:23], v[198:201]
    v_mfma_f32_16x16x32_bf16 v[218:221], v[98:101], a[8:11], v[218:221]
    ds_read_b128 v[162:165], v10 offset:9216
    v_mfma_f32_16x16x32_bf16 v[218:221], v[118:121], a[24:27], v[218:221]
    buffer_load_dwordx4 v[54:57], v16, s[20:23], s45 offen offset:2048 sc1
    v_mfma_f32_16x16x32_bf16 v[238:241], v[98:101], a[12:15], v[238:241]
    v_mfma_f32_16x16x32_bf16 v[238:241], v[118:121], a[28:31], v[238:241]
    v_mfma_f32_16x16x32_bf16 v[182:185], v[102:105], a[0:3], v[182:185]
    buffer_load_dwordx4 v[58:61], v16, s[20:23], s45 offen offset:3072 sc1
    v_mfma_f32_16x16x32_bf16 v[182:185], v[122:125], a[16:19], v[182:185]
    v_mfma_f32_16x16x32_bf16 v[202:205], v[102:105], a[4:7], v[202:205]
    v_mfma_f32_16x16x32_bf16 v[202:205], v[122:125], a[20:23], v[202:205]
    buffer_load_dwordx4 v[62:65], v17, s[20:23], s45 offen offset:0 sc1
    v_mfma_f32_16x16x32_bf16 v[222:225], v[102:105], a[8:11], v[222:225]
    v_mfma_f32_16x16x32_bf16 v[222:225], v[122:125], a[24:27], v[222:225]
    v_mfma_f32_16x16x32_bf16 v[242:245], v[102:105], a[12:15], v[242:245]
    v_mfma_f32_16x16x32_bf16 v[242:245], v[122:125], a[28:31], v[242:245]
    s_waitcnt vmcnt(18) lgkmcnt(0)
    v_mfma_f32_16x16x32_bf16 v[166:169], v[126:129], a[32:35], v[166:169]
    s_mov_b32 s44, 393216
    buffer_load_dwordx4 a[0:3], v4, s[8:11], s44 offen sc1
    v_mfma_f32_16x16x32_bf16 v[166:169], v[146:149], a[48:51], v[166:169]
    v_mfma_f32_16x16x32_bf16 v[186:189], v[126:129], a[36:39], v[186:189]
    buffer_load_dwordx4 a[4:7], v5, s[8:11], s44 offen sc1
    v_mfma_f32_16x16x32_bf16 v[186:189], v[146:149], a[52:55], v[186:189]
    v_mfma_f32_16x16x32_bf16 v[206:209], v[126:129], a[40:43], v[206:209]
    v_mfma_f32_16x16x32_bf16 v[206:209], v[146:149], a[56:59], v[206:209]
    buffer_load_dwordx4 a[8:11], v6, s[8:11], s44 offen sc1
    v_mfma_f32_16x16x32_bf16 v[226:229], v[126:129], a[44:47], v[226:229]
    v_mfma_f32_16x16x32_bf16 v[226:229], v[146:149], a[60:63], v[226:229]
    v_mfma_f32_16x16x32_bf16 v[170:173], v[130:133], a[32:35], v[170:173]
    buffer_load_dwordx4 a[12:15], v7, s[8:11], s44 offen sc1
    v_mfma_f32_16x16x32_bf16 v[170:173], v[150:153], a[48:51], v[170:173]
    v_mfma_f32_16x16x32_bf16 v[190:193], v[130:133], a[36:39], v[190:193]
    v_mfma_f32_16x16x32_bf16 v[190:193], v[150:153], a[52:55], v[190:193]
    s_mov_b32 s44, 409600
    buffer_load_dwordx4 a[16:19], v4, s[8:11], s44 offen sc1
    v_mfma_f32_16x16x32_bf16 v[210:213], v[130:133], a[40:43], v[210:213]
    v_mfma_f32_16x16x32_bf16 v[210:213], v[150:153], a[56:59], v[210:213]
    v_mfma_f32_16x16x32_bf16 v[230:233], v[130:133], a[44:47], v[230:233]
    buffer_load_dwordx4 a[20:23], v5, s[8:11], s44 offen sc1
    v_mfma_f32_16x16x32_bf16 v[230:233], v[150:153], a[60:63], v[230:233]
    v_mfma_f32_16x16x32_bf16 v[174:177], v[134:137], a[32:35], v[174:177]
    v_mfma_f32_16x16x32_bf16 v[174:177], v[154:157], a[48:51], v[174:177]
    buffer_load_dwordx4 a[24:27], v6, s[8:11], s44 offen sc1
    v_mfma_f32_16x16x32_bf16 v[194:197], v[134:137], a[36:39], v[194:197]
    v_mfma_f32_16x16x32_bf16 v[194:197], v[154:157], a[52:55], v[194:197]
    v_mfma_f32_16x16x32_bf16 v[214:217], v[134:137], a[40:43], v[214:217]
    buffer_load_dwordx4 a[28:31], v7, s[8:11], s44 offen sc1
    v_mfma_f32_16x16x32_bf16 v[214:217], v[154:157], a[56:59], v[214:217]
    v_mfma_f32_16x16x32_bf16 v[234:237], v[134:137], a[44:47], v[234:237]
    v_mfma_f32_16x16x32_bf16 v[234:237], v[154:157], a[60:63], v[234:237]
    s_mov_b32 s45, 634880
    buffer_load_dwordx4 v[66:69], v16, s[20:23], s45 offen offset:0 sc1
    v_mfma_f32_16x16x32_bf16 v[178:181], v[138:141], a[32:35], v[178:181]
    v_mfma_f32_16x16x32_bf16 v[178:181], v[158:161], a[48:51], v[178:181]
    v_mfma_f32_16x16x32_bf16 v[198:201], v[138:141], a[36:39], v[198:201]
    buffer_load_dwordx4 v[70:73], v16, s[20:23], s45 offen offset:1024 sc1
    v_mfma_f32_16x16x32_bf16 v[198:201], v[158:161], a[52:55], v[198:201]
    v_mfma_f32_16x16x32_bf16 v[218:221], v[138:141], a[40:43], v[218:221]
    v_mfma_f32_16x16x32_bf16 v[218:221], v[158:161], a[56:59], v[218:221]
    buffer_load_dwordx4 v[74:77], v16, s[20:23], s45 offen offset:2048 sc1
    v_mfma_f32_16x16x32_bf16 v[238:241], v[138:141], a[44:47], v[238:241]
    v_mfma_f32_16x16x32_bf16 v[238:241], v[158:161], a[60:63], v[238:241]
    v_mfma_f32_16x16x32_bf16 v[182:185], v[142:145], a[32:35], v[182:185]
    buffer_load_dwordx4 v[78:81], v16, s[20:23], s45 offen offset:3072 sc1
    v_mfma_f32_16x16x32_bf16 v[182:185], v[162:165], a[48:51], v[182:185]
    v_mfma_f32_16x16x32_bf16 v[202:205], v[142:145], a[36:39], v[202:205]
    v_mfma_f32_16x16x32_bf16 v[202:205], v[162:165], a[52:55], v[202:205]
    buffer_load_dwordx4 v[82:85], v17, s[20:23], s45 offen offset:0 sc1
    v_mfma_f32_16x16x32_bf16 v[222:225], v[142:145], a[40:43], v[222:225]
    v_mfma_f32_16x16x32_bf16 v[222:225], v[162:165], a[56:59], v[222:225]
    v_mfma_f32_16x16x32_bf16 v[242:245], v[142:145], a[44:47], v[242:245]
    v_mfma_f32_16x16x32_bf16 v[242:245], v[162:165], a[60:63], v[242:245]
    s_waitcnt vmcnt(18)
    v_mfma_f32_16x16x32_bf16 v[166:169], a[96:99], a[64:67], v[166:169]
    s_mov_b32 s44, 425984
    buffer_load_dwordx4 a[32:35], v4, s[8:11], s44 offen sc1
    v_mfma_f32_16x16x32_bf16 v[166:169], a[116:119], a[80:83], v[166:169]
    v_mfma_f32_16x16x32_bf16 v[186:189], a[96:99], a[68:71], v[186:189]
    v_mfma_f32_16x16x32_bf16 v[186:189], a[116:119], a[84:87], v[186:189]
    v_mfma_f32_16x16x32_bf16 v[206:209], a[96:99], a[72:75], v[206:209]
    buffer_load_dwordx4 a[36:39], v5, s[8:11], s44 offen sc1
    v_mfma_f32_16x16x32_bf16 v[206:209], a[116:119], a[88:91], v[206:209]
    v_mfma_f32_16x16x32_bf16 v[226:229], a[96:99], a[76:79], v[226:229]
    v_mfma_f32_16x16x32_bf16 v[226:229], a[116:119], a[92:95], v[226:229]
    v_mfma_f32_16x16x32_bf16 v[170:173], a[100:103], a[64:67], v[170:173]
    v_mfma_f32_16x16x32_bf16 v[170:173], a[120:123], a[80:83], v[170:173]
    buffer_load_dwordx4 a[40:43], v6, s[8:11], s44 offen sc1
    v_mfma_f32_16x16x32_bf16 v[190:193], a[100:103], a[68:71], v[190:193]
    v_mfma_f32_16x16x32_bf16 v[190:193], a[120:123], a[84:87], v[190:193]
    v_mfma_f32_16x16x32_bf16 v[210:213], a[100:103], a[72:75], v[210:213]
    v_mfma_f32_16x16x32_bf16 v[210:213], a[120:123], a[88:91], v[210:213]
    v_mfma_f32_16x16x32_bf16 v[230:233], a[100:103], a[76:79], v[230:233]
    buffer_load_dwordx4 a[44:47], v7, s[8:11], s44 offen sc1
    v_mfma_f32_16x16x32_bf16 v[230:233], a[120:123], a[92:95], v[230:233]
    v_mfma_f32_16x16x32_bf16 v[174:177], a[104:107], a[64:67], v[174:177]
    v_mfma_f32_16x16x32_bf16 v[174:177], a[124:127], a[80:83], v[174:177]
    v_mfma_f32_16x16x32_bf16 v[194:197], a[104:107], a[68:71], v[194:197]
    v_mfma_f32_16x16x32_bf16 v[194:197], a[124:127], a[84:87], v[194:197]
    s_mov_b32 s44, 442368
    buffer_load_dwordx4 a[48:51], v4, s[8:11], s44 offen sc1
    v_mfma_f32_16x16x32_bf16 v[214:217], a[104:107], a[72:75], v[214:217]
    v_mfma_f32_16x16x32_bf16 v[214:217], a[124:127], a[88:91], v[214:217]
    v_mfma_f32_16x16x32_bf16 v[234:237], a[104:107], a[76:79], v[234:237]
    v_mfma_f32_16x16x32_bf16 v[234:237], a[124:127], a[92:95], v[234:237]
    buffer_load_dwordx4 a[52:55], v5, s[8:11], s44 offen sc1
    v_mfma_f32_16x16x32_bf16 v[178:181], a[108:111], a[64:67], v[178:181]
    v_mfma_f32_16x16x32_bf16 v[178:181], a[128:131], a[80:83], v[178:181]
    v_mfma_f32_16x16x32_bf16 v[198:201], a[108:111], a[68:71], v[198:201]
    v_mfma_f32_16x16x32_bf16 v[198:201], a[128:131], a[84:87], v[198:201]
    v_mfma_f32_16x16x32_bf16 v[218:221], a[108:111], a[72:75], v[218:221]
    buffer_load_dwordx4 a[56:59], v6, s[8:11], s44 offen sc1
    v_mfma_f32_16x16x32_bf16 v[218:221], a[128:131], a[88:91], v[218:221]
    v_mfma_f32_16x16x32_bf16 v[238:241], a[108:111], a[76:79], v[238:241]
    v_mfma_f32_16x16x32_bf16 v[238:241], a[128:131], a[92:95], v[238:241]
    v_mfma_f32_16x16x32_bf16 v[182:185], a[112:115], a[64:67], v[182:185]
    v_mfma_f32_16x16x32_bf16 v[182:185], a[132:135], a[80:83], v[182:185]
    buffer_load_dwordx4 a[60:63], v7, s[8:11], s44 offen sc1
    v_mfma_f32_16x16x32_bf16 v[202:205], a[112:115], a[68:71], v[202:205]
    v_mfma_f32_16x16x32_bf16 v[202:205], a[132:135], a[84:87], v[202:205]
    v_mfma_f32_16x16x32_bf16 v[222:225], a[112:115], a[72:75], v[222:225]
    v_mfma_f32_16x16x32_bf16 v[222:225], a[132:135], a[88:91], v[222:225]
    v_mfma_f32_16x16x32_bf16 v[242:245], a[112:115], a[76:79], v[242:245]
    s_cmp_eq_u32 s101, 0
    s_cbranch_scc1 L_no_fl
    v_lshlrev_b32 v1, 4, v19
    v_add_u32 v1, 0x291400, v1
    buffer_load_dwordx4 v[150:153], v1, s[76:79], 0 offen offset:0 sc1
    buffer_load_dwordx4 v[154:157], v1, s[76:79], 0 offen offset:1024 sc1
    buffer_load_dwordx4 v[158:161], v1, s[76:79], 0 offen offset:2048 sc1
    buffer_load_dwordx4 v[162:165], v1, s[76:79], 0 offen offset:3072 sc1
L_no_fl:
    v_mfma_f32_16x16x32_bf16 v[242:245], a[132:135], a[92:95], v[242:245]
    s_waitcnt vmcnt(13)
    v_mfma_f32_16x16x32_bf16 v[166:169], a[136:139], a[0:3], v[166:169]
    s_mov_b32 s44, 458752
    buffer_load_dwordx4 a[64:67], v4, s[8:11], s44 offen sc1
    v_mfma_f32_16x16x32_bf16 v[166:169], a[156:159], a[16:19], v[166:169]
    v_mfma_f32_16x16x32_bf16 v[186:189], a[136:139], a[4:7], v[186:189]
    v_mfma_f32_16x16x32_bf16 v[186:189], a[156:159], a[20:23], v[186:189]
    v_mfma_f32_16x16x32_bf16 v[206:209], a[136:139], a[8:11], v[206:209]
    buffer_load_dwordx4 a[68:71], v5, s[8:11], s44 offen sc1
    v_mfma_f32_16x16x32_bf16 v[206:209], a[156:159], a[24:27], v[206:209]
    v_mfma_f32_16x16x32_bf16 v[226:229], a[136:139], a[12:15], v[226:229]
    v_mfma_f32_16x16x32_bf16 v[226:229], a[156:159], a[28:31], v[226:229]
    v_mfma_f32_16x16x32_bf16 v[170:173], a[140:143], a[0:3], v[170:173]
    v_mfma_f32_16x16x32_bf16 v[170:173], a[160:163], a[16:19], v[170:173]
    buffer_load_dwordx4 a[72:75], v6, s[8:11], s44 offen sc1
    v_mfma_f32_16x16x32_bf16 v[190:193], a[140:143], a[4:7], v[190:193]
    v_mfma_f32_16x16x32_bf16 v[190:193], a[160:163], a[20:23], v[190:193]
    v_mfma_f32_16x16x32_bf16 v[210:213], a[140:143], a[8:11], v[210:213]
    v_mfma_f32_16x16x32_bf16 v[210:213], a[160:163], a[24:27], v[210:213]
    v_mfma_f32_16x16x32_bf16 v[230:233], a[140:143], a[12:15], v[230:233]
    buffer_load_dwordx4 a[76:79], v7, s[8:11], s44 offen sc1
    v_mfma_f32_16x16x32_bf16 v[230:233], a[160:163], a[28:31], v[230:233]
    v_mfma_f32_16x16x32_bf16 v[174:177], a[144:147], a[0:3], v[174:177]
    v_mfma_f32_16x16x32_bf16 v[174:177], a[164:167], a[16:19], v[174:177]
    v_mfma_f32_16x16x32_bf16 v[194:197], a[144:147], a[4:7], v[194:197]
    v_mfma_f32_16x16x32_bf16 v[194:197], a[164:167], a[20:23], v[194:197]
    s_mov_b32 s44, 475136
    buffer_load_dwordx4 a[80:83], v4, s[8:11], s44 offen sc1
    v_mfma_f32_16x16x32_bf16 v[214:217], a[144:147], a[8:11], v[214:217]
    v_mfma_f32_16x16x32_bf16 v[214:217], a[164:167], a[24:27], v[214:217]
    v_mfma_f32_16x16x32_bf16 v[234:237], a[144:147], a[12:15], v[234:237]
    v_mfma_f32_16x16x32_bf16 v[234:237], a[164:167], a[28:31], v[234:237]
    buffer_load_dwordx4 a[84:87], v5, s[8:11], s44 offen sc1
    v_mfma_f32_16x16x32_bf16 v[178:181], a[148:151], a[0:3], v[178:181]
    v_mfma_f32_16x16x32_bf16 v[178:181], a[168:171], a[16:19], v[178:181]
    v_mfma_f32_16x16x32_bf16 v[198:201], a[148:151], a[4:7], v[198:201]
    v_mfma_f32_16x16x32_bf16 v[198:201], a[168:171], a[20:23], v[198:201]
    v_mfma_f32_16x16x32_bf16 v[218:221], a[148:151], a[8:11], v[218:221]
    buffer_load_dwordx4 a[88:91], v6, s[8:11], s44 offen sc1
    v_mfma_f32_16x16x32_bf16 v[218:221], a[168:171], a[24:27], v[218:221]
    v_mfma_f32_16x16x32_bf16 v[238:241], a[148:151], a[12:15], v[238:241]
    v_mfma_f32_16x16x32_bf16 v[238:241], a[168:171], a[28:31], v[238:241]
    v_mfma_f32_16x16x32_bf16 v[182:185], a[152:155], a[0:3], v[182:185]
    v_mfma_f32_16x16x32_bf16 v[182:185], a[172:175], a[16:19], v[182:185]
    buffer_load_dwordx4 a[92:95], v7, s[8:11], s44 offen sc1
    v_mfma_f32_16x16x32_bf16 v[202:205], a[152:155], a[4:7], v[202:205]
    v_mfma_f32_16x16x32_bf16 v[202:205], a[172:175], a[20:23], v[202:205]
    v_mfma_f32_16x16x32_bf16 v[222:225], a[152:155], a[8:11], v[222:225]
    v_mfma_f32_16x16x32_bf16 v[222:225], a[172:175], a[24:27], v[222:225]
    v_mfma_f32_16x16x32_bf16 v[242:245], a[152:155], a[12:15], v[242:245]
    v_mfma_f32_16x16x32_bf16 v[242:245], a[172:175], a[28:31], v[242:245]
    s_waitcnt vmcnt(8)
    v_mfma_f32_16x16x32_bf16 v[166:169], a[176:179], a[32:35], v[166:169]
    s_mov_b32 s44, 491520
    buffer_load_dwordx4 a[0:3], v4, s[8:11], s44 offen sc1
    v_mfma_f32_16x16x32_bf16 v[166:169], a[196:199], a[48:51], v[166:169]
    v_mfma_f32_16x16x32_bf16 v[186:189], a[176:179], a[36:39], v[186:189]
    v_mfma_f32_16x16x32_bf16 v[186:189], a[196:199], a[52:55], v[186:189]
    v_mfma_f32_16x16x32_bf16 v[206:209], a[176:179], a[40:43], v[206:209]
    buffer_load_dwordx4 a[4:7], v5, s[8:11], s44 offen sc1
    v_mfma_f32_16x16x32_bf16 v[206:209], a[196:199], a[56:59], v[206:209]
    v_mfma_f32_16x16x32_bf16 v[226:229], a[176:179], a[44:47], v[226:229]
    v_mfma_f32_16x16x32_bf16 v[226:229], a[196:199], a[60:63], v[226:229]
    v_mfma_f32_16x16x32_bf16 v[170:173], a[180:183], a[32:35], v[170:173]
    v_mfma_f32_16x16x32_bf16 v[170:173], a[200:203], a[48:51], v[170:173]
    buffer_load_dwordx4 a[8:11], v6, s[8:11], s44 offen sc1
    v_mfma_f32_16x16x32_bf16 v[190:193], a[180:183], a[36:39], v[190:193]
    v_mfma_f32_16x16x32_bf16 v[190:193], a[200:203], a[52:55], v[190:193]
    v_mfma_f32_16x16x32_bf16 v[210:213], a[180:183], a[40:43], v[210:213]
    v_mfma_f32_16x16x32_bf16 v[210:213], a[200:203], a[56:59], v[210:213]
    v_mfma_f32_16x16x32_bf16 v[230:233], a[180:183], a[44:47], v[230:233]
    buffer_load_dwordx4 a[12:15], v7, s[8:11], s44 offen sc1
    v_mfma_f32_16x16x32_bf16 v[230:233], a[200:203], a[60:63], v[230:233]
    v_mfma_f32_16x16x32_bf16 v[174:177], a[184:187], a[32:35], v[174:177]
    v_mfma_f32_16x16x32_bf16 v[174:177], a[204:207], a[48:51], v[174:177]
    v_mfma_f32_16x16x32_bf16 v[194:197], a[184:187], a[36:39], v[194:197]
    v_mfma_f32_16x16x32_bf16 v[194:197], a[204:207], a[52:55], v[194:197]
    s_mov_b32 s44, 507904
    buffer_load_dwordx4 a[16:19], v4, s[8:11], s44 offen sc1
    v_mfma_f32_16x16x32_bf16 v[214:217], a[184:187], a[40:43], v[214:217]
    v_mfma_f32_16x16x32_bf16 v[214:217], a[204:207], a[56:59], v[214:217]
    v_mfma_f32_16x16x32_bf16 v[234:237], a[184:187], a[44:47], v[234:237]
    v_mfma_f32_16x16x32_bf16 v[234:237], a[204:207], a[60:63], v[234:237]
    buffer_load_dwordx4 a[20:23], v5, s[8:11], s44 offen sc1
    v_mfma_f32_16x16x32_bf16 v[178:181], a[188:191], a[32:35], v[178:181]
    v_mfma_f32_16x16x32_bf16 v[178:181], a[208:211], a[48:51], v[178:181]
    v_mfma_f32_16x16x32_bf16 v[198:201], a[188:191], a[36:39], v[198:201]
    v_mfma_f32_16x16x32_bf16 v[198:201], a[208:211], a[52:55], v[198:201]
    v_mfma_f32_16x16x32_bf16 v[218:221], a[188:191], a[40:43], v[218:221]
    buffer_load_dwordx4 a[24:27], v6, s[8:11], s44 offen sc1
    v_mfma_f32_16x16x32_bf16 v[218:221], a[208:211], a[56:59], v[218:221]
    v_mfma_f32_16x16x32_bf16 v[238:241], a[188:191], a[44:47], v[238:241]
    v_mfma_f32_16x16x32_bf16 v[238:241], a[208:211], a[60:63], v[238:241]
    v_mfma_f32_16x16x32_bf16 v[182:185], a[192:195], a[32:35], v[182:185]
    v_mfma_f32_16x16x32_bf16 v[182:185], a[212:215], a[48:51], v[182:185]
    buffer_load_dwordx4 a[28:31], v7, s[8:11], s44 offen sc1
    v_mfma_f32_16x16x32_bf16 v[202:205], a[192:195], a[36:39], v[202:205]
    v_mfma_f32_16x16x32_bf16 v[202:205], a[212:215], a[52:55], v[202:205]
    v_mfma_f32_16x16x32_bf16 v[222:225], a[192:195], a[40:43], v[222:225]
    v_mfma_f32_16x16x32_bf16 v[222:225], a[212:215], a[56:59], v[222:225]
    v_mfma_f32_16x16x32_bf16 v[242:245], a[192:195], a[44:47], v[242:245]
    s_cmp_eq_u32 s101, 0
    s_cbranch_scc1 L_no_y
    s_waitcnt vmcnt(16)
    v_min3_u32 v150, v150, v151, v152
    v_min3_u32 v150, v150, v153, v154
    v_min3_u32 v150, v150, v155, v156
    v_min3_u32 v150, v150, v157, v158
    v_min3_u32 v150, v150, v159, v160
    v_min3_u32 v150, v150, v161, v162
    v_min3_u32 v150, v150, v163, v164
    v_min_u32 v150, v150, v165
    v_cmp_gt_u32 vcc, 1, v150
    s_and_b64 vcc, vcc, exec
    s_cbranch_scc1 L_spin_ffn
L_back_ffn:
    s_ff1_i32_b32 s40, s101
    v_readlane_b32 s43, v3, s40
    s_mul_i32 s42, s40, 2560
    buffer_load_dwordx4 v[86:89], v11, s[16:19], s42 offen sc1
    s_add_u32 s42, s42, 20480
    buffer_load_dwordx4 v[90:93], v11, s[16:19], s42 offen sc1
    s_add_u32 s42, s42, 20480
    buffer_load_dwordx4 v[94:97], v11, s[16:19], s42 offen sc1
    s_add_u32 s42, s42, 20480
    buffer_load_dwordx4 v[98:101], v11, s[16:19], s42 offen sc1
    s_add_u32 s42, s42, 20480
    buffer_load_dwordx4 v[102:105], v11, s[16:19], s42 offen sc1
    s_add_u32 s42, s42, 20480
    buffer_load_dwordx4 v[106:109], v11, s[16:19], s42 offen sc1
    s_add_u32 s42, s42, 20480
    buffer_load_dwordx4 v[110:113], v11, s[16:19], s42 offen sc1
    s_add_u32 s42, s42, 20480
    buffer_load_dwordx4 v[114:117], v11, s[16:19], s42 offen sc1
    s_add_u32 s42, s42, 20480
    buffer_load_dwordx4 v[118:121], v11, s[16:19], s42 offen sc1
    s_add_u32 s42, s42, 20480
    buffer_load_dwordx4 v[122:125], v11, s[16:19], s42 offen sc1
    s_add_u32 s42, s42, 20480
    buffer_load_dwordx4 v[126:129], v11, s[16:19], s42 offen sc1
    s_add_u32 s42, s42, 20480
    buffer_load_dwordx4 v[130:133], v11, s[16:19], s42 offen sc1
    s_add_u32 s42, s42, 20480
    buffer_load_dwordx4 v[134:137], v11, s[16:19], s42 offen sc1
    s_add_u32 s42, s42, 20480
    buffer_load_dwordx4 v[138:141], v11, s[16:19], s42 offen sc1
    s_add_u32 s42, s42, 20480
    buffer_load_dwordx4 v[142:145], v11, s[16:19], s42 offen sc1
    s_add_u32 s42, s42, 20480
    buffer_load_dwordx4 v[146:149], v11, s[16:19], s42 offen sc1
    s_add_u32 s42, s42, 20480
    buffer_load_dwordx4 v[150:153], v11, s[16:19], s42 offen sc1
    s_add_u32 s42, s42, 20480
    buffer_load_dwordx4 v[154:157], v11, s[16:19], s42 offen sc1
    s_add_u32 s42, s42, 20480
    s_not_b32 s43, s43
    s_and_b32 s43, s43, 0x7ff
    s_lshl_b32 s42, s43, 3
    s_add_u32 s42, s42, 0x280000
    buffer_load_dwordx2 v[160:161], off, s[76:79], s42 sc1
    s_mul_i32 s43, s43, 1280
    s_mul_i32 s42, s100, 160
    s_add_u32 s42, s42, s43
    v_subrev_u32 v14, 81920, v13
    v_lshrrev_b32 v14, 1, v14
    buffer_load_dwordx2 v[158:159], v14, s[88:91], s42 offen
    s_mov_b32 s41, s101
    s_bitset0_b32 s41, s40
    s_cmp_eq_u32 s41, 0
    s_cbranch_scc1 L_no_y
    s_ff1_i32_b32 s40, s41
    v_readlane_b32 s43, v3, s40
    s_mul_i32 s42, s40, 2560
    buffer_load_dwordx4 a[96:99], v11, s[16:19], s42 offen sc1
    s_add_u32 s42, s42, 20480
    buffer_load_dwordx4 a[100:103], v11, s[16:19], s42 offen sc1
    s_add_u32 s42, s42, 20480
    buffer_load_dwordx4 a[104:107], v11, s[16:19], s42 offen sc1
    s_add_u32 s42, s42, 20480
    buffer_load_dwordx4 a[108:111], v11, s[16:19], s42 offen sc1
    s_add_u32 s42, s42, 20480
    buffer_load_dwordx4 a[112:115], v11, s[16:19], s42 offen sc1
    s_add_u32 s42, s42, 20480
    buffer_load_dwordx4 a[116:119], v11, s[16:19], s42 offen sc1
    s_add_u32 s42, s42, 20480
    buffer_load_dwordx4 a[120:123], v11, s[16:19], s42 offen sc1
    s_add_u32 s42, s42, 20480
    buffer_load_dwordx4 a[124:127], v11, s[16:19], s42 offen sc1
    s_add_u32 s42, s42, 20480
    buffer_load_dwordx4 a[128:131], v11, s[16:19], s42 offen sc1
    s_add_u32 s42, s42, 20480
    buffer_load_dwordx4 a[132:135], v11, s[16:19], s42 offen sc1
    s_add_u32 s42, s42, 20480
    buffer_load_dwordx4 a[136:139], v11, s[16:19], s42 offen sc1
    s_add_u32 s42, s42, 20480
    buffer_load_dwordx4 a[140:143], v11, s[16:19], s42 offen sc1
    s_add_u32 s42, s42, 20480
    buffer_load_dwordx4 a[144:147], v11, s[16:19], s42 offen sc1
    s_add_u32 s42, s42, 20480
    buffer_load_dwordx4 a[148:151], v11, s[16:19], s42 offen sc1
    s_add_u32 s42, s42, 20480
    buffer_load_dwordx4 a[152:155], v11, s[16:19], s42 offen sc1
    s_add_u32 s42, s42, 20480
    buffer_load_dwordx4 a[156:159], v11, s[16:19], s42 offen sc1
    s_add_u32 s42, s42, 20480
    buffer_load_dwordx4 a[160:163], v11, s[16:19], s42 offen sc1
    s_add_u32 s42, s42, 20480
    buffer_load_dwordx4 a[164:167], v11, s[16:19], s42 offen sc1
    s_add_u32 s42, s42, 20480
    s_not_b32 s43, s43
    s_and_b32 s43, s43, 0x7ff
    s_lshl_b32 s42, s43, 3
    s_add_u32 s42, s42, 0x280000
    buffer_load_dwordx2 a[170:171], off, s[76:79], s42 sc1
    s_mul_i32 s43, s43, 1280
    s_mul_i32 s42, s100, 160
    s_add_u32 s42, s42, s43
    v_subrev_u32 v14, 81920, v13
    v_lshrrev_b32 v14, 1, v14
    buffer_load_dwordx2 a[168:169], v14, s[88:91], s42 offen
L_no_y:
    v_mfma_f32_16x16x32_bf16 v[242:245], a[212:215], a[60:63], v[242:245]
    s_waitcnt vmcnt(8)
    v_mfma_f32_16x16x32_bf16 v[166:169], a[216:219], a[64:67], v[166:169]
    v_mfma_f32_16x16x32_bf16 v[166:169], a[236:239], a[80:83], v[166:169]
    v_mfma_f32_16x16x32_bf16 v[186:189], a[216:219], a[68:71], v[186:189]
    v_mfma_f32_16x16x32_bf16 v[186:189], a[236:239], a[84:87], v[186:189]
    v_mfma_f32_16x16x32_bf16 v[206:209], a[216:219], a[72:75], v[206:209]
    v_mfma_f32_16x16x32_bf16 v[206:209], a[236:239], a[88:91], v[206:209]
    v_mfma_f32_16x16x32_bf16 v[226:229], a[216:219], a[76:79], v[226:229]
    v_mfma_f32_16x16x32_bf16 v[226:229], a[236:239], a[92:95], v[226:229]
    v_mfma_f32_16x16x32_bf16 v[170:173], a[220:223], a[64:67], v[170:173]
    v_mfma_f32_16x16x32_bf16 v[170:173], a[240:243], a[80:83], v[170:173]
    v_mfma_f32_16x16x32_bf16 v[190:193], a[220:223], a[68:71], v[190:193]
    v_mfma_f32_16x16x32_bf16 v[190:193], a[240:243], a[84:87], v[190:193]
    v_mfma_f32_16x16x32_bf16 v[210:213], a[220:223], a[72:75], v[210:213]
    v_mfma_f32_16x16x32_bf16 v[210:213], a[240:243], a[88:91], v[210:213]
    v_mfma_f32_16x16x32_bf16 v[230:233], a[220:223], a[76:79], v[230:233]
    v_mfma_f32_16x16x32_bf16 v[230:233], a[240:243], a[92:95], v[230:233]
    v_mfma_f32_16x16x32_bf16 v[174:177], a[224:227], a[64:67], v[174:177]
    v_mfma_f32_16x16x32_bf16 v[174:177], a[244:247], a[80:83], v[174:177]
    v_mfma_f32_16x16x32_bf16 v[194:197], a[224:227], a[68:71], v[194:197]
    v_mfma_f32_16x16x32_bf16 v[194:197], a[244:247], a[84:87], v[194:197]
    v_mfma_f32_16x16x32_bf16 v[214:217], a[224:227], a[72:75], v[214:217]
    v_mfma_f32_16x16x32_bf16 v[214:217], a[244:247], a[88:91], v[214:217]
    v_mfma_f32_16x16x32_bf16 v[234:237], a[224:227], a[76:79], v[234:237]
    v_mfma_f32_16x16x32_bf16 v[234:237], a[244:247], a[92:95], v[234:237]
    v_mfma_f32_16x16x32_bf16 v[178:181], a[228:231], a[64:67], v[178:181]
    v_mfma_f32_16x16x32_bf16 v[178:181], a[248:251], a[80:83], v[178:181]
    v_mfma_f32_16x16x32_bf16 v[198:201], a[228:231], a[68:71], v[198:201]
    v_mfma_f32_16x16x32_bf16 v[198:201], a[248:251], a[84:87], v[198:201]
    v_mfma_f32_16x16x32_bf16 v[218:221], a[228:231], a[72:75], v[218:221]
    v_mfma_f32_16x16x32_bf16 v[218:221], a[248:251], a[88:91], v[218:221]
    v_mfma_f32_16x16x32_bf16 v[238:241], a[228:231], a[76:79], v[238:241]
    v_mfma_f32_16x16x32_bf16 v[238:241], a[248:251], a[92:95], v[238:241]
    v_mfma_f32_16x16x32_bf16 v[182:185], a[232:235], a[64:67], v[182:185]
    v_mfma_f32_16x16x32_bf16 v[182:185], a[252:255], a[80:83], v[182:185]
    v_mfma_f32_16x16x32_bf16 v[202:205], a[232:235], a[68:71], v[202:205]
    v_mfma_f32_16x16x32_bf16 v[202:205], a[252:255], a[84:87], v[202:205]
    v_mfma_f32_16x16x32_bf16 v[222:225], a[232:235], a[72:75], v[222:225]
    v_mfma_f32_16x16x32_bf16 v[222:225], a[252:255], a[88:91], v[222:225]
    v_mfma_f32_16x16x32_bf16 v[242:245], a[232:235], a[76:79], v[242:245]
    s_sub_u32 s40, s5, 1
    s_and_b32 s40, s40, 3
    s_mul_i32 s40, s40, 10240
    v_lshl_add_u32 v5, v19, 4, s40
    s_sub_u32 s40, s5, 2
    s_and_b32 s40, s40, 3
    s_mul_i32 s40, s40, 10240
    v_lshl_add_u32 v6, v19, 4, s40
    s_sub_u32 s40, s5, 3
    s_and_b32 s40, s40, 3
    s_mul_i32 s40, s40, 10240
    v_lshl_add_u32 v7, v19, 4, s40
    v_mfma_f32_16x16x32_bf16 v[242:245], a[252:255], a[92:95], v[242:245]
    s_waitcnt vmcnt(0)
    v_mfma_f32_16x16x32_bf16 v[166:169], v[46:49], a[0:3], v[166:169]
    v_mfma_f32_16x16x32_bf16 v[166:169], v[66:69], a[16:19], v[166:169]
    v_mfma_f32_16x16x32_bf16 v[186:189], v[46:49], a[4:7], v[186:189]
    v_mfma_f32_16x16x32_bf16 v[186:189], v[66:69], a[20:23], v[186:189]
    v_mfma_f32_16x16x32_bf16 v[206:209], v[46:49], a[8:11], v[206:209]
    v_mfma_f32_16x16x32_bf16 v[206:209], v[66:69], a[24:27], v[206:209]
    v_mfma_f32_16x16x32_bf16 v[226:229], v[46:49], a[12:15], v[226:229]
    v_mfma_f32_16x16x32_bf16 v[226:229], v[66:69], a[28:31], v[226:229]
    v_mfma_f32_16x16x32_bf16 v[170:173], v[50:53], a[0:3], v[170:173]
    v_mfma_f32_16x16x32_bf16 v[170:173], v[70:73], a[16:19], v[170:173]
    v_mfma_f32_16x16x32_bf16 v[190:193], v[50:53], a[4:7], v[190:193]
    v_mfma_f32_16x16x32_bf16 v[190:193], v[70:73], a[20:23], v[190:193]
    v_mfma_f32_16x16x32_bf16 v[210:213], v[50:53], a[8:11], v[210:213]
    v_mfma_f32_16x16x32_bf16 v[210:213], v[70:73], a[24:27], v[210:213]
    v_mfma_f32_16x16x32_bf16 v[230:233], v[50:53], a[12:15], v[230:233]
    v_mfma_f32_16x16x32_bf16 v[230:233], v[70:73], a[28:31], v[230:233]
    v_mfma_f32_16x16x32_bf16 v[174:177], v[54:57], a[0:3], v[174:177]
    v_mfma_f32_16x16x32_bf16 v[174:177], v[74:77], a[16:19], v[174:177]
    v_mfma_f32_16x16x32_bf16 v[194:197], v[54:57], a[4:7], v[194:197]
    v_mfma_f32_16x16x32_bf16 v[194:197], v[74:77], a[20:23], v[194:197]
    v_mfma_f32_16x16x32_bf16 v[214:217], v[54:57], a[8:11], v[214:217]
    v_mfma_f32_16x16x32_bf16 v[214:217], v[74:77], a[24:27], v[214:217]
    v_mfma_f32_16x16x32_bf16 v[234:237], v[54:57], a[12:15], v[234:237]
    v_mfma_f32_16x16x32_bf16 v[234:237], v[74:77], a[28:31], v[234:237]
    v_mfma_f32_16x16x32_bf16 v[178:181], v[58:61], a[0:3], v[178:181]
    v_mfma_f32_16x16x32_bf16 v[178:181], v[78:81], a[16:19], v[178:181]
    v_mfma_f32_16x16x32_bf16 v[198:201], v[58:61], a[4:7], v[198:201]
    v_mfma_f32_16x16x32_bf16 v[198:201], v[78:81], a[20:23], v[198:201]
    v_mfma_f32_16x16x32_bf16 v[218:221], v[58:61], a[8:11], v[218:221]
    v_mfma_f32_16x16x32_bf16 v[218:221], v[78:81], a[24:27], v[218:221]
    v_mfma_f32_16x16x32_bf16 v[238:241], v[58:61], a[12:15], v[238:241]
    v_mfma_f32_16x16x32_bf16 v[238:241], v[78:81], a[28:31], v[238:241]
    v_mfma_f32_16x16x32_bf16 v[182:185], v[62:65], a[0:3], v[182:185]
    v_mfma_f32_16x16x32_bf16 v[182:185], v[82:85], a[16:19], v[182:185]
    v_mfma_f32_16x16x32_bf16 v[202:205], v[62:65], a[4:7], v[202:205]
    v_mfma_f32_16x16x32_bf16 v[202:205], v[82:85], a[20:23], v[202:205]
    v_mfma_f32_16x16x32_bf16 v[222:225], v[62:65], a[8:11], v[222:225]
    v_mfma_f32_16x16x32_bf16 v[222:225], v[82:85], a[24:27], v[222:225]
    v_mfma_f32_16x16x32_bf16 v[242:245], v[62:65], a[12:15], v[242:245]
    v_mfma_f32_16x16x32_bf16 v[242:245], v[82:85], a[28:31], v[242:245]
    s_nop 3
    ds_write_b128 v9, v[186:189] offset:0
    ds_write_b128 v9, v[190:193] offset:1024
    ds_write_b128 v9, v[194:197] offset:2048
    ds_write_b128 v9, v[198:201] offset:3072
    ds_write_b128 v9, v[202:205] offset:4096
    ds_write_b128 v9, v[206:209] offset:5120
    ds_write_b128 v9, v[210:213] offset:6144
    ds_write_b128 v9, v[214:217] offset:7168
    ds_write_b128 v9, v[218:221] offset:8192
    ds_write_b128 v9, v[222:225] offset:9216
    ds_write_b128 v9, v[226:229] offset:40960
    ds_write_b128 v9, v[230:233] offset:41984
    ds_write_b128 v9, v[234:237] offset:43008
    ds_write_b128 v9, v[238:241] offset:44032
    ds_write_b128 v9, v[242:245] offset:45056
    s_waitcnt lgkmcnt(0)
    s_barrier
    s_cmp_eq_u32 s101, 0
    s_cbranch_scc1 L_routed_done
    s_mov_b32 s44, 0
    s_mul_i32 s40, s5, 192
    s_add_u32 s40, s40, 86400
    v_subrev_u32 v47, 81920, v13
    v_lshrrev_b32 v47, 1, v47
    v_add_u32 v47, s40, v47
    v_lshrrev_b32 v48, 4, v19
    v_lshl_add_u32 v48, v48, 3, s40
L_routed:
    s_ff1_i32_b32 s45, s101
    s_bitset0_b32 s101, s45
    s_cmp_eq_u32 s44, 0
    s_cbranch_scc1 L_routed_sum
    s_cmp_eq_u32 s44, 1
    s_cbranch_scc1 L_routed_second
    v_readlane_b32 s43, v3, s45
    s_mul_i32 s42, s45, 2560
    buffer_load_dwordx4 v[86:89], v11, s[16:19], s42 offen sc1
    s_add_u32 s42, s42, 20480
    buffer_load_dwordx4 v[90:93], v11, s[16:19], s42 offen sc1
    s_add_u32 s42, s42, 20480
    buffer_load_dwordx4 v[94:97], v11, s[16:19], s42 offen sc1
    s_add_u32 s42, s42, 20480
    buffer_load_dwordx4 v[98:101], v11, s[16:19], s42 offen sc1
    s_add_u32 s42, s42, 20480
    buffer_load_dwordx4 v[102:105], v11, s[16:19], s42 offen sc1
    s_add_u32 s42, s42, 20480
    buffer_load_dwordx4 v[106:109], v11, s[16:19], s42 offen sc1
    s_add_u32 s42, s42, 20480
    buffer_load_dwordx4 v[110:113], v11, s[16:19], s42 offen sc1
    s_add_u32 s42, s42, 20480
    buffer_load_dwordx4 v[114:117], v11, s[16:19], s42 offen sc1
    s_add_u32 s42, s42, 20480
    buffer_load_dwordx4 v[118:121], v11, s[16:19], s42 offen sc1
    s_add_u32 s42, s42, 20480
    buffer_load_dwordx4 v[122:125], v11, s[16:19], s42 offen sc1
    s_add_u32 s42, s42, 20480
    buffer_load_dwordx4 v[126:129], v11, s[16:19], s42 offen sc1
    s_add_u32 s42, s42, 20480
    buffer_load_dwordx4 v[130:133], v11, s[16:19], s42 offen sc1
    s_add_u32 s42, s42, 20480
    buffer_load_dwordx4 v[134:137], v11, s[16:19], s42 offen sc1
    s_add_u32 s42, s42, 20480
    buffer_load_dwordx4 v[138:141], v11, s[16:19], s42 offen sc1
    s_add_u32 s42, s42, 20480
    buffer_load_dwordx4 v[142:145], v11, s[16:19], s42 offen sc1
    s_add_u32 s42, s42, 20480
    buffer_load_dwordx4 v[146:149], v11, s[16:19], s42 offen sc1
    s_add_u32 s42, s42, 20480
    buffer_load_dwordx4 v[150:153], v11, s[16:19], s42 offen sc1
    s_add_u32 s42, s42, 20480
    buffer_load_dwordx4 v[154:157], v11, s[16:19], s42 offen sc1
    s_add_u32 s42, s42, 20480
    s_not_b32 s43, s43
    s_and_b32 s43, s43, 0x7ff
    s_lshl_b32 s42, s43, 3
    s_add_u32 s42, s42, 0x280000
    buffer_load_dwordx2 v[160:161], off, s[76:79], s42 sc1
    s_mul_i32 s43, s43, 1280
    s_mul_i32 s42, s100, 160
    s_add_u32 s42, s42, s43
    v_subrev_u32 v14, 81920, v13
    v_lshrrev_b32 v14, 1, v14
    buffer_load_dwordx2 v[158:159], v14, s[88:91], s42 offen
    s_waitcnt vmcnt(0)
    s_branch L_routed_sum
L_routed_second:
    v_accvgpr_read_b32 v86, a96
    v_accvgpr_read_b32 v87, a97
    v_accvgpr_read_b32 v88, a98
    v_accvgpr_read_b32 v89, a99
    v_accvgpr_read_b32 v90, a100
    v_accvgpr_read_b32 v91, a101
    v_accvgpr_read_b32 v92, a102
    v_accvgpr_read_b32 v93, a103
    v_accvgpr_read_b32 v94, a104
    v_accvgpr_read_b32 v95, a105
    v_accvgpr_read_b32 v96, a106
    v_accvgpr_read_b32 v97, a107
    v_accvgpr_read_b32 v98, a108
    v_accvgpr_read_b32 v99, a109
    v_accvgpr_read_b32 v100, a110
    v_accvgpr_read_b32 v101, a111
    v_accvgpr_read_b32 v102, a112
    v_accvgpr_read_b32 v103, a113
    v_accvgpr_read_b32 v104, a114
    v_accvgpr_read_b32 v105, a115
    v_accvgpr_read_b32 v106, a116
    v_accvgpr_read_b32 v107, a117
    v_accvgpr_read_b32 v108, a118
    v_accvgpr_read_b32 v109, a119
    v_accvgpr_read_b32 v110, a120
    v_accvgpr_read_b32 v111, a121
    v_accvgpr_read_b32 v112, a122
    v_accvgpr_read_b32 v113, a123
    v_accvgpr_read_b32 v114, a124
    v_accvgpr_read_b32 v115, a125
    v_accvgpr_read_b32 v116, a126
    v_accvgpr_read_b32 v117, a127
    v_accvgpr_read_b32 v118, a128
    v_accvgpr_read_b32 v119, a129
    v_accvgpr_read_b32 v120, a130
    v_accvgpr_read_b32 v121, a131
    v_accvgpr_read_b32 v122, a132
    v_accvgpr_read_b32 v123, a133
    v_accvgpr_read_b32 v124, a134
    v_accvgpr_read_b32 v125, a135
    v_accvgpr_read_b32 v126, a136
    v_accvgpr_read_b32 v127, a137
    v_accvgpr_read_b32 v128, a138
    v_accvgpr_read_b32 v129, a139
    v_accvgpr_read_b32 v130, a140
    v_accvgpr_read_b32 v131, a141
    v_accvgpr_read_b32 v132, a142
    v_accvgpr_read_b32 v133, a143
    v_accvgpr_read_b32 v134, a144
    v_accvgpr_read_b32 v135, a145
    v_accvgpr_read_b32 v136, a146
    v_accvgpr_read_b32 v137, a147
    v_accvgpr_read_b32 v138, a148
    v_accvgpr_read_b32 v139, a149
    v_accvgpr_read_b32 v140, a150
    v_accvgpr_read_b32 v141, a151
    v_accvgpr_read_b32 v142, a152
    v_accvgpr_read_b32 v143, a153
    v_accvgpr_read_b32 v144, a154
    v_accvgpr_read_b32 v145, a155
    v_accvgpr_read_b32 v146, a156
    v_accvgpr_read_b32 v147, a157
    v_accvgpr_read_b32 v148, a158
    v_accvgpr_read_b32 v149, a159
    v_accvgpr_read_b32 v150, a160
    v_accvgpr_read_b32 v151, a161
    v_accvgpr_read_b32 v152, a162
    v_accvgpr_read_b32 v153, a163
    v_accvgpr_read_b32 v154, a164
    v_accvgpr_read_b32 v155, a165
    v_accvgpr_read_b32 v156, a166
    v_accvgpr_read_b32 v157, a167
    v_accvgpr_read_b32 v158, a168
    v_accvgpr_read_b32 v159, a169
    v_accvgpr_read_b32 v160, a170
    v_accvgpr_read_b32 v161, a171
L_routed_sum:
    v_readlane_b32 s42, v3, s45
    v_add_f32 v186, v86, v90
    v_add_f32 v187, v87, v91
    v_add_f32 v188, v88, v92
    v_add_f32 v189, v89, v93
    v_add_f32 v186, v186, v94
    v_add_f32 v187, v187, v95
    v_add_f32 v188, v188, v96
    v_add_f32 v189, v189, v97
    v_add_f32 v186, v186, v98
    v_add_f32 v187, v187, v99
    v_add_f32 v188, v188, v100
    v_add_f32 v189, v189, v101
    v_add_f32 v186, v186, v102
    v_add_f32 v187, v187, v103
    v_add_f32 v188, v188, v104
    v_add_f32 v189, v189, v105
    v_add_f32 v186, v186, v106
    v_add_f32 v187, v187, v107
    v_add_f32 v188, v188, v108
    v_add_f32 v189, v189, v109
    v_add_f32 v186, v186, v110
    v_add_f32 v187, v187, v111
    v_add_f32 v188, v188, v112
    v_add_f32 v189, v189, v113
    v_add_f32 v186, v186, v114
    v_add_f32 v187, v187, v115
    v_add_f32 v188, v188, v116
    v_add_f32 v189, v189, v117
    v_add_f32 v186, v186, v118
    v_add_f32 v187, v187, v119
    v_add_f32 v188, v188, v120
    v_add_f32 v189, v189, v121
    v_add_f32 v186, v186, v122
    v_add_f32 v187, v187, v123
    v_add_f32 v188, v188, v124
    v_add_f32 v189, v189, v125
    v_add_f32 v186, v186, v126
    v_add_f32 v187, v187, v127
    v_add_f32 v188, v188, v128
    v_add_f32 v189, v189, v129
    v_add_f32 v186, v186, v130
    v_add_f32 v187, v187, v131
    v_add_f32 v188, v188, v132
    v_add_f32 v189, v189, v133
    v_add_f32 v186, v186, v134
    v_add_f32 v187, v187, v135
    v_add_f32 v188, v188, v136
    v_add_f32 v189, v189, v137
    v_add_f32 v186, v186, v138
    v_add_f32 v187, v187, v139
    v_add_f32 v188, v188, v140
    v_add_f32 v189, v189, v141
    v_add_f32 v186, v186, v142
    v_add_f32 v187, v187, v143
    v_add_f32 v188, v188, v144
    v_add_f32 v189, v189, v145
    v_add_f32 v186, v186, v146
    v_add_f32 v187, v187, v147
    v_add_f32 v188, v188, v148
    v_add_f32 v189, v189, v149
    v_add_f32 v186, v186, v150
    v_add_f32 v187, v187, v151
    v_add_f32 v188, v188, v152
    v_add_f32 v189, v189, v153
    v_add_f32 v186, v186, v154
    v_add_f32 v187, v187, v155
    v_add_f32 v188, v188, v156
    v_add_f32 v189, v189, v157
    ds_write_b128 v12, v[186:189]
    s_and_b32 s40, s42, 0xffff0000
    s_ashr_i32 s41, s40, 31
    s_andn2_b32 s41, 0x7fff0000, s41
    s_or_b32 s41, s41, 0x80000000
    s_xor_b32 s40, s40, s41
    s_not_b32 s42, s42
    s_and_b32 s42, s42, 0x7ff
    v_mov_b32 v46, 0xbfb8aa3b
    v_mul_f32 v46, s40, v46
    v_exp_f32 v46, v46
    v_lshlrev_b32 v86, 16, v158
    v_and_b32 v87, 0xffff0000, v158
    v_lshlrev_b32 v88, 16, v159
    v_and_b32 v89, 0xffff0000, v159
    v_add_f32 v46, 1.0, v46
    v_rcp_f32 v46, v46
    s_waitcnt lgkmcnt(0)
    s_barrier
    ds_read_b128 v[190:193], v13 offset:0
    ds_read_b128 v[194:197], v13 offset:320
    ds_read_b128 v[198:201], v13 offset:640
    ds_read_b128 v[202:205], v13 offset:960
    ds_read_b128 v[206:209], v13 offset:1280
    ds_read_b128 v[210:213], v13 offset:1600
    ds_read_b128 v[214:217], v13 offset:1920
    ds_read_b128 v[218:221], v13 offset:2240
    ds_read_b128 v[222:225], v13 offset:2560
    ds_read_b128 v[226:229], v13 offset:2880
    ds_read_b128 v[230:233], v13 offset:3200
    ds_read_b128 v[234:237], v13 offset:3520
    v_cvt_pk_bf16_f32 v46, v46, v46
    v_lshlrev_b32 v46, 16, v46
    v_sub_f32 v86, v86, v160
    v_sub_f32 v87, v87, v160
    v_sub_f32 v88, v88, v160
    v_sub_f32 v89, v89, v160
    v_cvt_pk_bf16_f32 v90, v86, v87
    v_cvt_pk_bf16_f32 v91, v88, v89
    v_lshlrev_b32 v86, 16, v90
    v_and_b32 v87, 0xffff0000, v90
    v_lshlrev_b32 v88, 16, v91
    v_and_b32 v89, 0xffff0000, v91
    v_mul_f32 v86, v86, v161
    v_mul_f32 v87, v87, v161
    v_mul_f32 v88, v88, v161
    v_mul_f32 v89, v89, v161
    v_cvt_pk_bf16_f32 v90, v86, v87
    v_cvt_pk_bf16_f32 v91, v88, v89
    v_lshlrev_b32 v86, 16, v90
    v_and_b32 v87, 0xffff0000, v90
    v_lshlrev_b32 v88, 16, v91
    v_and_b32 v89, 0xffff0000, v91
    s_waitcnt lgkmcnt(8)
    v_add_f32 v190, v190, v194
    v_add_f32 v191, v191, v195
    v_add_f32 v192, v192, v196
    v_add_f32 v193, v193, v197
    v_add_f32 v190, v190, v198
    v_add_f32 v191, v191, v199
    v_add_f32 v192, v192, v200
    v_add_f32 v193, v193, v201
    v_add_f32 v190, v190, v202
    v_add_f32 v191, v191, v203
    v_add_f32 v192, v192, v204
    v_add_f32 v193, v193, v205
    s_waitcnt lgkmcnt(4)
    v_add_f32 v190, v190, v206
    v_add_f32 v191, v191, v207
    v_add_f32 v192, v192, v208
    v_add_f32 v193, v193, v209
    v_add_f32 v190, v190, v210
    v_add_f32 v191, v191, v211
    v_add_f32 v192, v192, v212
    v_add_f32 v193, v193, v213
    v_add_f32 v190, v190, v214
    v_add_f32 v191, v191, v215
    v_add_f32 v192, v192, v216
    v_add_f32 v193, v193, v217
    v_add_f32 v190, v190, v218
    v_add_f32 v191, v191, v219
    v_add_f32 v192, v192, v220
    v_add_f32 v193, v193, v221
    s_waitcnt lgkmcnt(0)
    v_add_f32 v190, v190, v222
    v_add_f32 v191, v191, v223
    v_add_f32 v192, v192, v224
    v_add_f32 v193, v193, v225
    v_add_f32 v190, v190, v226
    v_add_f32 v191, v191, v227
    v_add_f32 v192, v192, v228
    v_add_f32 v193, v193, v229
    v_add_f32 v190, v190, v230
    v_add_f32 v191, v191, v231
    v_add_f32 v192, v192, v232
    v_add_f32 v193, v193, v233
    v_add_f32 v190, v190, v234
    v_add_f32 v191, v191, v235
    v_add_f32 v192, v192, v236
    v_add_f32 v193, v193, v237
    s_barrier
    v_cvt_pk_bf16_f32 v90, v190, v191
    v_cvt_pk_bf16_f32 v91, v192, v193
    v_lshlrev_b32 v190, 16, v90
    v_and_b32 v191, 0xffff0000, v90
    v_lshlrev_b32 v192, 16, v91
    v_and_b32 v193, 0xffff0000, v91
    v_mul_f32 v190, v190, v46
    v_mul_f32 v191, v191, v46
    v_mul_f32 v192, v192, v46
    v_mul_f32 v193, v193, v46
    v_cvt_pk_bf16_f32 v90, v190, v191
    v_cvt_pk_bf16_f32 v91, v192, v193
    v_lshlrev_b32 v190, 16, v90
    v_and_b32 v191, 0xffff0000, v90
    v_lshlrev_b32 v192, 16, v91
    v_and_b32 v193, 0xffff0000, v91
    v_add_f32 v190, v190, v86
    v_add_f32 v191, v191, v87
    v_add_f32 v192, v192, v88
    v_add_f32 v193, v193, v89
    v_cvt_pk_bf16_f32 v90, v190, v191
    v_cvt_pk_bf16_f32 v91, v192, v193
    v_lshlrev_b32 v190, 16, v90
    v_and_b32 v191, 0xffff0000, v90
    v_lshlrev_b32 v192, 16, v91
    v_and_b32 v193, 0xffff0000, v91
    v_mul_f32 v90, 0xbfb8aa3b, v190
    v_mul_f32 v91, 0xbfb8aa3b, v191
    v_mul_f32 v92, 0xbfb8aa3b, v192
    v_mul_f32 v93, 0xbfb8aa3b, v193
    v_exp_f32 v90, v90
    v_exp_f32 v91, v91
    v_exp_f32 v92, v92
    v_exp_f32 v93, v93
    v_add_f32 v90, 1.0, v90
    v_add_f32 v91, 1.0, v91
    v_add_f32 v92, 1.0, v92
    v_add_f32 v93, 1.0, v93
    v_rcp_f32 v90, v90
    v_rcp_f32 v91, v91
    v_rcp_f32 v92, v92
    v_rcp_f32 v93, v93
    v_mul_f32 v190, v190, v90
    v_mul_f32 v191, v191, v91
    v_mul_f32 v192, v192, v92
    v_mul_f32 v193, v193, v93
    v_cvt_pk_bf16_f32 v186, v190, v191
    v_cvt_pk_bf16_f32 v187, v192, v193
    ds_write_b64 v47, v[186:187]
    v_cmp_eq_u32 vcc, s42, v35
    s_waitcnt lgkmcnt(0)
    ds_read_b64 v[190:191], v48 offset:0
    ds_read_b64 v[192:193], v48 offset:32
    ds_read_b64 v[194:195], v48 offset:64
    ds_read_b64 v[196:197], v48 offset:96
    ds_read_b64 v[198:199], v48 offset:128
    s_add_u32 s44, s44, 1
    s_cmp_lg_u32 s101, 0
    s_waitcnt lgkmcnt(0)
    v_cndmask_b32 v36, v36, v190, vcc
    v_cndmask_b32 v37, v37, v191, vcc
    v_cndmask_b32 v38, v38, v192, vcc
    v_cndmask_b32 v39, v39, v193, vcc
    v_cndmask_b32 v40, v40, v194, vcc
    v_cndmask_b32 v41, v41, v195, vcc
    v_cndmask_b32 v42, v42, v196, vcc
    v_cndmask_b32 v43, v43, v197, vcc
    v_cndmask_b32 v44, v44, v198, vcc
    v_cndmask_b32 v45, v45, v199, vcc
    s_cbranch_scc1 L_routed
L_routed_done:
    ds_read_b128 v[186:189], v5 offset:0
    ds_read_b128 v[190:193], v5 offset:1024
    ds_read_b128 v[194:197], v5 offset:2048
    ds_read_b128 v[198:201], v5 offset:3072
    ds_read_b128 v[202:205], v5 offset:4096
    ds_read_b128 v[206:209], v6 offset:5120
    ds_read_b128 v[210:213], v6 offset:6144
    ds_read_b128 v[214:217], v6 offset:7168
    ds_read_b128 v[218:221], v6 offset:8192
    ds_read_b128 v[222:225], v6 offset:9216
    ds_read_b128 v[226:229], v7 offset:40960
    ds_read_b128 v[230:233], v7 offset:41984
    ds_read_b128 v[234:237], v7 offset:43008
    ds_read_b128 v[238:241], v7 offset:44032
    ds_read_b128 v[242:245], v7 offset:45056
    v_lshlrev_b32 v66, 16, v36
    v_and_b32 v67, 0xffff0000, v36
    v_lshlrev_b32 v86, 16, v22
    v_and_b32 v87, 0xffff0000, v22
    v_lshlrev_b32 v68, 16, v37
    v_and_b32 v69, 0xffff0000, v37
    v_lshlrev_b32 v88, 16, v23
    v_and_b32 v89, 0xffff0000, v23
    v_lshlrev_b32 v70, 16, v38
    v_and_b32 v71, 0xffff0000, v38
    v_lshlrev_b32 v90, 16, v24
    v_and_b32 v91, 0xffff0000, v24
    v_lshlrev_b32 v72, 16, v39
    v_and_b32 v73, 0xffff0000, v39
    v_lshlrev_b32 v92, 16, v25
    v_and_b32 v93, 0xffff0000, v25
    v_lshlrev_b32 v74, 16, v40
    v_and_b32 v75, 0xffff0000, v40
    v_lshlrev_b32 v94, 16, v26
    v_and_b32 v95, 0xffff0000, v26
    v_lshlrev_b32 v76, 16, v41
    v_and_b32 v77, 0xffff0000, v41
    v_lshlrev_b32 v96, 16, v27
    v_and_b32 v97, 0xffff0000, v27
    v_lshlrev_b32 v78, 16, v42
    v_and_b32 v79, 0xffff0000, v42
    v_lshlrev_b32 v98, 16, v28
    v_and_b32 v99, 0xffff0000, v28
    v_lshlrev_b32 v80, 16, v43
    v_and_b32 v81, 0xffff0000, v43
    v_lshlrev_b32 v100, 16, v29
    v_and_b32 v101, 0xffff0000, v29
    v_lshlrev_b32 v82, 16, v44
    v_and_b32 v83, 0xffff0000, v44
    v_lshlrev_b32 v102, 16, v30
    v_and_b32 v103, 0xffff0000, v30
    v_lshlrev_b32 v84, 16, v45
    v_and_b32 v85, 0xffff0000, v45
    v_lshlrev_b32 v104, 16, v31
    v_and_b32 v105, 0xffff0000, v31
    s_waitcnt lgkmcnt(10)
    v_add_f32 v166, v166, v186
    v_add_f32 v167, v167, v187
    v_add_f32 v168, v168, v188
    v_add_f32 v169, v169, v189
    v_add_f32 v170, v170, v190
    v_add_f32 v171, v171, v191
    v_add_f32 v172, v172, v192
    v_add_f32 v173, v173, v193
    v_add_f32 v174, v174, v194
    v_add_f32 v175, v175, v195
    v_add_f32 v176, v176, v196
    v_add_f32 v177, v177, v197
    v_add_f32 v178, v178, v198
    v_add_f32 v179, v179, v199
    v_add_f32 v180, v180, v200
    v_add_f32 v181, v181, v201
    v_add_f32 v182, v182, v202
    v_add_f32 v183, v183, v203
    v_add_f32 v184, v184, v204
    v_add_f32 v185, v185, v205
    s_waitcnt lgkmcnt(5)
    v_add_f32 v166, v166, v206
    v_add_f32 v167, v167, v207
    v_add_f32 v168, v168, v208
    v_add_f32 v169, v169, v209
    v_add_f32 v170, v170, v210
    v_add_f32 v171, v171, v211
    v_add_f32 v172, v172, v212
    v_add_f32 v173, v173, v213
    v_add_f32 v174, v174, v214
    v_add_f32 v175, v175, v215
    v_add_f32 v176, v176, v216
    v_add_f32 v177, v177, v217
    v_add_f32 v178, v178, v218
    v_add_f32 v179, v179, v219
    v_add_f32 v180, v180, v220
    v_add_f32 v181, v181, v221
    v_add_f32 v182, v182, v222
    v_add_f32 v183, v183, v223
    v_add_f32 v184, v184, v224
    v_add_f32 v185, v185, v225
    s_waitcnt lgkmcnt(0)
    v_add_f32 v166, v166, v226
    v_add_f32 v167, v167, v227
    v_add_f32 v168, v168, v228
    v_add_f32 v169, v169, v229
    v_add_f32 v170, v170, v230
    v_add_f32 v171, v171, v231
    v_add_f32 v172, v172, v232
    v_add_f32 v173, v173, v233
    v_add_f32 v174, v174, v234
    v_add_f32 v175, v175, v235
    v_add_f32 v176, v176, v236
    v_add_f32 v177, v177, v237
    v_add_f32 v178, v178, v238
    v_add_f32 v179, v179, v239
    v_add_f32 v180, v180, v240
    v_add_f32 v181, v181, v241
    v_add_f32 v182, v182, v242
    v_add_f32 v183, v183, v243
    v_add_f32 v184, v184, v244
    v_add_f32 v185, v185, v245
    v_cvt_pk_bf16_f32 v46, v166, v167
    v_cvt_pk_bf16_f32 v47, v168, v169
    v_cvt_pk_bf16_f32 v48, v170, v171
    v_cvt_pk_bf16_f32 v49, v172, v173
    v_cvt_pk_bf16_f32 v50, v174, v175
    v_cvt_pk_bf16_f32 v51, v176, v177
    v_cvt_pk_bf16_f32 v52, v178, v179
    v_cvt_pk_bf16_f32 v53, v180, v181
    v_cvt_pk_bf16_f32 v54, v182, v183
    v_cvt_pk_bf16_f32 v55, v184, v185
    v_lshlrev_b32 v166, 16, v46
    v_and_b32 v167, 0xffff0000, v46
    v_lshlrev_b32 v168, 16, v47
    v_and_b32 v169, 0xffff0000, v47
    v_lshlrev_b32 v170, 16, v48
    v_and_b32 v171, 0xffff0000, v48
    v_lshlrev_b32 v172, 16, v49
    v_and_b32 v173, 0xffff0000, v49
    v_lshlrev_b32 v174, 16, v50
    v_and_b32 v175, 0xffff0000, v50
    v_lshlrev_b32 v176, 16, v51
    v_and_b32 v177, 0xffff0000, v51
    v_lshlrev_b32 v178, 16, v52
    v_and_b32 v179, 0xffff0000, v52
    v_lshlrev_b32 v180, 16, v53
    v_and_b32 v181, 0xffff0000, v53
    v_lshlrev_b32 v182, 16, v54
    v_and_b32 v183, 0xffff0000, v54
    v_lshlrev_b32 v184, 16, v55
    v_and_b32 v185, 0xffff0000, v55
    v_mul_f32 v166, v166, v66
    v_mul_f32 v167, v167, v67
    v_mul_f32 v168, v168, v68
    v_mul_f32 v169, v169, v69
    v_mul_f32 v170, v170, v70
    v_mul_f32 v171, v171, v71
    v_mul_f32 v172, v172, v72
    v_mul_f32 v173, v173, v73
    v_mul_f32 v174, v174, v74
    v_mul_f32 v175, v175, v75
    v_mul_f32 v176, v176, v76
    v_mul_f32 v177, v177, v77
    v_mul_f32 v178, v178, v78
    v_mul_f32 v179, v179, v79
    v_mul_f32 v180, v180, v80
    v_mul_f32 v181, v181, v81
    v_mul_f32 v182, v182, v82
    v_mul_f32 v183, v183, v83
    v_mul_f32 v184, v184, v84
    v_mul_f32 v185, v185, v85
    v_cvt_pk_bf16_f32 v46, v166, v167
    v_cvt_pk_bf16_f32 v47, v168, v169
    v_cvt_pk_bf16_f32 v48, v170, v171
    v_cvt_pk_bf16_f32 v49, v172, v173
    v_cvt_pk_bf16_f32 v50, v174, v175
    v_cvt_pk_bf16_f32 v51, v176, v177
    v_cvt_pk_bf16_f32 v52, v178, v179
    v_cvt_pk_bf16_f32 v53, v180, v181
    v_cvt_pk_bf16_f32 v54, v182, v183
    v_cvt_pk_bf16_f32 v55, v184, v185
    v_lshlrev_b32 v166, 16, v46
    v_and_b32 v167, 0xffff0000, v46
    v_lshlrev_b32 v168, 16, v47
    v_and_b32 v169, 0xffff0000, v47
    v_lshlrev_b32 v170, 16, v48
    v_and_b32 v171, 0xffff0000, v48
    v_lshlrev_b32 v172, 16, v49
    v_and_b32 v173, 0xffff0000, v49
    v_lshlrev_b32 v174, 16, v50
    v_and_b32 v175, 0xffff0000, v50
    v_lshlrev_b32 v176, 16, v51
    v_and_b32 v177, 0xffff0000, v51
    v_lshlrev_b32 v178, 16, v52
    v_and_b32 v179, 0xffff0000, v52
    v_lshlrev_b32 v180, 16, v53
    v_and_b32 v181, 0xffff0000, v53
    v_lshlrev_b32 v182, 16, v54
    v_and_b32 v183, 0xffff0000, v54
    v_lshlrev_b32 v184, 16, v55
    v_and_b32 v185, 0xffff0000, v55
    v_add_f32 v166, v166, v86
    v_add_f32 v167, v167, v87
    v_add_f32 v168, v168, v88
    v_add_f32 v169, v169, v89
    v_add_f32 v170, v170, v90
    v_add_f32 v171, v171, v91
    v_add_f32 v172, v172, v92
    v_add_f32 v173, v173, v93
    v_add_f32 v174, v174, v94
    v_add_f32 v175, v175, v95
    v_add_f32 v176, v176, v96
    v_add_f32 v177, v177, v97
    v_add_f32 v178, v178, v98
    v_add_f32 v179, v179, v99
    v_add_f32 v180, v180, v100
    v_add_f32 v181, v181, v101
    v_add_f32 v182, v182, v102
    v_add_f32 v183, v183, v103
    v_add_f32 v184, v184, v104
    v_add_f32 v185, v185, v105
    v_cvt_pk_bf16_f32 v46, v166, v167
    v_cvt_pk_bf16_f32 v47, v168, v169
    v_cvt_pk_bf16_f32 v48, v170, v171
    v_cvt_pk_bf16_f32 v49, v172, v173
    v_cvt_pk_bf16_f32 v50, v174, v175
    v_cvt_pk_bf16_f32 v51, v176, v177
    v_cvt_pk_bf16_f32 v52, v178, v179
    v_cvt_pk_bf16_f32 v53, v180, v181
    v_cvt_pk_bf16_f32 v54, v182, v183
    v_cvt_pk_bf16_f32 v55, v184, v185
    buffer_store_dwordx2 v[46:47], v34, s[12:15], 0 offen offset:0
    buffer_store_dwordx2 v[48:49], v34, s[12:15], 0 offen offset:32
    buffer_store_dwordx2 v[50:51], v34, s[12:15], 0 offen offset:64
    buffer_store_dwordx2 v[52:53], v34, s[12:15], 0 offen offset:96
    buffer_store_dwordx2 v[54:55], v34, s[12:15], 0 offen offset:128
L_end:
    s_endpgm
L_slow:
    s_cmp_lg_u32 s86, 0
    s_cbranch_scc1 L_publish
    s_mov_b32 s86, 1
    s_lshl_b32 s40, s5, 12
    v_subrev_u32 v13, s40, v13
    v_subrev_u32 v14, s40, v14
    v_subrev_u32 v15, s40, v15
    v_subrev_u32 v16, s40, v16
    v_subrev_u32 v17, s40, v17
    v_subrev_u32 v18, s40, v18
    s_and_b32 s40, s5, 1
    s_lshr_b32 s41, s5, 1
    s_mul_i32 s41, s41, 3
    s_add_u32 s40, s40, s41
    s_add_u32 s40, s40, 1
    s_lshl_b32 s34, s40, 13
    s_sub_u32 s40, s34, 98304
    v_add_u32 v1, s40, v1
    v_add_u32 v2, s40, v2
    v_add_u32 v3, s40, v3
    v_add_u32 v4, s40, v4
    v_add_u32 v5, s34, v5
    v_add_u32 v6, s34, v6
    v_add_u32 v7, s34, v7
    v_add_u32 v8, s34, v8
    v_add_u32 v9, s34, v9
    v_add_u32 v10, s34, v10
    v_add_u32 v11, s34, v11
    v_add_u32 v12, s34, v12
    v_mov_b32 v212, 0xff800000
    v_mov_b32 v216, 0
    v_mov_b32 v213, 0xff800000
    v_mov_b32 v217, 0
    v_mov_b32 v214, 0xff800000
    v_mov_b32 v218, 0
    v_mov_b32 v215, 0xff800000
    v_mov_b32 v219, 0
    v_accvgpr_write_b32 a0, 0
    v_accvgpr_write_b32 a1, 0
    v_accvgpr_write_b32 a2, 0
    v_accvgpr_write_b32 a3, 0
    v_accvgpr_write_b32 a4, 0
    v_accvgpr_write_b32 a5, 0
    v_accvgpr_write_b32 a6, 0
    v_accvgpr_write_b32 a7, 0
    v_accvgpr_write_b32 a8, 0
    v_accvgpr_write_b32 a9, 0
    v_accvgpr_write_b32 a10, 0
    v_accvgpr_write_b32 a11, 0
    v_accvgpr_write_b32 a12, 0
    v_accvgpr_write_b32 a13, 0
    v_accvgpr_write_b32 a14, 0
    v_accvgpr_write_b32 a15, 0
    v_accvgpr_write_b32 a16, 0
    v_accvgpr_write_b32 a17, 0
    v_accvgpr_write_b32 a18, 0
    v_accvgpr_write_b32 a19, 0
    v_accvgpr_write_b32 a20, 0
    v_accvgpr_write_b32 a21, 0
    v_accvgpr_write_b32 a22, 0
    v_accvgpr_write_b32 a23, 0
    v_accvgpr_write_b32 a24, 0
    v_accvgpr_write_b32 a25, 0
    v_accvgpr_write_b32 a26, 0
    v_accvgpr_write_b32 a27, 0
    v_accvgpr_write_b32 a28, 0
    v_accvgpr_write_b32 a29, 0
    v_accvgpr_write_b32 a30, 0
    v_accvgpr_write_b32 a31, 0
    v_accvgpr_write_b32 a32, 0
    v_accvgpr_write_b32 a33, 0
    v_accvgpr_write_b32 a34, 0
    v_accvgpr_write_b32 a35, 0
    v_accvgpr_write_b32 a36, 0
    v_accvgpr_write_b32 a37, 0
    v_accvgpr_write_b32 a38, 0
    v_accvgpr_write_b32 a39, 0
    v_accvgpr_write_b32 a40, 0
    v_accvgpr_write_b32 a41, 0
    v_accvgpr_write_b32 a42, 0
    v_accvgpr_write_b32 a43, 0
    v_accvgpr_write_b32 a44, 0
    v_accvgpr_write_b32 a45, 0
    v_accvgpr_write_b32 a46, 0
    v_accvgpr_write_b32 a47, 0
    v_accvgpr_write_b32 a48, 0
    v_accvgpr_write_b32 a49, 0
    v_accvgpr_write_b32 a50, 0
    v_accvgpr_write_b32 a51, 0
    v_accvgpr_write_b32 a52, 0
    v_accvgpr_write_b32 a53, 0
    v_accvgpr_write_b32 a54, 0
    v_accvgpr_write_b32 a55, 0
    v_accvgpr_write_b32 a56, 0
    v_accvgpr_write_b32 a57, 0
    v_accvgpr_write_b32 a58, 0
    v_accvgpr_write_b32 a59, 0
    v_accvgpr_write_b32 a60, 0
    v_accvgpr_write_b32 a61, 0
    v_accvgpr_write_b32 a62, 0
    v_accvgpr_write_b32 a63, 0
    v_accvgpr_write_b32 a64, 0
    v_accvgpr_write_b32 a65, 0
    v_accvgpr_write_b32 a66, 0
    v_accvgpr_write_b32 a67, 0
    v_accvgpr_write_b32 a68, 0
    v_accvgpr_write_b32 a69, 0
    v_accvgpr_write_b32 a70, 0
    v_accvgpr_write_b32 a71, 0
    v_accvgpr_write_b32 a72, 0
    v_accvgpr_write_b32 a73, 0
    v_accvgpr_write_b32 a74, 0
    v_accvgpr_write_b32 a75, 0
    v_accvgpr_write_b32 a76, 0
    v_accvgpr_write_b32 a77, 0
    v_accvgpr_write_b32 a78, 0
    v_accvgpr_write_b32 a79, 0
    v_accvgpr_write_b32 a80, 0
    v_accvgpr_write_b32 a81, 0
    v_accvgpr_write_b32 a82, 0
    v_accvgpr_write_b32 a83, 0
    v_accvgpr_write_b32 a84, 0
    v_accvgpr_write_b32 a85, 0
    v_accvgpr_write_b32 a86, 0
    v_accvgpr_write_b32 a87, 0
    v_accvgpr_write_b32 a88, 0
    v_accvgpr_write_b32 a89, 0
    v_accvgpr_write_b32 a90, 0
    v_accvgpr_write_b32 a91, 0
    v_accvgpr_write_b32 a92, 0
    v_accvgpr_write_b32 a93, 0
    v_accvgpr_write_b32 a94, 0
    v_accvgpr_write_b32 a95, 0
    v_accvgpr_write_b32 a96, 0
    v_accvgpr_write_b32 a97, 0
    v_accvgpr_write_b32 a98, 0
    v_accvgpr_write_b32 a99, 0
    v_accvgpr_write_b32 a100, 0
    v_accvgpr_write_b32 a101, 0
    v_accvgpr_write_b32 a102, 0
    v_accvgpr_write_b32 a103, 0
    v_accvgpr_write_b32 a104, 0
    v_accvgpr_write_b32 a105, 0
    v_accvgpr_write_b32 a106, 0
    v_accvgpr_write_b32 a107, 0
    v_accvgpr_write_b32 a108, 0
    v_accvgpr_write_b32 a109, 0
    v_accvgpr_write_b32 a110, 0
    v_accvgpr_write_b32 a111, 0
    v_accvgpr_write_b32 a112, 0
    v_accvgpr_write_b32 a113, 0
    v_accvgpr_write_b32 a114, 0
    v_accvgpr_write_b32 a115, 0
    v_accvgpr_write_b32 a116, 0
    v_accvgpr_write_b32 a117, 0
    v_accvgpr_write_b32 a118, 0
    v_accvgpr_write_b32 a119, 0
    v_accvgpr_write_b32 a120, 0
    v_accvgpr_write_b32 a121, 0
    v_accvgpr_write_b32 a122, 0
    v_accvgpr_write_b32 a123, 0
    v_accvgpr_write_b32 a124, 0
    v_accvgpr_write_b32 a125, 0
    v_accvgpr_write_b32 a126, 0
    v_accvgpr_write_b32 a127, 0
    s_mov_b32 s28, 0
L_slow_loop:
    s_add_u32 m0, s34, 0
    s_add_u32 s40, s28, 0
    buffer_load_dwordx4 v13, s[8:11], s40 offen offset:0 lds
    buffer_load_dwordx4 v14, s[8:11], s40 offen offset:1024 lds
    buffer_load_dwordx4 v15, s[8:11], s40 offen offset:2048 lds
    buffer_load_dwordx4 v16, s[8:11], s40 offen offset:3072 lds
    s_add_u32 m0, s34, 4096
    s_add_u32 s40, s28, 4096
    buffer_load_dwordx4 v13, s[8:11], s40 offen offset:0 lds
    buffer_load_dwordx4 v14, s[8:11], s40 offen offset:1024 lds
    buffer_load_dwordx4 v15, s[8:11], s40 offen offset:2048 lds
    buffer_load_dwordx4 v16, s[8:11], s40 offen offset:3072 lds
    s_waitcnt vmcnt(0)
    ds_read_b128 v[148:151], v1 offset:0
    ds_read_b128 v[152:155], v2 offset:0
    ds_read_b128 v[156:159], v3 offset:0
    ds_read_b128 v[160:163], v4 offset:0
    ds_read_b128 v[164:167], v1 offset:4096
    ds_read_b128 v[168:171], v2 offset:4096
    ds_read_b128 v[172:175], v3 offset:4096
    ds_read_b128 v[176:179], v4 offset:4096
    s_waitcnt lgkmcnt(0)
    s_add_u32 m0, s34, 0
    s_add_u32 s40, s28, 0
    buffer_load_dwordx4 v17, s[12:15], s40 offen offset:0 lds
    buffer_load_dwordx4 v18, s[12:15], s40 offen offset:1024 lds
    buffer_load_dwordx4 v17, s[12:15], s40 offen offset:2048 lds
    buffer_load_dwordx4 v18, s[12:15], s40 offen offset:3072 lds
    s_add_u32 m0, s34, 4096
    s_add_u32 s40, s28, 4096
    buffer_load_dwordx4 v17, s[12:15], s40 offen offset:0 lds
    buffer_load_dwordx4 v18, s[12:15], s40 offen offset:1024 lds
    buffer_load_dwordx4 v17, s[12:15], s40 offen offset:2048 lds
    buffer_load_dwordx4 v18, s[12:15], s40 offen offset:3072 lds
    s_waitcnt vmcnt(0)
    ds_read_b64_tr_b16 v[196:197], v5 offset:0
    ds_read_b64_tr_b16 v[198:199], v5 offset:4096
    ds_read_b64_tr_b16 v[200:201], v6 offset:0
    ds_read_b64_tr_b16 v[202:203], v6 offset:4096
    ds_read_b64_tr_b16 v[204:205], v7 offset:0
    ds_read_b64_tr_b16 v[206:207], v7 offset:4096
    ds_read_b64_tr_b16 v[208:209], v8 offset:0
    ds_read_b64_tr_b16 v[210:211], v8 offset:4096
    ds_read_b64_tr_b16 v[228:229], v9 offset:0
    ds_read_b64_tr_b16 v[230:231], v9 offset:4096
    ds_read_b64_tr_b16 v[232:233], v10 offset:0
    ds_read_b64_tr_b16 v[234:235], v10 offset:4096
    ds_read_b64_tr_b16 v[236:237], v11 offset:0
    ds_read_b64_tr_b16 v[238:239], v11 offset:4096
    ds_read_b64_tr_b16 v[240:241], v12 offset:0
    ds_read_b64_tr_b16 v[242:243], v12 offset:4096
    v_mfma_f32_16x16x32_bf16 v[116:119], v[148:151], v[36:39], 0
    v_mfma_f32_16x16x32_bf16 v[116:119], v[152:155], v[40:43], v[116:119]
    v_mfma_f32_16x16x32_bf16 v[116:119], v[156:159], v[44:47], v[116:119]
    v_mfma_f32_16x16x32_bf16 v[116:119], v[160:163], v[48:51], v[116:119]
    v_mfma_f32_16x16x32_bf16 v[132:135], v[164:167], v[36:39], 0
    v_mfma_f32_16x16x32_bf16 v[132:135], v[168:171], v[40:43], v[132:135]
    v_mfma_f32_16x16x32_bf16 v[132:135], v[172:175], v[44:47], v[132:135]
    v_mfma_f32_16x16x32_bf16 v[132:135], v[176:179], v[48:51], v[132:135]
    v_mfma_f32_16x16x32_bf16 v[120:123], v[148:151], v[52:55], 0
    v_mfma_f32_16x16x32_bf16 v[120:123], v[152:155], v[56:59], v[120:123]
    v_mfma_f32_16x16x32_bf16 v[120:123], v[156:159], v[60:63], v[120:123]
    v_mfma_f32_16x16x32_bf16 v[120:123], v[160:163], v[64:67], v[120:123]
    v_mfma_f32_16x16x32_bf16 v[136:139], v[164:167], v[52:55], 0
    v_mfma_f32_16x16x32_bf16 v[136:139], v[168:171], v[56:59], v[136:139]
    v_mfma_f32_16x16x32_bf16 v[136:139], v[172:175], v[60:63], v[136:139]
    v_mfma_f32_16x16x32_bf16 v[136:139], v[176:179], v[64:67], v[136:139]
    v_mfma_f32_16x16x32_bf16 v[124:127], v[148:151], v[68:71], 0
    v_mfma_f32_16x16x32_bf16 v[124:127], v[152:155], v[72:75], v[124:127]
    v_mfma_f32_16x16x32_bf16 v[124:127], v[156:159], v[76:79], v[124:127]
    v_mfma_f32_16x16x32_bf16 v[124:127], v[160:163], v[80:83], v[124:127]
    v_mfma_f32_16x16x32_bf16 v[140:143], v[164:167], v[68:71], 0
    v_mfma_f32_16x16x32_bf16 v[140:143], v[168:171], v[72:75], v[140:143]
    v_mfma_f32_16x16x32_bf16 v[140:143], v[172:175], v[76:79], v[140:143]
    v_mfma_f32_16x16x32_bf16 v[140:143], v[176:179], v[80:83], v[140:143]
    v_mfma_f32_16x16x32_bf16 v[128:131], v[148:151], v[84:87], 0
    v_mfma_f32_16x16x32_bf16 v[128:131], v[152:155], v[88:91], v[128:131]
    v_mfma_f32_16x16x32_bf16 v[128:131], v[156:159], v[92:95], v[128:131]
    v_mfma_f32_16x16x32_bf16 v[128:131], v[160:163], v[96:99], v[128:131]
    v_mfma_f32_16x16x32_bf16 v[144:147], v[164:167], v[84:87], 0
    v_mfma_f32_16x16x32_bf16 v[144:147], v[168:171], v[88:91], v[144:147]
    v_mfma_f32_16x16x32_bf16 v[144:147], v[172:175], v[92:95], v[144:147]
    v_mfma_f32_16x16x32_bf16 v[144:147], v[176:179], v[96:99], v[144:147]
    s_waitcnt lgkmcnt(0)
    s_nop 7
    v_max3_f32 v224, v116, v117, v118
    v_max3_f32 v224, v224, v119, v132
    v_max3_f32 v224, v224, v133, v134
    v_max3_f32 v224, v224, v135, v212
    v_mov_b32 v225, v224
    s_nop 1
    v_permlane32_swap_b32 v224, v225
    v_max_f32 v224, v224, v225
    v_mov_b32 v225, v224
    s_nop 1
    v_permlane16_swap_b32 v224, v225
    v_max_f32 v224, v224, v225
    v_sub_f32 v220, v212, v224
    v_exp_f32 v220, v220
    v_mov_b32 v212, v224
    v_sub_f32 v116, v116, v224
    v_sub_f32 v117, v117, v224
    v_sub_f32 v118, v118, v224
    v_sub_f32 v119, v119, v224
    v_sub_f32 v132, v132, v224
    v_sub_f32 v133, v133, v224
    v_sub_f32 v134, v134, v224
    v_sub_f32 v135, v135, v224
    v_mul_f32 v216, v216, v220
    v_exp_f32 v116, v116
    v_exp_f32 v117, v117
    v_exp_f32 v118, v118
    v_exp_f32 v119, v119
    v_exp_f32 v132, v132
    v_exp_f32 v133, v133
    v_exp_f32 v134, v134
    v_exp_f32 v135, v135
    v_accvgpr_read_b32 v224, a0
    v_accvgpr_read_b32 v225, a1
    v_accvgpr_read_b32 v226, a2
    v_accvgpr_read_b32 v227, a3
    v_mul_f32 v224, v224, v220
    v_mul_f32 v225, v225, v220
    v_mul_f32 v226, v226, v220
    v_mul_f32 v227, v227, v220
    v_accvgpr_write_b32 a0, v224
    v_accvgpr_write_b32 a1, v225
    v_accvgpr_write_b32 a2, v226
    v_accvgpr_write_b32 a3, v227
    v_accvgpr_read_b32 v224, a16
    v_accvgpr_read_b32 v225, a17
    v_accvgpr_read_b32 v226, a18
    v_accvgpr_read_b32 v227, a19
    v_mul_f32 v224, v224, v220
    v_mul_f32 v225, v225, v220
    v_mul_f32 v226, v226, v220
    v_mul_f32 v227, v227, v220
    v_accvgpr_write_b32 a16, v224
    v_accvgpr_write_b32 a17, v225
    v_accvgpr_write_b32 a18, v226
    v_accvgpr_write_b32 a19, v227
    v_accvgpr_read_b32 v224, a32
    v_accvgpr_read_b32 v225, a33
    v_accvgpr_read_b32 v226, a34
    v_accvgpr_read_b32 v227, a35
    v_mul_f32 v224, v224, v220
    v_mul_f32 v225, v225, v220
    v_mul_f32 v226, v226, v220
    v_mul_f32 v227, v227, v220
    v_accvgpr_write_b32 a32, v224
    v_accvgpr_write_b32 a33, v225
    v_accvgpr_write_b32 a34, v226
    v_accvgpr_write_b32 a35, v227
    v_accvgpr_read_b32 v224, a48
    v_accvgpr_read_b32 v225, a49
    v_accvgpr_read_b32 v226, a50
    v_accvgpr_read_b32 v227, a51
    v_mul_f32 v224, v224, v220
    v_mul_f32 v225, v225, v220
    v_mul_f32 v226, v226, v220
    v_mul_f32 v227, v227, v220
    v_accvgpr_write_b32 a48, v224
    v_accvgpr_write_b32 a49, v225
    v_accvgpr_write_b32 a50, v226
    v_accvgpr_write_b32 a51, v227
    v_accvgpr_read_b32 v224, a64
    v_accvgpr_read_b32 v225, a65
    v_accvgpr_read_b32 v226, a66
    v_accvgpr_read_b32 v227, a67
    v_mul_f32 v224, v224, v220
    v_mul_f32 v225, v225, v220
    v_mul_f32 v226, v226, v220
    v_mul_f32 v227, v227, v220
    v_accvgpr_write_b32 a64, v224
    v_accvgpr_write_b32 a65, v225
    v_accvgpr_write_b32 a66, v226
    v_accvgpr_write_b32 a67, v227
    v_accvgpr_read_b32 v224, a80
    v_accvgpr_read_b32 v225, a81
    v_accvgpr_read_b32 v226, a82
    v_accvgpr_read_b32 v227, a83
    v_mul_f32 v224, v224, v220
    v_mul_f32 v225, v225, v220
    v_mul_f32 v226, v226, v220
    v_mul_f32 v227, v227, v220
    v_accvgpr_write_b32 a80, v224
    v_accvgpr_write_b32 a81, v225
    v_accvgpr_write_b32 a82, v226
    v_accvgpr_write_b32 a83, v227
    v_accvgpr_read_b32 v224, a96
    v_accvgpr_read_b32 v225, a97
    v_accvgpr_read_b32 v226, a98
    v_accvgpr_read_b32 v227, a99
    v_mul_f32 v224, v224, v220
    v_mul_f32 v225, v225, v220
    v_mul_f32 v226, v226, v220
    v_mul_f32 v227, v227, v220
    v_accvgpr_write_b32 a96, v224
    v_accvgpr_write_b32 a97, v225
    v_accvgpr_write_b32 a98, v226
    v_accvgpr_write_b32 a99, v227
    v_accvgpr_read_b32 v224, a112
    v_accvgpr_read_b32 v225, a113
    v_accvgpr_read_b32 v226, a114
    v_accvgpr_read_b32 v227, a115
    v_mul_f32 v224, v224, v220
    v_mul_f32 v225, v225, v220
    v_mul_f32 v226, v226, v220
    v_mul_f32 v227, v227, v220
    v_accvgpr_write_b32 a112, v224
    v_accvgpr_write_b32 a113, v225
    v_accvgpr_write_b32 a114, v226
    v_accvgpr_write_b32 a115, v227
    v_add_f32 v216, v216, v116
    v_add_f32 v216, v216, v117
    v_add_f32 v216, v216, v118
    v_add_f32 v216, v216, v119
    v_add_f32 v216, v216, v132
    v_add_f32 v216, v216, v133
    v_add_f32 v216, v216, v134
    v_add_f32 v216, v216, v135
    v_cvt_pk_bf16_f32 v180, v116, v117
    v_cvt_pk_bf16_f32 v181, v118, v119
    v_cvt_pk_bf16_f32 v182, v132, v133
    v_cvt_pk_bf16_f32 v183, v134, v135
    s_nop 1
    v_mfma_f32_16x16x32_bf16 a[0:3], v[196:199], v[180:183], a[0:3]
    v_mfma_f32_16x16x32_bf16 a[16:19], v[200:203], v[180:183], a[16:19]
    v_mfma_f32_16x16x32_bf16 a[32:35], v[204:207], v[180:183], a[32:35]
    v_mfma_f32_16x16x32_bf16 a[48:51], v[208:211], v[180:183], a[48:51]
    v_mfma_f32_16x16x32_bf16 a[64:67], v[228:231], v[180:183], a[64:67]
    v_mfma_f32_16x16x32_bf16 a[80:83], v[232:235], v[180:183], a[80:83]
    v_mfma_f32_16x16x32_bf16 a[96:99], v[236:239], v[180:183], a[96:99]
    v_mfma_f32_16x16x32_bf16 a[112:115], v[240:243], v[180:183], a[112:115]
    v_max3_f32 v224, v120, v121, v122
    v_max3_f32 v224, v224, v123, v136
    v_max3_f32 v224, v224, v137, v138
    v_max3_f32 v224, v224, v139, v213
    v_mov_b32 v225, v224
    s_nop 1
    v_permlane32_swap_b32 v224, v225
    v_max_f32 v224, v224, v225
    v_mov_b32 v225, v224
    s_nop 1
    v_permlane16_swap_b32 v224, v225
    v_max_f32 v224, v224, v225
    v_sub_f32 v220, v213, v224
    v_exp_f32 v220, v220
    v_mov_b32 v213, v224
    v_sub_f32 v120, v120, v224
    v_sub_f32 v121, v121, v224
    v_sub_f32 v122, v122, v224
    v_sub_f32 v123, v123, v224
    v_sub_f32 v136, v136, v224
    v_sub_f32 v137, v137, v224
    v_sub_f32 v138, v138, v224
    v_sub_f32 v139, v139, v224
    v_mul_f32 v217, v217, v220
    v_exp_f32 v120, v120
    v_exp_f32 v121, v121
    v_exp_f32 v122, v122
    v_exp_f32 v123, v123
    v_exp_f32 v136, v136
    v_exp_f32 v137, v137
    v_exp_f32 v138, v138
    v_exp_f32 v139, v139
    v_accvgpr_read_b32 v224, a4
    v_accvgpr_read_b32 v225, a5
    v_accvgpr_read_b32 v226, a6
    v_accvgpr_read_b32 v227, a7
    v_mul_f32 v224, v224, v220
    v_mul_f32 v225, v225, v220
    v_mul_f32 v226, v226, v220
    v_mul_f32 v227, v227, v220
    v_accvgpr_write_b32 a4, v224
    v_accvgpr_write_b32 a5, v225
    v_accvgpr_write_b32 a6, v226
    v_accvgpr_write_b32 a7, v227
    v_accvgpr_read_b32 v224, a20
    v_accvgpr_read_b32 v225, a21
    v_accvgpr_read_b32 v226, a22
    v_accvgpr_read_b32 v227, a23
    v_mul_f32 v224, v224, v220
    v_mul_f32 v225, v225, v220
    v_mul_f32 v226, v226, v220
    v_mul_f32 v227, v227, v220
    v_accvgpr_write_b32 a20, v224
    v_accvgpr_write_b32 a21, v225
    v_accvgpr_write_b32 a22, v226
    v_accvgpr_write_b32 a23, v227
    v_accvgpr_read_b32 v224, a36
    v_accvgpr_read_b32 v225, a37
    v_accvgpr_read_b32 v226, a38
    v_accvgpr_read_b32 v227, a39
    v_mul_f32 v224, v224, v220
    v_mul_f32 v225, v225, v220
    v_mul_f32 v226, v226, v220
    v_mul_f32 v227, v227, v220
    v_accvgpr_write_b32 a36, v224
    v_accvgpr_write_b32 a37, v225
    v_accvgpr_write_b32 a38, v226
    v_accvgpr_write_b32 a39, v227
    v_accvgpr_read_b32 v224, a52
    v_accvgpr_read_b32 v225, a53
    v_accvgpr_read_b32 v226, a54
    v_accvgpr_read_b32 v227, a55
    v_mul_f32 v224, v224, v220
    v_mul_f32 v225, v225, v220
    v_mul_f32 v226, v226, v220
    v_mul_f32 v227, v227, v220
    v_accvgpr_write_b32 a52, v224
    v_accvgpr_write_b32 a53, v225
    v_accvgpr_write_b32 a54, v226
    v_accvgpr_write_b32 a55, v227
    v_accvgpr_read_b32 v224, a68
    v_accvgpr_read_b32 v225, a69
    v_accvgpr_read_b32 v226, a70
    v_accvgpr_read_b32 v227, a71
    v_mul_f32 v224, v224, v220
    v_mul_f32 v225, v225, v220
    v_mul_f32 v226, v226, v220
    v_mul_f32 v227, v227, v220
    v_accvgpr_write_b32 a68, v224
    v_accvgpr_write_b32 a69, v225
    v_accvgpr_write_b32 a70, v226
    v_accvgpr_write_b32 a71, v227
    v_accvgpr_read_b32 v224, a84
    v_accvgpr_read_b32 v225, a85
    v_accvgpr_read_b32 v226, a86
    v_accvgpr_read_b32 v227, a87
    v_mul_f32 v224, v224, v220
    v_mul_f32 v225, v225, v220
    v_mul_f32 v226, v226, v220
    v_mul_f32 v227, v227, v220
    v_accvgpr_write_b32 a84, v224
    v_accvgpr_write_b32 a85, v225
    v_accvgpr_write_b32 a86, v226
    v_accvgpr_write_b32 a87, v227
    v_accvgpr_read_b32 v224, a100
    v_accvgpr_read_b32 v225, a101
    v_accvgpr_read_b32 v226, a102
    v_accvgpr_read_b32 v227, a103
    v_mul_f32 v224, v224, v220
    v_mul_f32 v225, v225, v220
    v_mul_f32 v226, v226, v220
    v_mul_f32 v227, v227, v220
    v_accvgpr_write_b32 a100, v224
    v_accvgpr_write_b32 a101, v225
    v_accvgpr_write_b32 a102, v226
    v_accvgpr_write_b32 a103, v227
    v_accvgpr_read_b32 v224, a116
    v_accvgpr_read_b32 v225, a117
    v_accvgpr_read_b32 v226, a118
    v_accvgpr_read_b32 v227, a119
    v_mul_f32 v224, v224, v220
    v_mul_f32 v225, v225, v220
    v_mul_f32 v226, v226, v220
    v_mul_f32 v227, v227, v220
    v_accvgpr_write_b32 a116, v224
    v_accvgpr_write_b32 a117, v225
    v_accvgpr_write_b32 a118, v226
    v_accvgpr_write_b32 a119, v227
    v_add_f32 v217, v217, v120
    v_add_f32 v217, v217, v121
    v_add_f32 v217, v217, v122
    v_add_f32 v217, v217, v123
    v_add_f32 v217, v217, v136
    v_add_f32 v217, v217, v137
    v_add_f32 v217, v217, v138
    v_add_f32 v217, v217, v139
    v_cvt_pk_bf16_f32 v184, v120, v121
    v_cvt_pk_bf16_f32 v185, v122, v123
    v_cvt_pk_bf16_f32 v186, v136, v137
    v_cvt_pk_bf16_f32 v187, v138, v139
    s_nop 1
    v_mfma_f32_16x16x32_bf16 a[4:7], v[196:199], v[184:187], a[4:7]
    v_mfma_f32_16x16x32_bf16 a[20:23], v[200:203], v[184:187], a[20:23]
    v_mfma_f32_16x16x32_bf16 a[36:39], v[204:207], v[184:187], a[36:39]
    v_mfma_f32_16x16x32_bf16 a[52:55], v[208:211], v[184:187], a[52:55]
    v_mfma_f32_16x16x32_bf16 a[68:71], v[228:231], v[184:187], a[68:71]
    v_mfma_f32_16x16x32_bf16 a[84:87], v[232:235], v[184:187], a[84:87]
    v_mfma_f32_16x16x32_bf16 a[100:103], v[236:239], v[184:187], a[100:103]
    v_mfma_f32_16x16x32_bf16 a[116:119], v[240:243], v[184:187], a[116:119]
    v_max3_f32 v224, v124, v125, v126
    v_max3_f32 v224, v224, v127, v140
    v_max3_f32 v224, v224, v141, v142
    v_max3_f32 v224, v224, v143, v214
    v_mov_b32 v225, v224
    s_nop 1
    v_permlane32_swap_b32 v224, v225
    v_max_f32 v224, v224, v225
    v_mov_b32 v225, v224
    s_nop 1
    v_permlane16_swap_b32 v224, v225
    v_max_f32 v224, v224, v225
    v_sub_f32 v220, v214, v224
    v_exp_f32 v220, v220
    v_mov_b32 v214, v224
    v_sub_f32 v124, v124, v224
    v_sub_f32 v125, v125, v224
    v_sub_f32 v126, v126, v224
    v_sub_f32 v127, v127, v224
    v_sub_f32 v140, v140, v224
    v_sub_f32 v141, v141, v224
    v_sub_f32 v142, v142, v224
    v_sub_f32 v143, v143, v224
    v_mul_f32 v218, v218, v220
    v_exp_f32 v124, v124
    v_exp_f32 v125, v125
    v_exp_f32 v126, v126
    v_exp_f32 v127, v127
    v_exp_f32 v140, v140
    v_exp_f32 v141, v141
    v_exp_f32 v142, v142
    v_exp_f32 v143, v143
    v_accvgpr_read_b32 v224, a8
    v_accvgpr_read_b32 v225, a9
    v_accvgpr_read_b32 v226, a10
    v_accvgpr_read_b32 v227, a11
    v_mul_f32 v224, v224, v220
    v_mul_f32 v225, v225, v220
    v_mul_f32 v226, v226, v220
    v_mul_f32 v227, v227, v220
    v_accvgpr_write_b32 a8, v224
    v_accvgpr_write_b32 a9, v225
    v_accvgpr_write_b32 a10, v226
    v_accvgpr_write_b32 a11, v227
    v_accvgpr_read_b32 v224, a24
    v_accvgpr_read_b32 v225, a25
    v_accvgpr_read_b32 v226, a26
    v_accvgpr_read_b32 v227, a27
    v_mul_f32 v224, v224, v220
    v_mul_f32 v225, v225, v220
    v_mul_f32 v226, v226, v220
    v_mul_f32 v227, v227, v220
    v_accvgpr_write_b32 a24, v224
    v_accvgpr_write_b32 a25, v225
    v_accvgpr_write_b32 a26, v226
    v_accvgpr_write_b32 a27, v227
    v_accvgpr_read_b32 v224, a40
    v_accvgpr_read_b32 v225, a41
    v_accvgpr_read_b32 v226, a42
    v_accvgpr_read_b32 v227, a43
    v_mul_f32 v224, v224, v220
    v_mul_f32 v225, v225, v220
    v_mul_f32 v226, v226, v220
    v_mul_f32 v227, v227, v220
    v_accvgpr_write_b32 a40, v224
    v_accvgpr_write_b32 a41, v225
    v_accvgpr_write_b32 a42, v226
    v_accvgpr_write_b32 a43, v227
    v_accvgpr_read_b32 v224, a56
    v_accvgpr_read_b32 v225, a57
    v_accvgpr_read_b32 v226, a58
    v_accvgpr_read_b32 v227, a59
    v_mul_f32 v224, v224, v220
    v_mul_f32 v225, v225, v220
    v_mul_f32 v226, v226, v220
    v_mul_f32 v227, v227, v220
    v_accvgpr_write_b32 a56, v224
    v_accvgpr_write_b32 a57, v225
    v_accvgpr_write_b32 a58, v226
    v_accvgpr_write_b32 a59, v227
    v_accvgpr_read_b32 v224, a72
    v_accvgpr_read_b32 v225, a73
    v_accvgpr_read_b32 v226, a74
    v_accvgpr_read_b32 v227, a75
    v_mul_f32 v224, v224, v220
    v_mul_f32 v225, v225, v220
    v_mul_f32 v226, v226, v220
    v_mul_f32 v227, v227, v220
    v_accvgpr_write_b32 a72, v224
    v_accvgpr_write_b32 a73, v225
    v_accvgpr_write_b32 a74, v226
    v_accvgpr_write_b32 a75, v227
    v_accvgpr_read_b32 v224, a88
    v_accvgpr_read_b32 v225, a89
    v_accvgpr_read_b32 v226, a90
    v_accvgpr_read_b32 v227, a91
    v_mul_f32 v224, v224, v220
    v_mul_f32 v225, v225, v220
    v_mul_f32 v226, v226, v220
    v_mul_f32 v227, v227, v220
    v_accvgpr_write_b32 a88, v224
    v_accvgpr_write_b32 a89, v225
    v_accvgpr_write_b32 a90, v226
    v_accvgpr_write_b32 a91, v227
    v_accvgpr_read_b32 v224, a104
    v_accvgpr_read_b32 v225, a105
    v_accvgpr_read_b32 v226, a106
    v_accvgpr_read_b32 v227, a107
    v_mul_f32 v224, v224, v220
    v_mul_f32 v225, v225, v220
    v_mul_f32 v226, v226, v220
    v_mul_f32 v227, v227, v220
    v_accvgpr_write_b32 a104, v224
    v_accvgpr_write_b32 a105, v225
    v_accvgpr_write_b32 a106, v226
    v_accvgpr_write_b32 a107, v227
    v_accvgpr_read_b32 v224, a120
    v_accvgpr_read_b32 v225, a121
    v_accvgpr_read_b32 v226, a122
    v_accvgpr_read_b32 v227, a123
    v_mul_f32 v224, v224, v220
    v_mul_f32 v225, v225, v220
    v_mul_f32 v226, v226, v220
    v_mul_f32 v227, v227, v220
    v_accvgpr_write_b32 a120, v224
    v_accvgpr_write_b32 a121, v225
    v_accvgpr_write_b32 a122, v226
    v_accvgpr_write_b32 a123, v227
    v_add_f32 v218, v218, v124
    v_add_f32 v218, v218, v125
    v_add_f32 v218, v218, v126
    v_add_f32 v218, v218, v127
    v_add_f32 v218, v218, v140
    v_add_f32 v218, v218, v141
    v_add_f32 v218, v218, v142
    v_add_f32 v218, v218, v143
    v_cvt_pk_bf16_f32 v188, v124, v125
    v_cvt_pk_bf16_f32 v189, v126, v127
    v_cvt_pk_bf16_f32 v190, v140, v141
    v_cvt_pk_bf16_f32 v191, v142, v143
    s_nop 1
    v_mfma_f32_16x16x32_bf16 a[8:11], v[196:199], v[188:191], a[8:11]
    v_mfma_f32_16x16x32_bf16 a[24:27], v[200:203], v[188:191], a[24:27]
    v_mfma_f32_16x16x32_bf16 a[40:43], v[204:207], v[188:191], a[40:43]
    v_mfma_f32_16x16x32_bf16 a[56:59], v[208:211], v[188:191], a[56:59]
    v_mfma_f32_16x16x32_bf16 a[72:75], v[228:231], v[188:191], a[72:75]
    v_mfma_f32_16x16x32_bf16 a[88:91], v[232:235], v[188:191], a[88:91]
    v_mfma_f32_16x16x32_bf16 a[104:107], v[236:239], v[188:191], a[104:107]
    v_mfma_f32_16x16x32_bf16 a[120:123], v[240:243], v[188:191], a[120:123]
    v_max3_f32 v224, v128, v129, v130
    v_max3_f32 v224, v224, v131, v144
    v_max3_f32 v224, v224, v145, v146
    v_max3_f32 v224, v224, v147, v215
    v_mov_b32 v225, v224
    s_nop 1
    v_permlane32_swap_b32 v224, v225
    v_max_f32 v224, v224, v225
    v_mov_b32 v225, v224
    s_nop 1
    v_permlane16_swap_b32 v224, v225
    v_max_f32 v224, v224, v225
    v_sub_f32 v220, v215, v224
    v_exp_f32 v220, v220
    v_mov_b32 v215, v224
    v_sub_f32 v128, v128, v224
    v_sub_f32 v129, v129, v224
    v_sub_f32 v130, v130, v224
    v_sub_f32 v131, v131, v224
    v_sub_f32 v144, v144, v224
    v_sub_f32 v145, v145, v224
    v_sub_f32 v146, v146, v224
    v_sub_f32 v147, v147, v224
    v_mul_f32 v219, v219, v220
    v_exp_f32 v128, v128
    v_exp_f32 v129, v129
    v_exp_f32 v130, v130
    v_exp_f32 v131, v131
    v_exp_f32 v144, v144
    v_exp_f32 v145, v145
    v_exp_f32 v146, v146
    v_exp_f32 v147, v147
    v_accvgpr_read_b32 v224, a12
    v_accvgpr_read_b32 v225, a13
    v_accvgpr_read_b32 v226, a14
    v_accvgpr_read_b32 v227, a15
    v_mul_f32 v224, v224, v220
    v_mul_f32 v225, v225, v220
    v_mul_f32 v226, v226, v220
    v_mul_f32 v227, v227, v220
    v_accvgpr_write_b32 a12, v224
    v_accvgpr_write_b32 a13, v225
    v_accvgpr_write_b32 a14, v226
    v_accvgpr_write_b32 a15, v227
    v_accvgpr_read_b32 v224, a28
    v_accvgpr_read_b32 v225, a29
    v_accvgpr_read_b32 v226, a30
    v_accvgpr_read_b32 v227, a31
    v_mul_f32 v224, v224, v220
    v_mul_f32 v225, v225, v220
    v_mul_f32 v226, v226, v220
    v_mul_f32 v227, v227, v220
    v_accvgpr_write_b32 a28, v224
    v_accvgpr_write_b32 a29, v225
    v_accvgpr_write_b32 a30, v226
    v_accvgpr_write_b32 a31, v227
    v_accvgpr_read_b32 v224, a44
    v_accvgpr_read_b32 v225, a45
    v_accvgpr_read_b32 v226, a46
    v_accvgpr_read_b32 v227, a47
    v_mul_f32 v224, v224, v220
    v_mul_f32 v225, v225, v220
    v_mul_f32 v226, v226, v220
    v_mul_f32 v227, v227, v220
    v_accvgpr_write_b32 a44, v224
    v_accvgpr_write_b32 a45, v225
    v_accvgpr_write_b32 a46, v226
    v_accvgpr_write_b32 a47, v227
    v_accvgpr_read_b32 v224, a60
    v_accvgpr_read_b32 v225, a61
    v_accvgpr_read_b32 v226, a62
    v_accvgpr_read_b32 v227, a63
    v_mul_f32 v224, v224, v220
    v_mul_f32 v225, v225, v220
    v_mul_f32 v226, v226, v220
    v_mul_f32 v227, v227, v220
    v_accvgpr_write_b32 a60, v224
    v_accvgpr_write_b32 a61, v225
    v_accvgpr_write_b32 a62, v226
    v_accvgpr_write_b32 a63, v227
    v_accvgpr_read_b32 v224, a76
    v_accvgpr_read_b32 v225, a77
    v_accvgpr_read_b32 v226, a78
    v_accvgpr_read_b32 v227, a79
    v_mul_f32 v224, v224, v220
    v_mul_f32 v225, v225, v220
    v_mul_f32 v226, v226, v220
    v_mul_f32 v227, v227, v220
    v_accvgpr_write_b32 a76, v224
    v_accvgpr_write_b32 a77, v225
    v_accvgpr_write_b32 a78, v226
    v_accvgpr_write_b32 a79, v227
    v_accvgpr_read_b32 v224, a92
    v_accvgpr_read_b32 v225, a93
    v_accvgpr_read_b32 v226, a94
    v_accvgpr_read_b32 v227, a95
    v_mul_f32 v224, v224, v220
    v_mul_f32 v225, v225, v220
    v_mul_f32 v226, v226, v220
    v_mul_f32 v227, v227, v220
    v_accvgpr_write_b32 a92, v224
    v_accvgpr_write_b32 a93, v225
    v_accvgpr_write_b32 a94, v226
    v_accvgpr_write_b32 a95, v227
    v_accvgpr_read_b32 v224, a108
    v_accvgpr_read_b32 v225, a109
    v_accvgpr_read_b32 v226, a110
    v_accvgpr_read_b32 v227, a111
    v_mul_f32 v224, v224, v220
    v_mul_f32 v225, v225, v220
    v_mul_f32 v226, v226, v220
    v_mul_f32 v227, v227, v220
    v_accvgpr_write_b32 a108, v224
    v_accvgpr_write_b32 a109, v225
    v_accvgpr_write_b32 a110, v226
    v_accvgpr_write_b32 a111, v227
    v_accvgpr_read_b32 v224, a124
    v_accvgpr_read_b32 v225, a125
    v_accvgpr_read_b32 v226, a126
    v_accvgpr_read_b32 v227, a127
    v_mul_f32 v224, v224, v220
    v_mul_f32 v225, v225, v220
    v_mul_f32 v226, v226, v220
    v_mul_f32 v227, v227, v220
    v_accvgpr_write_b32 a124, v224
    v_accvgpr_write_b32 a125, v225
    v_accvgpr_write_b32 a126, v226
    v_accvgpr_write_b32 a127, v227
    v_add_f32 v219, v219, v128
    v_add_f32 v219, v219, v129
    v_add_f32 v219, v219, v130
    v_add_f32 v219, v219, v131
    v_add_f32 v219, v219, v144
    v_add_f32 v219, v219, v145
    v_add_f32 v219, v219, v146
    v_add_f32 v219, v219, v147
    v_cvt_pk_bf16_f32 v192, v128, v129
    v_cvt_pk_bf16_f32 v193, v130, v131
    v_cvt_pk_bf16_f32 v194, v144, v145
    v_cvt_pk_bf16_f32 v195, v146, v147
    s_nop 1
    v_mfma_f32_16x16x32_bf16 a[12:15], v[196:199], v[192:195], a[12:15]
    v_mfma_f32_16x16x32_bf16 a[28:31], v[200:203], v[192:195], a[28:31]
    v_mfma_f32_16x16x32_bf16 a[44:47], v[204:207], v[192:195], a[44:47]
    v_mfma_f32_16x16x32_bf16 a[60:63], v[208:211], v[192:195], a[60:63]
    v_mfma_f32_16x16x32_bf16 a[76:79], v[228:231], v[192:195], a[76:79]
    v_mfma_f32_16x16x32_bf16 a[92:95], v[232:235], v[192:195], a[92:95]
    v_mfma_f32_16x16x32_bf16 a[108:111], v[236:239], v[192:195], a[108:111]
    v_mfma_f32_16x16x32_bf16 a[124:127], v[240:243], v[192:195], a[124:127]
    s_add_u32 s28, s28, 8192
    s_cmp_lt_u32 s28, 524288
    s_cbranch_scc1 L_slow_loop
    v_mov_b32 v224, v216
    s_nop 1
    v_permlane32_swap_b32 v216, v224
    v_add_f32 v216, v216, v224
    v_mov_b32 v224, v216
    s_nop 1
    v_permlane16_swap_b32 v216, v224
    v_add_f32 v216, v216, v224
    v_mov_b32 v100, v216
    v_mov_b32 v224, v217
    s_nop 1
    v_permlane32_swap_b32 v217, v224
    v_add_f32 v217, v217, v224
    v_mov_b32 v224, v217
    s_nop 1
    v_permlane16_swap_b32 v217, v224
    v_add_f32 v217, v217, v224
    v_mov_b32 v102, v217
    v_mov_b32 v224, v218
    s_nop 1
    v_permlane32_swap_b32 v218, v224
    v_add_f32 v218, v218, v224
    v_mov_b32 v224, v218
    s_nop 1
    v_permlane16_swap_b32 v218, v224
    v_add_f32 v218, v218, v224
    v_mov_b32 v104, v218
    v_mov_b32 v224, v219
    s_nop 1
    v_permlane32_swap_b32 v219, v224
    v_add_f32 v219, v219, v224
    v_mov_b32 v224, v219
    s_nop 1
    v_permlane16_swap_b32 v219, v224
    v_add_f32 v219, v219, v224
    v_mov_b32 v106, v219
    s_branch L_norm
L_spin_rows:
    s_mov_b32 s7, 32768
L_retry_rows:
    s_sleep 2
    buffer_load_dword v252, off, s[92:95], s74 sc1
    s_waitcnt vmcnt(0)
    v_cmp_ne_u32 vcc, 32, v252
    s_and_b64 vcc, vcc, exec
    s_cbranch_scc0 L_back_rows
    s_sub_u32 s7, s7, 1
    s_cbranch_scc0 L_retry_rows
    s_branch L_back_rows
L_spin_all:
    s_mov_b32 s7, 32768
L_retry_all:
    s_sleep 2
    buffer_load_dword v252, v253, s[92:95], 0 offen sc1
    s_waitcnt vmcnt(0)
    v_cmp_ne_u32 vcc, 32, v252
    s_and_b64 vcc, vcc, exec
    s_cbranch_scc0 L_back_all
    s_sub_u32 s7, s7, 1
    s_cbranch_scc0 L_retry_all
    s_branch L_back_all
L_site0:
    s_mov_b32 s43, m0
    s_mov_b32 m0, s38
    s_add_u32 s38, s38, 1024
    buffer_load_dwordx4 v24, s[16:19], s37 offen lds
    s_mov_b32 m0, s43
    s_add_u32 s37, s37, 221184
    s_cmp_eq_u32 s35, 2
    s_cselect_b32 s36, 4, s36
    s_branch L_site_back0
L_site1:
    s_mov_b32 s43, m0
    s_mov_b32 m0, s38
    s_add_u32 s38, s38, 1024
    buffer_load_dwordx4 v24, s[16:19], s37 offen lds
    s_mov_b32 m0, s43
    s_add_u32 s37, s37, 221184
    s_cmp_eq_u32 s35, 2
    s_cselect_b32 s36, 4, s36
    s_branch L_site_back1
L_site2:
    s_mov_b32 s43, m0
    s_mov_b32 m0, s38
    s_add_u32 s38, s38, 1024
    buffer_load_dwordx4 v24, s[16:19], s37 offen lds
    s_mov_b32 m0, s43
    s_add_u32 s37, s37, 221184
    s_cmp_eq_u32 s35, 2
    s_cselect_b32 s36, 4, s36
    s_branch L_site_back2
L_site3:
    s_mov_b32 s43, m0
    s_mov_b32 m0, s38
    s_add_u32 s38, s38, 1024
    buffer_load_dwordx4 v24, s[16:19], s37 offen lds
    s_mov_b32 m0, s43
    s_add_u32 s37, s37, 221184
    s_cmp_eq_u32 s35, 2
    s_cselect_b32 s36, 4, s36
    s_branch L_site_back3
L_spin_pack:
    s_mov_b32 s7, 32768
L_retry_pack:
    s_sleep 2
    buffer_load_dwordx4 v[28:31], v32, s[76:79], 0 offen sc1
    s_waitcnt vmcnt(0)
    v_min3_u32 v28, v28, v29, v30
    v_min_u32 v28, v28, v31
    v_cmp_gt_u32 vcc, 1, v28
    s_and_b64 vcc, vcc, exec
    s_cbranch_scc0 L_back_pack
    s_sub_u32 s7, s7, 1
    s_cbranch_scc0 L_retry_pack
    s_branch L_back_pack
L_spin_o:
    s_mov_b32 s7, 32768
L_retry_o:
    s_sleep 2
    buffer_load_dword v252, v1, s[76:79], 0 offen sc1
    s_waitcnt vmcnt(0)
    v_cmp_ne_u32 vcc, 1, v252
    s_and_b64 vcc, vcc, exec
    s_cbranch_scc0 L_back_o
    s_sub_u32 s7, s7, 1
    s_cbranch_scc0 L_retry_o
    s_branch L_back_o
L_spin_ffn:
    s_mov_b32 s7, 32768
L_retry_ffn:
    s_sleep 2
    buffer_load_dwordx4 v[150:153], v1, s[76:79], 0 offen offset:0 sc1
    buffer_load_dwordx4 v[154:157], v1, s[76:79], 0 offen offset:1024 sc1
    buffer_load_dwordx4 v[158:161], v1, s[76:79], 0 offen offset:2048 sc1
    buffer_load_dwordx4 v[162:165], v1, s[76:79], 0 offen offset:3072 sc1
    s_waitcnt vmcnt(0)
    v_min3_u32 v150, v150, v151, v152
    v_min3_u32 v150, v150, v153, v154
    v_min3_u32 v150, v150, v155, v156
    v_min3_u32 v150, v150, v157, v158
    v_min3_u32 v150, v150, v159, v160
    v_min3_u32 v150, v150, v161, v162
    v_min3_u32 v150, v150, v163, v164
    v_min_u32 v150, v150, v165
    v_cmp_gt_u32 vcc, 1, v150
    s_and_b64 vcc, vcc, exec
    s_cbranch_scc0 L_back_ffn
    s_sub_u32 s7, s7, 1
    s_cbranch_scc0 L_retry_ffn
    s_branch L_back_ffn

.section .rodata,"a"
.p2align 6
.amdhsa_kernel recurrent_scan__mha_block_cached__moe_arch_mod__prompt_kernel
  .amdhsa_next_free_vgpr 512
  .amdhsa_next_free_sgpr 102
  .amdhsa_accum_offset 256
  .amdhsa_group_segment_fixed_size 0
  .amdhsa_kernarg_size 104
  .amdhsa_user_sgpr_count 2
  .amdhsa_user_sgpr_kernarg_segment_ptr 1
  .amdhsa_system_sgpr_workgroup_id_x 1
  .amdhsa_float_denorm_mode_32 3
.end_amdhsa_kernel
```

```asm
; @launch grid=(256,1,1) block=(256,1,1) lds=163840
.amdgcn_target "amdgcn-amd-amdhsa--gfx950"
.text
.globl recurrent_scan__mha_block_cached__moe_arch_mod__prompt_kernel
.p2align 8
.type recurrent_scan__mha_block_cached__moe_arch_mod__prompt_kernel,@function
recurrent_scan__mha_block_cached__moe_arch_mod__prompt_kernel:
    s_cmp_ge_u32 s2, 256
    s_cbranch_scc1 L_end
    s_load_dwordx16 s[48:63], s[0:1], 0
    s_load_dwordx8 s[64:71], s[0:1], 64
    s_load_dwordx2 s[72:73], s[0:1], 96
    s_getpc_b64 s[40:41]
L_touch:
    s_bfe_u32 s42, s2, 0x20003
    s_lshl_b32 s42, s42, 8
    v_add_u32 v252, s42, v0
    v_min_u32 v252, (L_code_end - L_touch) / 128, v252
    v_lshlrev_b32 v252, 7, v252
    global_load_dword a120, v252, s[40:41]
    v_lshrrev_b32 v116, 6, v0
    v_and_b32 v19, 63, v0
    s_and_b32 s40, s2, 7
    v_readfirstlane_b32 s5, v116
    s_lshl_b32 s40, s40, 2
    s_bfe_u32 s41, s2, 0x20003
    s_add_u32 s3, s40, s41
    s_lshr_b32 s4, s2, 5
    s_lshl_b32 s74, s4, 5
    s_add_u32 s6, s74, s3
    v_lshrrev_b32 v118, 4, v19
    v_and_b32 v117, 15, v19
    v_lshlrev_b32 v119, 1, v118
    v_xor_b32 v119, v117, v119
    s_lshl_b32 s42, s5, 4
    v_add_u32 v120, s42, v118
    v_lshlrev_b32 v121, 4, v119
    v_xor_b32 v122, 0x80, v121
    v_lshl_add_u32 v123, v120, 13, v121
    v_lshl_add_u32 v116, v120, 13, v122
    v_add_u32 v44, 0, v123
    v_add_u32 v45, 31744, v123
    v_add_u32 v46, 63488, v116
    v_add_u32 v47, 95232, v116
    v_lshl_add_u32 v17, v120, 8, v121
    v_lshl_add_u32 v18, v120, 8, v122
    v_xor_b32 v117, v117, v118
    v_xor_b32 v121, 0, v117
    v_lshlrev_b32 v121, 4, v121
    v_lshl_add_u32 v13, v120, 8, v121
    v_xor_b32 v121, 4, v117
    v_lshlrev_b32 v121, 4, v121
    v_lshl_add_u32 v14, v120, 8, v121
    v_xor_b32 v121, 8, v117
    v_lshlrev_b32 v121, 4, v121
    v_lshl_add_u32 v15, v120, 8, v121
    v_xor_b32 v121, 12, v117
    v_lshlrev_b32 v121, 4, v121
    v_lshl_add_u32 v16, v120, 8, v121
    v_lshrrev_b32 v116, 3, v19
    v_and_b32 v117, 7, v19
    v_xor_b32 v117, v117, v118
    v_mul_u32_u24 v116, 1280, v116
    s_mul_i32 s42, s5, 81920
    v_lshl_add_u32 v119, v117, 4, v116
    v_xor_b32 v117, 4, v117
    v_lshl_add_u32 v120, v117, 4, v116
    v_add_u32 v119, s42, v119
    v_add_u32 v120, s42, v120
    v_add_u32 v36, 0, v119
    v_add_u32 v37, 9216, v120
    v_add_u32 v38, 18432, v119
    v_add_u32 v39, 27648, v120
    v_add_u32 v40, 40960, v119
    v_add_u32 v41, 50176, v120
    v_add_u32 v42, 59392, v119
    v_add_u32 v43, 68608, v120
    s_lshl_b32 s43, s6, 2
    s_add_u32 s43, s43, s5
    s_lshl_b32 s43, s43, 1
    s_mul_i32 s38, s5, 24576
    s_lshl_b32 s40, s5, 12
    s_add_u32 s39, s40, 98304
    s_mov_b32 s34, s39
    s_mov_b32 s28, 0
    s_mov_b32 s29, 0
    s_waitcnt lgkmcnt(0)
    s_mov_b32 s88, s48
    s_mov_b32 s89, s49
    s_mov_b32 s90, 0x280000
    s_mov_b32 s91, 0x20000
    s_mov_b32 s92, s60
    s_mov_b32 s93, s61
    s_mov_b32 s94, 0x500
    s_mov_b32 s95, 0x20000
    s_lshl_b32 s40, s3, 8
    s_add_u32 s20, s54, s40
    s_addc_u32 s21, s55, 0
    s_mov_b32 s22, 0x4fe100
    s_mov_b32 s23, 0x20000
    s_mul_i32 s40, s4, 327680
    s_add_u32 s16, s48, s40
    s_addc_u32 s17, s49, 0
    s_mov_b32 s18, 0x50000
    s_mov_b32 s19, 0x20000
    s_add_u32 m0, s39, 0
    s_mov_b32 s37, 0
    buffer_load_dwordx4 v44, s[20:23], s37 offen offset:0 lds
    buffer_load_dwordx4 v45, s[20:23], s37 offen offset:1024 lds
    buffer_load_dwordx4 v46, s[20:23], s37 offen offset:2048 lds
    buffer_load_dwordx4 v47, s[20:23], s37 offen offset:3072 lds
    s_add_u32 m0, s38, 0
    s_mov_b32 s36, 0
    buffer_load_dwordx4 v36, s[16:19], s36 offen offset:0 lds
    buffer_load_dwordx4 v37, s[16:19], s36 offen offset:1024 lds
    buffer_load_dwordx4 v38, s[16:19], s36 offen offset:2048 lds
    buffer_load_dwordx4 v39, s[16:19], s36 offen offset:3072 lds
    s_add_u32 m0, s38, 4096
    s_nop 0
    buffer_load_dwordx4 v40, s[16:19], s36 offen offset:0 lds
    buffer_load_dwordx4 v41, s[16:19], s36 offen offset:1024 lds
    buffer_load_dwordx4 v42, s[16:19], s36 offen offset:2048 lds
    buffer_load_dwordx4 v43, s[16:19], s36 offen offset:3072 lds
    v_lshrrev_b32 v108, 5, v19
    v_add_u32 v108, s43, v108
    v_and_b32 v110, 31, v19
    v_lshlrev_b32 v110, 3, v110
    v_mul_u32_u24 v109, 1280, v108
    v_add_u32 v109, v109, v110
    buffer_load_dwordx2 v[60:61], v109, s[88:91], 0 offen offset:0
    buffer_load_dwordx2 v[62:63], v109, s[88:91], 0 offen offset:256
    buffer_load_dwordx2 v[64:65], v109, s[88:91], 0 offen offset:512
    buffer_load_dwordx2 v[66:67], v109, s[88:91], 0 offen offset:768
    buffer_load_dwordx2 v[68:69], v109, s[88:91], 0 offen offset:1024
    buffer_load_dwordx2 v[70:71], v110, s[92:95], 0 offen offset:0
    buffer_load_dwordx2 v[72:73], v110, s[92:95], 0 offen offset:256
    buffer_load_dwordx2 v[74:75], v110, s[92:95], 0 offen offset:512
    buffer_load_dwordx2 v[76:77], v110, s[92:95], 0 offen offset:768
    buffer_load_dwordx2 v[78:79], v110, s[92:95], 0 offen offset:1024
    s_lshl_b32 s40, s3, 19
    s_add_u32 s8, s50, s40
    s_addc_u32 s9, s51, 0
    s_mov_b32 s10, 0x80000
    s_mov_b32 s11, 0x20000
    s_add_u32 s12, s52, s40
    s_addc_u32 s13, s53, 0
    s_mov_b32 s14, 0x80000
    s_mov_b32 s15, 0x20000
    s_and_b32 s40, s5, 1
    s_lshl_b32 s40, s40, 12
    s_cmp_ge_u32 s5, 2
    s_cselect_b32 s30, 32, 8
    s_cselect_b32 s31, 40, 16
    s_cselect_b32 s32, 0, 56
    s_cselect_b32 s33, 48, 24
    s_lshl_b32 s30, s30, 10
    s_add_u32 s30, s30, s40
    s_lshl_b32 s31, s31, 10
    s_add_u32 s31, s31, s40
    s_lshl_b32 s32, s32, 10
    s_add_u32 s32, s32, s40
    s_lshl_b32 s33, s33, 10
    s_add_u32 s33, s33, s40
    s_mov_b32 s44, 0x3e0293ee
    s_mov_b32 s45, 4096
    s_mov_b32 s86, 0
    s_mov_b32 s76, s72
    s_mov_b32 s77, s73
    s_mov_b32 s78, 0x2000000
    s_mov_b32 s79, 0x20000
    s_mov_b32 s92, s70
    s_mov_b32 s93, s71
    s_mov_b32 s94, 0x100
    s_mov_b32 s95, 0x20000
    s_lshl_b32 s41, s4, 2
    s_add_u32 s41, s41, s5
    s_lshl_b32 s40, s41, 5
    s_add_u32 s40, s40, s3
    s_lshl_b32 s40, s40, 14
    s_add_u32 s40, s40, 0x400000
    s_add_u32 s24, s72, s40
    s_addc_u32 s25, s73, 0
    s_mov_b32 s26, 0x4000
    s_mov_b32 s27, 0x20000
    s_and_b32 s42, s3, 3
    s_lshl_b32 s42, s42, 2
    s_lshr_b32 s40, s6, 2
    s_lshl_b32 s40, s40, 7
    s_add_u32 s40, s40, s42
    s_add_u32 s75, s40, 0x290000
    s_lshr_b32 s40, s3, 2
    s_lshl_b32 s40, s40, 7
    s_add_u32 s40, s40, s42
    s_lshl_b32 s42, s41, 10
    s_add_u32 s40, s40, s42
    s_add_u32 s58, s40, 0x292000
    s_cmp_eq_u32 s5, 0
    s_cselect_b32 s59, 5, 8
    s_lshl_b32 s41, s41, 10
    s_add_u32 s46, s41, 0x280000
    v_lshrrev_b32 v116, 4, v19
    v_and_b32 v117, 15, v19
    v_lshlrev_b32 v59, 4, v117
    v_xor_b32 v118, v116, v117
    v_lshlrev_b32 v119, 8, v117
    v_add_u32 v119, 98304, v119
    s_add_u32 s41, s5, 0
    s_and_b32 s41, s41, 3
    s_lshl_b32 s41, s41, 2
    v_xor_b32 v120, s41, v118
    v_lshl_add_u32 v1, v120, 4, v119
    s_add_u32 s41, s5, 1
    s_and_b32 s41, s41, 3
    s_lshl_b32 s41, s41, 2
    v_xor_b32 v120, s41, v118
    v_lshl_add_u32 v2, v120, 4, v119
    s_add_u32 s41, s5, 2
    s_and_b32 s41, s41, 3
    s_lshl_b32 s41, s41, 2
    v_xor_b32 v120, s41, v118
    v_lshl_add_u32 v3, v120, 4, v119
    s_add_u32 s41, s5, 3
    s_and_b32 s41, s41, 3
    s_lshl_b32 s41, s41, 2
    v_xor_b32 v120, s41, v118
    v_lshl_add_u32 v4, v120, 4, v119
    v_lshrrev_b32 v118, 1, v117
    v_xor_b32 v118, v116, v118
    v_lshlrev_b32 v119, 7, v117
    v_add_u32 v119, s38, v119
    v_xor_b32 v120, 0, v118
    v_lshl_add_u32 v48, v120, 4, v119
    v_xor_b32 v120, 4, v118
    v_lshl_add_u32 v49, v120, 4, v119
    v_bfe_u32 v118, v19, 2, 2
    v_bfe_u32 v119, v19, 2, 3
    v_and_b32 v120, 3, v19
    v_lshlrev_b32 v120, 3, v120
    v_lshl_add_u32 v121, v116, 2, v118
    v_lshl_add_u32 v121, v121, 8, v120
    v_lshl_add_u32 v122, v116, 3, v118
    v_lshl_add_u32 v122, v122, 8, v120
    v_add_u32 v122, 98304, v122
    v_xor_b32 v123, 0, v119
    v_lshl_add_u32 v5, v123, 5, v121
    v_xor_b32 v123, 1, v119
    v_lshl_add_u32 v6, v123, 5, v121
    v_xor_b32 v123, 2, v119
    v_lshl_add_u32 v7, v123, 5, v121
    v_xor_b32 v123, 3, v119
    v_lshl_add_u32 v8, v123, 5, v121
    v_xor_b32 v123, 4, v119
    v_lshl_add_u32 v9, v123, 5, v121
    v_xor_b32 v123, 5, v119
    v_lshl_add_u32 v10, v123, 5, v121
    v_xor_b32 v123, 6, v119
    v_lshl_add_u32 v11, v123, 5, v121
    v_xor_b32 v123, 7, v119
    v_lshl_add_u32 v12, v123, 5, v121
    s_lshl_b32 s42, s5, 1
    s_add_u32 s41, s42, 0
    s_and_b32 s41, s41, 7
    v_xor_b32 v123, s41, v119
    v_lshl_add_u32 v50, v123, 5, v122
    s_add_u32 s41, s42, 1
    s_and_b32 s41, s41, 7
    v_xor_b32 v123, s41, v119
    v_lshl_add_u32 v51, v123, 5, v122
    s_add_u32 s41, s42, 2
    s_and_b32 s41, s41, 7
    v_xor_b32 v123, s41, v119
    v_lshl_add_u32 v52, v123, 5, v122
    s_add_u32 s41, s42, 3
    s_and_b32 s41, s41, 7
    v_xor_b32 v123, s41, v119
    v_lshl_add_u32 v53, v123, 5, v122
    s_add_u32 s41, s42, 4
    s_and_b32 s41, s41, 7
    v_xor_b32 v123, s41, v119
    v_lshl_add_u32 v54, v123, 5, v122
    s_add_u32 s41, s42, 5
    s_and_b32 s41, s41, 7
    v_xor_b32 v123, s41, v119
    v_lshl_add_u32 v55, v123, 5, v122
    s_add_u32 s41, s42, 6
    s_and_b32 s41, s41, 7
    v_xor_b32 v123, s41, v119
    v_lshl_add_u32 v56, v123, 5, v122
    s_add_u32 s41, s42, 7
    s_and_b32 s41, s41, 7
    v_xor_b32 v123, s41, v119
    v_lshl_add_u32 v57, v123, 5, v122
    s_lshl_b32 s41, s5, 7
    s_add_u32 s41, s41, 65536
    v_lshl_add_u32 v58, v116, 4, s41
    v_mov_b32 v32, 0x3f803f80
    v_mov_b32 v33, 0x3f803f80
    v_mov_b32 v34, 0x3f803f80
    v_mov_b32 v35, 0x3f803f80
    v_and_b32 v120, 1, v19
    v_cmp_eq_u32 vcc, 0, v120
    v_mov_b32 v121, 0x44444444
    v_mov_b32 v122, 0xeeeeeeee
    v_cndmask_b32 v248, v122, v121, vcc
    v_and_b32 v120, 2, v19
    v_cmp_eq_u32 vcc, 0, v120
    v_mov_b32 v27, 1
    v_mov_b32 v28, 0
    v_cndmask_b32 v244, 0, v32, vcc
    v_cndmask_b32 v245, 0, v32, vcc
    v_cndmask_b32 v246, 0, v32, vcc
    v_cndmask_b32 v247, 0, v32, vcc
    v_accvgpr_write_b32 a224, 0
    v_accvgpr_write_b32 a225, 0
    v_accvgpr_write_b32 a226, 0
    v_accvgpr_write_b32 a227, 0
    v_accvgpr_write_b32 a228, 0
    v_accvgpr_write_b32 a229, 0
    v_accvgpr_write_b32 a230, 0
    v_accvgpr_write_b32 a231, 0
    v_accvgpr_write_b32 a232, 0
    v_accvgpr_write_b32 a233, 0
    v_accvgpr_write_b32 a234, 0
    v_accvgpr_write_b32 a235, 0
    v_accvgpr_write_b32 a236, 0
    v_accvgpr_write_b32 a237, 0
    v_accvgpr_write_b32 a238, 0
    v_accvgpr_write_b32 a239, 0
    s_mul_i32 s47, s5, 5120
    s_mov_b32 s96, s56
    s_mov_b32 s97, s57
    s_mov_b32 s98, 0x500000
    s_mov_b32 s99, 0x20000
    s_lshr_b32 s40, s6, 1
    s_and_b32 s41, s6, 1
    s_lshl_b32 s41, s41, 2
    s_add_u32 s41, s41, s5
    s_add_u32 s47, s47, 65536
    s_mul_i32 s42, s40, 40960
    s_mul_i32 s43, s41, 160
    s_add_u32 s42, s42, s43
    v_add_u32 v25, 0, v19
    v_mul_u32_u24 v26, 6554, v25
    v_lshrrev_b32 v26, 16, v26
    v_mul_u32_u24 v20, 1120, v26
    v_lshl_add_u32 v20, v25, 4, v20
    v_add_u32 v20, s42, v20
    v_add_u32 v25, 64, v19
    v_mul_u32_u24 v26, 6554, v25
    v_lshrrev_b32 v26, 16, v26
    v_mul_u32_u24 v21, 1120, v26
    v_lshl_add_u32 v21, v25, 4, v21
    v_add_u32 v21, s42, v21
    v_add_u32 v25, 128, v19
    v_mul_u32_u24 v26, 6554, v25
    v_lshrrev_b32 v26, 16, v26
    v_mul_u32_u24 v22, 1120, v26
    v_lshl_add_u32 v22, v25, 4, v22
    v_add_u32 v22, s42, v22
    v_add_u32 v25, 192, v19
    v_mul_u32_u24 v26, 6554, v25
    v_lshrrev_b32 v26, 16, v26
    v_mul_u32_u24 v23, 1120, v26
    v_lshl_add_u32 v23, v25, 4, v23
    v_add_u32 v23, s42, v23
    v_add_u32 v25, 256, v19
    v_mul_u32_u24 v26, 6554, v25
    v_lshrrev_b32 v26, 16, v26
    v_mul_u32_u24 v24, 1120, v26
    v_lshl_add_u32 v24, v25, 4, v24
    v_add_u32 v24, s42, v24
    v_lshrrev_b32 v25, 2, v19
    v_mul_u32_u24 v25, 160, v25
    v_and_b32 v26, 3, v19
    v_lshl_add_u32 v25, v26, 3, v25
    v_add_u32 v25, s47, v25
    s_lshl_b32 s42, s41, 7
    s_add_u32 s42, s42, s40
    s_mul_i32 s42, s42, 5120
    s_add_u32 s42, s42, 0x1400000
    v_lshlrev_b32 v26, 4, v19
    v_add_u32 v26, s42, v26
    s_add_u32 m0, s39, 16384
    s_mov_b32 s37, 524288
    buffer_load_dwordx4 v44, s[20:23], s37 offen offset:0 lds
    buffer_load_dwordx4 v45, s[20:23], s37 offen offset:1024 lds
    buffer_load_dwordx4 v46, s[20:23], s37 offen offset:2048 lds
    buffer_load_dwordx4 v47, s[20:23], s37 offen offset:3072 lds
    s_add_u32 m0, s38, 8192
    s_mov_b32 s36, 128
    buffer_load_dwordx4 v36, s[16:19], s36 offen offset:0 lds
    buffer_load_dwordx4 v37, s[16:19], s36 offen offset:1024 lds
    buffer_load_dwordx4 v38, s[16:19], s36 offen offset:2048 lds
    buffer_load_dwordx4 v39, s[16:19], s36 offen offset:3072 lds
    s_add_u32 m0, s38, 12288
    s_nop 0
    buffer_load_dwordx4 v40, s[16:19], s36 offen offset:0 lds
    buffer_load_dwordx4 v41, s[16:19], s36 offen offset:1024 lds
    buffer_load_dwordx4 v42, s[16:19], s36 offen offset:2048 lds
    buffer_load_dwordx4 v43, s[16:19], s36 offen offset:3072 lds
    s_add_u32 m0, s39, 32768
    s_mov_b32 s37, 1048576
    buffer_load_dwordx4 v44, s[20:23], s37 offen offset:0 lds
    buffer_load_dwordx4 v45, s[20:23], s37 offen offset:1024 lds
    buffer_load_dwordx4 v46, s[20:23], s37 offen offset:2048 lds
    buffer_load_dwordx4 v47, s[20:23], s37 offen offset:3072 lds
    s_add_u32 m0, s38, 16384
    s_mov_b32 s36, 256
    buffer_load_dwordx4 v36, s[16:19], s36 offen offset:0 lds
    buffer_load_dwordx4 v37, s[16:19], s36 offen offset:1024 lds
    buffer_load_dwordx4 v38, s[16:19], s36 offen offset:2048 lds
    buffer_load_dwordx4 v39, s[16:19], s36 offen offset:3072 lds
    s_add_u32 m0, s38, 20480
    s_nop 0
    buffer_load_dwordx4 v40, s[16:19], s36 offen offset:0 lds
    buffer_load_dwordx4 v41, s[16:19], s36 offen offset:1024 lds
    s_waitcnt vmcnt(32)
    s_barrier
    ds_read_b64_tr_b16 a[0:1], v50 offset:0
    ds_read_b64_tr_b16 a[2:3], v50 offset:1024
    ds_read_b128 a[32:35], v48 offset:0
    ds_read_b128 a[36:39], v48 offset:2048
    ds_read_b128 a[40:43], v48 offset:4096
    ds_read_b128 a[44:47], v48 offset:6144
    ds_read_b64_tr_b16 a[4:5], v51 offset:0
    ds_read_b64_tr_b16 a[6:7], v51 offset:1024
    ds_read_b64_tr_b16 a[8:9], v52 offset:0
    ds_read_b64_tr_b16 a[10:11], v52 offset:1024
    ds_read_b64_tr_b16 a[12:13], v53 offset:0
    ds_read_b64_tr_b16 a[14:15], v53 offset:1024
    ds_read_b64_tr_b16 a[16:17], v54 offset:0
    ds_read_b64_tr_b16 a[18:19], v54 offset:1024
    ds_read_b64_tr_b16 a[20:21], v55 offset:0
    ds_read_b64_tr_b16 a[22:23], v55 offset:1024
    ds_read_b64_tr_b16 a[24:25], v56 offset:0
    ds_read_b64_tr_b16 a[26:27], v56 offset:1024
    ds_read_b64_tr_b16 a[28:29], v57 offset:0
    ds_read_b64_tr_b16 a[30:31], v57 offset:1024
    s_waitcnt lgkmcnt(0)
    v_mfma_f32_16x16x32_bf16 v[100:103], a[0:3], v[32:35], 0
    ds_read_b64_tr_b16 a[48:49], v50 offset:8192
    v_mfma_f32_16x16x32_bf16 v[104:107], a[4:7], v[32:35], 0
    ds_read_b64_tr_b16 a[50:51], v50 offset:9216
    v_mfma_f32_16x16x32_bf16 v[116:119], a[0:3], a[32:35], 0
    buffer_load_dwordx4 v42, s[16:19], s36 offen offset:2048 lds
    v_mfma_f32_16x16x32_bf16 v[148:151], a[0:3], a[36:39], 0
    ds_read_b128 a[80:83], v49 offset:0
    v_mfma_f32_16x16x32_bf16 v[180:183], a[0:3], a[40:43], 0
    ds_read_b128 a[84:87], v49 offset:2048
    v_mfma_f32_16x16x32_bf16 v[212:215], a[0:3], a[44:47], 0
    ds_read_b128 a[88:91], v49 offset:4096
    v_mfma_f32_16x16x32_bf16 v[216:219], a[4:7], a[44:47], 0
    ds_read_b128 a[92:95], v49 offset:6144
    v_mfma_f32_16x16x32_bf16 v[184:187], a[4:7], a[40:43], 0
    ds_read_b64_tr_b16 a[52:53], v51 offset:8192
    v_mfma_f32_16x16x32_bf16 v[152:155], a[4:7], a[36:39], 0
    ds_read_b64_tr_b16 a[54:55], v51 offset:9216
    v_mfma_f32_16x16x32_bf16 v[120:123], a[4:7], a[32:35], 0
    ds_read_b64_tr_b16 a[56:57], v52 offset:8192
    v_mfma_f32_16x16x32_bf16 v[124:127], a[8:11], a[32:35], 0
    ds_read_b64_tr_b16 a[58:59], v52 offset:9216
    v_mfma_f32_16x16x32_bf16 v[156:159], a[8:11], a[36:39], 0
    ds_read_b64_tr_b16 a[60:61], v53 offset:8192
    v_mfma_f32_16x16x32_bf16 v[188:191], a[8:11], a[40:43], 0
    ds_read_b64_tr_b16 a[62:63], v53 offset:9216
    v_mfma_f32_16x16x32_bf16 v[220:223], a[8:11], a[44:47], 0
    ds_read_b64_tr_b16 a[64:65], v54 offset:8192
    v_mfma_f32_16x16x32_bf16 v[224:227], a[12:15], a[44:47], 0
    ds_read_b64_tr_b16 a[66:67], v54 offset:9216
    v_mfma_f32_16x16x32_bf16 v[192:195], a[12:15], a[40:43], 0
    ds_read_b64_tr_b16 a[68:69], v55 offset:8192
    v_mfma_f32_16x16x32_bf16 v[160:163], a[12:15], a[36:39], 0
    ds_read_b64_tr_b16 a[70:71], v55 offset:9216
    v_mfma_f32_16x16x32_bf16 v[128:131], a[12:15], a[32:35], 0
    buffer_load_dwordx4 v43, s[16:19], s36 offen offset:3072 lds
    v_mfma_f32_16x16x32_bf16 v[132:135], a[16:19], a[32:35], 0
    ds_read_b64_tr_b16 a[72:73], v56 offset:8192
    v_mfma_f32_16x16x32_bf16 v[164:167], a[16:19], a[36:39], 0
    ds_read_b64_tr_b16 a[74:75], v56 offset:9216
    v_mfma_f32_16x16x32_bf16 v[196:199], a[16:19], a[40:43], 0
    ds_read_b64_tr_b16 a[76:77], v57 offset:8192
    v_mfma_f32_16x16x32_bf16 v[228:231], a[16:19], a[44:47], 0
    ds_read_b64_tr_b16 a[78:79], v57 offset:9216
    v_mfma_f32_16x16x32_bf16 v[232:235], a[20:23], a[44:47], 0
    v_mfma_f32_16x16x32_bf16 v[200:203], a[20:23], a[40:43], 0
    v_mfma_f32_16x16x32_bf16 v[168:171], a[20:23], a[36:39], 0
    v_mfma_f32_16x16x32_bf16 v[136:139], a[20:23], a[32:35], 0
    v_mfma_f32_16x16x32_bf16 v[140:143], a[24:27], a[32:35], 0
    v_mfma_f32_16x16x32_bf16 v[172:175], a[24:27], a[36:39], 0
    v_mfma_f32_16x16x32_bf16 v[204:207], a[24:27], a[40:43], 0
    v_mfma_f32_16x16x32_bf16 v[236:239], a[24:27], a[44:47], 0
    v_mfma_f32_16x16x32_bf16 v[240:243], a[28:31], a[44:47], 0
    v_mfma_f32_16x16x32_bf16 v[208:211], a[28:31], a[40:43], 0
    v_mfma_f32_16x16x32_bf16 v[176:179], a[28:31], a[36:39], 0
    v_mfma_f32_16x16x32_bf16 v[144:147], a[28:31], a[32:35], 0
    s_waitcnt vmcnt(24)
    s_lshl_b32 s40, s6, 7
    s_add_u32 s41, s40, 0x292000
    s_add_u32 s40, s40, 0x290000
    s_cmp_lt_u32 s6, 64
    s_cselect_b32 s40, s40, 0x2000000
    s_cmp_eq_u32 s5, 1
    s_cselect_b32 s40, s40, 0x2000000
    s_cmp_eq_u32 s5, 0
    s_cselect_b32 s40, s41, s40
    v_lshlrev_b32 v29, 2, v19
    s_mov_b32 exec_hi, 0
    buffer_store_dword v28, v29, s[76:79], s40 offen sc1
    s_mov_b32 exec_hi, -1
    v_lshlrev_b32 v80, 16, v60
    v_and_b32 v81, 0xffff0000, v60
    v_lshlrev_b32 v82, 16, v61
    v_and_b32 v83, 0xffff0000, v61
    v_lshlrev_b32 v84, 16, v62
    v_and_b32 v85, 0xffff0000, v62
    v_lshlrev_b32 v86, 16, v63
    v_and_b32 v87, 0xffff0000, v63
    v_lshlrev_b32 v88, 16, v64
    v_and_b32 v89, 0xffff0000, v64
    v_lshlrev_b32 v90, 16, v65
    v_and_b32 v91, 0xffff0000, v65
    v_lshlrev_b32 v92, 16, v66
    v_and_b32 v93, 0xffff0000, v66
    v_lshlrev_b32 v94, 16, v67
    v_and_b32 v95, 0xffff0000, v67
    v_lshlrev_b32 v96, 16, v68
    v_and_b32 v97, 0xffff0000, v68
    v_lshlrev_b32 v98, 16, v69
    v_and_b32 v99, 0xffff0000, v69
    v_add_f32 v109, v80, v81
    v_add_f32 v110, v82, v83
    v_add_f32 v109, v109, v84
    v_add_f32 v110, v110, v85
    v_add_f32 v109, v109, v86
    v_add_f32 v110, v110, v87
    v_add_f32 v109, v109, v88
    v_add_f32 v110, v110, v89
    v_add_f32 v109, v109, v90
    v_add_f32 v110, v110, v91
    v_add_f32 v109, v109, v92
    v_add_f32 v110, v110, v93
    v_add_f32 v109, v109, v94
    v_add_f32 v110, v110, v95
    v_add_f32 v109, v109, v96
    v_add_f32 v110, v110, v97
    v_add_f32 v109, v109, v98
    v_add_f32 v110, v110, v99
    v_add_f32 v109, v109, v110
    s_nop 1
    v_add_f32_dpp v109, v109, v109 quad_perm:[1,0,3,2] row_mask:0xf bank_mask:0xf
    s_nop 1
    v_add_f32_dpp v109, v109, v109 quad_perm:[2,3,0,1] row_mask:0xf bank_mask:0xf
    s_nop 1
    v_add_f32_dpp v109, v109, v109 row_half_mirror row_mask:0xf bank_mask:0xf
    s_nop 1
    v_add_f32_dpp v109, v109, v109 row_mirror row_mask:0xf bank_mask:0xf
    v_mov_b32 v110, v109
    s_nop 1
    v_permlane16_swap_b32 v109, v110
    v_add_f32 v109, v109, v110
    v_mul_f32 v111, 0x3acccccd, v109
    v_sub_f32 v60, v80, v111
    v_mul_f32 v109, v60, v60
    v_sub_f32 v61, v81, v111
    v_mul_f32 v112, v61, v61
    v_sub_f32 v60, v82, v111
    v_fmac_f32 v109, v60, v60
    v_sub_f32 v61, v83, v111
    v_fmac_f32 v112, v61, v61
    v_sub_f32 v60, v84, v111
    v_fmac_f32 v109, v60, v60
    v_sub_f32 v61, v85, v111
    v_fmac_f32 v112, v61, v61
    v_sub_f32 v60, v86, v111
    v_fmac_f32 v109, v60, v60
    v_sub_f32 v61, v87, v111
    v_fmac_f32 v112, v61, v61
    v_sub_f32 v60, v88, v111
    v_fmac_f32 v109, v60, v60
    v_sub_f32 v61, v89, v111
    v_fmac_f32 v112, v61, v61
    v_sub_f32 v60, v90, v111
    v_fmac_f32 v109, v60, v60
    v_sub_f32 v61, v91, v111
    v_fmac_f32 v112, v61, v61
    v_sub_f32 v60, v92, v111
    v_fmac_f32 v109, v60, v60
    v_sub_f32 v61, v93, v111
    v_fmac_f32 v112, v61, v61
    v_sub_f32 v60, v94, v111
    v_fmac_f32 v109, v60, v60
    v_sub_f32 v61, v95, v111
    v_fmac_f32 v112, v61, v61
    v_sub_f32 v60, v96, v111
    v_fmac_f32 v109, v60, v60
    v_sub_f32 v61, v97, v111
    v_fmac_f32 v112, v61, v61
    v_sub_f32 v60, v98, v111
    v_fmac_f32 v109, v60, v60
    v_sub_f32 v61, v99, v111
    v_fmac_f32 v112, v61, v61
    v_add_f32 v109, v109, v112
    s_nop 1
    v_add_f32_dpp v109, v109, v109 quad_perm:[1,0,3,2] row_mask:0xf bank_mask:0xf
    s_nop 1
    v_add_f32_dpp v109, v109, v109 quad_perm:[2,3,0,1] row_mask:0xf bank_mask:0xf
    s_nop 1
    v_add_f32_dpp v109, v109, v109 row_half_mirror row_mask:0xf bank_mask:0xf
    s_nop 1
    v_add_f32_dpp v109, v109, v109 row_mirror row_mask:0xf bank_mask:0xf
    v_mov_b32 v110, v109
    s_nop 1
    v_permlane16_swap_b32 v109, v110
    v_add_f32 v109, v109, v110
    v_mul_f32 v109, 0x3acccccd, v109
    v_cvt_pk_bf16_f32 v110, v111, v109
    v_lshlrev_b32 v111, 16, v110
    v_and_b32 v109, 0xffff0000, v110
    v_add_f32 v109, 0x3727c5ac, v109
    v_cvt_pk_bf16_f32 v109, v109, v109
    v_lshlrev_b32 v109, 16, v109
    v_sqrt_f32 v109, v109
    v_sub_f32 v80, v80, v111
    v_sub_f32 v81, v81, v111
    v_sub_f32 v82, v82, v111
    v_sub_f32 v83, v83, v111
    v_sub_f32 v84, v84, v111
    v_sub_f32 v85, v85, v111
    v_sub_f32 v86, v86, v111
    v_sub_f32 v87, v87, v111
    v_sub_f32 v88, v88, v111
    v_sub_f32 v89, v89, v111
    v_sub_f32 v90, v90, v111
    v_sub_f32 v91, v91, v111
    v_sub_f32 v92, v92, v111
    v_sub_f32 v93, v93, v111
    v_sub_f32 v94, v94, v111
    v_sub_f32 v95, v95, v111
    v_sub_f32 v96, v96, v111
    v_sub_f32 v97, v97, v111
    v_sub_f32 v98, v98, v111
    v_sub_f32 v99, v99, v111
    v_cvt_pk_bf16_f32 v109, v109, v109
    v_lshlrev_b32 v109, 16, v109
    v_rcp_f32 v112, v109
    v_cvt_pk_bf16_f32 v60, v80, v81
    v_cvt_pk_bf16_f32 v61, v82, v83
    v_cvt_pk_bf16_f32 v62, v84, v85
    v_cvt_pk_bf16_f32 v63, v86, v87
    v_cvt_pk_bf16_f32 v64, v88, v89
    v_cvt_pk_bf16_f32 v65, v90, v91
    v_cvt_pk_bf16_f32 v66, v92, v93
    v_cvt_pk_bf16_f32 v67, v94, v95
    v_cvt_pk_bf16_f32 v68, v96, v97
    v_cvt_pk_bf16_f32 v69, v98, v99
    v_lshlrev_b32 v80, 16, v60
    v_and_b32 v81, 0xffff0000, v60
    v_lshlrev_b32 v82, 16, v61
    v_and_b32 v83, 0xffff0000, v61
    v_lshlrev_b32 v84, 16, v62
    v_and_b32 v85, 0xffff0000, v62
    v_lshlrev_b32 v86, 16, v63
    v_and_b32 v87, 0xffff0000, v63
    v_lshlrev_b32 v88, 16, v64
    v_and_b32 v89, 0xffff0000, v64
    v_lshlrev_b32 v90, 16, v65
    v_and_b32 v91, 0xffff0000, v65
    v_lshlrev_b32 v92, 16, v66
    v_and_b32 v93, 0xffff0000, v66
    v_lshlrev_b32 v94, 16, v67
    v_and_b32 v95, 0xffff0000, v67
    v_lshlrev_b32 v96, 16, v68
    v_and_b32 v97, 0xffff0000, v68
    v_lshlrev_b32 v98, 16, v69
    v_and_b32 v99, 0xffff0000, v69
    v_mul_f32 v80, v80, v112
    v_mul_f32 v81, v81, v112
    v_mul_f32 v82, v82, v112
    v_mul_f32 v83, v83, v112
    v_mul_f32 v84, v84, v112
    v_mul_f32 v85, v85, v112
    v_mul_f32 v86, v86, v112
    v_mul_f32 v87, v87, v112
    v_mul_f32 v88, v88, v112
    v_mul_f32 v89, v89, v112
    v_mul_f32 v90, v90, v112
    v_mul_f32 v91, v91, v112
    v_mul_f32 v92, v92, v112
    v_mul_f32 v93, v93, v112
    v_mul_f32 v94, v94, v112
    v_mul_f32 v95, v95, v112
    v_mul_f32 v96, v96, v112
    v_mul_f32 v97, v97, v112
    v_mul_f32 v98, v98, v112
    v_mul_f32 v99, v99, v112
    v_cvt_pk_bf16_f32 v60, v80, v81
    v_cvt_pk_bf16_f32 v61, v82, v83
    v_cvt_pk_bf16_f32 v62, v84, v85
    v_cvt_pk_bf16_f32 v63, v86, v87
    v_cvt_pk_bf16_f32 v64, v88, v89
    v_cvt_pk_bf16_f32 v65, v90, v91
    v_cvt_pk_bf16_f32 v66, v92, v93
    v_cvt_pk_bf16_f32 v67, v94, v95
    v_cvt_pk_bf16_f32 v68, v96, v97
    v_cvt_pk_bf16_f32 v69, v98, v99
    v_mov_b32 v109, 0
    v_dot2c_f32_bf16 v109, v60, v70
    v_dot2c_f32_bf16 v109, v61, v71
    v_dot2c_f32_bf16 v109, v62, v72
    v_dot2c_f32_bf16 v109, v63, v73
    v_dot2c_f32_bf16 v109, v64, v74
    v_dot2c_f32_bf16 v109, v65, v75
    v_dot2c_f32_bf16 v109, v66, v76
    v_dot2c_f32_bf16 v109, v67, v77
    v_dot2c_f32_bf16 v109, v68, v78
    v_dot2c_f32_bf16 v109, v69, v79
    s_nop 2
    s_nop 1
    v_add_f32_dpp v109, v109, v109 quad_perm:[1,0,3,2] row_mask:0xf bank_mask:0xf
    s_nop 1
    v_add_f32_dpp v109, v109, v109 quad_perm:[2,3,0,1] row_mask:0xf bank_mask:0xf
    s_nop 1
    v_add_f32_dpp v109, v109, v109 row_half_mirror row_mask:0xf bank_mask:0xf
    s_nop 1
    v_add_f32_dpp v109, v109, v109 row_mirror row_mask:0xf bank_mask:0xf
    v_mov_b32 v110, v109
    s_nop 1
    v_permlane16_swap_b32 v109, v110
    v_add_f32 v109, v109, v110
    v_cvt_pk_bf16_f32 v109, v109, v109
    v_lshlrev_b32 v109, 16, v109
    v_ashrrev_i32 v110, 31, v109
    v_or_b32 v110, 0x80000000, v110
    v_xor_b32 v109, v109, v110
    v_and_b32 v109, 0xffff0000, v109
    v_sub_u32 v110, 0xffff, v108
    v_or_b32 v62, v109, v110
    v_mov_b32 v60, v111
    v_mov_b32 v61, v112
    v_mov_b32 v63, 0
    v_lshlrev_b32 v110, 4, v108
    s_mov_b32 s40, 0x280000
    s_mov_b32 exec_lo, 1
    s_mov_b32 exec_hi, 1
    buffer_store_dwordx4 v[60:63], v110, s[76:79], s40 offen sc1
    s_mov_b64 exec, -1
    s_waitcnt vmcnt(14) lgkmcnt(0)
    s_barrier
    v_mfma_f32_16x16x32_bf16 v[100:103], a[48:51], v[32:35], v[100:103]
    ds_read_b64_tr_b16 a[0:1], v50 offset:16384
    v_mfma_f32_16x16x32_bf16 v[104:107], a[52:55], v[32:35], v[104:107]
    s_add_u32 m0, s39, 0
    s_mov_b32 s37, 1572864
    ds_read_b64_tr_b16 a[2:3], v50 offset:17408
    v_mfma_f32_16x16x32_bf16 v[116:119], a[48:51], a[80:83], v[116:119]
    buffer_load_dwordx4 v44, s[20:23], s37 offen offset:0 lds
    v_mfma_f32_16x16x32_bf16 v[148:151], a[48:51], a[84:87], v[148:151]
    ds_read_b128 a[32:35], v48 offset:8192
    v_mfma_f32_16x16x32_bf16 v[180:183], a[48:51], a[88:91], v[180:183]
    ds_read_b128 a[36:39], v48 offset:10240
    v_mfma_f32_16x16x32_bf16 v[212:215], a[48:51], a[92:95], v[212:215]
    ds_read_b128 a[40:43], v48 offset:12288
    v_mfma_f32_16x16x32_bf16 v[216:219], a[52:55], a[92:95], v[216:219]
    ds_read_b128 a[44:47], v48 offset:14336
    v_mfma_f32_16x16x32_bf16 v[184:187], a[52:55], a[88:91], v[184:187]
    buffer_load_dwordx4 v45, s[20:23], s37 offen offset:1024 lds
    v_mfma_f32_16x16x32_bf16 v[152:155], a[52:55], a[84:87], v[152:155]
    ds_read_b64_tr_b16 a[4:5], v51 offset:16384
    v_mfma_f32_16x16x32_bf16 v[120:123], a[52:55], a[80:83], v[120:123]
    ds_read_b64_tr_b16 a[6:7], v51 offset:17408
    v_mfma_f32_16x16x32_bf16 v[124:127], a[56:59], a[80:83], v[124:127]
    ds_read_b64_tr_b16 a[8:9], v52 offset:16384
    v_mfma_f32_16x16x32_bf16 v[156:159], a[56:59], a[84:87], v[156:159]
    ds_read_b64_tr_b16 a[10:11], v52 offset:17408
    v_mfma_f32_16x16x32_bf16 v[188:191], a[56:59], a[88:91], v[188:191]
    buffer_load_dwordx4 v46, s[20:23], s37 offen offset:2048 lds
    v_mfma_f32_16x16x32_bf16 v[220:223], a[56:59], a[92:95], v[220:223]
    ds_read_b64_tr_b16 a[12:13], v53 offset:16384
    v_mfma_f32_16x16x32_bf16 v[224:227], a[60:63], a[92:95], v[224:227]
    ds_read_b64_tr_b16 a[14:15], v53 offset:17408
    v_mfma_f32_16x16x32_bf16 v[192:195], a[60:63], a[88:91], v[192:195]
    ds_read_b64_tr_b16 a[16:17], v54 offset:16384
    v_mfma_f32_16x16x32_bf16 v[160:163], a[60:63], a[84:87], v[160:163]
    ds_read_b64_tr_b16 a[18:19], v54 offset:17408
    v_mfma_f32_16x16x32_bf16 v[128:131], a[60:63], a[80:83], v[128:131]
    buffer_load_dwordx4 v47, s[20:23], s37 offen offset:3072 lds
    v_mfma_f32_16x16x32_bf16 v[132:135], a[64:67], a[80:83], v[132:135]
    ds_read_b64_tr_b16 a[20:21], v55 offset:16384
    v_mfma_f32_16x16x32_bf16 v[164:167], a[64:67], a[84:87], v[164:167]
    ds_read_b64_tr_b16 a[22:23], v55 offset:17408
    v_mfma_f32_16x16x32_bf16 v[196:199], a[64:67], a[88:91], v[196:199]
    ds_read_b64_tr_b16 a[24:25], v56 offset:16384
    v_mfma_f32_16x16x32_bf16 v[228:231], a[64:67], a[92:95], v[228:231]
    s_add_u32 m0, s38, 0
    s_mov_b32 s36, 384
    ds_read_b64_tr_b16 a[26:27], v56 offset:17408
    v_mfma_f32_16x16x32_bf16 v[232:235], a[68:71], a[92:95], v[232:235]
    buffer_load_dwordx4 v36, s[16:19], s36 offen offset:0 lds
    v_mfma_f32_16x16x32_bf16 v[200:203], a[68:71], a[88:91], v[200:203]
    ds_read_b64_tr_b16 a[28:29], v57 offset:16384
    v_mfma_f32_16x16x32_bf16 v[168:171], a[68:71], a[84:87], v[168:171]
    ds_read_b64_tr_b16 a[30:31], v57 offset:17408
    v_mfma_f32_16x16x32_bf16 v[136:139], a[68:71], a[80:83], v[136:139]
    v_mfma_f32_16x16x32_bf16 v[140:143], a[72:75], a[80:83], v[140:143]
    v_mfma_f32_16x16x32_bf16 v[172:175], a[72:75], a[84:87], v[172:175]
    buffer_load_dwordx4 v37, s[16:19], s36 offen offset:1024 lds
    v_mfma_f32_16x16x32_bf16 v[204:207], a[72:75], a[88:91], v[204:207]
    v_mfma_f32_16x16x32_bf16 v[236:239], a[72:75], a[92:95], v[236:239]
    v_mfma_f32_16x16x32_bf16 v[240:243], a[76:79], a[92:95], v[240:243]
    v_mfma_f32_16x16x32_bf16 v[208:211], a[76:79], a[88:91], v[208:211]
    v_mfma_f32_16x16x32_bf16 v[176:179], a[76:79], a[84:87], v[176:179]
    v_mfma_f32_16x16x32_bf16 v[144:147], a[76:79], a[80:83], v[144:147]
    s_waitcnt lgkmcnt(0)
    v_mfma_f32_16x16x32_bf16 v[100:103], a[0:3], v[32:35], v[100:103]
    ds_read_b64_tr_b16 a[48:49], v50 offset:24576
    v_mfma_f32_16x16x32_bf16 v[104:107], a[4:7], v[32:35], v[104:107]
    ds_read_b64_tr_b16 a[50:51], v50 offset:25600
    v_mfma_f32_16x16x32_bf16 v[116:119], a[0:3], a[32:35], v[116:119]
    buffer_load_dwordx4 v38, s[16:19], s36 offen offset:2048 lds
    v_mfma_f32_16x16x32_bf16 v[148:151], a[0:3], a[36:39], v[148:151]
    ds_read_b128 a[80:83], v49 offset:8192
    v_mfma_f32_16x16x32_bf16 v[180:183], a[0:3], a[40:43], v[180:183]
    ds_read_b128 a[84:87], v49 offset:10240
    v_mfma_f32_16x16x32_bf16 v[212:215], a[0:3], a[44:47], v[212:215]
    ds_read_b128 a[88:91], v49 offset:12288
    v_mfma_f32_16x16x32_bf16 v[216:219], a[4:7], a[44:47], v[216:219]
    ds_read_b128 a[92:95], v49 offset:14336
    v_mfma_f32_16x16x32_bf16 v[184:187], a[4:7], a[40:43], v[184:187]
    buffer_load_dwordx4 v39, s[16:19], s36 offen offset:3072 lds
    v_mfma_f32_16x16x32_bf16 v[152:155], a[4:7], a[36:39], v[152:155]
    ds_read_b64_tr_b16 a[52:53], v51 offset:24576
    v_mfma_f32_16x16x32_bf16 v[120:123], a[4:7], a[32:35], v[120:123]
    ds_read_b64_tr_b16 a[54:55], v51 offset:25600
    v_mfma_f32_16x16x32_bf16 v[124:127], a[8:11], a[32:35], v[124:127]
    ds_read_b64_tr_b16 a[56:57], v52 offset:24576
    v_mfma_f32_16x16x32_bf16 v[156:159], a[8:11], a[36:39], v[156:159]
    s_add_u32 m0, s38, 4096
    ds_read_b64_tr_b16 a[58:59], v52 offset:25600
    v_mfma_f32_16x16x32_bf16 v[188:191], a[8:11], a[40:43], v[188:191]
    buffer_load_dwordx4 v40, s[16:19], s36 offen offset:0 lds
    v_mfma_f32_16x16x32_bf16 v[220:223], a[8:11], a[44:47], v[220:223]
    ds_read_b64_tr_b16 a[60:61], v53 offset:24576
    v_mfma_f32_16x16x32_bf16 v[224:227], a[12:15], a[44:47], v[224:227]
    ds_read_b64_tr_b16 a[62:63], v53 offset:25600
    v_mfma_f32_16x16x32_bf16 v[192:195], a[12:15], a[40:43], v[192:195]
    ds_read_b64_tr_b16 a[64:65], v54 offset:24576
    v_mfma_f32_16x16x32_bf16 v[160:163], a[12:15], a[36:39], v[160:163]
    ds_read_b64_tr_b16 a[66:67], v54 offset:25600
    v_mfma_f32_16x16x32_bf16 v[128:131], a[12:15], a[32:35], v[128:131]
    buffer_load_dwordx4 v41, s[16:19], s36 offen offset:1024 lds
    v_mfma_f32_16x16x32_bf16 v[132:135], a[16:19], a[32:35], v[132:135]
    ds_read_b64_tr_b16 a[68:69], v55 offset:24576
    v_mfma_f32_16x16x32_bf16 v[164:167], a[16:19], a[36:39], v[164:167]
    ds_read_b64_tr_b16 a[70:71], v55 offset:25600
    v_mfma_f32_16x16x32_bf16 v[196:199], a[16:19], a[40:43], v[196:199]
    ds_read_b64_tr_b16 a[72:73], v56 offset:24576
    v_mfma_f32_16x16x32_bf16 v[228:231], a[16:19], a[44:47], v[228:231]
    ds_read_b64_tr_b16 a[74:75], v56 offset:25600
    v_mfma_f32_16x16x32_bf16 v[232:235], a[20:23], a[44:47], v[232:235]
    buffer_load_dwordx4 v42, s[16:19], s36 offen offset:2048 lds
    v_mfma_f32_16x16x32_bf16 v[200:203], a[20:23], a[40:43], v[200:203]
    ds_read_b64_tr_b16 a[76:77], v57 offset:24576
    v_mfma_f32_16x16x32_bf16 v[168:171], a[20:23], a[36:39], v[168:171]
    ds_read_b64_tr_b16 a[78:79], v57 offset:25600
    v_mfma_f32_16x16x32_bf16 v[136:139], a[20:23], a[32:35], v[136:139]
    v_mfma_f32_16x16x32_bf16 v[140:143], a[24:27], a[32:35], v[140:143]
    v_mfma_f32_16x16x32_bf16 v[172:175], a[24:27], a[36:39], v[172:175]
    buffer_load_dwordx4 v43, s[16:19], s36 offen offset:3072 lds
    v_mfma_f32_16x16x32_bf16 v[204:207], a[24:27], a[40:43], v[204:207]
    v_mfma_f32_16x16x32_bf16 v[236:239], a[24:27], a[44:47], v[236:239]
    v_mfma_f32_16x16x32_bf16 v[240:243], a[28:31], a[44:47], v[240:243]
    v_mfma_f32_16x16x32_bf16 v[208:211], a[28:31], a[40:43], v[208:211]
    v_mfma_f32_16x16x32_bf16 v[176:179], a[28:31], a[36:39], v[176:179]
    v_mfma_f32_16x16x32_bf16 v[144:147], a[28:31], a[32:35], v[144:147]
    s_waitcnt vmcnt(14) lgkmcnt(0)
    s_barrier
    v_mfma_f32_16x16x32_bf16 v[100:103], a[48:51], v[32:35], v[100:103]
    ds_read_b64_tr_b16 a[0:1], v50 offset:32768
    v_mfma_f32_16x16x32_bf16 v[104:107], a[52:55], v[32:35], v[104:107]
    s_add_u32 m0, s39, 16384
    s_mov_b32 s37, 2097152
    ds_read_b64_tr_b16 a[2:3], v50 offset:33792
    v_mfma_f32_16x16x32_bf16 v[116:119], a[48:51], a[80:83], v[116:119]
    buffer_load_dwordx4 v44, s[20:23], s37 offen offset:0 lds
    v_mfma_f32_16x16x32_bf16 v[148:151], a[48:51], a[84:87], v[148:151]
    ds_read_b128 a[32:35], v48 offset:16384
    v_mfma_f32_16x16x32_bf16 v[180:183], a[48:51], a[88:91], v[180:183]
    ds_read_b128 a[36:39], v48 offset:18432
    v_mfma_f32_16x16x32_bf16 v[212:215], a[48:51], a[92:95], v[212:215]
    ds_read_b128 a[40:43], v48 offset:20480
    v_mfma_f32_16x16x32_bf16 v[216:219], a[52:55], a[92:95], v[216:219]
    ds_read_b128 a[44:47], v48 offset:22528
    v_mfma_f32_16x16x32_bf16 v[184:187], a[52:55], a[88:91], v[184:187]
    buffer_load_dwordx4 v45, s[20:23], s37 offen offset:1024 lds
    v_mfma_f32_16x16x32_bf16 v[152:155], a[52:55], a[84:87], v[152:155]
    ds_read_b64_tr_b16 a[4:5], v51 offset:32768
    v_mfma_f32_16x16x32_bf16 v[120:123], a[52:55], a[80:83], v[120:123]
    ds_read_b64_tr_b16 a[6:7], v51 offset:33792
    v_mfma_f32_16x16x32_bf16 v[124:127], a[56:59], a[80:83], v[124:127]
    ds_read_b64_tr_b16 a[8:9], v52 offset:32768
    v_mfma_f32_16x16x32_bf16 v[156:159], a[56:59], a[84:87], v[156:159]
    ds_read_b64_tr_b16 a[10:11], v52 offset:33792
    v_mfma_f32_16x16x32_bf16 v[188:191], a[56:59], a[88:91], v[188:191]
    buffer_load_dwordx4 v46, s[20:23], s37 offen offset:2048 lds
    v_mfma_f32_16x16x32_bf16 v[220:223], a[56:59], a[92:95], v[220:223]
    ds_read_b64_tr_b16 a[12:13], v53 offset:32768
    v_mfma_f32_16x16x32_bf16 v[224:227], a[60:63], a[92:95], v[224:227]
    ds_read_b64_tr_b16 a[14:15], v53 offset:33792
    v_mfma_f32_16x16x32_bf16 v[192:195], a[60:63], a[88:91], v[192:195]
    ds_read_b64_tr_b16 a[16:17], v54 offset:32768
    v_mfma_f32_16x16x32_bf16 v[160:163], a[60:63], a[84:87], v[160:163]
    ds_read_b64_tr_b16 a[18:19], v54 offset:33792
    v_mfma_f32_16x16x32_bf16 v[128:131], a[60:63], a[80:83], v[128:131]
    buffer_load_dwordx4 v47, s[20:23], s37 offen offset:3072 lds
    v_mfma_f32_16x16x32_bf16 v[132:135], a[64:67], a[80:83], v[132:135]
    ds_read_b64_tr_b16 a[20:21], v55 offset:32768
    v_mfma_f32_16x16x32_bf16 v[164:167], a[64:67], a[84:87], v[164:167]
    ds_read_b64_tr_b16 a[22:23], v55 offset:33792
    v_mfma_f32_16x16x32_bf16 v[196:199], a[64:67], a[88:91], v[196:199]
    ds_read_b64_tr_b16 a[24:25], v56 offset:32768
    v_mfma_f32_16x16x32_bf16 v[228:231], a[64:67], a[92:95], v[228:231]
    s_add_u32 m0, s38, 8192
    s_mov_b32 s36, 512
    ds_read_b64_tr_b16 a[26:27], v56 offset:33792
    v_mfma_f32_16x16x32_bf16 v[232:235], a[68:71], a[92:95], v[232:235]
    buffer_load_dwordx4 v36, s[16:19], s36 offen offset:0 lds
    v_mfma_f32_16x16x32_bf16 v[200:203], a[68:71], a[88:91], v[200:203]
    ds_read_b64_tr_b16 a[28:29], v57 offset:32768
    v_mfma_f32_16x16x32_bf16 v[168:171], a[68:71], a[84:87], v[168:171]
    ds_read_b64_tr_b16 a[30:31], v57 offset:33792
    v_mfma_f32_16x16x32_bf16 v[136:139], a[68:71], a[80:83], v[136:139]
    v_mfma_f32_16x16x32_bf16 v[140:143], a[72:75], a[80:83], v[140:143]
    v_mfma_f32_16x16x32_bf16 v[172:175], a[72:75], a[84:87], v[172:175]
    buffer_load_dwordx4 v37, s[16:19], s36 offen offset:1024 lds
    v_mfma_f32_16x16x32_bf16 v[204:207], a[72:75], a[88:91], v[204:207]
    v_mfma_f32_16x16x32_bf16 v[236:239], a[72:75], a[92:95], v[236:239]
    v_mfma_f32_16x16x32_bf16 v[240:243], a[76:79], a[92:95], v[240:243]
    v_mfma_f32_16x16x32_bf16 v[208:211], a[76:79], a[88:91], v[208:211]
    v_mfma_f32_16x16x32_bf16 v[176:179], a[76:79], a[84:87], v[176:179]
    v_mfma_f32_16x16x32_bf16 v[144:147], a[76:79], a[80:83], v[144:147]
    s_waitcnt lgkmcnt(0)
    v_mfma_f32_16x16x32_bf16 v[100:103], a[0:3], v[32:35], v[100:103]
    ds_read_b64_tr_b16 a[48:49], v50 offset:40960
    v_mfma_f32_16x16x32_bf16 v[104:107], a[4:7], v[32:35], v[104:107]
    ds_read_b64_tr_b16 a[50:51], v50 offset:41984
    v_mfma_f32_16x16x32_bf16 v[116:119], a[0:3], a[32:35], v[116:119]
    buffer_load_dwordx4 v38, s[16:19], s36 offen offset:2048 lds
    v_mfma_f32_16x16x32_bf16 v[148:151], a[0:3], a[36:39], v[148:151]
    ds_read_b128 a[80:83], v49 offset:16384
    v_mfma_f32_16x16x32_bf16 v[180:183], a[0:3], a[40:43], v[180:183]
    ds_read_b128 a[84:87], v49 offset:18432
    v_mfma_f32_16x16x32_bf16 v[212:215], a[0:3], a[44:47], v[212:215]
    ds_read_b128 a[88:91], v49 offset:20480
    v_mfma_f32_16x16x32_bf16 v[216:219], a[4:7], a[44:47], v[216:219]
    ds_read_b128 a[92:95], v49 offset:22528
    v_mfma_f32_16x16x32_bf16 v[184:187], a[4:7], a[40:43], v[184:187]
    buffer_load_dwordx4 v39, s[16:19], s36 offen offset:3072 lds
    v_mfma_f32_16x16x32_bf16 v[152:155], a[4:7], a[36:39], v[152:155]
    ds_read_b64_tr_b16 a[52:53], v51 offset:40960
    v_mfma_f32_16x16x32_bf16 v[120:123], a[4:7], a[32:35], v[120:123]
    ds_read_b64_tr_b16 a[54:55], v51 offset:41984
    v_mfma_f32_16x16x32_bf16 v[124:127], a[8:11], a[32:35], v[124:127]
    ds_read_b64_tr_b16 a[56:57], v52 offset:40960
    v_mfma_f32_16x16x32_bf16 v[156:159], a[8:11], a[36:39], v[156:159]
    s_add_u32 m0, s38, 12288
    ds_read_b64_tr_b16 a[58:59], v52 offset:41984
    v_mfma_f32_16x16x32_bf16 v[188:191], a[8:11], a[40:43], v[188:191]
    buffer_load_dwordx4 v40, s[16:19], s36 offen offset:0 lds
    v_mfma_f32_16x16x32_bf16 v[220:223], a[8:11], a[44:47], v[220:223]
    ds_read_b64_tr_b16 a[60:61], v53 offset:40960
    v_mfma_f32_16x16x32_bf16 v[224:227], a[12:15], a[44:47], v[224:227]
    ds_read_b64_tr_b16 a[62:63], v53 offset:41984
    v_mfma_f32_16x16x32_bf16 v[192:195], a[12:15], a[40:43], v[192:195]
    ds_read_b64_tr_b16 a[64:65], v54 offset:40960
    v_mfma_f32_16x16x32_bf16 v[160:163], a[12:15], a[36:39], v[160:163]
    ds_read_b64_tr_b16 a[66:67], v54 offset:41984
    v_mfma_f32_16x16x32_bf16 v[128:131], a[12:15], a[32:35], v[128:131]
    buffer_load_dwordx4 v41, s[16:19], s36 offen offset:1024 lds
    v_mfma_f32_16x16x32_bf16 v[132:135], a[16:19], a[32:35], v[132:135]
    ds_read_b64_tr_b16 a[68:69], v55 offset:40960
    v_mfma_f32_16x16x32_bf16 v[164:167], a[16:19], a[36:39], v[164:167]
    ds_read_b64_tr_b16 a[70:71], v55 offset:41984
    v_mfma_f32_16x16x32_bf16 v[196:199], a[16:19], a[40:43], v[196:199]
    ds_read_b64_tr_b16 a[72:73], v56 offset:40960
    v_mfma_f32_16x16x32_bf16 v[228:231], a[16:19], a[44:47], v[228:231]
    ds_read_b64_tr_b16 a[74:75], v56 offset:41984
    v_mfma_f32_16x16x32_bf16 v[232:235], a[20:23], a[44:47], v[232:235]
    buffer_load_dwordx4 v42, s[16:19], s36 offen offset:2048 lds
    v_mfma_f32_16x16x32_bf16 v[200:203], a[20:23], a[40:43], v[200:203]
    ds_read_b64_tr_b16 a[76:77], v57 offset:40960
    v_mfma_f32_16x16x32_bf16 v[168:171], a[20:23], a[36:39], v[168:171]
    ds_read_b64_tr_b16 a[78:79], v57 offset:41984
    v_mfma_f32_16x16x32_bf16 v[136:139], a[20:23], a[32:35], v[136:139]
    v_mfma_f32_16x16x32_bf16 v[140:143], a[24:27], a[32:35], v[140:143]
    v_mfma_f32_16x16x32_bf16 v[172:175], a[24:27], a[36:39], v[172:175]
    buffer_load_dwordx4 v43, s[16:19], s36 offen offset:3072 lds
    v_mfma_f32_16x16x32_bf16 v[204:207], a[24:27], a[40:43], v[204:207]
    v_mfma_f32_16x16x32_bf16 v[236:239], a[24:27], a[44:47], v[236:239]
    v_mfma_f32_16x16x32_bf16 v[240:243], a[28:31], a[44:47], v[240:243]
    v_mfma_f32_16x16x32_bf16 v[208:211], a[28:31], a[40:43], v[208:211]
    v_mfma_f32_16x16x32_bf16 v[176:179], a[28:31], a[36:39], v[176:179]
    v_mfma_f32_16x16x32_bf16 v[144:147], a[28:31], a[32:35], v[144:147]
    s_waitcnt vmcnt(12) lgkmcnt(0)
    s_barrier
    s_cmp_lg_u32 s5, 0
    s_cbranch_scc1 L_signalled
    s_mov_b64 exec, 1
    buffer_atomic_add v27, off, s[92:95], s74 sc1
    s_mov_b64 exec, -1
L_signalled:
    v_mfma_f32_16x16x32_bf16 v[100:103], a[48:51], v[32:35], v[100:103]
    ds_read_b64_tr_b16 a[0:1], v50 offset:0
    v_mfma_f32_16x16x32_bf16 v[104:107], a[52:55], v[32:35], v[104:107]
    s_add_u32 m0, s39, 32768
    s_mov_b32 s37, 2621440
    ds_read_b64_tr_b16 a[2:3], v50 offset:1024
    v_mfma_f32_16x16x32_bf16 v[116:119], a[48:51], a[80:83], v[116:119]
    buffer_load_dwordx4 v44, s[20:23], s37 offen offset:0 lds
    v_mfma_f32_16x16x32_bf16 v[148:151], a[48:51], a[84:87], v[148:151]
    ds_read_b128 a[32:35], v48 offset:0
    v_mfma_f32_16x16x32_bf16 v[180:183], a[48:51], a[88:91], v[180:183]
    ds_read_b128 a[36:39], v48 offset:2048
    v_mfma_f32_16x16x32_bf16 v[212:215], a[48:51], a[92:95], v[212:215]
    ds_read_b128 a[40:43], v48 offset:4096
    v_mfma_f32_16x16x32_bf16 v[216:219], a[52:55], a[92:95], v[216:219]
    ds_read_b128 a[44:47], v48 offset:6144
    v_mfma_f32_16x16x32_bf16 v[184:187], a[52:55], a[88:91], v[184:187]
    buffer_load_dwordx4 v45, s[20:23], s37 offen offset:1024 lds
    v_mfma_f32_16x16x32_bf16 v[152:155], a[52:55], a[84:87], v[152:155]
    ds_read_b64_tr_b16 a[4:5], v51 offset:0
    v_mfma_f32_16x16x32_bf16 v[120:123], a[52:55], a[80:83], v[120:123]
    ds_read_b64_tr_b16 a[6:7], v51 offset:1024
    v_mfma_f32_16x16x32_bf16 v[124:127], a[56:59], a[80:83], v[124:127]
    ds_read_b64_tr_b16 a[8:9], v52 offset:0
    v_mfma_f32_16x16x32_bf16 v[156:159], a[56:59], a[84:87], v[156:159]
    ds_read_b64_tr_b16 a[10:11], v52 offset:1024
    v_mfma_f32_16x16x32_bf16 v[188:191], a[56:59], a[88:91], v[188:191]
    buffer_load_dwordx4 v46, s[20:23], s37 offen offset:2048 lds
    v_mfma_f32_16x16x32_bf16 v[220:223], a[56:59], a[92:95], v[220:223]
    ds_read_b64_tr_b16 a[12:13], v53 offset:0
    v_mfma_f32_16x16x32_bf16 v[224:227], a[60:63], a[92:95], v[224:227]
    ds_read_b64_tr_b16 a[14:15], v53 offset:1024
    v_mfma_f32_16x16x32_bf16 v[192:195], a[60:63], a[88:91], v[192:195]
    ds_read_b64_tr_b16 a[16:17], v54 offset:0
    v_mfma_f32_16x16x32_bf16 v[160:163], a[60:63], a[84:87], v[160:163]
    ds_read_b64_tr_b16 a[18:19], v54 offset:1024
    v_mfma_f32_16x16x32_bf16 v[128:131], a[60:63], a[80:83], v[128:131]
    buffer_load_dwordx4 v47, s[20:23], s37 offen offset:3072 lds
    v_mfma_f32_16x16x32_bf16 v[132:135], a[64:67], a[80:83], v[132:135]
    ds_read_b64_tr_b16 a[20:21], v55 offset:0
    v_mfma_f32_16x16x32_bf16 v[164:167], a[64:67], a[84:87], v[164:167]
    ds_read_b64_tr_b16 a[22:23], v55 offset:1024
    v_mfma_f32_16x16x32_bf16 v[196:199], a[64:67], a[88:91], v[196:199]
    ds_read_b64_tr_b16 a[24:25], v56 offset:0
    v_mfma_f32_16x16x32_bf16 v[228:231], a[64:67], a[92:95], v[228:231]
    s_add_u32 m0, s38, 16384
    s_mov_b32 s36, 640
    ds_read_b64_tr_b16 a[26:27], v56 offset:1024
    v_mfma_f32_16x16x32_bf16 v[232:235], a[68:71], a[92:95], v[232:235]
    buffer_load_dwordx4 v36, s[16:19], s36 offen offset:0 lds
    v_mfma_f32_16x16x32_bf16 v[200:203], a[68:71], a[88:91], v[200:203]
    ds_read_b64_tr_b16 a[28:29], v57 offset:0
    v_mfma_f32_16x16x32_bf16 v[168:171], a[68:71], a[84:87], v[168:171]
    ds_read_b64_tr_b16 a[30:31], v57 offset:1024
    v_mfma_f32_16x16x32_bf16 v[136:139], a[68:71], a[80:83], v[136:139]
    v_mfma_f32_16x16x32_bf16 v[140:143], a[72:75], a[80:83], v[140:143]
    v_mfma_f32_16x16x32_bf16 v[172:175], a[72:75], a[84:87], v[172:175]
    buffer_load_dwordx4 v37, s[16:19], s36 offen offset:1024 lds
    v_mfma_f32_16x16x32_bf16 v[204:207], a[72:75], a[88:91], v[204:207]
    v_mfma_f32_16x16x32_bf16 v[236:239], a[72:75], a[92:95], v[236:239]
    v_mfma_f32_16x16x32_bf16 v[240:243], a[76:79], a[92:95], v[240:243]
    v_mfma_f32_16x16x32_bf16 v[208:211], a[76:79], a[88:91], v[208:211]
    v_mfma_f32_16x16x32_bf16 v[176:179], a[76:79], a[84:87], v[176:179]
    v_mfma_f32_16x16x32_bf16 v[144:147], a[76:79], a[80:83], v[144:147]
    s_waitcnt lgkmcnt(0)
    v_mfma_f32_16x16x32_bf16 v[100:103], a[0:3], v[32:35], v[100:103]
    ds_read_b64_tr_b16 a[48:49], v50 offset:8192
    v_mfma_f32_16x16x32_bf16 v[104:107], a[4:7], v[32:35], v[104:107]
    ds_read_b64_tr_b16 a[50:51], v50 offset:9216
    v_mfma_f32_16x16x32_bf16 v[116:119], a[0:3], a[32:35], v[116:119]
    buffer_load_dwordx4 v38, s[16:19], s36 offen offset:2048 lds
    v_mfma_f32_16x16x32_bf16 v[148:151], a[0:3], a[36:39], v[148:151]
    ds_read_b128 a[80:83], v49 offset:0
    v_mfma_f32_16x16x32_bf16 v[180:183], a[0:3], a[40:43], v[180:183]
    ds_read_b128 a[84:87], v49 offset:2048
    v_mfma_f32_16x16x32_bf16 v[212:215], a[0:3], a[44:47], v[212:215]
    ds_read_b128 a[88:91], v49 offset:4096
    v_mfma_f32_16x16x32_bf16 v[216:219], a[4:7], a[44:47], v[216:219]
    ds_read_b128 a[92:95], v49 offset:6144
    v_mfma_f32_16x16x32_bf16 v[184:187], a[4:7], a[40:43], v[184:187]
    buffer_load_dwordx4 v39, s[16:19], s36 offen offset:3072 lds
    v_mfma_f32_16x16x32_bf16 v[152:155], a[4:7], a[36:39], v[152:155]
    ds_read_b64_tr_b16 a[52:53], v51 offset:8192
    v_mfma_f32_16x16x32_bf16 v[120:123], a[4:7], a[32:35], v[120:123]
    ds_read_b64_tr_b16 a[54:55], v51 offset:9216
    v_mfma_f32_16x16x32_bf16 v[124:127], a[8:11], a[32:35], v[124:127]
    ds_read_b64_tr_b16 a[56:57], v52 offset:8192
    v_mfma_f32_16x16x32_bf16 v[156:159], a[8:11], a[36:39], v[156:159]
    s_add_u32 m0, s38, 20480
    ds_read_b64_tr_b16 a[58:59], v52 offset:9216
    v_mfma_f32_16x16x32_bf16 v[188:191], a[8:11], a[40:43], v[188:191]
    buffer_load_dwordx4 v40, s[16:19], s36 offen offset:0 lds
    v_mfma_f32_16x16x32_bf16 v[220:223], a[8:11], a[44:47], v[220:223]
    ds_read_b64_tr_b16 a[60:61], v53 offset:8192
    v_mfma_f32_16x16x32_bf16 v[224:227], a[12:15], a[44:47], v[224:227]
    ds_read_b64_tr_b16 a[62:63], v53 offset:9216
    v_mfma_f32_16x16x32_bf16 v[192:195], a[12:15], a[40:43], v[192:195]
    ds_read_b64_tr_b16 a[64:65], v54 offset:8192
    v_mfma_f32_16x16x32_bf16 v[160:163], a[12:15], a[36:39], v[160:163]
    ds_read_b64_tr_b16 a[66:67], v54 offset:9216
    v_mfma_f32_16x16x32_bf16 v[128:131], a[12:15], a[32:35], v[128:131]
    buffer_load_dwordx4 v41, s[16:19], s36 offen offset:1024 lds
    v_mfma_f32_16x16x32_bf16 v[132:135], a[16:19], a[32:35], v[132:135]
    ds_read_b64_tr_b16 a[68:69], v55 offset:8192
    v_mfma_f32_16x16x32_bf16 v[164:167], a[16:19], a[36:39], v[164:167]
    ds_read_b64_tr_b16 a[70:71], v55 offset:9216
    v_mfma_f32_16x16x32_bf16 v[196:199], a[16:19], a[40:43], v[196:199]
    ds_read_b64_tr_b16 a[72:73], v56 offset:8192
    v_mfma_f32_16x16x32_bf16 v[228:231], a[16:19], a[44:47], v[228:231]
    ds_read_b64_tr_b16 a[74:75], v56 offset:9216
    v_mfma_f32_16x16x32_bf16 v[232:235], a[20:23], a[44:47], v[232:235]
    buffer_load_dwordx4 v42, s[16:19], s36 offen offset:2048 lds
    v_mfma_f32_16x16x32_bf16 v[200:203], a[20:23], a[40:43], v[200:203]
    ds_read_b64_tr_b16 a[76:77], v57 offset:8192
    v_mfma_f32_16x16x32_bf16 v[168:171], a[20:23], a[36:39], v[168:171]
    ds_read_b64_tr_b16 a[78:79], v57 offset:9216
    v_mfma_f32_16x16x32_bf16 v[136:139], a[20:23], a[32:35], v[136:139]
    v_mfma_f32_16x16x32_bf16 v[140:143], a[24:27], a[32:35], v[140:143]
    v_mfma_f32_16x16x32_bf16 v[172:175], a[24:27], a[36:39], v[172:175]
    buffer_load_dwordx4 v43, s[16:19], s36 offen offset:3072 lds
    v_mfma_f32_16x16x32_bf16 v[204:207], a[24:27], a[40:43], v[204:207]
    v_mfma_f32_16x16x32_bf16 v[236:239], a[24:27], a[44:47], v[236:239]
    v_mfma_f32_16x16x32_bf16 v[240:243], a[28:31], a[44:47], v[240:243]
    v_mfma_f32_16x16x32_bf16 v[208:211], a[28:31], a[40:43], v[208:211]
    v_mfma_f32_16x16x32_bf16 v[176:179], a[28:31], a[36:39], v[176:179]
    v_mfma_f32_16x16x32_bf16 v[144:147], a[28:31], a[32:35], v[144:147]
    s_waitcnt vmcnt(12) lgkmcnt(0)
    s_barrier
    v_mfma_f32_16x16x32_bf16 v[100:103], a[48:51], v[32:35], v[100:103]
    ds_read_b64_tr_b16 a[0:1], v50 offset:16384
    v_mfma_f32_16x16x32_bf16 v[104:107], a[52:55], v[32:35], v[104:107]
    s_add_u32 m0, s39, 0
    s_mov_b32 s37, 3145728
    ds_read_b64_tr_b16 a[2:3], v50 offset:17408
    v_mfma_f32_16x16x32_bf16 v[116:119], a[48:51], a[80:83], v[116:119]
    buffer_load_dwordx4 v44, s[20:23], s37 offen offset:0 lds
    v_mfma_f32_16x16x32_bf16 v[148:151], a[48:51], a[84:87], v[148:151]
    ds_read_b128 a[32:35], v48 offset:8192
    v_mfma_f32_16x16x32_bf16 v[180:183], a[48:51], a[88:91], v[180:183]
    ds_read_b128 a[36:39], v48 offset:10240
    v_mfma_f32_16x16x32_bf16 v[212:215], a[48:51], a[92:95], v[212:215]
    ds_read_b128 a[40:43], v48 offset:12288
    v_mfma_f32_16x16x32_bf16 v[216:219], a[52:55], a[92:95], v[216:219]
    ds_read_b128 a[44:47], v48 offset:14336
    v_mfma_f32_16x16x32_bf16 v[184:187], a[52:55], a[88:91], v[184:187]
    buffer_load_dwordx4 v45, s[20:23], s37 offen offset:1024 lds
    v_mfma_f32_16x16x32_bf16 v[152:155], a[52:55], a[84:87], v[152:155]
    ds_read_b64_tr_b16 a[4:5], v51 offset:16384
    v_mfma_f32_16x16x32_bf16 v[120:123], a[52:55], a[80:83], v[120:123]
    ds_read_b64_tr_b16 a[6:7], v51 offset:17408
    v_mfma_f32_16x16x32_bf16 v[124:127], a[56:59], a[80:83], v[124:127]
    ds_read_b64_tr_b16 a[8:9], v52 offset:16384
    v_mfma_f32_16x16x32_bf16 v[156:159], a[56:59], a[84:87], v[156:159]
    ds_read_b64_tr_b16 a[10:11], v52 offset:17408
    v_mfma_f32_16x16x32_bf16 v[188:191], a[56:59], a[88:91], v[188:191]
    buffer_load_dwordx4 v46, s[20:23], s37 offen offset:2048 lds
    v_mfma_f32_16x16x32_bf16 v[220:223], a[56:59], a[92:95], v[220:223]
    ds_read_b64_tr_b16 a[12:13], v53 offset:16384
    v_mfma_f32_16x16x32_bf16 v[224:227], a[60:63], a[92:95], v[224:227]
    ds_read_b64_tr_b16 a[14:15], v53 offset:17408
    v_mfma_f32_16x16x32_bf16 v[192:195], a[60:63], a[88:91], v[192:195]
    ds_read_b64_tr_b16 a[16:17], v54 offset:16384
    v_mfma_f32_16x16x32_bf16 v[160:163], a[60:63], a[84:87], v[160:163]
    ds_read_b64_tr_b16 a[18:19], v54 offset:17408
    v_mfma_f32_16x16x32_bf16 v[128:131], a[60:63], a[80:83], v[128:131]
    buffer_load_dwordx4 v47, s[20:23], s37 offen offset:3072 lds
    v_mfma_f32_16x16x32_bf16 v[132:135], a[64:67], a[80:83], v[132:135]
    ds_read_b64_tr_b16 a[20:21], v55 offset:16384
    v_mfma_f32_16x16x32_bf16 v[164:167], a[64:67], a[84:87], v[164:167]
    ds_read_b64_tr_b16 a[22:23], v55 offset:17408
    v_mfma_f32_16x16x32_bf16 v[196:199], a[64:67], a[88:91], v[196:199]
    ds_read_b64_tr_b16 a[24:25], v56 offset:16384
    v_mfma_f32_16x16x32_bf16 v[228:231], a[64:67], a[92:95], v[228:231]
    s_add_u32 m0, s38, 0
    s_mov_b32 s36, 768
    ds_read_b64_tr_b16 a[26:27], v56 offset:17408
    v_mfma_f32_16x16x32_bf16 v[232:235], a[68:71], a[92:95], v[232:235]
    buffer_load_dwordx4 v36, s[16:19], s36 offen offset:0 lds
    v_mfma_f32_16x16x32_bf16 v[200:203], a[68:71], a[88:91], v[200:203]
    ds_read_b64_tr_b16 a[28:29], v57 offset:16384
    v_mfma_f32_16x16x32_bf16 v[168:171], a[68:71], a[84:87], v[168:171]
    ds_read_b64_tr_b16 a[30:31], v57 offset:17408
    v_mfma_f32_16x16x32_bf16 v[136:139], a[68:71], a[80:83], v[136:139]
    v_mfma_f32_16x16x32_bf16 v[140:143], a[72:75], a[80:83], v[140:143]
    v_mfma_f32_16x16x32_bf16 v[172:175], a[72:75], a[84:87], v[172:175]
    buffer_load_dwordx4 v37, s[16:19], s36 offen offset:1024 lds
    v_mfma_f32_16x16x32_bf16 v[204:207], a[72:75], a[88:91], v[204:207]
    v_mfma_f32_16x16x32_bf16 v[236:239], a[72:75], a[92:95], v[236:239]
    v_mfma_f32_16x16x32_bf16 v[240:243], a[76:79], a[92:95], v[240:243]
    v_mfma_f32_16x16x32_bf16 v[208:211], a[76:79], a[88:91], v[208:211]
    v_mfma_f32_16x16x32_bf16 v[176:179], a[76:79], a[84:87], v[176:179]
    v_mfma_f32_16x16x32_bf16 v[144:147], a[76:79], a[80:83], v[144:147]
    s_waitcnt lgkmcnt(0)
    v_mfma_f32_16x16x32_bf16 v[100:103], a[0:3], v[32:35], v[100:103]
    ds_read_b64_tr_b16 a[48:49], v50 offset:24576
    v_mfma_f32_16x16x32_bf16 v[104:107], a[4:7], v[32:35], v[104:107]
    ds_read_b64_tr_b16 a[50:51], v50 offset:25600
    v_mfma_f32_16x16x32_bf16 v[116:119], a[0:3], a[32:35], v[116:119]
    buffer_load_dwordx4 v38, s[16:19], s36 offen offset:2048 lds
    v_mfma_f32_16x16x32_bf16 v[148:151], a[0:3], a[36:39], v[148:151]
    ds_read_b128 a[80:83], v49 offset:8192
    v_mfma_f32_16x16x32_bf16 v[180:183], a[0:3], a[40:43], v[180:183]
    ds_read_b128 a[84:87], v49 offset:10240
    v_mfma_f32_16x16x32_bf16 v[212:215], a[0:3], a[44:47], v[212:215]
    ds_read_b128 a[88:91], v49 offset:12288
    v_mfma_f32_16x16x32_bf16 v[216:219], a[4:7], a[44:47], v[216:219]
    ds_read_b128 a[92:95], v49 offset:14336
    v_mfma_f32_16x16x32_bf16 v[184:187], a[4:7], a[40:43], v[184:187]
    buffer_load_dwordx4 v39, s[16:19], s36 offen offset:3072 lds
    v_mfma_f32_16x16x32_bf16 v[152:155], a[4:7], a[36:39], v[152:155]
    ds_read_b64_tr_b16 a[52:53], v51 offset:24576
    v_mfma_f32_16x16x32_bf16 v[120:123], a[4:7], a[32:35], v[120:123]
    ds_read_b64_tr_b16 a[54:55], v51 offset:25600
    v_mfma_f32_16x16x32_bf16 v[124:127], a[8:11], a[32:35], v[124:127]
    ds_read_b64_tr_b16 a[56:57], v52 offset:24576
    v_mfma_f32_16x16x32_bf16 v[156:159], a[8:11], a[36:39], v[156:159]
    s_add_u32 m0, s38, 4096
    ds_read_b64_tr_b16 a[58:59], v52 offset:25600
    v_mfma_f32_16x16x32_bf16 v[188:191], a[8:11], a[40:43], v[188:191]
    buffer_load_dwordx4 v40, s[16:19], s36 offen offset:0 lds
    v_mfma_f32_16x16x32_bf16 v[220:223], a[8:11], a[44:47], v[220:223]
    ds_read_b64_tr_b16 a[60:61], v53 offset:24576
    v_mfma_f32_16x16x32_bf16 v[224:227], a[12:15], a[44:47], v[224:227]
    ds_read_b64_tr_b16 a[62:63], v53 offset:25600
    v_mfma_f32_16x16x32_bf16 v[192:195], a[12:15], a[40:43], v[192:195]
    ds_read_b64_tr_b16 a[64:65], v54 offset:24576
    v_mfma_f32_16x16x32_bf16 v[160:163], a[12:15], a[36:39], v[160:163]
    ds_read_b64_tr_b16 a[66:67], v54 offset:25600
    v_mfma_f32_16x16x32_bf16 v[128:131], a[12:15], a[32:35], v[128:131]
    buffer_load_dwordx4 v41, s[16:19], s36 offen offset:1024 lds
    v_mfma_f32_16x16x32_bf16 v[132:135], a[16:19], a[32:35], v[132:135]
    ds_read_b64_tr_b16 a[68:69], v55 offset:24576
    v_mfma_f32_16x16x32_bf16 v[164:167], a[16:19], a[36:39], v[164:167]
    ds_read_b64_tr_b16 a[70:71], v55 offset:25600
    v_mfma_f32_16x16x32_bf16 v[196:199], a[16:19], a[40:43], v[196:199]
    ds_read_b64_tr_b16 a[72:73], v56 offset:24576
    v_mfma_f32_16x16x32_bf16 v[228:231], a[16:19], a[44:47], v[228:231]
    ds_read_b64_tr_b16 a[74:75], v56 offset:25600
    v_mfma_f32_16x16x32_bf16 v[232:235], a[20:23], a[44:47], v[232:235]
    buffer_load_dwordx4 v42, s[16:19], s36 offen offset:2048 lds
    v_mfma_f32_16x16x32_bf16 v[200:203], a[20:23], a[40:43], v[200:203]
    ds_read_b64_tr_b16 a[76:77], v57 offset:24576
    v_mfma_f32_16x16x32_bf16 v[168:171], a[20:23], a[36:39], v[168:171]
    ds_read_b64_tr_b16 a[78:79], v57 offset:25600
    v_mfma_f32_16x16x32_bf16 v[136:139], a[20:23], a[32:35], v[136:139]
    v_mfma_f32_16x16x32_bf16 v[140:143], a[24:27], a[32:35], v[140:143]
    v_mfma_f32_16x16x32_bf16 v[172:175], a[24:27], a[36:39], v[172:175]
    buffer_load_dwordx4 v43, s[16:19], s36 offen offset:3072 lds
    v_mfma_f32_16x16x32_bf16 v[204:207], a[24:27], a[40:43], v[204:207]
    v_mfma_f32_16x16x32_bf16 v[236:239], a[24:27], a[44:47], v[236:239]
    v_mfma_f32_16x16x32_bf16 v[240:243], a[28:31], a[44:47], v[240:243]
    v_mfma_f32_16x16x32_bf16 v[208:211], a[28:31], a[40:43], v[208:211]
    v_mfma_f32_16x16x32_bf16 v[176:179], a[28:31], a[36:39], v[176:179]
    v_mfma_f32_16x16x32_bf16 v[144:147], a[28:31], a[32:35], v[144:147]
    s_waitcnt vmcnt(12) lgkmcnt(0)
    s_barrier
    v_mfma_f32_16x16x32_bf16 v[100:103], a[48:51], v[32:35], v[100:103]
    ds_read_b64_tr_b16 a[0:1], v50 offset:32768
    v_mfma_f32_16x16x32_bf16 v[104:107], a[52:55], v[32:35], v[104:107]
    s_add_u32 m0, s39, 16384
    s_mov_b32 s37, 3670016
    ds_read_b64_tr_b16 a[2:3], v50 offset:33792
    v_mfma_f32_16x16x32_bf16 v[116:119], a[48:51], a[80:83], v[116:119]
    buffer_load_dwordx4 v44, s[20:23], s37 offen offset:0 lds
    v_mfma_f32_16x16x32_bf16 v[148:151], a[48:51], a[84:87], v[148:151]
    ds_read_b128 a[32:35], v48 offset:16384
    v_mfma_f32_16x16x32_bf16 v[180:183], a[48:51], a[88:91], v[180:183]
    ds_read_b128 a[36:39], v48 offset:18432
    v_mfma_f32_16x16x32_bf16 v[212:215], a[48:51], a[92:95], v[212:215]
    buffer_load_dwordx4 v45, s[20:23], s37 offen offset:1024 lds
    v_mfma_f32_16x16x32_bf16 v[216:219], a[52:55], a[92:95], v[216:219]
    ds_read_b128 a[40:43], v48 offset:20480
    v_mfma_f32_16x16x32_bf16 v[184:187], a[52:55], a[88:91], v[184:187]
    ds_read_b128 a[44:47], v48 offset:22528
    v_mfma_f32_16x16x32_bf16 v[152:155], a[52:55], a[84:87], v[152:155]
    ds_read_b64_tr_b16 a[4:5], v51 offset:32768
    v_mfma_f32_16x16x32_bf16 v[120:123], a[52:55], a[80:83], v[120:123]
    buffer_load_dwordx4 v46, s[20:23], s37 offen offset:2048 lds
    v_mfma_f32_16x16x32_bf16 v[124:127], a[56:59], a[80:83], v[124:127]
    ds_read_b64_tr_b16 a[6:7], v51 offset:33792
    v_mfma_f32_16x16x32_bf16 v[156:159], a[56:59], a[84:87], v[156:159]
    ds_read_b64_tr_b16 a[8:9], v52 offset:32768
    v_mfma_f32_16x16x32_bf16 v[188:191], a[56:59], a[88:91], v[188:191]
    ds_read_b64_tr_b16 a[10:11], v52 offset:33792
    v_mfma_f32_16x16x32_bf16 v[220:223], a[56:59], a[92:95], v[220:223]
    buffer_load_dwordx4 v47, s[20:23], s37 offen offset:3072 lds
    v_mfma_f32_16x16x32_bf16 v[224:227], a[60:63], a[92:95], v[224:227]
    ds_read_b64_tr_b16 a[12:13], v53 offset:32768
    v_mfma_f32_16x16x32_bf16 v[192:195], a[60:63], a[88:91], v[192:195]
    ds_read_b64_tr_b16 a[14:15], v53 offset:33792
    v_mfma_f32_16x16x32_bf16 v[160:163], a[60:63], a[84:87], v[160:163]
    s_add_u32 m0, s38, 8192
    s_mov_b32 s36, 896
    ds_read_b64_tr_b16 a[16:17], v54 offset:32768
    v_mfma_f32_16x16x32_bf16 v[128:131], a[60:63], a[80:83], v[128:131]
    buffer_load_dwordx4 v36, s[16:19], s36 offen offset:0 lds
    v_mfma_f32_16x16x32_bf16 v[132:135], a[64:67], a[80:83], v[132:135]
    ds_read_b64_tr_b16 a[18:19], v54 offset:33792
    v_mfma_f32_16x16x32_bf16 v[164:167], a[64:67], a[84:87], v[164:167]
    ds_read_b64_tr_b16 a[20:21], v55 offset:32768
    v_mfma_f32_16x16x32_bf16 v[196:199], a[64:67], a[88:91], v[196:199]
    buffer_load_dwordx4 v37, s[16:19], s36 offen offset:1024 lds
    v_mfma_f32_16x16x32_bf16 v[228:231], a[64:67], a[92:95], v[228:231]
    ds_read_b64_tr_b16 a[22:23], v55 offset:33792
    v_mfma_f32_16x16x32_bf16 v[232:235], a[68:71], a[92:95], v[232:235]
    ds_read_b64_tr_b16 a[24:25], v56 offset:32768
    v_mfma_f32_16x16x32_bf16 v[200:203], a[68:71], a[88:91], v[200:203]
    ds_read_b64_tr_b16 a[26:27], v56 offset:33792
    v_mfma_f32_16x16x32_bf16 v[168:171], a[68:71], a[84:87], v[168:171]
    buffer_load_dwordx4 v38, s[16:19], s36 offen offset:2048 lds
    v_mfma_f32_16x16x32_bf16 v[136:139], a[68:71], a[80:83], v[136:139]
    ds_read_b64_tr_b16 a[28:29], v57 offset:32768
    v_mfma_f32_16x16x32_bf16 v[140:143], a[72:75], a[80:83], v[140:143]
    ds_read_b64_tr_b16 a[30:31], v57 offset:33792
    v_mfma_f32_16x16x32_bf16 v[172:175], a[72:75], a[84:87], v[172:175]
    v_mfma_f32_16x16x32_bf16 v[204:207], a[72:75], a[88:91], v[204:207]
    buffer_load_dwordx4 v39, s[16:19], s36 offen offset:3072 lds
    v_mfma_f32_16x16x32_bf16 v[236:239], a[72:75], a[92:95], v[236:239]
    v_mfma_f32_16x16x32_bf16 v[240:243], a[76:79], a[92:95], v[240:243]
    v_mfma_f32_16x16x32_bf16 v[208:211], a[76:79], a[88:91], v[208:211]
    v_mfma_f32_16x16x32_bf16 v[176:179], a[76:79], a[84:87], v[176:179]
    v_mfma_f32_16x16x32_bf16 v[144:147], a[76:79], a[80:83], v[144:147]
    s_waitcnt lgkmcnt(0)
    v_mfma_f32_16x16x32_bf16 v[100:103], a[0:3], v[32:35], v[100:103]
    ds_read_b64_tr_b16 a[48:49], v50 offset:40960
    v_mfma_f32_16x16x32_bf16 v[104:107], a[4:7], v[32:35], v[104:107]
    s_add_u32 m0, s38, 12288
    ds_read_b64_tr_b16 a[50:51], v50 offset:41984
    v_mfma_f32_16x16x32_bf16 v[116:119], a[0:3], a[32:35], v[116:119]
    buffer_load_dwordx4 v40, s[16:19], s36 offen offset:0 lds
    v_mfma_f32_16x16x32_bf16 v[148:151], a[0:3], a[36:39], v[148:151]
    ds_read_b128 a[80:83], v49 offset:16384
    v_mfma_f32_16x16x32_bf16 v[180:183], a[0:3], a[40:43], v[180:183]
    ds_read_b128 a[84:87], v49 offset:18432
    v_mfma_f32_16x16x32_bf16 v[212:215], a[0:3], a[44:47], v[212:215]
    buffer_load_dwordx4 v41, s[16:19], s36 offen offset:1024 lds
    v_mfma_f32_16x16x32_bf16 v[216:219], a[4:7], a[44:47], v[216:219]
    ds_read_b128 a[88:91], v49 offset:20480
    v_mfma_f32_16x16x32_bf16 v[184:187], a[4:7], a[40:43], v[184:187]
    ds_read_b128 a[92:95], v49 offset:22528
    v_mfma_f32_16x16x32_bf16 v[152:155], a[4:7], a[36:39], v[152:155]
    ds_read_b64_tr_b16 a[52:53], v51 offset:40960
    v_mfma_f32_16x16x32_bf16 v[120:123], a[4:7], a[32:35], v[120:123]
    buffer_load_dwordx4 v42, s[16:19], s36 offen offset:2048 lds
    v_mfma_f32_16x16x32_bf16 v[124:127], a[8:11], a[32:35], v[124:127]
    ds_read_b64_tr_b16 a[54:55], v51 offset:41984
    v_mfma_f32_16x16x32_bf16 v[156:159], a[8:11], a[36:39], v[156:159]
    ds_read_b64_tr_b16 a[56:57], v52 offset:40960
    v_mfma_f32_16x16x32_bf16 v[188:191], a[8:11], a[40:43], v[188:191]
    ds_read_b64_tr_b16 a[58:59], v52 offset:41984
    v_mfma_f32_16x16x32_bf16 v[220:223], a[8:11], a[44:47], v[220:223]
    buffer_load_dwordx4 v43, s[16:19], s36 offen offset:3072 lds
    v_mfma_f32_16x16x32_bf16 v[224:227], a[12:15], a[44:47], v[224:227]
    ds_read_b64_tr_b16 a[60:61], v53 offset:40960
    v_mfma_f32_16x16x32_bf16 v[192:195], a[12:15], a[40:43], v[192:195]
    ds_read_b64_tr_b16 a[62:63], v53 offset:41984
    v_mfma_f32_16x16x32_bf16 v[160:163], a[12:15], a[36:39], v[160:163]
    s_add_u32 m0, s34, 49152
    ds_read_b64_tr_b16 a[64:65], v54 offset:40960
    v_mfma_f32_16x16x32_bf16 v[128:131], a[12:15], a[32:35], v[128:131]
    buffer_load_dwordx4 v13, s[8:11], s28 offen offset:0 lds
    v_mfma_f32_16x16x32_bf16 v[132:135], a[16:19], a[32:35], v[132:135]
    ds_read_b64_tr_b16 a[66:67], v54 offset:41984
    v_mfma_f32_16x16x32_bf16 v[164:167], a[16:19], a[36:39], v[164:167]
    ds_read_b64_tr_b16 a[68:69], v55 offset:40960
    v_mfma_f32_16x16x32_bf16 v[196:199], a[16:19], a[40:43], v[196:199]
    buffer_load_dwordx4 v14, s[8:11], s28 offen offset:1024 lds
    v_mfma_f32_16x16x32_bf16 v[228:231], a[16:19], a[44:47], v[228:231]
    ds_read_b64_tr_b16 a[70:71], v55 offset:41984
    v_mfma_f32_16x16x32_bf16 v[232:235], a[20:23], a[44:47], v[232:235]
    ds_read_b64_tr_b16 a[72:73], v56 offset:40960
    v_mfma_f32_16x16x32_bf16 v[200:203], a[20:23], a[40:43], v[200:203]
    ds_read_b64_tr_b16 a[74:75], v56 offset:41984
    v_mfma_f32_16x16x32_bf16 v[168:171], a[20:23], a[36:39], v[168:171]
    buffer_load_dwordx4 v15, s[8:11], s28 offen offset:2048 lds
    v_mfma_f32_16x16x32_bf16 v[136:139], a[20:23], a[32:35], v[136:139]
    ds_read_b64_tr_b16 a[76:77], v57 offset:40960
    v_mfma_f32_16x16x32_bf16 v[140:143], a[24:27], a[32:35], v[140:143]
    ds_read_b64_tr_b16 a[78:79], v57 offset:41984
    v_mfma_f32_16x16x32_bf16 v[172:175], a[24:27], a[36:39], v[172:175]
    v_mfma_f32_16x16x32_bf16 v[204:207], a[24:27], a[40:43], v[204:207]
    buffer_load_dwordx4 v16, s[8:11], s28 offen offset:3072 lds
    v_mfma_f32_16x16x32_bf16 v[236:239], a[24:27], a[44:47], v[236:239]
    v_mfma_f32_16x16x32_bf16 v[240:243], a[28:31], a[44:47], v[240:243]
    v_mfma_f32_16x16x32_bf16 v[208:211], a[28:31], a[40:43], v[208:211]
    v_mfma_f32_16x16x32_bf16 v[176:179], a[28:31], a[36:39], v[176:179]
    v_mfma_f32_16x16x32_bf16 v[144:147], a[28:31], a[32:35], v[144:147]
    s_add_u32 s28, s28, 16384
    s_waitcnt vmcnt(16) lgkmcnt(0)
    s_barrier
    v_mfma_f32_16x16x32_bf16 v[100:103], a[48:51], v[32:35], v[100:103]
    ds_read_b64_tr_b16 a[0:1], v50 offset:0
    v_mfma_f32_16x16x32_bf16 v[104:107], a[52:55], v[32:35], v[104:107]
    s_add_u32 m0, s39, 32768
    s_mov_b32 s37, 4194304
    ds_read_b64_tr_b16 a[2:3], v50 offset:1024
    v_mfma_f32_16x16x32_bf16 v[116:119], a[48:51], a[80:83], v[116:119]
    buffer_load_dwordx4 v44, s[20:23], s37 offen offset:0 lds
    v_mfma_f32_16x16x32_bf16 v[148:151], a[48:51], a[84:87], v[148:151]
    ds_read_b128 a[32:35], v48 offset:0
    v_mfma_f32_16x16x32_bf16 v[180:183], a[48:51], a[88:91], v[180:183]
    ds_read_b128 a[36:39], v48 offset:2048
    v_mfma_f32_16x16x32_bf16 v[212:215], a[48:51], a[92:95], v[212:215]
    ds_read_b128 a[40:43], v48 offset:4096
    v_mfma_f32_16x16x32_bf16 v[216:219], a[52:55], a[92:95], v[216:219]
    ds_read_b128 a[44:47], v48 offset:6144
    v_mfma_f32_16x16x32_bf16 v[184:187], a[52:55], a[88:91], v[184:187]
    buffer_load_dwordx4 v45, s[20:23], s37 offen offset:1024 lds
    v_mfma_f32_16x16x32_bf16 v[152:155], a[52:55], a[84:87], v[152:155]
    ds_read_b64_tr_b16 a[4:5], v51 offset:0
    v_mfma_f32_16x16x32_bf16 v[120:123], a[52:55], a[80:83], v[120:123]
    ds_read_b64_tr_b16 a[6:7], v51 offset:1024
    v_mfma_f32_16x16x32_bf16 v[124:127], a[56:59], a[80:83], v[124:127]
    ds_read_b64_tr_b16 a[8:9], v52 offset:0
    v_mfma_f32_16x16x32_bf16 v[156:159], a[56:59], a[84:87], v[156:159]
    ds_read_b64_tr_b16 a[10:11], v52 offset:1024
    v_mfma_f32_16x16x32_bf16 v[188:191], a[56:59], a[88:91], v[188:191]
    buffer_load_dwordx4 v46, s[20:23], s37 offen offset:2048 lds
    v_mfma_f32_16x16x32_bf16 v[220:223], a[56:59], a[92:95], v[220:223]
    ds_read_b64_tr_b16 a[12:13], v53 offset:0
    v_mfma_f32_16x16x32_bf16 v[224:227], a[60:63], a[92:95], v[224:227]
    ds_read_b64_tr_b16 a[14:15], v53 offset:1024
    v_mfma_f32_16x16x32_bf16 v[192:195], a[60:63], a[88:91], v[192:195]
    ds_read_b64_tr_b16 a[16:17], v54 offset:0
    v_mfma_f32_16x16x32_bf16 v[160:163], a[60:63], a[84:87], v[160:163]
    ds_read_b64_tr_b16 a[18:19], v54 offset:1024
    v_mfma_f32_16x16x32_bf16 v[128:131], a[60:63], a[80:83], v[128:131]
    buffer_load_dwordx4 v47, s[20:23], s37 offen offset:3072 lds
    v_mfma_f32_16x16x32_bf16 v[132:135], a[64:67], a[80:83], v[132:135]
    ds_read_b64_tr_b16 a[20:21], v55 offset:0
    v_mfma_f32_16x16x32_bf16 v[164:167], a[64:67], a[84:87], v[164:167]
    ds_read_b64_tr_b16 a[22:23], v55 offset:1024
    v_mfma_f32_16x16x32_bf16 v[196:199], a[64:67], a[88:91], v[196:199]
    ds_read_b64_tr_b16 a[24:25], v56 offset:0
    v_mfma_f32_16x16x32_bf16 v[228:231], a[64:67], a[92:95], v[228:231]
    s_add_u32 m0, s38, 16384
    s_mov_b32 s36, 1024
    ds_read_b64_tr_b16 a[26:27], v56 offset:1024
    v_mfma_f32_16x16x32_bf16 v[232:235], a[68:71], a[92:95], v[232:235]
    buffer_load_dwordx4 v36, s[16:19], s36 offen offset:0 lds
    v_mfma_f32_16x16x32_bf16 v[200:203], a[68:71], a[88:91], v[200:203]
    ds_read_b64_tr_b16 a[28:29], v57 offset:0
    v_mfma_f32_16x16x32_bf16 v[168:171], a[68:71], a[84:87], v[168:171]
    ds_read_b64_tr_b16 a[30:31], v57 offset:1024
    v_mfma_f32_16x16x32_bf16 v[136:139], a[68:71], a[80:83], v[136:139]
    v_mfma_f32_16x16x32_bf16 v[140:143], a[72:75], a[80:83], v[140:143]
    v_mfma_f32_16x16x32_bf16 v[172:175], a[72:75], a[84:87], v[172:175]
    buffer_load_dwordx4 v37, s[16:19], s36 offen offset:1024 lds
    v_mfma_f32_16x16x32_bf16 v[204:207], a[72:75], a[88:91], v[204:207]
    v_mfma_f32_16x16x32_bf16 v[236:239], a[72:75], a[92:95], v[236:239]
    v_mfma_f32_16x16x32_bf16 v[240:243], a[76:79], a[92:95], v[240:243]
    v_mfma_f32_16x16x32_bf16 v[208:211], a[76:79], a[88:91], v[208:211]
    v_mfma_f32_16x16x32_bf16 v[176:179], a[76:79], a[84:87], v[176:179]
    v_mfma_f32_16x16x32_bf16 v[144:147], a[76:79], a[80:83], v[144:147]
    s_waitcnt lgkmcnt(0)
    v_mfma_f32_16x16x32_bf16 v[100:103], a[0:3], v[32:35], v[100:103]
    ds_read_b64_tr_b16 a[48:49], v50 offset:8192
    v_mfma_f32_16x16x32_bf16 v[104:107], a[4:7], v[32:35], v[104:107]
    ds_read_b64_tr_b16 a[50:51], v50 offset:9216
    v_mfma_f32_16x16x32_bf16 v[116:119], a[0:3], a[32:35], v[116:119]
    buffer_load_dwordx4 v38, s[16:19], s36 offen offset:2048 lds
    v_mfma_f32_16x16x32_bf16 v[148:151], a[0:3], a[36:39], v[148:151]
    ds_read_b128 a[80:83], v49 offset:0
    v_mfma_f32_16x16x32_bf16 v[180:183], a[0:3], a[40:43], v[180:183]
    ds_read_b128 a[84:87], v49 offset:2048
    v_mfma_f32_16x16x32_bf16 v[212:215], a[0:3], a[44:47], v[212:215]
    ds_read_b128 a[88:91], v49 offset:4096
    v_mfma_f32_16x16x32_bf16 v[216:219], a[4:7], a[44:47], v[216:219]
    ds_read_b128 a[92:95], v49 offset:6144
    v_mfma_f32_16x16x32_bf16 v[184:187], a[4:7], a[40:43], v[184:187]
    buffer_load_dwordx4 v39, s[16:19], s36 offen offset:3072 lds
    v_mfma_f32_16x16x32_bf16 v[152:155], a[4:7], a[36:39], v[152:155]
    ds_read_b64_tr_b16 a[52:53], v51 offset:8192
    v_mfma_f32_16x16x32_bf16 v[120:123], a[4:7], a[32:35], v[120:123]
    ds_read_b64_tr_b16 a[54:55], v51 offset:9216
    v_mfma_f32_16x16x32_bf16 v[124:127], a[8:11], a[32:35], v[124:127]
    ds_read_b64_tr_b16 a[56:57], v52 offset:8192
    v_mfma_f32_16x16x32_bf16 v[156:159], a[8:11], a[36:39], v[156:159]
    s_add_u32 m0, s38, 20480
    ds_read_b64_tr_b16 a[58:59], v52 offset:9216
    v_mfma_f32_16x16x32_bf16 v[188:191], a[8:11], a[40:43], v[188:191]
    buffer_load_dwordx4 v40, s[16:19], s36 offen offset:0 lds
    v_mfma_f32_16x16x32_bf16 v[220:223], a[8:11], a[44:47], v[220:223]
    ds_read_b64_tr_b16 a[60:61], v53 offset:8192
    v_mfma_f32_16x16x32_bf16 v[224:227], a[12:15], a[44:47], v[224:227]
    ds_read_b64_tr_b16 a[62:63], v53 offset:9216
    v_mfma_f32_16x16x32_bf16 v[192:195], a[12:15], a[40:43], v[192:195]
    ds_read_b64_tr_b16 a[64:65], v54 offset:8192
    v_mfma_f32_16x16x32_bf16 v[160:163], a[12:15], a[36:39], v[160:163]
    ds_read_b64_tr_b16 a[66:67], v54 offset:9216
    v_mfma_f32_16x16x32_bf16 v[128:131], a[12:15], a[32:35], v[128:131]
    buffer_load_dwordx4 v41, s[16:19], s36 offen offset:1024 lds
    v_mfma_f32_16x16x32_bf16 v[132:135], a[16:19], a[32:35], v[132:135]
    ds_read_b64_tr_b16 a[68:69], v55 offset:8192
    v_mfma_f32_16x16x32_bf16 v[164:167], a[16:19], a[36:39], v[164:167]
    ds_read_b64_tr_b16 a[70:71], v55 offset:9216
    v_mfma_f32_16x16x32_bf16 v[196:199], a[16:19], a[40:43], v[196:199]
    ds_read_b64_tr_b16 a[72:73], v56 offset:8192
    v_mfma_f32_16x16x32_bf16 v[228:231], a[16:19], a[44:47], v[228:231]
    ds_read_b64_tr_b16 a[74:75], v56 offset:9216
    v_mfma_f32_16x16x32_bf16 v[232:235], a[20:23], a[44:47], v[232:235]
    buffer_load_dwordx4 v42, s[16:19], s36 offen offset:2048 lds
    v_mfma_f32_16x16x32_bf16 v[200:203], a[20:23], a[40:43], v[200:203]
    ds_read_b64_tr_b16 a[76:77], v57 offset:8192
    v_mfma_f32_16x16x32_bf16 v[168:171], a[20:23], a[36:39], v[168:171]
    ds_read_b64_tr_b16 a[78:79], v57 offset:9216
    v_mfma_f32_16x16x32_bf16 v[136:139], a[20:23], a[32:35], v[136:139]
    v_mfma_f32_16x16x32_bf16 v[140:143], a[24:27], a[32:35], v[140:143]
    v_mfma_f32_16x16x32_bf16 v[172:175], a[24:27], a[36:39], v[172:175]
    buffer_load_dwordx4 v43, s[16:19], s36 offen offset:3072 lds
    v_mfma_f32_16x16x32_bf16 v[204:207], a[24:27], a[40:43], v[204:207]
    v_mfma_f32_16x16x32_bf16 v[236:239], a[24:27], a[44:47], v[236:239]
    v_mfma_f32_16x16x32_bf16 v[240:243], a[28:31], a[44:47], v[240:243]
    v_mfma_f32_16x16x32_bf16 v[208:211], a[28:31], a[40:43], v[208:211]
    v_mfma_f32_16x16x32_bf16 v[176:179], a[28:31], a[36:39], v[176:179]
    v_mfma_f32_16x16x32_bf16 v[144:147], a[28:31], a[32:35], v[144:147]
    s_waitcnt vmcnt(16) lgkmcnt(0)
    s_barrier
    v_mfma_f32_16x16x32_bf16 v[100:103], a[48:51], v[32:35], v[100:103]
    ds_read_b64_tr_b16 a[0:1], v50 offset:16384
    v_mfma_f32_16x16x32_bf16 v[104:107], a[52:55], v[32:35], v[104:107]
    s_add_u32 m0, s39, 0
    s_mov_b32 s37, 4718592
    ds_read_b64_tr_b16 a[2:3], v50 offset:17408
    v_mfma_f32_16x16x32_bf16 v[116:119], a[48:51], a[80:83], v[116:119]
    buffer_load_dwordx4 v44, s[20:23], s37 offen offset:0 lds
    v_mfma_f32_16x16x32_bf16 v[148:151], a[48:51], a[84:87], v[148:151]
    ds_read_b128 a[32:35], v48 offset:8192
    v_mfma_f32_16x16x32_bf16 v[180:183], a[48:51], a[88:91], v[180:183]
    ds_read_b128 a[36:39], v48 offset:10240
    v_mfma_f32_16x16x32_bf16 v[212:215], a[48:51], a[92:95], v[212:215]
    ds_read_b128 a[40:43], v48 offset:12288
    v_mfma_f32_16x16x32_bf16 v[216:219], a[52:55], a[92:95], v[216:219]
    ds_read_b128 a[44:47], v48 offset:14336
    v_mfma_f32_16x16x32_bf16 v[184:187], a[52:55], a[88:91], v[184:187]
    buffer_load_dwordx4 v45, s[20:23], s37 offen offset:1024 lds
    v_mfma_f32_16x16x32_bf16 v[152:155], a[52:55], a[84:87], v[152:155]
    ds_read_b64_tr_b16 a[4:5], v51 offset:16384
    v_mfma_f32_16x16x32_bf16 v[120:123], a[52:55], a[80:83], v[120:123]
    ds_read_b64_tr_b16 a[6:7], v51 offset:17408
    v_mfma_f32_16x16x32_bf16 v[124:127], a[56:59], a[80:83], v[124:127]
    ds_read_b64_tr_b16 a[8:9], v52 offset:16384
    v_mfma_f32_16x16x32_bf16 v[156:159], a[56:59], a[84:87], v[156:159]
    ds_read_b64_tr_b16 a[10:11], v52 offset:17408
    v_mfma_f32_16x16x32_bf16 v[188:191], a[56:59], a[88:91], v[188:191]
    buffer_load_dwordx4 v46, s[20:23], s37 offen offset:2048 lds
    v_mfma_f32_16x16x32_bf16 v[220:223], a[56:59], a[92:95], v[220:223]
    ds_read_b64_tr_b16 a[12:13], v53 offset:16384
    v_mfma_f32_16x16x32_bf16 v[224:227], a[60:63], a[92:95], v[224:227]
    ds_read_b64_tr_b16 a[14:15], v53 offset:17408
    v_mfma_f32_16x16x32_bf16 v[192:195], a[60:63], a[88:91], v[192:195]
    ds_read_b64_tr_b16 a[16:17], v54 offset:16384
    v_mfma_f32_16x16x32_bf16 v[160:163], a[60:63], a[84:87], v[160:163]
    ds_read_b64_tr_b16 a[18:19], v54 offset:17408
    v_mfma_f32_16x16x32_bf16 v[128:131], a[60:63], a[80:83], v[128:131]
    buffer_load_dwordx4 v47, s[20:23], s37 offen offset:3072 lds
    v_mfma_f32_16x16x32_bf16 v[132:135], a[64:67], a[80:83], v[132:135]
    ds_read_b64_tr_b16 a[20:21], v55 offset:16384
    v_mfma_f32_16x16x32_bf16 v[164:167], a[64:67], a[84:87], v[164:167]
    ds_read_b64_tr_b16 a[22:23], v55 offset:17408
    v_mfma_f32_16x16x32_bf16 v[196:199], a[64:67], a[88:91], v[196:199]
    ds_read_b64_tr_b16 a[24:25], v56 offset:16384
    v_mfma_f32_16x16x32_bf16 v[228:231], a[64:67], a[92:95], v[228:231]
    s_add_u32 m0, s38, 0
    s_mov_b32 s36, 1152
    ds_read_b64_tr_b16 a[26:27], v56 offset:17408
    v_mfma_f32_16x16x32_bf16 v[232:235], a[68:71], a[92:95], v[232:235]
    buffer_load_dwordx4 v36, s[16:19], s36 offen offset:0 lds
    v_mfma_f32_16x16x32_bf16 v[200:203], a[68:71], a[88:91], v[200:203]
    ds_read_b64_tr_b16 a[28:29], v57 offset:16384
    v_mfma_f32_16x16x32_bf16 v[168:171], a[68:71], a[84:87], v[168:171]
    ds_read_b64_tr_b16 a[30:31], v57 offset:17408
    v_mfma_f32_16x16x32_bf16 v[136:139], a[68:71], a[80:83], v[136:139]
    v_mfma_f32_16x16x32_bf16 v[140:143], a[72:75], a[80:83], v[140:143]
    v_mfma_f32_16x16x32_bf16 v[172:175], a[72:75], a[84:87], v[172:175]
    buffer_load_dwordx4 v37, s[16:19], s36 offen offset:1024 lds
    v_mfma_f32_16x16x32_bf16 v[204:207], a[72:75], a[88:91], v[204:207]
    v_mfma_f32_16x16x32_bf16 v[236:239], a[72:75], a[92:95], v[236:239]
    v_mfma_f32_16x16x32_bf16 v[240:243], a[76:79], a[92:95], v[240:243]
    v_mfma_f32_16x16x32_bf16 v[208:211], a[76:79], a[88:91], v[208:211]
    v_mfma_f32_16x16x32_bf16 v[176:179], a[76:79], a[84:87], v[176:179]
    v_mfma_f32_16x16x32_bf16 v[144:147], a[76:79], a[80:83], v[144:147]
    s_waitcnt lgkmcnt(0)
    v_mfma_f32_16x16x32_bf16 v[100:103], a[0:3], v[32:35], v[100:103]
    ds_read_b64_tr_b16 a[48:49], v50 offset:24576
    v_mfma_f32_16x16x32_bf16 v[104:107], a[4:7], v[32:35], v[104:107]
    ds_read_b64_tr_b16 a[50:51], v50 offset:25600
    v_mfma_f32_16x16x32_bf16 v[116:119], a[0:3], a[32:35], v[116:119]
    buffer_load_dwordx4 v38, s[16:19], s36 offen offset:2048 lds
    v_mfma_f32_16x16x32_bf16 v[148:151], a[0:3], a[36:39], v[148:151]
    ds_read_b128 a[80:83], v49 offset:8192
    v_mfma_f32_16x16x32_bf16 v[180:183], a[0:3], a[40:43], v[180:183]
    ds_read_b128 a[84:87], v49 offset:10240
    v_mfma_f32_16x16x32_bf16 v[212:215], a[0:3], a[44:47], v[212:215]
    ds_read_b128 a[88:91], v49 offset:12288
    v_mfma_f32_16x16x32_bf16 v[216:219], a[4:7], a[44:47], v[216:219]
    ds_read_b128 a[92:95], v49 offset:14336
    v_mfma_f32_16x16x32_bf16 v[184:187], a[4:7], a[40:43], v[184:187]
    buffer_load_dwordx4 v39, s[16:19], s36 offen offset:3072 lds
    v_mfma_f32_16x16x32_bf16 v[152:155], a[4:7], a[36:39], v[152:155]
    ds_read_b64_tr_b16 a[52:53], v51 offset:24576
    v_mfma_f32_16x16x32_bf16 v[120:123], a[4:7], a[32:35], v[120:123]
    ds_read_b64_tr_b16 a[54:55], v51 offset:25600
    v_mfma_f32_16x16x32_bf16 v[124:127], a[8:11], a[32:35], v[124:127]
    ds_read_b64_tr_b16 a[56:57], v52 offset:24576
    v_mfma_f32_16x16x32_bf16 v[156:159], a[8:11], a[36:39], v[156:159]
    s_add_u32 m0, s38, 4096
    ds_read_b64_tr_b16 a[58:59], v52 offset:25600
    v_mfma_f32_16x16x32_bf16 v[188:191], a[8:11], a[40:43], v[188:191]
    buffer_load_dwordx4 v40, s[16:19], s36 offen offset:0 lds
    v_mfma_f32_16x16x32_bf16 v[220:223], a[8:11], a[44:47], v[220:223]
    ds_read_b64_tr_b16 a[60:61], v53 offset:24576
    v_mfma_f32_16x16x32_bf16 v[224:227], a[12:15], a[44:47], v[224:227]
    ds_read_b64_tr_b16 a[62:63], v53 offset:25600
    v_mfma_f32_16x16x32_bf16 v[192:195], a[12:15], a[40:43], v[192:195]
    ds_read_b64_tr_b16 a[64:65], v54 offset:24576
    v_mfma_f32_16x16x32_bf16 v[160:163], a[12:15], a[36:39], v[160:163]
    ds_read_b64_tr_b16 a[66:67], v54 offset:25600
    v_mfma_f32_16x16x32_bf16 v[128:131], a[12:15], a[32:35], v[128:131]
    buffer_load_dwordx4 v41, s[16:19], s36 offen offset:1024 lds
    v_mfma_f32_16x16x32_bf16 v[132:135], a[16:19], a[32:35], v[132:135]
    ds_read_b64_tr_b16 a[68:69], v55 offset:24576
    v_mfma_f32_16x16x32_bf16 v[164:167], a[16:19], a[36:39], v[164:167]
    ds_read_b64_tr_b16 a[70:71], v55 offset:25600
    v_mfma_f32_16x16x32_bf16 v[196:199], a[16:19], a[40:43], v[196:199]
    ds_read_b64_tr_b16 a[72:73], v56 offset:24576
    v_mfma_f32_16x16x32_bf16 v[228:231], a[16:19], a[44:47], v[228:231]
    ds_read_b64_tr_b16 a[74:75], v56 offset:25600
    v_mfma_f32_16x16x32_bf16 v[232:235], a[20:23], a[44:47], v[232:235]
    buffer_load_dword v252, off, s[92:95], s74 sc1
    buffer_load_dwordx4 v42, s[16:19], s36 offen offset:2048 lds
    v_mfma_f32_16x16x32_bf16 v[200:203], a[20:23], a[40:43], v[200:203]
    ds_read_b64_tr_b16 a[76:77], v57 offset:24576
    v_mfma_f32_16x16x32_bf16 v[168:171], a[20:23], a[36:39], v[168:171]
    ds_read_b64_tr_b16 a[78:79], v57 offset:25600
    v_mfma_f32_16x16x32_bf16 v[136:139], a[20:23], a[32:35], v[136:139]
    v_mfma_f32_16x16x32_bf16 v[140:143], a[24:27], a[32:35], v[140:143]
    v_mfma_f32_16x16x32_bf16 v[172:175], a[24:27], a[36:39], v[172:175]
    buffer_load_dwordx4 v43, s[16:19], s36 offen offset:3072 lds
    v_mfma_f32_16x16x32_bf16 v[204:207], a[24:27], a[40:43], v[204:207]
    v_mfma_f32_16x16x32_bf16 v[236:239], a[24:27], a[44:47], v[236:239]
    v_mfma_f32_16x16x32_bf16 v[240:243], a[28:31], a[44:47], v[240:243]
    v_mfma_f32_16x16x32_bf16 v[208:211], a[28:31], a[40:43], v[208:211]
    v_mfma_f32_16x16x32_bf16 v[176:179], a[28:31], a[36:39], v[176:179]
    v_mfma_f32_16x16x32_bf16 v[144:147], a[28:31], a[32:35], v[144:147]
    s_waitcnt vmcnt(13) lgkmcnt(0)
    s_barrier
    v_mfma_f32_16x16x32_bf16 v[100:103], a[48:51], v[32:35], v[100:103]
    ds_read_b64_tr_b16 a[0:1], v50 offset:32768
    v_mfma_f32_16x16x32_bf16 v[104:107], a[52:55], v[32:35], v[104:107]
    s_add_u32 m0, s34, 16384
    ds_read_b64_tr_b16 a[2:3], v50 offset:33792
    v_mfma_f32_16x16x32_bf16 v[116:119], a[48:51], a[80:83], v[116:119]
    buffer_load_dwordx4 v13, s[8:11], s28 offen offset:0 lds
    v_mfma_f32_16x16x32_bf16 v[148:151], a[48:51], a[84:87], v[148:151]
    ds_read_b128 a[32:35], v48 offset:16384
    v_mfma_f32_16x16x32_bf16 v[180:183], a[48:51], a[88:91], v[180:183]
    ds_read_b128 a[36:39], v48 offset:18432
    v_mfma_f32_16x16x32_bf16 v[212:215], a[48:51], a[92:95], v[212:215]
    ds_read_b128 a[40:43], v48 offset:20480
    v_mfma_f32_16x16x32_bf16 v[216:219], a[52:55], a[92:95], v[216:219]
    ds_read_b128 a[44:47], v48 offset:22528
    v_mfma_f32_16x16x32_bf16 v[184:187], a[52:55], a[88:91], v[184:187]
    ds_read_b64_tr_b16 a[4:5], v51 offset:32768
    v_mfma_f32_16x16x32_bf16 v[152:155], a[52:55], a[84:87], v[152:155]
    ds_read_b64_tr_b16 a[6:7], v51 offset:33792
    v_mfma_f32_16x16x32_bf16 v[120:123], a[52:55], a[80:83], v[120:123]
    ds_read_b64_tr_b16 a[8:9], v52 offset:32768
    v_mfma_f32_16x16x32_bf16 v[124:127], a[56:59], a[80:83], v[124:127]
    ds_read_b64_tr_b16 a[10:11], v52 offset:33792
    v_mfma_f32_16x16x32_bf16 v[156:159], a[56:59], a[84:87], v[156:159]
    ds_read_b64_tr_b16 a[12:13], v53 offset:32768
    v_mfma_f32_16x16x32_bf16 v[188:191], a[56:59], a[88:91], v[188:191]
    ds_read_b64_tr_b16 a[14:15], v53 offset:33792
    v_mfma_f32_16x16x32_bf16 v[220:223], a[56:59], a[92:95], v[220:223]
    ds_read_b64_tr_b16 a[16:17], v54 offset:32768
    v_mfma_f32_16x16x32_bf16 v[224:227], a[60:63], a[92:95], v[224:227]
    ds_read_b64_tr_b16 a[18:19], v54 offset:33792
    v_mfma_f32_16x16x32_bf16 v[192:195], a[60:63], a[88:91], v[192:195]
    ds_read_b64_tr_b16 a[20:21], v55 offset:32768
    v_mfma_f32_16x16x32_bf16 v[160:163], a[60:63], a[84:87], v[160:163]
    ds_read_b64_tr_b16 a[22:23], v55 offset:33792
    v_mfma_f32_16x16x32_bf16 v[128:131], a[60:63], a[80:83], v[128:131]
    buffer_load_dwordx4 v14, s[8:11], s28 offen offset:1024 lds
    v_mfma_f32_16x16x32_bf16 v[132:135], a[64:67], a[80:83], v[132:135]
    ds_read_b64_tr_b16 a[24:25], v56 offset:32768
    v_mfma_f32_16x16x32_bf16 v[164:167], a[64:67], a[84:87], v[164:167]
    ds_read_b64_tr_b16 a[26:27], v56 offset:33792
    v_mfma_f32_16x16x32_bf16 v[196:199], a[64:67], a[88:91], v[196:199]
    ds_read_b64_tr_b16 a[28:29], v57 offset:32768
    v_mfma_f32_16x16x32_bf16 v[228:231], a[64:67], a[92:95], v[228:231]
    ds_read_b64_tr_b16 a[30:31], v57 offset:33792
    v_mfma_f32_16x16x32_bf16 v[232:235], a[68:71], a[92:95], v[232:235]
    v_mfma_f32_16x16x32_bf16 v[200:203], a[68:71], a[88:91], v[200:203]
    v_mfma_f32_16x16x32_bf16 v[168:171], a[68:71], a[84:87], v[168:171]
    v_mfma_f32_16x16x32_bf16 v[136:139], a[68:71], a[80:83], v[136:139]
    v_mfma_f32_16x16x32_bf16 v[140:143], a[72:75], a[80:83], v[140:143]
    v_mfma_f32_16x16x32_bf16 v[172:175], a[72:75], a[84:87], v[172:175]
    v_mfma_f32_16x16x32_bf16 v[204:207], a[72:75], a[88:91], v[204:207]
    v_mfma_f32_16x16x32_bf16 v[236:239], a[72:75], a[92:95], v[236:239]
    v_mfma_f32_16x16x32_bf16 v[240:243], a[76:79], a[92:95], v[240:243]
    v_mfma_f32_16x16x32_bf16 v[208:211], a[76:79], a[88:91], v[208:211]
    v_mfma_f32_16x16x32_bf16 v[176:179], a[76:79], a[84:87], v[176:179]
    v_mfma_f32_16x16x32_bf16 v[144:147], a[76:79], a[80:83], v[144:147]
    s_waitcnt lgkmcnt(0)
    v_mfma_f32_16x16x32_bf16 v[100:103], a[0:3], v[32:35], v[100:103]
    ds_read_b64_tr_b16 a[48:49], v50 offset:40960
    v_mfma_f32_16x16x32_bf16 v[104:107], a[4:7], v[32:35], v[104:107]
    ds_read_b64_tr_b16 a[50:51], v50 offset:41984
    v_mfma_f32_16x16x32_bf16 v[116:119], a[0:3], a[32:35], v[116:119]
    buffer_load_dwordx4 v15, s[8:11], s28 offen offset:2048 lds
    v_mfma_f32_16x16x32_bf16 v[148:151], a[0:3], a[36:39], v[148:151]
    ds_read_b128 a[80:83], v49 offset:16384
    v_mfma_f32_16x16x32_bf16 v[180:183], a[0:3], a[40:43], v[180:183]
    ds_read_b128 a[84:87], v49 offset:18432
    v_mfma_f32_16x16x32_bf16 v[212:215], a[0:3], a[44:47], v[212:215]
    ds_read_b128 a[88:91], v49 offset:20480
    v_mfma_f32_16x16x32_bf16 v[216:219], a[4:7], a[44:47], v[216:219]
    ds_read_b128 a[92:95], v49 offset:22528
    v_mfma_f32_16x16x32_bf16 v[184:187], a[4:7], a[40:43], v[184:187]
    ds_read_b64_tr_b16 a[52:53], v51 offset:40960
    v_mfma_f32_16x16x32_bf16 v[152:155], a[4:7], a[36:39], v[152:155]
    ds_read_b64_tr_b16 a[54:55], v51 offset:41984
    v_mfma_f32_16x16x32_bf16 v[120:123], a[4:7], a[32:35], v[120:123]
    ds_read_b64_tr_b16 a[56:57], v52 offset:40960
    v_mfma_f32_16x16x32_bf16 v[124:127], a[8:11], a[32:35], v[124:127]
    ds_read_b64_tr_b16 a[58:59], v52 offset:41984
    v_mfma_f32_16x16x32_bf16 v[156:159], a[8:11], a[36:39], v[156:159]
    ds_read_b64_tr_b16 a[60:61], v53 offset:40960
    v_mfma_f32_16x16x32_bf16 v[188:191], a[8:11], a[40:43], v[188:191]
    ds_read_b64_tr_b16 a[62:63], v53 offset:41984
    v_mfma_f32_16x16x32_bf16 v[220:223], a[8:11], a[44:47], v[220:223]
    ds_read_b64_tr_b16 a[64:65], v54 offset:40960
    v_mfma_f32_16x16x32_bf16 v[224:227], a[12:15], a[44:47], v[224:227]
    ds_read_b64_tr_b16 a[66:67], v54 offset:41984
    v_mfma_f32_16x16x32_bf16 v[192:195], a[12:15], a[40:43], v[192:195]
    ds_read_b64_tr_b16 a[68:69], v55 offset:40960
    v_mfma_f32_16x16x32_bf16 v[160:163], a[12:15], a[36:39], v[160:163]
    ds_read_b64_tr_b16 a[70:71], v55 offset:41984
    v_mfma_f32_16x16x32_bf16 v[128:131], a[12:15], a[32:35], v[128:131]
    buffer_load_dwordx4 v16, s[8:11], s28 offen offset:3072 lds
    v_mfma_f32_16x16x32_bf16 v[132:135], a[16:19], a[32:35], v[132:135]
    ds_read_b64_tr_b16 a[72:73], v56 offset:40960
    v_mfma_f32_16x16x32_bf16 v[164:167], a[16:19], a[36:39], v[164:167]
    ds_read_b64_tr_b16 a[74:75], v56 offset:41984
    v_mfma_f32_16x16x32_bf16 v[196:199], a[16:19], a[40:43], v[196:199]
    ds_read_b64_tr_b16 a[76:77], v57 offset:40960
    v_mfma_f32_16x16x32_bf16 v[228:231], a[16:19], a[44:47], v[228:231]
    s_waitcnt vmcnt(6)
    v_cmp_gt_u32 vcc, 32, v252
    s_and_b64 vcc, vcc, exec
    s_cbranch_scc1 L_spin_rows
L_back_rows:
    buffer_load_dwordx2 v[108:109], v59, s[76:79], s46 offen offset:0 sc1
    buffer_load_dwordx2 v[110:111], v59, s[76:79], s46 offen offset:256 sc1
    buffer_load_dwordx2 v[112:113], v59, s[76:79], s46 offen offset:512 sc1
    buffer_load_dwordx2 v[114:115], v59, s[76:79], s46 offen offset:768 sc1
    ds_read_b64_tr_b16 a[78:79], v57 offset:41984
    v_mfma_f32_16x16x32_bf16 v[232:235], a[20:23], a[44:47], v[232:235]
    v_mfma_f32_16x16x32_bf16 v[200:203], a[20:23], a[40:43], v[200:203]
    v_mfma_f32_16x16x32_bf16 v[168:171], a[20:23], a[36:39], v[168:171]
    v_mfma_f32_16x16x32_bf16 v[136:139], a[20:23], a[32:35], v[136:139]
    v_mfma_f32_16x16x32_bf16 v[140:143], a[24:27], a[32:35], v[140:143]
    v_mfma_f32_16x16x32_bf16 v[172:175], a[24:27], a[36:39], v[172:175]
    v_mfma_f32_16x16x32_bf16 v[204:207], a[24:27], a[40:43], v[204:207]
    v_mfma_f32_16x16x32_bf16 v[236:239], a[24:27], a[44:47], v[236:239]
    v_mfma_f32_16x16x32_bf16 v[240:243], a[28:31], a[44:47], v[240:243]
    v_mfma_f32_16x16x32_bf16 v[208:211], a[28:31], a[40:43], v[208:211]
    v_mfma_f32_16x16x32_bf16 v[176:179], a[28:31], a[36:39], v[176:179]
    v_mfma_f32_16x16x32_bf16 v[144:147], a[28:31], a[32:35], v[144:147]
    s_add_u32 s28, s28, 16384
    s_waitcnt vmcnt(8) lgkmcnt(0)
    s_barrier
    v_mfma_f32_16x16x32_bf16 v[100:103], a[48:51], v[32:35], v[100:103]
    ds_read_b64_tr_b16 a[0:1], v50 offset:0
    v_mfma_f32_16x16x32_bf16 v[104:107], a[52:55], v[32:35], v[104:107]
    s_add_u32 m0, s34, 32768
    ds_read_b64_tr_b16 a[2:3], v50 offset:1024
    v_mfma_f32_16x16x32_bf16 v[116:119], a[48:51], a[80:83], v[116:119]
    buffer_load_dwordx4 v13, s[8:11], s28 offen offset:0 lds
    v_mfma_f32_16x16x32_bf16 v[148:151], a[48:51], a[84:87], v[148:151]
    ds_read_b128 a[32:35], v48 offset:0
    v_mfma_f32_16x16x32_bf16 v[180:183], a[48:51], a[88:91], v[180:183]
    ds_read_b128 a[36:39], v48 offset:2048
    v_mfma_f32_16x16x32_bf16 v[212:215], a[48:51], a[92:95], v[212:215]
    ds_read_b128 a[40:43], v48 offset:4096
    v_mfma_f32_16x16x32_bf16 v[216:219], a[52:55], a[92:95], v[216:219]
    ds_read_b128 a[44:47], v48 offset:6144
    v_mfma_f32_16x16x32_bf16 v[184:187], a[52:55], a[88:91], v[184:187]
    ds_read_b64_tr_b16 a[4:5], v51 offset:0
    v_mfma_f32_16x16x32_bf16 v[152:155], a[52:55], a[84:87], v[152:155]
    ds_read_b64_tr_b16 a[6:7], v51 offset:1024
    v_mfma_f32_16x16x32_bf16 v[120:123], a[52:55], a[80:83], v[120:123]
    buffer_load_dwordx4 v14, s[8:11], s28 offen offset:1024 lds
    v_mfma_f32_16x16x32_bf16 v[124:127], a[56:59], a[80:83], v[124:127]
    ds_read_b64_tr_b16 a[8:9], v52 offset:0
    v_mfma_f32_16x16x32_bf16 v[156:159], a[56:59], a[84:87], v[156:159]
    ds_read_b64_tr_b16 a[10:11], v52 offset:1024
    v_mfma_f32_16x16x32_bf16 v[188:191], a[56:59], a[88:91], v[188:191]
    ds_read_b64_tr_b16 a[12:13], v53 offset:0
    v_mfma_f32_16x16x32_bf16 v[220:223], a[56:59], a[92:95], v[220:223]
    ds_read_b64_tr_b16 a[14:15], v53 offset:1024
    v_mfma_f32_16x16x32_bf16 v[224:227], a[60:63], a[92:95], v[224:227]
    ds_read_b64_tr_b16 a[16:17], v54 offset:0
    v_mfma_f32_16x16x32_bf16 v[192:195], a[60:63], a[88:91], v[192:195]
    ds_read_b64_tr_b16 a[18:19], v54 offset:1024
    v_mfma_f32_16x16x32_bf16 v[160:163], a[60:63], a[84:87], v[160:163]
    ds_read_b64_tr_b16 a[20:21], v55 offset:0
    v_mfma_f32_16x16x32_bf16 v[128:131], a[60:63], a[80:83], v[128:131]
    buffer_load_dwordx4 v15, s[8:11], s28 offen offset:2048 lds
    v_mfma_f32_16x16x32_bf16 v[132:135], a[64:67], a[80:83], v[132:135]
    ds_read_b64_tr_b16 a[22:23], v55 offset:1024
    v_mfma_f32_16x16x32_bf16 v[164:167], a[64:67], a[84:87], v[164:167]
    ds_read_b64_tr_b16 a[24:25], v56 offset:0
    v_mfma_f32_16x16x32_bf16 v[196:199], a[64:67], a[88:91], v[196:199]
    ds_read_b64_tr_b16 a[26:27], v56 offset:1024
    v_mfma_f32_16x16x32_bf16 v[228:231], a[64:67], a[92:95], v[228:231]
    ds_read_b64_tr_b16 a[28:29], v57 offset:0
    v_mfma_f32_16x16x32_bf16 v[232:235], a[68:71], a[92:95], v[232:235]
    ds_read_b64_tr_b16 a[30:31], v57 offset:1024
    v_mfma_f32_16x16x32_bf16 v[200:203], a[68:71], a[88:91], v[200:203]
    v_mfma_f32_16x16x32_bf16 v[168:171], a[68:71], a[84:87], v[168:171]
    buffer_load_dwordx4 v16, s[8:11], s28 offen offset:3072 lds
    v_mfma_f32_16x16x32_bf16 v[136:139], a[68:71], a[80:83], v[136:139]
    v_mfma_f32_16x16x32_bf16 v[140:143], a[72:75], a[80:83], v[140:143]
    v_mfma_f32_16x16x32_bf16 v[172:175], a[72:75], a[84:87], v[172:175]
    v_mfma_f32_16x16x32_bf16 v[204:207], a[72:75], a[88:91], v[204:207]
    v_mfma_f32_16x16x32_bf16 v[236:239], a[72:75], a[92:95], v[236:239]
    v_mfma_f32_16x16x32_bf16 v[240:243], a[76:79], a[92:95], v[240:243]
    v_mfma_f32_16x16x32_bf16 v[208:211], a[76:79], a[88:91], v[208:211]
    v_mfma_f32_16x16x32_bf16 v[176:179], a[76:79], a[84:87], v[176:179]
    v_mfma_f32_16x16x32_bf16 v[144:147], a[76:79], a[80:83], v[144:147]
    s_waitcnt lgkmcnt(0)
    v_mfma_f32_16x16x32_bf16 v[100:103], a[0:3], v[32:35], v[100:103]
    ds_read_b64_tr_b16 a[48:49], v50 offset:8192
    v_mfma_f32_16x16x32_bf16 v[104:107], a[4:7], v[32:35], v[104:107]
    s_add_u32 s28, s28, 16384
    s_mov_b32 m0, s30
    ds_read_b64_tr_b16 a[50:51], v50 offset:9216
    v_mfma_f32_16x16x32_bf16 v[116:119], a[0:3], a[32:35], v[116:119]
    buffer_load_dwordx4 v17, s[12:15], s29 offen offset:0 lds
    v_mfma_f32_16x16x32_bf16 v[148:151], a[0:3], a[36:39], v[148:151]
    ds_read_b128 a[80:83], v49 offset:0
    v_mfma_f32_16x16x32_bf16 v[180:183], a[0:3], a[40:43], v[180:183]
    ds_read_b128 a[84:87], v49 offset:2048
    v_mfma_f32_16x16x32_bf16 v[212:215], a[0:3], a[44:47], v[212:215]
    ds_read_b128 a[88:91], v49 offset:4096
    v_mfma_f32_16x16x32_bf16 v[216:219], a[4:7], a[44:47], v[216:219]
    ds_read_b128 a[92:95], v49 offset:6144
    v_mfma_f32_16x16x32_bf16 v[184:187], a[4:7], a[40:43], v[184:187]
    ds_read_b64_tr_b16 a[52:53], v51 offset:8192
    v_mfma_f32_16x16x32_bf16 v[152:155], a[4:7], a[36:39], v[152:155]
    ds_read_b64_tr_b16 a[54:55], v51 offset:9216
    v_mfma_f32_16x16x32_bf16 v[120:123], a[4:7], a[32:35], v[120:123]
    buffer_load_dwordx4 v18, s[12:15], s29 offen offset:1024 lds
    v_mfma_f32_16x16x32_bf16 v[124:127], a[8:11], a[32:35], v[124:127]
    ds_read_b64_tr_b16 a[56:57], v52 offset:8192
    v_mfma_f32_16x16x32_bf16 v[156:159], a[8:11], a[36:39], v[156:159]
    ds_read_b64_tr_b16 a[58:59], v52 offset:9216
    v_mfma_f32_16x16x32_bf16 v[188:191], a[8:11], a[40:43], v[188:191]
    ds_read_b64_tr_b16 a[60:61], v53 offset:8192
    v_mfma_f32_16x16x32_bf16 v[220:223], a[8:11], a[44:47], v[220:223]
    ds_read_b64_tr_b16 a[62:63], v53 offset:9216
    v_mfma_f32_16x16x32_bf16 v[224:227], a[12:15], a[44:47], v[224:227]
    ds_read_b64_tr_b16 a[64:65], v54 offset:8192
    v_mfma_f32_16x16x32_bf16 v[192:195], a[12:15], a[40:43], v[192:195]
    ds_read_b64_tr_b16 a[66:67], v54 offset:9216
    v_mfma_f32_16x16x32_bf16 v[160:163], a[12:15], a[36:39], v[160:163]
    ds_read_b64_tr_b16 a[68:69], v55 offset:8192
    v_mfma_f32_16x16x32_bf16 v[128:131], a[12:15], a[32:35], v[128:131]
    buffer_load_dwordx4 v17, s[12:15], s29 offen offset:2048 lds
    v_mfma_f32_16x16x32_bf16 v[132:135], a[16:19], a[32:35], v[132:135]
    ds_read_b64_tr_b16 a[70:71], v55 offset:9216
    v_mfma_f32_16x16x32_bf16 v[164:167], a[16:19], a[36:39], v[164:167]
    ds_read_b64_tr_b16 a[72:73], v56 offset:8192
    v_mfma_f32_16x16x32_bf16 v[196:199], a[16:19], a[40:43], v[196:199]
    ds_read_b64_tr_b16 a[74:75], v56 offset:9216
    v_mfma_f32_16x16x32_bf16 v[228:231], a[16:19], a[44:47], v[228:231]
    ds_read_b64_tr_b16 a[76:77], v57 offset:8192
    v_mfma_f32_16x16x32_bf16 v[232:235], a[20:23], a[44:47], v[232:235]
    ds_read_b64_tr_b16 a[78:79], v57 offset:9216
    v_mfma_f32_16x16x32_bf16 v[200:203], a[20:23], a[40:43], v[200:203]
    v_mfma_f32_16x16x32_bf16 v[168:171], a[20:23], a[36:39], v[168:171]
    buffer_load_dwordx4 v18, s[12:15], s29 offen offset:3072 lds
    v_mfma_f32_16x16x32_bf16 v[136:139], a[20:23], a[32:35], v[136:139]
    v_mfma_f32_16x16x32_bf16 v[140:143], a[24:27], a[32:35], v[140:143]
    v_mfma_f32_16x16x32_bf16 v[172:175], a[24:27], a[36:39], v[172:175]
    v_mfma_f32_16x16x32_bf16 v[204:207], a[24:27], a[40:43], v[204:207]
    v_mfma_f32_16x16x32_bf16 v[236:239], a[24:27], a[44:47], v[236:239]
    v_mfma_f32_16x16x32_bf16 v[240:243], a[28:31], a[44:47], v[240:243]
    v_mfma_f32_16x16x32_bf16 v[208:211], a[28:31], a[40:43], v[208:211]
    v_mfma_f32_16x16x32_bf16 v[176:179], a[28:31], a[36:39], v[176:179]
    v_mfma_f32_16x16x32_bf16 v[144:147], a[28:31], a[32:35], v[144:147]
    s_add_u32 s29, s29, 16384
    s_waitcnt lgkmcnt(0)
    v_mfma_f32_16x16x32_bf16 v[100:103], a[48:51], v[32:35], v[100:103]
    ds_read_b128 a[128:131], v1 offset:49152
    v_mfma_f32_16x16x32_bf16 v[104:107], a[52:55], v[32:35], v[104:107]
    ds_read_b128 a[132:135], v2 offset:49152
    v_mfma_f32_16x16x32_bf16 v[116:119], a[48:51], a[80:83], v[116:119]
    ds_read_b128 a[136:139], v3 offset:49152
    v_mfma_f32_16x16x32_bf16 v[120:123], a[52:55], a[80:83], v[120:123]
    ds_read_b128 a[140:143], v4 offset:49152
    v_mfma_f32_16x16x32_bf16 v[124:127], a[56:59], a[80:83], v[124:127]
    ds_read_b128 a[144:147], v1 offset:53248
    v_mfma_f32_16x16x32_bf16 v[128:131], a[60:63], a[80:83], v[128:131]
    ds_read_b128 a[148:151], v2 offset:53248
    v_mfma_f32_16x16x32_bf16 v[132:135], a[64:67], a[80:83], v[132:135]
    ds_read_b128 a[152:155], v3 offset:53248
    v_mfma_f32_16x16x32_bf16 v[136:139], a[68:71], a[80:83], v[136:139]
    ds_read_b128 a[156:159], v4 offset:53248
    v_mfma_f32_16x16x32_bf16 v[140:143], a[72:75], a[80:83], v[140:143]
    v_mfma_f32_16x16x32_bf16 v[144:147], a[76:79], a[80:83], v[144:147]
    v_mfma_f32_16x16x32_bf16 v[148:151], a[48:51], a[84:87], v[148:151]
    ds_write_b128 v58, v[100:103] offset:0
    v_mfma_f32_16x16x32_bf16 v[152:155], a[52:55], a[84:87], v[152:155]
    ds_write_b128 v58, v[104:107] offset:64
    v_mfma_f32_16x16x32_bf16 v[156:159], a[56:59], a[84:87], v[156:159]
    ds_write_b128 v58, v[100:103] offset:512
    v_mfma_f32_16x16x32_bf16 v[160:163], a[60:63], a[84:87], v[160:163]
    ds_write_b128 v58, v[104:107] offset:576
    v_mfma_f32_16x16x32_bf16 v[164:167], a[64:67], a[84:87], v[164:167]
    v_mfma_f32_16x16x32_bf16 v[168:171], a[68:71], a[84:87], v[168:171]
    v_mfma_f32_16x16x32_bf16 v[172:175], a[72:75], a[84:87], v[172:175]
    v_mfma_f32_16x16x32_bf16 v[176:179], a[76:79], a[84:87], v[176:179]
    s_waitcnt lgkmcnt(0)
    s_barrier
    v_mfma_f32_16x16x32_bf16 v[180:183], a[48:51], a[88:91], v[180:183]
    ds_read_b128 v[68:71], v58 offset:0
    v_mfma_f32_16x16x32_bf16 v[184:187], a[52:55], a[88:91], v[184:187]
    ds_read_b128 v[72:75], v58 offset:64
    v_mfma_f32_16x16x32_bf16 v[188:191], a[56:59], a[88:91], v[188:191]
    ds_read_b128 v[76:79], v58 offset:128
    v_mfma_f32_16x16x32_bf16 v[192:195], a[60:63], a[88:91], v[192:195]
    ds_read_b128 v[80:83], v58 offset:192
    v_mfma_f32_16x16x32_bf16 v[196:199], a[64:67], a[88:91], v[196:199]
    ds_read_b128 v[84:87], v58 offset:256
    v_mfma_f32_16x16x32_bf16 v[200:203], a[68:71], a[88:91], v[200:203]
    ds_read_b128 v[88:91], v58 offset:320
    v_mfma_f32_16x16x32_bf16 v[204:207], a[72:75], a[88:91], v[204:207]
    ds_read_b128 v[92:95], v58 offset:384
    v_mfma_f32_16x16x32_bf16 v[208:211], a[76:79], a[88:91], v[208:211]
    ds_read_b128 v[96:99], v58 offset:448
    v_mfma_f32_16x16x32_bf16 v[212:215], a[48:51], a[92:95], v[212:215]
    v_mfma_f32_16x16x32_bf16 v[216:219], a[52:55], a[92:95], v[216:219]
    v_mfma_f32_16x16x32_bf16 v[220:223], a[56:59], a[92:95], v[220:223]
    v_mfma_f32_16x16x32_bf16 v[224:227], a[60:63], a[92:95], v[224:227]
    v_mfma_f32_16x16x32_bf16 v[228:231], a[64:67], a[92:95], v[228:231]
    v_mfma_f32_16x16x32_bf16 v[232:235], a[68:71], a[92:95], v[232:235]
    v_mfma_f32_16x16x32_bf16 v[236:239], a[72:75], a[92:95], v[236:239]
    v_mfma_f32_16x16x32_bf16 v[240:243], a[76:79], a[92:95], v[240:243]
    s_waitcnt vmcnt(8) lgkmcnt(0)
    v_mul_f32 v109, s44, v109
    v_mul_f32 v111, s44, v111
    v_mul_f32 v113, s44, v113
    v_mul_f32 v115, s44, v115
    ds_read_b128 a[160:163], v1 offset:57344
    ds_read_b128 a[164:167], v2 offset:57344
    ds_read_b128 a[168:171], v3 offset:57344
    ds_read_b128 a[172:175], v4 offset:57344
    ds_read_b128 a[176:179], v1 offset:61440
    ds_read_b128 a[180:183], v2 offset:61440
    ds_read_b128 a[184:187], v3 offset:61440
    ds_read_b128 a[188:191], v4 offset:61440
    v_pk_fma_f32 v[116:117], v[108:109], v[68:69], v[116:117] op_sel_hi:[0,1,1] neg_lo:[1,0,0] neg_hi:[1,0,0]
    v_pk_fma_f32 v[118:119], v[108:109], v[70:71], v[118:119] op_sel_hi:[0,1,1] neg_lo:[1,0,0] neg_hi:[1,0,0]
    v_pk_fma_f32 v[120:121], v[108:109], v[72:73], v[120:121] op_sel_hi:[0,1,1] neg_lo:[1,0,0] neg_hi:[1,0,0]
    v_pk_fma_f32 v[122:123], v[108:109], v[74:75], v[122:123] op_sel_hi:[0,1,1] neg_lo:[1,0,0] neg_hi:[1,0,0]
    v_pk_fma_f32 v[124:125], v[108:109], v[76:77], v[124:125] op_sel_hi:[0,1,1] neg_lo:[1,0,0] neg_hi:[1,0,0]
    v_pk_fma_f32 v[126:127], v[108:109], v[78:79], v[126:127] op_sel_hi:[0,1,1] neg_lo:[1,0,0] neg_hi:[1,0,0]
    v_pk_fma_f32 v[128:129], v[108:109], v[80:81], v[128:129] op_sel_hi:[0,1,1] neg_lo:[1,0,0] neg_hi:[1,0,0]
    v_pk_fma_f32 v[130:131], v[108:109], v[82:83], v[130:131] op_sel_hi:[0,1,1] neg_lo:[1,0,0] neg_hi:[1,0,0]
    v_pk_fma_f32 v[132:133], v[108:109], v[84:85], v[132:133] op_sel_hi:[0,1,1] neg_lo:[1,0,0] neg_hi:[1,0,0]
    v_pk_fma_f32 v[134:135], v[108:109], v[86:87], v[134:135] op_sel_hi:[0,1,1] neg_lo:[1,0,0] neg_hi:[1,0,0]
    v_pk_fma_f32 v[136:137], v[108:109], v[88:89], v[136:137] op_sel_hi:[0,1,1] neg_lo:[1,0,0] neg_hi:[1,0,0]
    v_pk_fma_f32 v[138:139], v[108:109], v[90:91], v[138:139] op_sel_hi:[0,1,1] neg_lo:[1,0,0] neg_hi:[1,0,0]
    v_pk_fma_f32 v[140:141], v[108:109], v[92:93], v[140:141] op_sel_hi:[0,1,1] neg_lo:[1,0,0] neg_hi:[1,0,0]
    v_pk_fma_f32 v[142:143], v[108:109], v[94:95], v[142:143] op_sel_hi:[0,1,1] neg_lo:[1,0,0] neg_hi:[1,0,0]
    v_pk_fma_f32 v[144:145], v[108:109], v[96:97], v[144:145] op_sel_hi:[0,1,1] neg_lo:[1,0,0] neg_hi:[1,0,0]
    v_pk_fma_f32 v[146:147], v[108:109], v[98:99], v[146:147] op_sel_hi:[0,1,1] neg_lo:[1,0,0] neg_hi:[1,0,0]
    v_pk_fma_f32 v[148:149], v[110:111], v[68:69], v[148:149] op_sel_hi:[0,1,1] neg_lo:[1,0,0] neg_hi:[1,0,0]
    v_pk_fma_f32 v[150:151], v[110:111], v[70:71], v[150:151] op_sel_hi:[0,1,1] neg_lo:[1,0,0] neg_hi:[1,0,0]
    v_pk_fma_f32 v[152:153], v[110:111], v[72:73], v[152:153] op_sel_hi:[0,1,1] neg_lo:[1,0,0] neg_hi:[1,0,0]
    v_pk_fma_f32 v[154:155], v[110:111], v[74:75], v[154:155] op_sel_hi:[0,1,1] neg_lo:[1,0,0] neg_hi:[1,0,0]
    v_pk_fma_f32 v[156:157], v[110:111], v[76:77], v[156:157] op_sel_hi:[0,1,1] neg_lo:[1,0,0] neg_hi:[1,0,0]
    v_pk_fma_f32 v[158:159], v[110:111], v[78:79], v[158:159] op_sel_hi:[0,1,1] neg_lo:[1,0,0] neg_hi:[1,0,0]
    v_pk_fma_f32 v[160:161], v[110:111], v[80:81], v[160:161] op_sel_hi:[0,1,1] neg_lo:[1,0,0] neg_hi:[1,0,0]
    v_pk_fma_f32 v[162:163], v[110:111], v[82:83], v[162:163] op_sel_hi:[0,1,1] neg_lo:[1,0,0] neg_hi:[1,0,0]
    v_pk_fma_f32 v[164:165], v[110:111], v[84:85], v[164:165] op_sel_hi:[0,1,1] neg_lo:[1,0,0] neg_hi:[1,0,0]
    v_pk_fma_f32 v[166:167], v[110:111], v[86:87], v[166:167] op_sel_hi:[0,1,1] neg_lo:[1,0,0] neg_hi:[1,0,0]
    v_pk_fma_f32 v[168:169], v[110:111], v[88:89], v[168:169] op_sel_hi:[0,1,1] neg_lo:[1,0,0] neg_hi:[1,0,0]
    v_pk_fma_f32 v[170:171], v[110:111], v[90:91], v[170:171] op_sel_hi:[0,1,1] neg_lo:[1,0,0] neg_hi:[1,0,0]
    v_pk_fma_f32 v[172:173], v[110:111], v[92:93], v[172:173] op_sel_hi:[0,1,1] neg_lo:[1,0,0] neg_hi:[1,0,0]
    v_pk_fma_f32 v[174:175], v[110:111], v[94:95], v[174:175] op_sel_hi:[0,1,1] neg_lo:[1,0,0] neg_hi:[1,0,0]
    v_pk_fma_f32 v[176:177], v[110:111], v[96:97], v[176:177] op_sel_hi:[0,1,1] neg_lo:[1,0,0] neg_hi:[1,0,0]
    v_pk_fma_f32 v[178:179], v[110:111], v[98:99], v[178:179] op_sel_hi:[0,1,1] neg_lo:[1,0,0] neg_hi:[1,0,0]
    v_pk_fma_f32 v[180:181], v[112:113], v[68:69], v[180:181] op_sel_hi:[0,1,1] neg_lo:[1,0,0] neg_hi:[1,0,0]
    v_pk_fma_f32 v[182:183], v[112:113], v[70:71], v[182:183] op_sel_hi:[0,1,1] neg_lo:[1,0,0] neg_hi:[1,0,0]
    v_pk_fma_f32 v[184:185], v[112:113], v[72:73], v[184:185] op_sel_hi:[0,1,1] neg_lo:[1,0,0] neg_hi:[1,0,0]
    v_pk_fma_f32 v[186:187], v[112:113], v[74:75], v[186:187] op_sel_hi:[0,1,1] neg_lo:[1,0,0] neg_hi:[1,0,0]
    v_pk_fma_f32 v[188:189], v[112:113], v[76:77], v[188:189] op_sel_hi:[0,1,1] neg_lo:[1,0,0] neg_hi:[1,0,0]
    v_pk_fma_f32 v[190:191], v[112:113], v[78:79], v[190:191] op_sel_hi:[0,1,1] neg_lo:[1,0,0] neg_hi:[1,0,0]
    v_pk_fma_f32 v[192:193], v[112:113], v[80:81], v[192:193] op_sel_hi:[0,1,1] neg_lo:[1,0,0] neg_hi:[1,0,0]
    v_pk_fma_f32 v[194:195], v[112:113], v[82:83], v[194:195] op_sel_hi:[0,1,1] neg_lo:[1,0,0] neg_hi:[1,0,0]
    v_pk_fma_f32 v[196:197], v[112:113], v[84:85], v[196:197] op_sel_hi:[0,1,1] neg_lo:[1,0,0] neg_hi:[1,0,0]
    v_pk_fma_f32 v[198:199], v[112:113], v[86:87], v[198:199] op_sel_hi:[0,1,1] neg_lo:[1,0,0] neg_hi:[1,0,0]
    v_pk_fma_f32 v[200:201], v[112:113], v[88:89], v[200:201] op_sel_hi:[0,1,1] neg_lo:[1,0,0] neg_hi:[1,0,0]
    v_pk_fma_f32 v[202:203], v[112:113], v[90:91], v[202:203] op_sel_hi:[0,1,1] neg_lo:[1,0,0] neg_hi:[1,0,0]
    v_pk_fma_f32 v[204:205], v[112:113], v[92:93], v[204:205] op_sel_hi:[0,1,1] neg_lo:[1,0,0] neg_hi:[1,0,0]
    v_pk_fma_f32 v[206:207], v[112:113], v[94:95], v[206:207] op_sel_hi:[0,1,1] neg_lo:[1,0,0] neg_hi:[1,0,0]
    v_pk_fma_f32 v[208:209], v[112:113], v[96:97], v[208:209] op_sel_hi:[0,1,1] neg_lo:[1,0,0] neg_hi:[1,0,0]
    v_pk_fma_f32 v[210:211], v[112:113], v[98:99], v[210:211] op_sel_hi:[0,1,1] neg_lo:[1,0,0] neg_hi:[1,0,0]
    v_pk_fma_f32 v[212:213], v[114:115], v[68:69], v[212:213] op_sel_hi:[0,1,1] neg_lo:[1,0,0] neg_hi:[1,0,0]
    v_pk_fma_f32 v[214:215], v[114:115], v[70:71], v[214:215] op_sel_hi:[0,1,1] neg_lo:[1,0,0] neg_hi:[1,0,0]
    v_pk_fma_f32 v[216:217], v[114:115], v[72:73], v[216:217] op_sel_hi:[0,1,1] neg_lo:[1,0,0] neg_hi:[1,0,0]
    v_pk_fma_f32 v[218:219], v[114:115], v[74:75], v[218:219] op_sel_hi:[0,1,1] neg_lo:[1,0,0] neg_hi:[1,0,0]
    v_pk_fma_f32 v[220:221], v[114:115], v[76:77], v[220:221] op_sel_hi:[0,1,1] neg_lo:[1,0,0] neg_hi:[1,0,0]
    v_pk_fma_f32 v[222:223], v[114:115], v[78:79], v[222:223] op_sel_hi:[0,1,1] neg_lo:[1,0,0] neg_hi:[1,0,0]
    v_pk_fma_f32 v[224:225], v[114:115], v[80:81], v[224:225] op_sel_hi:[0,1,1] neg_lo:[1,0,0] neg_hi:[1,0,0]
    v_pk_fma_f32 v[226:227], v[114:115], v[82:83], v[226:227] op_sel_hi:[0,1,1] neg_lo:[1,0,0] neg_hi:[1,0,0]
    v_pk_fma_f32 v[228:229], v[114:115], v[84:85], v[228:229] op_sel_hi:[0,1,1] neg_lo:[1,0,0] neg_hi:[1,0,0]
    v_pk_fma_f32 v[230:231], v[114:115], v[86:87], v[230:231] op_sel_hi:[0,1,1] neg_lo:[1,0,0] neg_hi:[1,0,0]
    v_pk_fma_f32 v[232:233], v[114:115], v[88:89], v[232:233] op_sel_hi:[0,1,1] neg_lo:[1,0,0] neg_hi:[1,0,0]
    v_pk_fma_f32 v[234:235], v[114:115], v[90:91], v[234:235] op_sel_hi:[0,1,1] neg_lo:[1,0,0] neg_hi:[1,0,0]
    v_pk_fma_f32 v[236:237], v[114:115], v[92:93], v[236:237] op_sel_hi:[0,1,1] neg_lo:[1,0,0] neg_hi:[1,0,0]
    v_pk_fma_f32 v[238:239], v[114:115], v[94:95], v[238:239] op_sel_hi:[0,1,1] neg_lo:[1,0,0] neg_hi:[1,0,0]
    v_pk_fma_f32 v[240:241], v[114:115], v[96:97], v[240:241] op_sel_hi:[0,1,1] neg_lo:[1,0,0] neg_hi:[1,0,0]
    v_pk_fma_f32 v[242:243], v[114:115], v[98:99], v[242:243] op_sel_hi:[0,1,1] neg_lo:[1,0,0] neg_hi:[1,0,0]
    v_pk_mul_f32 v[116:117], v[116:117], v[108:109] op_sel:[0,1] op_sel_hi:[1,1]
    v_pk_mul_f32 v[118:119], v[118:119], v[108:109] op_sel:[0,1] op_sel_hi:[1,1]
    v_pk_mul_f32 v[120:121], v[120:121], v[108:109] op_sel:[0,1] op_sel_hi:[1,1]
    v_pk_mul_f32 v[122:123], v[122:123], v[108:109] op_sel:[0,1] op_sel_hi:[1,1]
    v_pk_mul_f32 v[124:125], v[124:125], v[108:109] op_sel:[0,1] op_sel_hi:[1,1]
    v_pk_mul_f32 v[126:127], v[126:127], v[108:109] op_sel:[0,1] op_sel_hi:[1,1]
    v_pk_mul_f32 v[128:129], v[128:129], v[108:109] op_sel:[0,1] op_sel_hi:[1,1]
    v_pk_mul_f32 v[130:131], v[130:131], v[108:109] op_sel:[0,1] op_sel_hi:[1,1]
    v_pk_mul_f32 v[132:133], v[132:133], v[108:109] op_sel:[0,1] op_sel_hi:[1,1]
    v_pk_mul_f32 v[134:135], v[134:135], v[108:109] op_sel:[0,1] op_sel_hi:[1,1]
    v_pk_mul_f32 v[136:137], v[136:137], v[108:109] op_sel:[0,1] op_sel_hi:[1,1]
    v_pk_mul_f32 v[138:139], v[138:139], v[108:109] op_sel:[0,1] op_sel_hi:[1,1]
    v_pk_mul_f32 v[140:141], v[140:141], v[108:109] op_sel:[0,1] op_sel_hi:[1,1]
    v_pk_mul_f32 v[142:143], v[142:143], v[108:109] op_sel:[0,1] op_sel_hi:[1,1]
    v_pk_mul_f32 v[144:145], v[144:145], v[108:109] op_sel:[0,1] op_sel_hi:[1,1]
    v_pk_mul_f32 v[146:147], v[146:147], v[108:109] op_sel:[0,1] op_sel_hi:[1,1]
    v_cvt_pk_bf16_f32 v36, v116, v117
    v_cvt_pk_bf16_f32 v37, v118, v119
    v_cvt_pk_bf16_f32 v38, v120, v121
    v_cvt_pk_bf16_f32 v39, v122, v123
    v_cvt_pk_bf16_f32 v40, v124, v125
    v_cvt_pk_bf16_f32 v41, v126, v127
    v_cvt_pk_bf16_f32 v42, v128, v129
    v_cvt_pk_bf16_f32 v43, v130, v131
    v_cvt_pk_bf16_f32 v44, v132, v133
    v_cvt_pk_bf16_f32 v45, v134, v135
    v_cvt_pk_bf16_f32 v46, v136, v137
    v_cvt_pk_bf16_f32 v47, v138, v139
    v_cvt_pk_bf16_f32 v48, v140, v141
    v_cvt_pk_bf16_f32 v49, v142, v143
    v_cvt_pk_bf16_f32 v50, v144, v145
    v_cvt_pk_bf16_f32 v51, v146, v147
    v_permlane32_swap_b32 v36, v38
    v_permlane32_swap_b32 v37, v39
    v_permlane32_swap_b32 v40, v42
    v_permlane32_swap_b32 v41, v43
    v_permlane32_swap_b32 v44, v46
    v_permlane32_swap_b32 v45, v47
    v_permlane32_swap_b32 v48, v50
    v_permlane32_swap_b32 v49, v51
    v_permlane16_swap_b32 v36, v38
    v_permlane16_swap_b32 v37, v39
    v_permlane16_swap_b32 v40, v42
    v_permlane16_swap_b32 v41, v43
    v_permlane16_swap_b32 v44, v46
    v_permlane16_swap_b32 v45, v47
    v_permlane16_swap_b32 v48, v50
    v_permlane16_swap_b32 v49, v51
    s_nop 1
    v_mfma_f32_16x16x32_bf16 v[116:119], a[128:131], v[36:39], 0
    v_pk_mul_f32 v[148:149], v[148:149], v[110:111] op_sel:[0,1] op_sel_hi:[1,1]
    v_pk_mul_f32 v[150:151], v[150:151], v[110:111] op_sel:[0,1] op_sel_hi:[1,1]
    v_pk_mul_f32 v[152:153], v[152:153], v[110:111] op_sel:[0,1] op_sel_hi:[1,1]
    v_pk_mul_f32 v[154:155], v[154:155], v[110:111] op_sel:[0,1] op_sel_hi:[1,1]
    v_pk_mul_f32 v[156:157], v[156:157], v[110:111] op_sel:[0,1] op_sel_hi:[1,1]
    v_pk_mul_f32 v[158:159], v[158:159], v[110:111] op_sel:[0,1] op_sel_hi:[1,1]
    v_mfma_f32_16x16x32_bf16 v[116:119], a[132:135], v[40:43], v[116:119]
    v_pk_mul_f32 v[160:161], v[160:161], v[110:111] op_sel:[0,1] op_sel_hi:[1,1]
    v_pk_mul_f32 v[162:163], v[162:163], v[110:111] op_sel:[0,1] op_sel_hi:[1,1]
    v_pk_mul_f32 v[164:165], v[164:165], v[110:111] op_sel:[0,1] op_sel_hi:[1,1]
    v_pk_mul_f32 v[166:167], v[166:167], v[110:111] op_sel:[0,1] op_sel_hi:[1,1]
    v_pk_mul_f32 v[168:169], v[168:169], v[110:111] op_sel:[0,1] op_sel_hi:[1,1]
    v_pk_mul_f32 v[170:171], v[170:171], v[110:111] op_sel:[0,1] op_sel_hi:[1,1]
    v_mfma_f32_16x16x32_bf16 v[116:119], a[136:139], v[44:47], v[116:119]
    v_pk_mul_f32 v[172:173], v[172:173], v[110:111] op_sel:[0,1] op_sel_hi:[1,1]
    v_pk_mul_f32 v[174:175], v[174:175], v[110:111] op_sel:[0,1] op_sel_hi:[1,1]
    v_pk_mul_f32 v[176:177], v[176:177], v[110:111] op_sel:[0,1] op_sel_hi:[1,1]
    v_pk_mul_f32 v[178:179], v[178:179], v[110:111] op_sel:[0,1] op_sel_hi:[1,1]
    v_cvt_pk_bf16_f32 v52, v148, v149
    v_cvt_pk_bf16_f32 v53, v150, v151
    v_mfma_f32_16x16x32_bf16 v[116:119], a[140:143], v[48:51], v[116:119]
    v_cvt_pk_bf16_f32 v54, v152, v153
    v_cvt_pk_bf16_f32 v55, v154, v155
    v_cvt_pk_bf16_f32 v56, v156, v157
    v_cvt_pk_bf16_f32 v57, v158, v159
    v_cvt_pk_bf16_f32 v58, v160, v161
    v_cvt_pk_bf16_f32 v59, v162, v163
    v_mfma_f32_16x16x32_bf16 v[132:135], a[144:147], v[36:39], 0
    v_cvt_pk_bf16_f32 v60, v164, v165
    v_cvt_pk_bf16_f32 v61, v166, v167
    v_cvt_pk_bf16_f32 v62, v168, v169
    v_cvt_pk_bf16_f32 v63, v170, v171
    v_cvt_pk_bf16_f32 v64, v172, v173
    v_cvt_pk_bf16_f32 v65, v174, v175
    v_mfma_f32_16x16x32_bf16 v[132:135], a[148:151], v[40:43], v[132:135]
    v_cvt_pk_bf16_f32 v66, v176, v177
    v_cvt_pk_bf16_f32 v67, v178, v179
    v_permlane32_swap_b32 v52, v54
    v_permlane32_swap_b32 v53, v55
    v_permlane32_swap_b32 v56, v58
    v_permlane32_swap_b32 v57, v59
    v_mfma_f32_16x16x32_bf16 v[132:135], a[152:155], v[44:47], v[132:135]
    v_permlane32_swap_b32 v60, v62
    v_permlane32_swap_b32 v61, v63
    v_permlane32_swap_b32 v64, v66
    v_permlane32_swap_b32 v65, v67
    v_permlane16_swap_b32 v52, v54
    v_permlane16_swap_b32 v53, v55
    v_mfma_f32_16x16x32_bf16 v[132:135], a[156:159], v[48:51], v[132:135]
    v_permlane16_swap_b32 v56, v58
    v_permlane16_swap_b32 v57, v59
    v_permlane16_swap_b32 v60, v62
    v_permlane16_swap_b32 v61, v63
    v_permlane16_swap_b32 v64, v66
    v_permlane16_swap_b32 v65, v67
    s_nop 1
    v_mfma_f32_16x16x32_bf16 v[120:123], a[140:143], v[64:67], 0
    v_pk_mul_f32 v[180:181], v[180:181], v[112:113] op_sel:[0,1] op_sel_hi:[1,1]
    v_pk_mul_f32 v[182:183], v[182:183], v[112:113] op_sel:[0,1] op_sel_hi:[1,1]
    v_pk_mul_f32 v[184:185], v[184:185], v[112:113] op_sel:[0,1] op_sel_hi:[1,1]
    v_pk_mul_f32 v[186:187], v[186:187], v[112:113] op_sel:[0,1] op_sel_hi:[1,1]
    v_pk_mul_f32 v[188:189], v[188:189], v[112:113] op_sel:[0,1] op_sel_hi:[1,1]
    v_pk_mul_f32 v[190:191], v[190:191], v[112:113] op_sel:[0,1] op_sel_hi:[1,1]
    v_mfma_f32_16x16x32_bf16 v[120:123], a[136:139], v[60:63], v[120:123]
    v_pk_mul_f32 v[192:193], v[192:193], v[112:113] op_sel:[0,1] op_sel_hi:[1,1]
    v_pk_mul_f32 v[194:195], v[194:195], v[112:113] op_sel:[0,1] op_sel_hi:[1,1]
    v_pk_mul_f32 v[196:197], v[196:197], v[112:113] op_sel:[0,1] op_sel_hi:[1,1]
    v_pk_mul_f32 v[198:199], v[198:199], v[112:113] op_sel:[0,1] op_sel_hi:[1,1]
    v_pk_mul_f32 v[200:201], v[200:201], v[112:113] op_sel:[0,1] op_sel_hi:[1,1]
    v_pk_mul_f32 v[202:203], v[202:203], v[112:113] op_sel:[0,1] op_sel_hi:[1,1]
    v_mfma_f32_16x16x32_bf16 v[120:123], a[132:135], v[56:59], v[120:123]
    v_pk_mul_f32 v[204:205], v[204:205], v[112:113] op_sel:[0,1] op_sel_hi:[1,1]
    v_pk_mul_f32 v[206:207], v[206:207], v[112:113] op_sel:[0,1] op_sel_hi:[1,1]
    v_pk_mul_f32 v[208:209], v[208:209], v[112:113] op_sel:[0,1] op_sel_hi:[1,1]
    v_pk_mul_f32 v[210:211], v[210:211], v[112:113] op_sel:[0,1] op_sel_hi:[1,1]
    v_cvt_pk_bf16_f32 v68, v180, v181
    v_cvt_pk_bf16_f32 v69, v182, v183
    v_mfma_f32_16x16x32_bf16 v[120:123], a[128:131], v[52:55], v[120:123]
    v_cvt_pk_bf16_f32 v70, v184, v185
    v_cvt_pk_bf16_f32 v71, v186, v187
    v_cvt_pk_bf16_f32 v72, v188, v189
    v_cvt_pk_bf16_f32 v73, v190, v191
    v_cvt_pk_bf16_f32 v74, v192, v193
    v_cvt_pk_bf16_f32 v75, v194, v195
    v_mfma_f32_16x16x32_bf16 v[136:139], a[156:159], v[64:67], 0
    v_cvt_pk_bf16_f32 v76, v196, v197
    v_cvt_pk_bf16_f32 v77, v198, v199
    v_cvt_pk_bf16_f32 v78, v200, v201
    v_cvt_pk_bf16_f32 v79, v202, v203
    v_cvt_pk_bf16_f32 v80, v204, v205
    v_cvt_pk_bf16_f32 v81, v206, v207
    v_mfma_f32_16x16x32_bf16 v[136:139], a[152:155], v[60:63], v[136:139]
    v_cvt_pk_bf16_f32 v82, v208, v209
    v_cvt_pk_bf16_f32 v83, v210, v211
    v_permlane32_swap_b32 v68, v70
    v_permlane32_swap_b32 v69, v71
    v_permlane32_swap_b32 v72, v74
    v_permlane32_swap_b32 v73, v75
    v_mfma_f32_16x16x32_bf16 v[136:139], a[148:151], v[56:59], v[136:139]
    v_permlane32_swap_b32 v76, v78
    v_permlane32_swap_b32 v77, v79
    v_permlane32_swap_b32 v80, v82
    v_permlane32_swap_b32 v81, v83
    v_permlane16_swap_b32 v68, v70
    v_permlane16_swap_b32 v69, v71
    v_mfma_f32_16x16x32_bf16 v[136:139], a[144:147], v[52:55], v[136:139]
    v_permlane16_swap_b32 v72, v74
    v_permlane16_swap_b32 v73, v75
    v_permlane16_swap_b32 v76, v78
    v_permlane16_swap_b32 v77, v79
    v_permlane16_swap_b32 v80, v82
    v_permlane16_swap_b32 v81, v83
    s_nop 1
    v_mfma_f32_16x16x32_bf16 v[124:127], a[128:131], v[68:71], 0
    v_pk_mul_f32 v[212:213], v[212:213], v[114:115] op_sel:[0,1] op_sel_hi:[1,1]
    v_pk_mul_f32 v[214:215], v[214:215], v[114:115] op_sel:[0,1] op_sel_hi:[1,1]
    v_pk_mul_f32 v[216:217], v[216:217], v[114:115] op_sel:[0,1] op_sel_hi:[1,1]
    v_pk_mul_f32 v[218:219], v[218:219], v[114:115] op_sel:[0,1] op_sel_hi:[1,1]
    v_pk_mul_f32 v[220:221], v[220:221], v[114:115] op_sel:[0,1] op_sel_hi:[1,1]
    v_pk_mul_f32 v[222:223], v[222:223], v[114:115] op_sel:[0,1] op_sel_hi:[1,1]
    v_mfma_f32_16x16x32_bf16 v[124:127], a[132:135], v[72:75], v[124:127]
    v_pk_mul_f32 v[224:225], v[224:225], v[114:115] op_sel:[0,1] op_sel_hi:[1,1]
    v_pk_mul_f32 v[226:227], v[226:227], v[114:115] op_sel:[0,1] op_sel_hi:[1,1]
    v_pk_mul_f32 v[228:229], v[228:229], v[114:115] op_sel:[0,1] op_sel_hi:[1,1]
    v_pk_mul_f32 v[230:231], v[230:231], v[114:115] op_sel:[0,1] op_sel_hi:[1,1]
    v_pk_mul_f32 v[232:233], v[232:233], v[114:115] op_sel:[0,1] op_sel_hi:[1,1]
    v_pk_mul_f32 v[234:235], v[234:235], v[114:115] op_sel:[0,1] op_sel_hi:[1,1]
    v_mfma_f32_16x16x32_bf16 v[124:127], a[136:139], v[76:79], v[124:127]
    v_pk_mul_f32 v[236:237], v[236:237], v[114:115] op_sel:[0,1] op_sel_hi:[1,1]
    v_pk_mul_f32 v[238:239], v[238:239], v[114:115] op_sel:[0,1] op_sel_hi:[1,1]
    v_pk_mul_f32 v[240:241], v[240:241], v[114:115] op_sel:[0,1] op_sel_hi:[1,1]
    v_pk_mul_f32 v[242:243], v[242:243], v[114:115] op_sel:[0,1] op_sel_hi:[1,1]
    v_cvt_pk_bf16_f32 v84, v212, v213
    v_cvt_pk_bf16_f32 v85, v214, v215
    v_mfma_f32_16x16x32_bf16 v[124:127], a[140:143], v[80:83], v[124:127]
    v_cvt_pk_bf16_f32 v86, v216, v217
    v_cvt_pk_bf16_f32 v87, v218, v219
    v_cvt_pk_bf16_f32 v88, v220, v221
    v_cvt_pk_bf16_f32 v89, v222, v223
    v_cvt_pk_bf16_f32 v90, v224, v225
    v_cvt_pk_bf16_f32 v91, v226, v227
    v_mfma_f32_16x16x32_bf16 v[140:143], a[144:147], v[68:71], 0
    v_cvt_pk_bf16_f32 v92, v228, v229
    v_cvt_pk_bf16_f32 v93, v230, v231
    v_cvt_pk_bf16_f32 v94, v232, v233
    v_cvt_pk_bf16_f32 v95, v234, v235
    v_cvt_pk_bf16_f32 v96, v236, v237
    v_cvt_pk_bf16_f32 v97, v238, v239
    v_mfma_f32_16x16x32_bf16 v[140:143], a[148:151], v[72:75], v[140:143]
    v_cvt_pk_bf16_f32 v98, v240, v241
    v_cvt_pk_bf16_f32 v99, v242, v243
    v_permlane32_swap_b32 v84, v86
    v_permlane32_swap_b32 v85, v87
    v_permlane32_swap_b32 v88, v90
    v_permlane32_swap_b32 v89, v91
    v_mfma_f32_16x16x32_bf16 v[140:143], a[152:155], v[76:79], v[140:143]
    v_permlane32_swap_b32 v92, v94
    v_permlane32_swap_b32 v93, v95
    v_permlane32_swap_b32 v96, v98
    v_permlane32_swap_b32 v97, v99
    v_permlane16_swap_b32 v84, v86
    v_permlane16_swap_b32 v85, v87
    v_mfma_f32_16x16x32_bf16 v[140:143], a[156:159], v[80:83], v[140:143]
    v_permlane16_swap_b32 v88, v90
    v_permlane16_swap_b32 v89, v91
    v_permlane16_swap_b32 v92, v94
    v_permlane16_swap_b32 v93, v95
    v_permlane16_swap_b32 v96, v98
    v_permlane16_swap_b32 v97, v99
    s_nop 1
    v_mfma_f32_16x16x32_bf16 v[128:131], a[140:143], v[96:99], 0
    v_max3_f32 v28, v116, v117, v118
    v_max3_f32 v29, v119, v132, v133
    v_max3_f32 v28, v28, v134, v135
    v_max_f32 v28, v28, v29
    v_mov_b32 v29, v28
    s_nop 1
    v_mfma_f32_16x16x32_bf16 v[128:131], a[136:139], v[92:95], v[128:131]
    v_permlane32_swap_b32 v28, v29
    v_max_f32 v28, v28, v29
    v_mov_b32 v29, v28
    s_nop 1
    v_permlane16_swap_b32 v28, v29
    v_max_f32 v28, v28, v29
    v_mfma_f32_16x16x32_bf16 v[128:131], a[132:135], v[88:91], v[128:131]
    v_sub_f32 v100, 0, v28
    v_sub_f32 v101, 0, v28
    v_sub_f32 v102, 0, v28
    v_sub_f32 v103, 0, v28
    v_sub_f32 v116, v116, v28
    v_sub_f32 v117, v117, v28
    v_mfma_f32_16x16x32_bf16 v[128:131], a[128:131], v[84:87], v[128:131]
    v_sub_f32 v118, v118, v28
    v_sub_f32 v119, v119, v28
    v_sub_f32 v132, v132, v28
    v_sub_f32 v133, v133, v28
    v_sub_f32 v134, v134, v28
    v_sub_f32 v135, v135, v28
    v_mfma_f32_16x16x32_bf16 v[144:147], a[156:159], v[96:99], 0
    v_max3_f32 v30, v120, v121, v122
    v_max3_f32 v31, v123, v136, v137
    v_max3_f32 v30, v30, v138, v139
    v_max_f32 v30, v30, v31
    v_mov_b32 v31, v30
    s_nop 1
    v_mfma_f32_16x16x32_bf16 v[144:147], a[152:155], v[92:95], v[144:147]
    v_permlane32_swap_b32 v30, v31
    v_max_f32 v30, v30, v31
    v_mov_b32 v31, v30
    s_nop 1
    v_permlane16_swap_b32 v30, v31
    v_max_f32 v30, v30, v31
    v_mfma_f32_16x16x32_bf16 v[144:147], a[148:151], v[88:91], v[144:147]
    v_sub_f32 v104, 0, v30
    v_sub_f32 v105, 0, v30
    v_sub_f32 v106, 0, v30
    v_sub_f32 v107, 0, v30
    v_sub_f32 v120, v120, v30
    v_sub_f32 v121, v121, v30
    v_mfma_f32_16x16x32_bf16 v[144:147], a[144:147], v[84:87], v[144:147]
    v_sub_f32 v122, v122, v30
    v_sub_f32 v123, v123, v30
    v_sub_f32 v136, v136, v30
    v_sub_f32 v137, v137, v30
    v_sub_f32 v138, v138, v30
    v_sub_f32 v139, v139, v30
    s_waitcnt vmcnt(12) lgkmcnt(0)
    s_barrier
    v_and_b32 v253, 7, v19
    v_lshlrev_b32 v253, 5, v253
    buffer_load_dword v252, v253, s[92:95], 0 offen sc1
    v_mfma_f32_16x16x32_bf16 v[148:151], a[160:163], v[36:39], v[100:103]
    s_add_u32 m0, s34, 0
    ds_read_b128 a[128:131], v1 offset:16384
    ds_read_b128 a[132:135], v2 offset:16384
    v_mfma_f32_16x16x32_bf16 v[148:151], a[164:167], v[40:43], v[148:151]
    buffer_load_dwordx4 v13, s[8:11], s28 offen offset:0 lds
    v_max3_f32 v32, v124, v125, v126
    v_max3_f32 v33, v127, v140, v141
    v_mfma_f32_16x16x32_bf16 v[148:151], a[168:171], v[44:47], v[148:151]
    v_max3_f32 v32, v32, v142, v143
    v_max_f32 v32, v32, v33
    v_mov_b32 v33, v32
    v_mfma_f32_16x16x32_bf16 v[148:151], a[172:175], v[48:51], v[148:151]
    s_nop 1
    v_permlane32_swap_b32 v32, v33
    v_max_f32 v32, v32, v33
    v_mov_b32 v33, v32
    v_mfma_f32_16x16x32_bf16 v[152:155], a[172:175], v[64:67], v[104:107]
    s_nop 1
    v_permlane16_swap_b32 v32, v33
    v_max_f32 v32, v32, v33
    v_mfma_f32_16x16x32_bf16 v[152:155], a[168:171], v[60:63], v[152:155]
    v_sub_f32 v108, 0, v32
    v_sub_f32 v109, 0, v32
    v_sub_f32 v110, 0, v32
    v_mfma_f32_16x16x32_bf16 v[152:155], a[164:167], v[56:59], v[152:155]
    v_sub_f32 v111, 0, v32
    v_sub_f32 v124, v124, v32
    v_sub_f32 v125, v125, v32
    v_sub_f32 v126, v126, v32
    v_mfma_f32_16x16x32_bf16 v[152:155], a[160:163], v[52:55], v[152:155]
    v_sub_f32 v127, v127, v32
    v_sub_f32 v140, v140, v32
    v_sub_f32 v141, v141, v32
    v_mfma_f32_16x16x32_bf16 v[164:167], a[176:179], v[36:39], v[100:103]
    v_sub_f32 v142, v142, v32
    v_sub_f32 v143, v143, v32
    v_max3_f32 v34, v128, v129, v130
    v_mfma_f32_16x16x32_bf16 v[164:167], a[180:183], v[40:43], v[164:167]
    v_max3_f32 v35, v131, v144, v145
    v_max3_f32 v34, v34, v146, v147
    v_max_f32 v34, v34, v35
    v_mov_b32 v35, v34
    v_mfma_f32_16x16x32_bf16 v[164:167], a[184:187], v[44:47], v[164:167]
    s_nop 1
    v_permlane32_swap_b32 v34, v35
    v_max_f32 v34, v34, v35
    v_mfma_f32_16x16x32_bf16 v[164:167], a[188:191], v[48:51], v[164:167]
    v_mov_b32 v35, v34
    s_nop 1
    v_permlane16_swap_b32 v34, v35
    v_mfma_f32_16x16x32_bf16 v[168:171], a[188:191], v[64:67], v[104:107]
    v_max_f32 v34, v34, v35
    v_sub_f32 v112, 0, v34
    v_sub_f32 v113, 0, v34
    v_sub_f32 v114, 0, v34
    v_mfma_f32_16x16x32_bf16 v[168:171], a[184:187], v[60:63], v[168:171]
    v_sub_f32 v115, 0, v34
    v_sub_f32 v128, v128, v34
    v_sub_f32 v129, v129, v34
    v_mfma_f32_16x16x32_bf16 v[168:171], a[180:183], v[56:59], v[168:171]
    v_sub_f32 v130, v130, v34
    v_sub_f32 v131, v131, v34
    v_sub_f32 v144, v144, v34
    v_mfma_f32_16x16x32_bf16 v[168:171], a[176:179], v[52:55], v[168:171]
    v_sub_f32 v145, v145, v34
    v_sub_f32 v146, v146, v34
    v_sub_f32 v147, v147, v34
    s_nop 0
    v_mfma_f32_16x16x32_bf16 v[156:159], a[160:163], v[68:71], v[108:111]
    v_mfma_f32_16x16x32_bf16 v[156:159], a[164:167], v[72:75], v[156:159]
    v_mfma_f32_16x16x32_bf16 v[156:159], a[168:171], v[76:79], v[156:159]
    ds_read_b128 a[136:139], v3 offset:16384
    v_mfma_f32_16x16x32_bf16 v[156:159], a[172:175], v[80:83], v[156:159]
    v_mfma_f32_16x16x32_bf16 v[160:163], a[172:175], v[96:99], v[112:115]
    v_mfma_f32_16x16x32_bf16 v[160:163], a[168:171], v[92:95], v[160:163]
    ds_read_b128 a[140:143], v4 offset:16384
    v_mfma_f32_16x16x32_bf16 v[160:163], a[164:167], v[88:91], v[160:163]
    v_mfma_f32_16x16x32_bf16 v[160:163], a[160:163], v[84:87], v[160:163]
    buffer_load_dwordx4 v14, s[8:11], s28 offen offset:1024 lds
    s_waitcnt lgkmcnt(2)
    v_mfma_f32_16x16x32_bf16 v[172:175], a[176:179], v[68:71], v[108:111]
    v_exp_f32 v116, v116
    ds_read_b128 a[144:147], v1 offset:20480
    v_mfma_f32_16x16x32_bf16 v[172:175], a[180:183], v[72:75], v[172:175]
    v_exp_f32 v117, v117
    ds_read_b128 a[148:151], v2 offset:20480
    s_mov_b32 s43, m0
    s_add_u32 m0, s47, 0
    s_nop 0
    buffer_load_dwordx4 v20, s[96:99], 0 offen lds
    s_mov_b32 m0, s43
    v_mfma_f32_16x16x32_bf16 v[172:175], a[184:187], v[76:79], v[172:175]
    v_exp_f32 v118, v118
    v_cvt_pk_bf16_f32 v180, v116, v117
    v_mfma_f32_16x16x32_bf16 v[172:175], a[188:191], v[80:83], v[172:175]
    v_exp_f32 v119, v119
    v_mfma_f32_16x16x32_bf16 v[176:179], a[188:191], v[96:99], v[112:115]
    v_exp_f32 v120, v120
    v_cvt_pk_bf16_f32 v181, v118, v119
    v_mfma_f32_16x16x32_bf16 v[176:179], a[184:187], v[92:95], v[176:179]
    v_exp_f32 v121, v121
    v_mfma_f32_16x16x32_bf16 v[176:179], a[180:183], v[88:91], v[176:179]
    v_exp_f32 v122, v122
    buffer_load_dwordx4 v15, s[8:11], s28 offen offset:2048 lds
    v_cvt_pk_bf16_f32 v188, v120, v121
    v_mfma_f32_16x16x32_bf16 v[176:179], a[176:179], v[84:87], v[176:179]
    v_exp_f32 v123, v123
    s_waitcnt lgkmcnt(2)
    v_mfma_f32_16x16x32_bf16 v[116:119], a[128:131], v[36:39], v[100:103]
    v_exp_f32 v124, v124
    ds_read_b128 a[152:155], v3 offset:20480
    v_cvt_pk_bf16_f32 v189, v122, v123
    v_mfma_f32_16x16x32_bf16 v[116:119], a[132:135], v[40:43], v[116:119]
    v_exp_f32 v125, v125
    ds_read_b128 a[156:159], v4 offset:20480
    s_mov_b32 s43, m0
    s_add_u32 m0, s47, 1024
    s_nop 0
    buffer_load_dwordx4 v21, s[96:99], 0 offen lds
    s_mov_b32 m0, s43
    v_mfma_f32_16x16x32_bf16 v[116:119], a[136:139], v[44:47], v[116:119]
    v_exp_f32 v126, v126
    v_cvt_pk_bf16_f32 v196, v124, v125
    v_mfma_f32_16x16x32_bf16 v[116:119], a[140:143], v[48:51], v[116:119]
    v_exp_f32 v127, v127
    v_mfma_f32_16x16x32_bf16 v[120:123], a[140:143], v[64:67], v[104:107]
    v_exp_f32 v128, v128
    v_cvt_pk_bf16_f32 v197, v126, v127
    v_mfma_f32_16x16x32_bf16 v[120:123], a[136:139], v[60:63], v[120:123]
    v_exp_f32 v129, v129
    v_mfma_f32_16x16x32_bf16 v[120:123], a[132:135], v[56:59], v[120:123]
    v_exp_f32 v130, v130
    buffer_load_dwordx4 v16, s[8:11], s28 offen offset:3072 lds
    v_cvt_pk_bf16_f32 v204, v128, v129
    v_mfma_f32_16x16x32_bf16 v[120:123], a[128:131], v[52:55], v[120:123]
    v_exp_f32 v131, v131
    s_waitcnt lgkmcnt(2)
    v_mfma_f32_16x16x32_bf16 v[124:127], a[128:131], v[68:71], v[108:111]
    v_exp_f32 v132, v132
    ds_read_b128 a[160:163], v1 offset:24576
    v_cvt_pk_bf16_f32 v205, v130, v131
    v_mfma_f32_16x16x32_bf16 v[124:127], a[132:135], v[72:75], v[124:127]
    v_exp_f32 v133, v133
    ds_read_b128 a[164:167], v2 offset:24576
    s_mov_b32 s43, m0
    s_add_u32 m0, s47, 2048
    s_nop 0
    buffer_load_dwordx4 v22, s[96:99], 0 offen lds
    s_mov_b32 m0, s43
    v_mfma_f32_16x16x32_bf16 v[124:127], a[136:139], v[76:79], v[124:127]
    v_exp_f32 v134, v134
    v_cvt_pk_bf16_f32 v182, v132, v133
    v_mfma_f32_16x16x32_bf16 v[124:127], a[140:143], v[80:83], v[124:127]
    v_exp_f32 v135, v135
    v_mfma_f32_16x16x32_bf16 v[128:131], a[140:143], v[96:99], v[112:115]
    v_exp_f32 v136, v136
    v_cvt_pk_bf16_f32 v183, v134, v135
    v_mfma_f32_16x16x32_bf16 v[128:131], a[136:139], v[92:95], v[128:131]
    v_exp_f32 v137, v137
    v_mfma_f32_16x16x32_bf16 v[128:131], a[132:135], v[88:91], v[128:131]
    s_add_u32 s28, s28, 16384
    s_mov_b32 m0, s31
    v_exp_f32 v138, v138
    buffer_load_dwordx4 v17, s[12:15], s29 offen offset:0 lds
    v_cvt_pk_bf16_f32 v190, v136, v137
    v_mfma_f32_16x16x32_bf16 v[128:131], a[128:131], v[84:87], v[128:131]
    v_exp_f32 v139, v139
    s_waitcnt lgkmcnt(2)
    v_mfma_f32_16x16x32_bf16 v[132:135], a[144:147], v[36:39], v[100:103]
    v_exp_f32 v140, v140
    ds_read_b128 a[168:171], v3 offset:24576
    v_cvt_pk_bf16_f32 v191, v138, v139
    v_mfma_f32_16x16x32_bf16 v[132:135], a[148:151], v[40:43], v[132:135]
    v_exp_f32 v141, v141
    ds_read_b128 a[172:175], v4 offset:24576
    s_mov_b32 s43, m0
    s_add_u32 m0, s47, 3072
    s_nop 0
    buffer_load_dwordx4 v23, s[96:99], 0 offen lds
    s_mov_b32 m0, s43
    v_mfma_f32_16x16x32_bf16 v[132:135], a[152:155], v[44:47], v[132:135]
    v_exp_f32 v142, v142
    v_cvt_pk_bf16_f32 v198, v140, v141
    v_mfma_f32_16x16x32_bf16 v[132:135], a[156:159], v[48:51], v[132:135]
    v_exp_f32 v143, v143
    v_mfma_f32_16x16x32_bf16 v[136:139], a[156:159], v[64:67], v[104:107]
    v_exp_f32 v144, v144
    v_cvt_pk_bf16_f32 v199, v142, v143
    v_mfma_f32_16x16x32_bf16 v[136:139], a[152:155], v[60:63], v[136:139]
    v_exp_f32 v145, v145
    v_mfma_f32_16x16x32_bf16 v[136:139], a[148:151], v[56:59], v[136:139]
    v_exp_f32 v146, v146
    buffer_load_dwordx4 v18, s[12:15], s29 offen offset:1024 lds
    v_cvt_pk_bf16_f32 v206, v144, v145
    v_mfma_f32_16x16x32_bf16 v[136:139], a[144:147], v[52:55], v[136:139]
    v_exp_f32 v147, v147
    s_waitcnt lgkmcnt(2)
    v_mfma_f32_16x16x32_bf16 v[140:143], a[144:147], v[68:71], v[108:111]
    v_exp_f32 v148, v148
    ds_read_b128 a[176:179], v1 offset:28672
    v_cvt_pk_bf16_f32 v207, v146, v147
    v_mfma_f32_16x16x32_bf16 v[140:143], a[148:151], v[72:75], v[140:143]
    v_exp_f32 v149, v149
    ds_read_b128 a[180:183], v2 offset:28672
    s_mov_b32 s43, m0
    s_add_u32 m0, s47, 4096
    s_nop 0
    buffer_load_dwordx4 v24, s[96:99], 0 offen lds
    s_mov_b32 m0, s43
    v_mfma_f32_16x16x32_bf16 v[140:143], a[152:155], v[76:79], v[140:143]
    v_exp_f32 v150, v150
    v_cvt_pk_bf16_f32 v184, v148, v149
    v_mfma_f32_16x16x32_bf16 v[140:143], a[156:159], v[80:83], v[140:143]
    v_exp_f32 v151, v151
    s_waitcnt vmcnt(11)
    v_cmp_gt_u32 vcc, 32, v252
    s_and_b64 vcc, vcc, exec
    s_cbranch_scc1 L_spin_all
L_back_all:
    s_lshl_b32 s40, s5, 13
    s_add_u32 s40, s40, 0x280008
    v_lshlrev_b32 v253, 4, v19
    buffer_load_dword v28, v253, s[76:79], s40 offen offset:0 sc1
    buffer_load_dword v29, v253, s[76:79], s40 offen offset:1024 sc1
    buffer_load_dword v30, v253, s[76:79], s40 offen offset:2048 sc1
    buffer_load_dword v31, v253, s[76:79], s40 offen offset:3072 sc1
    s_add_u32 s40, s40, 4096
    buffer_load_dword v32, v253, s[76:79], s40 offen offset:0 sc1
    buffer_load_dword v33, v253, s[76:79], s40 offen offset:1024 sc1
    buffer_load_dword v34, v253, s[76:79], s40 offen offset:2048 sc1
    buffer_load_dword v35, v253, s[76:79], s40 offen offset:3072 sc1
    v_mfma_f32_16x16x32_bf16 v[144:147], a[156:159], v[96:99], v[112:115]
    v_exp_f32 v152, v152
    v_cvt_pk_bf16_f32 v185, v150, v151
    v_mfma_f32_16x16x32_bf16 v[144:147], a[152:155], v[92:95], v[144:147]
    v_exp_f32 v153, v153
    v_mfma_f32_16x16x32_bf16 v[144:147], a[148:151], v[88:91], v[144:147]
    v_exp_f32 v154, v154
    buffer_load_dwordx4 v17, s[12:15], s29 offen offset:2048 lds
    v_cvt_pk_bf16_f32 v192, v152, v153
    v_mfma_f32_16x16x32_bf16 v[144:147], a[144:147], v[84:87], v[144:147]
    v_exp_f32 v155, v155
    s_waitcnt lgkmcnt(2)
    v_mfma_f32_16x16x32_bf16 v[148:151], a[160:163], v[36:39], v[100:103]
    v_exp_f32 v156, v156
    ds_read_b128 a[184:187], v3 offset:28672
    v_cvt_pk_bf16_f32 v193, v154, v155
    v_mfma_f32_16x16x32_bf16 v[148:151], a[164:167], v[40:43], v[148:151]
    v_exp_f32 v157, v157
    ds_read_b128 a[188:191], v4 offset:28672
    v_mfma_f32_16x16x32_bf16 v[148:151], a[168:171], v[44:47], v[148:151]
    v_exp_f32 v158, v158
    v_cvt_pk_bf16_f32 v200, v156, v157
    v_mfma_f32_16x16x32_bf16 v[148:151], a[172:175], v[48:51], v[148:151]
    v_exp_f32 v159, v159
    v_mfma_f32_16x16x32_bf16 v[152:155], a[172:175], v[64:67], v[104:107]
    v_exp_f32 v160, v160
    v_cvt_pk_bf16_f32 v201, v158, v159
    v_mfma_f32_16x16x32_bf16 v[152:155], a[168:171], v[60:63], v[152:155]
    v_exp_f32 v161, v161
    v_mfma_f32_16x16x32_bf16 v[152:155], a[164:167], v[56:59], v[152:155]
    v_exp_f32 v162, v162
    buffer_load_dwordx4 v18, s[12:15], s29 offen offset:3072 lds
    v_cvt_pk_bf16_f32 v208, v160, v161
    v_mfma_f32_16x16x32_bf16 v[152:155], a[160:163], v[52:55], v[152:155]
    s_add_u32 s29, s29, 16384
    v_exp_f32 v163, v163
    s_waitcnt vmcnt(22) lgkmcnt(2)
    s_barrier
    v_mfma_f32_16x16x32_bf16 v[156:159], a[160:163], v[68:71], v[108:111]
    v_exp_f32 v164, v164
    ds_read_b64_tr_b16 a[192:193], v5 offset:8192
    v_cvt_pk_bf16_f32 v209, v162, v163
    v_mfma_f32_16x16x32_bf16 v[156:159], a[164:167], v[72:75], v[156:159]
    v_exp_f32 v165, v165
    ds_read_b64_tr_b16 a[194:195], v5 offset:12288
    v_mfma_f32_16x16x32_bf16 v[156:159], a[168:171], v[76:79], v[156:159]
    v_exp_f32 v166, v166
    ds_read_b128 a[128:131], v1 offset:32768
    v_cvt_pk_bf16_f32 v186, v164, v165
    v_mfma_f32_16x16x32_bf16 v[156:159], a[172:175], v[80:83], v[156:159]
    v_exp_f32 v167, v167
    ds_read_b64_tr_b16 a[196:197], v5 offset:32768
    v_mfma_f32_16x16x32_bf16 v[160:163], a[172:175], v[96:99], v[112:115]
    v_exp_f32 v168, v168
    ds_read_b64_tr_b16 a[198:199], v5 offset:36864
    v_cvt_pk_bf16_f32 v187, v166, v167
    v_mfma_f32_16x16x32_bf16 v[160:163], a[168:171], v[92:95], v[160:163]
    v_exp_f32 v169, v169
    ds_read_b128 a[132:135], v2 offset:32768
    v_mfma_f32_16x16x32_bf16 v[160:163], a[164:167], v[88:91], v[160:163]
    s_add_u32 m0, s34, 49152
    v_exp_f32 v170, v170
    buffer_load_dwordx4 v13, s[8:11], s28 offen offset:0 lds
    v_cvt_pk_bf16_f32 v194, v168, v169
    v_mfma_f32_16x16x32_bf16 v[160:163], a[160:163], v[84:87], v[160:163]
    v_exp_f32 v171, v171
    s_waitcnt lgkmcnt(6)
    v_mfma_f32_16x16x32_bf16 v[164:167], a[176:179], v[36:39], v[100:103]
    v_exp_f32 v172, v172
    ds_read_b64_tr_b16 a[200:201], v6 offset:8192
    v_cvt_pk_bf16_f32 v195, v170, v171
    v_mfma_f32_16x16x32_bf16 v[164:167], a[180:183], v[40:43], v[164:167]
    v_exp_f32 v173, v173
    ds_read_b64_tr_b16 a[202:203], v6 offset:12288
    v_mfma_f32_16x16x32_bf16 v[164:167], a[184:187], v[44:47], v[164:167]
    v_exp_f32 v174, v174
    ds_read_b128 a[136:139], v3 offset:32768
    v_cvt_pk_bf16_f32 v202, v172, v173
    v_mfma_f32_16x16x32_bf16 v[164:167], a[188:191], v[48:51], v[164:167]
    v_exp_f32 v175, v175
    ds_read_b64_tr_b16 a[204:205], v6 offset:32768
    v_mfma_f32_16x16x32_bf16 v[168:171], a[188:191], v[64:67], v[104:107]
    v_exp_f32 v176, v176
    ds_read_b64_tr_b16 a[206:207], v6 offset:36864
    v_cvt_pk_bf16_f32 v203, v174, v175
    v_mfma_f32_16x16x32_bf16 v[168:171], a[184:187], v[60:63], v[168:171]
    v_exp_f32 v177, v177
    ds_read_b128 a[140:143], v4 offset:32768
    v_mfma_f32_16x16x32_bf16 v[168:171], a[180:183], v[56:59], v[168:171]
    v_exp_f32 v178, v178
    buffer_load_dwordx4 v14, s[8:11], s28 offen offset:1024 lds
    v_cvt_pk_bf16_f32 v210, v176, v177
    v_mfma_f32_16x16x32_bf16 v[168:171], a[176:179], v[52:55], v[168:171]
    v_exp_f32 v179, v179
    s_waitcnt lgkmcnt(6)
    v_mfma_f32_16x16x32_bf16 v[172:175], a[176:179], v[68:71], v[108:111]
    v_exp_f32 v116, v116
    v_mfma_f32_16x16x32_bf16 v[172:175], a[180:183], v[72:75], v[172:175]
    ds_read_b64_tr_b16 a[208:209], v7 offset:8192
    v_cvt_pk_bf16_f32 v211, v178, v179
    v_mfma_f32_16x16x32_bf16 v[172:175], a[184:187], v[76:79], v[172:175]
    v_exp_f32 v117, v117
    v_mfma_f32_16x16x32_bf16 v[172:175], a[188:191], v[80:83], v[172:175]
    ds_read_b64_tr_b16 a[210:211], v7 offset:12288
    s_mov_b32 s16, s62
    s_mov_b32 s17, s63
    s_mov_b32 s18, 0x21c000
    s_mov_b32 s19, 0x20000
    s_mov_b32 s20, s64
    s_mov_b32 s21, s65
    s_mov_b32 s22, 0x21c000
    s_mov_b32 s23, 0x20000
    s_mov_b32 s96, s66
    s_mov_b32 s97, s67
    s_mov_b32 s98, 0x21c000
    s_mov_b32 s99, 0x20000
    v_mfma_f32_16x16x32_bf16 v[176:179], a[188:191], v[96:99], v[112:115]
    v_exp_f32 v118, v118
    v_mfma_f32_16x16x32_bf16 v[176:179], a[184:187], v[92:95], v[176:179]
    ds_read_b128 a[144:147], v1 offset:36864
    v_cvt_pk_bf16_f32 v212, v116, v117
    v_mfma_f32_16x16x32_bf16 v[176:179], a[180:183], v[88:91], v[176:179]
    v_exp_f32 v119, v119
    v_mfma_f32_16x16x32_bf16 v[176:179], a[176:179], v[84:87], v[176:179]
    ds_read_b64_tr_b16 a[212:213], v7 offset:32768
    v_mul_u32_u24 v24, 3456, v19
    s_lshl_b32 s40, s6, 4
    v_add_u32 v24, s40, v24
    s_cmp_ge_u32 s5, 2
    s_cselect_b32 s16, s20, s16
    s_cselect_b32 s17, s21, s17
    s_cmp_ge_u32 s6, 216
    s_cselect_b32 s18, 0, s18
    s_and_b32 s40, s5, 1
    s_mul_i32 s37, s40, 1105920
    s_mul_i32 s38, s5, 5120
    s_add_u32 s38, s38, 65536
    s_mov_b32 s36, s5
    v_mfma_f32_16x16x32_bf16 a[0:3], a[192:195], v[180:183], 0
    v_exp_f32 v120, v120
    v_mfma_f32_16x16x32_bf16 a[0:3], a[196:199], v[184:187], a[0:3]
    ds_read_b64_tr_b16 a[214:215], v7 offset:36864
    v_cvt_pk_bf16_f32 v213, v118, v119
    v_mfma_f32_16x16x32_bf16 a[4:7], a[196:199], v[192:195], 0
    v_exp_f32 v121, v121
    v_mfma_f32_16x16x32_bf16 a[4:7], a[192:195], v[188:191], a[4:7]
    ds_read_b128 a[148:151], v2 offset:36864
    v_cvt_pk_bf16_f32 v220, v120, v121
    v_mfma_f32_16x16x32_bf16 a[8:11], a[192:195], v[196:199], 0
    v_exp_f32 v122, v122
    v_mfma_f32_16x16x32_bf16 a[8:11], a[196:199], v[200:203], a[8:11]
    buffer_load_dwordx4 v15, s[8:11], s28 offen offset:2048 lds
    v_mfma_f32_16x16x32_bf16 a[12:15], a[196:199], v[208:211], 0
    v_exp_f32 v123, v123
    v_mfma_f32_16x16x32_bf16 a[12:15], a[192:195], v[204:207], a[12:15]
    s_waitcnt lgkmcnt(6)
    v_mfma_f32_16x16x32_bf16 v[116:119], a[128:131], v[36:39], v[100:103]
    v_exp_f32 v124, v124
    s_waitcnt vmcnt(5)
    v_mfma_f32_16x16x32_bf16 v[116:119], a[132:135], v[40:43], v[116:119]
    s_mov_b32 s42, -1
    ds_read_b64_tr_b16 a[216:217], v8 offset:8192
    v_cvt_pk_bf16_f32 v221, v122, v123
    v_sub_u32 v20, s42, v28
    v_mfma_f32_16x16x32_bf16 v[116:119], a[136:139], v[44:47], v[116:119]
    v_exp_f32 v125, v125
    v_sub_u32 v21, s42, v29
    v_mfma_f32_16x16x32_bf16 v[116:119], a[140:143], v[48:51], v[116:119]
    ds_read_b64_tr_b16 a[218:219], v8 offset:12288
    v_sub_u32 v22, s42, v30
    v_min3_u32 v20, v20, v21, v22
    v_mfma_f32_16x16x32_bf16 v[120:123], a[140:143], v[64:67], v[104:107]
    v_exp_f32 v126, v126
    v_sub_u32 v21, s42, v31
    v_sub_u32 v22, s42, v32
    v_mfma_f32_16x16x32_bf16 v[120:123], a[136:139], v[60:63], v[120:123]
    ds_read_b128 a[152:155], v3 offset:36864
    v_cvt_pk_bf16_f32 v228, v124, v125
    v_min3_u32 v20, v20, v21, v22
    v_mfma_f32_16x16x32_bf16 v[120:123], a[132:135], v[56:59], v[120:123]
    v_exp_f32 v127, v127
    v_sub_u32 v21, s42, v33
    v_sub_u32 v22, s42, v34
    v_mfma_f32_16x16x32_bf16 v[120:123], a[128:131], v[52:55], v[120:123]
    ds_read_b64_tr_b16 a[220:221], v8 offset:32768
    v_min3_u32 v20, v20, v21, v22
    v_sub_u32 v21, s42, v35
    v_mfma_f32_16x16x32_bf16 a[16:19], a[200:203], v[180:183], 0
    v_exp_f32 v128, v128
    v_min_u32 v20, v20, v21
    v_mfma_f32_16x16x32_bf16 a[16:19], a[204:207], v[184:187], a[16:19]
    ds_read_b64_tr_b16 a[222:223], v8 offset:36864
    v_cvt_pk_bf16_f32 v229, v126, v127
    v_min_u32_dpp v20, v20, v20 row_shr:1 row_mask:0xf bank_mask:0xf
    s_nop 1
    v_min_u32_dpp v20, v20, v20 row_shr:2 row_mask:0xf bank_mask:0xf
    v_mfma_f32_16x16x32_bf16 a[20:23], a[204:207], v[192:195], 0
    v_exp_f32 v129, v129
    v_min_u32_dpp v20, v20, v20 row_shr:4 row_mask:0xf bank_mask:0xf
    v_mfma_f32_16x16x32_bf16 a[20:23], a[200:203], v[188:191], a[20:23]
    ds_read_b128 a[156:159], v4 offset:36864
    v_min_u32_dpp v20, v20, v20 row_shr:8 row_mask:0xf bank_mask:0xf
    s_nop 1
    v_min_u32_dpp v20, v20, v20 row_bcast:15 row_mask:0xa bank_mask:0xf
    v_mfma_f32_16x16x32_bf16 a[24:27], a[200:203], v[196:199], 0
    v_exp_f32 v130, v130
    v_min_u32_dpp v20, v20, v20 row_bcast:31 row_mask:0xc bank_mask:0xf
    s_nop 0
    v_readlane_b32 s50, v20, 63
    v_mfma_f32_16x16x32_bf16 a[24:27], a[204:207], v[200:203], a[24:27]
    s_sub_u32 s50, s42, s50
    v_cvt_pk_bf16_f32 v236, v128, v129
    v_mfma_f32_16x16x32_bf16 a[28:31], a[204:207], v[208:211], 0
    s_sub_u32 s42, s50, 1
    v_exp_f32 v131, v131
    v_sub_u32 v20, s42, v28
    v_mfma_f32_16x16x32_bf16 a[28:31], a[200:203], v[204:207], a[28:31]
    buffer_load_dwordx4 v16, s[8:11], s28 offen offset:3072 lds
    v_sub_u32 v21, s42, v29
    v_sub_u32 v22, s42, v30
    v_smfmac_f32_16x16x64_bf16 a[224:227], v[244:247], v[180:187], v248
    s_waitcnt lgkmcnt(6)
    v_mfma_f32_16x16x32_bf16 v[124:127], a[128:131], v[68:71], v[108:111]
    v_exp_f32 v132, v132
    v_min3_u32 v20, v20, v21, v22
    v_mfma_f32_16x16x32_bf16 v[124:127], a[132:135], v[72:75], v[124:127]
    ds_read_b64_tr_b16 a[192:193], v9 offset:8192
    v_cvt_pk_bf16_f32 v237, v130, v131
    v_sub_u32 v21, s42, v31
    v_sub_u32 v22, s42, v32
    v_mfma_f32_16x16x32_bf16 v[124:127], a[136:139], v[76:79], v[124:127]
    v_exp_f32 v133, v133
    v_min3_u32 v20, v20, v21, v22
    v_mfma_f32_16x16x32_bf16 v[124:127], a[140:143], v[80:83], v[124:127]
    ds_read_b64_tr_b16 a[194:195], v9 offset:12288
    s_waitcnt vmcnt(14)
    ds_read_b64_tr_b16 a[240:241], v25 offset:0
    ds_read_b64_tr_b16 a[242:243], v25 offset:2560
    v_sub_u32 v21, s42, v33
    v_sub_u32 v22, s42, v34
    v_mfma_f32_16x16x32_bf16 v[128:131], a[140:143], v[96:99], v[112:115]
    v_exp_f32 v134, v134
    v_min3_u32 v20, v20, v21, v22
    v_sub_u32 v21, s42, v35
    v_mfma_f32_16x16x32_bf16 v[128:131], a[136:139], v[92:95], v[128:131]
    ds_read_b128 a[160:163], v1 offset:40960
    v_cvt_pk_bf16_f32 v214, v132, v133
    v_min_u32 v20, v20, v21
    v_mfma_f32_16x16x32_bf16 v[128:131], a[132:135], v[88:91], v[128:131]
    v_exp_f32 v135, v135
    v_min_u32_dpp v20, v20, v20 row_shr:1 row_mask:0xf bank_mask:0xf
    s_nop 1
    v_min_u32_dpp v20, v20, v20 row_shr:2 row_mask:0xf bank_mask:0xf
    v_mfma_f32_16x16x32_bf16 v[128:131], a[128:131], v[84:87], v[128:131]
    ds_read_b64_tr_b16 a[196:197], v9 offset:32768
    ds_read_b64_tr_b16 a[244:245], v25 offset:32
    ds_read_b64_tr_b16 a[246:247], v25 offset:2592
    v_min_u32_dpp v20, v20, v20 row_shr:4 row_mask:0xf bank_mask:0xf
    s_nop 1
    v_min_u32_dpp v20, v20, v20 row_shr:8 row_mask:0xf bank_mask:0xf
    v_mfma_f32_16x16x32_bf16 a[32:35], a[208:211], v[180:183], 0
    v_exp_f32 v136, v136
    v_min_u32_dpp v20, v20, v20 row_bcast:15 row_mask:0xa bank_mask:0xf
    v_mfma_f32_16x16x32_bf16 a[32:35], a[212:215], v[184:187], a[32:35]
    ds_read_b64_tr_b16 a[198:199], v9 offset:36864
    v_cvt_pk_bf16_f32 v215, v134, v135
    v_min_u32_dpp v20, v20, v20 row_bcast:31 row_mask:0xc bank_mask:0xf
    s_nop 0
    v_readlane_b32 s51, v20, 63
    v_mfma_f32_16x16x32_bf16 a[36:39], a[212:215], v[192:195], 0
    s_sub_u32 s51, s42, s51
    v_exp_f32 v137, v137
    v_mfma_f32_16x16x32_bf16 a[36:39], a[208:211], v[188:191], a[36:39]
    s_sub_u32 s42, s51, 1
    ds_read_b128 a[164:167], v2 offset:40960
    v_cvt_pk_bf16_f32 v222, v136, v137
    v_sub_u32 v20, s42, v28
    v_mfma_f32_16x16x32_bf16 a[40:43], a[208:211], v[196:199], 0
    s_add_u32 s28, s28, 16384
    s_mov_b32 m0, s32
    v_exp_f32 v138, v138
    v_sub_u32 v21, s42, v29
    v_sub_u32 v22, s42, v30
    v_mfma_f32_16x16x32_bf16 a[40:43], a[212:215], v[200:203], a[40:43]
    buffer_load_dwordx4 v17, s[12:15], s29 offen offset:0 lds
    v_min3_u32 v20, v20, v21, v22
    v_mfma_f32_16x16x32_bf16 a[44:47], a[212:215], v[208:211], 0
    v_exp_f32 v139, v139
    v_sub_u32 v21, s42, v31
    v_sub_u32 v22, s42, v32
    v_mfma_f32_16x16x32_bf16 a[44:47], a[208:211], v[204:207], a[44:47]
    s_waitcnt lgkmcnt(6)
    v_min3_u32 v20, v20, v21, v22
    v_sub_u32 v21, s42, v33
    v_mfma_f32_16x16x32_bf16 v[132:135], a[144:147], v[36:39], v[100:103]
    v_exp_f32 v140, v140
    v_sub_u32 v22, s42, v34
    v_mfma_f32_16x16x32_bf16 v[132:135], a[148:151], v[40:43], v[132:135]
    ds_read_b64_tr_b16 a[200:201], v10 offset:8192
    v_cvt_pk_bf16_f32 v223, v138, v139
    v_min3_u32 v20, v20, v21, v22
    v_sub_u32 v21, s42, v35
    v_mfma_f32_16x16x32_bf16 v[132:135], a[152:155], v[44:47], v[132:135]
    v_exp_f32 v141, v141
    v_min_u32 v20, v20, v21
    v_mfma_f32_16x16x32_bf16 v[132:135], a[156:159], v[48:51], v[132:135]
    ds_read_b64_tr_b16 a[202:203], v10 offset:12288
    ds_read_b64_tr_b16 a[248:249], v25 offset:64
    ds_read_b64_tr_b16 a[250:251], v25 offset:2624
    v_min_u32_dpp v20, v20, v20 row_shr:1 row_mask:0xf bank_mask:0xf
    s_nop 1
    v_min_u32_dpp v20, v20, v20 row_shr:2 row_mask:0xf bank_mask:0xf
    v_mfma_f32_16x16x32_bf16 v[136:139], a[156:159], v[64:67], v[104:107]
    v_exp_f32 v142, v142
    v_min_u32_dpp v20, v20, v20 row_shr:4 row_mask:0xf bank_mask:0xf
    s_nop 1
    v_min_u32_dpp v20, v20, v20 row_shr:8 row_mask:0xf bank_mask:0xf
    v_mfma_f32_16x16x32_bf16 v[136:139], a[152:155], v[60:63], v[136:139]
    ds_read_b128 a[168:171], v3 offset:40960
    v_cvt_pk_bf16_f32 v230, v140, v141
    v_min_u32_dpp v20, v20, v20 row_bcast:15 row_mask:0xa bank_mask:0xf
    v_mfma_f32_16x16x32_bf16 v[136:139], a[148:151], v[56:59], v[136:139]
    v_exp_f32 v143, v143
    v_min_u32_dpp v20, v20, v20 row_bcast:31 row_mask:0xc bank_mask:0xf
    s_nop 0
    v_readlane_b32 s52, v20, 63
    v_mfma_f32_16x16x32_bf16 v[136:139], a[144:147], v[52:55], v[136:139]
    s_sub_u32 s52, s42, s52
    ds_read_b64_tr_b16 a[204:205], v10 offset:32768
    ds_read_b64_tr_b16 a[252:253], v25 offset:96
    ds_read_b64_tr_b16 a[254:255], v25 offset:2656
    s_sub_u32 s42, s52, 1
    v_mfma_f32_16x16x32_bf16 a[48:51], a[216:219], v[180:183], 0
    v_exp_f32 v144, v144
    v_sub_u32 v20, s42, v28
    v_mfma_f32_16x16x32_bf16 a[48:51], a[220:223], v[184:187], a[48:51]
    ds_read_b64_tr_b16 a[206:207], v10 offset:36864
    v_cvt_pk_bf16_f32 v231, v142, v143
    v_sub_u32 v21, s42, v29
    v_sub_u32 v22, s42, v30
    v_mfma_f32_16x16x32_bf16 a[52:55], a[220:223], v[192:195], 0
    v_exp_f32 v145, v145
    v_min3_u32 v20, v20, v21, v22
    v_mfma_f32_16x16x32_bf16 a[52:55], a[216:219], v[188:191], a[52:55]
    ds_read_b128 a[172:175], v4 offset:40960
    v_sub_u32 v21, s42, v31
    v_sub_u32 v22, s42, v32
    v_mfma_f32_16x16x32_bf16 a[56:59], a[216:219], v[196:199], 0
    v_exp_f32 v146, v146
    v_min3_u32 v20, v20, v21, v22
    v_sub_u32 v21, s42, v33
    v_mfma_f32_16x16x32_bf16 a[56:59], a[220:223], v[200:203], a[56:59]
    v_cvt_pk_bf16_f32 v238, v144, v145
    v_sub_u32 v22, s42, v34
    v_mfma_f32_16x16x32_bf16 a[60:63], a[220:223], v[208:211], 0
    v_exp_f32 v147, v147
    v_min3_u32 v20, v20, v21, v22
    v_sub_u32 v21, s42, v35
    v_mfma_f32_16x16x32_bf16 a[60:63], a[216:219], v[204:207], a[60:63]
    buffer_load_dwordx4 v18, s[12:15], s29 offen offset:1024 lds
    v_min_u32 v20, v20, v21
    s_nop 1
    v_min_u32_dpp v20, v20, v20 row_shr:1 row_mask:0xf bank_mask:0xf
    v_smfmac_f32_16x16x64_bf16 a[228:231], v[244:247], v[188:195], v248
    s_waitcnt lgkmcnt(6)
    v_mfma_f32_16x16x32_bf16 v[140:143], a[144:147], v[68:71], v[108:111]
    v_exp_f32 v148, v148
    v_min_u32_dpp v20, v20, v20 row_shr:2 row_mask:0xf bank_mask:0xf
    v_mfma_f32_16x16x32_bf16 v[140:143], a[148:151], v[72:75], v[140:143]
    ds_read_b64_tr_b16 a[208:209], v11 offset:8192
    v_cvt_pk_bf16_f32 v239, v146, v147
    v_min_u32_dpp v20, v20, v20 row_shr:4 row_mask:0xf bank_mask:0xf
    s_nop 1
    v_min_u32_dpp v20, v20, v20 row_shr:8 row_mask:0xf bank_mask:0xf
    v_mfma_f32_16x16x32_bf16 v[140:143], a[152:155], v[76:79], v[140:143]
    v_exp_f32 v149, v149
    v_min_u32_dpp v20, v20, v20 row_bcast:15 row_mask:0xa bank_mask:0xf
    v_mfma_f32_16x16x32_bf16 v[140:143], a[156:159], v[80:83], v[140:143]
    ds_read_b64_tr_b16 a[210:211], v11 offset:12288
    ds_read_b64_tr_b16 v[252:253], v25 offset:128
    ds_read_b64_tr_b16 v[254:255], v25 offset:2688
    v_min_u32_dpp v20, v20, v20 row_bcast:31 row_mask:0xc bank_mask:0xf
    s_nop 0
    v_readlane_b32 s53, v20, 63
    v_mfma_f32_16x16x32_bf16 v[144:147], a[156:159], v[96:99], v[112:115]
    s_sub_u32 s53, s42, s53
    v_exp_f32 v150, v150
    s_sub_u32 s42, s53, 1
    v_mfma_f32_16x16x32_bf16 v[144:147], a[152:155], v[92:95], v[144:147]
    ds_read_b128 a[176:179], v1 offset:45056
    v_cvt_pk_bf16_f32 v216, v148, v149
    v_sub_u32 v20, s42, v28
    v_mfma_f32_16x16x32_bf16 v[144:147], a[148:151], v[88:91], v[144:147]
    v_exp_f32 v151, v151
    v_sub_u32 v21, s42, v29
    v_sub_u32 v22, s42, v30
    v_mfma_f32_16x16x32_bf16 v[144:147], a[144:147], v[84:87], v[144:147]
    ds_read_b64_tr_b16 a[212:213], v11 offset:32768
    v_min3_u32 v20, v20, v21, v22
    v_sub_u32 v21, s42, v31
    v_mfma_f32_16x16x32_bf16 a[64:67], a[192:195], v[180:183], 0
    v_exp_f32 v152, v152
    v_sub_u32 v22, s42, v32
    v_mfma_f32_16x16x32_bf16 a[64:67], a[196:199], v[184:187], a[64:67]
    ds_read_b64_tr_b16 a[214:215], v11 offset:36864
    v_cvt_pk_bf16_f32 v217, v150, v151
    v_min3_u32 v20, v20, v21, v22
    v_sub_u32 v21, s42, v33
    v_mfma_f32_16x16x32_bf16 a[68:71], a[196:199], v[192:195], 0
    v_exp_f32 v153, v153
    v_sub_u32 v22, s42, v34
    v_mfma_f32_16x16x32_bf16 a[68:71], a[192:195], v[188:191], a[68:71]
    ds_read_b128 a[180:183], v2 offset:45056
    v_cvt_pk_bf16_f32 v224, v152, v153
    v_min3_u32 v20, v20, v21, v22
    v_sub_u32 v21, s42, v35
    v_mfma_f32_16x16x32_bf16 a[72:75], a[192:195], v[196:199], 0
    v_exp_f32 v154, v154
    v_min_u32 v20, v20, v21
    s_nop 1
    v_min_u32_dpp v20, v20, v20 row_shr:1 row_mask:0xf bank_mask:0xf
    v_mfma_f32_16x16x32_bf16 a[72:75], a[196:199], v[200:203], a[72:75]
    buffer_load_dwordx4 v17, s[12:15], s29 offen offset:2048 lds
    v_min_u32_dpp v20, v20, v20 row_shr:2 row_mask:0xf bank_mask:0xf
    v_mfma_f32_16x16x32_bf16 a[76:79], a[196:199], v[208:211], 0
    v_exp_f32 v155, v155
    v_min_u32_dpp v20, v20, v20 row_shr:4 row_mask:0xf bank_mask:0xf
    s_nop 1
    v_min_u32_dpp v20, v20, v20 row_shr:8 row_mask:0xf bank_mask:0xf
    v_mfma_f32_16x16x32_bf16 a[76:79], a[192:195], v[204:207], a[76:79]
    s_waitcnt lgkmcnt(6)
    v_min_u32_dpp v20, v20, v20 row_bcast:15 row_mask:0xa bank_mask:0xf
    s_nop 1
    v_min_u32_dpp v20, v20, v20 row_bcast:31 row_mask:0xc bank_mask:0xf
    v_mfma_f32_16x16x32_bf16 v[148:151], a[160:163], v[36:39], v[100:103]
    v_exp_f32 v156, v156
    v_readlane_b32 s54, v20, 63
    v_mfma_f32_16x16x32_bf16 v[148:151], a[164:167], v[40:43], v[148:151]
    s_sub_u32 s54, s42, s54
    ds_read_b64_tr_b16 a[216:217], v12 offset:8192
    v_cvt_pk_bf16_f32 v225, v154, v155
    s_sub_u32 s42, s54, 1
    v_mfma_f32_16x16x32_bf16 v[148:151], a[168:171], v[44:47], v[148:151]
    v_exp_f32 v157, v157
    v_sub_u32 v20, s42, v28
    v_mfma_f32_16x16x32_bf16 v[148:151], a[172:175], v[48:51], v[148:151]
    ds_read_b64_tr_b16 a[218:219], v12 offset:12288
    v_sub_u32 v21, s42, v29
    v_sub_u32 v22, s42, v30
    v_mfma_f32_16x16x32_bf16 v[152:155], a[172:175], v[64:67], v[104:107]
    v_exp_f32 v158, v158
    v_min3_u32 v20, v20, v21, v22
    v_sub_u32 v21, s42, v31
    v_mfma_f32_16x16x32_bf16 v[152:155], a[168:171], v[60:63], v[152:155]
    ds_read_b128 a[184:187], v3 offset:45056
    v_cvt_pk_bf16_f32 v232, v156, v157
    v_sub_u32 v22, s42, v32
    v_mfma_f32_16x16x32_bf16 v[152:155], a[164:167], v[56:59], v[152:155]
    v_exp_f32 v159, v159
    v_min3_u32 v20, v20, v21, v22
    v_sub_u32 v21, s42, v33
    v_mfma_f32_16x16x32_bf16 v[152:155], a[160:163], v[52:55], v[152:155]
    ds_read_b64_tr_b16 a[220:221], v12 offset:32768
    v_sub_u32 v22, s42, v34
    v_min3_u32 v20, v20, v21, v22
    v_mfma_f32_16x16x32_bf16 a[80:83], a[200:203], v[180:183], 0
    v_exp_f32 v160, v160
    v_sub_u32 v21, s42, v35
    v_mfma_f32_16x16x32_bf16 a[80:83], a[204:207], v[184:187], a[80:83]
    ds_read_b64_tr_b16 a[222:223], v12 offset:36864
    v_cvt_pk_bf16_f32 v233, v158, v159
    v_min_u32 v20, v20, v21
    s_nop 1
    v_min_u32_dpp v20, v20, v20 row_shr:1 row_mask:0xf bank_mask:0xf
    v_mfma_f32_16x16x32_bf16 a[84:87], a[204:207], v[192:195], 0
    v_exp_f32 v161, v161
    v_min_u32_dpp v20, v20, v20 row_shr:2 row_mask:0xf bank_mask:0xf
    v_mfma_f32_16x16x32_bf16 a[84:87], a[200:203], v[188:191], a[84:87]
    ds_read_b128 a[188:191], v4 offset:45056
    v_min_u32_dpp v20, v20, v20 row_shr:4 row_mask:0xf bank_mask:0xf
    s_nop 1
    v_min_u32_dpp v20, v20, v20 row_shr:8 row_mask:0xf bank_mask:0xf
    v_mfma_f32_16x16x32_bf16 a[88:91], a[200:203], v[196:199], 0
    v_exp_f32 v162, v162
    v_min_u32_dpp v20, v20, v20 row_bcast:15 row_mask:0xa bank_mask:0xf
    s_nop 1
    v_min_u32_dpp v20, v20, v20 row_bcast:31 row_mask:0xc bank_mask:0xf
    v_mfma_f32_16x16x32_bf16 a[88:91], a[204:207], v[200:203], a[88:91]
    v_cvt_pk_bf16_f32 v240, v160, v161
    v_readlane_b32 s55, v20, 63
    v_mfma_f32_16x16x32_bf16 a[92:95], a[204:207], v[208:211], 0
    s_sub_u32 s55, s42, s55
    v_exp_f32 v163, v163
    s_sub_u32 s42, s55, 1
    v_mfma_f32_16x16x32_bf16 a[92:95], a[200:203], v[204:207], a[92:95]
    buffer_load_dwordx4 v18, s[12:15], s29 offen offset:3072 lds
    v_sub_u32 v20, s42, v28
    v_sub_u32 v21, s42, v29
    v_smfmac_f32_16x16x64_bf16 a[232:235], v[244:247], v[196:203], v248
    s_waitcnt vmcnt(8) lgkmcnt(6)
    s_barrier
    s_add_u32 s29, s29, 16384
    v_mfma_f32_16x16x32_bf16 v[156:159], a[160:163], v[68:71], v[108:111]
    v_exp_f32 v164, v164
    v_sub_u32 v22, s42, v30
    v_mfma_f32_16x16x32_bf16 v[156:159], a[164:167], v[72:75], v[156:159]
    ds_read_b64_tr_b16 a[192:193], v5 offset:16384
    v_cvt_pk_bf16_f32 v241, v162, v163
    v_min3_u32 v20, v20, v21, v22
    v_sub_u32 v21, s42, v31
    v_mfma_f32_16x16x32_bf16 v[156:159], a[168:171], v[76:79], v[156:159]
    v_exp_f32 v165, v165
    v_sub_u32 v22, s42, v32
    v_mfma_f32_16x16x32_bf16 v[156:159], a[172:175], v[80:83], v[156:159]
    ds_read_b64_tr_b16 a[194:195], v5 offset:20480
    buffer_store_dwordx4 a[240:243], v26, s[76:79], 0 offen offset:0 sc1
    v_min3_u32 v20, v20, v21, v22
    v_sub_u32 v21, s42, v33
    v_mfma_f32_16x16x32_bf16 v[160:163], a[172:175], v[96:99], v[112:115]
    v_exp_f32 v166, v166
    v_sub_u32 v22, s42, v34
    v_min3_u32 v20, v20, v21, v22
    v_mfma_f32_16x16x32_bf16 v[160:163], a[168:171], v[92:95], v[160:163]
    ds_read_b128 a[128:131], v1 offset:0
    v_cvt_pk_bf16_f32 v218, v164, v165
    v_sub_u32 v21, s42, v35
    v_mfma_f32_16x16x32_bf16 v[160:163], a[164:167], v[88:91], v[160:163]
    v_exp_f32 v167, v167
    v_min_u32 v20, v20, v21
    s_nop 1
    v_min_u32_dpp v20, v20, v20 row_shr:1 row_mask:0xf bank_mask:0xf
    v_mfma_f32_16x16x32_bf16 v[160:163], a[160:163], v[84:87], v[160:163]
    ds_read_b64_tr_b16 a[196:197], v5 offset:40960
    buffer_store_dwordx4 a[244:247], v26, s[76:79], 0 offen offset:1024 sc1
    v_min_u32_dpp v20, v20, v20 row_shr:2 row_mask:0xf bank_mask:0xf
    s_nop 1
    v_min_u32_dpp v20, v20, v20 row_shr:4 row_mask:0xf bank_mask:0xf
    v_mfma_f32_16x16x32_bf16 a[96:99], a[208:211], v[180:183], 0
    v_exp_f32 v168, v168
    v_min_u32_dpp v20, v20, v20 row_shr:8 row_mask:0xf bank_mask:0xf
    v_mfma_f32_16x16x32_bf16 a[96:99], a[212:215], v[184:187], a[96:99]
    ds_read_b64_tr_b16 a[198:199], v5 offset:45056
    v_cvt_pk_bf16_f32 v219, v166, v167
    v_min_u32_dpp v20, v20, v20 row_bcast:15 row_mask:0xa bank_mask:0xf
    s_nop 1
    v_min_u32_dpp v20, v20, v20 row_bcast:31 row_mask:0xc bank_mask:0xf
    v_mfma_f32_16x16x32_bf16 a[100:103], a[212:215], v[192:195], 0
    v_exp_f32 v169, v169
    v_readlane_b32 s56, v20, 63
    v_mfma_f32_16x16x32_bf16 a[100:103], a[208:211], v[188:191], a[100:103]
    s_sub_u32 s56, s42, s56
    ds_read_b128 a[132:135], v2 offset:0
    v_cvt_pk_bf16_f32 v226, v168, v169
    s_sub_u32 s42, s56, 1
    v_mfma_f32_16x16x32_bf16 a[104:107], a[208:211], v[196:199], 0
    s_add_u32 m0, s34, 16384
    v_exp_f32 v170, v170
    v_sub_u32 v20, s42, v28
    v_sub_u32 v21, s42, v29
    v_mfma_f32_16x16x32_bf16 a[104:107], a[212:215], v[200:203], a[104:107]
    buffer_load_dwordx4 v13, s[8:11], s28 offen offset:0 lds
    v_sub_u32 v22, s42, v30
    v_mfma_f32_16x16x32_bf16 a[108:111], a[212:215], v[208:211], 0
    v_exp_f32 v171, v171
    v_min3_u32 v20, v20, v21, v22
    v_sub_u32 v21, s42, v31
    v_mfma_f32_16x16x32_bf16 a[108:111], a[208:211], v[204:207], a[108:111]
    s_waitcnt lgkmcnt(6)
    v_sub_u32 v22, s42, v32
    v_min3_u32 v20, v20, v21, v22
    v_mfma_f32_16x16x32_bf16 v[164:167], a[176:179], v[36:39], v[100:103]
    v_exp_f32 v172, v172
    v_sub_u32 v21, s42, v33
    v_mfma_f32_16x16x32_bf16 v[164:167], a[180:183], v[40:43], v[164:167]
    ds_read_b64_tr_b16 a[200:201], v6 offset:16384
    v_cvt_pk_bf16_f32 v227, v170, v171
    v_sub_u32 v22, s42, v34
    v_min3_u32 v20, v20, v21, v22
    v_mfma_f32_16x16x32_bf16 v[164:167], a[184:187], v[44:47], v[164:167]
    v_exp_f32 v173, v173
    v_sub_u32 v21, s42, v35
    v_mfma_f32_16x16x32_bf16 v[164:167], a[188:191], v[48:51], v[164:167]
    ds_read_b64_tr_b16 a[202:203], v6 offset:20480
    buffer_store_dwordx4 a[248:251], v26, s[76:79], 0 offen offset:2048 sc1
    v_min_u32 v20, v20, v21
    s_nop 1
    v_min_u32_dpp v20, v20, v20 row_shr:1 row_mask:0xf bank_mask:0xf
    v_mfma_f32_16x16x32_bf16 v[168:171], a[188:191], v[64:67], v[104:107]
    v_exp_f32 v174, v174
    v_min_u32_dpp v20, v20, v20 row_shr:2 row_mask:0xf bank_mask:0xf
    s_nop 1
    v_min_u32_dpp v20, v20, v20 row_shr:4 row_mask:0xf bank_mask:0xf
    v_mfma_f32_16x16x32_bf16 v[168:171], a[184:187], v[60:63], v[168:171]
    ds_read_b128 a[136:139], v3 offset:0
    v_cvt_pk_bf16_f32 v234, v172, v173
    v_min_u32_dpp v20, v20, v20 row_shr:8 row_mask:0xf bank_mask:0xf
    v_mfma_f32_16x16x32_bf16 v[168:171], a[180:183], v[56:59], v[168:171]
    v_exp_f32 v175, v175
    v_min_u32_dpp v20, v20, v20 row_bcast:15 row_mask:0xa bank_mask:0xf
    s_nop 1
    v_min_u32_dpp v20, v20, v20 row_bcast:31 row_mask:0xc bank_mask:0xf
    v_mfma_f32_16x16x32_bf16 v[168:171], a[176:179], v[52:55], v[168:171]
    ds_read_b64_tr_b16 a[204:205], v6 offset:40960
    buffer_store_dwordx4 a[252:255], v26, s[76:79], 0 offen offset:3072 sc1
    buffer_store_dwordx4 v[252:255], v26, s[76:79], s45 offen offset:0 sc1
    v_readlane_b32 s57, v20, 63
    s_sub_u32 s57, s42, s57
    v_mfma_f32_16x16x32_bf16 a[112:115], a[216:219], v[180:183], 0
    s_sub_u32 s42, s57, 1
    v_exp_f32 v176, v176
    v_mfma_f32_16x16x32_bf16 a[112:115], a[220:223], v[184:187], a[112:115]
    ds_read_b64_tr_b16 a[206:207], v6 offset:45056
    v_cvt_pk_bf16_f32 v235, v174, v175
    v_mov_b32 v20, s50
    v_writelane_b32 v20, s51, 1
    v_mfma_f32_16x16x32_bf16 a[116:119], a[220:223], v[192:195], 0
    v_exp_f32 v177, v177
    v_writelane_b32 v20, s52, 2
    v_mfma_f32_16x16x32_bf16 a[116:119], a[216:219], v[188:191], a[116:119]
    ds_read_b128 a[140:143], v4 offset:0
    v_writelane_b32 v20, s53, 3
    v_writelane_b32 v20, s54, 4
    v_mfma_f32_16x16x32_bf16 a[120:123], a[216:219], v[196:199], 0
    v_exp_f32 v178, v178
    v_writelane_b32 v20, s55, 5
    v_writelane_b32 v20, s56, 6
    v_mfma_f32_16x16x32_bf16 a[120:123], a[220:223], v[200:203], a[120:123]
    v_cvt_pk_bf16_f32 v242, v176, v177
    v_writelane_b32 v20, s57, 7
    v_mfma_f32_16x16x32_bf16 a[124:127], a[220:223], v[208:211], 0
    s_lshl_b32 s42, s5, 8
    v_exp_f32 v179, v179
    s_add_u32 s42, s42, 86016
    v_mfma_f32_16x16x32_bf16 a[124:127], a[216:219], v[204:207], a[124:127]
    buffer_load_dwordx4 v14, s[8:11], s28 offen offset:1024 lds
    v_lshl_add_u32 v21, v19, 2, s42
    ds_write_b32 v21, v20
    v_smfmac_f32_16x16x64_bf16 a[236:239], v[244:247], v[204:211], v248
    s_waitcnt lgkmcnt(6)
    s_mov_b32 s35, 5
.p2align 6
L_attn_loop:
    v_mfma_f32_16x16x32_bf16 v[172:175], a[176:179], v[68:71], v[108:111]
    v_exp_f32 v116, v116
    v_mfma_f32_16x16x32_bf16 v[172:175], a[180:183], v[72:75], v[172:175]
    ds_read_b64_tr_b16 a[208:209], v7 offset:16384
    v_cvt_pk_bf16_f32 v243, v178, v179
    v_mfma_f32_16x16x32_bf16 v[172:175], a[184:187], v[76:79], v[172:175]
    v_exp_f32 v117, v117
    v_mfma_f32_16x16x32_bf16 v[172:175], a[188:191], v[80:83], v[172:175]
    ds_read_b64_tr_b16 a[210:211], v7 offset:20480
    v_mfma_f32_16x16x32_bf16 v[176:179], a[188:191], v[96:99], v[112:115]
    v_exp_f32 v118, v118
    v_mfma_f32_16x16x32_bf16 v[176:179], a[184:187], v[92:95], v[176:179]
    ds_read_b128 a[144:147], v1 offset:4096
    v_cvt_pk_bf16_f32 v180, v116, v117
    v_mfma_f32_16x16x32_bf16 v[176:179], a[180:183], v[88:91], v[176:179]
    v_exp_f32 v119, v119
    v_mfma_f32_16x16x32_bf16 v[176:179], a[176:179], v[84:87], v[176:179]
    ds_read_b64_tr_b16 a[212:213], v7 offset:40960
    v_mfma_f32_16x16x32_bf16 a[0:3], a[192:195], v[212:215], a[0:3]
    v_exp_f32 v120, v120
    v_mfma_f32_16x16x32_bf16 a[0:3], a[196:199], v[216:219], a[0:3]
    ds_read_b64_tr_b16 a[214:215], v7 offset:45056
    v_cvt_pk_bf16_f32 v181, v118, v119
    v_mfma_f32_16x16x32_bf16 a[4:7], a[196:199], v[224:227], a[4:7]
    v_exp_f32 v121, v121
    v_mfma_f32_16x16x32_bf16 a[4:7], a[192:195], v[220:223], a[4:7]
    ds_read_b128 a[148:151], v2 offset:4096
    v_cvt_pk_bf16_f32 v188, v120, v121
    v_mfma_f32_16x16x32_bf16 a[8:11], a[192:195], v[228:231], a[8:11]
    v_exp_f32 v122, v122
    v_mfma_f32_16x16x32_bf16 a[8:11], a[196:199], v[232:235], a[8:11]
    buffer_load_dwordx4 v15, s[8:11], s28 offen offset:2048 lds
    v_mfma_f32_16x16x32_bf16 a[12:15], a[196:199], v[240:243], a[12:15]
    v_exp_f32 v123, v123
    v_mfma_f32_16x16x32_bf16 a[12:15], a[192:195], v[236:239], a[12:15]
    s_waitcnt lgkmcnt(6)
    v_mfma_f32_16x16x32_bf16 v[116:119], a[128:131], v[36:39], v[100:103]
    v_exp_f32 v124, v124
    v_mfma_f32_16x16x32_bf16 v[116:119], a[132:135], v[40:43], v[116:119]
    ds_read_b64_tr_b16 a[216:217], v8 offset:16384
    v_cvt_pk_bf16_f32 v189, v122, v123
    v_mfma_f32_16x16x32_bf16 v[116:119], a[136:139], v[44:47], v[116:119]
    v_exp_f32 v125, v125
    v_mfma_f32_16x16x32_bf16 v[116:119], a[140:143], v[48:51], v[116:119]
    ds_read_b64_tr_b16 a[218:219], v8 offset:20480
    v_mfma_f32_16x16x32_bf16 v[120:123], a[140:143], v[64:67], v[104:107]
    v_exp_f32 v126, v126
    v_mfma_f32_16x16x32_bf16 v[120:123], a[136:139], v[60:63], v[120:123]
    ds_read_b128 a[152:155], v3 offset:4096
    v_cvt_pk_bf16_f32 v196, v124, v125
    v_mfma_f32_16x16x32_bf16 v[120:123], a[132:135], v[56:59], v[120:123]
    v_exp_f32 v127, v127
    v_mfma_f32_16x16x32_bf16 v[120:123], a[128:131], v[52:55], v[120:123]
    ds_read_b64_tr_b16 a[220:221], v8 offset:40960
    v_mfma_f32_16x16x32_bf16 a[16:19], a[200:203], v[212:215], a[16:19]
    v_exp_f32 v128, v128
    v_mfma_f32_16x16x32_bf16 a[16:19], a[204:207], v[216:219], a[16:19]
    ds_read_b64_tr_b16 a[222:223], v8 offset:45056
    v_cvt_pk_bf16_f32 v197, v126, v127
    v_mfma_f32_16x16x32_bf16 a[20:23], a[204:207], v[224:227], a[20:23]
    v_exp_f32 v129, v129
    v_mfma_f32_16x16x32_bf16 a[20:23], a[200:203], v[220:223], a[20:23]
    ds_read_b128 a[156:159], v4 offset:4096
    v_mfma_f32_16x16x32_bf16 a[24:27], a[200:203], v[228:231], a[24:27]
    v_exp_f32 v130, v130
    v_mfma_f32_16x16x32_bf16 a[24:27], a[204:207], v[232:235], a[24:27]
    v_cvt_pk_bf16_f32 v204, v128, v129
    v_mfma_f32_16x16x32_bf16 a[28:31], a[204:207], v[240:243], a[28:31]
    v_exp_f32 v131, v131
    v_mfma_f32_16x16x32_bf16 a[28:31], a[200:203], v[236:239], a[28:31]
    buffer_load_dwordx4 v16, s[8:11], s28 offen offset:3072 lds
    v_smfmac_f32_16x16x64_bf16 a[224:227], v[244:247], v[212:219], v248
    s_waitcnt lgkmcnt(6)
    v_mfma_f32_16x16x32_bf16 v[124:127], a[128:131], v[68:71], v[108:111]
    v_exp_f32 v132, v132
    v_mfma_f32_16x16x32_bf16 v[124:127], a[132:135], v[72:75], v[124:127]
    ds_read_b64_tr_b16 a[192:193], v9 offset:16384
    v_cvt_pk_bf16_f32 v205, v130, v131
    v_mfma_f32_16x16x32_bf16 v[124:127], a[136:139], v[76:79], v[124:127]
    v_exp_f32 v133, v133
    v_mfma_f32_16x16x32_bf16 v[124:127], a[140:143], v[80:83], v[124:127]
    ds_read_b64_tr_b16 a[194:195], v9 offset:20480
    s_cmp_eq_u32 s36, 0
    s_cbranch_scc1 L_site0
L_site_back0:
    v_mfma_f32_16x16x32_bf16 v[128:131], a[140:143], v[96:99], v[112:115]
    v_exp_f32 v134, v134
    v_mfma_f32_16x16x32_bf16 v[128:131], a[136:139], v[92:95], v[128:131]
    ds_read_b128 a[160:163], v1 offset:8192
    v_cvt_pk_bf16_f32 v182, v132, v133
    v_mfma_f32_16x16x32_bf16 v[128:131], a[132:135], v[88:91], v[128:131]
    v_exp_f32 v135, v135
    v_mfma_f32_16x16x32_bf16 v[128:131], a[128:131], v[84:87], v[128:131]
    ds_read_b64_tr_b16 a[196:197], v9 offset:40960
    v_mfma_f32_16x16x32_bf16 a[32:35], a[208:211], v[212:215], a[32:35]
    v_exp_f32 v136, v136
    v_mfma_f32_16x16x32_bf16 a[32:35], a[212:215], v[216:219], a[32:35]
    ds_read_b64_tr_b16 a[198:199], v9 offset:45056
    v_cvt_pk_bf16_f32 v183, v134, v135
    v_mfma_f32_16x16x32_bf16 a[36:39], a[212:215], v[224:227], a[36:39]
    v_exp_f32 v137, v137
    v_mfma_f32_16x16x32_bf16 a[36:39], a[208:211], v[220:223], a[36:39]
    ds_read_b128 a[164:167], v2 offset:8192
    v_cvt_pk_bf16_f32 v190, v136, v137
    v_mfma_f32_16x16x32_bf16 a[40:43], a[208:211], v[228:231], a[40:43]
    s_add_u32 s28, s28, 16384
    s_mov_b32 m0, s33
    v_exp_f32 v138, v138
    v_mfma_f32_16x16x32_bf16 a[40:43], a[212:215], v[232:235], a[40:43]
    buffer_load_dwordx4 v17, s[12:15], s29 offen offset:0 lds
    v_mfma_f32_16x16x32_bf16 a[44:47], a[212:215], v[240:243], a[44:47]
    v_exp_f32 v139, v139
    v_mfma_f32_16x16x32_bf16 a[44:47], a[208:211], v[236:239], a[44:47]
    s_waitcnt lgkmcnt(6)
    v_mfma_f32_16x16x32_bf16 v[132:135], a[144:147], v[36:39], v[100:103]
    v_exp_f32 v140, v140
    v_mfma_f32_16x16x32_bf16 v[132:135], a[148:151], v[40:43], v[132:135]
    ds_read_b64_tr_b16 a[200:201], v10 offset:16384
    v_cvt_pk_bf16_f32 v191, v138, v139
    v_mfma_f32_16x16x32_bf16 v[132:135], a[152:155], v[44:47], v[132:135]
    v_exp_f32 v141, v141
    v_mfma_f32_16x16x32_bf16 v[132:135], a[156:159], v[48:51], v[132:135]
    ds_read_b64_tr_b16 a[202:203], v10 offset:20480
    v_mfma_f32_16x16x32_bf16 v[136:139], a[156:159], v[64:67], v[104:107]
    v_exp_f32 v142, v142
    v_mfma_f32_16x16x32_bf16 v[136:139], a[152:155], v[60:63], v[136:139]
    ds_read_b128 a[168:171], v3 offset:8192
    v_cvt_pk_bf16_f32 v198, v140, v141
    v_mfma_f32_16x16x32_bf16 v[136:139], a[148:151], v[56:59], v[136:139]
    v_exp_f32 v143, v143
    v_mfma_f32_16x16x32_bf16 v[136:139], a[144:147], v[52:55], v[136:139]
    ds_read_b64_tr_b16 a[204:205], v10 offset:40960
    v_mfma_f32_16x16x32_bf16 a[48:51], a[216:219], v[212:215], a[48:51]
    v_exp_f32 v144, v144
    v_mfma_f32_16x16x32_bf16 a[48:51], a[220:223], v[216:219], a[48:51]
    ds_read_b64_tr_b16 a[206:207], v10 offset:45056
    v_cvt_pk_bf16_f32 v199, v142, v143
    v_mfma_f32_16x16x32_bf16 a[52:55], a[220:223], v[224:227], a[52:55]
    v_exp_f32 v145, v145
    v_mfma_f32_16x16x32_bf16 a[52:55], a[216:219], v[220:223], a[52:55]
    ds_read_b128 a[172:175], v4 offset:8192
    v_mfma_f32_16x16x32_bf16 a[56:59], a[216:219], v[228:231], a[56:59]
    v_exp_f32 v146, v146
    v_mfma_f32_16x16x32_bf16 a[56:59], a[220:223], v[232:235], a[56:59]
    v_cvt_pk_bf16_f32 v206, v144, v145
    v_mfma_f32_16x16x32_bf16 a[60:63], a[220:223], v[240:243], a[60:63]
    v_exp_f32 v147, v147
    v_mfma_f32_16x16x32_bf16 a[60:63], a[216:219], v[236:239], a[60:63]
    buffer_load_dwordx4 v18, s[12:15], s29 offen offset:1024 lds
    v_smfmac_f32_16x16x64_bf16 a[228:231], v[244:247], v[220:227], v248
    s_waitcnt lgkmcnt(6)
    v_mfma_f32_16x16x32_bf16 v[140:143], a[144:147], v[68:71], v[108:111]
    v_exp_f32 v148, v148
    v_mfma_f32_16x16x32_bf16 v[140:143], a[148:151], v[72:75], v[140:143]
    ds_read_b64_tr_b16 a[208:209], v11 offset:16384
    v_cvt_pk_bf16_f32 v207, v146, v147
    v_mfma_f32_16x16x32_bf16 v[140:143], a[152:155], v[76:79], v[140:143]
    v_exp_f32 v149, v149
    v_mfma_f32_16x16x32_bf16 v[140:143], a[156:159], v[80:83], v[140:143]
    ds_read_b64_tr_b16 a[210:211], v11 offset:20480
    v_mfma_f32_16x16x32_bf16 v[144:147], a[156:159], v[96:99], v[112:115]
    v_exp_f32 v150, v150
    v_mfma_f32_16x16x32_bf16 v[144:147], a[152:155], v[92:95], v[144:147]
    ds_read_b128 a[176:179], v1 offset:12288
    v_cvt_pk_bf16_f32 v184, v148, v149
    v_mfma_f32_16x16x32_bf16 v[144:147], a[148:151], v[88:91], v[144:147]
    v_exp_f32 v151, v151
    v_mfma_f32_16x16x32_bf16 v[144:147], a[144:147], v[84:87], v[144:147]
    ds_read_b64_tr_b16 a[212:213], v11 offset:40960
    v_mfma_f32_16x16x32_bf16 a[64:67], a[192:195], v[212:215], a[64:67]
    v_exp_f32 v152, v152
    v_mfma_f32_16x16x32_bf16 a[64:67], a[196:199], v[216:219], a[64:67]
    ds_read_b64_tr_b16 a[214:215], v11 offset:45056
    v_cvt_pk_bf16_f32 v185, v150, v151
    v_mfma_f32_16x16x32_bf16 a[68:71], a[196:199], v[224:227], a[68:71]
    v_exp_f32 v153, v153
    v_mfma_f32_16x16x32_bf16 a[68:71], a[192:195], v[220:223], a[68:71]
    ds_read_b128 a[180:183], v2 offset:12288
    v_cvt_pk_bf16_f32 v192, v152, v153
    v_mfma_f32_16x16x32_bf16 a[72:75], a[192:195], v[228:231], a[72:75]
    v_exp_f32 v154, v154
    v_mfma_f32_16x16x32_bf16 a[72:75], a[196:199], v[232:235], a[72:75]
    buffer_load_dwordx4 v17, s[12:15], s29 offen offset:2048 lds
    v_mfma_f32_16x16x32_bf16 a[76:79], a[196:199], v[240:243], a[76:79]
    v_exp_f32 v155, v155
    v_mfma_f32_16x16x32_bf16 a[76:79], a[192:195], v[236:239], a[76:79]
    s_waitcnt lgkmcnt(6)
    v_mfma_f32_16x16x32_bf16 v[148:151], a[160:163], v[36:39], v[100:103]
    v_exp_f32 v156, v156
    v_mfma_f32_16x16x32_bf16 v[148:151], a[164:167], v[40:43], v[148:151]
    ds_read_b64_tr_b16 a[216:217], v12 offset:16384
    v_cvt_pk_bf16_f32 v193, v154, v155
    v_mfma_f32_16x16x32_bf16 v[148:151], a[168:171], v[44:47], v[148:151]
    v_exp_f32 v157, v157
    v_mfma_f32_16x16x32_bf16 v[148:151], a[172:175], v[48:51], v[148:151]
    ds_read_b64_tr_b16 a[218:219], v12 offset:20480
    v_mfma_f32_16x16x32_bf16 v[152:155], a[172:175], v[64:67], v[104:107]
    v_exp_f32 v158, v158
    v_mfma_f32_16x16x32_bf16 v[152:155], a[168:171], v[60:63], v[152:155]
    ds_read_b128 a[184:187], v3 offset:12288
    v_cvt_pk_bf16_f32 v200, v156, v157
    v_mfma_f32_16x16x32_bf16 v[152:155], a[164:167], v[56:59], v[152:155]
    v_exp_f32 v159, v159
    v_mfma_f32_16x16x32_bf16 v[152:155], a[160:163], v[52:55], v[152:155]
    ds_read_b64_tr_b16 a[220:221], v12 offset:40960
    v_mfma_f32_16x16x32_bf16 a[80:83], a[200:203], v[212:215], a[80:83]
    v_exp_f32 v160, v160
    v_mfma_f32_16x16x32_bf16 a[80:83], a[204:207], v[216:219], a[80:83]
    ds_read_b64_tr_b16 a[222:223], v12 offset:45056
    v_cvt_pk_bf16_f32 v201, v158, v159
    v_mfma_f32_16x16x32_bf16 a[84:87], a[204:207], v[224:227], a[84:87]
    v_exp_f32 v161, v161
    v_mfma_f32_16x16x32_bf16 a[84:87], a[200:203], v[220:223], a[84:87]
    ds_read_b128 a[188:191], v4 offset:12288
    v_mfma_f32_16x16x32_bf16 a[88:91], a[200:203], v[228:231], a[88:91]
    v_exp_f32 v162, v162
    v_mfma_f32_16x16x32_bf16 a[88:91], a[204:207], v[232:235], a[88:91]
    v_cvt_pk_bf16_f32 v208, v160, v161
    v_mfma_f32_16x16x32_bf16 a[92:95], a[204:207], v[240:243], a[92:95]
    v_exp_f32 v163, v163
    v_mfma_f32_16x16x32_bf16 a[92:95], a[200:203], v[236:239], a[92:95]
    buffer_load_dwordx4 v18, s[12:15], s29 offen offset:3072 lds
    v_smfmac_f32_16x16x64_bf16 a[232:235], v[244:247], v[228:235], v248
    s_waitcnt vmcnt(8) lgkmcnt(6)
    s_barrier
    s_add_u32 s29, s29, 16384
    v_mfma_f32_16x16x32_bf16 v[156:159], a[160:163], v[68:71], v[108:111]
    v_exp_f32 v164, v164
    v_mfma_f32_16x16x32_bf16 v[156:159], a[164:167], v[72:75], v[156:159]
    ds_read_b64_tr_b16 a[192:193], v5 offset:57344
    v_cvt_pk_bf16_f32 v209, v162, v163
    v_mfma_f32_16x16x32_bf16 v[156:159], a[168:171], v[76:79], v[156:159]
    v_exp_f32 v165, v165
    v_mfma_f32_16x16x32_bf16 v[156:159], a[172:175], v[80:83], v[156:159]
    ds_read_b64_tr_b16 a[194:195], v5 offset:61440
    v_mfma_f32_16x16x32_bf16 v[160:163], a[172:175], v[96:99], v[112:115]
    v_exp_f32 v166, v166
    v_mfma_f32_16x16x32_bf16 v[160:163], a[168:171], v[92:95], v[160:163]
    ds_read_b128 a[128:131], v1 offset:49152
    v_cvt_pk_bf16_f32 v186, v164, v165
    v_mfma_f32_16x16x32_bf16 v[160:163], a[164:167], v[88:91], v[160:163]
    v_exp_f32 v167, v167
    v_mfma_f32_16x16x32_bf16 v[160:163], a[160:163], v[84:87], v[160:163]
    ds_read_b64_tr_b16 a[196:197], v5 offset:0
    v_mfma_f32_16x16x32_bf16 a[96:99], a[208:211], v[212:215], a[96:99]
    v_exp_f32 v168, v168
    v_mfma_f32_16x16x32_bf16 a[96:99], a[212:215], v[216:219], a[96:99]
    ds_read_b64_tr_b16 a[198:199], v5 offset:4096
    v_cvt_pk_bf16_f32 v187, v166, v167
    v_mfma_f32_16x16x32_bf16 a[100:103], a[212:215], v[224:227], a[100:103]
    v_exp_f32 v169, v169
    v_mfma_f32_16x16x32_bf16 a[100:103], a[208:211], v[220:223], a[100:103]
    ds_read_b128 a[132:135], v2 offset:49152
    v_cvt_pk_bf16_f32 v194, v168, v169
    v_mfma_f32_16x16x32_bf16 a[104:107], a[208:211], v[228:231], a[104:107]
    s_add_u32 m0, s34, 32768
    v_exp_f32 v170, v170
    v_mfma_f32_16x16x32_bf16 a[104:107], a[212:215], v[232:235], a[104:107]
    buffer_load_dwordx4 v13, s[8:11], s28 offen offset:0 lds
    v_mfma_f32_16x16x32_bf16 a[108:111], a[212:215], v[240:243], a[108:111]
    v_exp_f32 v171, v171
    v_mfma_f32_16x16x32_bf16 a[108:111], a[208:211], v[236:239], a[108:111]
    s_waitcnt lgkmcnt(6)
    v_mfma_f32_16x16x32_bf16 v[164:167], a[176:179], v[36:39], v[100:103]
    v_exp_f32 v172, v172
    v_mfma_f32_16x16x32_bf16 v[164:167], a[180:183], v[40:43], v[164:167]
    ds_read_b64_tr_b16 a[200:201], v6 offset:57344
    v_cvt_pk_bf16_f32 v195, v170, v171
    v_mfma_f32_16x16x32_bf16 v[164:167], a[184:187], v[44:47], v[164:167]
    v_exp_f32 v173, v173
    v_mfma_f32_16x16x32_bf16 v[164:167], a[188:191], v[48:51], v[164:167]
    ds_read_b64_tr_b16 a[202:203], v6 offset:61440
    v_mfma_f32_16x16x32_bf16 v[168:171], a[188:191], v[64:67], v[104:107]
    v_exp_f32 v174, v174
    v_mfma_f32_16x16x32_bf16 v[168:171], a[184:187], v[60:63], v[168:171]
    ds_read_b128 a[136:139], v3 offset:49152
    v_cvt_pk_bf16_f32 v202, v172, v173
    v_mfma_f32_16x16x32_bf16 v[168:171], a[180:183], v[56:59], v[168:171]
    v_exp_f32 v175, v175
    v_mfma_f32_16x16x32_bf16 v[168:171], a[176:179], v[52:55], v[168:171]
    ds_read_b64_tr_b16 a[204:205], v6 offset:0
    v_mfma_f32_16x16x32_bf16 a[112:115], a[216:219], v[212:215], a[112:115]
    v_exp_f32 v176, v176
    v_mfma_f32_16x16x32_bf16 a[112:115], a[220:223], v[216:219], a[112:115]
    ds_read_b64_tr_b16 a[206:207], v6 offset:4096
    v_cvt_pk_bf16_f32 v203, v174, v175
    v_mfma_f32_16x16x32_bf16 a[116:119], a[220:223], v[224:227], a[116:119]
    v_exp_f32 v177, v177
    v_mfma_f32_16x16x32_bf16 a[116:119], a[216:219], v[220:223], a[116:119]
    ds_read_b128 a[140:143], v4 offset:49152
    v_mfma_f32_16x16x32_bf16 a[120:123], a[216:219], v[228:231], a[120:123]
    v_exp_f32 v178, v178
    v_mfma_f32_16x16x32_bf16 a[120:123], a[220:223], v[232:235], a[120:123]
    v_cvt_pk_bf16_f32 v210, v176, v177
    v_mfma_f32_16x16x32_bf16 a[124:127], a[220:223], v[240:243], a[124:127]
    v_exp_f32 v179, v179
    v_mfma_f32_16x16x32_bf16 a[124:127], a[216:219], v[236:239], a[124:127]
    buffer_load_dwordx4 v14, s[8:11], s28 offen offset:1024 lds
    v_smfmac_f32_16x16x64_bf16 a[236:239], v[244:247], v[236:243], v248
    s_waitcnt lgkmcnt(6)
    v_mfma_f32_16x16x32_bf16 v[172:175], a[176:179], v[68:71], v[108:111]
    v_exp_f32 v116, v116
    v_mfma_f32_16x16x32_bf16 v[172:175], a[180:183], v[72:75], v[172:175]
    ds_read_b64_tr_b16 a[208:209], v7 offset:57344
    v_cvt_pk_bf16_f32 v211, v178, v179
    v_mfma_f32_16x16x32_bf16 v[172:175], a[184:187], v[76:79], v[172:175]
    v_exp_f32 v117, v117
    v_mfma_f32_16x16x32_bf16 v[172:175], a[188:191], v[80:83], v[172:175]
    ds_read_b64_tr_b16 a[210:211], v7 offset:61440
    v_mfma_f32_16x16x32_bf16 v[176:179], a[188:191], v[96:99], v[112:115]
    v_exp_f32 v118, v118
    v_mfma_f32_16x16x32_bf16 v[176:179], a[184:187], v[92:95], v[176:179]
    ds_read_b128 a[144:147], v1 offset:53248
    v_cvt_pk_bf16_f32 v212, v116, v117
    v_mfma_f32_16x16x32_bf16 v[176:179], a[180:183], v[88:91], v[176:179]
    v_exp_f32 v119, v119
    v_mfma_f32_16x16x32_bf16 v[176:179], a[176:179], v[84:87], v[176:179]
    ds_read_b64_tr_b16 a[212:213], v7 offset:0
    v_mfma_f32_16x16x32_bf16 a[0:3], a[192:195], v[180:183], a[0:3]
    v_exp_f32 v120, v120
    v_mfma_f32_16x16x32_bf16 a[0:3], a[196:199], v[184:187], a[0:3]
    ds_read_b64_tr_b16 a[214:215], v7 offset:4096
    v_cvt_pk_bf16_f32 v213, v118, v119
    v_mfma_f32_16x16x32_bf16 a[4:7], a[196:199], v[192:195], a[4:7]
    v_exp_f32 v121, v121
    v_mfma_f32_16x16x32_bf16 a[4:7], a[192:195], v[188:191], a[4:7]
    ds_read_b128 a[148:151], v2 offset:53248
    v_cvt_pk_bf16_f32 v220, v120, v121
    v_mfma_f32_16x16x32_bf16 a[8:11], a[192:195], v[196:199], a[8:11]
    v_exp_f32 v122, v122
    v_mfma_f32_16x16x32_bf16 a[8:11], a[196:199], v[200:203], a[8:11]
    buffer_load_dwordx4 v15, s[8:11], s28 offen offset:2048 lds
    v_mfma_f32_16x16x32_bf16 a[12:15], a[196:199], v[208:211], a[12:15]
    v_exp_f32 v123, v123
    v_mfma_f32_16x16x32_bf16 a[12:15], a[192:195], v[204:207], a[12:15]
    s_waitcnt lgkmcnt(6)
    v_mfma_f32_16x16x32_bf16 v[116:119], a[128:131], v[36:39], v[100:103]
    v_exp_f32 v124, v124
    v_mfma_f32_16x16x32_bf16 v[116:119], a[132:135], v[40:43], v[116:119]
    ds_read_b64_tr_b16 a[216:217], v8 offset:57344
    v_cvt_pk_bf16_f32 v221, v122, v123
    v_mfma_f32_16x16x32_bf16 v[116:119], a[136:139], v[44:47], v[116:119]
    v_exp_f32 v125, v125
    v_mfma_f32_16x16x32_bf16 v[116:119], a[140:143], v[48:51], v[116:119]
    ds_read_b64_tr_b16 a[218:219], v8 offset:61440
    v_mfma_f32_16x16x32_bf16 v[120:123], a[140:143], v[64:67], v[104:107]
    v_exp_f32 v126, v126
    v_mfma_f32_16x16x32_bf16 v[120:123], a[136:139], v[60:63], v[120:123]
    ds_read_b128 a[152:155], v3 offset:53248
    v_cvt_pk_bf16_f32 v228, v124, v125
    v_mfma_f32_16x16x32_bf16 v[120:123], a[132:135], v[56:59], v[120:123]
    v_exp_f32 v127, v127
    v_mfma_f32_16x16x32_bf16 v[120:123], a[128:131], v[52:55], v[120:123]
    ds_read_b64_tr_b16 a[220:221], v8 offset:0
    v_mfma_f32_16x16x32_bf16 a[16:19], a[200:203], v[180:183], a[16:19]
    v_exp_f32 v128, v128
    v_mfma_f32_16x16x32_bf16 a[16:19], a[204:207], v[184:187], a[16:19]
    ds_read_b64_tr_b16 a[222:223], v8 offset:4096
    v_cvt_pk_bf16_f32 v229, v126, v127
    v_mfma_f32_16x16x32_bf16 a[20:23], a[204:207], v[192:195], a[20:23]
    v_exp_f32 v129, v129
    v_mfma_f32_16x16x32_bf16 a[20:23], a[200:203], v[188:191], a[20:23]
    ds_read_b128 a[156:159], v4 offset:53248
    v_mfma_f32_16x16x32_bf16 a[24:27], a[200:203], v[196:199], a[24:27]
    v_exp_f32 v130, v130
    v_mfma_f32_16x16x32_bf16 a[24:27], a[204:207], v[200:203], a[24:27]
    v_cvt_pk_bf16_f32 v236, v128, v129
    v_mfma_f32_16x16x32_bf16 a[28:31], a[204:207], v[208:211], a[28:31]
    v_exp_f32 v131, v131
    v_mfma_f32_16x16x32_bf16 a[28:31], a[200:203], v[204:207], a[28:31]
    buffer_load_dwordx4 v16, s[8:11], s28 offen offset:3072 lds
    v_smfmac_f32_16x16x64_bf16 a[224:227], v[244:247], v[180:187], v248
    s_waitcnt lgkmcnt(6)
    v_mfma_f32_16x16x32_bf16 v[124:127], a[128:131], v[68:71], v[108:111]
    v_exp_f32 v132, v132
    v_mfma_f32_16x16x32_bf16 v[124:127], a[132:135], v[72:75], v[124:127]
    ds_read_b64_tr_b16 a[192:193], v9 offset:57344
    v_cvt_pk_bf16_f32 v237, v130, v131
    v_mfma_f32_16x16x32_bf16 v[124:127], a[136:139], v[76:79], v[124:127]
    v_exp_f32 v133, v133
    v_mfma_f32_16x16x32_bf16 v[124:127], a[140:143], v[80:83], v[124:127]
    ds_read_b64_tr_b16 a[194:195], v9 offset:61440
    s_cmp_eq_u32 s36, 1
    s_cbranch_scc1 L_site1
L_site_back1:
    v_mfma_f32_16x16x32_bf16 v[128:131], a[140:143], v[96:99], v[112:115]
    v_exp_f32 v134, v134
    v_mfma_f32_16x16x32_bf16 v[128:131], a[136:139], v[92:95], v[128:131]
    ds_read_b128 a[160:163], v1 offset:57344
    v_cvt_pk_bf16_f32 v214, v132, v133
    v_mfma_f32_16x16x32_bf16 v[128:131], a[132:135], v[88:91], v[128:131]
    v_exp_f32 v135, v135
    v_mfma_f32_16x16x32_bf16 v[128:131], a[128:131], v[84:87], v[128:131]
    ds_read_b64_tr_b16 a[196:197], v9 offset:0
    v_mfma_f32_16x16x32_bf16 a[32:35], a[208:211], v[180:183], a[32:35]
    v_exp_f32 v136, v136
    v_mfma_f32_16x16x32_bf16 a[32:35], a[212:215], v[184:187], a[32:35]
    ds_read_b64_tr_b16 a[198:199], v9 offset:4096
    v_cvt_pk_bf16_f32 v215, v134, v135
    v_mfma_f32_16x16x32_bf16 a[36:39], a[212:215], v[192:195], a[36:39]
    v_exp_f32 v137, v137
    v_mfma_f32_16x16x32_bf16 a[36:39], a[208:211], v[188:191], a[36:39]
    ds_read_b128 a[164:167], v2 offset:57344
    v_cvt_pk_bf16_f32 v222, v136, v137
    v_mfma_f32_16x16x32_bf16 a[40:43], a[208:211], v[196:199], a[40:43]
    s_add_u32 s28, s28, 16384
    s_mov_b32 m0, s30
    v_exp_f32 v138, v138
    v_mfma_f32_16x16x32_bf16 a[40:43], a[212:215], v[200:203], a[40:43]
    buffer_load_dwordx4 v17, s[12:15], s29 offen offset:0 lds
    v_mfma_f32_16x16x32_bf16 a[44:47], a[212:215], v[208:211], a[44:47]
    v_exp_f32 v139, v139
    v_mfma_f32_16x16x32_bf16 a[44:47], a[208:211], v[204:207], a[44:47]
    s_waitcnt lgkmcnt(6)
    v_mfma_f32_16x16x32_bf16 v[132:135], a[144:147], v[36:39], v[100:103]
    v_exp_f32 v140, v140
    v_mfma_f32_16x16x32_bf16 v[132:135], a[148:151], v[40:43], v[132:135]
    ds_read_b64_tr_b16 a[200:201], v10 offset:57344
    v_cvt_pk_bf16_f32 v223, v138, v139
    v_mfma_f32_16x16x32_bf16 v[132:135], a[152:155], v[44:47], v[132:135]
    v_exp_f32 v141, v141
    v_mfma_f32_16x16x32_bf16 v[132:135], a[156:159], v[48:51], v[132:135]
    ds_read_b64_tr_b16 a[202:203], v10 offset:61440
    v_mfma_f32_16x16x32_bf16 v[136:139], a[156:159], v[64:67], v[104:107]
    v_exp_f32 v142, v142
    v_mfma_f32_16x16x32_bf16 v[136:139], a[152:155], v[60:63], v[136:139]
    ds_read_b128 a[168:171], v3 offset:57344
    v_cvt_pk_bf16_f32 v230, v140, v141
    v_mfma_f32_16x16x32_bf16 v[136:139], a[148:151], v[56:59], v[136:139]
    v_exp_f32 v143, v143
    v_mfma_f32_16x16x32_bf16 v[136:139], a[144:147], v[52:55], v[136:139]
    ds_read_b64_tr_b16 a[204:205], v10 offset:0
    v_mfma_f32_16x16x32_bf16 a[48:51], a[216:219], v[180:183], a[48:51]
    v_exp_f32 v144, v144
    v_mfma_f32_16x16x32_bf16 a[48:51], a[220:223], v[184:187], a[48:51]
    ds_read_b64_tr_b16 a[206:207], v10 offset:4096
    v_cvt_pk_bf16_f32 v231, v142, v143
    v_mfma_f32_16x16x32_bf16 a[52:55], a[220:223], v[192:195], a[52:55]
    v_exp_f32 v145, v145
    v_mfma_f32_16x16x32_bf16 a[52:55], a[216:219], v[188:191], a[52:55]
    ds_read_b128 a[172:175], v4 offset:57344
    v_mfma_f32_16x16x32_bf16 a[56:59], a[216:219], v[196:199], a[56:59]
    v_exp_f32 v146, v146
    v_mfma_f32_16x16x32_bf16 a[56:59], a[220:223], v[200:203], a[56:59]
    v_cvt_pk_bf16_f32 v238, v144, v145
    v_mfma_f32_16x16x32_bf16 a[60:63], a[220:223], v[208:211], a[60:63]
    v_exp_f32 v147, v147
    v_mfma_f32_16x16x32_bf16 a[60:63], a[216:219], v[204:207], a[60:63]
    buffer_load_dwordx4 v18, s[12:15], s29 offen offset:1024 lds
    v_smfmac_f32_16x16x64_bf16 a[228:231], v[244:247], v[188:195], v248
    s_waitcnt lgkmcnt(6)
    v_mfma_f32_16x16x32_bf16 v[140:143], a[144:147], v[68:71], v[108:111]
    v_exp_f32 v148, v148
    v_mfma_f32_16x16x32_bf16 v[140:143], a[148:151], v[72:75], v[140:143]
    ds_read_b64_tr_b16 a[208:209], v11 offset:57344
    v_cvt_pk_bf16_f32 v239, v146, v147
    v_mfma_f32_16x16x32_bf16 v[140:143], a[152:155], v[76:79], v[140:143]
    v_exp_f32 v149, v149
    v_mfma_f32_16x16x32_bf16 v[140:143], a[156:159], v[80:83], v[140:143]
    ds_read_b64_tr_b16 a[210:211], v11 offset:61440
    v_mfma_f32_16x16x32_bf16 v[144:147], a[156:159], v[96:99], v[112:115]
    v_exp_f32 v150, v150
    v_mfma_f32_16x16x32_bf16 v[144:147], a[152:155], v[92:95], v[144:147]
    ds_read_b128 a[176:179], v1 offset:61440
    v_cvt_pk_bf16_f32 v216, v148, v149
    v_mfma_f32_16x16x32_bf16 v[144:147], a[148:151], v[88:91], v[144:147]
    v_exp_f32 v151, v151
    v_mfma_f32_16x16x32_bf16 v[144:147], a[144:147], v[84:87], v[144:147]
    ds_read_b64_tr_b16 a[212:213], v11 offset:0
    v_mfma_f32_16x16x32_bf16 a[64:67], a[192:195], v[180:183], a[64:67]
    v_exp_f32 v152, v152
    v_mfma_f32_16x16x32_bf16 a[64:67], a[196:199], v[184:187], a[64:67]
    ds_read_b64_tr_b16 a[214:215], v11 offset:4096
    v_cvt_pk_bf16_f32 v217, v150, v151
    v_mfma_f32_16x16x32_bf16 a[68:71], a[196:199], v[192:195], a[68:71]
    v_exp_f32 v153, v153
    v_mfma_f32_16x16x32_bf16 a[68:71], a[192:195], v[188:191], a[68:71]
    ds_read_b128 a[180:183], v2 offset:61440
    v_cvt_pk_bf16_f32 v224, v152, v153
    v_mfma_f32_16x16x32_bf16 a[72:75], a[192:195], v[196:199], a[72:75]
    v_exp_f32 v154, v154
    v_mfma_f32_16x16x32_bf16 a[72:75], a[196:199], v[200:203], a[72:75]
    buffer_load_dwordx4 v17, s[12:15], s29 offen offset:2048 lds
    v_mfma_f32_16x16x32_bf16 a[76:79], a[196:199], v[208:211], a[76:79]
    v_exp_f32 v155, v155
    v_mfma_f32_16x16x32_bf16 a[76:79], a[192:195], v[204:207], a[76:79]
    s_waitcnt lgkmcnt(6)
    v_mfma_f32_16x16x32_bf16 v[148:151], a[160:163], v[36:39], v[100:103]
    v_exp_f32 v156, v156
    v_mfma_f32_16x16x32_bf16 v[148:151], a[164:167], v[40:43], v[148:151]
    ds_read_b64_tr_b16 a[216:217], v12 offset:57344
    v_cvt_pk_bf16_f32 v225, v154, v155
    v_mfma_f32_16x16x32_bf16 v[148:151], a[168:171], v[44:47], v[148:151]
    v_exp_f32 v157, v157
    v_mfma_f32_16x16x32_bf16 v[148:151], a[172:175], v[48:51], v[148:151]
    ds_read_b64_tr_b16 a[218:219], v12 offset:61440
    v_mfma_f32_16x16x32_bf16 v[152:155], a[172:175], v[64:67], v[104:107]
    v_exp_f32 v158, v158
    v_mfma_f32_16x16x32_bf16 v[152:155], a[168:171], v[60:63], v[152:155]
    ds_read_b128 a[184:187], v3 offset:61440
    v_cvt_pk_bf16_f32 v232, v156, v157
    v_mfma_f32_16x16x32_bf16 v[152:155], a[164:167], v[56:59], v[152:155]
    v_exp_f32 v159, v159
    v_mfma_f32_16x16x32_bf16 v[152:155], a[160:163], v[52:55], v[152:155]
    ds_read_b64_tr_b16 a[220:221], v12 offset:0
    v_mfma_f32_16x16x32_bf16 a[80:83], a[200:203], v[180:183], a[80:83]
    v_exp_f32 v160, v160
    v_mfma_f32_16x16x32_bf16 a[80:83], a[204:207], v[184:187], a[80:83]
    ds_read_b64_tr_b16 a[222:223], v12 offset:4096
    v_cvt_pk_bf16_f32 v233, v158, v159
    v_mfma_f32_16x16x32_bf16 a[84:87], a[204:207], v[192:195], a[84:87]
    v_exp_f32 v161, v161
    v_mfma_f32_16x16x32_bf16 a[84:87], a[200:203], v[188:191], a[84:87]
    ds_read_b128 a[188:191], v4 offset:61440
    v_mfma_f32_16x16x32_bf16 a[88:91], a[200:203], v[196:199], a[88:91]
    v_exp_f32 v162, v162
    v_mfma_f32_16x16x32_bf16 a[88:91], a[204:207], v[200:203], a[88:91]
    v_cvt_pk_bf16_f32 v240, v160, v161
    v_mfma_f32_16x16x32_bf16 a[92:95], a[204:207], v[208:211], a[92:95]
    v_exp_f32 v163, v163
    v_mfma_f32_16x16x32_bf16 a[92:95], a[200:203], v[204:207], a[92:95]
    buffer_load_dwordx4 v18, s[12:15], s29 offen offset:3072 lds
    v_smfmac_f32_16x16x64_bf16 a[232:235], v[244:247], v[196:203], v248
    s_waitcnt vmcnt(8) lgkmcnt(6)
    s_barrier
    s_add_u32 s29, s29, 16384
    v_mfma_f32_16x16x32_bf16 v[156:159], a[160:163], v[68:71], v[108:111]
    v_exp_f32 v164, v164
    v_mfma_f32_16x16x32_bf16 v[156:159], a[164:167], v[72:75], v[156:159]
    ds_read_b64_tr_b16 a[192:193], v5 offset:24576
    v_cvt_pk_bf16_f32 v241, v162, v163
    v_mfma_f32_16x16x32_bf16 v[156:159], a[168:171], v[76:79], v[156:159]
    v_exp_f32 v165, v165
    v_mfma_f32_16x16x32_bf16 v[156:159], a[172:175], v[80:83], v[156:159]
    ds_read_b64_tr_b16 a[194:195], v5 offset:28672
    v_mfma_f32_16x16x32_bf16 v[160:163], a[172:175], v[96:99], v[112:115]
    v_exp_f32 v166, v166
    v_mfma_f32_16x16x32_bf16 v[160:163], a[168:171], v[92:95], v[160:163]
    ds_read_b128 a[128:131], v1 offset:16384
    v_cvt_pk_bf16_f32 v218, v164, v165
    v_mfma_f32_16x16x32_bf16 v[160:163], a[164:167], v[88:91], v[160:163]
    v_exp_f32 v167, v167
    v_mfma_f32_16x16x32_bf16 v[160:163], a[160:163], v[84:87], v[160:163]
    ds_read_b64_tr_b16 a[196:197], v5 offset:49152
    v_mfma_f32_16x16x32_bf16 a[96:99], a[208:211], v[180:183], a[96:99]
    v_exp_f32 v168, v168
    v_mfma_f32_16x16x32_bf16 a[96:99], a[212:215], v[184:187], a[96:99]
    ds_read_b64_tr_b16 a[198:199], v5 offset:53248
    v_cvt_pk_bf16_f32 v219, v166, v167
    v_mfma_f32_16x16x32_bf16 a[100:103], a[212:215], v[192:195], a[100:103]
    v_exp_f32 v169, v169
    v_mfma_f32_16x16x32_bf16 a[100:103], a[208:211], v[188:191], a[100:103]
    ds_read_b128 a[132:135], v2 offset:16384
    v_cvt_pk_bf16_f32 v226, v168, v169
    v_mfma_f32_16x16x32_bf16 a[104:107], a[208:211], v[196:199], a[104:107]
    s_add_u32 m0, s34, 0
    v_exp_f32 v170, v170
    v_mfma_f32_16x16x32_bf16 a[104:107], a[212:215], v[200:203], a[104:107]
    buffer_load_dwordx4 v13, s[8:11], s28 offen offset:0 lds
    v_mfma_f32_16x16x32_bf16 a[108:111], a[212:215], v[208:211], a[108:111]
    v_exp_f32 v171, v171
    v_mfma_f32_16x16x32_bf16 a[108:111], a[208:211], v[204:207], a[108:111]
    s_waitcnt lgkmcnt(6)
    v_mfma_f32_16x16x32_bf16 v[164:167], a[176:179], v[36:39], v[100:103]
    v_exp_f32 v172, v172
    v_mfma_f32_16x16x32_bf16 v[164:167], a[180:183], v[40:43], v[164:167]
    ds_read_b64_tr_b16 a[200:201], v6 offset:24576
    v_cvt_pk_bf16_f32 v227, v170, v171
    v_mfma_f32_16x16x32_bf16 v[164:167], a[184:187], v[44:47], v[164:167]
    v_exp_f32 v173, v173
    v_mfma_f32_16x16x32_bf16 v[164:167], a[188:191], v[48:51], v[164:167]
    ds_read_b64_tr_b16 a[202:203], v6 offset:28672
    s_cmp_eq_u32 s59, s35
    s_cbranch_scc1 L_once_pack
L_once_back_pack:
    v_mfma_f32_16x16x32_bf16 v[168:171], a[188:191], v[64:67], v[104:107]
    v_exp_f32 v174, v174
    v_mfma_f32_16x16x32_bf16 v[168:171], a[184:187], v[60:63], v[168:171]
    ds_read_b128 a[136:139], v3 offset:16384
    v_cvt_pk_bf16_f32 v234, v172, v173
    v_mfma_f32_16x16x32_bf16 v[168:171], a[180:183], v[56:59], v[168:171]
    v_exp_f32 v175, v175
    v_mfma_f32_16x16x32_bf16 v[168:171], a[176:179], v[52:55], v[168:171]
    ds_read_b64_tr_b16 a[204:205], v6 offset:49152
    v_mfma_f32_16x16x32_bf16 a[112:115], a[216:219], v[180:183], a[112:115]
    v_exp_f32 v176, v176
    v_mfma_f32_16x16x32_bf16 a[112:115], a[220:223], v[184:187], a[112:115]
    ds_read_b64_tr_b16 a[206:207], v6 offset:53248
    v_cvt_pk_bf16_f32 v235, v174, v175
    v_mfma_f32_16x16x32_bf16 a[116:119], a[220:223], v[192:195], a[116:119]
    v_exp_f32 v177, v177
    v_mfma_f32_16x16x32_bf16 a[116:119], a[216:219], v[188:191], a[116:119]
    ds_read_b128 a[140:143], v4 offset:16384
    v_mfma_f32_16x16x32_bf16 a[120:123], a[216:219], v[196:199], a[120:123]
    v_exp_f32 v178, v178
    v_mfma_f32_16x16x32_bf16 a[120:123], a[220:223], v[200:203], a[120:123]
    v_cvt_pk_bf16_f32 v242, v176, v177
    v_mfma_f32_16x16x32_bf16 a[124:127], a[220:223], v[208:211], a[124:127]
    v_exp_f32 v179, v179
    v_mfma_f32_16x16x32_bf16 a[124:127], a[216:219], v[204:207], a[124:127]
    buffer_load_dwordx4 v14, s[8:11], s28 offen offset:1024 lds
    v_smfmac_f32_16x16x64_bf16 a[236:239], v[244:247], v[204:211], v248
    s_waitcnt lgkmcnt(6)
    v_mfma_f32_16x16x32_bf16 v[172:175], a[176:179], v[68:71], v[108:111]
    v_exp_f32 v116, v116
    v_mfma_f32_16x16x32_bf16 v[172:175], a[180:183], v[72:75], v[172:175]
    ds_read_b64_tr_b16 a[208:209], v7 offset:24576
    v_cvt_pk_bf16_f32 v243, v178, v179
    v_mfma_f32_16x16x32_bf16 v[172:175], a[184:187], v[76:79], v[172:175]
    v_exp_f32 v117, v117
    v_mfma_f32_16x16x32_bf16 v[172:175], a[188:191], v[80:83], v[172:175]
    ds_read_b64_tr_b16 a[210:211], v7 offset:28672
    v_mfma_f32_16x16x32_bf16 v[176:179], a[188:191], v[96:99], v[112:115]
    v_exp_f32 v118, v118
    v_mfma_f32_16x16x32_bf16 v[176:179], a[184:187], v[92:95], v[176:179]
    ds_read_b128 a[144:147], v1 offset:20480
    v_cvt_pk_bf16_f32 v180, v116, v117
    v_mfma_f32_16x16x32_bf16 v[176:179], a[180:183], v[88:91], v[176:179]
    v_exp_f32 v119, v119
    v_mfma_f32_16x16x32_bf16 v[176:179], a[176:179], v[84:87], v[176:179]
    ds_read_b64_tr_b16 a[212:213], v7 offset:49152
    v_mfma_f32_16x16x32_bf16 a[0:3], a[192:195], v[212:215], a[0:3]
    v_exp_f32 v120, v120
    v_mfma_f32_16x16x32_bf16 a[0:3], a[196:199], v[216:219], a[0:3]
    ds_read_b64_tr_b16 a[214:215], v7 offset:53248
    v_cvt_pk_bf16_f32 v181, v118, v119
    v_mfma_f32_16x16x32_bf16 a[4:7], a[196:199], v[224:227], a[4:7]
    v_exp_f32 v121, v121
    v_mfma_f32_16x16x32_bf16 a[4:7], a[192:195], v[220:223], a[4:7]
    ds_read_b128 a[148:151], v2 offset:20480
    v_cvt_pk_bf16_f32 v188, v120, v121
    v_mfma_f32_16x16x32_bf16 a[8:11], a[192:195], v[228:231], a[8:11]
    v_exp_f32 v122, v122
    v_mfma_f32_16x16x32_bf16 a[8:11], a[196:199], v[232:235], a[8:11]
    buffer_load_dwordx4 v15, s[8:11], s28 offen offset:2048 lds
    v_mfma_f32_16x16x32_bf16 a[12:15], a[196:199], v[240:243], a[12:15]
    v_exp_f32 v123, v123
    v_mfma_f32_16x16x32_bf16 a[12:15], a[192:195], v[236:239], a[12:15]
    s_waitcnt lgkmcnt(6)
    v_mfma_f32_16x16x32_bf16 v[116:119], a[128:131], v[36:39], v[100:103]
    v_exp_f32 v124, v124
    v_mfma_f32_16x16x32_bf16 v[116:119], a[132:135], v[40:43], v[116:119]
    ds_read_b64_tr_b16 a[216:217], v8 offset:24576
    v_cvt_pk_bf16_f32 v189, v122, v123
    v_mfma_f32_16x16x32_bf16 v[116:119], a[136:139], v[44:47], v[116:119]
    v_exp_f32 v125, v125
    v_mfma_f32_16x16x32_bf16 v[116:119], a[140:143], v[48:51], v[116:119]
    ds_read_b64_tr_b16 a[218:219], v8 offset:28672
    v_mfma_f32_16x16x32_bf16 v[120:123], a[140:143], v[64:67], v[104:107]
    v_exp_f32 v126, v126
    v_mfma_f32_16x16x32_bf16 v[120:123], a[136:139], v[60:63], v[120:123]
    ds_read_b128 a[152:155], v3 offset:20480
    v_cvt_pk_bf16_f32 v196, v124, v125
    v_mfma_f32_16x16x32_bf16 v[120:123], a[132:135], v[56:59], v[120:123]
    v_exp_f32 v127, v127
    v_mfma_f32_16x16x32_bf16 v[120:123], a[128:131], v[52:55], v[120:123]
    ds_read_b64_tr_b16 a[220:221], v8 offset:49152
    v_mfma_f32_16x16x32_bf16 a[16:19], a[200:203], v[212:215], a[16:19]
    v_exp_f32 v128, v128
    v_mfma_f32_16x16x32_bf16 a[16:19], a[204:207], v[216:219], a[16:19]
    ds_read_b64_tr_b16 a[222:223], v8 offset:53248
    v_cvt_pk_bf16_f32 v197, v126, v127
    v_mfma_f32_16x16x32_bf16 a[20:23], a[204:207], v[224:227], a[20:23]
    v_exp_f32 v129, v129
    v_mfma_f32_16x16x32_bf16 a[20:23], a[200:203], v[220:223], a[20:23]
    ds_read_b128 a[156:159], v4 offset:20480
    v_mfma_f32_16x16x32_bf16 a[24:27], a[200:203], v[228:231], a[24:27]
    v_exp_f32 v130, v130
    v_mfma_f32_16x16x32_bf16 a[24:27], a[204:207], v[232:235], a[24:27]
    v_cvt_pk_bf16_f32 v204, v128, v129
    v_mfma_f32_16x16x32_bf16 a[28:31], a[204:207], v[240:243], a[28:31]
    v_exp_f32 v131, v131
    v_mfma_f32_16x16x32_bf16 a[28:31], a[200:203], v[236:239], a[28:31]
    buffer_load_dwordx4 v16, s[8:11], s28 offen offset:3072 lds
    v_smfmac_f32_16x16x64_bf16 a[224:227], v[244:247], v[212:219], v248
    s_waitcnt lgkmcnt(6)
    v_mfma_f32_16x16x32_bf16 v[124:127], a[128:131], v[68:71], v[108:111]
    v_exp_f32 v132, v132
    v_mfma_f32_16x16x32_bf16 v[124:127], a[132:135], v[72:75], v[124:127]
    ds_read_b64_tr_b16 a[192:193], v9 offset:24576
    v_cvt_pk_bf16_f32 v205, v130, v131
    v_mfma_f32_16x16x32_bf16 v[124:127], a[136:139], v[76:79], v[124:127]
    v_exp_f32 v133, v133
    v_mfma_f32_16x16x32_bf16 v[124:127], a[140:143], v[80:83], v[124:127]
    ds_read_b64_tr_b16 a[194:195], v9 offset:28672
    s_cmp_eq_u32 s36, 2
    s_cbranch_scc1 L_site2
L_site_back2:
    v_mfma_f32_16x16x32_bf16 v[128:131], a[140:143], v[96:99], v[112:115]
    v_exp_f32 v134, v134
    v_mfma_f32_16x16x32_bf16 v[128:131], a[136:139], v[92:95], v[128:131]
    ds_read_b128 a[160:163], v1 offset:24576
    v_cvt_pk_bf16_f32 v182, v132, v133
    v_mfma_f32_16x16x32_bf16 v[128:131], a[132:135], v[88:91], v[128:131]
    v_exp_f32 v135, v135
    v_mfma_f32_16x16x32_bf16 v[128:131], a[128:131], v[84:87], v[128:131]
    ds_read_b64_tr_b16 a[196:197], v9 offset:49152
    v_mfma_f32_16x16x32_bf16 a[32:35], a[208:211], v[212:215], a[32:35]
    v_exp_f32 v136, v136
    v_mfma_f32_16x16x32_bf16 a[32:35], a[212:215], v[216:219], a[32:35]
    ds_read_b64_tr_b16 a[198:199], v9 offset:53248
    v_cvt_pk_bf16_f32 v183, v134, v135
    v_mfma_f32_16x16x32_bf16 a[36:39], a[212:215], v[224:227], a[36:39]
    v_exp_f32 v137, v137
    v_mfma_f32_16x16x32_bf16 a[36:39], a[208:211], v[220:223], a[36:39]
    ds_read_b128 a[164:167], v2 offset:24576
    v_cvt_pk_bf16_f32 v190, v136, v137
    v_mfma_f32_16x16x32_bf16 a[40:43], a[208:211], v[228:231], a[40:43]
    s_add_u32 s28, s28, 16384
    s_mov_b32 m0, s31
    v_exp_f32 v138, v138
    v_mfma_f32_16x16x32_bf16 a[40:43], a[212:215], v[232:235], a[40:43]
    buffer_load_dwordx4 v17, s[12:15], s29 offen offset:0 lds
    v_mfma_f32_16x16x32_bf16 a[44:47], a[212:215], v[240:243], a[44:47]
    v_exp_f32 v139, v139
    v_mfma_f32_16x16x32_bf16 a[44:47], a[208:211], v[236:239], a[44:47]
    s_waitcnt lgkmcnt(6)
    v_mfma_f32_16x16x32_bf16 v[132:135], a[144:147], v[36:39], v[100:103]
    v_exp_f32 v140, v140
    v_mfma_f32_16x16x32_bf16 v[132:135], a[148:151], v[40:43], v[132:135]
    ds_read_b64_tr_b16 a[200:201], v10 offset:24576
    v_cvt_pk_bf16_f32 v191, v138, v139
    v_mfma_f32_16x16x32_bf16 v[132:135], a[152:155], v[44:47], v[132:135]
    v_exp_f32 v141, v141
    v_mfma_f32_16x16x32_bf16 v[132:135], a[156:159], v[48:51], v[132:135]
    ds_read_b64_tr_b16 a[202:203], v10 offset:28672
    v_mfma_f32_16x16x32_bf16 v[136:139], a[156:159], v[64:67], v[104:107]
    v_exp_f32 v142, v142
    v_mfma_f32_16x16x32_bf16 v[136:139], a[152:155], v[60:63], v[136:139]
    ds_read_b128 a[168:171], v3 offset:24576
    v_cvt_pk_bf16_f32 v198, v140, v141
    v_mfma_f32_16x16x32_bf16 v[136:139], a[148:151], v[56:59], v[136:139]
    v_exp_f32 v143, v143
    v_mfma_f32_16x16x32_bf16 v[136:139], a[144:147], v[52:55], v[136:139]
    ds_read_b64_tr_b16 a[204:205], v10 offset:49152
    v_mfma_f32_16x16x32_bf16 a[48:51], a[216:219], v[212:215], a[48:51]
    v_exp_f32 v144, v144
    v_mfma_f32_16x16x32_bf16 a[48:51], a[220:223], v[216:219], a[48:51]
    ds_read_b64_tr_b16 a[206:207], v10 offset:53248
    v_cvt_pk_bf16_f32 v199, v142, v143
    v_mfma_f32_16x16x32_bf16 a[52:55], a[220:223], v[224:227], a[52:55]
    v_exp_f32 v145, v145
    v_mfma_f32_16x16x32_bf16 a[52:55], a[216:219], v[220:223], a[52:55]
    ds_read_b128 a[172:175], v4 offset:24576
    v_mfma_f32_16x16x32_bf16 a[56:59], a[216:219], v[228:231], a[56:59]
    v_exp_f32 v146, v146
    v_mfma_f32_16x16x32_bf16 a[56:59], a[220:223], v[232:235], a[56:59]
    v_cvt_pk_bf16_f32 v206, v144, v145
    v_mfma_f32_16x16x32_bf16 a[60:63], a[220:223], v[240:243], a[60:63]
    v_exp_f32 v147, v147
    v_mfma_f32_16x16x32_bf16 a[60:63], a[216:219], v[236:239], a[60:63]
    buffer_load_dwordx4 v18, s[12:15], s29 offen offset:1024 lds
    v_smfmac_f32_16x16x64_bf16 a[228:231], v[244:247], v[220:227], v248
    s_waitcnt lgkmcnt(6)
    v_mfma_f32_16x16x32_bf16 v[140:143], a[144:147], v[68:71], v[108:111]
    v_exp_f32 v148, v148
    v_mfma_f32_16x16x32_bf16 v[140:143], a[148:151], v[72:75], v[140:143]
    ds_read_b64_tr_b16 a[208:209], v11 offset:24576
    v_cvt_pk_bf16_f32 v207, v146, v147
    v_mfma_f32_16x16x32_bf16 v[140:143], a[152:155], v[76:79], v[140:143]
    v_exp_f32 v149, v149
    v_mfma_f32_16x16x32_bf16 v[140:143], a[156:159], v[80:83], v[140:143]
    ds_read_b64_tr_b16 a[210:211], v11 offset:28672
    v_mfma_f32_16x16x32_bf16 v[144:147], a[156:159], v[96:99], v[112:115]
    v_exp_f32 v150, v150
    v_mfma_f32_16x16x32_bf16 v[144:147], a[152:155], v[92:95], v[144:147]
    ds_read_b128 a[176:179], v1 offset:28672
    v_cvt_pk_bf16_f32 v184, v148, v149
    v_mfma_f32_16x16x32_bf16 v[144:147], a[148:151], v[88:91], v[144:147]
    v_exp_f32 v151, v151
    v_mfma_f32_16x16x32_bf16 v[144:147], a[144:147], v[84:87], v[144:147]
    ds_read_b64_tr_b16 a[212:213], v11 offset:49152
    v_mfma_f32_16x16x32_bf16 a[64:67], a[192:195], v[212:215], a[64:67]
    v_exp_f32 v152, v152
    v_mfma_f32_16x16x32_bf16 a[64:67], a[196:199], v[216:219], a[64:67]
    ds_read_b64_tr_b16 a[214:215], v11 offset:53248
    v_cvt_pk_bf16_f32 v185, v150, v151
    v_mfma_f32_16x16x32_bf16 a[68:71], a[196:199], v[224:227], a[68:71]
    v_exp_f32 v153, v153
    v_mfma_f32_16x16x32_bf16 a[68:71], a[192:195], v[220:223], a[68:71]
    ds_read_b128 a[180:183], v2 offset:28672
    v_cvt_pk_bf16_f32 v192, v152, v153
    v_mfma_f32_16x16x32_bf16 a[72:75], a[192:195], v[228:231], a[72:75]
    v_exp_f32 v154, v154
    v_mfma_f32_16x16x32_bf16 a[72:75], a[196:199], v[232:235], a[72:75]
    buffer_load_dwordx4 v17, s[12:15], s29 offen offset:2048 lds
    v_mfma_f32_16x16x32_bf16 a[76:79], a[196:199], v[240:243], a[76:79]
    v_exp_f32 v155, v155
    v_mfma_f32_16x16x32_bf16 a[76:79], a[192:195], v[236:239], a[76:79]
    s_waitcnt lgkmcnt(6)
    v_mfma_f32_16x16x32_bf16 v[148:151], a[160:163], v[36:39], v[100:103]
    v_exp_f32 v156, v156
    v_mfma_f32_16x16x32_bf16 v[148:151], a[164:167], v[40:43], v[148:151]
    ds_read_b64_tr_b16 a[216:217], v12 offset:24576
    v_cvt_pk_bf16_f32 v193, v154, v155
    v_mfma_f32_16x16x32_bf16 v[148:151], a[168:171], v[44:47], v[148:151]
    v_exp_f32 v157, v157
    v_mfma_f32_16x16x32_bf16 v[148:151], a[172:175], v[48:51], v[148:151]
    ds_read_b64_tr_b16 a[218:219], v12 offset:28672
    v_mfma_f32_16x16x32_bf16 v[152:155], a[172:175], v[64:67], v[104:107]
    v_exp_f32 v158, v158
    v_mfma_f32_16x16x32_bf16 v[152:155], a[168:171], v[60:63], v[152:155]
    ds_read_b128 a[184:187], v3 offset:28672
    v_cvt_pk_bf16_f32 v200, v156, v157
    v_mfma_f32_16x16x32_bf16 v[152:155], a[164:167], v[56:59], v[152:155]
    v_exp_f32 v159, v159
    v_mfma_f32_16x16x32_bf16 v[152:155], a[160:163], v[52:55], v[152:155]
    ds_read_b64_tr_b16 a[220:221], v12 offset:49152
    v_mfma_f32_16x16x32_bf16 a[80:83], a[200:203], v[212:215], a[80:83]
    v_exp_f32 v160, v160
    v_mfma_f32_16x16x32_bf16 a[80:83], a[204:207], v[216:219], a[80:83]
    ds_read_b64_tr_b16 a[222:223], v12 offset:53248
    v_cvt_pk_bf16_f32 v201, v158, v159
    v_mfma_f32_16x16x32_bf16 a[84:87], a[204:207], v[224:227], a[84:87]
    v_exp_f32 v161, v161
    v_mfma_f32_16x16x32_bf16 a[84:87], a[200:203], v[220:223], a[84:87]
    ds_read_b128 a[188:191], v4 offset:28672
    v_mfma_f32_16x16x32_bf16 a[88:91], a[200:203], v[228:231], a[88:91]
    v_exp_f32 v162, v162
    v_mfma_f32_16x16x32_bf16 a[88:91], a[204:207], v[232:235], a[88:91]
    v_cvt_pk_bf16_f32 v208, v160, v161
    v_mfma_f32_16x16x32_bf16 a[92:95], a[204:207], v[240:243], a[92:95]
    v_exp_f32 v163, v163
    v_mfma_f32_16x16x32_bf16 a[92:95], a[200:203], v[236:239], a[92:95]
    buffer_load_dwordx4 v18, s[12:15], s29 offen offset:3072 lds
    v_smfmac_f32_16x16x64_bf16 a[232:235], v[244:247], v[228:235], v248
    s_waitcnt vmcnt(8) lgkmcnt(6)
    s_barrier
    s_add_u32 s29, s29, 16384
    v_mfma_f32_16x16x32_bf16 v[156:159], a[160:163], v[68:71], v[108:111]
    v_exp_f32 v164, v164
    v_mfma_f32_16x16x32_bf16 v[156:159], a[164:167], v[72:75], v[156:159]
    ds_read_b64_tr_b16 a[192:193], v5 offset:8192
    v_cvt_pk_bf16_f32 v209, v162, v163
    v_mfma_f32_16x16x32_bf16 v[156:159], a[168:171], v[76:79], v[156:159]
    v_exp_f32 v165, v165
    v_mfma_f32_16x16x32_bf16 v[156:159], a[172:175], v[80:83], v[156:159]
    ds_read_b64_tr_b16 a[194:195], v5 offset:12288
    v_mfma_f32_16x16x32_bf16 v[160:163], a[172:175], v[96:99], v[112:115]
    v_exp_f32 v166, v166
    v_mfma_f32_16x16x32_bf16 v[160:163], a[168:171], v[92:95], v[160:163]
    ds_read_b128 a[128:131], v1 offset:32768
    v_cvt_pk_bf16_f32 v186, v164, v165
    v_mfma_f32_16x16x32_bf16 v[160:163], a[164:167], v[88:91], v[160:163]
    v_exp_f32 v167, v167
    v_mfma_f32_16x16x32_bf16 v[160:163], a[160:163], v[84:87], v[160:163]
    ds_read_b64_tr_b16 a[196:197], v5 offset:32768
    v_mfma_f32_16x16x32_bf16 a[96:99], a[208:211], v[212:215], a[96:99]
    v_exp_f32 v168, v168
    v_mfma_f32_16x16x32_bf16 a[96:99], a[212:215], v[216:219], a[96:99]
    ds_read_b64_tr_b16 a[198:199], v5 offset:36864
    v_cvt_pk_bf16_f32 v187, v166, v167
    v_mfma_f32_16x16x32_bf16 a[100:103], a[212:215], v[224:227], a[100:103]
    v_exp_f32 v169, v169
    v_mfma_f32_16x16x32_bf16 a[100:103], a[208:211], v[220:223], a[100:103]
    ds_read_b128 a[132:135], v2 offset:32768
    v_cvt_pk_bf16_f32 v194, v168, v169
    v_mfma_f32_16x16x32_bf16 a[104:107], a[208:211], v[228:231], a[104:107]
    s_add_u32 m0, s34, 49152
    v_exp_f32 v170, v170
    v_mfma_f32_16x16x32_bf16 a[104:107], a[212:215], v[232:235], a[104:107]
    buffer_load_dwordx4 v13, s[8:11], s28 offen offset:0 lds
    v_mfma_f32_16x16x32_bf16 a[108:111], a[212:215], v[240:243], a[108:111]
    v_exp_f32 v171, v171
    v_mfma_f32_16x16x32_bf16 a[108:111], a[208:211], v[236:239], a[108:111]
    s_waitcnt lgkmcnt(6)
    v_mfma_f32_16x16x32_bf16 v[164:167], a[176:179], v[36:39], v[100:103]
    v_exp_f32 v172, v172
    v_mfma_f32_16x16x32_bf16 v[164:167], a[180:183], v[40:43], v[164:167]
    ds_read_b64_tr_b16 a[200:201], v6 offset:8192
    v_cvt_pk_bf16_f32 v195, v170, v171
    v_mfma_f32_16x16x32_bf16 v[164:167], a[184:187], v[44:47], v[164:167]
    v_exp_f32 v173, v173
    v_mfma_f32_16x16x32_bf16 v[164:167], a[188:191], v[48:51], v[164:167]
    ds_read_b64_tr_b16 a[202:203], v6 offset:12288
    v_mfma_f32_16x16x32_bf16 v[168:171], a[188:191], v[64:67], v[104:107]
    v_exp_f32 v174, v174
    v_mfma_f32_16x16x32_bf16 v[168:171], a[184:187], v[60:63], v[168:171]
    ds_read_b128 a[136:139], v3 offset:32768
    v_cvt_pk_bf16_f32 v202, v172, v173
    v_mfma_f32_16x16x32_bf16 v[168:171], a[180:183], v[56:59], v[168:171]
    v_exp_f32 v175, v175
    v_mfma_f32_16x16x32_bf16 v[168:171], a[176:179], v[52:55], v[168:171]
    ds_read_b64_tr_b16 a[204:205], v6 offset:32768
    v_mfma_f32_16x16x32_bf16 a[112:115], a[216:219], v[212:215], a[112:115]
    v_exp_f32 v176, v176
    v_mfma_f32_16x16x32_bf16 a[112:115], a[220:223], v[216:219], a[112:115]
    ds_read_b64_tr_b16 a[206:207], v6 offset:36864
    v_cvt_pk_bf16_f32 v203, v174, v175
    v_mfma_f32_16x16x32_bf16 a[116:119], a[220:223], v[224:227], a[116:119]
    v_exp_f32 v177, v177
    v_mfma_f32_16x16x32_bf16 a[116:119], a[216:219], v[220:223], a[116:119]
    ds_read_b128 a[140:143], v4 offset:32768
    v_mfma_f32_16x16x32_bf16 a[120:123], a[216:219], v[228:231], a[120:123]
    v_exp_f32 v178, v178
    v_mfma_f32_16x16x32_bf16 a[120:123], a[220:223], v[232:235], a[120:123]
    v_cvt_pk_bf16_f32 v210, v176, v177
    v_mfma_f32_16x16x32_bf16 a[124:127], a[220:223], v[240:243], a[124:127]
    v_exp_f32 v179, v179
    v_mfma_f32_16x16x32_bf16 a[124:127], a[216:219], v[236:239], a[124:127]
    buffer_load_dwordx4 v14, s[8:11], s28 offen offset:1024 lds
    v_smfmac_f32_16x16x64_bf16 a[236:239], v[244:247], v[236:243], v248
    s_waitcnt lgkmcnt(6)
    v_mfma_f32_16x16x32_bf16 v[172:175], a[176:179], v[68:71], v[108:111]
    v_exp_f32 v116, v116
    v_mfma_f32_16x16x32_bf16 v[172:175], a[180:183], v[72:75], v[172:175]
    ds_read_b64_tr_b16 a[208:209], v7 offset:8192
    v_cvt_pk_bf16_f32 v211, v178, v179
    v_mfma_f32_16x16x32_bf16 v[172:175], a[184:187], v[76:79], v[172:175]
    v_exp_f32 v117, v117
    v_mfma_f32_16x16x32_bf16 v[172:175], a[188:191], v[80:83], v[172:175]
    ds_read_b64_tr_b16 a[210:211], v7 offset:12288
    v_mfma_f32_16x16x32_bf16 v[176:179], a[188:191], v[96:99], v[112:115]
    v_exp_f32 v118, v118
    v_mfma_f32_16x16x32_bf16 v[176:179], a[184:187], v[92:95], v[176:179]
    ds_read_b128 a[144:147], v1 offset:36864
    v_cvt_pk_bf16_f32 v212, v116, v117
    v_mfma_f32_16x16x32_bf16 v[176:179], a[180:183], v[88:91], v[176:179]
    v_exp_f32 v119, v119
    v_mfma_f32_16x16x32_bf16 v[176:179], a[176:179], v[84:87], v[176:179]
    ds_read_b64_tr_b16 a[212:213], v7 offset:32768
    v_mfma_f32_16x16x32_bf16 a[0:3], a[192:195], v[180:183], a[0:3]
    v_exp_f32 v120, v120
    v_mfma_f32_16x16x32_bf16 a[0:3], a[196:199], v[184:187], a[0:3]
    ds_read_b64_tr_b16 a[214:215], v7 offset:36864
    v_cvt_pk_bf16_f32 v213, v118, v119
    v_mfma_f32_16x16x32_bf16 a[4:7], a[196:199], v[192:195], a[4:7]
    v_exp_f32 v121, v121
    v_mfma_f32_16x16x32_bf16 a[4:7], a[192:195], v[188:191], a[4:7]
    ds_read_b128 a[148:151], v2 offset:36864
    v_cvt_pk_bf16_f32 v220, v120, v121
    v_mfma_f32_16x16x32_bf16 a[8:11], a[192:195], v[196:199], a[8:11]
    v_exp_f32 v122, v122
    v_mfma_f32_16x16x32_bf16 a[8:11], a[196:199], v[200:203], a[8:11]
    buffer_load_dwordx4 v15, s[8:11], s28 offen offset:2048 lds
    v_mfma_f32_16x16x32_bf16 a[12:15], a[196:199], v[208:211], a[12:15]
    v_exp_f32 v123, v123
    v_mfma_f32_16x16x32_bf16 a[12:15], a[192:195], v[204:207], a[12:15]
    s_waitcnt lgkmcnt(6)
    v_mfma_f32_16x16x32_bf16 v[116:119], a[128:131], v[36:39], v[100:103]
    v_exp_f32 v124, v124
    v_mfma_f32_16x16x32_bf16 v[116:119], a[132:135], v[40:43], v[116:119]
    ds_read_b64_tr_b16 a[216:217], v8 offset:8192
    v_cvt_pk_bf16_f32 v221, v122, v123
    v_mfma_f32_16x16x32_bf16 v[116:119], a[136:139], v[44:47], v[116:119]
    v_exp_f32 v125, v125
    v_mfma_f32_16x16x32_bf16 v[116:119], a[140:143], v[48:51], v[116:119]
    ds_read_b64_tr_b16 a[218:219], v8 offset:12288
    v_mfma_f32_16x16x32_bf16 v[120:123], a[140:143], v[64:67], v[104:107]
    v_exp_f32 v126, v126
    v_mfma_f32_16x16x32_bf16 v[120:123], a[136:139], v[60:63], v[120:123]
    ds_read_b128 a[152:155], v3 offset:36864
    v_cvt_pk_bf16_f32 v228, v124, v125
    v_mfma_f32_16x16x32_bf16 v[120:123], a[132:135], v[56:59], v[120:123]
    v_exp_f32 v127, v127
    v_mfma_f32_16x16x32_bf16 v[120:123], a[128:131], v[52:55], v[120:123]
    ds_read_b64_tr_b16 a[220:221], v8 offset:32768
    v_mfma_f32_16x16x32_bf16 a[16:19], a[200:203], v[180:183], a[16:19]
    v_exp_f32 v128, v128
    v_mfma_f32_16x16x32_bf16 a[16:19], a[204:207], v[184:187], a[16:19]
    ds_read_b64_tr_b16 a[222:223], v8 offset:36864
    v_cvt_pk_bf16_f32 v229, v126, v127
    v_mfma_f32_16x16x32_bf16 a[20:23], a[204:207], v[192:195], a[20:23]
    v_exp_f32 v129, v129
    v_mfma_f32_16x16x32_bf16 a[20:23], a[200:203], v[188:191], a[20:23]
    ds_read_b128 a[156:159], v4 offset:36864
    v_mfma_f32_16x16x32_bf16 a[24:27], a[200:203], v[196:199], a[24:27]
    v_exp_f32 v130, v130
    v_mfma_f32_16x16x32_bf16 a[24:27], a[204:207], v[200:203], a[24:27]
    v_cvt_pk_bf16_f32 v236, v128, v129
    v_mfma_f32_16x16x32_bf16 a[28:31], a[204:207], v[208:211], a[28:31]
    v_exp_f32 v131, v131
    v_mfma_f32_16x16x32_bf16 a[28:31], a[200:203], v[204:207], a[28:31]
    buffer_load_dwordx4 v16, s[8:11], s28 offen offset:3072 lds
    v_smfmac_f32_16x16x64_bf16 a[224:227], v[244:247], v[180:187], v248
    s_waitcnt lgkmcnt(6)
    v_mfma_f32_16x16x32_bf16 v[124:127], a[128:131], v[68:71], v[108:111]
    v_exp_f32 v132, v132
    v_mfma_f32_16x16x32_bf16 v[124:127], a[132:135], v[72:75], v[124:127]
    ds_read_b64_tr_b16 a[192:193], v9 offset:8192
    v_cvt_pk_bf16_f32 v237, v130, v131
    v_mfma_f32_16x16x32_bf16 v[124:127], a[136:139], v[76:79], v[124:127]
    v_exp_f32 v133, v133
    v_mfma_f32_16x16x32_bf16 v[124:127], a[140:143], v[80:83], v[124:127]
    ds_read_b64_tr_b16 a[194:195], v9 offset:12288
    s_cmp_eq_u32 s36, 3
    s_cbranch_scc1 L_site3
L_site_back3:
    v_mfma_f32_16x16x32_bf16 v[128:131], a[140:143], v[96:99], v[112:115]
    v_exp_f32 v134, v134
    v_mfma_f32_16x16x32_bf16 v[128:131], a[136:139], v[92:95], v[128:131]
    ds_read_b128 a[160:163], v1 offset:40960
    v_cvt_pk_bf16_f32 v214, v132, v133
    v_mfma_f32_16x16x32_bf16 v[128:131], a[132:135], v[88:91], v[128:131]
    v_exp_f32 v135, v135
    v_mfma_f32_16x16x32_bf16 v[128:131], a[128:131], v[84:87], v[128:131]
    ds_read_b64_tr_b16 a[196:197], v9 offset:32768
    v_mfma_f32_16x16x32_bf16 a[32:35], a[208:211], v[180:183], a[32:35]
    v_exp_f32 v136, v136
    v_mfma_f32_16x16x32_bf16 a[32:35], a[212:215], v[184:187], a[32:35]
    ds_read_b64_tr_b16 a[198:199], v9 offset:36864
    v_cvt_pk_bf16_f32 v215, v134, v135
    v_mfma_f32_16x16x32_bf16 a[36:39], a[212:215], v[192:195], a[36:39]
    v_exp_f32 v137, v137
    v_mfma_f32_16x16x32_bf16 a[36:39], a[208:211], v[188:191], a[36:39]
    ds_read_b128 a[164:167], v2 offset:40960
    v_cvt_pk_bf16_f32 v222, v136, v137
    v_mfma_f32_16x16x32_bf16 a[40:43], a[208:211], v[196:199], a[40:43]
    s_add_u32 s28, s28, 16384
    s_mov_b32 m0, s32
    v_exp_f32 v138, v138
    v_mfma_f32_16x16x32_bf16 a[40:43], a[212:215], v[200:203], a[40:43]
    buffer_load_dwordx4 v17, s[12:15], s29 offen offset:0 lds
    v_mfma_f32_16x16x32_bf16 a[44:47], a[212:215], v[208:211], a[44:47]
    v_exp_f32 v139, v139
    v_mfma_f32_16x16x32_bf16 a[44:47], a[208:211], v[204:207], a[44:47]
    s_waitcnt lgkmcnt(6)
    v_mfma_f32_16x16x32_bf16 v[132:135], a[144:147], v[36:39], v[100:103]
    v_exp_f32 v140, v140
    v_mfma_f32_16x16x32_bf16 v[132:135], a[148:151], v[40:43], v[132:135]
    ds_read_b64_tr_b16 a[200:201], v10 offset:8192
    v_cvt_pk_bf16_f32 v223, v138, v139
    v_mfma_f32_16x16x32_bf16 v[132:135], a[152:155], v[44:47], v[132:135]
    v_exp_f32 v141, v141
    v_mfma_f32_16x16x32_bf16 v[132:135], a[156:159], v[48:51], v[132:135]
    ds_read_b64_tr_b16 a[202:203], v10 offset:12288
    v_mfma_f32_16x16x32_bf16 v[136:139], a[156:159], v[64:67], v[104:107]
    v_exp_f32 v142, v142
    v_mfma_f32_16x16x32_bf16 v[136:139], a[152:155], v[60:63], v[136:139]
    ds_read_b128 a[168:171], v3 offset:40960
    v_cvt_pk_bf16_f32 v230, v140, v141
    v_mfma_f32_16x16x32_bf16 v[136:139], a[148:151], v[56:59], v[136:139]
    v_exp_f32 v143, v143
    v_mfma_f32_16x16x32_bf16 v[136:139], a[144:147], v[52:55], v[136:139]
    ds_read_b64_tr_b16 a[204:205], v10 offset:32768
    v_mfma_f32_16x16x32_bf16 a[48:51], a[216:219], v[180:183], a[48:51]
    v_exp_f32 v144, v144
    v_mfma_f32_16x16x32_bf16 a[48:51], a[220:223], v[184:187], a[48:51]
    ds_read_b64_tr_b16 a[206:207], v10 offset:36864
    v_cvt_pk_bf16_f32 v231, v142, v143
    v_mfma_f32_16x16x32_bf16 a[52:55], a[220:223], v[192:195], a[52:55]
    v_exp_f32 v145, v145
    v_mfma_f32_16x16x32_bf16 a[52:55], a[216:219], v[188:191], a[52:55]
    ds_read_b128 a[172:175], v4 offset:40960
    v_mfma_f32_16x16x32_bf16 a[56:59], a[216:219], v[196:199], a[56:59]
    v_exp_f32 v146, v146
    v_mfma_f32_16x16x32_bf16 a[56:59], a[220:223], v[200:203], a[56:59]
    v_cvt_pk_bf16_f32 v238, v144, v145
    v_mfma_f32_16x16x32_bf16 a[60:63], a[220:223], v[208:211], a[60:63]
    v_exp_f32 v147, v147
    v_mfma_f32_16x16x32_bf16 a[60:63], a[216:219], v[204:207], a[60:63]
    buffer_load_dwordx4 v18, s[12:15], s29 offen offset:1024 lds
    v_smfmac_f32_16x16x64_bf16 a[228:231], v[244:247], v[188:195], v248
    s_waitcnt lgkmcnt(6)
    v_mfma_f32_16x16x32_bf16 v[140:143], a[144:147], v[68:71], v[108:111]
    v_exp_f32 v148, v148
    v_mfma_f32_16x16x32_bf16 v[140:143], a[148:151], v[72:75], v[140:143]
    ds_read_b64_tr_b16 a[208:209], v11 offset:8192
    v_cvt_pk_bf16_f32 v239, v146, v147
    v_mfma_f32_16x16x32_bf16 v[140:143], a[152:155], v[76:79], v[140:143]
    v_exp_f32 v149, v149
    v_mfma_f32_16x16x32_bf16 v[140:143], a[156:159], v[80:83], v[140:143]
    ds_read_b64_tr_b16 a[210:211], v11 offset:12288
    v_mfma_f32_16x16x32_bf16 v[144:147], a[156:159], v[96:99], v[112:115]
    v_exp_f32 v150, v150
    v_mfma_f32_16x16x32_bf16 v[144:147], a[152:155], v[92:95], v[144:147]
    ds_read_b128 a[176:179], v1 offset:45056
    v_cvt_pk_bf16_f32 v216, v148, v149
    v_mfma_f32_16x16x32_bf16 v[144:147], a[148:151], v[88:91], v[144:147]
    v_exp_f32 v151, v151
    v_mfma_f32_16x16x32_bf16 v[144:147], a[144:147], v[84:87], v[144:147]
    ds_read_b64_tr_b16 a[212:213], v11 offset:32768
    v_mfma_f32_16x16x32_bf16 a[64:67], a[192:195], v[180:183], a[64:67]
    v_exp_f32 v152, v152
    v_mfma_f32_16x16x32_bf16 a[64:67], a[196:199], v[184:187], a[64:67]
    ds_read_b64_tr_b16 a[214:215], v11 offset:36864
    v_cvt_pk_bf16_f32 v217, v150, v151
    v_mfma_f32_16x16x32_bf16 a[68:71], a[196:199], v[192:195], a[68:71]
    v_exp_f32 v153, v153
    v_mfma_f32_16x16x32_bf16 a[68:71], a[192:195], v[188:191], a[68:71]
    ds_read_b128 a[180:183], v2 offset:45056
    v_cvt_pk_bf16_f32 v224, v152, v153
    v_mfma_f32_16x16x32_bf16 a[72:75], a[192:195], v[196:199], a[72:75]
    v_exp_f32 v154, v154
    v_mfma_f32_16x16x32_bf16 a[72:75], a[196:199], v[200:203], a[72:75]
    buffer_load_dwordx4 v17, s[12:15], s29 offen offset:2048 lds
    v_mfma_f32_16x16x32_bf16 a[76:79], a[196:199], v[208:211], a[76:79]
    v_exp_f32 v155, v155
    v_mfma_f32_16x16x32_bf16 a[76:79], a[192:195], v[204:207], a[76:79]
    s_waitcnt lgkmcnt(6)
    v_mfma_f32_16x16x32_bf16 v[148:151], a[160:163], v[36:39], v[100:103]
    v_exp_f32 v156, v156
    v_mfma_f32_16x16x32_bf16 v[148:151], a[164:167], v[40:43], v[148:151]
    ds_read_b64_tr_b16 a[216:217], v12 offset:8192
    v_cvt_pk_bf16_f32 v225, v154, v155
    v_mfma_f32_16x16x32_bf16 v[148:151], a[168:171], v[44:47], v[148:151]
    v_exp_f32 v157, v157
    v_mfma_f32_16x16x32_bf16 v[148:151], a[172:175], v[48:51], v[148:151]
    ds_read_b64_tr_b16 a[218:219], v12 offset:12288
    v_mfma_f32_16x16x32_bf16 v[152:155], a[172:175], v[64:67], v[104:107]
    v_exp_f32 v158, v158
    v_mfma_f32_16x16x32_bf16 v[152:155], a[168:171], v[60:63], v[152:155]
    ds_read_b128 a[184:187], v3 offset:45056
    v_cvt_pk_bf16_f32 v232, v156, v157
    v_mfma_f32_16x16x32_bf16 v[152:155], a[164:167], v[56:59], v[152:155]
    v_exp_f32 v159, v159
    v_mfma_f32_16x16x32_bf16 v[152:155], a[160:163], v[52:55], v[152:155]
    ds_read_b64_tr_b16 a[220:221], v12 offset:32768
    v_mfma_f32_16x16x32_bf16 a[80:83], a[200:203], v[180:183], a[80:83]
    v_exp_f32 v160, v160
    v_mfma_f32_16x16x32_bf16 a[80:83], a[204:207], v[184:187], a[80:83]
    ds_read_b64_tr_b16 a[222:223], v12 offset:36864
    v_cvt_pk_bf16_f32 v233, v158, v159
    v_mfma_f32_16x16x32_bf16 a[84:87], a[204:207], v[192:195], a[84:87]
    v_exp_f32 v161, v161
    v_mfma_f32_16x16x32_bf16 a[84:87], a[200:203], v[188:191], a[84:87]
    ds_read_b128 a[188:191], v4 offset:45056
    v_mfma_f32_16x16x32_bf16 a[88:91], a[200:203], v[196:199], a[88:91]
    v_exp_f32 v162, v162
    v_mfma_f32_16x16x32_bf16 a[88:91], a[204:207], v[200:203], a[88:91]
    v_cvt_pk_bf16_f32 v240, v160, v161
    v_mfma_f32_16x16x32_bf16 a[92:95], a[204:207], v[208:211], a[92:95]
    v_exp_f32 v163, v163
    v_mfma_f32_16x16x32_bf16 a[92:95], a[200:203], v[204:207], a[92:95]
    buffer_load_dwordx4 v18, s[12:15], s29 offen offset:3072 lds
    v_smfmac_f32_16x16x64_bf16 a[232:235], v[244:247], v[196:203], v248
    s_waitcnt vmcnt(8) lgkmcnt(6)
    s_barrier
    s_add_u32 s29, s29, 16384
    v_mfma_f32_16x16x32_bf16 v[156:159], a[160:163], v[68:71], v[108:111]
    v_exp_f32 v164, v164
    v_mfma_f32_16x16x32_bf16 v[156:159], a[164:167], v[72:75], v[156:159]
    ds_read_b64_tr_b16 a[192:193], v5 offset:16384
    v_cvt_pk_bf16_f32 v241, v162, v163
    v_mfma_f32_16x16x32_bf16 v[156:159], a[168:171], v[76:79], v[156:159]
    v_exp_f32 v165, v165
    v_mfma_f32_16x16x32_bf16 v[156:159], a[172:175], v[80:83], v[156:159]
    ds_read_b64_tr_b16 a[194:195], v5 offset:20480
    v_mfma_f32_16x16x32_bf16 v[160:163], a[172:175], v[96:99], v[112:115]
    v_exp_f32 v166, v166
    v_mfma_f32_16x16x32_bf16 v[160:163], a[168:171], v[92:95], v[160:163]
    ds_read_b128 a[128:131], v1 offset:0
    v_cvt_pk_bf16_f32 v218, v164, v165
    v_mfma_f32_16x16x32_bf16 v[160:163], a[164:167], v[88:91], v[160:163]
    v_exp_f32 v167, v167
    v_mfma_f32_16x16x32_bf16 v[160:163], a[160:163], v[84:87], v[160:163]
    ds_read_b64_tr_b16 a[196:197], v5 offset:40960
    v_mfma_f32_16x16x32_bf16 a[96:99], a[208:211], v[180:183], a[96:99]
    v_exp_f32 v168, v168
    v_mfma_f32_16x16x32_bf16 a[96:99], a[212:215], v[184:187], a[96:99]
    ds_read_b64_tr_b16 a[198:199], v5 offset:45056
    v_cvt_pk_bf16_f32 v219, v166, v167
    v_mfma_f32_16x16x32_bf16 a[100:103], a[212:215], v[192:195], a[100:103]
    v_exp_f32 v169, v169
    v_mfma_f32_16x16x32_bf16 a[100:103], a[208:211], v[188:191], a[100:103]
    ds_read_b128 a[132:135], v2 offset:0
    v_cvt_pk_bf16_f32 v226, v168, v169
    v_mfma_f32_16x16x32_bf16 a[104:107], a[208:211], v[196:199], a[104:107]
    s_add_u32 m0, s34, 16384
    v_exp_f32 v170, v170
    v_mfma_f32_16x16x32_bf16 a[104:107], a[212:215], v[200:203], a[104:107]
    buffer_load_dwordx4 v13, s[8:11], s28 offen offset:0 lds
    v_mfma_f32_16x16x32_bf16 a[108:111], a[212:215], v[208:211], a[108:111]
    v_exp_f32 v171, v171
    v_mfma_f32_16x16x32_bf16 a[108:111], a[208:211], v[204:207], a[108:111]
    s_waitcnt lgkmcnt(6)
    v_mfma_f32_16x16x32_bf16 v[164:167], a[176:179], v[36:39], v[100:103]
    v_exp_f32 v172, v172
    v_mfma_f32_16x16x32_bf16 v[164:167], a[180:183], v[40:43], v[164:167]
    ds_read_b64_tr_b16 a[200:201], v6 offset:16384
    v_cvt_pk_bf16_f32 v227, v170, v171
    v_mfma_f32_16x16x32_bf16 v[164:167], a[184:187], v[44:47], v[164:167]
    v_exp_f32 v173, v173
    v_mfma_f32_16x16x32_bf16 v[164:167], a[188:191], v[48:51], v[164:167]
    ds_read_b64_tr_b16 a[202:203], v6 offset:20480
    v_mfma_f32_16x16x32_bf16 v[168:171], a[188:191], v[64:67], v[104:107]
    v_exp_f32 v174, v174
    v_mfma_f32_16x16x32_bf16 v[168:171], a[184:187], v[60:63], v[168:171]
    ds_read_b128 a[136:139], v3 offset:0
    v_cvt_pk_bf16_f32 v234, v172, v173
    v_mfma_f32_16x16x32_bf16 v[168:171], a[180:183], v[56:59], v[168:171]
    v_exp_f32 v175, v175
    v_mfma_f32_16x16x32_bf16 v[168:171], a[176:179], v[52:55], v[168:171]
    ds_read_b64_tr_b16 a[204:205], v6 offset:40960
    v_mfma_f32_16x16x32_bf16 a[112:115], a[216:219], v[180:183], a[112:115]
    v_exp_f32 v176, v176
    v_mfma_f32_16x16x32_bf16 a[112:115], a[220:223], v[184:187], a[112:115]
    ds_read_b64_tr_b16 a[206:207], v6 offset:45056
    v_cvt_pk_bf16_f32 v235, v174, v175
    v_mfma_f32_16x16x32_bf16 a[116:119], a[220:223], v[192:195], a[116:119]
    v_exp_f32 v177, v177
    v_mfma_f32_16x16x32_bf16 a[116:119], a[216:219], v[188:191], a[116:119]
    ds_read_b128 a[140:143], v4 offset:0
    v_mfma_f32_16x16x32_bf16 a[120:123], a[216:219], v[196:199], a[120:123]
    v_exp_f32 v178, v178
    v_mfma_f32_16x16x32_bf16 a[120:123], a[220:223], v[200:203], a[120:123]
    v_cvt_pk_bf16_f32 v242, v176, v177
    v_mfma_f32_16x16x32_bf16 a[124:127], a[220:223], v[208:211], a[124:127]
    v_exp_f32 v179, v179
    v_mfma_f32_16x16x32_bf16 a[124:127], a[216:219], v[204:207], a[124:127]
    buffer_load_dwordx4 v14, s[8:11], s28 offen offset:1024 lds
    v_smfmac_f32_16x16x64_bf16 a[236:239], v[244:247], v[204:211], v248
    s_waitcnt lgkmcnt(6)
    s_sub_u32 s35, s35, 1
    s_cbranch_scc0 L_attn_loop
    v_mfma_f32_16x16x32_bf16 v[172:175], a[176:179], v[68:71], v[108:111]
    v_exp_f32 v116, v116
    v_mfma_f32_16x16x32_bf16 v[172:175], a[180:183], v[72:75], v[172:175]
    ds_read_b64_tr_b16 a[208:209], v7 offset:16384
    v_cvt_pk_bf16_f32 v243, v178, v179
    v_mfma_f32_16x16x32_bf16 v[172:175], a[184:187], v[76:79], v[172:175]
    v_exp_f32 v117, v117
    v_mfma_f32_16x16x32_bf16 v[172:175], a[188:191], v[80:83], v[172:175]
    ds_read_b64_tr_b16 a[210:211], v7 offset:20480
    v_bfe_u32 v21, v19, 3, 2
    v_lshlrev_b32 v21, 8, v21
    v_and_b32 v20, 7, v19
    v_lshl_add_u32 v21, v20, 2, v21
    v_add_u32 v21, 86016, v21
    ds_read_b32 v20, v21
    v_mfma_f32_16x16x32_bf16 v[176:179], a[188:191], v[96:99], v[112:115]
    v_exp_f32 v118, v118
    v_mfma_f32_16x16x32_bf16 v[176:179], a[184:187], v[92:95], v[176:179]
    ds_read_b128 a[144:147], v1 offset:4096
    v_cvt_pk_bf16_f32 v180, v116, v117
    v_mfma_f32_16x16x32_bf16 v[176:179], a[180:183], v[88:91], v[176:179]
    v_exp_f32 v119, v119
    v_mfma_f32_16x16x32_bf16 v[176:179], a[176:179], v[84:87], v[176:179]
    ds_read_b64_tr_b16 a[212:213], v7 offset:40960
    v_lshlrev_b32 v32, 7, v19
    v_add_u32 v32, 0x290000, v32
    buffer_load_dwordx4 v[28:31], v32, s[76:79], 0 offen sc1
    v_mfma_f32_16x16x32_bf16 a[0:3], a[192:195], v[212:215], a[0:3]
    v_exp_f32 v120, v120
    v_mfma_f32_16x16x32_bf16 a[0:3], a[196:199], v[216:219], a[0:3]
    ds_read_b64_tr_b16 a[214:215], v7 offset:45056
    v_cvt_pk_bf16_f32 v181, v118, v119
    v_mfma_f32_16x16x32_bf16 a[4:7], a[196:199], v[224:227], a[4:7]
    v_exp_f32 v121, v121
    v_mfma_f32_16x16x32_bf16 a[4:7], a[192:195], v[220:223], a[4:7]
    ds_read_b128 a[148:151], v2 offset:4096
    v_cvt_pk_bf16_f32 v188, v120, v121
    v_mfma_f32_16x16x32_bf16 a[8:11], a[192:195], v[228:231], a[8:11]
    v_exp_f32 v122, v122
    v_mfma_f32_16x16x32_bf16 a[8:11], a[196:199], v[232:235], a[8:11]
    buffer_load_dwordx4 v15, s[8:11], s28 offen offset:2048 lds
    v_mfma_f32_16x16x32_bf16 a[12:15], a[196:199], v[240:243], a[12:15]
    v_exp_f32 v123, v123
    v_mfma_f32_16x16x32_bf16 a[12:15], a[192:195], v[236:239], a[12:15]
    s_waitcnt lgkmcnt(6)
    v_mfma_f32_16x16x32_bf16 v[116:119], a[128:131], v[36:39], v[100:103]
    v_exp_f32 v124, v124
    v_mfma_f32_16x16x32_bf16 v[116:119], a[132:135], v[40:43], v[116:119]
    ds_read_b64_tr_b16 a[216:217], v8 offset:16384
    v_cvt_pk_bf16_f32 v189, v122, v123
    v_mfma_f32_16x16x32_bf16 v[116:119], a[136:139], v[44:47], v[116:119]
    v_exp_f32 v125, v125
    v_mfma_f32_16x16x32_bf16 v[116:119], a[140:143], v[48:51], v[116:119]
    ds_read_b64_tr_b16 a[218:219], v8 offset:20480
    s_bfe_u32 s40, s2, 0x20001
    s_lshl_b32 s40, s40, 3
    s_bfe_u32 s41, s2, 0x30003
    s_add_u32 s87, s40, s41
    s_and_b32 s40, s2, 1
    s_lshl_b32 s40, s40, 2
    s_lshr_b32 s41, s2, 6
    s_add_u32 s100, s40, s41
    s_add_u32 s16, s72, 0x1a00000
    s_addc_u32 s17, s73, 0
    s_mov_b32 s18, 0x438000
    s_mov_b32 s19, 0x20000
    v_mfma_f32_16x16x32_bf16 v[120:123], a[140:143], v[64:67], v[104:107]
    v_exp_f32 v126, v126
    v_mfma_f32_16x16x32_bf16 v[120:123], a[136:139], v[60:63], v[120:123]
    ds_read_b128 a[152:155], v3 offset:4096
    v_cvt_pk_bf16_f32 v196, v124, v125
    v_mfma_f32_16x16x32_bf16 v[120:123], a[132:135], v[56:59], v[120:123]
    v_exp_f32 v127, v127
    v_mfma_f32_16x16x32_bf16 v[120:123], a[128:131], v[52:55], v[120:123]
    ds_read_b64_tr_b16 a[220:221], v8 offset:40960
    v_mfma_f32_16x16x32_bf16 a[16:19], a[200:203], v[212:215], a[16:19]
    v_exp_f32 v128, v128
    v_mfma_f32_16x16x32_bf16 a[16:19], a[204:207], v[216:219], a[16:19]
    ds_read_b64_tr_b16 a[222:223], v8 offset:45056
    v_cvt_pk_bf16_f32 v197, v126, v127
    v_mfma_f32_16x16x32_bf16 a[20:23], a[204:207], v[224:227], a[20:23]
    v_exp_f32 v129, v129
    v_mfma_f32_16x16x32_bf16 a[20:23], a[200:203], v[220:223], a[20:23]
    ds_read_b128 a[156:159], v4 offset:4096
    v_mfma_f32_16x16x32_bf16 a[24:27], a[200:203], v[228:231], a[24:27]
    v_exp_f32 v130, v130
    v_mfma_f32_16x16x32_bf16 a[24:27], a[204:207], v[232:235], a[24:27]
    v_cvt_pk_bf16_f32 v204, v128, v129
    v_mfma_f32_16x16x32_bf16 a[28:31], a[204:207], v[240:243], a[28:31]
    v_exp_f32 v131, v131
    v_mfma_f32_16x16x32_bf16 a[28:31], a[200:203], v[236:239], a[28:31]
    buffer_load_dwordx4 v16, s[8:11], s28 offen offset:3072 lds
    v_smfmac_f32_16x16x64_bf16 a[224:227], v[244:247], v[212:219], v248
    s_waitcnt lgkmcnt(6)
    v_mfma_f32_16x16x32_bf16 v[124:127], a[128:131], v[68:71], v[108:111]
    s_mov_b32 s42, -1
    v_exp_f32 v132, v132
    v_mfma_f32_16x16x32_bf16 v[124:127], a[132:135], v[72:75], v[124:127]
    ds_read_b64_tr_b16 a[192:193], v9 offset:16384
    v_cvt_pk_bf16_f32 v205, v130, v131
    v_mfma_f32_16x16x32_bf16 v[124:127], a[136:139], v[76:79], v[124:127]
    v_exp_f32 v133, v133
    v_sub_u32 v21, s42, v20
    v_mfma_f32_16x16x32_bf16 v[124:127], a[140:143], v[80:83], v[124:127]
    ds_read_b64_tr_b16 a[194:195], v9 offset:20480
    v_min_u32_dpp v21, v21, v21 row_shr:1 row_mask:0xf bank_mask:0xf
    v_mfma_f32_16x16x32_bf16 v[128:131], a[140:143], v[96:99], v[112:115]
    v_exp_f32 v134, v134
    v_min_u32_dpp v21, v21, v21 row_shr:2 row_mask:0xf bank_mask:0xf
    v_mfma_f32_16x16x32_bf16 v[128:131], a[136:139], v[92:95], v[128:131]
    ds_read_b128 a[160:163], v1 offset:8192
    v_cvt_pk_bf16_f32 v182, v132, v133
    v_min_u32_dpp v21, v21, v21 row_shr:4 row_mask:0xf bank_mask:0xf
    v_mfma_f32_16x16x32_bf16 v[128:131], a[132:135], v[88:91], v[128:131]
    v_exp_f32 v135, v135
    v_min_u32_dpp v21, v21, v21 row_shr:8 row_mask:0xf bank_mask:0xf
    v_mfma_f32_16x16x32_bf16 v[128:131], a[128:131], v[84:87], v[128:131]
    ds_read_b64_tr_b16 a[196:197], v9 offset:40960
    v_min_u32_dpp v21, v21, v21 row_bcast:15 row_mask:0xa bank_mask:0xf
    v_mfma_f32_16x16x32_bf16 a[32:35], a[208:211], v[212:215], a[32:35]
    v_exp_f32 v136, v136
    v_min_u32_dpp v21, v21, v21 row_bcast:31 row_mask:0xc bank_mask:0xf
    v_mfma_f32_16x16x32_bf16 a[32:35], a[212:215], v[216:219], a[32:35]
    ds_read_b64_tr_b16 a[198:199], v9 offset:45056
    v_cvt_pk_bf16_f32 v183, v134, v135
    v_readlane_b32 s50, v21, 63
    v_mfma_f32_16x16x32_bf16 a[36:39], a[212:215], v[224:227], a[36:39]
    s_sub_u32 s50, s42, s50
    v_exp_f32 v137, v137
    v_mfma_f32_16x16x32_bf16 a[36:39], a[208:211], v[220:223], a[36:39]
    s_sub_u32 s42, s50, 1
    ds_read_b128 a[164:167], v2 offset:8192
    v_cvt_pk_bf16_f32 v190, v136, v137
    v_mfma_f32_16x16x32_bf16 a[40:43], a[208:211], v[228:231], a[40:43]
    s_add_u32 s28, s28, 16384
    s_mov_b32 m0, s33
    v_exp_f32 v138, v138
    v_sub_u32 v21, s42, v20
    v_mfma_f32_16x16x32_bf16 a[40:43], a[212:215], v[232:235], a[40:43]
    buffer_load_dwordx4 v17, s[12:15], s29 offen offset:0 lds
    v_mfma_f32_16x16x32_bf16 a[44:47], a[212:215], v[240:243], a[44:47]
    v_exp_f32 v139, v139
    v_min_u32_dpp v21, v21, v21 row_shr:1 row_mask:0xf bank_mask:0xf
    v_mfma_f32_16x16x32_bf16 a[44:47], a[208:211], v[236:239], a[44:47]
    s_waitcnt lgkmcnt(6)
    v_min_u32_dpp v21, v21, v21 row_shr:2 row_mask:0xf bank_mask:0xf
    s_nop 1
    v_min_u32_dpp v21, v21, v21 row_shr:4 row_mask:0xf bank_mask:0xf
    v_mfma_f32_16x16x32_bf16 v[132:135], a[144:147], v[36:39], v[100:103]
    v_exp_f32 v140, v140
    v_mfma_f32_16x16x32_bf16 v[132:135], a[148:151], v[40:43], v[132:135]
    ds_read_b64_tr_b16 a[200:201], v10 offset:16384
    v_cvt_pk_bf16_f32 v191, v138, v139
    v_min_u32_dpp v21, v21, v21 row_shr:8 row_mask:0xf bank_mask:0xf
    v_mfma_f32_16x16x32_bf16 v[132:135], a[152:155], v[44:47], v[132:135]
    v_exp_f32 v141, v141
    v_min_u32_dpp v21, v21, v21 row_bcast:15 row_mask:0xa bank_mask:0xf
    v_mfma_f32_16x16x32_bf16 v[132:135], a[156:159], v[48:51], v[132:135]
    ds_read_b64_tr_b16 a[202:203], v10 offset:20480
    v_min_u32_dpp v21, v21, v21 row_bcast:31 row_mask:0xc bank_mask:0xf
    v_mfma_f32_16x16x32_bf16 v[136:139], a[156:159], v[64:67], v[104:107]
    v_exp_f32 v142, v142
    v_readlane_b32 s51, v21, 63
    v_mfma_f32_16x16x32_bf16 v[136:139], a[152:155], v[60:63], v[136:139]
    s_sub_u32 s51, s42, s51
    ds_read_b128 a[168:171], v3 offset:8192
    v_cvt_pk_bf16_f32 v198, v140, v141
    v_mfma_f32_16x16x32_bf16 v[136:139], a[148:151], v[56:59], v[136:139]
    s_sub_u32 s42, s51, 1
    v_exp_f32 v143, v143
    v_mfma_f32_16x16x32_bf16 v[136:139], a[144:147], v[52:55], v[136:139]
    ds_read_b64_tr_b16 a[204:205], v10 offset:40960
    v_sub_u32 v21, s42, v20
    v_mfma_f32_16x16x32_bf16 a[48:51], a[216:219], v[212:215], a[48:51]
    v_exp_f32 v144, v144
    v_min_u32_dpp v21, v21, v21 row_shr:1 row_mask:0xf bank_mask:0xf
    v_mfma_f32_16x16x32_bf16 a[48:51], a[220:223], v[216:219], a[48:51]
    ds_read_b64_tr_b16 a[206:207], v10 offset:45056
    v_cvt_pk_bf16_f32 v199, v142, v143
    v_min_u32_dpp v21, v21, v21 row_shr:2 row_mask:0xf bank_mask:0xf
    v_mfma_f32_16x16x32_bf16 a[52:55], a[220:223], v[224:227], a[52:55]
    v_exp_f32 v145, v145
    v_min_u32_dpp v21, v21, v21 row_shr:4 row_mask:0xf bank_mask:0xf
    v_mfma_f32_16x16x32_bf16 a[52:55], a[216:219], v[220:223], a[52:55]
    ds_read_b128 a[172:175], v4 offset:8192
    v_min_u32_dpp v21, v21, v21 row_shr:8 row_mask:0xf bank_mask:0xf
    v_mfma_f32_16x16x32_bf16 a[56:59], a[216:219], v[228:231], a[56:59]
    v_exp_f32 v146, v146
    v_mfma_f32_16x16x32_bf16 a[56:59], a[220:223], v[232:235], a[56:59]
    v_cvt_pk_bf16_f32 v206, v144, v145
    v_min_u32_dpp v21, v21, v21 row_bcast:15 row_mask:0xa bank_mask:0xf
    v_mfma_f32_16x16x32_bf16 a[60:63], a[220:223], v[240:243], a[60:63]
    v_exp_f32 v147, v147
    v_min_u32_dpp v21, v21, v21 row_bcast:31 row_mask:0xc bank_mask:0xf
    v_mfma_f32_16x16x32_bf16 a[60:63], a[216:219], v[236:239], a[60:63]
    buffer_load_dwordx4 v18, s[12:15], s29 offen offset:1024 lds
    v_readlane_b32 s52, v21, 63
    v_smfmac_f32_16x16x64_bf16 a[228:231], v[244:247], v[220:227], v248
    s_waitcnt lgkmcnt(6)
    v_mfma_f32_16x16x32_bf16 v[140:143], a[144:147], v[68:71], v[108:111]
    s_sub_u32 s52, s42, s52
    v_exp_f32 v148, v148
    v_mfma_f32_16x16x32_bf16 v[140:143], a[148:151], v[72:75], v[140:143]
    s_sub_u32 s42, s52, 1
    ds_read_b64_tr_b16 a[208:209], v11 offset:16384
    v_cvt_pk_bf16_f32 v207, v146, v147
    v_mfma_f32_16x16x32_bf16 v[140:143], a[152:155], v[76:79], v[140:143]
    v_exp_f32 v149, v149
    v_sub_u32 v21, s42, v20
    v_mfma_f32_16x16x32_bf16 v[140:143], a[156:159], v[80:83], v[140:143]
    ds_read_b64_tr_b16 a[210:211], v11 offset:20480
    v_min_u32_dpp v21, v21, v21 row_shr:1 row_mask:0xf bank_mask:0xf
    v_mfma_f32_16x16x32_bf16 v[144:147], a[156:159], v[96:99], v[112:115]
    v_exp_f32 v150, v150
    v_min_u32_dpp v21, v21, v21 row_shr:2 row_mask:0xf bank_mask:0xf
    v_mfma_f32_16x16x32_bf16 v[144:147], a[152:155], v[92:95], v[144:147]
    ds_read_b128 a[176:179], v1 offset:12288
    v_cvt_pk_bf16_f32 v184, v148, v149
    v_min_u32_dpp v21, v21, v21 row_shr:4 row_mask:0xf bank_mask:0xf
    v_mfma_f32_16x16x32_bf16 v[144:147], a[148:151], v[88:91], v[144:147]
    v_exp_f32 v151, v151
    v_min_u32_dpp v21, v21, v21 row_shr:8 row_mask:0xf bank_mask:0xf
    v_mfma_f32_16x16x32_bf16 v[144:147], a[144:147], v[84:87], v[144:147]
    ds_read_b64_tr_b16 a[212:213], v11 offset:40960
    v_min_u32_dpp v21, v21, v21 row_bcast:15 row_mask:0xa bank_mask:0xf
    v_mfma_f32_16x16x32_bf16 a[64:67], a[192:195], v[212:215], a[64:67]
    v_exp_f32 v152, v152
    v_min_u32_dpp v21, v21, v21 row_bcast:31 row_mask:0xc bank_mask:0xf
    v_mfma_f32_16x16x32_bf16 a[64:67], a[196:199], v[216:219], a[64:67]
    ds_read_b64_tr_b16 a[214:215], v11 offset:45056
    v_cvt_pk_bf16_f32 v185, v150, v151
    v_mfma_f32_16x16x32_bf16 a[68:71], a[196:199], v[224:227], a[68:71]
    v_exp_f32 v153, v153
    v_readlane_b32 s53, v21, 63
    v_mfma_f32_16x16x32_bf16 a[68:71], a[192:195], v[220:223], a[68:71]
    s_sub_u32 s53, s42, s53
    ds_read_b128 a[180:183], v2 offset:12288
    v_cvt_pk_bf16_f32 v192, v152, v153
    v_mfma_f32_16x16x32_bf16 a[72:75], a[192:195], v[228:231], a[72:75]
    s_sub_u32 s42, s53, 1
    v_exp_f32 v154, v154
    v_mfma_f32_16x16x32_bf16 a[72:75], a[196:199], v[232:235], a[72:75]
    buffer_load_dwordx4 v17, s[12:15], s29 offen offset:2048 lds
    v_sub_u32 v21, s42, v20
    v_mfma_f32_16x16x32_bf16 a[76:79], a[196:199], v[240:243], a[76:79]
    v_exp_f32 v155, v155
    v_min_u32_dpp v21, v21, v21 row_shr:1 row_mask:0xf bank_mask:0xf
    v_mfma_f32_16x16x32_bf16 a[76:79], a[192:195], v[236:239], a[76:79]
    s_waitcnt lgkmcnt(6)
    v_min_u32_dpp v21, v21, v21 row_shr:2 row_mask:0xf bank_mask:0xf
    s_nop 1
    v_min_u32_dpp v21, v21, v21 row_shr:4 row_mask:0xf bank_mask:0xf
    v_mfma_f32_16x16x32_bf16 v[148:151], a[160:163], v[36:39], v[100:103]
    v_exp_f32 v156, v156
    v_mfma_f32_16x16x32_bf16 v[148:151], a[164:167], v[40:43], v[148:151]
    ds_read_b64_tr_b16 a[216:217], v12 offset:16384
    v_cvt_pk_bf16_f32 v193, v154, v155
    v_min_u32_dpp v21, v21, v21 row_shr:8 row_mask:0xf bank_mask:0xf
    v_mfma_f32_16x16x32_bf16 v[148:151], a[168:171], v[44:47], v[148:151]
    v_exp_f32 v157, v157
    v_min_u32_dpp v21, v21, v21 row_bcast:15 row_mask:0xa bank_mask:0xf
    v_mfma_f32_16x16x32_bf16 v[148:151], a[172:175], v[48:51], v[148:151]
    ds_read_b64_tr_b16 a[218:219], v12 offset:20480
    v_min_u32_dpp v21, v21, v21 row_bcast:31 row_mask:0xc bank_mask:0xf
    v_mfma_f32_16x16x32_bf16 v[152:155], a[172:175], v[64:67], v[104:107]
    v_exp_f32 v158, v158
    v_readlane_b32 s54, v21, 63
    v_mfma_f32_16x16x32_bf16 v[152:155], a[168:171], v[60:63], v[152:155]
    s_sub_u32 s54, s42, s54
    ds_read_b128 a[184:187], v3 offset:12288
    v_cvt_pk_bf16_f32 v200, v156, v157
    v_mfma_f32_16x16x32_bf16 v[152:155], a[164:167], v[56:59], v[152:155]
    s_sub_u32 s42, s54, 1
    v_exp_f32 v159, v159
    v_mfma_f32_16x16x32_bf16 v[152:155], a[160:163], v[52:55], v[152:155]
    ds_read_b64_tr_b16 a[220:221], v12 offset:40960
    v_sub_u32 v21, s42, v20
    v_mfma_f32_16x16x32_bf16 a[80:83], a[200:203], v[212:215], a[80:83]
    v_exp_f32 v160, v160
    v_mfma_f32_16x16x32_bf16 a[80:83], a[204:207], v[216:219], a[80:83]
    ds_read_b64_tr_b16 a[222:223], v12 offset:45056
    v_cvt_pk_bf16_f32 v201, v158, v159
    v_min_u32_dpp v21, v21, v21 row_shr:1 row_mask:0xf bank_mask:0xf
    v_mfma_f32_16x16x32_bf16 a[84:87], a[204:207], v[224:227], a[84:87]
    v_exp_f32 v161, v161
    v_min_u32_dpp v21, v21, v21 row_shr:2 row_mask:0xf bank_mask:0xf
    v_mfma_f32_16x16x32_bf16 a[84:87], a[200:203], v[220:223], a[84:87]
    ds_read_b128 a[188:191], v4 offset:12288
    v_min_u32_dpp v21, v21, v21 row_shr:4 row_mask:0xf bank_mask:0xf
    v_mfma_f32_16x16x32_bf16 a[88:91], a[200:203], v[228:231], a[88:91]
    v_exp_f32 v162, v162
    v_min_u32_dpp v21, v21, v21 row_shr:8 row_mask:0xf bank_mask:0xf
    v_mfma_f32_16x16x32_bf16 a[88:91], a[204:207], v[232:235], a[88:91]
    v_cvt_pk_bf16_f32 v208, v160, v161
    v_min_u32_dpp v21, v21, v21 row_bcast:15 row_mask:0xa bank_mask:0xf
    v_mfma_f32_16x16x32_bf16 a[92:95], a[204:207], v[240:243], a[92:95]
    v_exp_f32 v163, v163
    v_min_u32_dpp v21, v21, v21 row_bcast:31 row_mask:0xc bank_mask:0xf
    v_mfma_f32_16x16x32_bf16 a[92:95], a[200:203], v[236:239], a[92:95]
    buffer_load_dwordx4 v18, s[12:15], s29 offen offset:3072 lds
    v_readlane_b32 s55, v21, 63
    v_smfmac_f32_16x16x64_bf16 a[232:235], v[244:247], v[228:235], v248
    s_waitcnt vmcnt(9) lgkmcnt(6)
    s_barrier
    s_add_u32 s29, s29, 16384
    v_mfma_f32_16x16x32_bf16 v[156:159], a[160:163], v[68:71], v[108:111]
    s_sub_u32 s55, s42, s55
    v_exp_f32 v164, v164
    v_mfma_f32_16x16x32_bf16 v[156:159], a[164:167], v[72:75], v[156:159]
    s_sub_u32 s42, s55, 1
    ds_read_b64_tr_b16 a[192:193], v5 offset:57344
    v_cvt_pk_bf16_f32 v209, v162, v163
    v_mfma_f32_16x16x32_bf16 v[156:159], a[168:171], v[76:79], v[156:159]
    v_exp_f32 v165, v165
    v_sub_u32 v21, s42, v20
    v_mfma_f32_16x16x32_bf16 v[156:159], a[172:175], v[80:83], v[156:159]
    ds_read_b64_tr_b16 a[194:195], v5 offset:61440
    s_mov_b32 s43, m0
    v_lshlrev_b32 v25, 4, v19
    s_mul_i32 s40, s5, 3072
    s_mul_i32 s41, s6, 10240
    s_add_u32 m0, s40, 86016
    s_add_u32 s41, s41, s40
    buffer_load_dwordx4 v25, s[96:99], s41 offen offset:0 lds
    buffer_load_dwordx4 v25, s[96:99], s41 offen offset:1024 lds
    buffer_load_dwordx4 v25, s[96:99], s41 offen offset:2048 lds
    s_mov_b32 m0, s43
    v_min_u32_dpp v21, v21, v21 row_shr:1 row_mask:0xf bank_mask:0xf
    v_mfma_f32_16x16x32_bf16 v[160:163], a[172:175], v[96:99], v[112:115]
    v_exp_f32 v166, v166
    v_mfma_f32_16x16x32_bf16 v[160:163], a[168:171], v[92:95], v[160:163]
    ds_read_b128 a[128:131], v1 offset:49152
    v_cvt_pk_bf16_f32 v186, v164, v165
    v_min_u32_dpp v21, v21, v21 row_shr:2 row_mask:0xf bank_mask:0xf
    v_mfma_f32_16x16x32_bf16 v[160:163], a[164:167], v[88:91], v[160:163]
    v_exp_f32 v167, v167
    v_min_u32_dpp v21, v21, v21 row_shr:4 row_mask:0xf bank_mask:0xf
    v_mfma_f32_16x16x32_bf16 v[160:163], a[160:163], v[84:87], v[160:163]
    ds_read_b64_tr_b16 a[196:197], v5 offset:0
    v_min_u32_dpp v21, v21, v21 row_shr:8 row_mask:0xf bank_mask:0xf
    v_mfma_f32_16x16x32_bf16 a[96:99], a[208:211], v[212:215], a[96:99]
    v_exp_f32 v168, v168
    v_min_u32_dpp v21, v21, v21 row_bcast:15 row_mask:0xa bank_mask:0xf
    v_mfma_f32_16x16x32_bf16 a[96:99], a[212:215], v[216:219], a[96:99]
    ds_read_b64_tr_b16 a[198:199], v5 offset:4096
    v_cvt_pk_bf16_f32 v187, v166, v167
    v_min_u32_dpp v21, v21, v21 row_bcast:31 row_mask:0xc bank_mask:0xf
    v_mfma_f32_16x16x32_bf16 a[100:103], a[212:215], v[224:227], a[100:103]
    v_exp_f32 v169, v169
    v_readlane_b32 s56, v21, 63
    v_mfma_f32_16x16x32_bf16 a[100:103], a[208:211], v[220:223], a[100:103]
    s_sub_u32 s56, s42, s56
    ds_read_b128 a[132:135], v2 offset:49152
    v_cvt_pk_bf16_f32 v194, v168, v169
    v_mfma_f32_16x16x32_bf16 a[104:107], a[208:211], v[228:231], a[104:107]
    s_sub_u32 s42, s56, 1
    s_add_u32 m0, s34, 32768
    v_exp_f32 v170, v170
    v_mfma_f32_16x16x32_bf16 a[104:107], a[212:215], v[232:235], a[104:107]
    buffer_load_dwordx4 v13, s[8:11], s28 offen offset:0 lds
    v_sub_u32 v21, s42, v20
    v_mfma_f32_16x16x32_bf16 a[108:111], a[212:215], v[240:243], a[108:111]
    v_exp_f32 v171, v171
    v_min_u32_dpp v21, v21, v21 row_shr:1 row_mask:0xf bank_mask:0xf
    v_mfma_f32_16x16x32_bf16 a[108:111], a[208:211], v[236:239], a[108:111]
    s_waitcnt lgkmcnt(6)
    v_min_u32_dpp v21, v21, v21 row_shr:2 row_mask:0xf bank_mask:0xf
    s_nop 1
    v_min_u32_dpp v21, v21, v21 row_shr:4 row_mask:0xf bank_mask:0xf
    v_mfma_f32_16x16x32_bf16 v[164:167], a[176:179], v[36:39], v[100:103]
    v_exp_f32 v172, v172
    v_mfma_f32_16x16x32_bf16 v[164:167], a[180:183], v[40:43], v[164:167]
    ds_read_b64_tr_b16 a[200:201], v6 offset:57344
    v_cvt_pk_bf16_f32 v195, v170, v171
    v_min_u32_dpp v21, v21, v21 row_shr:8 row_mask:0xf bank_mask:0xf
    v_mfma_f32_16x16x32_bf16 v[164:167], a[184:187], v[44:47], v[164:167]
    v_exp_f32 v173, v173
    v_mfma_f32_16x16x32_bf16 v[164:167], a[188:191], v[48:51], v[164:167]
    ds_read_b64_tr_b16 a[202:203], v6 offset:61440
    s_waitcnt vmcnt(10)
    v_min3_u32 v28, v28, v29, v30
    v_min_u32 v28, v28, v31
    v_cmp_gt_u32 vcc, 1, v28
    s_and_b64 vcc, vcc, exec
    s_cbranch_scc1 L_spin_pack
L_back_pack:
    v_min_u32_dpp v21, v21, v21 row_bcast:15 row_mask:0xa bank_mask:0xf
    v_mfma_f32_16x16x32_bf16 v[168:171], a[188:191], v[64:67], v[104:107]
    v_exp_f32 v174, v174
    v_min_u32_dpp v21, v21, v21 row_bcast:31 row_mask:0xc bank_mask:0xf
    v_mfma_f32_16x16x32_bf16 v[168:171], a[184:187], v[60:63], v[168:171]
    ds_read_b128 a[136:139], v3 offset:49152
    v_cvt_pk_bf16_f32 v202, v172, v173
    v_readlane_b32 s57, v21, 63
    v_mfma_f32_16x16x32_bf16 v[168:171], a[180:183], v[56:59], v[168:171]
    s_sub_u32 s57, s42, s57
    v_exp_f32 v175, v175
    v_mfma_f32_16x16x32_bf16 v[168:171], a[176:179], v[52:55], v[168:171]
    s_sub_u32 s42, s57, 1
    ds_read_b64_tr_b16 a[204:205], v6 offset:0
    v_mov_b32 v249, s50
    v_mfma_f32_16x16x32_bf16 a[112:115], a[216:219], v[212:215], a[112:115]
    v_exp_f32 v176, v176
    v_mfma_f32_16x16x32_bf16 a[112:115], a[220:223], v[216:219], a[112:115]
    ds_read_b64_tr_b16 a[206:207], v6 offset:4096
    v_cvt_pk_bf16_f32 v203, v174, v175
    v_writelane_b32 v249, s51, 1
    v_mfma_f32_16x16x32_bf16 a[116:119], a[220:223], v[224:227], a[116:119]
    v_exp_f32 v177, v177
    v_writelane_b32 v249, s52, 2
    v_mfma_f32_16x16x32_bf16 a[116:119], a[216:219], v[220:223], a[116:119]
    ds_read_b128 a[140:143], v4 offset:49152
    v_writelane_b32 v249, s53, 3
    v_mfma_f32_16x16x32_bf16 a[120:123], a[216:219], v[228:231], a[120:123]
    v_exp_f32 v178, v178
    v_writelane_b32 v249, s54, 4
    v_mfma_f32_16x16x32_bf16 a[120:123], a[220:223], v[232:235], a[120:123]
    v_cvt_pk_bf16_f32 v210, v176, v177
    v_writelane_b32 v249, s55, 5
    v_mfma_f32_16x16x32_bf16 a[124:127], a[220:223], v[240:243], a[124:127]
    v_exp_f32 v179, v179
    v_writelane_b32 v249, s56, 6
    v_mfma_f32_16x16x32_bf16 a[124:127], a[216:219], v[236:239], a[124:127]
    buffer_load_dwordx4 v14, s[8:11], s28 offen offset:1024 lds
    v_writelane_b32 v249, s57, 7
    v_smfmac_f32_16x16x64_bf16 a[236:239], v[244:247], v[236:243], v248
    s_waitcnt lgkmcnt(6)
    v_mfma_f32_16x16x32_bf16 v[172:175], a[176:179], v[68:71], v[108:111]
    v_exp_f32 v116, v116
    v_mfma_f32_16x16x32_bf16 v[172:175], a[180:183], v[72:75], v[172:175]
    ds_read_b64_tr_b16 a[208:209], v7 offset:57344
    v_cvt_pk_bf16_f32 v211, v178, v179
    v_mfma_f32_16x16x32_bf16 v[172:175], a[184:187], v[76:79], v[172:175]
    v_exp_f32 v117, v117
    v_mfma_f32_16x16x32_bf16 v[172:175], a[188:191], v[80:83], v[172:175]
    ds_read_b64_tr_b16 a[210:211], v7 offset:61440
    v_and_b32 v23, 7, v19
    v_lshlrev_b32 v23, 2, v23
    ds_bpermute_b32 v22, v23, v249
    v_mov_b32 v24, 0x3f803f80
    v_accvgpr_write_b32 a240, v24
    v_accvgpr_write_b32 a241, v24
    v_accvgpr_write_b32 a242, v24
    v_accvgpr_write_b32 a243, v24
    v_mfma_f32_16x16x32_bf16 v[176:179], a[188:191], v[96:99], v[112:115]
    v_exp_f32 v118, v118
    v_mfma_f32_16x16x32_bf16 v[176:179], a[184:187], v[92:95], v[176:179]
    ds_read_b128 a[144:147], v1 offset:53248
    v_cvt_pk_bf16_f32 v212, v116, v117
    v_mfma_f32_16x16x32_bf16 v[176:179], a[180:183], v[88:91], v[176:179]
    v_exp_f32 v119, v119
    v_mfma_f32_16x16x32_bf16 v[176:179], a[176:179], v[84:87], v[176:179]
    ds_read_b64_tr_b16 a[212:213], v7 offset:0
    v_accvgpr_write_b32 a244, v24
    v_accvgpr_write_b32 a245, v24
    v_accvgpr_write_b32 a246, v24
    v_accvgpr_write_b32 a247, v24
    v_accvgpr_write_b32 a248, v24
    v_accvgpr_write_b32 a249, v24
    v_mfma_f32_16x16x32_bf16 a[0:3], a[192:195], v[180:183], a[0:3]
    v_exp_f32 v120, v120
    v_mfma_f32_16x16x32_bf16 a[0:3], a[196:199], v[184:187], a[0:3]
    ds_read_b64_tr_b16 a[214:215], v7 offset:4096
    v_cvt_pk_bf16_f32 v213, v118, v119
    v_mfma_f32_16x16x32_bf16 a[4:7], a[196:199], v[192:195], a[4:7]
    v_exp_f32 v121, v121
    v_mfma_f32_16x16x32_bf16 a[4:7], a[192:195], v[188:191], a[4:7]
    ds_read_b128 a[148:151], v2 offset:53248
    v_cvt_pk_bf16_f32 v220, v120, v121
    v_mfma_f32_16x16x32_bf16 a[8:11], a[192:195], v[196:199], a[8:11]
    v_exp_f32 v122, v122
    v_mfma_f32_16x16x32_bf16 a[8:11], a[196:199], v[200:203], a[8:11]
    buffer_load_dwordx4 v15, s[8:11], s28 offen offset:2048 lds
    v_mfma_f32_16x16x32_bf16 a[12:15], a[196:199], v[208:211], a[12:15]
    v_exp_f32 v123, v123
    v_mfma_f32_16x16x32_bf16 a[12:15], a[192:195], v[204:207], a[12:15]
    s_waitcnt lgkmcnt(6)
    v_mfma_f32_16x16x32_bf16 v[116:119], a[128:131], v[36:39], v[100:103]
    v_exp_f32 v124, v124
    v_mfma_f32_16x16x32_bf16 v[116:119], a[132:135], v[40:43], v[116:119]
    ds_read_b64_tr_b16 a[216:217], v8 offset:57344
    v_cvt_pk_bf16_f32 v221, v122, v123
    v_mfma_f32_16x16x32_bf16 v[116:119], a[136:139], v[44:47], v[116:119]
    v_exp_f32 v125, v125
    v_mfma_f32_16x16x32_bf16 v[116:119], a[140:143], v[48:51], v[116:119]
    ds_read_b64_tr_b16 a[218:219], v8 offset:61440
    v_accvgpr_write_b32 a250, v24
    v_accvgpr_write_b32 a251, v24
    v_accvgpr_write_b32 a252, v24
    v_accvgpr_write_b32 a253, v24
    v_accvgpr_write_b32 a254, v24
    v_mfma_f32_16x16x32_bf16 v[120:123], a[140:143], v[64:67], v[104:107]
    v_exp_f32 v126, v126
    v_mfma_f32_16x16x32_bf16 v[120:123], a[136:139], v[60:63], v[120:123]
    ds_read_b128 a[152:155], v3 offset:53248
    v_cvt_pk_bf16_f32 v228, v124, v125
    v_mfma_f32_16x16x32_bf16 v[120:123], a[132:135], v[56:59], v[120:123]
    v_exp_f32 v127, v127
    v_mfma_f32_16x16x32_bf16 v[120:123], a[128:131], v[52:55], v[120:123]
    ds_read_b64_tr_b16 a[220:221], v8 offset:0
    v_accvgpr_write_b32 a255, v24
    v_mov_b32 v252, v24
    v_mov_b32 v253, v24
    v_mov_b32 v254, v24
    v_mov_b32 v255, v24
    v_mfma_f32_16x16x32_bf16 a[16:19], a[200:203], v[180:183], a[16:19]
    v_exp_f32 v128, v128
    v_mfma_f32_16x16x32_bf16 a[16:19], a[204:207], v[184:187], a[16:19]
    ds_read_b64_tr_b16 a[222:223], v8 offset:4096
    v_cvt_pk_bf16_f32 v229, v126, v127
    v_mfma_f32_16x16x32_bf16 a[20:23], a[204:207], v[192:195], a[20:23]
    v_exp_f32 v129, v129
    v_mfma_f32_16x16x32_bf16 a[20:23], a[200:203], v[188:191], a[20:23]
    ds_read_b128 a[156:159], v4 offset:53248
    v_mfma_f32_16x16x32_bf16 a[24:27], a[200:203], v[196:199], a[24:27]
    v_exp_f32 v130, v130
    v_mfma_f32_16x16x32_bf16 a[24:27], a[204:207], v[200:203], a[24:27]
    v_cvt_pk_bf16_f32 v236, v128, v129
    v_mfma_f32_16x16x32_bf16 a[28:31], a[204:207], v[208:211], a[28:31]
    v_exp_f32 v131, v131
    v_mfma_f32_16x16x32_bf16 a[28:31], a[200:203], v[204:207], a[28:31]
    buffer_load_dwordx4 v16, s[8:11], s28 offen offset:3072 lds
    v_smfmac_f32_16x16x64_bf16 a[224:227], v[244:247], v[180:187], v248
    s_waitcnt lgkmcnt(6)
    v_mfma_f32_16x16x32_bf16 v[124:127], a[128:131], v[68:71], v[108:111]
    v_exp_f32 v132, v132
    v_mfma_f32_16x16x32_bf16 v[124:127], a[132:135], v[72:75], v[124:127]
    ds_read_b64_tr_b16 a[192:193], v9 offset:57344
    v_cvt_pk_bf16_f32 v237, v130, v131
    v_mfma_f32_16x16x32_bf16 v[124:127], a[136:139], v[76:79], v[124:127]
    v_exp_f32 v133, v133
    v_mfma_f32_16x16x32_bf16 v[124:127], a[140:143], v[80:83], v[124:127]
    ds_read_b64_tr_b16 a[194:195], v9 offset:61440
    v_not_b32 v22, v22
    v_and_b32 v22, 0x7ff, v22
    v_lshrrev_b32 v24, 4, v19
    v_lshlrev_b32 v23, 4, v22
    v_mul_u32_u24 v22, 1280, v22
    v_lshl_add_u32 v22, v24, 4, v22
    s_mul_i32 s40, s5, 320
    s_mov_b32 s41, 0x280000
    v_mfma_f32_16x16x32_bf16 v[128:131], a[140:143], v[96:99], v[112:115]
    v_exp_f32 v134, v134
    v_mfma_f32_16x16x32_bf16 v[128:131], a[136:139], v[92:95], v[128:131]
    ds_read_b128 a[160:163], v1 offset:57344
    v_cvt_pk_bf16_f32 v214, v132, v133
    v_mfma_f32_16x16x32_bf16 v[128:131], a[132:135], v[88:91], v[128:131]
    v_exp_f32 v135, v135
    v_mfma_f32_16x16x32_bf16 v[128:131], a[128:131], v[84:87], v[128:131]
    ds_read_b64_tr_b16 a[196:197], v9 offset:0
    buffer_load_dwordx2 v[20:21], v23, s[76:79], s41 offen sc1
    s_mov_b32 exec_lo, 0x00ff00ff
    s_mov_b32 exec_hi, 0x00ff00ff
    buffer_load_dwordx4 a[240:243], v22, s[88:91], s40 offen offset:0
    buffer_load_dwordx4 a[244:247], v22, s[88:91], s40 offen offset:64
    buffer_load_dwordx4 a[248:251], v22, s[88:91], s40 offen offset:128
    buffer_load_dwordx4 a[252:255], v22, s[88:91], s40 offen offset:192
    buffer_load_dwordx4 v[252:255], v22, s[88:91], s40 offen offset:256
    s_mov_b64 exec, -1
    v_mfma_f32_16x16x32_bf16 a[32:35], a[208:211], v[180:183], a[32:35]
    v_exp_f32 v136, v136
    v_mfma_f32_16x16x32_bf16 a[32:35], a[212:215], v[184:187], a[32:35]
    ds_read_b64_tr_b16 a[198:199], v9 offset:4096
    v_cvt_pk_bf16_f32 v215, v134, v135
    v_mfma_f32_16x16x32_bf16 a[36:39], a[212:215], v[192:195], a[36:39]
    v_exp_f32 v137, v137
    v_mfma_f32_16x16x32_bf16 a[36:39], a[208:211], v[188:191], a[36:39]
    ds_read_b128 a[164:167], v2 offset:57344
    v_cvt_pk_bf16_f32 v222, v136, v137
    v_mfma_f32_16x16x32_bf16 a[40:43], a[208:211], v[196:199], a[40:43]
    s_add_u32 s28, s28, 16384
    s_mov_b32 m0, s30
    v_exp_f32 v138, v138
    v_mfma_f32_16x16x32_bf16 a[40:43], a[212:215], v[200:203], a[40:43]
    buffer_load_dwordx4 v17, s[12:15], s29 offen offset:0 lds
    v_mfma_f32_16x16x32_bf16 a[44:47], a[212:215], v[208:211], a[44:47]
    v_exp_f32 v139, v139
    v_mfma_f32_16x16x32_bf16 a[44:47], a[208:211], v[204:207], a[44:47]
    s_waitcnt lgkmcnt(6)
    v_mfma_f32_16x16x32_bf16 v[132:135], a[144:147], v[36:39], v[100:103]
    v_exp_f32 v140, v140
    v_mfma_f32_16x16x32_bf16 v[132:135], a[148:151], v[40:43], v[132:135]
    ds_read_b64_tr_b16 a[200:201], v10 offset:57344
    v_cvt_pk_bf16_f32 v223, v138, v139
    v_mfma_f32_16x16x32_bf16 v[132:135], a[152:155], v[44:47], v[132:135]
    v_exp_f32 v141, v141
    v_mfma_f32_16x16x32_bf16 v[132:135], a[156:159], v[48:51], v[132:135]
    ds_read_b64_tr_b16 a[202:203], v10 offset:61440
    v_lshrrev_b32 v22, 4, v19
    v_mfma_f32_16x16x32_bf16 v[136:139], a[156:159], v[64:67], v[104:107]
    v_exp_f32 v142, v142
    v_mfma_f32_16x16x32_bf16 v[136:139], a[152:155], v[60:63], v[136:139]
    ds_read_b128 a[168:171], v3 offset:57344
    v_cvt_pk_bf16_f32 v230, v140, v141
    v_mfma_f32_16x16x32_bf16 v[136:139], a[148:151], v[56:59], v[136:139]
    v_exp_f32 v143, v143
    v_mfma_f32_16x16x32_bf16 v[136:139], a[144:147], v[52:55], v[136:139]
    ds_read_b64_tr_b16 a[204:205], v10 offset:0
    v_bfe_u32 v24, v19, 2, 2
    v_mfma_f32_16x16x32_bf16 a[48:51], a[216:219], v[180:183], a[48:51]
    v_exp_f32 v144, v144
    v_mfma_f32_16x16x32_bf16 a[48:51], a[220:223], v[184:187], a[48:51]
    ds_read_b64_tr_b16 a[206:207], v10 offset:4096
    v_cvt_pk_bf16_f32 v231, v142, v143
    v_mfma_f32_16x16x32_bf16 a[52:55], a[220:223], v[192:195], a[52:55]
    v_exp_f32 v145, v145
    v_mfma_f32_16x16x32_bf16 a[52:55], a[216:219], v[188:191], a[52:55]
    ds_read_b128 a[172:175], v4 offset:57344
    v_lshl_add_u32 v22, v22, 3, v24
    v_mfma_f32_16x16x32_bf16 a[56:59], a[216:219], v[196:199], a[56:59]
    v_exp_f32 v146, v146
    v_mfma_f32_16x16x32_bf16 a[56:59], a[220:223], v[200:203], a[56:59]
    v_cvt_pk_bf16_f32 v238, v144, v145
    v_and_b32 v24, 1, v19
    v_mfma_f32_16x16x32_bf16 a[60:63], a[220:223], v[208:211], a[60:63]
    v_exp_f32 v147, v147
    v_mfma_f32_16x16x32_bf16 a[60:63], a[216:219], v[204:207], a[60:63]
    buffer_load_dwordx4 v18, s[12:15], s29 offen offset:1024 lds
    v_smfmac_f32_16x16x64_bf16 a[228:231], v[244:247], v[188:195], v248
    s_waitcnt lgkmcnt(6)
    v_mfma_f32_16x16x32_bf16 v[140:143], a[144:147], v[68:71], v[108:111]
    v_exp_f32 v148, v148
    v_mfma_f32_16x16x32_bf16 v[140:143], a[148:151], v[72:75], v[140:143]
    ds_read_b64_tr_b16 a[208:209], v11 offset:57344
    v_cvt_pk_bf16_f32 v239, v146, v147
    v_mfma_f32_16x16x32_bf16 v[140:143], a[152:155], v[76:79], v[140:143]
    v_exp_f32 v149, v149
    v_mfma_f32_16x16x32_bf16 v[140:143], a[156:159], v[80:83], v[140:143]
    ds_read_b64_tr_b16 a[210:211], v11 offset:61440
    v_lshl_add_u32 v22, v22, 1, v24
    v_mfma_f32_16x16x32_bf16 v[144:147], a[156:159], v[96:99], v[112:115]
    v_exp_f32 v150, v150
    v_mfma_f32_16x16x32_bf16 v[144:147], a[152:155], v[92:95], v[144:147]
    ds_read_b128 a[176:179], v1 offset:61440
    v_cvt_pk_bf16_f32 v216, v148, v149
    v_mfma_f32_16x16x32_bf16 v[144:147], a[148:151], v[88:91], v[144:147]
    v_exp_f32 v151, v151
    v_mfma_f32_16x16x32_bf16 v[144:147], a[144:147], v[84:87], v[144:147]
    ds_read_b64_tr_b16 a[212:213], v11 offset:0
    v_bfe_u32 v24, v19, 1, 1
    v_mfma_f32_16x16x32_bf16 a[64:67], a[192:195], v[180:183], a[64:67]
    v_exp_f32 v152, v152
    v_mfma_f32_16x16x32_bf16 a[64:67], a[196:199], v[184:187], a[64:67]
    ds_read_b64_tr_b16 a[214:215], v11 offset:4096
    v_cvt_pk_bf16_f32 v217, v150, v151
    v_mfma_f32_16x16x32_bf16 a[68:71], a[196:199], v[192:195], a[68:71]
    v_exp_f32 v153, v153
    v_mfma_f32_16x16x32_bf16 a[68:71], a[192:195], v[188:191], a[68:71]
    ds_read_b128 a[180:183], v2 offset:61440
    v_cvt_pk_bf16_f32 v224, v152, v153
    v_mfma_f32_16x16x32_bf16 a[72:75], a[192:195], v[196:199], a[72:75]
    v_exp_f32 v154, v154
    v_mfma_f32_16x16x32_bf16 a[72:75], a[196:199], v[200:203], a[72:75]
    buffer_load_dwordx4 v17, s[12:15], s29 offen offset:2048 lds
    v_mfma_f32_16x16x32_bf16 a[76:79], a[196:199], v[208:211], a[76:79]
    v_exp_f32 v155, v155
    v_mfma_f32_16x16x32_bf16 a[76:79], a[192:195], v[204:207], a[76:79]
    s_waitcnt lgkmcnt(6)
    v_mul_u32_u24 v24, 10240, v24
    v_lshl_add_u32 v22, v22, 3, v24
    v_mfma_f32_16x16x32_bf16 v[148:151], a[160:163], v[36:39], v[100:103]
    s_mul_i32 s42, s5, 2560
    v_exp_f32 v156, v156
    v_mfma_f32_16x16x32_bf16 v[148:151], a[164:167], v[40:43], v[148:151]
    s_add_u32 s42, s42, 65536
    ds_read_b64_tr_b16 a[216:217], v12 offset:57344
    v_cvt_pk_bf16_f32 v225, v154, v155
    v_mfma_f32_16x16x32_bf16 v[148:151], a[168:171], v[44:47], v[148:151]
    v_exp_f32 v157, v157
    v_mfma_f32_16x16x32_bf16 v[148:151], a[172:175], v[48:51], v[148:151]
    ds_read_b64_tr_b16 a[218:219], v12 offset:61440
    v_add_u32 v22, s42, v22
    v_mfma_f32_16x16x32_bf16 v[152:155], a[172:175], v[64:67], v[104:107]
    s_mov_b32 s42, 65536
    v_exp_f32 v158, v158
    v_mfma_f32_16x16x32_bf16 v[152:155], a[168:171], v[60:63], v[152:155]
    ds_read_b128 a[184:187], v3 offset:61440
    v_cvt_pk_bf16_f32 v232, v156, v157
    v_mfma_f32_16x16x32_bf16 v[152:155], a[164:167], v[56:59], v[152:155]
    v_exp_f32 v159, v159
    v_mfma_f32_16x16x32_bf16 v[152:155], a[160:163], v[52:55], v[152:155]
    ds_read_b64_tr_b16 a[220:221], v12 offset:0
    v_lshl_add_u32 v23, v19, 4, s42
    v_mfma_f32_16x16x32_bf16 a[80:83], a[200:203], v[180:183], a[80:83]
    v_exp_f32 v160, v160
    v_mfma_f32_16x16x32_bf16 a[80:83], a[204:207], v[184:187], a[80:83]
    ds_read_b64_tr_b16 a[222:223], v12 offset:4096
    v_cvt_pk_bf16_f32 v233, v158, v159
    v_mfma_f32_16x16x32_bf16 a[84:87], a[204:207], v[192:195], a[84:87]
    v_exp_f32 v161, v161
    v_mfma_f32_16x16x32_bf16 a[84:87], a[200:203], v[188:191], a[84:87]
    ds_read_b128 a[188:191], v4 offset:61440
    v_mfma_f32_16x16x32_bf16 a[88:91], a[200:203], v[196:199], a[88:91]
    v_exp_f32 v162, v162
    v_mfma_f32_16x16x32_bf16 a[88:91], a[204:207], v[200:203], a[88:91]
    v_cvt_pk_bf16_f32 v240, v160, v161
    v_mfma_f32_16x16x32_bf16 a[92:95], a[204:207], v[208:211], a[92:95]
    v_exp_f32 v163, v163
    v_mfma_f32_16x16x32_bf16 a[92:95], a[200:203], v[204:207], a[92:95]
    buffer_load_dwordx4 v18, s[12:15], s29 offen offset:3072 lds
    v_smfmac_f32_16x16x64_bf16 a[232:235], v[244:247], v[196:203], v248
    s_waitcnt vmcnt(17) lgkmcnt(6)
    s_barrier
    s_add_u32 s29, s29, 16384
    v_mfma_f32_16x16x32_bf16 v[156:159], a[160:163], v[68:71], v[108:111]
    v_exp_f32 v164, v164
    v_mfma_f32_16x16x32_bf16 v[156:159], a[164:167], v[72:75], v[156:159]
    ds_read_b64_tr_b16 a[192:193], v5 offset:24576
    v_cvt_pk_bf16_f32 v241, v162, v163
    v_mfma_f32_16x16x32_bf16 v[156:159], a[168:171], v[76:79], v[156:159]
    v_exp_f32 v165, v165
    v_mfma_f32_16x16x32_bf16 v[156:159], a[172:175], v[80:83], v[156:159]
    ds_read_b64_tr_b16 a[194:195], v5 offset:28672
    v_mfma_f32_16x16x32_bf16 v[160:163], a[172:175], v[96:99], v[112:115]
    v_exp_f32 v166, v166
    v_mfma_f32_16x16x32_bf16 v[160:163], a[168:171], v[92:95], v[160:163]
    ds_read_b128 a[128:131], v1 offset:16384
    v_cvt_pk_bf16_f32 v218, v164, v165
    v_mfma_f32_16x16x32_bf16 v[160:163], a[164:167], v[88:91], v[160:163]
    v_exp_f32 v167, v167
    v_mfma_f32_16x16x32_bf16 v[160:163], a[160:163], v[84:87], v[160:163]
    ds_read_b64_tr_b16 a[196:197], v5 offset:49152
    v_mfma_f32_16x16x32_bf16 a[96:99], a[208:211], v[180:183], a[96:99]
    v_exp_f32 v168, v168
    v_mfma_f32_16x16x32_bf16 a[96:99], a[212:215], v[184:187], a[96:99]
    ds_read_b64_tr_b16 a[198:199], v5 offset:53248
    v_cvt_pk_bf16_f32 v219, v166, v167
    v_mfma_f32_16x16x32_bf16 a[100:103], a[212:215], v[192:195], a[100:103]
    v_exp_f32 v169, v169
    v_mfma_f32_16x16x32_bf16 a[100:103], a[208:211], v[188:191], a[100:103]
    ds_read_b128 a[132:135], v2 offset:16384
    v_cvt_pk_bf16_f32 v226, v168, v169
    v_mfma_f32_16x16x32_bf16 a[104:107], a[208:211], v[196:199], a[104:107]
    s_add_u32 m0, s34, 0
    v_exp_f32 v170, v170
    v_mfma_f32_16x16x32_bf16 a[104:107], a[212:215], v[200:203], a[104:107]
    buffer_load_dwordx4 v13, s[8:11], s28 offen offset:0 lds
    v_mfma_f32_16x16x32_bf16 a[108:111], a[212:215], v[208:211], a[108:111]
    v_exp_f32 v171, v171
    v_mfma_f32_16x16x32_bf16 a[108:111], a[208:211], v[204:207], a[108:111]
    s_waitcnt lgkmcnt(6)
    v_mfma_f32_16x16x32_bf16 v[164:167], a[176:179], v[36:39], v[100:103]
    v_exp_f32 v172, v172
    v_mfma_f32_16x16x32_bf16 v[164:167], a[180:183], v[40:43], v[164:167]
    ds_read_b64_tr_b16 a[200:201], v6 offset:24576
    v_cvt_pk_bf16_f32 v227, v170, v171
    v_mfma_f32_16x16x32_bf16 v[164:167], a[184:187], v[44:47], v[164:167]
    v_exp_f32 v173, v173
    v_mfma_f32_16x16x32_bf16 v[164:167], a[188:191], v[48:51], v[164:167]
    ds_read_b64_tr_b16 a[202:203], v6 offset:28672
    ds_read_b64_tr_b16 v[24:25], v22 offset:0
    ds_read_b64_tr_b16 v[26:27], v22 offset:64
    v_mfma_f32_16x16x32_bf16 v[168:171], a[188:191], v[64:67], v[104:107]
    v_exp_f32 v174, v174
    v_mfma_f32_16x16x32_bf16 v[168:171], a[184:187], v[60:63], v[168:171]
    ds_read_b128 a[136:139], v3 offset:16384
    v_cvt_pk_bf16_f32 v234, v172, v173
    v_mfma_f32_16x16x32_bf16 v[168:171], a[180:183], v[56:59], v[168:171]
    v_exp_f32 v175, v175
    v_mfma_f32_16x16x32_bf16 v[168:171], a[176:179], v[52:55], v[168:171]
    ds_read_b64_tr_b16 a[204:205], v6 offset:49152
    ds_read_b64_tr_b16 v[28:29], v22 offset:512
    ds_read_b64_tr_b16 v[30:31], v22 offset:576
    v_mfma_f32_16x16x32_bf16 a[112:115], a[216:219], v[180:183], a[112:115]
    v_exp_f32 v176, v176
    v_mfma_f32_16x16x32_bf16 a[112:115], a[220:223], v[184:187], a[112:115]
    ds_read_b64_tr_b16 a[206:207], v6 offset:53248
    v_cvt_pk_bf16_f32 v235, v174, v175
    v_mfma_f32_16x16x32_bf16 a[116:119], a[220:223], v[192:195], a[116:119]
    v_exp_f32 v177, v177
    v_mfma_f32_16x16x32_bf16 a[116:119], a[216:219], v[188:191], a[116:119]
    ds_read_b128 a[140:143], v4 offset:16384
    v_mfma_f32_16x16x32_bf16 a[120:123], a[216:219], v[196:199], a[120:123]
    v_exp_f32 v178, v178
    v_mfma_f32_16x16x32_bf16 a[120:123], a[220:223], v[200:203], a[120:123]
    v_cvt_pk_bf16_f32 v242, v176, v177
    v_mfma_f32_16x16x32_bf16 a[124:127], a[220:223], v[208:211], a[124:127]
    v_exp_f32 v179, v179
    v_mfma_f32_16x16x32_bf16 a[124:127], a[216:219], v[204:207], a[124:127]
    buffer_load_dwordx4 v14, s[8:11], s28 offen offset:1024 lds
    v_smfmac_f32_16x16x64_bf16 a[236:239], v[244:247], v[204:211], v248
    s_waitcnt lgkmcnt(6)
    v_mfma_f32_16x16x32_bf16 v[172:175], a[176:179], v[68:71], v[108:111]
    v_exp_f32 v116, v116
    v_mfma_f32_16x16x32_bf16 v[172:175], a[180:183], v[72:75], v[172:175]
    ds_read_b64_tr_b16 a[208:209], v7 offset:24576
    v_cvt_pk_bf16_f32 v243, v178, v179
    v_mfma_f32_16x16x32_bf16 v[172:175], a[184:187], v[76:79], v[172:175]
    v_exp_f32 v117, v117
    v_mfma_f32_16x16x32_bf16 v[172:175], a[188:191], v[80:83], v[172:175]
    ds_read_b64_tr_b16 a[210:211], v7 offset:28672
    v_mfma_f32_16x16x32_bf16 v[176:179], a[188:191], v[96:99], v[112:115]
    v_exp_f32 v118, v118
    v_mfma_f32_16x16x32_bf16 v[176:179], a[184:187], v[92:95], v[176:179]
    ds_read_b128 a[144:147], v1 offset:20480
    v_cvt_pk_bf16_f32 v180, v116, v117
    v_mfma_f32_16x16x32_bf16 v[176:179], a[180:183], v[88:91], v[176:179]
    v_exp_f32 v119, v119
    v_mfma_f32_16x16x32_bf16 v[176:179], a[176:179], v[84:87], v[176:179]
    ds_read_b64_tr_b16 a[212:213], v7 offset:49152
    s_waitcnt vmcnt(6)
    s_waitcnt lgkmcnt(6)
    v_mfma_f32_16x16x32_bf16 v[32:35], v[24:27], a[240:243], 0
    v_mfma_f32_16x16x32_bf16 v[32:35], v[28:31], a[244:247], v[32:35]
    ds_read_b64_tr_b16 v[24:25], v22 offset:1024
    ds_read_b64_tr_b16 v[26:27], v22 offset:1088
    ds_read_b64_tr_b16 v[28:29], v22 offset:1536
    ds_read_b64_tr_b16 v[30:31], v22 offset:1600
    v_mfma_f32_16x16x32_bf16 a[0:3], a[192:195], v[212:215], a[0:3]
    v_exp_f32 v120, v120
    v_mfma_f32_16x16x32_bf16 a[0:3], a[196:199], v[216:219], a[0:3]
    ds_read_b64_tr_b16 a[214:215], v7 offset:53248
    v_cvt_pk_bf16_f32 v181, v118, v119
    v_mfma_f32_16x16x32_bf16 a[4:7], a[196:199], v[224:227], a[4:7]
    v_exp_f32 v121, v121
    v_mfma_f32_16x16x32_bf16 a[4:7], a[192:195], v[220:223], a[4:7]
    ds_read_b128 a[148:151], v2 offset:20480
    v_cvt_pk_bf16_f32 v188, v120, v121
    v_mfma_f32_16x16x32_bf16 a[8:11], a[192:195], v[228:231], a[8:11]
    v_exp_f32 v122, v122
    v_mfma_f32_16x16x32_bf16 a[8:11], a[196:199], v[232:235], a[8:11]
    buffer_load_dwordx4 v15, s[8:11], s28 offen offset:2048 lds
    v_mfma_f32_16x16x32_bf16 a[12:15], a[196:199], v[240:243], a[12:15]
    v_exp_f32 v123, v123
    v_mfma_f32_16x16x32_bf16 a[12:15], a[192:195], v[236:239], a[12:15]
    s_waitcnt lgkmcnt(6)
    v_mfma_f32_16x16x32_bf16 v[116:119], a[128:131], v[36:39], v[100:103]
    v_exp_f32 v124, v124
    v_mfma_f32_16x16x32_bf16 v[116:119], a[132:135], v[40:43], v[116:119]
    ds_read_b64_tr_b16 a[216:217], v8 offset:24576
    v_cvt_pk_bf16_f32 v189, v122, v123
    v_mfma_f32_16x16x32_bf16 v[116:119], a[136:139], v[44:47], v[116:119]
    v_exp_f32 v125, v125
    v_mfma_f32_16x16x32_bf16 v[116:119], a[140:143], v[48:51], v[116:119]
    ds_read_b64_tr_b16 a[218:219], v8 offset:28672
    v_mfma_f32_16x16x32_bf16 v[120:123], a[140:143], v[64:67], v[104:107]
    v_exp_f32 v126, v126
    v_mfma_f32_16x16x32_bf16 v[120:123], a[136:139], v[60:63], v[120:123]
    ds_read_b128 a[152:155], v3 offset:20480
    v_cvt_pk_bf16_f32 v196, v124, v125
    v_mfma_f32_16x16x32_bf16 v[120:123], a[132:135], v[56:59], v[120:123]
    v_exp_f32 v127, v127
    v_mfma_f32_16x16x32_bf16 v[120:123], a[128:131], v[52:55], v[120:123]
    ds_read_b64_tr_b16 a[220:221], v8 offset:49152
    s_waitcnt lgkmcnt(6)
    v_mfma_f32_16x16x32_bf16 v[32:35], v[24:27], a[248:251], v[32:35]
    v_mfma_f32_16x16x32_bf16 v[32:35], v[28:31], a[252:255], v[32:35]
    ds_read_b64_tr_b16 v[24:25], v22 offset:2048
    ds_read_b64_tr_b16 v[26:27], v22 offset:2112
    v_mfma_f32_16x16x32_bf16 a[16:19], a[200:203], v[212:215], a[16:19]
    v_exp_f32 v128, v128
    v_mfma_f32_16x16x32_bf16 a[16:19], a[204:207], v[216:219], a[16:19]
    ds_read_b64_tr_b16 a[222:223], v8 offset:53248
    v_cvt_pk_bf16_f32 v197, v126, v127
    v_mfma_f32_16x16x32_bf16 a[20:23], a[204:207], v[224:227], a[20:23]
    v_exp_f32 v129, v129
    v_mfma_f32_16x16x32_bf16 a[20:23], a[200:203], v[220:223], a[20:23]
    ds_read_b128 a[156:159], v4 offset:20480
    v_mfma_f32_16x16x32_bf16 a[24:27], a[200:203], v[228:231], a[24:27]
    v_exp_f32 v130, v130
    v_mfma_f32_16x16x32_bf16 a[24:27], a[204:207], v[232:235], a[24:27]
    v_cvt_pk_bf16_f32 v204, v128, v129
    v_mfma_f32_16x16x32_bf16 a[28:31], a[204:207], v[240:243], a[28:31]
    v_exp_f32 v131, v131
    v_mfma_f32_16x16x32_bf16 a[28:31], a[200:203], v[236:239], a[28:31]
    buffer_load_dwordx4 v16, s[8:11], s28 offen offset:3072 lds
    v_smfmac_f32_16x16x64_bf16 a[224:227], v[244:247], v[212:219], v248
    s_waitcnt lgkmcnt(6)
    v_mfma_f32_16x16x32_bf16 v[124:127], a[128:131], v[68:71], v[108:111]
    v_exp_f32 v132, v132
    v_mfma_f32_16x16x32_bf16 v[124:127], a[132:135], v[72:75], v[124:127]
    ds_read_b64_tr_b16 a[192:193], v9 offset:24576
    v_cvt_pk_bf16_f32 v205, v130, v131
    v_mfma_f32_16x16x32_bf16 v[124:127], a[136:139], v[76:79], v[124:127]
    v_exp_f32 v133, v133
    v_mfma_f32_16x16x32_bf16 v[124:127], a[140:143], v[80:83], v[124:127]
    ds_read_b64_tr_b16 a[194:195], v9 offset:28672
    v_mfma_f32_16x16x32_bf16 v[128:131], a[140:143], v[96:99], v[112:115]
    v_exp_f32 v134, v134
    v_mfma_f32_16x16x32_bf16 v[128:131], a[136:139], v[92:95], v[128:131]
    ds_read_b128 a[160:163], v1 offset:24576
    v_cvt_pk_bf16_f32 v182, v132, v133
    v_mfma_f32_16x16x32_bf16 v[128:131], a[132:135], v[88:91], v[128:131]
    v_exp_f32 v135, v135
    v_mfma_f32_16x16x32_bf16 v[128:131], a[128:131], v[84:87], v[128:131]
    ds_read_b64_tr_b16 a[196:197], v9 offset:49152
    s_waitcnt lgkmcnt(6)
    v_mfma_f32_16x16x32_bf16 v[32:35], v[24:27], v[252:255], v[32:35]
    s_mul_i32 s40, s5, 2560
    v_add_u32 v28, s40, v23
    v_mfma_f32_16x16x32_bf16 a[32:35], a[208:211], v[212:215], a[32:35]
    v_exp_f32 v136, v136
    v_mfma_f32_16x16x32_bf16 a[32:35], a[212:215], v[216:219], a[32:35]
    ds_read_b64_tr_b16 a[198:199], v9 offset:53248
    v_cvt_pk_bf16_f32 v183, v134, v135
    v_mfma_f32_16x16x32_bf16 a[36:39], a[212:215], v[224:227], a[36:39]
    v_exp_f32 v137, v137
    v_mfma_f32_16x16x32_bf16 a[36:39], a[208:211], v[220:223], a[36:39]
    ds_read_b128 a[164:167], v2 offset:24576
    v_cvt_pk_bf16_f32 v190, v136, v137
    v_mfma_f32_16x16x32_bf16 a[40:43], a[208:211], v[228:231], a[40:43]
    s_add_u32 s28, s28, 16384
    s_mov_b32 m0, s31
    v_exp_f32 v138, v138
    v_mfma_f32_16x16x32_bf16 a[40:43], a[212:215], v[232:235], a[40:43]
    buffer_load_dwordx4 v17, s[12:15], s29 offen offset:0 lds
    v_mfma_f32_16x16x32_bf16 a[44:47], a[212:215], v[240:243], a[44:47]
    v_exp_f32 v139, v139
    v_mfma_f32_16x16x32_bf16 a[44:47], a[208:211], v[236:239], a[44:47]
    s_waitcnt lgkmcnt(6)
    v_mfma_f32_16x16x32_bf16 v[132:135], a[144:147], v[36:39], v[100:103]
    v_exp_f32 v140, v140
    v_mfma_f32_16x16x32_bf16 v[132:135], a[148:151], v[40:43], v[132:135]
    ds_read_b64_tr_b16 a[200:201], v10 offset:24576
    v_cvt_pk_bf16_f32 v191, v138, v139
    v_mfma_f32_16x16x32_bf16 v[132:135], a[152:155], v[44:47], v[132:135]
    v_exp_f32 v141, v141
    v_mfma_f32_16x16x32_bf16 v[132:135], a[156:159], v[48:51], v[132:135]
    ds_read_b64_tr_b16 a[202:203], v10 offset:28672
    ds_write_b128 v28, v[32:35]
    v_mfma_f32_16x16x32_bf16 v[136:139], a[156:159], v[64:67], v[104:107]
    v_exp_f32 v142, v142
    v_mfma_f32_16x16x32_bf16 v[136:139], a[152:155], v[60:63], v[136:139]
    ds_read_b128 a[168:171], v3 offset:24576
    v_cvt_pk_bf16_f32 v198, v140, v141
    v_mfma_f32_16x16x32_bf16 v[136:139], a[148:151], v[56:59], v[136:139]
    v_exp_f32 v143, v143
    v_mfma_f32_16x16x32_bf16 v[136:139], a[144:147], v[52:55], v[136:139]
    ds_read_b64_tr_b16 a[204:205], v10 offset:49152
    v_bfe_u32 v22, v19, 2, 3
    v_mul_u32_u24 v22, 160, v22
    v_and_b32 v0, 3, v19
    v_add_u32 v22, v22, v0
    v_mfma_f32_16x16x32_bf16 a[48:51], a[216:219], v[212:215], a[48:51]
    v_exp_f32 v144, v144
    v_mfma_f32_16x16x32_bf16 a[48:51], a[220:223], v[216:219], a[48:51]
    ds_read_b64_tr_b16 a[206:207], v10 offset:53248
    v_cvt_pk_bf16_f32 v199, v142, v143
    v_mfma_f32_16x16x32_bf16 a[52:55], a[220:223], v[224:227], a[52:55]
    v_exp_f32 v145, v145
    v_mfma_f32_16x16x32_bf16 a[52:55], a[216:219], v[220:223], a[52:55]
    ds_read_b128 a[172:175], v4 offset:24576
    v_mfma_f32_16x16x32_bf16 a[56:59], a[216:219], v[228:231], a[56:59]
    v_exp_f32 v146, v146
    v_mfma_f32_16x16x32_bf16 a[56:59], a[220:223], v[232:235], a[56:59]
    v_cvt_pk_bf16_f32 v206, v144, v145
    v_mfma_f32_16x16x32_bf16 a[60:63], a[220:223], v[240:243], a[60:63]
    v_exp_f32 v147, v147
    v_mfma_f32_16x16x32_bf16 a[60:63], a[216:219], v[236:239], a[60:63]
    buffer_load_dwordx4 v18, s[12:15], s29 offen offset:1024 lds
    v_smfmac_f32_16x16x64_bf16 a[228:231], v[244:247], v[220:227], v248
    s_waitcnt lgkmcnt(6)
    v_mfma_f32_16x16x32_bf16 v[140:143], a[144:147], v[68:71], v[108:111]
    v_exp_f32 v148, v148
    v_mfma_f32_16x16x32_bf16 v[140:143], a[148:151], v[72:75], v[140:143]
    ds_read_b64_tr_b16 a[208:209], v11 offset:24576
    v_cvt_pk_bf16_f32 v207, v146, v147
    v_mfma_f32_16x16x32_bf16 v[140:143], a[152:155], v[76:79], v[140:143]
    v_exp_f32 v149, v149
    v_mfma_f32_16x16x32_bf16 v[140:143], a[156:159], v[80:83], v[140:143]
    ds_read_b64_tr_b16 a[210:211], v11 offset:28672
    s_mul_i32 s42, s5, 320
    s_add_u32 s42, s42, 86016
    v_lshl_add_u32 v22, v22, 3, s42
    v_mfma_f32_16x16x32_bf16 v[144:147], a[156:159], v[96:99], v[112:115]
    v_exp_f32 v150, v150
    v_mfma_f32_16x16x32_bf16 v[144:147], a[152:155], v[92:95], v[144:147]
    ds_read_b128 a[176:179], v1 offset:28672
    v_cvt_pk_bf16_f32 v184, v148, v149
    v_mfma_f32_16x16x32_bf16 v[144:147], a[148:151], v[88:91], v[144:147]
    v_exp_f32 v151, v151
    v_mfma_f32_16x16x32_bf16 v[144:147], a[144:147], v[84:87], v[144:147]
    ds_read_b64_tr_b16 a[212:213], v11 offset:49152
    v_mfma_f32_16x16x32_bf16 a[64:67], a[192:195], v[212:215], a[64:67]
    v_exp_f32 v152, v152
    v_mfma_f32_16x16x32_bf16 a[64:67], a[196:199], v[216:219], a[64:67]
    ds_read_b64_tr_b16 a[214:215], v11 offset:53248
    v_cvt_pk_bf16_f32 v185, v150, v151
    v_mfma_f32_16x16x32_bf16 a[68:71], a[196:199], v[224:227], a[68:71]
    v_exp_f32 v153, v153
    v_mfma_f32_16x16x32_bf16 a[68:71], a[192:195], v[220:223], a[68:71]
    ds_read_b128 a[180:183], v2 offset:28672
    v_cvt_pk_bf16_f32 v192, v152, v153
    v_mfma_f32_16x16x32_bf16 a[72:75], a[192:195], v[228:231], a[72:75]
    v_exp_f32 v154, v154
    v_mfma_f32_16x16x32_bf16 a[72:75], a[196:199], v[232:235], a[72:75]
    buffer_load_dwordx4 v17, s[12:15], s29 offen offset:2048 lds
    v_mfma_f32_16x16x32_bf16 a[76:79], a[196:199], v[240:243], a[76:79]
    v_exp_f32 v155, v155
    v_mfma_f32_16x16x32_bf16 a[76:79], a[192:195], v[236:239], a[76:79]
    s_waitcnt lgkmcnt(6)
    v_mfma_f32_16x16x32_bf16 v[148:151], a[160:163], v[36:39], v[100:103]
    v_exp_f32 v156, v156
    v_mfma_f32_16x16x32_bf16 v[148:151], a[164:167], v[40:43], v[148:151]
    ds_read_b64_tr_b16 a[216:217], v12 offset:24576
    v_cvt_pk_bf16_f32 v193, v154, v155
    v_mfma_f32_16x16x32_bf16 v[148:151], a[168:171], v[44:47], v[148:151]
    v_exp_f32 v157, v157
    v_mfma_f32_16x16x32_bf16 v[148:151], a[172:175], v[48:51], v[148:151]
    ds_read_b64_tr_b16 a[218:219], v12 offset:28672
    v_mfma_f32_16x16x32_bf16 v[152:155], a[172:175], v[64:67], v[104:107]
    v_exp_f32 v158, v158
    v_mfma_f32_16x16x32_bf16 v[152:155], a[168:171], v[60:63], v[152:155]
    ds_read_b128 a[184:187], v3 offset:28672
    v_cvt_pk_bf16_f32 v200, v156, v157
    v_mfma_f32_16x16x32_bf16 v[152:155], a[164:167], v[56:59], v[152:155]
    v_exp_f32 v159, v159
    v_mfma_f32_16x16x32_bf16 v[152:155], a[160:163], v[52:55], v[152:155]
    ds_read_b64_tr_b16 a[220:221], v12 offset:49152
    v_mfma_f32_16x16x32_bf16 a[80:83], a[200:203], v[212:215], a[80:83]
    v_exp_f32 v160, v160
    v_mfma_f32_16x16x32_bf16 a[80:83], a[204:207], v[216:219], a[80:83]
    ds_read_b64_tr_b16 a[222:223], v12 offset:53248
    v_cvt_pk_bf16_f32 v201, v158, v159
    v_mfma_f32_16x16x32_bf16 a[84:87], a[204:207], v[224:227], a[84:87]
    v_exp_f32 v161, v161
    v_mfma_f32_16x16x32_bf16 a[84:87], a[200:203], v[220:223], a[84:87]
    ds_read_b128 a[188:191], v4 offset:28672
    v_mfma_f32_16x16x32_bf16 a[88:91], a[200:203], v[228:231], a[88:91]
    v_exp_f32 v162, v162
    v_mfma_f32_16x16x32_bf16 a[88:91], a[204:207], v[232:235], a[88:91]
    v_cvt_pk_bf16_f32 v208, v160, v161
    v_mfma_f32_16x16x32_bf16 a[92:95], a[204:207], v[240:243], a[92:95]
    v_exp_f32 v163, v163
    v_mfma_f32_16x16x32_bf16 a[92:95], a[200:203], v[236:239], a[92:95]
    buffer_load_dwordx4 v18, s[12:15], s29 offen offset:3072 lds
    v_smfmac_f32_16x16x64_bf16 a[232:235], v[244:247], v[228:235], v248
    s_waitcnt vmcnt(8) lgkmcnt(6)
    s_barrier
    s_add_u32 s29, s29, 16384
    v_mfma_f32_16x16x32_bf16 v[156:159], a[160:163], v[68:71], v[108:111]
    v_exp_f32 v164, v164
    v_mfma_f32_16x16x32_bf16 v[156:159], a[164:167], v[72:75], v[156:159]
    ds_read_b64_tr_b16 a[192:193], v5 offset:8192
    v_cvt_pk_bf16_f32 v209, v162, v163
    v_mfma_f32_16x16x32_bf16 v[156:159], a[168:171], v[76:79], v[156:159]
    v_exp_f32 v165, v165
    v_mfma_f32_16x16x32_bf16 v[156:159], a[172:175], v[80:83], v[156:159]
    ds_read_b64_tr_b16 a[194:195], v5 offset:12288
    ds_read_b128 v[24:27], v23 offset:0
    v_mfma_f32_16x16x32_bf16 v[160:163], a[172:175], v[96:99], v[112:115]
    v_exp_f32 v166, v166
    v_mfma_f32_16x16x32_bf16 v[160:163], a[168:171], v[92:95], v[160:163]
    ds_read_b128 a[128:131], v1 offset:32768
    v_cvt_pk_bf16_f32 v186, v164, v165
    ds_read_b128 v[28:31], v23 offset:2560
    v_mfma_f32_16x16x32_bf16 v[160:163], a[164:167], v[88:91], v[160:163]
    v_exp_f32 v167, v167
    v_mfma_f32_16x16x32_bf16 v[160:163], a[160:163], v[84:87], v[160:163]
    ds_read_b64_tr_b16 a[196:197], v5 offset:32768
    ds_read_b128 v[32:35], v23 offset:5120
    v_mfma_f32_16x16x32_bf16 a[96:99], a[208:211], v[212:215], a[96:99]
    v_exp_f32 v168, v168
    v_mfma_f32_16x16x32_bf16 a[96:99], a[212:215], v[216:219], a[96:99]
    ds_read_b64_tr_b16 a[198:199], v5 offset:36864
    v_cvt_pk_bf16_f32 v187, v166, v167
    ds_read_b128 v[252:255], v23 offset:7680
    v_mfma_f32_16x16x32_bf16 a[100:103], a[212:215], v[224:227], a[100:103]
    v_exp_f32 v169, v169
    v_mfma_f32_16x16x32_bf16 a[100:103], a[208:211], v[220:223], a[100:103]
    ds_read_b128 a[132:135], v2 offset:32768
    v_cvt_pk_bf16_f32 v194, v168, v169
    v_mfma_f32_16x16x32_bf16 a[104:107], a[208:211], v[228:231], a[104:107]
    s_mov_b32 m0, s32
    v_exp_f32 v170, v170
    v_mfma_f32_16x16x32_bf16 a[104:107], a[212:215], v[232:235], a[104:107]
    buffer_load_dwordx4 v17, s[12:15], s29 offen offset:0 lds
    v_mfma_f32_16x16x32_bf16 a[108:111], a[212:215], v[240:243], a[108:111]
    v_exp_f32 v171, v171
    v_mfma_f32_16x16x32_bf16 a[108:111], a[208:211], v[236:239], a[108:111]
    s_waitcnt lgkmcnt(6)
    v_mfma_f32_16x16x32_bf16 v[164:167], a[176:179], v[36:39], v[100:103]
    v_exp_f32 v172, v172
    v_mfma_f32_16x16x32_bf16 v[164:167], a[180:183], v[40:43], v[164:167]
    ds_read_b64_tr_b16 a[200:201], v6 offset:8192
    v_cvt_pk_bf16_f32 v195, v170, v171
    v_mfma_f32_16x16x32_bf16 v[164:167], a[184:187], v[44:47], v[164:167]
    v_exp_f32 v173, v173
    v_mfma_f32_16x16x32_bf16 v[164:167], a[188:191], v[48:51], v[164:167]
    ds_read_b64_tr_b16 a[202:203], v6 offset:12288
    ds_read_b64_tr_b16 a[240:241], v22 offset:0
    ds_read_b64_tr_b16 a[242:243], v22 offset:32
    v_mfma_f32_16x16x32_bf16 v[168:171], a[188:191], v[64:67], v[104:107]
    v_exp_f32 v174, v174
    v_mfma_f32_16x16x32_bf16 v[168:171], a[184:187], v[60:63], v[168:171]
    ds_read_b128 a[136:139], v3 offset:32768
    v_cvt_pk_bf16_f32 v202, v172, v173
    ds_read_b64_tr_b16 a[244:245], v22 offset:64
    ds_read_b64_tr_b16 a[246:247], v22 offset:96
    v_mfma_f32_16x16x32_bf16 v[168:171], a[180:183], v[56:59], v[168:171]
    v_exp_f32 v175, v175
    v_mfma_f32_16x16x32_bf16 v[168:171], a[176:179], v[52:55], v[168:171]
    ds_read_b64_tr_b16 a[204:205], v6 offset:32768
    ds_read_b64_tr_b16 a[248:249], v22 offset:128
    ds_read_b64_tr_b16 a[250:251], v22 offset:160
    v_mfma_f32_16x16x32_bf16 a[112:115], a[216:219], v[212:215], a[112:115]
    v_exp_f32 v176, v176
    v_mfma_f32_16x16x32_bf16 a[112:115], a[220:223], v[216:219], a[112:115]
    ds_read_b64_tr_b16 a[206:207], v6 offset:36864
    v_cvt_pk_bf16_f32 v203, v174, v175
    ds_read_b64_tr_b16 a[252:253], v22 offset:192
    ds_read_b64_tr_b16 a[254:255], v22 offset:224
    v_mfma_f32_16x16x32_bf16 a[116:119], a[220:223], v[224:227], a[116:119]
    v_exp_f32 v177, v177
    v_mfma_f32_16x16x32_bf16 a[116:119], a[216:219], v[220:223], a[116:119]
    ds_read_b128 a[140:143], v4 offset:32768
    v_mfma_f32_16x16x32_bf16 a[120:123], a[216:219], v[228:231], a[120:123]
    v_exp_f32 v178, v178
    v_mfma_f32_16x16x32_bf16 a[120:123], a[220:223], v[232:235], a[120:123]
    v_cvt_pk_bf16_f32 v210, v176, v177
    v_mfma_f32_16x16x32_bf16 a[124:127], a[220:223], v[240:243], a[124:127]
    v_exp_f32 v179, v179
    v_mfma_f32_16x16x32_bf16 a[124:127], a[216:219], v[236:239], a[124:127]
    buffer_load_dwordx4 v18, s[12:15], s29 offen offset:1024 lds
    v_smfmac_f32_16x16x64_bf16 a[236:239], v[244:247], v[236:243], v248
    s_waitcnt lgkmcnt(6)
    v_mfma_f32_16x16x32_bf16 v[172:175], a[176:179], v[68:71], v[108:111]
    v_exp_f32 v116, v116
    v_add_f32 v24, v24, v28
    v_mfma_f32_16x16x32_bf16 v[172:175], a[180:183], v[72:75], v[172:175]
    ds_read_b64_tr_b16 a[208:209], v7 offset:8192
    v_cvt_pk_bf16_f32 v211, v178, v179
    v_add_f32 v25, v25, v29
    v_mfma_f32_16x16x32_bf16 v[172:175], a[184:187], v[76:79], v[172:175]
    v_exp_f32 v117, v117
    v_add_f32 v26, v26, v30
    v_mfma_f32_16x16x32_bf16 v[172:175], a[188:191], v[80:83], v[172:175]
    ds_read_b64_tr_b16 a[210:211], v7 offset:12288
    v_add_f32 v27, v27, v31
    v_add_f32 v24, v24, v32
    v_mfma_f32_16x16x32_bf16 v[176:179], a[188:191], v[96:99], v[112:115]
    v_exp_f32 v118, v118
    v_add_f32 v25, v25, v33
    v_mfma_f32_16x16x32_bf16 v[176:179], a[184:187], v[92:95], v[176:179]
    ds_read_b128 a[144:147], v1 offset:36864
    v_cvt_pk_bf16_f32 v212, v116, v117
    v_add_f32 v26, v26, v34
    v_mfma_f32_16x16x32_bf16 v[176:179], a[180:183], v[88:91], v[176:179]
    v_exp_f32 v119, v119
    v_add_f32 v27, v27, v35
    v_add_f32 v24, v24, v252
    v_mfma_f32_16x16x32_bf16 v[176:179], a[176:179], v[84:87], v[176:179]
    ds_read_b64_tr_b16 a[212:213], v7 offset:32768
    v_add_f32 v25, v25, v253
    v_mfma_f32_16x16x32_bf16 a[0:3], a[192:195], v[180:183], a[0:3]
    v_exp_f32 v120, v120
    v_add_f32 v26, v26, v254
    v_mfma_f32_16x16x32_bf16 a[0:3], a[196:199], v[184:187], a[0:3]
    ds_read_b64_tr_b16 a[214:215], v7 offset:36864
    v_cvt_pk_bf16_f32 v213, v118, v119
    v_add_f32 v27, v27, v255
    v_mov_b32_dpp v28, v24 row_newbcast:8 row_mask:0xf bank_mask:0xf
    v_mfma_f32_16x16x32_bf16 a[4:7], a[196:199], v[192:195], a[4:7]
    v_exp_f32 v121, v121
    v_mov_b32_dpp v29, v25 row_newbcast:8 row_mask:0xf bank_mask:0xf
    v_mfma_f32_16x16x32_bf16 a[4:7], a[192:195], v[188:191], a[4:7]
    ds_read_b128 a[148:151], v2 offset:36864
    v_cvt_pk_bf16_f32 v220, v120, v121
    v_mov_b32_dpp v30, v26 row_newbcast:8 row_mask:0xf bank_mask:0xf
    v_mfma_f32_16x16x32_bf16 a[8:11], a[192:195], v[196:199], a[8:11]
    v_exp_f32 v122, v122
    v_mov_b32_dpp v31, v27 row_newbcast:8 row_mask:0xf bank_mask:0xf
    v_fma_f32 v24, -v20, v28, v24
    v_mfma_f32_16x16x32_bf16 a[8:11], a[196:199], v[200:203], a[8:11]
    buffer_load_dwordx4 v17, s[12:15], s29 offen offset:2048 lds
    v_fma_f32 v25, -v20, v29, v25
    v_mfma_f32_16x16x32_bf16 a[12:15], a[196:199], v[208:211], a[12:15]
    v_exp_f32 v123, v123
    v_fma_f32 v26, -v20, v30, v26
    v_mfma_f32_16x16x32_bf16 a[12:15], a[192:195], v[204:207], a[12:15]
    s_waitcnt lgkmcnt(6)
    v_fma_f32 v27, -v20, v31, v27
    v_mul_f32 v24, v24, v21
    v_mfma_f32_16x16x32_bf16 v[116:119], a[128:131], v[36:39], v[100:103]
    v_exp_f32 v124, v124
    v_mul_f32 v25, v25, v21
    v_mfma_f32_16x16x32_bf16 v[116:119], a[132:135], v[40:43], v[116:119]
    ds_read_b64_tr_b16 a[216:217], v8 offset:8192
    v_cvt_pk_bf16_f32 v221, v122, v123
    v_mul_f32 v26, v26, v21
    v_mfma_f32_16x16x32_bf16 v[116:119], a[136:139], v[44:47], v[116:119]
    v_exp_f32 v125, v125
    v_mul_f32 v27, v27, v21
    v_mfma_f32_16x16x32_bf16 v[116:119], a[140:143], v[48:51], v[116:119]
    ds_read_b64_tr_b16 a[218:219], v8 offset:12288
    v_cvt_pk_bf16_f32 v28, v24, v25
    v_cvt_pk_bf16_f32 v29, v26, v27
    v_mfma_f32_16x16x32_bf16 v[120:123], a[140:143], v[64:67], v[104:107]
    v_exp_f32 v126, v126
    v_lshlrev_b32 v24, 16, v28
    v_mfma_f32_16x16x32_bf16 v[120:123], a[136:139], v[60:63], v[120:123]
    ds_read_b128 a[152:155], v3 offset:36864
    v_cvt_pk_bf16_f32 v228, v124, v125
    v_and_b32 v25, 0xffff0000, v28
    v_mfma_f32_16x16x32_bf16 v[120:123], a[132:135], v[56:59], v[120:123]
    v_exp_f32 v127, v127
    v_lshlrev_b32 v26, 16, v29
    v_and_b32 v27, 0xffff0000, v29
    v_mfma_f32_16x16x32_bf16 v[120:123], a[128:131], v[52:55], v[120:123]
    ds_read_b64_tr_b16 a[220:221], v8 offset:32768
    v_mov_b32 v32, v24
    v_mfma_f32_16x16x32_bf16 a[16:19], a[200:203], v[180:183], a[16:19]
    v_exp_f32 v128, v128
    v_mov_b32 v33, v25
    v_mfma_f32_16x16x32_bf16 a[16:19], a[204:207], v[184:187], a[16:19]
    ds_read_b64_tr_b16 a[222:223], v8 offset:36864
    v_cvt_pk_bf16_f32 v229, v126, v127
    v_mov_b32 v34, v26
    v_mov_b32 v35, v27
    v_mfma_f32_16x16x32_bf16 a[20:23], a[204:207], v[192:195], a[20:23]
    v_exp_f32 v129, v129
    v_permlane32_swap_b32 v24, v32
    v_mfma_f32_16x16x32_bf16 a[20:23], a[200:203], v[188:191], a[20:23]
    ds_read_b128 a[156:159], v4 offset:36864
    v_permlane32_swap_b32 v25, v33
    v_mfma_f32_16x16x32_bf16 a[24:27], a[200:203], v[196:199], a[24:27]
    v_exp_f32 v130, v130
    v_permlane32_swap_b32 v26, v34
    v_permlane32_swap_b32 v27, v35
    v_mfma_f32_16x16x32_bf16 a[24:27], a[204:207], v[200:203], a[24:27]
    v_cvt_pk_bf16_f32 v236, v128, v129
    v_mul_f32 v28, 0xbfb8aa3b, v24
    v_mfma_f32_16x16x32_bf16 a[28:31], a[204:207], v[208:211], a[28:31]
    v_exp_f32 v131, v131
    v_mul_f32 v29, 0xbfb8aa3b, v25
    v_mfma_f32_16x16x32_bf16 a[28:31], a[200:203], v[204:207], a[28:31]
    buffer_load_dwordx4 v18, s[12:15], s29 offen offset:3072 lds
    v_mul_f32 v30, 0xbfb8aa3b, v26
    v_mul_f32 v31, 0xbfb8aa3b, v27
    v_smfmac_f32_16x16x64_bf16 a[224:227], v[244:247], v[180:187], v248
    s_waitcnt lgkmcnt(6)
    s_add_u32 s29, s29, 16384
    v_mfma_f32_16x16x32_bf16 v[124:127], a[128:131], v[68:71], v[108:111]
    v_exp_f32 v132, v132
    v_exp_f32 v28, v28
    v_mfma_f32_16x16x32_bf16 v[124:127], a[132:135], v[72:75], v[124:127]
    ds_read_b64_tr_b16 a[192:193], v9 offset:8192
    v_cvt_pk_bf16_f32 v237, v130, v131
    v_exp_f32 v29, v29
    v_mfma_f32_16x16x32_bf16 v[124:127], a[136:139], v[76:79], v[124:127]
    v_exp_f32 v133, v133
    v_exp_f32 v30, v30
    v_mfma_f32_16x16x32_bf16 v[124:127], a[140:143], v[80:83], v[124:127]
    ds_read_b64_tr_b16 a[194:195], v9 offset:12288
    v_exp_f32 v31, v31
    v_add_f32 v28, 1.0, v28
    v_mfma_f32_16x16x32_bf16 v[128:131], a[140:143], v[96:99], v[112:115]
    v_exp_f32 v134, v134
    v_add_f32 v29, 1.0, v29
    v_mfma_f32_16x16x32_bf16 v[128:131], a[136:139], v[92:95], v[128:131]
    ds_read_b128 a[160:163], v1 offset:40960
    v_cvt_pk_bf16_f32 v214, v132, v133
    v_add_f32 v30, 1.0, v30
    v_mfma_f32_16x16x32_bf16 v[128:131], a[132:135], v[88:91], v[128:131]
    v_exp_f32 v135, v135
    v_add_f32 v31, 1.0, v31
    v_rcp_f32 v28, v28
    v_mfma_f32_16x16x32_bf16 v[128:131], a[128:131], v[84:87], v[128:131]
    ds_read_b64_tr_b16 a[196:197], v9 offset:32768
    v_rcp_f32 v29, v29
    v_mfma_f32_16x16x32_bf16 a[32:35], a[208:211], v[180:183], a[32:35]
    v_exp_f32 v136, v136
    v_rcp_f32 v30, v30
    v_mfma_f32_16x16x32_bf16 a[32:35], a[212:215], v[184:187], a[32:35]
    ds_read_b64_tr_b16 a[198:199], v9 offset:36864
    v_cvt_pk_bf16_f32 v215, v134, v135
    v_rcp_f32 v31, v31
    v_mul_f32 v24, v24, v28
    v_mfma_f32_16x16x32_bf16 a[36:39], a[212:215], v[192:195], a[36:39]
    v_exp_f32 v137, v137
    v_mul_f32 v25, v25, v29
    v_mfma_f32_16x16x32_bf16 a[36:39], a[208:211], v[188:191], a[36:39]
    ds_read_b128 a[164:167], v2 offset:40960
    v_mul_f32 v26, v26, v30
    v_mfma_f32_16x16x32_bf16 a[40:43], a[208:211], v[196:199], a[40:43]
    v_exp_f32 v138, v138
    v_mul_f32 v27, v27, v31
    v_cvt_pk_bf16_f32 v28, v24, v25
    v_mfma_f32_16x16x32_bf16 a[40:43], a[212:215], v[200:203], a[40:43]
    v_cvt_pk_bf16_f32 v222, v136, v137
    v_cvt_pk_bf16_f32 v29, v26, v27
    v_mfma_f32_16x16x32_bf16 a[44:47], a[212:215], v[208:211], a[44:47]
    v_exp_f32 v139, v139
    v_lshlrev_b32 v24, 16, v28
    v_mfma_f32_16x16x32_bf16 a[44:47], a[208:211], v[204:207], a[44:47]
    s_waitcnt lgkmcnt(6)
    v_and_b32 v25, 0xffff0000, v28
    v_lshlrev_b32 v26, 16, v29
    v_mfma_f32_16x16x32_bf16 v[132:135], a[144:147], v[36:39], v[100:103]
    v_exp_f32 v140, v140
    v_and_b32 v27, 0xffff0000, v29
    v_mfma_f32_16x16x32_bf16 v[132:135], a[148:151], v[40:43], v[132:135]
    ds_read_b64_tr_b16 a[200:201], v10 offset:8192
    v_cvt_pk_bf16_f32 v223, v138, v139
    v_mul_f32 v24, v24, v32
    v_mfma_f32_16x16x32_bf16 v[132:135], a[152:155], v[44:47], v[132:135]
    v_exp_f32 v141, v141
    v_mul_f32 v25, v25, v33
    v_mfma_f32_16x16x32_bf16 v[132:135], a[156:159], v[48:51], v[132:135]
    ds_read_b64_tr_b16 a[202:203], v10 offset:12288
    v_mul_f32 v26, v26, v34
    v_mul_f32 v27, v27, v35
    v_mfma_f32_16x16x32_bf16 v[136:139], a[156:159], v[64:67], v[104:107]
    v_exp_f32 v142, v142
    v_cmp_gt_u32 vcc, 32, v19
    v_mfma_f32_16x16x32_bf16 v[136:139], a[152:155], v[60:63], v[136:139]
    ds_read_b128 a[168:171], v3 offset:40960
    v_cvt_pk_bf16_f32 v230, v140, v141
    v_cvt_pk_bf16_f32 v252, v24, v25
    v_mfma_f32_16x16x32_bf16 v[136:139], a[148:151], v[56:59], v[136:139]
    v_exp_f32 v143, v143
    v_cvt_pk_bf16_f32 v253, v26, v27
    v_cndmask_b32 v252, 0, v252, vcc
    v_mfma_f32_16x16x32_bf16 v[136:139], a[144:147], v[52:55], v[136:139]
    ds_read_b64_tr_b16 a[204:205], v10 offset:32768
    v_cndmask_b32 v253, 0, v253, vcc
    v_mfma_f32_16x16x32_bf16 a[48:51], a[216:219], v[180:183], a[48:51]
    v_exp_f32 v144, v144
    v_and_b32 v23, 7, v19
    v_mfma_f32_16x16x32_bf16 a[48:51], a[220:223], v[184:187], a[48:51]
    ds_read_b64_tr_b16 a[206:207], v10 offset:36864
    v_cvt_pk_bf16_f32 v231, v142, v143
    v_mul_u32_u24 v23, 34560, v23
    v_lshrrev_b32 v0, 4, v19
    v_mfma_f32_16x16x32_bf16 a[52:55], a[220:223], v[192:195], a[52:55]
    v_exp_f32 v145, v145
    v_add_u32 v23, v23, v0
    v_mfma_f32_16x16x32_bf16 a[52:55], a[216:219], v[188:191], a[52:55]
    ds_read_b128 a[172:175], v4 offset:40960
    v_and_b32 v0, 8, v19
    v_mfma_f32_16x16x32_bf16 a[56:59], a[216:219], v[196:199], a[56:59]
    v_exp_f32 v146, v146
    v_lshrrev_b32 v0, 1, v0
    v_add_lshl_u32 v23, v23, v0, 4
    v_mfma_f32_16x16x32_bf16 a[56:59], a[220:223], v[200:203], a[56:59]
    s_mul_i32 s42, s5, 1080
    v_cvt_pk_bf16_f32 v238, v144, v145
    v_mfma_f32_16x16x32_bf16 a[60:63], a[220:223], v[208:211], a[60:63]
    s_add_u32 s42, s42, s6
    v_exp_f32 v147, v147
    v_mfma_f32_16x16x32_bf16 a[60:63], a[216:219], v[204:207], a[60:63]
    s_lshl_b32 s42, s42, 7
    s_cmp_lt_u32 s6, 216
    s_cselect_b32 s42, s42, 0x438000
    v_smfmac_f32_16x16x64_bf16 a[228:231], v[244:247], v[188:195], v248
    s_waitcnt lgkmcnt(6)
    v_mfma_f32_16x16x32_bf16 v[140:143], a[144:147], v[68:71], v[108:111]
    v_exp_f32 v148, v148
    v_mfma_f32_16x16x32_bf16 v[140:143], a[148:151], v[72:75], v[140:143]
    ds_read_b64_tr_b16 a[208:209], v11 offset:8192
    v_cvt_pk_bf16_f32 v239, v146, v147
    v_mfma_f32_16x16x32_bf16 v[140:143], a[152:155], v[76:79], v[140:143]
    v_exp_f32 v149, v149
    v_mfma_f32_16x16x32_bf16 v[140:143], a[156:159], v[80:83], v[140:143]
    ds_read_b64_tr_b16 a[210:211], v11 offset:12288
    v_mfma_f32_16x16x16_bf16 v[24:27], a[240:241], v[252:253], 0
    v_mfma_f32_16x16x16_bf16 v[28:31], a[242:243], v[252:253], 0
    v_mfma_f32_16x16x32_bf16 v[144:147], a[156:159], v[96:99], v[112:115]
    v_exp_f32 v150, v150
    v_mfma_f32_16x16x32_bf16 v[144:147], a[152:155], v[92:95], v[144:147]
    ds_read_b128 a[176:179], v1 offset:45056
    v_cvt_pk_bf16_f32 v216, v148, v149
    v_mfma_f32_16x16x32_bf16 v[144:147], a[148:151], v[88:91], v[144:147]
    v_exp_f32 v151, v151
    v_mfma_f32_16x16x32_bf16 v[144:147], a[144:147], v[84:87], v[144:147]
    ds_read_b64_tr_b16 a[212:213], v11 offset:32768
    v_mov_b32_dpp v24, v28 row_shr:8 row_mask:0xf bank_mask:0xc
    v_mov_b32_dpp v25, v29 row_shr:8 row_mask:0xf bank_mask:0xc
    v_mov_b32_dpp v26, v30 row_shr:8 row_mask:0xf bank_mask:0xc
    v_mov_b32_dpp v27, v31 row_shr:8 row_mask:0xf bank_mask:0xc
    buffer_store_dwordx4 v[24:27], v23, s[16:19], s42 offen sc1
    s_add_u32 s42, s42, 27648
    v_mfma_f32_16x16x16_bf16 v[32:35], a[244:245], v[252:253], 0
    v_mfma_f32_16x16x16_bf16 v[28:31], a[246:247], v[252:253], 0
    ds_read_b64_tr_b16 a[240:241], v22 offset:256
    ds_read_b64_tr_b16 a[242:243], v22 offset:288
    v_mfma_f32_16x16x32_bf16 a[64:67], a[192:195], v[180:183], a[64:67]
    v_exp_f32 v152, v152
    v_mfma_f32_16x16x32_bf16 a[64:67], a[196:199], v[184:187], a[64:67]
    ds_read_b64_tr_b16 a[214:215], v11 offset:36864
    v_cvt_pk_bf16_f32 v217, v150, v151
    v_mfma_f32_16x16x32_bf16 a[68:71], a[196:199], v[192:195], a[68:71]
    v_exp_f32 v153, v153
    v_mfma_f32_16x16x32_bf16 a[68:71], a[192:195], v[188:191], a[68:71]
    ds_read_b128 a[180:183], v2 offset:45056
    v_mov_b32_dpp v32, v28 row_shr:8 row_mask:0xf bank_mask:0xc
    v_mov_b32_dpp v33, v29 row_shr:8 row_mask:0xf bank_mask:0xc
    v_mov_b32_dpp v34, v30 row_shr:8 row_mask:0xf bank_mask:0xc
    v_mov_b32_dpp v35, v31 row_shr:8 row_mask:0xf bank_mask:0xc
    buffer_store_dwordx4 v[32:35], v23, s[16:19], s42 offen sc1
    s_add_u32 s42, s42, 27648
    v_mfma_f32_16x16x16_bf16 v[24:27], a[248:249], v[252:253], 0
    v_mfma_f32_16x16x16_bf16 v[28:31], a[250:251], v[252:253], 0
    v_mfma_f32_16x16x32_bf16 a[72:75], a[192:195], v[196:199], a[72:75]
    v_exp_f32 v154, v154
    v_mfma_f32_16x16x32_bf16 a[72:75], a[196:199], v[200:203], a[72:75]
    v_cvt_pk_bf16_f32 v224, v152, v153
    v_mfma_f32_16x16x32_bf16 a[76:79], a[196:199], v[208:211], a[76:79]
    v_exp_f32 v155, v155
    v_mfma_f32_16x16x32_bf16 a[76:79], a[192:195], v[204:207], a[76:79]
    s_waitcnt lgkmcnt(6)
    v_mfma_f32_16x16x32_bf16 v[148:151], a[160:163], v[36:39], v[100:103]
    v_exp_f32 v156, v156
    v_mfma_f32_16x16x32_bf16 v[148:151], a[164:167], v[40:43], v[148:151]
    ds_read_b64_tr_b16 a[216:217], v12 offset:8192
    v_cvt_pk_bf16_f32 v225, v154, v155
    v_mfma_f32_16x16x32_bf16 v[148:151], a[168:171], v[44:47], v[148:151]
    v_exp_f32 v157, v157
    v_mfma_f32_16x16x32_bf16 v[148:151], a[172:175], v[48:51], v[148:151]
    ds_read_b64_tr_b16 a[218:219], v12 offset:12288
    v_mov_b32_dpp v24, v28 row_shr:8 row_mask:0xf bank_mask:0xc
    v_mov_b32_dpp v25, v29 row_shr:8 row_mask:0xf bank_mask:0xc
    v_mov_b32_dpp v26, v30 row_shr:8 row_mask:0xf bank_mask:0xc
    v_mov_b32_dpp v27, v31 row_shr:8 row_mask:0xf bank_mask:0xc
    buffer_store_dwordx4 v[24:27], v23, s[16:19], s42 offen sc1
    s_add_u32 s42, s42, 27648
    v_mfma_f32_16x16x16_bf16 v[32:35], a[252:253], v[252:253], 0
    v_mfma_f32_16x16x16_bf16 v[28:31], a[254:255], v[252:253], 0
    v_mfma_f32_16x16x32_bf16 v[152:155], a[172:175], v[64:67], v[104:107]
    v_exp_f32 v158, v158
    v_mfma_f32_16x16x32_bf16 v[152:155], a[168:171], v[60:63], v[152:155]
    ds_read_b128 a[184:187], v3 offset:45056
    v_cvt_pk_bf16_f32 v232, v156, v157
    v_mfma_f32_16x16x32_bf16 v[152:155], a[164:167], v[56:59], v[152:155]
    v_exp_f32 v159, v159
    v_mfma_f32_16x16x32_bf16 v[152:155], a[160:163], v[52:55], v[152:155]
    ds_read_b64_tr_b16 a[220:221], v12 offset:32768
    v_mov_b32_dpp v32, v28 row_shr:8 row_mask:0xf bank_mask:0xc
    v_mov_b32_dpp v33, v29 row_shr:8 row_mask:0xf bank_mask:0xc
    v_mov_b32_dpp v34, v30 row_shr:8 row_mask:0xf bank_mask:0xc
    v_mov_b32_dpp v35, v31 row_shr:8 row_mask:0xf bank_mask:0xc
    buffer_store_dwordx4 v[32:35], v23, s[16:19], s42 offen sc1
    s_add_u32 s42, s42, 27648
    s_waitcnt lgkmcnt(6)
    v_mfma_f32_16x16x16_bf16 v[24:27], a[240:241], v[252:253], 0
    v_mfma_f32_16x16x16_bf16 v[28:31], a[242:243], v[252:253], 0
    v_mfma_f32_16x16x32_bf16 a[80:83], a[200:203], v[180:183], a[80:83]
    v_exp_f32 v160, v160
    v_mfma_f32_16x16x32_bf16 a[80:83], a[204:207], v[184:187], a[80:83]
    ds_read_b64_tr_b16 a[222:223], v12 offset:36864
    v_cvt_pk_bf16_f32 v233, v158, v159
    v_mfma_f32_16x16x32_bf16 a[84:87], a[204:207], v[192:195], a[84:87]
    v_exp_f32 v161, v161
    v_mfma_f32_16x16x32_bf16 a[84:87], a[200:203], v[188:191], a[84:87]
    ds_read_b128 a[188:191], v4 offset:45056
    v_mov_b32_dpp v24, v28 row_shr:8 row_mask:0xf bank_mask:0xc
    v_mov_b32_dpp v25, v29 row_shr:8 row_mask:0xf bank_mask:0xc
    v_mov_b32_dpp v26, v30 row_shr:8 row_mask:0xf bank_mask:0xc
    v_mov_b32_dpp v27, v31 row_shr:8 row_mask:0xf bank_mask:0xc
    buffer_store_dwordx4 v[24:27], v23, s[16:19], s42 offen sc1
    s_add_u32 s42, s42, 27648
    v_mfma_f32_16x16x32_bf16 a[88:91], a[200:203], v[196:199], a[88:91]
    v_exp_f32 v162, v162
    v_mfma_f32_16x16x32_bf16 a[88:91], a[204:207], v[200:203], a[88:91]
    v_cvt_pk_bf16_f32 v240, v160, v161
    v_mfma_f32_16x16x32_bf16 a[92:95], a[204:207], v[208:211], a[92:95]
    v_exp_f32 v163, v163
    v_mfma_f32_16x16x32_bf16 a[92:95], a[200:203], v[204:207], a[92:95]
    v_smfmac_f32_16x16x64_bf16 a[232:235], v[244:247], v[196:203], v248
    s_waitcnt vmcnt(9) lgkmcnt(0)
    s_barrier
    v_mfma_f32_16x16x32_bf16 v[156:159], a[160:163], v[68:71], v[108:111]
    v_exp_f32 v164, v164
    v_mfma_f32_16x16x32_bf16 v[156:159], a[164:167], v[72:75], v[156:159]
    ds_read_b64_tr_b16 a[192:193], v5 offset:16384
    v_cvt_pk_bf16_f32 v241, v162, v163
    v_mfma_f32_16x16x32_bf16 v[156:159], a[168:171], v[76:79], v[156:159]
    v_exp_f32 v165, v165
    v_mfma_f32_16x16x32_bf16 v[156:159], a[172:175], v[80:83], v[156:159]
    ds_read_b64_tr_b16 a[194:195], v5 offset:20480
    v_mfma_f32_16x16x32_bf16 v[160:163], a[172:175], v[96:99], v[112:115]
    v_exp_f32 v166, v166
    v_mfma_f32_16x16x32_bf16 v[160:163], a[168:171], v[92:95], v[160:163]
    ds_read_b128 a[128:131], v1 offset:0
    v_cvt_pk_bf16_f32 v218, v164, v165
    v_mfma_f32_16x16x32_bf16 v[160:163], a[164:167], v[88:91], v[160:163]
    v_exp_f32 v167, v167
    v_mfma_f32_16x16x32_bf16 v[160:163], a[160:163], v[84:87], v[160:163]
    ds_read_b64_tr_b16 a[196:197], v5 offset:40960
    v_mfma_f32_16x16x32_bf16 a[96:99], a[208:211], v[180:183], a[96:99]
    v_exp_f32 v168, v168
    v_mfma_f32_16x16x32_bf16 a[96:99], a[212:215], v[184:187], a[96:99]
    ds_read_b64_tr_b16 a[198:199], v5 offset:45056
    v_cvt_pk_bf16_f32 v219, v166, v167
    v_mfma_f32_16x16x32_bf16 a[100:103], a[212:215], v[192:195], a[100:103]
    v_exp_f32 v169, v169
    v_mfma_f32_16x16x32_bf16 a[100:103], a[208:211], v[188:191], a[100:103]
    ds_read_b128 a[132:135], v2 offset:0
    v_cvt_pk_bf16_f32 v226, v168, v169
    v_mfma_f32_16x16x32_bf16 a[104:107], a[208:211], v[196:199], a[104:107]
    s_mov_b32 m0, s33
    v_exp_f32 v170, v170
    v_mfma_f32_16x16x32_bf16 a[104:107], a[212:215], v[200:203], a[104:107]
    buffer_load_dwordx4 v17, s[12:15], s29 offen offset:0 lds
    v_mfma_f32_16x16x32_bf16 a[108:111], a[212:215], v[208:211], a[108:111]
    v_exp_f32 v171, v171
    v_mfma_f32_16x16x32_bf16 a[108:111], a[208:211], v[204:207], a[108:111]
    s_waitcnt lgkmcnt(6)
    v_mfma_f32_16x16x32_bf16 v[164:167], a[176:179], v[36:39], v[100:103]
    v_exp_f32 v172, v172
    v_mfma_f32_16x16x32_bf16 v[164:167], a[180:183], v[40:43], v[164:167]
    ds_read_b64_tr_b16 a[200:201], v6 offset:16384
    v_cvt_pk_bf16_f32 v227, v170, v171
    v_mfma_f32_16x16x32_bf16 v[164:167], a[184:187], v[44:47], v[164:167]
    v_exp_f32 v173, v173
    v_mfma_f32_16x16x32_bf16 v[164:167], a[188:191], v[48:51], v[164:167]
    ds_read_b64_tr_b16 a[202:203], v6 offset:20480
    v_mfma_f32_16x16x32_bf16 v[168:171], a[188:191], v[64:67], v[104:107]
    v_exp_f32 v174, v174
    v_mfma_f32_16x16x32_bf16 v[168:171], a[184:187], v[60:63], v[168:171]
    ds_read_b128 a[136:139], v3 offset:0
    v_cvt_pk_bf16_f32 v234, v172, v173
    v_mfma_f32_16x16x32_bf16 v[168:171], a[180:183], v[56:59], v[168:171]
    v_exp_f32 v175, v175
    v_mfma_f32_16x16x32_bf16 v[168:171], a[176:179], v[52:55], v[168:171]
    ds_read_b64_tr_b16 a[204:205], v6 offset:40960
    v_mfma_f32_16x16x32_bf16 a[112:115], a[216:219], v[180:183], a[112:115]
    v_exp_f32 v176, v176
    v_mfma_f32_16x16x32_bf16 a[112:115], a[220:223], v[184:187], a[112:115]
    ds_read_b64_tr_b16 a[206:207], v6 offset:45056
    v_cvt_pk_bf16_f32 v235, v174, v175
    v_mfma_f32_16x16x32_bf16 a[116:119], a[220:223], v[192:195], a[116:119]
    v_exp_f32 v177, v177
    v_mfma_f32_16x16x32_bf16 a[116:119], a[216:219], v[188:191], a[116:119]
    ds_read_b128 a[140:143], v4 offset:0
    v_mfma_f32_16x16x32_bf16 a[120:123], a[216:219], v[196:199], a[120:123]
    v_exp_f32 v178, v178
    v_mfma_f32_16x16x32_bf16 a[120:123], a[220:223], v[200:203], a[120:123]
    v_cvt_pk_bf16_f32 v242, v176, v177
    v_mfma_f32_16x16x32_bf16 a[124:127], a[220:223], v[208:211], a[124:127]
    v_exp_f32 v179, v179
    v_mfma_f32_16x16x32_bf16 a[124:127], a[216:219], v[204:207], a[124:127]
    buffer_load_dwordx4 v18, s[12:15], s29 offen offset:1024 lds
    v_smfmac_f32_16x16x64_bf16 a[236:239], v[244:247], v[204:211], v248
    s_waitcnt lgkmcnt(6)
    v_mfma_f32_16x16x32_bf16 v[172:175], a[176:179], v[68:71], v[108:111]
    v_exp_f32 v116, v116
    v_mfma_f32_16x16x32_bf16 v[172:175], a[180:183], v[72:75], v[172:175]
    ds_read_b64_tr_b16 a[208:209], v7 offset:16384
    v_cvt_pk_bf16_f32 v243, v178, v179
    v_mfma_f32_16x16x32_bf16 v[172:175], a[184:187], v[76:79], v[172:175]
    v_exp_f32 v117, v117
    v_mfma_f32_16x16x32_bf16 v[172:175], a[188:191], v[80:83], v[172:175]
    ds_read_b64_tr_b16 a[210:211], v7 offset:20480
    s_mul_i32 s46, s5, 10240
    s_mul_i32 s40, s100, 655360
    s_add_u32 s40, s40, 0x1400000
    s_add_u32 s20, s72, s40
    s_addc_u32 s21, s73, 0
    s_mov_b32 s22, 0xa0000
    s_mov_b32 s23, 0x20000
    s_mul_i32 s40, s5, 5120
    v_lshl_add_u32 v22, v19, 4, s40
    v_add_u32 v23, 4096, v22
    v_mov_b32 v0, 2
    v_mfma_f32_16x16x32_bf16 v[176:179], a[188:191], v[96:99], v[112:115]
    v_exp_f32 v118, v118
    v_mfma_f32_16x16x32_bf16 v[176:179], a[184:187], v[92:95], v[176:179]
    ds_read_b128 a[144:147], v1 offset:4096
    v_cvt_pk_bf16_f32 v180, v116, v117
    v_mfma_f32_16x16x32_bf16 v[176:179], a[180:183], v[88:91], v[176:179]
    v_exp_f32 v119, v119
    v_mfma_f32_16x16x32_bf16 v[176:179], a[176:179], v[84:87], v[176:179]
    ds_read_b64_tr_b16 a[212:213], v7 offset:40960
    v_mfma_f32_16x16x32_bf16 a[0:3], a[192:195], v[212:215], a[0:3]
    v_exp_f32 v120, v120
    v_mfma_f32_16x16x32_bf16 a[0:3], a[196:199], v[216:219], a[0:3]
    ds_read_b64_tr_b16 a[214:215], v7 offset:45056
    v_cvt_pk_bf16_f32 v181, v118, v119
    v_mfma_f32_16x16x32_bf16 a[4:7], a[196:199], v[224:227], a[4:7]
    v_exp_f32 v121, v121
    v_mfma_f32_16x16x32_bf16 a[4:7], a[192:195], v[220:223], a[4:7]
    ds_read_b128 a[148:151], v2 offset:4096
    v_cvt_pk_bf16_f32 v188, v120, v121
    v_mfma_f32_16x16x32_bf16 a[8:11], a[192:195], v[228:231], a[8:11]
    v_exp_f32 v122, v122
    v_mfma_f32_16x16x32_bf16 a[8:11], a[196:199], v[232:235], a[8:11]
    buffer_load_dwordx4 v17, s[12:15], s29 offen offset:2048 lds
    v_mfma_f32_16x16x32_bf16 a[12:15], a[196:199], v[240:243], a[12:15]
    v_exp_f32 v123, v123
    v_mfma_f32_16x16x32_bf16 a[12:15], a[192:195], v[236:239], a[12:15]
    s_waitcnt lgkmcnt(6)
    v_mfma_f32_16x16x32_bf16 v[116:119], a[128:131], v[36:39], v[100:103]
    v_exp_f32 v124, v124
    v_mfma_f32_16x16x32_bf16 v[116:119], a[132:135], v[40:43], v[116:119]
    ds_read_b64_tr_b16 a[216:217], v8 offset:16384
    v_cvt_pk_bf16_f32 v189, v122, v123
    v_mfma_f32_16x16x32_bf16 v[116:119], a[136:139], v[44:47], v[116:119]
    v_exp_f32 v125, v125
    v_mfma_f32_16x16x32_bf16 v[116:119], a[140:143], v[48:51], v[116:119]
    ds_read_b64_tr_b16 a[218:219], v8 offset:20480
    s_mov_b32 s101, 0
    s_not_b32 s40, s50
    s_bfe_u32 s40, s40, 0x50006
    s_cmp_eq_u32 s40, s87
    s_cselect_b32 s40, 1, 0
    s_lshl_b32 s40, s40, 0
    s_or_b32 s101, s101, s40
    s_not_b32 s40, s51
    s_bfe_u32 s40, s40, 0x50006
    s_cmp_eq_u32 s40, s87
    s_cselect_b32 s40, 1, 0
    s_lshl_b32 s40, s40, 1
    s_or_b32 s101, s101, s40
    s_not_b32 s40, s52
    s_bfe_u32 s40, s40, 0x50006
    s_cmp_eq_u32 s40, s87
    s_cselect_b32 s40, 1, 0
    s_lshl_b32 s40, s40, 2
    s_or_b32 s101, s101, s40
    s_not_b32 s40, s53
    s_bfe_u32 s40, s40, 0x50006
    s_cmp_eq_u32 s40, s87
    s_cselect_b32 s40, 1, 0
    s_lshl_b32 s40, s40, 3
    s_or_b32 s101, s101, s40
    v_mfma_f32_16x16x32_bf16 v[120:123], a[140:143], v[64:67], v[104:107]
    v_exp_f32 v126, v126
    v_mfma_f32_16x16x32_bf16 v[120:123], a[136:139], v[60:63], v[120:123]
    ds_read_b128 a[152:155], v3 offset:4096
    v_cvt_pk_bf16_f32 v196, v124, v125
    v_mfma_f32_16x16x32_bf16 v[120:123], a[132:135], v[56:59], v[120:123]
    v_exp_f32 v127, v127
    v_mfma_f32_16x16x32_bf16 v[120:123], a[128:131], v[52:55], v[120:123]
    ds_read_b64_tr_b16 a[220:221], v8 offset:40960
    s_not_b32 s40, s54
    s_bfe_u32 s40, s40, 0x50006
    s_cmp_eq_u32 s40, s87
    s_cselect_b32 s40, 1, 0
    s_lshl_b32 s40, s40, 4
    s_or_b32 s101, s101, s40
    s_not_b32 s40, s55
    s_bfe_u32 s40, s40, 0x50006
    s_cmp_eq_u32 s40, s87
    s_cselect_b32 s40, 1, 0
    s_lshl_b32 s40, s40, 5
    s_or_b32 s101, s101, s40
    s_not_b32 s40, s56
    s_bfe_u32 s40, s40, 0x50006
    s_cmp_eq_u32 s40, s87
    s_cselect_b32 s40, 1, 0
    s_lshl_b32 s40, s40, 6
    s_or_b32 s101, s101, s40
    s_not_b32 s40, s57
    s_bfe_u32 s40, s40, 0x50006
    s_cmp_eq_u32 s40, s87
    s_cselect_b32 s40, 1, 0
    s_lshl_b32 s40, s40, 7
    s_or_b32 s101, s101, s40
    v_mfma_f32_16x16x32_bf16 a[16:19], a[200:203], v[212:215], a[16:19]
    v_exp_f32 v128, v128
    v_mfma_f32_16x16x32_bf16 a[16:19], a[204:207], v[216:219], a[16:19]
    ds_read_b64_tr_b16 a[222:223], v8 offset:45056
    v_cvt_pk_bf16_f32 v197, v126, v127
    v_mfma_f32_16x16x32_bf16 a[20:23], a[204:207], v[224:227], a[20:23]
    v_exp_f32 v129, v129
    v_mfma_f32_16x16x32_bf16 a[20:23], a[200:203], v[220:223], a[20:23]
    ds_read_b128 a[156:159], v4 offset:4096
    v_mfma_f32_16x16x32_bf16 a[24:27], a[200:203], v[228:231], a[24:27]
    v_exp_f32 v130, v130
    v_mfma_f32_16x16x32_bf16 a[24:27], a[204:207], v[232:235], a[24:27]
    v_cvt_pk_bf16_f32 v204, v128, v129
    v_mfma_f32_16x16x32_bf16 a[28:31], a[204:207], v[240:243], a[28:31]
    v_exp_f32 v131, v131
    v_mfma_f32_16x16x32_bf16 a[28:31], a[200:203], v[236:239], a[28:31]
    buffer_load_dwordx4 v18, s[12:15], s29 offen offset:3072 lds
    v_smfmac_f32_16x16x64_bf16 a[224:227], v[244:247], v[212:219], v248
    s_waitcnt lgkmcnt(6)
    s_add_u32 s29, s29, 16384
    v_mfma_f32_16x16x32_bf16 v[124:127], a[128:131], v[68:71], v[108:111]
    v_exp_f32 v132, v132
    v_mfma_f32_16x16x32_bf16 v[124:127], a[132:135], v[72:75], v[124:127]
    ds_read_b64_tr_b16 a[192:193], v9 offset:16384
    v_cvt_pk_bf16_f32 v205, v130, v131
    v_mfma_f32_16x16x32_bf16 v[124:127], a[136:139], v[76:79], v[124:127]
    v_exp_f32 v133, v133
    v_mfma_f32_16x16x32_bf16 v[124:127], a[140:143], v[80:83], v[124:127]
    ds_read_b64_tr_b16 a[194:195], v9 offset:20480
    s_add_u32 m0, s46, 122880
    s_mov_b32 s45, 286720
    buffer_load_dwordx4 v22, s[20:23], s45 offen offset:0 sc1 lds
    v_mfma_f32_16x16x32_bf16 v[128:131], a[140:143], v[96:99], v[112:115]
    v_exp_f32 v134, v134
    v_mfma_f32_16x16x32_bf16 v[128:131], a[136:139], v[92:95], v[128:131]
    ds_read_b128 a[160:163], v1 offset:8192
    v_cvt_pk_bf16_f32 v182, v132, v133
    v_mfma_f32_16x16x32_bf16 v[128:131], a[132:135], v[88:91], v[128:131]
    v_exp_f32 v135, v135
    v_mfma_f32_16x16x32_bf16 v[128:131], a[128:131], v[84:87], v[128:131]
    ds_read_b64_tr_b16 a[196:197], v9 offset:40960
    buffer_load_dwordx4 v22, s[20:23], s45 offen offset:1024 sc1 lds
    v_mfma_f32_16x16x32_bf16 a[32:35], a[208:211], v[212:215], a[32:35]
    v_exp_f32 v136, v136
    v_mfma_f32_16x16x32_bf16 a[32:35], a[212:215], v[216:219], a[32:35]
    ds_read_b64_tr_b16 a[198:199], v9 offset:45056
    v_cvt_pk_bf16_f32 v183, v134, v135
    v_mfma_f32_16x16x32_bf16 a[36:39], a[212:215], v[224:227], a[36:39]
    v_exp_f32 v137, v137
    v_mfma_f32_16x16x32_bf16 a[36:39], a[208:211], v[220:223], a[36:39]
    ds_read_b128 a[164:167], v2 offset:8192
    v_mfma_f32_16x16x32_bf16 a[40:43], a[208:211], v[228:231], a[40:43]
    v_exp_f32 v138, v138
    v_mfma_f32_16x16x32_bf16 a[40:43], a[212:215], v[232:235], a[40:43]
    v_cvt_pk_bf16_f32 v190, v136, v137
    v_mfma_f32_16x16x32_bf16 a[44:47], a[212:215], v[240:243], a[44:47]
    v_exp_f32 v139, v139
    v_mfma_f32_16x16x32_bf16 a[44:47], a[208:211], v[236:239], a[44:47]
    s_waitcnt lgkmcnt(6)
    v_mfma_f32_16x16x32_bf16 v[132:135], a[144:147], v[36:39], v[100:103]
    v_exp_f32 v140, v140
    v_mfma_f32_16x16x32_bf16 v[132:135], a[148:151], v[40:43], v[132:135]
    ds_read_b64_tr_b16 a[200:201], v10 offset:16384
    v_cvt_pk_bf16_f32 v191, v138, v139
    v_mfma_f32_16x16x32_bf16 v[132:135], a[152:155], v[44:47], v[132:135]
    v_exp_f32 v141, v141
    v_mfma_f32_16x16x32_bf16 v[132:135], a[156:159], v[48:51], v[132:135]
    ds_read_b64_tr_b16 a[202:203], v10 offset:20480
    buffer_load_dwordx4 v22, s[20:23], s45 offen offset:2048 sc1 lds
    v_mfma_f32_16x16x32_bf16 v[136:139], a[156:159], v[64:67], v[104:107]
    v_exp_f32 v142, v142
    v_mfma_f32_16x16x32_bf16 v[136:139], a[152:155], v[60:63], v[136:139]
    ds_read_b128 a[168:171], v3 offset:8192
    v_cvt_pk_bf16_f32 v198, v140, v141
    v_mfma_f32_16x16x32_bf16 v[136:139], a[148:151], v[56:59], v[136:139]
    v_exp_f32 v143, v143
    v_mfma_f32_16x16x32_bf16 v[136:139], a[144:147], v[52:55], v[136:139]
    ds_read_b64_tr_b16 a[204:205], v10 offset:40960
    buffer_load_dwordx4 v22, s[20:23], s45 offen offset:3072 sc1 lds
    v_mfma_f32_16x16x32_bf16 a[48:51], a[216:219], v[212:215], a[48:51]
    v_exp_f32 v144, v144
    v_mfma_f32_16x16x32_bf16 a[48:51], a[220:223], v[216:219], a[48:51]
    ds_read_b64_tr_b16 a[206:207], v10 offset:45056
    v_cvt_pk_bf16_f32 v199, v142, v143
    v_mfma_f32_16x16x32_bf16 a[52:55], a[220:223], v[224:227], a[52:55]
    v_exp_f32 v145, v145
    v_mfma_f32_16x16x32_bf16 a[52:55], a[216:219], v[220:223], a[52:55]
    ds_read_b128 a[172:175], v4 offset:8192
    v_mfma_f32_16x16x32_bf16 a[56:59], a[216:219], v[228:231], a[56:59]
    v_exp_f32 v146, v146
    v_mfma_f32_16x16x32_bf16 a[56:59], a[220:223], v[232:235], a[56:59]
    v_cvt_pk_bf16_f32 v206, v144, v145
    v_mfma_f32_16x16x32_bf16 a[60:63], a[220:223], v[240:243], a[60:63]
    v_exp_f32 v147, v147
    v_mfma_f32_16x16x32_bf16 a[60:63], a[216:219], v[236:239], a[60:63]
    v_smfmac_f32_16x16x64_bf16 a[228:231], v[244:247], v[220:227], v248
    s_waitcnt lgkmcnt(6)
    v_mfma_f32_16x16x32_bf16 v[140:143], a[144:147], v[68:71], v[108:111]
    v_exp_f32 v148, v148
    v_mfma_f32_16x16x32_bf16 v[140:143], a[148:151], v[72:75], v[140:143]
    ds_read_b64_tr_b16 a[208:209], v11 offset:16384
    v_cvt_pk_bf16_f32 v207, v146, v147
    v_mfma_f32_16x16x32_bf16 v[140:143], a[152:155], v[76:79], v[140:143]
    v_exp_f32 v149, v149
    v_mfma_f32_16x16x32_bf16 v[140:143], a[156:159], v[80:83], v[140:143]
    ds_read_b64_tr_b16 a[210:211], v11 offset:20480
    s_add_u32 m0, s46, 126976
    s_nop 0
    buffer_load_dwordx4 v23, s[20:23], s45 offen offset:0 sc1 lds
    v_mfma_f32_16x16x32_bf16 v[144:147], a[156:159], v[96:99], v[112:115]
    v_exp_f32 v150, v150
    v_mfma_f32_16x16x32_bf16 v[144:147], a[152:155], v[92:95], v[144:147]
    ds_read_b128 a[176:179], v1 offset:12288
    v_cvt_pk_bf16_f32 v184, v148, v149
    v_mfma_f32_16x16x32_bf16 v[144:147], a[148:151], v[88:91], v[144:147]
    v_exp_f32 v151, v151
    v_mfma_f32_16x16x32_bf16 v[144:147], a[144:147], v[84:87], v[144:147]
    ds_read_b64_tr_b16 a[212:213], v11 offset:40960
    s_add_u32 m0, s46, 128000
    s_mov_b32 s45, 307200
    buffer_load_dwordx4 v22, s[20:23], s45 offen offset:0 sc1 lds
    v_mfma_f32_16x16x32_bf16 a[64:67], a[192:195], v[212:215], a[64:67]
    v_exp_f32 v152, v152
    v_mfma_f32_16x16x32_bf16 a[64:67], a[196:199], v[216:219], a[64:67]
    ds_read_b64_tr_b16 a[214:215], v11 offset:45056
    v_cvt_pk_bf16_f32 v185, v150, v151
    v_mfma_f32_16x16x32_bf16 a[68:71], a[196:199], v[224:227], a[68:71]
    v_exp_f32 v153, v153
    v_mfma_f32_16x16x32_bf16 a[68:71], a[192:195], v[220:223], a[68:71]
    ds_read_b128 a[180:183], v2 offset:12288
    v_mfma_f32_16x16x32_bf16 a[72:75], a[192:195], v[228:231], a[72:75]
    v_exp_f32 v154, v154
    v_mfma_f32_16x16x32_bf16 a[72:75], a[196:199], v[232:235], a[72:75]
    v_cvt_pk_bf16_f32 v192, v152, v153
    v_mfma_f32_16x16x32_bf16 a[76:79], a[196:199], v[240:243], a[76:79]
    v_exp_f32 v155, v155
    v_mfma_f32_16x16x32_bf16 a[76:79], a[192:195], v[236:239], a[76:79]
    s_waitcnt lgkmcnt(6)
    v_mfma_f32_16x16x32_bf16 v[148:151], a[160:163], v[36:39], v[100:103]
    v_exp_f32 v156, v156
    v_mfma_f32_16x16x32_bf16 v[148:151], a[164:167], v[40:43], v[148:151]
    ds_read_b64_tr_b16 a[216:217], v12 offset:16384
    v_cvt_pk_bf16_f32 v193, v154, v155
    v_mfma_f32_16x16x32_bf16 v[148:151], a[168:171], v[44:47], v[148:151]
    v_exp_f32 v157, v157
    v_mfma_f32_16x16x32_bf16 v[148:151], a[172:175], v[48:51], v[148:151]
    ds_read_b64_tr_b16 a[218:219], v12 offset:20480
    buffer_load_dwordx4 v22, s[20:23], s45 offen offset:1024 sc1 lds
    v_mfma_f32_16x16x32_bf16 v[152:155], a[172:175], v[64:67], v[104:107]
    v_exp_f32 v158, v158
    v_mfma_f32_16x16x32_bf16 v[152:155], a[168:171], v[60:63], v[152:155]
    ds_read_b128 a[184:187], v3 offset:12288
    v_cvt_pk_bf16_f32 v200, v156, v157
    v_mfma_f32_16x16x32_bf16 v[152:155], a[164:167], v[56:59], v[152:155]
    v_exp_f32 v159, v159
    v_mfma_f32_16x16x32_bf16 v[152:155], a[160:163], v[52:55], v[152:155]
    ds_read_b64_tr_b16 a[220:221], v12 offset:40960
    buffer_load_dwordx4 v22, s[20:23], s45 offen offset:2048 sc1 lds
    v_mfma_f32_16x16x32_bf16 a[80:83], a[200:203], v[212:215], a[80:83]
    v_exp_f32 v160, v160
    v_mfma_f32_16x16x32_bf16 a[80:83], a[204:207], v[216:219], a[80:83]
    ds_read_b64_tr_b16 a[222:223], v12 offset:45056
    v_cvt_pk_bf16_f32 v201, v158, v159
    v_mfma_f32_16x16x32_bf16 a[84:87], a[204:207], v[224:227], a[84:87]
    v_exp_f32 v161, v161
    v_mfma_f32_16x16x32_bf16 a[84:87], a[200:203], v[220:223], a[84:87]
    ds_read_b128 a[188:191], v4 offset:12288
    v_mfma_f32_16x16x32_bf16 a[88:91], a[200:203], v[228:231], a[88:91]
    v_exp_f32 v162, v162
    v_mfma_f32_16x16x32_bf16 a[88:91], a[204:207], v[232:235], a[88:91]
    v_cvt_pk_bf16_f32 v208, v160, v161
    v_mfma_f32_16x16x32_bf16 a[92:95], a[204:207], v[240:243], a[92:95]
    v_exp_f32 v163, v163
    v_mfma_f32_16x16x32_bf16 a[92:95], a[200:203], v[236:239], a[92:95]
    v_smfmac_f32_16x16x64_bf16 a[232:235], v[244:247], v[228:235], v248
    s_waitcnt vmcnt(12) lgkmcnt(6)
    s_barrier
    v_mfma_f32_16x16x32_bf16 v[156:159], a[160:163], v[68:71], v[108:111]
    v_exp_f32 v164, v164
    v_mfma_f32_16x16x32_bf16 v[156:159], a[164:167], v[72:75], v[156:159]
    ds_read_b64_tr_b16 a[192:193], v5 offset:57344
    v_cvt_pk_bf16_f32 v209, v162, v163
    v_mfma_f32_16x16x32_bf16 v[156:159], a[168:171], v[76:79], v[156:159]
    v_exp_f32 v165, v165
    v_mfma_f32_16x16x32_bf16 v[156:159], a[172:175], v[80:83], v[156:159]
    ds_read_b64_tr_b16 a[194:195], v5 offset:61440
    buffer_load_dwordx4 v22, s[20:23], s45 offen offset:3072 sc1 lds
    v_mfma_f32_16x16x32_bf16 v[160:163], a[172:175], v[96:99], v[112:115]
    v_exp_f32 v166, v166
    v_mfma_f32_16x16x32_bf16 v[160:163], a[168:171], v[92:95], v[160:163]
    ds_read_b64_tr_b16 a[196:197], v5 offset:0
    v_cvt_pk_bf16_f32 v186, v164, v165
    s_cmp_lg_u32 s5, 0
    s_cbranch_scc1 L_ffn_flagged
    s_mov_b64 exec, 1
    buffer_store_dword v0, off, s[76:79], s75 sc1
    s_mov_b64 exec, -1
L_ffn_flagged:
    v_mfma_f32_16x16x32_bf16 v[160:163], a[164:167], v[88:91], v[160:163]
    v_exp_f32 v167, v167
    v_mfma_f32_16x16x32_bf16 v[160:163], a[160:163], v[84:87], v[160:163]
    ds_read_b64_tr_b16 a[198:199], v5 offset:4096
    s_add_u32 m0, s46, 132096
    s_nop 0
    buffer_load_dwordx4 v23, s[20:23], s45 offen offset:0 sc1 lds
    v_mfma_f32_16x16x32_bf16 a[96:99], a[208:211], v[212:215], a[96:99]
    v_exp_f32 v168, v168
    v_mfma_f32_16x16x32_bf16 a[96:99], a[212:215], v[216:219], a[96:99]
    v_cvt_pk_bf16_f32 v187, v166, v167
    v_mfma_f32_16x16x32_bf16 a[100:103], a[212:215], v[224:227], a[100:103]
    v_exp_f32 v169, v169
    v_mfma_f32_16x16x32_bf16 a[100:103], a[208:211], v[220:223], a[100:103]
    v_mfma_f32_16x16x32_bf16 a[104:107], a[208:211], v[228:231], a[104:107]
    v_exp_f32 v170, v170
    v_mfma_f32_16x16x32_bf16 a[104:107], a[212:215], v[232:235], a[104:107]
    v_cvt_pk_bf16_f32 v194, v168, v169
    v_mfma_f32_16x16x32_bf16 a[108:111], a[212:215], v[240:243], a[108:111]
    v_exp_f32 v171, v171
    v_mfma_f32_16x16x32_bf16 a[108:111], a[208:211], v[236:239], a[108:111]
    s_waitcnt lgkmcnt(4)
    v_mfma_f32_16x16x32_bf16 v[164:167], a[176:179], v[36:39], v[100:103]
    v_exp_f32 v172, v172
    v_mfma_f32_16x16x32_bf16 v[164:167], a[180:183], v[40:43], v[164:167]
    ds_read_b64_tr_b16 a[200:201], v6 offset:57344
    v_cvt_pk_bf16_f32 v195, v170, v171
    v_mfma_f32_16x16x32_bf16 v[164:167], a[184:187], v[44:47], v[164:167]
    v_exp_f32 v173, v173
    v_mfma_f32_16x16x32_bf16 v[164:167], a[188:191], v[48:51], v[164:167]
    ds_read_b64_tr_b16 a[202:203], v6 offset:61440
    v_mfma_f32_16x16x32_bf16 v[168:171], a[188:191], v[64:67], v[104:107]
    v_exp_f32 v174, v174
    v_mfma_f32_16x16x32_bf16 v[168:171], a[184:187], v[60:63], v[168:171]
    ds_read_b64_tr_b16 a[204:205], v6 offset:0
    v_cvt_pk_bf16_f32 v202, v172, v173
    v_mfma_f32_16x16x32_bf16 v[168:171], a[180:183], v[56:59], v[168:171]
    v_exp_f32 v175, v175
    v_mfma_f32_16x16x32_bf16 v[168:171], a[176:179], v[52:55], v[168:171]
    ds_read_b64_tr_b16 a[206:207], v6 offset:4096
    v_mfma_f32_16x16x32_bf16 a[112:115], a[216:219], v[212:215], a[112:115]
    v_exp_f32 v176, v176
    v_mfma_f32_16x16x32_bf16 a[112:115], a[220:223], v[216:219], a[112:115]
    v_cvt_pk_bf16_f32 v203, v174, v175
    v_mfma_f32_16x16x32_bf16 a[116:119], a[220:223], v[224:227], a[116:119]
    v_exp_f32 v177, v177
    v_mfma_f32_16x16x32_bf16 a[116:119], a[216:219], v[220:223], a[116:119]
    v_mfma_f32_16x16x32_bf16 a[120:123], a[216:219], v[228:231], a[120:123]
    v_exp_f32 v178, v178
    v_mfma_f32_16x16x32_bf16 a[120:123], a[220:223], v[232:235], a[120:123]
    v_cvt_pk_bf16_f32 v210, v176, v177
    v_mfma_f32_16x16x32_bf16 a[124:127], a[220:223], v[240:243], a[124:127]
    v_exp_f32 v179, v179
    v_mfma_f32_16x16x32_bf16 a[124:127], a[216:219], v[236:239], a[124:127]
    v_smfmac_f32_16x16x64_bf16 a[236:239], v[244:247], v[236:243], v248
    s_waitcnt lgkmcnt(4)
    v_mfma_f32_16x16x32_bf16 v[172:175], a[176:179], v[68:71], v[108:111]
    v_exp_f32 v116, v116
    v_mfma_f32_16x16x32_bf16 v[172:175], a[180:183], v[72:75], v[172:175]
    ds_read_b64_tr_b16 a[208:209], v7 offset:57344
    v_cvt_pk_bf16_f32 v211, v178, v179
    v_mfma_f32_16x16x32_bf16 v[172:175], a[184:187], v[76:79], v[172:175]
    v_exp_f32 v117, v117
    v_mfma_f32_16x16x32_bf16 v[172:175], a[188:191], v[80:83], v[172:175]
    ds_read_b64_tr_b16 a[210:211], v7 offset:61440
    v_mfma_f32_16x16x32_bf16 v[176:179], a[188:191], v[96:99], v[112:115]
    v_exp_f32 v118, v118
    v_mfma_f32_16x16x32_bf16 v[176:179], a[184:187], v[92:95], v[176:179]
    ds_read_b64_tr_b16 a[212:213], v7 offset:0
    v_cvt_pk_bf16_f32 v212, v116, v117
    v_mfma_f32_16x16x32_bf16 v[176:179], a[180:183], v[88:91], v[176:179]
    v_exp_f32 v119, v119
    v_mfma_f32_16x16x32_bf16 v[176:179], a[176:179], v[84:87], v[176:179]
    ds_read_b64_tr_b16 a[214:215], v7 offset:4096
    v_mfma_f32_16x16x32_bf16 a[0:3], a[192:195], v[180:183], a[0:3]
    v_exp_f32 v120, v120
    v_mfma_f32_16x16x32_bf16 a[0:3], a[196:199], v[184:187], a[0:3]
    v_cvt_pk_bf16_f32 v213, v118, v119
    v_mfma_f32_16x16x32_bf16 a[4:7], a[196:199], v[192:195], a[4:7]
    v_exp_f32 v121, v121
    v_mfma_f32_16x16x32_bf16 a[4:7], a[192:195], v[188:191], a[4:7]
    v_mfma_f32_16x16x32_bf16 a[8:11], a[192:195], v[196:199], a[8:11]
    v_exp_f32 v122, v122
    v_mfma_f32_16x16x32_bf16 a[8:11], a[196:199], v[200:203], a[8:11]
    v_cvt_pk_bf16_f32 v220, v120, v121
    v_mfma_f32_16x16x32_bf16 a[12:15], a[196:199], v[208:211], a[12:15]
    v_exp_f32 v123, v123
    v_mfma_f32_16x16x32_bf16 a[12:15], a[192:195], v[204:207], a[12:15]
    s_waitcnt lgkmcnt(4)
    v_mfma_f32_16x16x32_bf16 a[16:19], a[200:203], v[180:183], a[16:19]
    v_exp_f32 v124, v124
    v_mfma_f32_16x16x32_bf16 a[16:19], a[204:207], v[184:187], a[16:19]
    ds_read_b64_tr_b16 a[216:217], v8 offset:57344
    v_cvt_pk_bf16_f32 v221, v122, v123
    v_exp_f32 v125, v125
    v_mfma_f32_16x16x32_bf16 a[20:23], a[204:207], v[192:195], a[20:23]
    ds_read_b64_tr_b16 a[218:219], v8 offset:61440
    v_mov_b32 v114, v22
    v_mov_b32 v115, v23
    v_exp_f32 v126, v126
    v_mfma_f32_16x16x32_bf16 a[20:23], a[200:203], v[188:191], a[20:23]
    ds_read_b64_tr_b16 a[220:221], v8 offset:0
    v_cvt_pk_bf16_f32 v228, v124, v125
    v_exp_f32 v127, v127
    v_mfma_f32_16x16x32_bf16 a[24:27], a[200:203], v[196:199], a[24:27]
    ds_read_b64_tr_b16 a[222:223], v8 offset:4096
    v_mfma_f32_16x16x32_bf16 a[24:27], a[204:207], v[200:203], a[24:27]
    v_exp_f32 v128, v128
    v_cvt_pk_bf16_f32 v229, v126, v127
    v_mfma_f32_16x16x32_bf16 a[28:31], a[204:207], v[208:211], a[28:31]
    v_exp_f32 v129, v129
    v_mfma_f32_16x16x32_bf16 a[28:31], a[200:203], v[204:207], a[28:31]
    v_exp_f32 v130, v130
    v_cvt_pk_bf16_f32 v236, v128, v129
    v_smfmac_f32_16x16x64_bf16 a[224:227], v[244:247], v[180:187], v248
    v_exp_f32 v131, v131
    s_waitcnt lgkmcnt(4)
    v_mfma_f32_16x16x32_bf16 a[32:35], a[208:211], v[180:183], a[32:35]
    v_exp_f32 v132, v132
    ds_read_b64_tr_b16 a[192:193], v9 offset:57344
    v_cvt_pk_bf16_f32 v237, v130, v131
    v_mfma_f32_16x16x32_bf16 a[32:35], a[212:215], v[184:187], a[32:35]
    v_exp_f32 v133, v133
    ds_read_b64_tr_b16 a[194:195], v9 offset:61440
    s_mov_b32 s45, 40960
    buffer_load_dwordx4 a[136:139], v114, s[20:23], s45 offen offset:0 sc1
    v_mfma_f32_16x16x32_bf16 a[36:39], a[212:215], v[192:195], a[36:39]
    v_exp_f32 v134, v134
    ds_read_b64_tr_b16 a[196:197], v9 offset:0
    v_cvt_pk_bf16_f32 v214, v132, v133
    v_mfma_f32_16x16x32_bf16 a[36:39], a[208:211], v[188:191], a[36:39]
    v_exp_f32 v135, v135
    ds_read_b64_tr_b16 a[198:199], v9 offset:4096
    buffer_load_dwordx4 a[140:143], v114, s[20:23], s45 offen offset:1024 sc1
    v_mfma_f32_16x16x32_bf16 a[40:43], a[208:211], v[196:199], a[40:43]
    v_exp_f32 v136, v136
    v_cvt_pk_bf16_f32 v215, v134, v135
    v_mfma_f32_16x16x32_bf16 a[40:43], a[212:215], v[200:203], a[40:43]
    v_exp_f32 v137, v137
    v_mfma_f32_16x16x32_bf16 a[44:47], a[212:215], v[208:211], a[44:47]
    v_exp_f32 v138, v138
    v_cvt_pk_bf16_f32 v222, v136, v137
    v_mfma_f32_16x16x32_bf16 a[44:47], a[208:211], v[204:207], a[44:47]
    v_exp_f32 v139, v139
    s_waitcnt lgkmcnt(4)
    v_mfma_f32_16x16x32_bf16 a[48:51], a[216:219], v[180:183], a[48:51]
    v_exp_f32 v140, v140
    v_mfma_f32_16x16x32_bf16 a[48:51], a[220:223], v[184:187], a[48:51]
    ds_read_b64_tr_b16 a[200:201], v10 offset:57344
    v_cvt_pk_bf16_f32 v223, v138, v139
    v_exp_f32 v141, v141
    v_mfma_f32_16x16x32_bf16 a[52:55], a[220:223], v[192:195], a[52:55]
    ds_read_b64_tr_b16 a[202:203], v10 offset:61440
    buffer_load_dwordx4 a[144:147], v114, s[20:23], s45 offen offset:2048 sc1
    v_exp_f32 v142, v142
    v_mfma_f32_16x16x32_bf16 a[52:55], a[216:219], v[188:191], a[52:55]
    ds_read_b64_tr_b16 a[204:205], v10 offset:0
    v_cvt_pk_bf16_f32 v230, v140, v141
    v_exp_f32 v143, v143
    v_mfma_f32_16x16x32_bf16 a[56:59], a[216:219], v[196:199], a[56:59]
    ds_read_b64_tr_b16 a[206:207], v10 offset:4096
    buffer_load_dwordx4 a[148:151], v114, s[20:23], s45 offen offset:3072 sc1
    v_mfma_f32_16x16x32_bf16 a[56:59], a[220:223], v[200:203], a[56:59]
    v_exp_f32 v144, v144
    v_cvt_pk_bf16_f32 v231, v142, v143
    v_mfma_f32_16x16x32_bf16 a[60:63], a[220:223], v[208:211], a[60:63]
    v_exp_f32 v145, v145
    v_mfma_f32_16x16x32_bf16 a[60:63], a[216:219], v[204:207], a[60:63]
    v_exp_f32 v146, v146
    v_cvt_pk_bf16_f32 v238, v144, v145
    v_smfmac_f32_16x16x64_bf16 a[228:231], v[244:247], v[188:195], v248
    v_exp_f32 v147, v147
    s_waitcnt lgkmcnt(4)
    v_mfma_f32_16x16x32_bf16 a[64:67], a[192:195], v[180:183], a[64:67]
    v_exp_f32 v148, v148
    ds_read_b64_tr_b16 a[208:209], v11 offset:57344
    v_cvt_pk_bf16_f32 v239, v146, v147
    v_mfma_f32_16x16x32_bf16 a[64:67], a[196:199], v[184:187], a[64:67]
    v_exp_f32 v149, v149
    ds_read_b64_tr_b16 a[210:211], v11 offset:61440
    buffer_load_dwordx4 a[152:155], v115, s[20:23], s45 offen offset:0 sc1
    v_mfma_f32_16x16x32_bf16 a[68:71], a[196:199], v[192:195], a[68:71]
    v_exp_f32 v150, v150
    ds_read_b64_tr_b16 a[212:213], v11 offset:0
    v_cvt_pk_bf16_f32 v216, v148, v149
    v_mfma_f32_16x16x32_bf16 a[68:71], a[192:195], v[188:191], a[68:71]
    v_exp_f32 v151, v151
    ds_read_b64_tr_b16 a[214:215], v11 offset:4096
    s_mov_b32 s45, 61440
    buffer_load_dwordx4 a[156:159], v114, s[20:23], s45 offen offset:0 sc1
    v_mfma_f32_16x16x32_bf16 a[72:75], a[192:195], v[196:199], a[72:75]
    v_exp_f32 v152, v152
    v_cvt_pk_bf16_f32 v217, v150, v151
    v_mfma_f32_16x16x32_bf16 a[72:75], a[196:199], v[200:203], a[72:75]
    v_exp_f32 v153, v153
    v_mfma_f32_16x16x32_bf16 a[76:79], a[196:199], v[208:211], a[76:79]
    v_exp_f32 v154, v154
    v_cvt_pk_bf16_f32 v224, v152, v153
    v_mfma_f32_16x16x32_bf16 a[76:79], a[192:195], v[204:207], a[76:79]
    v_exp_f32 v155, v155
    s_waitcnt lgkmcnt(4)
    v_mfma_f32_16x16x32_bf16 a[80:83], a[200:203], v[180:183], a[80:83]
    v_exp_f32 v156, v156
    v_mfma_f32_16x16x32_bf16 a[80:83], a[204:207], v[184:187], a[80:83]
    ds_read_b64_tr_b16 a[216:217], v12 offset:57344
    v_cvt_pk_bf16_f32 v225, v154, v155
    v_exp_f32 v157, v157
    v_mfma_f32_16x16x32_bf16 a[84:87], a[204:207], v[192:195], a[84:87]
    ds_read_b64_tr_b16 a[218:219], v12 offset:61440
    buffer_load_dwordx4 a[160:163], v114, s[20:23], s45 offen offset:1024 sc1
    v_exp_f32 v158, v158
    v_mfma_f32_16x16x32_bf16 a[84:87], a[200:203], v[188:191], a[84:87]
    ds_read_b64_tr_b16 a[220:221], v12 offset:0
    v_cvt_pk_bf16_f32 v232, v156, v157
    v_exp_f32 v159, v159
    v_mfma_f32_16x16x32_bf16 a[88:91], a[200:203], v[196:199], a[88:91]
    ds_read_b64_tr_b16 a[222:223], v12 offset:4096
    buffer_load_dwordx4 a[164:167], v114, s[20:23], s45 offen offset:2048 sc1
    v_mfma_f32_16x16x32_bf16 a[88:91], a[204:207], v[200:203], a[88:91]
    v_exp_f32 v160, v160
    v_cvt_pk_bf16_f32 v233, v158, v159
    v_mfma_f32_16x16x32_bf16 a[92:95], a[204:207], v[208:211], a[92:95]
    v_exp_f32 v161, v161
    v_mfma_f32_16x16x32_bf16 a[92:95], a[200:203], v[204:207], a[92:95]
    v_exp_f32 v162, v162
    v_cvt_pk_bf16_f32 v240, v160, v161
    v_smfmac_f32_16x16x64_bf16 a[232:235], v[244:247], v[196:203], v248
    v_exp_f32 v163, v163
    s_waitcnt vmcnt(18) lgkmcnt(4)
    s_barrier
    v_mfma_f32_16x16x32_bf16 a[96:99], a[208:211], v[180:183], a[96:99]
    v_exp_f32 v164, v164
    ds_read_b64_tr_b16 a[192:193], v5 offset:24576
    v_cvt_pk_bf16_f32 v241, v162, v163
    v_mfma_f32_16x16x32_bf16 a[96:99], a[212:215], v[184:187], a[96:99]
    v_exp_f32 v165, v165
    ds_read_b64_tr_b16 a[194:195], v5 offset:28672
    buffer_load_dwordx4 a[168:171], v114, s[20:23], s45 offen offset:3072 sc1
    v_mfma_f32_16x16x32_bf16 a[100:103], a[212:215], v[192:195], a[100:103]
    v_exp_f32 v166, v166
    ds_read_b64_tr_b16 a[196:197], v5 offset:49152
    v_cvt_pk_bf16_f32 v218, v164, v165
    v_mfma_f32_16x16x32_bf16 a[100:103], a[208:211], v[188:191], a[100:103]
    v_exp_f32 v167, v167
    ds_read_b64_tr_b16 a[198:199], v5 offset:53248
    buffer_load_dwordx4 a[172:175], v115, s[20:23], s45 offen offset:0 sc1
    v_mfma_f32_16x16x32_bf16 a[104:107], a[208:211], v[196:199], a[104:107]
    v_exp_f32 v168, v168
    v_cvt_pk_bf16_f32 v219, v166, v167
    v_mfma_f32_16x16x32_bf16 a[104:107], a[212:215], v[200:203], a[104:107]
    v_exp_f32 v169, v169
    v_mfma_f32_16x16x32_bf16 a[108:111], a[212:215], v[208:211], a[108:111]
    v_exp_f32 v170, v170
    v_cvt_pk_bf16_f32 v226, v168, v169
    v_mfma_f32_16x16x32_bf16 a[108:111], a[208:211], v[204:207], a[108:111]
    v_exp_f32 v171, v171
    s_waitcnt lgkmcnt(4)
    v_mfma_f32_16x16x32_bf16 a[112:115], a[216:219], v[180:183], a[112:115]
    v_exp_f32 v172, v172
    v_mfma_f32_16x16x32_bf16 a[112:115], a[220:223], v[184:187], a[112:115]
    ds_read_b64_tr_b16 a[200:201], v6 offset:24576
    v_cvt_pk_bf16_f32 v227, v170, v171
    v_exp_f32 v173, v173
    v_mfma_f32_16x16x32_bf16 a[116:119], a[220:223], v[192:195], a[116:119]
    ds_read_b64_tr_b16 a[202:203], v6 offset:28672
    v_exp_f32 v174, v174
    v_mfma_f32_16x16x32_bf16 a[116:119], a[216:219], v[188:191], a[116:119]
    ds_read_b64_tr_b16 a[204:205], v6 offset:49152
    v_cvt_pk_bf16_f32 v234, v172, v173
    v_exp_f32 v175, v175
    v_mfma_f32_16x16x32_bf16 a[120:123], a[216:219], v[196:199], a[120:123]
    ds_read_b64_tr_b16 a[206:207], v6 offset:53248
    v_mfma_f32_16x16x32_bf16 a[120:123], a[220:223], v[200:203], a[120:123]
    v_exp_f32 v176, v176
    v_cvt_pk_bf16_f32 v235, v174, v175
    v_mfma_f32_16x16x32_bf16 a[124:127], a[220:223], v[208:211], a[124:127]
    v_exp_f32 v177, v177
    v_mfma_f32_16x16x32_bf16 a[124:127], a[216:219], v[204:207], a[124:127]
    v_exp_f32 v178, v178
    v_cvt_pk_bf16_f32 v242, v176, v177
    v_smfmac_f32_16x16x64_bf16 a[236:239], v[244:247], v[204:211], v248
    v_exp_f32 v179, v179
    s_waitcnt lgkmcnt(4)
    v_mfma_f32_16x16x32_bf16 a[0:3], a[192:195], v[212:215], a[0:3]
    s_lshl_b32 s40, s87, 2
    s_add_u32 s40, s40, s5
    ds_read_b64_tr_b16 a[208:209], v7 offset:24576
    v_cvt_pk_bf16_f32 v243, v178, v179
    v_mfma_f32_16x16x32_bf16 a[0:3], a[196:199], v[216:219], a[0:3]
    s_lshl_b32 s40, s40, 4
    v_and_b32 v35, 15, v19
    v_add_u32 v35, s40, v35
    ds_read_b64_tr_b16 a[210:211], v7 offset:28672
    v_mul_u32_u24 v34, 1280, v35
    v_mfma_f32_16x16x32_bf16 a[4:7], a[196:199], v[224:227], a[4:7]
    v_lshrrev_b32 v116, 4, v19
    v_lshl_add_u32 v34, v116, 3, v34
    s_mul_i32 s40, s100, 160
    ds_read_b64_tr_b16 a[212:213], v7 offset:49152
    v_add_u32 v34, s40, v34
    v_mfma_f32_16x16x32_bf16 a[4:7], a[192:195], v[220:223], a[4:7]
    v_lshlrev_b32 v116, 4, v35
    s_mov_b32 s40, 0x280000
    ds_read_b64_tr_b16 a[214:215], v7 offset:53248
    buffer_load_dwordx2 v[32:33], v116, s[76:79], s40 offen sc1
    v_mfma_f32_16x16x32_bf16 a[8:11], a[192:195], v[228:231], a[8:11]
    buffer_load_dwordx2 v[22:23], v34, s[88:91], 0 offen offset:0
    buffer_load_dwordx2 v[24:25], v34, s[88:91], 0 offen offset:32
    buffer_load_dwordx2 v[26:27], v34, s[88:91], 0 offen offset:64
    buffer_load_dwordx2 v[28:29], v34, s[88:91], 0 offen offset:96
    v_mfma_f32_16x16x32_bf16 a[8:11], a[196:199], v[232:235], a[8:11]
    buffer_load_dwordx2 v[30:31], v34, s[88:91], 0 offen offset:128
    v_lshlrev_b32 v20, 7, v19
    v_add_u32 v20, 0x290000, v20
    v_mfma_f32_16x16x32_bf16 a[12:15], a[196:199], v[240:243], a[12:15]
    v_mfma_f32_16x16x32_bf16 a[12:15], a[192:195], v[236:239], a[12:15]
    s_waitcnt lgkmcnt(4)
    v_mfma_f32_16x16x32_bf16 a[16:19], a[200:203], v[212:215], a[16:19]
    v_mfma_f32_16x16x32_bf16 a[16:19], a[204:207], v[216:219], a[16:19]
    ds_read_b64_tr_b16 a[216:217], v8 offset:24576
    v_mfma_f32_16x16x32_bf16 a[20:23], a[204:207], v[224:227], a[20:23]
    ds_read_b64_tr_b16 a[218:219], v8 offset:28672
    v_mfma_f32_16x16x32_bf16 a[20:23], a[200:203], v[220:223], a[20:23]
    ds_read_b64_tr_b16 a[220:221], v8 offset:49152
    v_mfma_f32_16x16x32_bf16 a[24:27], a[200:203], v[228:231], a[24:27]
    ds_read_b64_tr_b16 a[222:223], v8 offset:53248
    v_mfma_f32_16x16x32_bf16 a[24:27], a[204:207], v[232:235], a[24:27]
    v_mfma_f32_16x16x32_bf16 a[28:31], a[204:207], v[240:243], a[28:31]
    v_mfma_f32_16x16x32_bf16 a[28:31], a[200:203], v[236:239], a[28:31]
    v_smfmac_f32_16x16x64_bf16 a[224:227], v[244:247], v[212:219], v248
    s_waitcnt lgkmcnt(4)
    v_mfma_f32_16x16x32_bf16 a[32:35], a[208:211], v[212:215], a[32:35]
    ds_read_b64_tr_b16 a[192:193], v9 offset:24576
    v_mfma_f32_16x16x32_bf16 a[32:35], a[212:215], v[216:219], a[32:35]
    ds_read_b64_tr_b16 a[194:195], v9 offset:28672
    v_mfma_f32_16x16x32_bf16 a[36:39], a[212:215], v[224:227], a[36:39]
    ds_read_b64_tr_b16 a[196:197], v9 offset:49152
    v_mfma_f32_16x16x32_bf16 a[36:39], a[208:211], v[220:223], a[36:39]
    ds_read_b64_tr_b16 a[198:199], v9 offset:53248
    v_mfma_f32_16x16x32_bf16 a[40:43], a[208:211], v[228:231], a[40:43]
    v_mfma_f32_16x16x32_bf16 a[40:43], a[212:215], v[232:235], a[40:43]
    v_mfma_f32_16x16x32_bf16 a[44:47], a[212:215], v[240:243], a[44:47]
    v_mfma_f32_16x16x32_bf16 a[44:47], a[208:211], v[236:239], a[44:47]
    s_waitcnt lgkmcnt(4)
    v_mfma_f32_16x16x32_bf16 a[48:51], a[216:219], v[212:215], a[48:51]
    v_mfma_f32_16x16x32_bf16 a[48:51], a[220:223], v[216:219], a[48:51]
    ds_read_b64_tr_b16 a[200:201], v10 offset:24576
    v_mfma_f32_16x16x32_bf16 a[52:55], a[220:223], v[224:227], a[52:55]
    ds_read_b64_tr_b16 a[202:203], v10 offset:28672
    v_mfma_f32_16x16x32_bf16 a[52:55], a[216:219], v[220:223], a[52:55]
    ds_read_b64_tr_b16 a[204:205], v10 offset:49152
    v_mfma_f32_16x16x32_bf16 a[56:59], a[216:219], v[228:231], a[56:59]
    ds_read_b64_tr_b16 a[206:207], v10 offset:53248
    v_mfma_f32_16x16x32_bf16 a[56:59], a[220:223], v[232:235], a[56:59]
    v_mfma_f32_16x16x32_bf16 a[60:63], a[220:223], v[240:243], a[60:63]
    v_mfma_f32_16x16x32_bf16 a[60:63], a[216:219], v[236:239], a[60:63]
    v_smfmac_f32_16x16x64_bf16 a[228:231], v[244:247], v[220:227], v248
    s_waitcnt lgkmcnt(4)
    v_mfma_f32_16x16x32_bf16 a[64:67], a[192:195], v[212:215], a[64:67]
    ds_read_b64_tr_b16 a[208:209], v11 offset:24576
    v_mfma_f32_16x16x32_bf16 a[64:67], a[196:199], v[216:219], a[64:67]
    ds_read_b64_tr_b16 a[210:211], v11 offset:28672
    v_mfma_f32_16x16x32_bf16 a[68:71], a[196:199], v[224:227], a[68:71]
    ds_read_b64_tr_b16 a[212:213], v11 offset:49152
    v_mfma_f32_16x16x32_bf16 a[68:71], a[192:195], v[220:223], a[68:71]
    ds_read_b64_tr_b16 a[214:215], v11 offset:53248
    v_mfma_f32_16x16x32_bf16 a[72:75], a[192:195], v[228:231], a[72:75]
    v_mfma_f32_16x16x32_bf16 a[72:75], a[196:199], v[232:235], a[72:75]
    v_mfma_f32_16x16x32_bf16 a[76:79], a[196:199], v[240:243], a[76:79]
    v_mfma_f32_16x16x32_bf16 a[76:79], a[192:195], v[236:239], a[76:79]
    s_waitcnt lgkmcnt(4)
    v_mfma_f32_16x16x32_bf16 a[80:83], a[200:203], v[212:215], a[80:83]
    v_mfma_f32_16x16x32_bf16 a[80:83], a[204:207], v[216:219], a[80:83]
    ds_read_b64_tr_b16 a[216:217], v12 offset:24576
    v_mfma_f32_16x16x32_bf16 a[84:87], a[204:207], v[224:227], a[84:87]
    ds_read_b64_tr_b16 a[218:219], v12 offset:28672
    v_mfma_f32_16x16x32_bf16 a[84:87], a[200:203], v[220:223], a[84:87]
    ds_read_b64_tr_b16 a[220:221], v12 offset:49152
    v_mfma_f32_16x16x32_bf16 a[88:91], a[200:203], v[228:231], a[88:91]
    ds_read_b64_tr_b16 a[222:223], v12 offset:53248
    v_mfma_f32_16x16x32_bf16 a[88:91], a[204:207], v[232:235], a[88:91]
    v_mfma_f32_16x16x32_bf16 a[92:95], a[204:207], v[240:243], a[92:95]
    v_mfma_f32_16x16x32_bf16 a[92:95], a[200:203], v[236:239], a[92:95]
    v_smfmac_f32_16x16x64_bf16 a[232:235], v[244:247], v[228:235], v248
    s_waitcnt lgkmcnt(4)
    v_mfma_f32_16x16x32_bf16 a[96:99], a[208:211], v[212:215], a[96:99]
    v_mfma_f32_16x16x32_bf16 a[96:99], a[212:215], v[216:219], a[96:99]
    v_mfma_f32_16x16x32_bf16 a[100:103], a[212:215], v[224:227], a[100:103]
    v_mfma_f32_16x16x32_bf16 a[100:103], a[208:211], v[220:223], a[100:103]
    v_mfma_f32_16x16x32_bf16 a[104:107], a[208:211], v[228:231], a[104:107]
    v_mfma_f32_16x16x32_bf16 a[104:107], a[212:215], v[232:235], a[104:107]
    v_mfma_f32_16x16x32_bf16 a[108:111], a[212:215], v[240:243], a[108:111]
    v_mfma_f32_16x16x32_bf16 a[108:111], a[208:211], v[236:239], a[108:111]
    s_waitcnt lgkmcnt(0)
    v_mfma_f32_16x16x32_bf16 a[112:115], a[216:219], v[212:215], a[112:115]
    v_mfma_f32_16x16x32_bf16 a[112:115], a[220:223], v[216:219], a[112:115]
    v_mfma_f32_16x16x32_bf16 a[116:119], a[220:223], v[224:227], a[116:119]
    buffer_load_dwordx4 v[252:255], v20, s[76:79], 0 offen sc1
    v_mfma_f32_16x16x32_bf16 a[116:119], a[216:219], v[220:223], a[116:119]
    v_mfma_f32_16x16x32_bf16 a[120:123], a[216:219], v[228:231], a[120:123]
    v_mfma_f32_16x16x32_bf16 a[120:123], a[220:223], v[232:235], a[120:123]
    v_mfma_f32_16x16x32_bf16 a[124:127], a[220:223], v[240:243], a[124:127]
    v_mfma_f32_16x16x32_bf16 a[124:127], a[216:219], v[236:239], a[124:127]
    v_smfmac_f32_16x16x64_bf16 a[236:239], v[244:247], v[236:243], v248
    s_nop 7
    v_accvgpr_read_b32 v100, a224
    v_accvgpr_read_b32 v101, a225
    v_accvgpr_read_b32 v102, a228
    v_accvgpr_read_b32 v103, a229
    v_accvgpr_read_b32 v104, a232
    v_accvgpr_read_b32 v105, a233
    v_accvgpr_read_b32 v106, a236
    v_accvgpr_read_b32 v107, a237
    v_add_f32 v100, v100, v101
    v_add_f32 v102, v102, v103
    v_add_f32 v104, v104, v105
    v_add_f32 v106, v106, v107
L_norm:
    v_maximum3_f32 v108, v100, v102, v104
    v_maximum3_f32 v108, v108, v106, v106
    v_mul_f32 v108, 0x6b800000, v108
    v_mov_b32 v109, 0
    v_accvgpr_read_b32 v116, a0
    v_accvgpr_read_b32 v117, a1
    v_accvgpr_read_b32 v118, a2
    v_accvgpr_read_b32 v119, a3
    v_maximum3_f32 v108, v108, |v116|, |v117|
    v_maximum3_f32 v109, v109, |v118|, |v119|
    v_accvgpr_read_b32 v120, a4
    v_accvgpr_read_b32 v121, a5
    v_accvgpr_read_b32 v122, a6
    v_accvgpr_read_b32 v123, a7
    v_maximum3_f32 v108, v108, |v120|, |v121|
    v_maximum3_f32 v109, v109, |v122|, |v123|
    v_accvgpr_read_b32 v124, a8
    v_accvgpr_read_b32 v125, a9
    v_accvgpr_read_b32 v126, a10
    v_accvgpr_read_b32 v127, a11
    v_maximum3_f32 v108, v108, |v124|, |v125|
    v_maximum3_f32 v109, v109, |v126|, |v127|
    v_accvgpr_read_b32 v128, a12
    v_accvgpr_read_b32 v129, a13
    v_accvgpr_read_b32 v130, a14
    v_accvgpr_read_b32 v131, a15
    v_maximum3_f32 v108, v108, |v128|, |v129|
    v_maximum3_f32 v109, v109, |v130|, |v131|
    v_accvgpr_read_b32 v132, a16
    v_accvgpr_read_b32 v133, a17
    v_accvgpr_read_b32 v134, a18
    v_accvgpr_read_b32 v135, a19
    v_maximum3_f32 v108, v108, |v132|, |v133|
    v_maximum3_f32 v109, v109, |v134|, |v135|
    v_accvgpr_read_b32 v136, a20
    v_accvgpr_read_b32 v137, a21
    v_accvgpr_read_b32 v138, a22
    v_accvgpr_read_b32 v139, a23
    v_maximum3_f32 v108, v108, |v136|, |v137|
    v_maximum3_f32 v109, v109, |v138|, |v139|
    v_accvgpr_read_b32 v140, a24
    v_accvgpr_read_b32 v141, a25
    v_accvgpr_read_b32 v142, a26
    v_accvgpr_read_b32 v143, a27
    v_maximum3_f32 v108, v108, |v140|, |v141|
    v_maximum3_f32 v109, v109, |v142|, |v143|
    v_accvgpr_read_b32 v144, a28
    v_accvgpr_read_b32 v145, a29
    v_accvgpr_read_b32 v146, a30
    v_accvgpr_read_b32 v147, a31
    v_maximum3_f32 v108, v108, |v144|, |v145|
    v_maximum3_f32 v109, v109, |v146|, |v147|
    v_accvgpr_read_b32 v148, a32
    v_accvgpr_read_b32 v149, a33
    v_accvgpr_read_b32 v150, a34
    v_accvgpr_read_b32 v151, a35
    v_maximum3_f32 v108, v108, |v148|, |v149|
    v_maximum3_f32 v109, v109, |v150|, |v151|
    v_accvgpr_read_b32 v152, a36
    v_accvgpr_read_b32 v153, a37
    v_accvgpr_read_b32 v154, a38
    v_accvgpr_read_b32 v155, a39
    v_maximum3_f32 v108, v108, |v152|, |v153|
    v_maximum3_f32 v109, v109, |v154|, |v155|
    v_accvgpr_read_b32 v156, a40
    v_accvgpr_read_b32 v157, a41
    v_accvgpr_read_b32 v158, a42
    v_accvgpr_read_b32 v159, a43
    v_maximum3_f32 v108, v108, |v156|, |v157|
    v_maximum3_f32 v109, v109, |v158|, |v159|
    v_accvgpr_read_b32 v160, a44
    v_accvgpr_read_b32 v161, a45
    v_accvgpr_read_b32 v162, a46
    v_accvgpr_read_b32 v163, a47
    v_maximum3_f32 v108, v108, |v160|, |v161|
    v_maximum3_f32 v109, v109, |v162|, |v163|
    v_accvgpr_read_b32 v164, a48
    v_accvgpr_read_b32 v165, a49
    v_accvgpr_read_b32 v166, a50
    v_accvgpr_read_b32 v167, a51
    v_maximum3_f32 v108, v108, |v164|, |v165|
    v_maximum3_f32 v109, v109, |v166|, |v167|
    v_accvgpr_read_b32 v168, a52
    v_accvgpr_read_b32 v169, a53
    v_accvgpr_read_b32 v170, a54
    v_accvgpr_read_b32 v171, a55
    v_maximum3_f32 v108, v108, |v168|, |v169|
    v_maximum3_f32 v109, v109, |v170|, |v171|
    v_accvgpr_read_b32 v172, a56
    v_accvgpr_read_b32 v173, a57
    v_accvgpr_read_b32 v174, a58
    v_accvgpr_read_b32 v175, a59
    v_maximum3_f32 v108, v108, |v172|, |v173|
    v_maximum3_f32 v109, v109, |v174|, |v175|
    v_accvgpr_read_b32 v176, a60
    v_accvgpr_read_b32 v177, a61
    v_accvgpr_read_b32 v178, a62
    v_accvgpr_read_b32 v179, a63
    v_maximum3_f32 v108, v108, |v176|, |v177|
    v_maximum3_f32 v109, v109, |v178|, |v179|
    v_accvgpr_read_b32 v180, a64
    v_accvgpr_read_b32 v181, a65
    v_accvgpr_read_b32 v182, a66
    v_accvgpr_read_b32 v183, a67
    v_maximum3_f32 v108, v108, |v180|, |v181|
    v_maximum3_f32 v109, v109, |v182|, |v183|
    v_accvgpr_read_b32 v184, a68
    v_accvgpr_read_b32 v185, a69
    v_accvgpr_read_b32 v186, a70
    v_accvgpr_read_b32 v187, a71
    v_maximum3_f32 v108, v108, |v184|, |v185|
    v_maximum3_f32 v109, v109, |v186|, |v187|
    v_accvgpr_read_b32 v188, a72
    v_accvgpr_read_b32 v189, a73
    v_accvgpr_read_b32 v190, a74
    v_accvgpr_read_b32 v191, a75
    v_maximum3_f32 v108, v108, |v188|, |v189|
    v_maximum3_f32 v109, v109, |v190|, |v191|
    v_accvgpr_read_b32 v192, a76
    v_accvgpr_read_b32 v193, a77
    v_accvgpr_read_b32 v194, a78
    v_accvgpr_read_b32 v195, a79
    v_maximum3_f32 v108, v108, |v192|, |v193|
    v_maximum3_f32 v109, v109, |v194|, |v195|
    v_accvgpr_read_b32 v196, a80
    v_accvgpr_read_b32 v197, a81
    v_accvgpr_read_b32 v198, a82
    v_accvgpr_read_b32 v199, a83
    v_maximum3_f32 v108, v108, |v196|, |v197|
    v_maximum3_f32 v109, v109, |v198|, |v199|
    v_accvgpr_read_b32 v200, a84
    v_accvgpr_read_b32 v201, a85
    v_accvgpr_read_b32 v202, a86
    v_accvgpr_read_b32 v203, a87
    v_maximum3_f32 v108, v108, |v200|, |v201|
    v_maximum3_f32 v109, v109, |v202|, |v203|
    v_accvgpr_read_b32 v204, a88
    v_accvgpr_read_b32 v205, a89
    v_accvgpr_read_b32 v206, a90
    v_accvgpr_read_b32 v207, a91
    v_maximum3_f32 v108, v108, |v204|, |v205|
    v_maximum3_f32 v109, v109, |v206|, |v207|
    v_accvgpr_read_b32 v208, a92
    v_accvgpr_read_b32 v209, a93
    v_accvgpr_read_b32 v210, a94
    v_accvgpr_read_b32 v211, a95
    v_maximum3_f32 v108, v108, |v208|, |v209|
    v_maximum3_f32 v109, v109, |v210|, |v211|
    v_accvgpr_read_b32 v212, a96
    v_accvgpr_read_b32 v213, a97
    v_accvgpr_read_b32 v214, a98
    v_accvgpr_read_b32 v215, a99
    v_maximum3_f32 v108, v108, |v212|, |v213|
    v_maximum3_f32 v109, v109, |v214|, |v215|
    v_accvgpr_read_b32 v216, a100
    v_accvgpr_read_b32 v217, a101
    v_accvgpr_read_b32 v218, a102
    v_accvgpr_read_b32 v219, a103
    v_maximum3_f32 v108, v108, |v216|, |v217|
    v_maximum3_f32 v109, v109, |v218|, |v219|
    v_accvgpr_read_b32 v220, a104
    v_accvgpr_read_b32 v221, a105
    v_accvgpr_read_b32 v222, a106
    v_accvgpr_read_b32 v223, a107
    v_maximum3_f32 v108, v108, |v220|, |v221|
    v_maximum3_f32 v109, v109, |v222|, |v223|
    v_accvgpr_read_b32 v224, a108
    v_accvgpr_read_b32 v225, a109
    v_accvgpr_read_b32 v226, a110
    v_accvgpr_read_b32 v227, a111
    v_maximum3_f32 v108, v108, |v224|, |v225|
    v_maximum3_f32 v109, v109, |v226|, |v227|
    v_accvgpr_read_b32 v228, a112
    v_accvgpr_read_b32 v229, a113
    v_accvgpr_read_b32 v230, a114
    v_accvgpr_read_b32 v231, a115
    v_maximum3_f32 v108, v108, |v228|, |v229|
    v_maximum3_f32 v109, v109, |v230|, |v231|
    v_accvgpr_read_b32 v232, a116
    v_accvgpr_read_b32 v233, a117
    v_accvgpr_read_b32 v234, a118
    v_accvgpr_read_b32 v235, a119
    v_maximum3_f32 v108, v108, |v232|, |v233|
    v_maximum3_f32 v109, v109, |v234|, |v235|
    v_accvgpr_read_b32 v236, a120
    v_accvgpr_read_b32 v237, a121
    v_accvgpr_read_b32 v238, a122
    v_accvgpr_read_b32 v239, a123
    v_maximum3_f32 v108, v108, |v236|, |v237|
    v_maximum3_f32 v109, v109, |v238|, |v239|
    v_accvgpr_read_b32 v240, a124
    v_accvgpr_read_b32 v241, a125
    v_accvgpr_read_b32 v242, a126
    v_accvgpr_read_b32 v243, a127
    v_maximum3_f32 v108, v108, |v240|, |v241|
    v_maximum3_f32 v109, v109, |v242|, |v243|
    v_rcp_f32 v100, v100
    v_rcp_f32 v102, v102
    v_rcp_f32 v104, v104
    v_rcp_f32 v106, v106
    v_maximum3_f32 v108, v108, v109, v109
    v_cmp_ngt_f32 vcc, 0x7f800000, v108
    v_lshlrev_b32 v110, 4, v19
    s_cbranch_vccnz L_slow
L_publish:
    s_mov_b32 s40, 0
    v_pk_mul_f32 v[116:117], v[116:117], v[100:101] op_sel_hi:[1,0]
    v_pk_mul_f32 v[118:119], v[118:119], v[100:101] op_sel_hi:[1,0]
    v_pk_mul_f32 v[132:133], v[132:133], v[100:101] op_sel_hi:[1,0]
    v_pk_mul_f32 v[134:135], v[134:135], v[100:101] op_sel_hi:[1,0]
    v_cvt_pk_bf16_f32 v36, v116, v117
    v_cvt_pk_bf16_f32 v37, v118, v119
    v_cvt_pk_bf16_f32 v38, v132, v133
    v_cvt_pk_bf16_f32 v39, v134, v135
    buffer_store_dwordx4 v[36:39], v110, s[24:27], s40 offen offset:0 sc1
    v_pk_mul_f32 v[120:121], v[120:121], v[102:103] op_sel_hi:[1,0]
    v_pk_mul_f32 v[122:123], v[122:123], v[102:103] op_sel_hi:[1,0]
    v_pk_mul_f32 v[136:137], v[136:137], v[102:103] op_sel_hi:[1,0]
    v_pk_mul_f32 v[138:139], v[138:139], v[102:103] op_sel_hi:[1,0]
    v_cvt_pk_bf16_f32 v40, v120, v121
    v_cvt_pk_bf16_f32 v41, v122, v123
    v_cvt_pk_bf16_f32 v42, v136, v137
    v_cvt_pk_bf16_f32 v43, v138, v139
    buffer_store_dwordx4 v[40:43], v110, s[24:27], s40 offen offset:1024 sc1
    v_pk_mul_f32 v[124:125], v[124:125], v[104:105] op_sel_hi:[1,0]
    v_pk_mul_f32 v[126:127], v[126:127], v[104:105] op_sel_hi:[1,0]
    v_pk_mul_f32 v[140:141], v[140:141], v[104:105] op_sel_hi:[1,0]
    v_pk_mul_f32 v[142:143], v[142:143], v[104:105] op_sel_hi:[1,0]
    v_cvt_pk_bf16_f32 v44, v124, v125
    v_cvt_pk_bf16_f32 v45, v126, v127
    v_cvt_pk_bf16_f32 v46, v140, v141
    v_cvt_pk_bf16_f32 v47, v142, v143
    buffer_store_dwordx4 v[44:47], v110, s[24:27], s40 offen offset:2048 sc1
    v_pk_mul_f32 v[128:129], v[128:129], v[106:107] op_sel_hi:[1,0]
    v_pk_mul_f32 v[130:131], v[130:131], v[106:107] op_sel_hi:[1,0]
    v_pk_mul_f32 v[144:145], v[144:145], v[106:107] op_sel_hi:[1,0]
    v_pk_mul_f32 v[146:147], v[146:147], v[106:107] op_sel_hi:[1,0]
    v_cvt_pk_bf16_f32 v48, v128, v129
    v_cvt_pk_bf16_f32 v49, v130, v131
    v_cvt_pk_bf16_f32 v50, v144, v145
    v_cvt_pk_bf16_f32 v51, v146, v147
    buffer_store_dwordx4 v[48:51], v110, s[24:27], s40 offen offset:3072 sc1
    s_mov_b32 s40, 4096
    v_pk_mul_f32 v[148:149], v[148:149], v[100:101] op_sel_hi:[1,0]
    v_pk_mul_f32 v[150:151], v[150:151], v[100:101] op_sel_hi:[1,0]
    v_pk_mul_f32 v[164:165], v[164:165], v[100:101] op_sel_hi:[1,0]
    v_pk_mul_f32 v[166:167], v[166:167], v[100:101] op_sel_hi:[1,0]
    v_cvt_pk_bf16_f32 v36, v148, v149
    v_cvt_pk_bf16_f32 v37, v150, v151
    v_cvt_pk_bf16_f32 v38, v164, v165
    v_cvt_pk_bf16_f32 v39, v166, v167
    buffer_store_dwordx4 v[36:39], v110, s[24:27], s40 offen offset:0 sc1
    v_pk_mul_f32 v[152:153], v[152:153], v[102:103] op_sel_hi:[1,0]
    v_pk_mul_f32 v[154:155], v[154:155], v[102:103] op_sel_hi:[1,0]
    v_pk_mul_f32 v[168:169], v[168:169], v[102:103] op_sel_hi:[1,0]
    v_pk_mul_f32 v[170:171], v[170:171], v[102:103] op_sel_hi:[1,0]
    v_cvt_pk_bf16_f32 v40, v152, v153
    v_cvt_pk_bf16_f32 v41, v154, v155
    v_cvt_pk_bf16_f32 v42, v168, v169
    v_cvt_pk_bf16_f32 v43, v170, v171
    buffer_store_dwordx4 v[40:43], v110, s[24:27], s40 offen offset:1024 sc1
    v_pk_mul_f32 v[156:157], v[156:157], v[104:105] op_sel_hi:[1,0]
    v_pk_mul_f32 v[158:159], v[158:159], v[104:105] op_sel_hi:[1,0]
    v_pk_mul_f32 v[172:173], v[172:173], v[104:105] op_sel_hi:[1,0]
    v_pk_mul_f32 v[174:175], v[174:175], v[104:105] op_sel_hi:[1,0]
    v_cvt_pk_bf16_f32 v44, v156, v157
    v_cvt_pk_bf16_f32 v45, v158, v159
    v_cvt_pk_bf16_f32 v46, v172, v173
    v_cvt_pk_bf16_f32 v47, v174, v175
    buffer_store_dwordx4 v[44:47], v110, s[24:27], s40 offen offset:2048 sc1
    v_pk_mul_f32 v[160:161], v[160:161], v[106:107] op_sel_hi:[1,0]
    v_pk_mul_f32 v[162:163], v[162:163], v[106:107] op_sel_hi:[1,0]
    v_pk_mul_f32 v[176:177], v[176:177], v[106:107] op_sel_hi:[1,0]
    v_pk_mul_f32 v[178:179], v[178:179], v[106:107] op_sel_hi:[1,0]
    v_cvt_pk_bf16_f32 v48, v160, v161
    v_cvt_pk_bf16_f32 v49, v162, v163
    v_cvt_pk_bf16_f32 v50, v176, v177
    v_cvt_pk_bf16_f32 v51, v178, v179
    buffer_store_dwordx4 v[48:51], v110, s[24:27], s40 offen offset:3072 sc1
    s_mov_b32 s40, 8192
    v_pk_mul_f32 v[180:181], v[180:181], v[100:101] op_sel_hi:[1,0]
    v_pk_mul_f32 v[182:183], v[182:183], v[100:101] op_sel_hi:[1,0]
    v_pk_mul_f32 v[196:197], v[196:197], v[100:101] op_sel_hi:[1,0]
    v_pk_mul_f32 v[198:199], v[198:199], v[100:101] op_sel_hi:[1,0]
    v_cvt_pk_bf16_f32 v36, v180, v181
    v_cvt_pk_bf16_f32 v37, v182, v183
    v_cvt_pk_bf16_f32 v38, v196, v197
    v_cvt_pk_bf16_f32 v39, v198, v199
    buffer_store_dwordx4 v[36:39], v110, s[24:27], s40 offen offset:0 sc1
    v_pk_mul_f32 v[184:185], v[184:185], v[102:103] op_sel_hi:[1,0]
    v_pk_mul_f32 v[186:187], v[186:187], v[102:103] op_sel_hi:[1,0]
    v_pk_mul_f32 v[200:201], v[200:201], v[102:103] op_sel_hi:[1,0]
    v_pk_mul_f32 v[202:203], v[202:203], v[102:103] op_sel_hi:[1,0]
    v_cvt_pk_bf16_f32 v40, v184, v185
    v_cvt_pk_bf16_f32 v41, v186, v187
    v_cvt_pk_bf16_f32 v42, v200, v201
    v_cvt_pk_bf16_f32 v43, v202, v203
    buffer_store_dwordx4 v[40:43], v110, s[24:27], s40 offen offset:1024 sc1
    v_pk_mul_f32 v[188:189], v[188:189], v[104:105] op_sel_hi:[1,0]
    v_pk_mul_f32 v[190:191], v[190:191], v[104:105] op_sel_hi:[1,0]
    v_pk_mul_f32 v[204:205], v[204:205], v[104:105] op_sel_hi:[1,0]
    v_pk_mul_f32 v[206:207], v[206:207], v[104:105] op_sel_hi:[1,0]
    v_cvt_pk_bf16_f32 v44, v188, v189
    v_cvt_pk_bf16_f32 v45, v190, v191
    v_cvt_pk_bf16_f32 v46, v204, v205
    v_cvt_pk_bf16_f32 v47, v206, v207
    buffer_store_dwordx4 v[44:47], v110, s[24:27], s40 offen offset:2048 sc1
    v_pk_mul_f32 v[192:193], v[192:193], v[106:107] op_sel_hi:[1,0]
    v_pk_mul_f32 v[194:195], v[194:195], v[106:107] op_sel_hi:[1,0]
    v_pk_mul_f32 v[208:209], v[208:209], v[106:107] op_sel_hi:[1,0]
    v_pk_mul_f32 v[210:211], v[210:211], v[106:107] op_sel_hi:[1,0]
    v_cvt_pk_bf16_f32 v48, v192, v193
    v_cvt_pk_bf16_f32 v49, v194, v195
    v_cvt_pk_bf16_f32 v50, v208, v209
    v_cvt_pk_bf16_f32 v51, v210, v211
    buffer_store_dwordx4 v[48:51], v110, s[24:27], s40 offen offset:3072 sc1
    s_mov_b32 s40, 12288
    v_pk_mul_f32 v[212:213], v[212:213], v[100:101] op_sel_hi:[1,0]
    v_pk_mul_f32 v[214:215], v[214:215], v[100:101] op_sel_hi:[1,0]
    v_pk_mul_f32 v[228:229], v[228:229], v[100:101] op_sel_hi:[1,0]
    v_pk_mul_f32 v[230:231], v[230:231], v[100:101] op_sel_hi:[1,0]
    v_cvt_pk_bf16_f32 v36, v212, v213
    v_cvt_pk_bf16_f32 v37, v214, v215
    v_cvt_pk_bf16_f32 v38, v228, v229
    v_cvt_pk_bf16_f32 v39, v230, v231
    buffer_store_dwordx4 v[36:39], v110, s[24:27], s40 offen offset:0 sc1
    v_pk_mul_f32 v[216:217], v[216:217], v[102:103] op_sel_hi:[1,0]
    v_pk_mul_f32 v[218:219], v[218:219], v[102:103] op_sel_hi:[1,0]
    v_pk_mul_f32 v[232:233], v[232:233], v[102:103] op_sel_hi:[1,0]
    v_pk_mul_f32 v[234:235], v[234:235], v[102:103] op_sel_hi:[1,0]
    v_cvt_pk_bf16_f32 v40, v216, v217
    v_cvt_pk_bf16_f32 v41, v218, v219
    v_cvt_pk_bf16_f32 v42, v232, v233
    v_cvt_pk_bf16_f32 v43, v234, v235
    buffer_store_dwordx4 v[40:43], v110, s[24:27], s40 offen offset:1024 sc1
    v_pk_mul_f32 v[220:221], v[220:221], v[104:105] op_sel_hi:[1,0]
    v_pk_mul_f32 v[222:223], v[222:223], v[104:105] op_sel_hi:[1,0]
    v_pk_mul_f32 v[236:237], v[236:237], v[104:105] op_sel_hi:[1,0]
    v_pk_mul_f32 v[238:239], v[238:239], v[104:105] op_sel_hi:[1,0]
    v_cvt_pk_bf16_f32 v44, v220, v221
    v_cvt_pk_bf16_f32 v45, v222, v223
    v_cvt_pk_bf16_f32 v46, v236, v237
    v_cvt_pk_bf16_f32 v47, v238, v239
    buffer_store_dwordx4 v[44:47], v110, s[24:27], s40 offen offset:2048 sc1
    v_pk_mul_f32 v[224:225], v[224:225], v[106:107] op_sel_hi:[1,0]
    v_pk_mul_f32 v[226:227], v[226:227], v[106:107] op_sel_hi:[1,0]
    v_pk_mul_f32 v[240:241], v[240:241], v[106:107] op_sel_hi:[1,0]
    v_pk_mul_f32 v[242:243], v[242:243], v[106:107] op_sel_hi:[1,0]
    v_cvt_pk_bf16_f32 v48, v224, v225
    v_cvt_pk_bf16_f32 v49, v226, v227
    v_cvt_pk_bf16_f32 v50, v240, v241
    v_cvt_pk_bf16_f32 v51, v242, v243
    buffer_store_dwordx4 v[48:51], v110, s[24:27], s40 offen offset:3072 sc1
    v_mov_b32 v16, v114
    v_mov_b32 v17, v115
    v_mov_b32 v3, v249
    v_mov_b32 v2, 1
    s_waitcnt vmcnt(16)
    v_lshlrev_b32 v166, 16, v22
    v_and_b32 v167, 0xffff0000, v22
    v_lshlrev_b32 v168, 16, v23
    v_and_b32 v169, 0xffff0000, v23
    v_lshlrev_b32 v170, 16, v24
    v_and_b32 v171, 0xffff0000, v24
    v_lshlrev_b32 v172, 16, v25
    v_and_b32 v173, 0xffff0000, v25
    v_lshlrev_b32 v174, 16, v26
    v_and_b32 v175, 0xffff0000, v26
    v_lshlrev_b32 v176, 16, v27
    v_and_b32 v177, 0xffff0000, v27
    v_lshlrev_b32 v178, 16, v28
    v_and_b32 v179, 0xffff0000, v28
    v_lshlrev_b32 v180, 16, v29
    v_and_b32 v181, 0xffff0000, v29
    v_lshlrev_b32 v182, 16, v30
    v_and_b32 v183, 0xffff0000, v30
    v_lshlrev_b32 v184, 16, v31
    v_and_b32 v185, 0xffff0000, v31
    v_pk_add_f32 v[166:167], v[166:167], v[32:33] op_sel_hi:[1,0] neg_lo:[0,1] neg_hi:[0,1]
    v_pk_add_f32 v[168:169], v[168:169], v[32:33] op_sel_hi:[1,0] neg_lo:[0,1] neg_hi:[0,1]
    v_pk_add_f32 v[170:171], v[170:171], v[32:33] op_sel_hi:[1,0] neg_lo:[0,1] neg_hi:[0,1]
    v_pk_add_f32 v[172:173], v[172:173], v[32:33] op_sel_hi:[1,0] neg_lo:[0,1] neg_hi:[0,1]
    v_pk_add_f32 v[174:175], v[174:175], v[32:33] op_sel_hi:[1,0] neg_lo:[0,1] neg_hi:[0,1]
    v_pk_add_f32 v[176:177], v[176:177], v[32:33] op_sel_hi:[1,0] neg_lo:[0,1] neg_hi:[0,1]
    v_pk_add_f32 v[178:179], v[178:179], v[32:33] op_sel_hi:[1,0] neg_lo:[0,1] neg_hi:[0,1]
    v_pk_add_f32 v[180:181], v[180:181], v[32:33] op_sel_hi:[1,0] neg_lo:[0,1] neg_hi:[0,1]
    v_pk_add_f32 v[182:183], v[182:183], v[32:33] op_sel_hi:[1,0] neg_lo:[0,1] neg_hi:[0,1]
    v_pk_add_f32 v[184:185], v[184:185], v[32:33] op_sel_hi:[1,0] neg_lo:[0,1] neg_hi:[0,1]
    v_cvt_pk_bf16_f32 v36, v166, v167
    v_cvt_pk_bf16_f32 v37, v168, v169
    v_cvt_pk_bf16_f32 v38, v170, v171
    v_cvt_pk_bf16_f32 v39, v172, v173
    v_cvt_pk_bf16_f32 v40, v174, v175
    v_cvt_pk_bf16_f32 v41, v176, v177
    v_cvt_pk_bf16_f32 v42, v178, v179
    v_cvt_pk_bf16_f32 v43, v180, v181
    v_cvt_pk_bf16_f32 v44, v182, v183
    v_cvt_pk_bf16_f32 v45, v184, v185
    v_lshlrev_b32 v166, 16, v36
    v_and_b32 v167, 0xffff0000, v36
    v_lshlrev_b32 v168, 16, v37
    v_and_b32 v169, 0xffff0000, v37
    v_lshlrev_b32 v170, 16, v38
    v_and_b32 v171, 0xffff0000, v38
    v_lshlrev_b32 v172, 16, v39
    v_and_b32 v173, 0xffff0000, v39
    v_lshlrev_b32 v174, 16, v40
    v_and_b32 v175, 0xffff0000, v40
    v_lshlrev_b32 v176, 16, v41
    v_and_b32 v177, 0xffff0000, v41
    v_lshlrev_b32 v178, 16, v42
    v_and_b32 v179, 0xffff0000, v42
    v_lshlrev_b32 v180, 16, v43
    v_and_b32 v181, 0xffff0000, v43
    v_lshlrev_b32 v182, 16, v44
    v_and_b32 v183, 0xffff0000, v44
    v_lshlrev_b32 v184, 16, v45
    v_and_b32 v185, 0xffff0000, v45
    v_pk_mul_f32 v[166:167], v[166:167], v[32:33] op_sel:[0,1] op_sel_hi:[1,1]
    v_pk_mul_f32 v[168:169], v[168:169], v[32:33] op_sel:[0,1] op_sel_hi:[1,1]
    v_pk_mul_f32 v[170:171], v[170:171], v[32:33] op_sel:[0,1] op_sel_hi:[1,1]
    v_pk_mul_f32 v[172:173], v[172:173], v[32:33] op_sel:[0,1] op_sel_hi:[1,1]
    v_pk_mul_f32 v[174:175], v[174:175], v[32:33] op_sel:[0,1] op_sel_hi:[1,1]
    v_pk_mul_f32 v[176:177], v[176:177], v[32:33] op_sel:[0,1] op_sel_hi:[1,1]
    v_pk_mul_f32 v[178:179], v[178:179], v[32:33] op_sel:[0,1] op_sel_hi:[1,1]
    v_pk_mul_f32 v[180:181], v[180:181], v[32:33] op_sel:[0,1] op_sel_hi:[1,1]
    v_pk_mul_f32 v[182:183], v[182:183], v[32:33] op_sel:[0,1] op_sel_hi:[1,1]
    v_pk_mul_f32 v[184:185], v[184:185], v[32:33] op_sel:[0,1] op_sel_hi:[1,1]
    v_cvt_pk_bf16_f32 v36, v166, v167
    v_cvt_pk_bf16_f32 v37, v168, v169
    v_cvt_pk_bf16_f32 v38, v170, v171
    v_cvt_pk_bf16_f32 v39, v172, v173
    v_cvt_pk_bf16_f32 v40, v174, v175
    v_cvt_pk_bf16_f32 v41, v176, v177
    v_cvt_pk_bf16_f32 v42, v178, v179
    v_cvt_pk_bf16_f32 v43, v180, v181
    v_cvt_pk_bf16_f32 v44, v182, v183
    v_cvt_pk_bf16_f32 v45, v184, v185
    s_lshl_b32 s40, s87, 19
    s_add_u32 s40, s40, 0x400000
    s_add_u32 s8, s72, s40
    s_addc_u32 s9, s73, 0
    s_mov_b32 s10, 0x80000
    s_mov_b32 s11, 0x20000
    s_mov_b32 s12, s68
    s_mov_b32 s13, s69
    s_mov_b32 s14, 0x280000
    s_mov_b32 s15, 0x20000
    s_add_u32 s40, s5, 0
    s_and_b32 s40, s40, 3
    s_lshl_b32 s41, s5, 2
    s_add_u32 s41, s41, s40
    s_lshl_b32 s41, s41, 10
    v_lshl_add_u32 v4, v19, 4, s41
    s_add_u32 s40, s5, 1
    s_and_b32 s40, s40, 3
    s_lshl_b32 s41, s5, 2
    s_add_u32 s41, s41, s40
    s_lshl_b32 s41, s41, 10
    v_lshl_add_u32 v5, v19, 4, s41
    s_add_u32 s40, s5, 2
    s_and_b32 s40, s40, 3
    s_lshl_b32 s41, s5, 2
    s_add_u32 s41, s41, s40
    s_lshl_b32 s41, s41, 10
    v_lshl_add_u32 v6, v19, 4, s41
    s_add_u32 s40, s5, 3
    s_and_b32 s40, s40, 3
    s_lshl_b32 s41, s5, 2
    s_add_u32 s41, s41, s40
    s_lshl_b32 s41, s41, 10
    v_lshl_add_u32 v7, v19, 4, s41
    v_lshl_add_u32 v9, v19, 4, s46
    v_add_u32 v10, 81920, v9
    s_waitcnt vmcnt(0)
    s_mov_b64 exec, 1
    buffer_store_dword v2, off, s[76:79], s58 sc1
    s_mov_b64 exec, -1
    s_mov_b32 s45, 0
    buffer_load_dwordx4 a[96:99], v16, s[20:23], s45 offen offset:0 sc1
    buffer_load_dwordx4 a[100:103], v16, s[20:23], s45 offen offset:1024 sc1
    buffer_load_dwordx4 a[104:107], v16, s[20:23], s45 offen offset:2048 sc1
    buffer_load_dwordx4 a[108:111], v16, s[20:23], s45 offen offset:3072 sc1
    buffer_load_dwordx4 a[112:115], v17, s[20:23], s45 offen offset:0 sc1
    s_mov_b32 s45, 20480
    buffer_load_dwordx4 a[116:119], v16, s[20:23], s45 offen offset:0 sc1
    buffer_load_dwordx4 a[120:123], v16, s[20:23], s45 offen offset:1024 sc1
    buffer_load_dwordx4 a[124:127], v16, s[20:23], s45 offen offset:2048 sc1
    buffer_load_dwordx4 a[128:131], v16, s[20:23], s45 offen offset:3072 sc1
    buffer_load_dwordx4 a[132:135], v17, s[20:23], s45 offen offset:0 sc1
    v_min3_u32 v252, v252, v253, v254
    v_min_u32 v252, v252, v255
    v_cmp_gt_u32 vcc, 2, v252
    s_and_b64 vcc, vcc, exec
    s_cbranch_scc1 L_spin_ffn
L_back_ffn:
    s_mul_i32 s40, s6, 27648
    s_lshl_b32 s41, s5, 10
    s_add_u32 s40, s40, s41
    v_lshlrev_b32 v194, 4, v19
    buffer_load_dwordx4 v[166:169], v194, s[16:19], s40 offen sc1
    s_add_u32 s40, s40, 4096
    buffer_load_dwordx4 v[170:173], v194, s[16:19], s40 offen sc1
    s_add_u32 s40, s40, 4096
    buffer_load_dwordx4 v[174:177], v194, s[16:19], s40 offen sc1
    s_add_u32 s40, s40, 4096
    buffer_load_dwordx4 v[178:181], v194, s[16:19], s40 offen sc1
    s_add_u32 s40, s40, 4096
    buffer_load_dwordx4 v[182:185], v194, s[16:19], s40 offen sc1
    s_add_u32 s40, s40, 4096
    buffer_load_dwordx4 v[186:189], v194, s[16:19], s40 offen sc1
    s_add_u32 s40, s40, 4096
    s_cmp_eq_u32 s5, 3
    s_cselect_b32 s40, 0x438000, s40
    buffer_load_dwordx4 v[190:193], v194, s[16:19], s40 offen sc1
    v_mov_b32 v11, 0x2000000
    s_not_b32 s40, s50
    s_and_b32 s40, s40, 0x7ff
    v_cmp_eq_u32 vcc, s40, v35
    s_mov_b32 s45, 81920
    buffer_load_dwordx4 a[176:179], v16, s[20:23], s45 offen offset:0 sc1
    v_mov_b32 v12, 0x29c000
    s_nop 0
    v_cndmask_b32 v11, v11, v12, vcc
    s_not_b32 s40, s51
    buffer_load_dwordx4 a[180:183], v16, s[20:23], s45 offen offset:1024 sc1
    s_and_b32 s40, s40, 0x7ff
    v_cmp_eq_u32 vcc, s40, v35
    v_mov_b32 v12, 0x29c500
    s_nop 0
    buffer_load_dwordx4 a[184:187], v16, s[20:23], s45 offen offset:2048 sc1
    v_cndmask_b32 v11, v11, v12, vcc
    s_not_b32 s40, s52
    s_and_b32 s40, s40, 0x7ff
    v_cmp_eq_u32 vcc, s40, v35
    buffer_load_dwordx4 a[188:191], v16, s[20:23], s45 offen offset:3072 sc1
    v_mov_b32 v12, 0x29ca00
    s_nop 0
    v_cndmask_b32 v11, v11, v12, vcc
    s_not_b32 s40, s53
    buffer_load_dwordx4 a[192:195], v17, s[20:23], s45 offen offset:0 sc1
    s_and_b32 s40, s40, 0x7ff
    v_cmp_eq_u32 vcc, s40, v35
    v_mov_b32 v12, 0x29cf00
    s_nop 0
    s_mov_b32 s45, 102400
    buffer_load_dwordx4 a[196:199], v16, s[20:23], s45 offen offset:0 sc1
    v_cndmask_b32 v11, v11, v12, vcc
    s_not_b32 s40, s54
    s_and_b32 s40, s40, 0x7ff
    v_cmp_eq_u32 vcc, s40, v35
    buffer_load_dwordx4 a[200:203], v16, s[20:23], s45 offen offset:1024 sc1
    v_mov_b32 v12, 0x29d400
    s_nop 0
    v_cndmask_b32 v11, v11, v12, vcc
    s_not_b32 s40, s55
    buffer_load_dwordx4 a[204:207], v16, s[20:23], s45 offen offset:2048 sc1
    s_and_b32 s40, s40, 0x7ff
    v_cmp_eq_u32 vcc, s40, v35
    v_mov_b32 v12, 0x29d900
    s_nop 0
    buffer_load_dwordx4 a[208:211], v16, s[20:23], s45 offen offset:3072 sc1
    v_cndmask_b32 v11, v11, v12, vcc
    s_not_b32 s40, s56
    s_and_b32 s40, s40, 0x7ff
    v_cmp_eq_u32 vcc, s40, v35
    buffer_load_dwordx4 a[212:215], v17, s[20:23], s45 offen offset:0 sc1
    v_mov_b32 v12, 0x29de00
    s_nop 0
    v_cndmask_b32 v11, v11, v12, vcc
    s_not_b32 s40, s57
    s_mov_b32 s45, 163840
    buffer_load_dwordx4 v[46:49], v16, s[20:23], s45 offen offset:0 sc1
    s_and_b32 s40, s40, 0x7ff
    v_cmp_eq_u32 vcc, s40, v35
    v_mov_b32 v12, 0x29e300
    s_nop 0
    buffer_load_dwordx4 v[50:53], v16, s[20:23], s45 offen offset:1024 sc1
    v_cndmask_b32 v11, v11, v12, vcc
    v_mul_u32_u24 v12, 1280, v35
    v_sub_u32 v12, v34, v12
    v_add_u32 v11, v11, v12
    buffer_load_dwordx4 v[54:57], v16, s[20:23], s45 offen offset:2048 sc1
    buffer_load_dwordx4 v[58:61], v16, s[20:23], s45 offen offset:3072 sc1
    buffer_load_dwordx4 v[62:65], v17, s[20:23], s45 offen offset:0 sc1
    s_waitcnt vmcnt(15)
    v_add_f32 v166, v166, v170
    v_add_f32 v167, v167, v171
    v_add_f32 v168, v168, v172
    v_add_f32 v169, v169, v173
    v_add_f32 v166, v166, v174
    v_add_f32 v167, v167, v175
    v_add_f32 v168, v168, v176
    v_add_f32 v169, v169, v177
    s_mov_b32 s45, 184320
    buffer_load_dwordx4 v[66:69], v16, s[20:23], s45 offen offset:0 sc1
    v_add_f32 v166, v166, v178
    v_add_f32 v167, v167, v179
    v_add_f32 v168, v168, v180
    v_add_f32 v169, v169, v181
    v_add_f32 v166, v166, v182
    v_add_f32 v167, v167, v183
    v_add_f32 v168, v168, v184
    v_add_f32 v169, v169, v185
    buffer_load_dwordx4 v[70:73], v16, s[20:23], s45 offen offset:1024 sc1
    v_add_f32 v166, v166, v186
    v_add_f32 v167, v167, v187
    v_add_f32 v168, v168, v188
    v_add_f32 v169, v169, v189
    v_add_f32 v166, v166, v190
    v_add_f32 v167, v167, v191
    v_add_f32 v168, v168, v192
    v_add_f32 v169, v169, v193
    buffer_load_dwordx4 v[74:77], v16, s[20:23], s45 offen offset:2048 sc1
    v_add_f32_dpp v166, v166, v166 row_ror:8 row_mask:0xf bank_mask:0xf
    v_add_f32_dpp v167, v167, v167 row_ror:8 row_mask:0xf bank_mask:0xf
    v_add_f32_dpp v168, v168, v168 row_ror:8 row_mask:0xf bank_mask:0xf
    v_add_f32_dpp v169, v169, v169 row_ror:8 row_mask:0xf bank_mask:0xf
    v_mov_b32 v170, v166
    v_mov_b32 v171, v167
    v_mov_b32 v172, v168
    v_mov_b32 v173, v169
    buffer_load_dwordx4 v[78:81], v16, s[20:23], s45 offen offset:3072 sc1
    v_permlane16_swap_b32 v166, v170
    v_permlane16_swap_b32 v167, v171
    v_permlane16_swap_b32 v168, v172
    v_permlane16_swap_b32 v169, v173
    v_add_f32 v166, v166, v170
    v_add_f32 v167, v167, v171
    v_add_f32 v168, v168, v172
    v_add_f32 v169, v169, v173
    buffer_load_dwordx4 v[82:85], v17, s[20:23], s45 offen offset:0 sc1
    v_mov_b32 v170, v166
    v_mov_b32 v171, v167
    v_mov_b32 v172, v168
    v_mov_b32 v173, v169
    v_permlane32_swap_b32 v166, v170
    v_permlane32_swap_b32 v167, v171
    v_permlane32_swap_b32 v168, v172
    v_permlane32_swap_b32 v169, v173
    v_add_f32 v166, v166, v170
    v_add_f32 v167, v167, v171
    v_add_f32 v168, v168, v172
    v_add_f32 v169, v169, v173
    v_and_b32 v194, 7, v19
    v_lshlrev_b32 v194, 4, v194
    v_add_u32 v194, 81920, v194
    s_lshl_b32 s40, s5, 7
    v_add_u32 v195, s40, v194
    ds_write_b128 v195, v[166:169]
    s_waitcnt lgkmcnt(0)
    s_barrier
    s_mov_b32 s45, 204800
    buffer_load_dwordx4 v[86:89], v16, s[20:23], s45 offen offset:0 sc1
    buffer_load_dwordx4 v[90:93], v16, s[20:23], s45 offen offset:1024 sc1
    buffer_load_dwordx4 v[94:97], v16, s[20:23], s45 offen offset:2048 sc1
    buffer_load_dwordx4 v[98:101], v16, s[20:23], s45 offen offset:3072 sc1
    buffer_load_dwordx4 v[102:105], v17, s[20:23], s45 offen offset:0 sc1
    s_mov_b32 s45, 225280
    buffer_load_dwordx4 v[106:109], v16, s[20:23], s45 offen offset:0 sc1
    buffer_load_dwordx4 v[110:113], v16, s[20:23], s45 offen offset:1024 sc1
    buffer_load_dwordx4 v[114:117], v16, s[20:23], s45 offen offset:2048 sc1
    buffer_load_dwordx4 v[118:121], v16, s[20:23], s45 offen offset:3072 sc1
    buffer_load_dwordx4 v[122:125], v17, s[20:23], s45 offen offset:0 sc1
    s_cmp_lg_u32 s5, 0
    s_cbranch_scc1 L_summed
    ds_read_b128 v[166:169], v194 offset:0
    ds_read_b128 v[170:173], v194 offset:128
    ds_read_b128 v[174:177], v194 offset:256
    ds_read_b128 v[178:181], v194 offset:384
    s_mul_i32 s42, s6, 3277
    s_lshr_b32 s42, s42, 16
    s_min_u32 s42, s42, 7
    v_readlane_b32 s40, v3, s42
    s_and_b32 s40, s40, 0xffff0000
    s_ashr_i32 s41, s40, 31
    s_andn2_b32 s41, 0x7fff0000, s41
    s_or_b32 s41, s41, 0x80000000
    s_xor_b32 s40, s40, s41
    v_mov_b32 v182, 0xbfb8aa3b
    v_mul_f32 v182, s40, v182
    v_exp_f32 v182, v182
    s_nop 0
    v_add_f32 v182, 1.0, v182
    v_rcp_f32 v182, v182
    s_nop 0
    v_cvt_pk_bf16_f32 v182, v182, v182
    v_lshlrev_b32 v182, 16, v182
    s_lshl_b32 s40, s6, 6
    s_add_u32 s40, s40, 0x29c000
    s_cmp_lt_u32 s6, 160
    s_cselect_b32 s40, s40, 0x2000000
    v_lshlrev_b32 v183, 3, v19
    s_waitcnt lgkmcnt(0)
    v_add_f32 v166, v166, v170
    v_add_f32 v167, v167, v171
    v_add_f32 v168, v168, v172
    v_add_f32 v169, v169, v173
    v_add_f32 v166, v166, v174
    v_add_f32 v167, v167, v175
    v_add_f32 v168, v168, v176
    v_add_f32 v169, v169, v177
    v_add_f32 v166, v166, v178
    v_add_f32 v167, v167, v179
    v_add_f32 v168, v168, v180
    v_add_f32 v169, v169, v181
    v_cvt_pk_bf16_f32 v170, v166, v167
    v_cvt_pk_bf16_f32 v171, v168, v169
    v_lshlrev_b32 v166, 16, v170
    v_and_b32 v167, 0xffff0000, v170
    v_lshlrev_b32 v168, 16, v171
    v_and_b32 v169, 0xffff0000, v171
    v_mul_f32 v166, v166, v182
    v_mul_f32 v167, v167, v182
    v_mul_f32 v168, v168, v182
    v_mul_f32 v169, v169, v182
    v_cvt_pk_bf16_f32 v170, v166, v167
    v_cvt_pk_bf16_f32 v171, v168, v169
    s_mov_b64 exec, 0xff
    buffer_store_dwordx2 v[170:171], v183, s[76:79], s40 offen sc1
    s_mov_b64 exec, -1
L_summed:
    s_mov_b32 s45, 245760
    buffer_load_dwordx4 v[126:129], v16, s[20:23], s45 offen offset:0 sc1
    buffer_load_dwordx4 v[130:133], v16, s[20:23], s45 offen offset:1024 sc1
    buffer_load_dwordx4 v[134:137], v16, s[20:23], s45 offen offset:2048 sc1
    buffer_load_dwordx4 v[138:141], v16, s[20:23], s45 offen offset:3072 sc1
    buffer_load_dwordx4 v[142:145], v17, s[20:23], s45 offen offset:0 sc1
    s_mov_b32 s45, 266240
    buffer_load_dwordx4 v[146:149], v16, s[20:23], s45 offen offset:0 sc1
    buffer_load_dwordx4 v[150:153], v16, s[20:23], s45 offen offset:1024 sc1
    buffer_load_dwordx4 v[154:157], v16, s[20:23], s45 offen offset:2048 sc1
    buffer_load_dwordx4 v[158:161], v16, s[20:23], s45 offen offset:3072 sc1
    buffer_load_dwordx4 v[162:165], v17, s[20:23], s45 offen offset:0 sc1
    s_mov_b32 s45, 122880
    buffer_load_dwordx4 a[216:219], v16, s[20:23], s45 offen offset:0 sc1
    buffer_load_dwordx4 a[220:223], v16, s[20:23], s45 offen offset:1024 sc1
    buffer_load_dwordx4 a[224:227], v16, s[20:23], s45 offen offset:2048 sc1
    buffer_load_dwordx4 a[228:231], v16, s[20:23], s45 offen offset:3072 sc1
    buffer_load_dwordx4 a[232:235], v17, s[20:23], s45 offen offset:0 sc1
    s_mov_b32 s45, 143360
    buffer_load_dwordx4 a[236:239], v16, s[20:23], s45 offen offset:0 sc1
    buffer_load_dwordx4 a[240:243], v16, s[20:23], s45 offen offset:1024 sc1
    buffer_load_dwordx4 a[244:247], v16, s[20:23], s45 offen offset:2048 sc1
    buffer_load_dwordx4 a[248:251], v16, s[20:23], s45 offen offset:3072 sc1
    buffer_load_dwordx4 a[252:255], v17, s[20:23], s45 offen offset:0 sc1
    v_mov_b32 v2, 3
    s_cmp_lg_u32 s5, 0
    s_cbranch_scc1 L_sum_flagged
    s_waitcnt vmcnt(20)
    s_mov_b64 exec, 1
    buffer_store_dword v2, off, s[76:79], s75 sc1
    s_mov_b64 exec, -1
L_sum_flagged:
    s_lshl_b32 s40, s87, 10
    s_add_u32 s40, s40, 0x292000
    v_and_b32 v1, 7, v19
    v_lshl_add_u32 v1, v1, 7, s40
    s_add_u32 m0, s46, 0
    s_mov_b32 s45, 327680
    buffer_load_dwordx4 v16, s[20:23], s45 offen offset:0 sc1 lds
    buffer_load_dwordx4 v16, s[20:23], s45 offen offset:1024 sc1 lds
    buffer_load_dwordx4 v16, s[20:23], s45 offen offset:2048 sc1 lds
    buffer_load_dwordx4 v16, s[20:23], s45 offen offset:3072 sc1 lds
    s_add_u32 m0, s46, 4096
    s_nop 0
    buffer_load_dwordx4 v17, s[20:23], s45 offen offset:0 sc1 lds
    s_add_u32 m0, s46, 5120
    s_mov_b32 s45, 348160
    buffer_load_dwordx4 v16, s[20:23], s45 offen offset:0 sc1 lds
    buffer_load_dwordx4 v16, s[20:23], s45 offen offset:1024 sc1 lds
    buffer_load_dwordx4 v16, s[20:23], s45 offen offset:2048 sc1 lds
    buffer_load_dwordx4 v16, s[20:23], s45 offen offset:3072 sc1 lds
    s_add_u32 m0, s46, 9216
    s_nop 0
    buffer_load_dwordx4 v17, s[20:23], s45 offen offset:0 sc1 lds
    buffer_load_dwordx4 v[252:255], v1, s[76:79], 0 offen sc1
    s_add_u32 m0, s46, 40960
    s_mov_b32 s45, 368640
    buffer_load_dwordx4 v16, s[20:23], s45 offen offset:0 sc1 lds
    buffer_load_dwordx4 v16, s[20:23], s45 offen offset:1024 sc1 lds
    buffer_load_dwordx4 v16, s[20:23], s45 offen offset:2048 sc1 lds
    buffer_load_dwordx4 v16, s[20:23], s45 offen offset:3072 sc1 lds
    s_add_u32 m0, s46, 45056
    s_nop 0
    buffer_load_dwordx4 v17, s[20:23], s45 offen offset:0 sc1 lds
    s_add_u32 m0, s46, 46080
    s_mov_b32 s45, 389120
    buffer_load_dwordx4 v16, s[20:23], s45 offen offset:0 sc1 lds
    buffer_load_dwordx4 v16, s[20:23], s45 offen offset:1024 sc1 lds
    buffer_load_dwordx4 v16, s[20:23], s45 offen offset:2048 sc1 lds
    buffer_load_dwordx4 v16, s[20:23], s45 offen offset:3072 sc1 lds
    s_add_u32 m0, s46, 50176
    s_nop 0
    buffer_load_dwordx4 v17, s[20:23], s45 offen offset:0 sc1 lds
    s_add_u32 m0, s46, 81920
    s_mov_b32 s45, 409600
    buffer_load_dwordx4 v16, s[20:23], s45 offen offset:0 sc1 lds
    buffer_load_dwordx4 v16, s[20:23], s45 offen offset:1024 sc1 lds
    buffer_load_dwordx4 v16, s[20:23], s45 offen offset:2048 sc1 lds
    buffer_load_dwordx4 v16, s[20:23], s45 offen offset:3072 sc1 lds
    s_add_u32 m0, s46, 86016
    s_nop 0
    buffer_load_dwordx4 v17, s[20:23], s45 offen offset:0 sc1 lds
    s_add_u32 m0, s46, 87040
    s_mov_b32 s45, 430080
    buffer_load_dwordx4 v16, s[20:23], s45 offen offset:0 sc1 lds
    buffer_load_dwordx4 v16, s[20:23], s45 offen offset:1024 sc1 lds
    buffer_load_dwordx4 v16, s[20:23], s45 offen offset:2048 sc1 lds
    buffer_load_dwordx4 v16, s[20:23], s45 offen offset:3072 sc1 lds
    s_add_u32 m0, s46, 91136
    s_nop 0
    buffer_load_dwordx4 v17, s[20:23], s45 offen offset:0 sc1 lds
    s_cmp_lg_u32 s5, 0
    s_cbranch_scc1 L_back_o
    s_waitcnt vmcnt(20)
    v_min3_u32 v252, v252, v253, v254
    v_min_u32 v252, v252, v255
    v_cmp_gt_u32 vcc, 1, v252
    s_and_b64 vcc, vcc, exec
    s_cbranch_scc1 L_spin_o
L_back_o:
    s_barrier
    s_mov_b32 s44, 0
    buffer_load_dwordx4 a[0:3], v4, s[8:11], s44 offen sc1
    buffer_load_dwordx4 a[4:7], v5, s[8:11], s44 offen sc1
    buffer_load_dwordx4 a[8:11], v6, s[8:11], s44 offen sc1
    buffer_load_dwordx4 a[12:15], v7, s[8:11], s44 offen sc1
    s_mov_b32 s44, 16384
    buffer_load_dwordx4 a[16:19], v4, s[8:11], s44 offen sc1
    buffer_load_dwordx4 a[20:23], v5, s[8:11], s44 offen sc1
    buffer_load_dwordx4 a[24:27], v6, s[8:11], s44 offen sc1
    buffer_load_dwordx4 a[28:31], v7, s[8:11], s44 offen sc1
    s_mov_b32 s44, 32768
    buffer_load_dwordx4 a[32:35], v4, s[8:11], s44 offen sc1
    buffer_load_dwordx4 a[36:39], v5, s[8:11], s44 offen sc1
    buffer_load_dwordx4 a[40:43], v6, s[8:11], s44 offen sc1
    buffer_load_dwordx4 a[44:47], v7, s[8:11], s44 offen sc1
    s_mov_b32 s44, 49152
    buffer_load_dwordx4 a[48:51], v4, s[8:11], s44 offen sc1
    buffer_load_dwordx4 a[52:55], v5, s[8:11], s44 offen sc1
    buffer_load_dwordx4 a[56:59], v6, s[8:11], s44 offen sc1
    buffer_load_dwordx4 a[60:63], v7, s[8:11], s44 offen sc1
    s_waitcnt vmcnt(8)
    v_mfma_f32_16x16x32_bf16 v[166:169], a[96:99], a[0:3], 0
    s_mov_b32 s44, 65536
    buffer_load_dwordx4 a[64:67], v4, s[8:11], s44 offen sc1
    v_mfma_f32_16x16x32_bf16 v[166:169], a[116:119], a[16:19], v[166:169]
    v_mfma_f32_16x16x32_bf16 v[186:189], a[116:119], a[20:23], 0
    v_mfma_f32_16x16x32_bf16 v[186:189], a[96:99], a[4:7], v[186:189]
    v_mfma_f32_16x16x32_bf16 v[206:209], a[96:99], a[8:11], 0
    buffer_load_dwordx4 a[68:71], v5, s[8:11], s44 offen sc1
    v_mfma_f32_16x16x32_bf16 v[206:209], a[116:119], a[24:27], v[206:209]
    v_mfma_f32_16x16x32_bf16 v[226:229], a[116:119], a[28:31], 0
    v_mfma_f32_16x16x32_bf16 v[226:229], a[96:99], a[12:15], v[226:229]
    v_mfma_f32_16x16x32_bf16 v[170:173], a[100:103], a[0:3], 0
    v_mfma_f32_16x16x32_bf16 v[170:173], a[120:123], a[16:19], v[170:173]
    buffer_load_dwordx4 a[72:75], v6, s[8:11], s44 offen sc1
    v_mfma_f32_16x16x32_bf16 v[190:193], a[120:123], a[20:23], 0
    v_mfma_f32_16x16x32_bf16 v[190:193], a[100:103], a[4:7], v[190:193]
    v_mfma_f32_16x16x32_bf16 v[210:213], a[100:103], a[8:11], 0
    v_mfma_f32_16x16x32_bf16 v[210:213], a[120:123], a[24:27], v[210:213]
    v_mfma_f32_16x16x32_bf16 v[230:233], a[120:123], a[28:31], 0
    buffer_load_dwordx4 a[76:79], v7, s[8:11], s44 offen sc1
    v_mfma_f32_16x16x32_bf16 v[230:233], a[100:103], a[12:15], v[230:233]
    v_mfma_f32_16x16x32_bf16 v[174:177], a[104:107], a[0:3], 0
    v_mfma_f32_16x16x32_bf16 v[174:177], a[124:127], a[16:19], v[174:177]
    v_mfma_f32_16x16x32_bf16 v[194:197], a[124:127], a[20:23], 0
    v_mfma_f32_16x16x32_bf16 v[194:197], a[104:107], a[4:7], v[194:197]
    s_mov_b32 s44, 81920
    buffer_load_dwordx4 a[80:83], v4, s[8:11], s44 offen sc1
    v_mfma_f32_16x16x32_bf16 v[214:217], a[104:107], a[8:11], 0
    v_mfma_f32_16x16x32_bf16 v[214:217], a[124:127], a[24:27], v[214:217]
    v_mfma_f32_16x16x32_bf16 v[234:237], a[124:127], a[28:31], 0
    v_mfma_f32_16x16x32_bf16 v[234:237], a[104:107], a[12:15], v[234:237]
    buffer_load_dwordx4 a[84:87], v5, s[8:11], s44 offen sc1
    v_mfma_f32_16x16x32_bf16 v[178:181], a[108:111], a[0:3], 0
    v_mfma_f32_16x16x32_bf16 v[178:181], a[128:131], a[16:19], v[178:181]
    v_mfma_f32_16x16x32_bf16 v[198:201], a[128:131], a[20:23], 0
    v_mfma_f32_16x16x32_bf16 v[198:201], a[108:111], a[4:7], v[198:201]
    v_mfma_f32_16x16x32_bf16 v[218:221], a[108:111], a[8:11], 0
    buffer_load_dwordx4 a[88:91], v6, s[8:11], s44 offen sc1
    v_mfma_f32_16x16x32_bf16 v[218:221], a[128:131], a[24:27], v[218:221]
    v_mfma_f32_16x16x32_bf16 v[238:241], a[128:131], a[28:31], 0
    v_mfma_f32_16x16x32_bf16 v[238:241], a[108:111], a[12:15], v[238:241]
    v_mfma_f32_16x16x32_bf16 v[182:185], a[112:115], a[0:3], 0
    v_mfma_f32_16x16x32_bf16 v[182:185], a[132:135], a[16:19], v[182:185]
    buffer_load_dwordx4 a[92:95], v7, s[8:11], s44 offen sc1
    v_mfma_f32_16x16x32_bf16 v[202:205], a[132:135], a[20:23], 0
    v_mfma_f32_16x16x32_bf16 v[202:205], a[112:115], a[4:7], v[202:205]
    v_mfma_f32_16x16x32_bf16 v[222:225], a[112:115], a[8:11], 0
    v_mfma_f32_16x16x32_bf16 v[222:225], a[132:135], a[24:27], v[222:225]
    v_mfma_f32_16x16x32_bf16 v[242:245], a[132:135], a[28:31], 0
    v_mfma_f32_16x16x32_bf16 v[242:245], a[112:115], a[12:15], v[242:245]
    s_waitcnt vmcnt(8)
    v_mfma_f32_16x16x32_bf16 v[166:169], a[136:139], a[32:35], v[166:169]
    s_mov_b32 s44, 98304
    buffer_load_dwordx4 a[0:3], v4, s[8:11], s44 offen sc1
    v_mfma_f32_16x16x32_bf16 v[166:169], a[156:159], a[48:51], v[166:169]
    v_mfma_f32_16x16x32_bf16 v[186:189], a[156:159], a[52:55], v[186:189]
    buffer_load_dwordx4 a[4:7], v5, s[8:11], s44 offen sc1
    v_mfma_f32_16x16x32_bf16 v[186:189], a[136:139], a[36:39], v[186:189]
    v_mfma_f32_16x16x32_bf16 v[206:209], a[136:139], a[40:43], v[206:209]
    v_mfma_f32_16x16x32_bf16 v[206:209], a[156:159], a[56:59], v[206:209]
    buffer_load_dwordx4 a[8:11], v6, s[8:11], s44 offen sc1
    v_mfma_f32_16x16x32_bf16 v[226:229], a[156:159], a[60:63], v[226:229]
    v_mfma_f32_16x16x32_bf16 v[226:229], a[136:139], a[44:47], v[226:229]
    v_mfma_f32_16x16x32_bf16 v[170:173], a[140:143], a[32:35], v[170:173]
    buffer_load_dwordx4 a[12:15], v7, s[8:11], s44 offen sc1
    v_mfma_f32_16x16x32_bf16 v[170:173], a[160:163], a[48:51], v[170:173]
    v_mfma_f32_16x16x32_bf16 v[190:193], a[160:163], a[52:55], v[190:193]
    v_mfma_f32_16x16x32_bf16 v[190:193], a[140:143], a[36:39], v[190:193]
    s_mov_b32 s44, 114688
    buffer_load_dwordx4 a[16:19], v4, s[8:11], s44 offen sc1
    v_mfma_f32_16x16x32_bf16 v[210:213], a[140:143], a[40:43], v[210:213]
    v_mfma_f32_16x16x32_bf16 v[210:213], a[160:163], a[56:59], v[210:213]
    v_mfma_f32_16x16x32_bf16 v[230:233], a[160:163], a[60:63], v[230:233]
    buffer_load_dwordx4 a[20:23], v5, s[8:11], s44 offen sc1
    v_mfma_f32_16x16x32_bf16 v[230:233], a[140:143], a[44:47], v[230:233]
    v_mfma_f32_16x16x32_bf16 v[174:177], a[144:147], a[32:35], v[174:177]
    v_mfma_f32_16x16x32_bf16 v[174:177], a[164:167], a[48:51], v[174:177]
    buffer_load_dwordx4 a[24:27], v6, s[8:11], s44 offen sc1
    v_mfma_f32_16x16x32_bf16 v[194:197], a[164:167], a[52:55], v[194:197]
    v_mfma_f32_16x16x32_bf16 v[194:197], a[144:147], a[36:39], v[194:197]
    v_mfma_f32_16x16x32_bf16 v[214:217], a[144:147], a[40:43], v[214:217]
    buffer_load_dwordx4 a[28:31], v7, s[8:11], s44 offen sc1
    v_mfma_f32_16x16x32_bf16 v[214:217], a[164:167], a[56:59], v[214:217]
    v_mfma_f32_16x16x32_bf16 v[234:237], a[164:167], a[60:63], v[234:237]
    v_mfma_f32_16x16x32_bf16 v[234:237], a[144:147], a[44:47], v[234:237]
    s_mov_b32 s45, 450560
    buffer_load_dwordx4 a[96:99], v16, s[20:23], s45 offen offset:0 sc1
    v_mfma_f32_16x16x32_bf16 v[178:181], a[148:151], a[32:35], v[178:181]
    v_mfma_f32_16x16x32_bf16 v[178:181], a[168:171], a[48:51], v[178:181]
    v_mfma_f32_16x16x32_bf16 v[198:201], a[168:171], a[52:55], v[198:201]
    buffer_load_dwordx4 a[100:103], v16, s[20:23], s45 offen offset:1024 sc1
    v_mfma_f32_16x16x32_bf16 v[198:201], a[148:151], a[36:39], v[198:201]
    v_mfma_f32_16x16x32_bf16 v[218:221], a[148:151], a[40:43], v[218:221]
    v_mfma_f32_16x16x32_bf16 v[218:221], a[168:171], a[56:59], v[218:221]
    buffer_load_dwordx4 a[104:107], v16, s[20:23], s45 offen offset:2048 sc1
    v_mfma_f32_16x16x32_bf16 v[238:241], a[168:171], a[60:63], v[238:241]
    v_mfma_f32_16x16x32_bf16 v[238:241], a[148:151], a[44:47], v[238:241]
    v_mfma_f32_16x16x32_bf16 v[182:185], a[152:155], a[32:35], v[182:185]
    buffer_load_dwordx4 a[108:111], v16, s[20:23], s45 offen offset:3072 sc1
    v_mfma_f32_16x16x32_bf16 v[182:185], a[172:175], a[48:51], v[182:185]
    v_mfma_f32_16x16x32_bf16 v[202:205], a[172:175], a[52:55], v[202:205]
    v_mfma_f32_16x16x32_bf16 v[202:205], a[152:155], a[36:39], v[202:205]
    buffer_load_dwordx4 a[112:115], v17, s[20:23], s45 offen offset:0 sc1
    v_mfma_f32_16x16x32_bf16 v[222:225], a[152:155], a[40:43], v[222:225]
    v_mfma_f32_16x16x32_bf16 v[222:225], a[172:175], a[56:59], v[222:225]
    v_mfma_f32_16x16x32_bf16 v[242:245], a[172:175], a[60:63], v[242:245]
    v_mfma_f32_16x16x32_bf16 v[242:245], a[152:155], a[44:47], v[242:245]
    s_waitcnt vmcnt(13)
    v_mfma_f32_16x16x32_bf16 v[166:169], a[176:179], a[64:67], v[166:169]
    s_mov_b32 s44, 131072
    buffer_load_dwordx4 a[32:35], v4, s[8:11], s44 offen sc1
    v_mfma_f32_16x16x32_bf16 v[166:169], a[196:199], a[80:83], v[166:169]
    v_mfma_f32_16x16x32_bf16 v[186:189], a[196:199], a[84:87], v[186:189]
    buffer_load_dwordx4 a[36:39], v5, s[8:11], s44 offen sc1
    v_mfma_f32_16x16x32_bf16 v[186:189], a[176:179], a[68:71], v[186:189]
    v_mfma_f32_16x16x32_bf16 v[206:209], a[176:179], a[72:75], v[206:209]
    v_mfma_f32_16x16x32_bf16 v[206:209], a[196:199], a[88:91], v[206:209]
    buffer_load_dwordx4 a[40:43], v6, s[8:11], s44 offen sc1
    v_mfma_f32_16x16x32_bf16 v[226:229], a[196:199], a[92:95], v[226:229]
    v_mfma_f32_16x16x32_bf16 v[226:229], a[176:179], a[76:79], v[226:229]
    v_mfma_f32_16x16x32_bf16 v[170:173], a[180:183], a[64:67], v[170:173]
    buffer_load_dwordx4 a[44:47], v7, s[8:11], s44 offen sc1
    v_mfma_f32_16x16x32_bf16 v[170:173], a[200:203], a[80:83], v[170:173]
    v_mfma_f32_16x16x32_bf16 v[190:193], a[200:203], a[84:87], v[190:193]
    v_mfma_f32_16x16x32_bf16 v[190:193], a[180:183], a[68:71], v[190:193]
    s_mov_b32 s44, 147456
    buffer_load_dwordx4 a[48:51], v4, s[8:11], s44 offen sc1
    v_mfma_f32_16x16x32_bf16 v[210:213], a[180:183], a[72:75], v[210:213]
    v_mfma_f32_16x16x32_bf16 v[210:213], a[200:203], a[88:91], v[210:213]
    v_mfma_f32_16x16x32_bf16 v[230:233], a[200:203], a[92:95], v[230:233]
    buffer_load_dwordx4 a[52:55], v5, s[8:11], s44 offen sc1
    v_mfma_f32_16x16x32_bf16 v[230:233], a[180:183], a[76:79], v[230:233]
    v_mfma_f32_16x16x32_bf16 v[174:177], a[184:187], a[64:67], v[174:177]
    v_mfma_f32_16x16x32_bf16 v[174:177], a[204:207], a[80:83], v[174:177]
    buffer_load_dwordx4 a[56:59], v6, s[8:11], s44 offen sc1
    v_mfma_f32_16x16x32_bf16 v[194:197], a[204:207], a[84:87], v[194:197]
    v_mfma_f32_16x16x32_bf16 v[194:197], a[184:187], a[68:71], v[194:197]
    v_mfma_f32_16x16x32_bf16 v[214:217], a[184:187], a[72:75], v[214:217]
    buffer_load_dwordx4 a[60:63], v7, s[8:11], s44 offen sc1
    v_mfma_f32_16x16x32_bf16 v[214:217], a[204:207], a[88:91], v[214:217]
    v_mfma_f32_16x16x32_bf16 v[234:237], a[204:207], a[92:95], v[234:237]
    v_mfma_f32_16x16x32_bf16 v[234:237], a[184:187], a[76:79], v[234:237]
    s_mov_b32 s45, 471040
    buffer_load_dwordx4 a[116:119], v16, s[20:23], s45 offen offset:0 sc1
    v_mfma_f32_16x16x32_bf16 v[178:181], a[188:191], a[64:67], v[178:181]
    v_mfma_f32_16x16x32_bf16 v[178:181], a[208:211], a[80:83], v[178:181]
    v_mfma_f32_16x16x32_bf16 v[198:201], a[208:211], a[84:87], v[198:201]
    buffer_load_dwordx4 a[120:123], v16, s[20:23], s45 offen offset:1024 sc1
    v_mfma_f32_16x16x32_bf16 v[198:201], a[188:191], a[68:71], v[198:201]
    v_mfma_f32_16x16x32_bf16 v[218:221], a[188:191], a[72:75], v[218:221]
    v_mfma_f32_16x16x32_bf16 v[218:221], a[208:211], a[88:91], v[218:221]
    buffer_load_dwordx4 a[124:127], v16, s[20:23], s45 offen offset:2048 sc1
    v_mfma_f32_16x16x32_bf16 v[238:241], a[208:211], a[92:95], v[238:241]
    v_mfma_f32_16x16x32_bf16 v[238:241], a[188:191], a[76:79], v[238:241]
    v_mfma_f32_16x16x32_bf16 v[182:185], a[192:195], a[64:67], v[182:185]
    buffer_load_dwordx4 a[128:131], v16, s[20:23], s45 offen offset:3072 sc1
    v_mfma_f32_16x16x32_bf16 v[182:185], a[212:215], a[80:83], v[182:185]
    v_mfma_f32_16x16x32_bf16 v[202:205], a[212:215], a[84:87], v[202:205]
    v_mfma_f32_16x16x32_bf16 v[202:205], a[192:195], a[68:71], v[202:205]
    buffer_load_dwordx4 a[132:135], v17, s[20:23], s45 offen offset:0 sc1
    v_mfma_f32_16x16x32_bf16 v[222:225], a[192:195], a[72:75], v[222:225]
    v_mfma_f32_16x16x32_bf16 v[222:225], a[212:215], a[88:91], v[222:225]
    v_mfma_f32_16x16x32_bf16 v[242:245], a[212:215], a[92:95], v[242:245]
    v_mfma_f32_16x16x32_bf16 v[242:245], a[192:195], a[76:79], v[242:245]
    s_waitcnt vmcnt(18)
    v_mfma_f32_16x16x32_bf16 v[166:169], a[216:219], a[0:3], v[166:169]
    s_mov_b32 s44, 163840
    buffer_load_dwordx4 a[64:67], v4, s[8:11], s44 offen sc1
    v_mfma_f32_16x16x32_bf16 v[166:169], a[236:239], a[16:19], v[166:169]
    v_mfma_f32_16x16x32_bf16 v[186:189], a[236:239], a[20:23], v[186:189]
    buffer_load_dwordx4 a[68:71], v5, s[8:11], s44 offen sc1
    v_mfma_f32_16x16x32_bf16 v[186:189], a[216:219], a[4:7], v[186:189]
    v_mfma_f32_16x16x32_bf16 v[206:209], a[216:219], a[8:11], v[206:209]
    v_mfma_f32_16x16x32_bf16 v[206:209], a[236:239], a[24:27], v[206:209]
    buffer_load_dwordx4 a[72:75], v6, s[8:11], s44 offen sc1
    v_mfma_f32_16x16x32_bf16 v[226:229], a[236:239], a[28:31], v[226:229]
    v_mfma_f32_16x16x32_bf16 v[226:229], a[216:219], a[12:15], v[226:229]
    v_mfma_f32_16x16x32_bf16 v[170:173], a[220:223], a[0:3], v[170:173]
    buffer_load_dwordx4 a[76:79], v7, s[8:11], s44 offen sc1
    v_mfma_f32_16x16x32_bf16 v[170:173], a[240:243], a[16:19], v[170:173]
    v_mfma_f32_16x16x32_bf16 v[190:193], a[240:243], a[20:23], v[190:193]
    v_mfma_f32_16x16x32_bf16 v[190:193], a[220:223], a[4:7], v[190:193]
    s_mov_b32 s44, 180224
    buffer_load_dwordx4 a[80:83], v4, s[8:11], s44 offen sc1
    v_mfma_f32_16x16x32_bf16 v[210:213], a[220:223], a[8:11], v[210:213]
    v_mfma_f32_16x16x32_bf16 v[210:213], a[240:243], a[24:27], v[210:213]
    v_mfma_f32_16x16x32_bf16 v[230:233], a[240:243], a[28:31], v[230:233]
    buffer_load_dwordx4 a[84:87], v5, s[8:11], s44 offen sc1
    v_mfma_f32_16x16x32_bf16 v[230:233], a[220:223], a[12:15], v[230:233]
    v_mfma_f32_16x16x32_bf16 v[174:177], a[224:227], a[0:3], v[174:177]
    v_mfma_f32_16x16x32_bf16 v[174:177], a[244:247], a[16:19], v[174:177]
    buffer_load_dwordx4 a[88:91], v6, s[8:11], s44 offen sc1
    v_mfma_f32_16x16x32_bf16 v[194:197], a[244:247], a[20:23], v[194:197]
    v_mfma_f32_16x16x32_bf16 v[194:197], a[224:227], a[4:7], v[194:197]
    v_mfma_f32_16x16x32_bf16 v[214:217], a[224:227], a[8:11], v[214:217]
    buffer_load_dwordx4 a[92:95], v7, s[8:11], s44 offen sc1
    v_mfma_f32_16x16x32_bf16 v[214:217], a[244:247], a[24:27], v[214:217]
    v_mfma_f32_16x16x32_bf16 v[234:237], a[244:247], a[28:31], v[234:237]
    v_mfma_f32_16x16x32_bf16 v[234:237], a[224:227], a[12:15], v[234:237]
    s_mov_b32 s45, 491520
    buffer_load_dwordx4 a[136:139], v16, s[20:23], s45 offen offset:0 sc1
    v_mfma_f32_16x16x32_bf16 v[178:181], a[228:231], a[0:3], v[178:181]
    v_mfma_f32_16x16x32_bf16 v[178:181], a[248:251], a[16:19], v[178:181]
    v_mfma_f32_16x16x32_bf16 v[198:201], a[248:251], a[20:23], v[198:201]
    buffer_load_dwordx4 a[140:143], v16, s[20:23], s45 offen offset:1024 sc1
    v_mfma_f32_16x16x32_bf16 v[198:201], a[228:231], a[4:7], v[198:201]
    v_mfma_f32_16x16x32_bf16 v[218:221], a[228:231], a[8:11], v[218:221]
    v_mfma_f32_16x16x32_bf16 v[218:221], a[248:251], a[24:27], v[218:221]
    buffer_load_dwordx4 a[144:147], v16, s[20:23], s45 offen offset:2048 sc1
    v_mfma_f32_16x16x32_bf16 v[238:241], a[248:251], a[28:31], v[238:241]
    v_mfma_f32_16x16x32_bf16 v[238:241], a[228:231], a[12:15], v[238:241]
    v_mfma_f32_16x16x32_bf16 v[182:185], a[232:235], a[0:3], v[182:185]
    buffer_load_dwordx4 a[148:151], v16, s[20:23], s45 offen offset:3072 sc1
    v_mfma_f32_16x16x32_bf16 v[182:185], a[252:255], a[16:19], v[182:185]
    v_mfma_f32_16x16x32_bf16 v[202:205], a[252:255], a[20:23], v[202:205]
    v_mfma_f32_16x16x32_bf16 v[202:205], a[232:235], a[4:7], v[202:205]
    buffer_load_dwordx4 a[152:155], v17, s[20:23], s45 offen offset:0 sc1
    v_mfma_f32_16x16x32_bf16 v[222:225], a[232:235], a[8:11], v[222:225]
    v_mfma_f32_16x16x32_bf16 v[222:225], a[252:255], a[24:27], v[222:225]
    v_mfma_f32_16x16x32_bf16 v[242:245], a[252:255], a[28:31], v[242:245]
    v_mfma_f32_16x16x32_bf16 v[242:245], a[232:235], a[12:15], v[242:245]
    s_waitcnt vmcnt(18)
    v_mfma_f32_16x16x32_bf16 v[166:169], v[46:49], a[32:35], v[166:169]
    s_mov_b32 s44, 196608
    buffer_load_dwordx4 a[0:3], v4, s[8:11], s44 offen sc1
    v_mfma_f32_16x16x32_bf16 v[166:169], v[66:69], a[48:51], v[166:169]
    v_mfma_f32_16x16x32_bf16 v[186:189], v[66:69], a[52:55], v[186:189]
    buffer_load_dwordx4 a[4:7], v5, s[8:11], s44 offen sc1
    v_mfma_f32_16x16x32_bf16 v[186:189], v[46:49], a[36:39], v[186:189]
    v_mfma_f32_16x16x32_bf16 v[206:209], v[46:49], a[40:43], v[206:209]
    v_mfma_f32_16x16x32_bf16 v[206:209], v[66:69], a[56:59], v[206:209]
    buffer_load_dwordx4 a[8:11], v6, s[8:11], s44 offen sc1
    v_mfma_f32_16x16x32_bf16 v[226:229], v[66:69], a[60:63], v[226:229]
    v_mfma_f32_16x16x32_bf16 v[226:229], v[46:49], a[44:47], v[226:229]
    v_mfma_f32_16x16x32_bf16 v[170:173], v[50:53], a[32:35], v[170:173]
    buffer_load_dwordx4 a[12:15], v7, s[8:11], s44 offen sc1
    v_mfma_f32_16x16x32_bf16 v[170:173], v[70:73], a[48:51], v[170:173]
    v_mfma_f32_16x16x32_bf16 v[190:193], v[70:73], a[52:55], v[190:193]
    v_mfma_f32_16x16x32_bf16 v[190:193], v[50:53], a[36:39], v[190:193]
    s_mov_b32 s44, 212992
    buffer_load_dwordx4 a[16:19], v4, s[8:11], s44 offen sc1
    v_mfma_f32_16x16x32_bf16 v[210:213], v[50:53], a[40:43], v[210:213]
    v_mfma_f32_16x16x32_bf16 v[210:213], v[70:73], a[56:59], v[210:213]
    v_mfma_f32_16x16x32_bf16 v[230:233], v[70:73], a[60:63], v[230:233]
    buffer_load_dwordx4 a[20:23], v5, s[8:11], s44 offen sc1
    v_mfma_f32_16x16x32_bf16 v[230:233], v[50:53], a[44:47], v[230:233]
    v_mfma_f32_16x16x32_bf16 v[174:177], v[54:57], a[32:35], v[174:177]
    v_mfma_f32_16x16x32_bf16 v[174:177], v[74:77], a[48:51], v[174:177]
    buffer_load_dwordx4 a[24:27], v6, s[8:11], s44 offen sc1
    v_mfma_f32_16x16x32_bf16 v[194:197], v[74:77], a[52:55], v[194:197]
    v_mfma_f32_16x16x32_bf16 v[194:197], v[54:57], a[36:39], v[194:197]
    v_mfma_f32_16x16x32_bf16 v[214:217], v[54:57], a[40:43], v[214:217]
    buffer_load_dwordx4 a[28:31], v7, s[8:11], s44 offen sc1
    v_mfma_f32_16x16x32_bf16 v[214:217], v[74:77], a[56:59], v[214:217]
    v_mfma_f32_16x16x32_bf16 v[234:237], v[74:77], a[60:63], v[234:237]
    v_mfma_f32_16x16x32_bf16 v[234:237], v[54:57], a[44:47], v[234:237]
    s_mov_b32 s45, 512000
    buffer_load_dwordx4 a[156:159], v16, s[20:23], s45 offen offset:0 sc1
    v_mfma_f32_16x16x32_bf16 v[178:181], v[58:61], a[32:35], v[178:181]
    v_mfma_f32_16x16x32_bf16 v[178:181], v[78:81], a[48:51], v[178:181]
    v_mfma_f32_16x16x32_bf16 v[198:201], v[78:81], a[52:55], v[198:201]
    buffer_load_dwordx4 a[160:163], v16, s[20:23], s45 offen offset:1024 sc1
    v_mfma_f32_16x16x32_bf16 v[198:201], v[58:61], a[36:39], v[198:201]
    v_mfma_f32_16x16x32_bf16 v[218:221], v[58:61], a[40:43], v[218:221]
    v_mfma_f32_16x16x32_bf16 v[218:221], v[78:81], a[56:59], v[218:221]
    buffer_load_dwordx4 a[164:167], v16, s[20:23], s45 offen offset:2048 sc1
    v_mfma_f32_16x16x32_bf16 v[238:241], v[78:81], a[60:63], v[238:241]
    v_mfma_f32_16x16x32_bf16 v[238:241], v[58:61], a[44:47], v[238:241]
    v_mfma_f32_16x16x32_bf16 v[182:185], v[62:65], a[32:35], v[182:185]
    buffer_load_dwordx4 a[168:171], v16, s[20:23], s45 offen offset:3072 sc1
    v_mfma_f32_16x16x32_bf16 v[182:185], v[82:85], a[48:51], v[182:185]
    v_mfma_f32_16x16x32_bf16 v[202:205], v[82:85], a[52:55], v[202:205]
    v_mfma_f32_16x16x32_bf16 v[202:205], v[62:65], a[36:39], v[202:205]
    buffer_load_dwordx4 a[172:175], v17, s[20:23], s45 offen offset:0 sc1
    v_mfma_f32_16x16x32_bf16 v[222:225], v[62:65], a[40:43], v[222:225]
    v_mfma_f32_16x16x32_bf16 v[222:225], v[82:85], a[56:59], v[222:225]
    v_mfma_f32_16x16x32_bf16 v[242:245], v[82:85], a[60:63], v[242:245]
    v_mfma_f32_16x16x32_bf16 v[242:245], v[62:65], a[44:47], v[242:245]
    s_waitcnt vmcnt(18)
    v_mfma_f32_16x16x32_bf16 v[166:169], v[86:89], a[64:67], v[166:169]
    s_mov_b32 s44, 229376
    buffer_load_dwordx4 a[32:35], v4, s[8:11], s44 offen sc1
    v_mfma_f32_16x16x32_bf16 v[166:169], v[106:109], a[80:83], v[166:169]
    v_mfma_f32_16x16x32_bf16 v[186:189], v[106:109], a[84:87], v[186:189]
    buffer_load_dwordx4 a[36:39], v5, s[8:11], s44 offen sc1
    v_mfma_f32_16x16x32_bf16 v[186:189], v[86:89], a[68:71], v[186:189]
    v_mfma_f32_16x16x32_bf16 v[206:209], v[86:89], a[72:75], v[206:209]
    v_mfma_f32_16x16x32_bf16 v[206:209], v[106:109], a[88:91], v[206:209]
    buffer_load_dwordx4 a[40:43], v6, s[8:11], s44 offen sc1
    v_mfma_f32_16x16x32_bf16 v[226:229], v[106:109], a[92:95], v[226:229]
    v_mfma_f32_16x16x32_bf16 v[226:229], v[86:89], a[76:79], v[226:229]
    v_mfma_f32_16x16x32_bf16 v[170:173], v[90:93], a[64:67], v[170:173]
    buffer_load_dwordx4 a[44:47], v7, s[8:11], s44 offen sc1
    v_mfma_f32_16x16x32_bf16 v[170:173], v[110:113], a[80:83], v[170:173]
    v_mfma_f32_16x16x32_bf16 v[190:193], v[110:113], a[84:87], v[190:193]
    v_mfma_f32_16x16x32_bf16 v[190:193], v[90:93], a[68:71], v[190:193]
    s_mov_b32 s44, 245760
    buffer_load_dwordx4 a[48:51], v4, s[8:11], s44 offen sc1
    v_mfma_f32_16x16x32_bf16 v[210:213], v[90:93], a[72:75], v[210:213]
    v_mfma_f32_16x16x32_bf16 v[210:213], v[110:113], a[88:91], v[210:213]
    v_mfma_f32_16x16x32_bf16 v[230:233], v[110:113], a[92:95], v[230:233]
    buffer_load_dwordx4 a[52:55], v5, s[8:11], s44 offen sc1
    v_mfma_f32_16x16x32_bf16 v[230:233], v[90:93], a[76:79], v[230:233]
    v_mfma_f32_16x16x32_bf16 v[174:177], v[94:97], a[64:67], v[174:177]
    v_mfma_f32_16x16x32_bf16 v[174:177], v[114:117], a[80:83], v[174:177]
    buffer_load_dwordx4 a[56:59], v6, s[8:11], s44 offen sc1
    v_mfma_f32_16x16x32_bf16 v[194:197], v[114:117], a[84:87], v[194:197]
    v_mfma_f32_16x16x32_bf16 v[194:197], v[94:97], a[68:71], v[194:197]
    v_mfma_f32_16x16x32_bf16 v[214:217], v[94:97], a[72:75], v[214:217]
    buffer_load_dwordx4 a[60:63], v7, s[8:11], s44 offen sc1
    v_mfma_f32_16x16x32_bf16 v[214:217], v[114:117], a[88:91], v[214:217]
    v_mfma_f32_16x16x32_bf16 v[234:237], v[114:117], a[92:95], v[234:237]
    v_mfma_f32_16x16x32_bf16 v[234:237], v[94:97], a[76:79], v[234:237]
    s_mov_b32 s45, 532480
    buffer_load_dwordx4 a[176:179], v16, s[20:23], s45 offen offset:0 sc1
    v_mfma_f32_16x16x32_bf16 v[178:181], v[98:101], a[64:67], v[178:181]
    v_mfma_f32_16x16x32_bf16 v[178:181], v[118:121], a[80:83], v[178:181]
    v_mfma_f32_16x16x32_bf16 v[198:201], v[118:121], a[84:87], v[198:201]
    buffer_load_dwordx4 a[180:183], v16, s[20:23], s45 offen offset:1024 sc1
    v_mfma_f32_16x16x32_bf16 v[198:201], v[98:101], a[68:71], v[198:201]
    v_mfma_f32_16x16x32_bf16 v[218:221], v[98:101], a[72:75], v[218:221]
    v_mfma_f32_16x16x32_bf16 v[218:221], v[118:121], a[88:91], v[218:221]
    buffer_load_dwordx4 a[184:187], v16, s[20:23], s45 offen offset:2048 sc1
    v_mfma_f32_16x16x32_bf16 v[238:241], v[118:121], a[92:95], v[238:241]
    v_mfma_f32_16x16x32_bf16 v[238:241], v[98:101], a[76:79], v[238:241]
    v_mfma_f32_16x16x32_bf16 v[182:185], v[102:105], a[64:67], v[182:185]
    buffer_load_dwordx4 a[188:191], v16, s[20:23], s45 offen offset:3072 sc1
    v_mfma_f32_16x16x32_bf16 v[182:185], v[122:125], a[80:83], v[182:185]
    v_mfma_f32_16x16x32_bf16 v[202:205], v[122:125], a[84:87], v[202:205]
    v_mfma_f32_16x16x32_bf16 v[202:205], v[102:105], a[68:71], v[202:205]
    buffer_load_dwordx4 a[192:195], v17, s[20:23], s45 offen offset:0 sc1
    v_mfma_f32_16x16x32_bf16 v[222:225], v[102:105], a[72:75], v[222:225]
    v_mfma_f32_16x16x32_bf16 v[222:225], v[122:125], a[88:91], v[222:225]
    v_mfma_f32_16x16x32_bf16 v[242:245], v[122:125], a[92:95], v[242:245]
    v_mfma_f32_16x16x32_bf16 v[242:245], v[102:105], a[76:79], v[242:245]
    s_waitcnt vmcnt(18)
    v_mfma_f32_16x16x32_bf16 v[166:169], v[126:129], a[0:3], v[166:169]
    s_mov_b32 s44, 262144
    buffer_load_dwordx4 a[64:67], v4, s[8:11], s44 offen sc1
    v_mfma_f32_16x16x32_bf16 v[166:169], v[146:149], a[16:19], v[166:169]
    ds_read_b128 v[86:89], v10 offset:40960
    v_mfma_f32_16x16x32_bf16 v[186:189], v[146:149], a[20:23], v[186:189]
    buffer_load_dwordx4 a[68:71], v5, s[8:11], s44 offen sc1
    v_mfma_f32_16x16x32_bf16 v[186:189], v[126:129], a[4:7], v[186:189]
    v_mfma_f32_16x16x32_bf16 v[206:209], v[126:129], a[8:11], v[206:209]
    ds_read_b128 v[90:93], v10 offset:41984
    v_mfma_f32_16x16x32_bf16 v[206:209], v[146:149], a[24:27], v[206:209]
    buffer_load_dwordx4 a[72:75], v6, s[8:11], s44 offen sc1
    v_mfma_f32_16x16x32_bf16 v[226:229], v[146:149], a[28:31], v[226:229]
    v_mfma_f32_16x16x32_bf16 v[226:229], v[126:129], a[12:15], v[226:229]
    ds_read_b128 v[94:97], v10 offset:43008
    v_mfma_f32_16x16x32_bf16 v[170:173], v[130:133], a[0:3], v[170:173]
    buffer_load_dwordx4 a[76:79], v7, s[8:11], s44 offen sc1
    v_mfma_f32_16x16x32_bf16 v[170:173], v[150:153], a[16:19], v[170:173]
    v_mfma_f32_16x16x32_bf16 v[190:193], v[150:153], a[20:23], v[190:193]
    ds_read_b128 v[98:101], v10 offset:44032
    v_mfma_f32_16x16x32_bf16 v[190:193], v[130:133], a[4:7], v[190:193]
    s_mov_b32 s44, 278528
    buffer_load_dwordx4 a[80:83], v4, s[8:11], s44 offen sc1
    v_mfma_f32_16x16x32_bf16 v[210:213], v[130:133], a[8:11], v[210:213]
    v_mfma_f32_16x16x32_bf16 v[210:213], v[150:153], a[24:27], v[210:213]
    ds_read_b128 v[102:105], v10 offset:45056
    v_mfma_f32_16x16x32_bf16 v[230:233], v[150:153], a[28:31], v[230:233]
    buffer_load_dwordx4 a[84:87], v5, s[8:11], s44 offen sc1
    v_mfma_f32_16x16x32_bf16 v[230:233], v[130:133], a[12:15], v[230:233]
    v_mfma_f32_16x16x32_bf16 v[174:177], v[134:137], a[0:3], v[174:177]
    ds_read_b128 v[106:109], v10 offset:46080
    v_mfma_f32_16x16x32_bf16 v[174:177], v[154:157], a[16:19], v[174:177]
    buffer_load_dwordx4 a[88:91], v6, s[8:11], s44 offen sc1
    v_mfma_f32_16x16x32_bf16 v[194:197], v[154:157], a[20:23], v[194:197]
    v_mfma_f32_16x16x32_bf16 v[194:197], v[134:137], a[4:7], v[194:197]
    ds_read_b128 v[110:113], v10 offset:47104
    v_mfma_f32_16x16x32_bf16 v[214:217], v[134:137], a[8:11], v[214:217]
    buffer_load_dwordx4 a[92:95], v7, s[8:11], s44 offen sc1
    v_mfma_f32_16x16x32_bf16 v[214:217], v[154:157], a[24:27], v[214:217]
    v_mfma_f32_16x16x32_bf16 v[234:237], v[154:157], a[28:31], v[234:237]
    ds_read_b128 v[114:117], v10 offset:48128
    v_mfma_f32_16x16x32_bf16 v[234:237], v[134:137], a[12:15], v[234:237]
    s_mov_b32 s45, 552960
    buffer_load_dwordx4 a[196:199], v16, s[20:23], s45 offen offset:0 sc1
    v_mfma_f32_16x16x32_bf16 v[178:181], v[138:141], a[0:3], v[178:181]
    v_mfma_f32_16x16x32_bf16 v[178:181], v[158:161], a[16:19], v[178:181]
    ds_read_b128 v[118:121], v10 offset:49152
    v_mfma_f32_16x16x32_bf16 v[198:201], v[158:161], a[20:23], v[198:201]
    buffer_load_dwordx4 a[200:203], v16, s[20:23], s45 offen offset:1024 sc1
    v_mfma_f32_16x16x32_bf16 v[198:201], v[138:141], a[4:7], v[198:201]
    v_mfma_f32_16x16x32_bf16 v[218:221], v[138:141], a[8:11], v[218:221]
    ds_read_b128 v[122:125], v10 offset:50176
    v_mfma_f32_16x16x32_bf16 v[218:221], v[158:161], a[24:27], v[218:221]
    buffer_load_dwordx4 a[204:207], v16, s[20:23], s45 offen offset:2048 sc1
    v_mfma_f32_16x16x32_bf16 v[238:241], v[158:161], a[28:31], v[238:241]
    v_mfma_f32_16x16x32_bf16 v[238:241], v[138:141], a[12:15], v[238:241]
    v_mfma_f32_16x16x32_bf16 v[182:185], v[142:145], a[0:3], v[182:185]
    buffer_load_dwordx4 a[208:211], v16, s[20:23], s45 offen offset:3072 sc1
    v_mfma_f32_16x16x32_bf16 v[182:185], v[162:165], a[16:19], v[182:185]
    v_mfma_f32_16x16x32_bf16 v[202:205], v[162:165], a[20:23], v[202:205]
    v_mfma_f32_16x16x32_bf16 v[202:205], v[142:145], a[4:7], v[202:205]
    buffer_load_dwordx4 a[212:215], v17, s[20:23], s45 offen offset:0 sc1
    v_mfma_f32_16x16x32_bf16 v[222:225], v[142:145], a[8:11], v[222:225]
    v_mfma_f32_16x16x32_bf16 v[222:225], v[162:165], a[24:27], v[222:225]
    v_mfma_f32_16x16x32_bf16 v[242:245], v[162:165], a[28:31], v[242:245]
    v_mfma_f32_16x16x32_bf16 v[242:245], v[142:145], a[12:15], v[242:245]
    s_waitcnt vmcnt(18) lgkmcnt(0)
    v_mfma_f32_16x16x32_bf16 v[166:169], v[86:89], a[32:35], v[166:169]
    s_mov_b32 s44, 294912
    buffer_load_dwordx4 a[0:3], v4, s[8:11], s44 offen sc1
    v_mfma_f32_16x16x32_bf16 v[166:169], v[106:109], a[48:51], v[166:169]
    ds_read_b128 v[126:129], v9 offset:0
    v_mfma_f32_16x16x32_bf16 v[186:189], v[106:109], a[52:55], v[186:189]
    buffer_load_dwordx4 a[4:7], v5, s[8:11], s44 offen sc1
    v_mfma_f32_16x16x32_bf16 v[186:189], v[86:89], a[36:39], v[186:189]
    v_mfma_f32_16x16x32_bf16 v[206:209], v[86:89], a[40:43], v[206:209]
    ds_read_b128 v[130:133], v9 offset:1024
    v_mfma_f32_16x16x32_bf16 v[206:209], v[106:109], a[56:59], v[206:209]
    buffer_load_dwordx4 a[8:11], v6, s[8:11], s44 offen sc1
    v_mfma_f32_16x16x32_bf16 v[226:229], v[106:109], a[60:63], v[226:229]
    v_mfma_f32_16x16x32_bf16 v[226:229], v[86:89], a[44:47], v[226:229]
    ds_read_b128 v[134:137], v9 offset:2048
    v_mfma_f32_16x16x32_bf16 v[170:173], v[90:93], a[32:35], v[170:173]
    buffer_load_dwordx4 a[12:15], v7, s[8:11], s44 offen sc1
    v_mfma_f32_16x16x32_bf16 v[170:173], v[110:113], a[48:51], v[170:173]
    v_mfma_f32_16x16x32_bf16 v[190:193], v[110:113], a[52:55], v[190:193]
    ds_read_b128 v[138:141], v9 offset:3072
    v_mfma_f32_16x16x32_bf16 v[190:193], v[90:93], a[36:39], v[190:193]
    s_mov_b32 s44, 311296
    buffer_load_dwordx4 a[16:19], v4, s[8:11], s44 offen sc1
    v_mfma_f32_16x16x32_bf16 v[210:213], v[90:93], a[40:43], v[210:213]
    v_mfma_f32_16x16x32_bf16 v[210:213], v[110:113], a[56:59], v[210:213]
    ds_read_b128 v[142:145], v9 offset:4096
    v_mfma_f32_16x16x32_bf16 v[230:233], v[110:113], a[60:63], v[230:233]
    buffer_load_dwordx4 a[20:23], v5, s[8:11], s44 offen sc1
    v_mfma_f32_16x16x32_bf16 v[230:233], v[90:93], a[44:47], v[230:233]
    v_mfma_f32_16x16x32_bf16 v[174:177], v[94:97], a[32:35], v[174:177]
    ds_read_b128 v[146:149], v9 offset:5120
    v_mfma_f32_16x16x32_bf16 v[174:177], v[114:117], a[48:51], v[174:177]
    buffer_load_dwordx4 a[24:27], v6, s[8:11], s44 offen sc1
    v_mfma_f32_16x16x32_bf16 v[194:197], v[114:117], a[52:55], v[194:197]
    v_mfma_f32_16x16x32_bf16 v[194:197], v[94:97], a[36:39], v[194:197]
    ds_read_b128 v[150:153], v9 offset:6144
    v_mfma_f32_16x16x32_bf16 v[214:217], v[94:97], a[40:43], v[214:217]
    buffer_load_dwordx4 a[28:31], v7, s[8:11], s44 offen sc1
    v_mfma_f32_16x16x32_bf16 v[214:217], v[114:117], a[56:59], v[214:217]
    v_mfma_f32_16x16x32_bf16 v[234:237], v[114:117], a[60:63], v[234:237]
    ds_read_b128 v[154:157], v9 offset:7168
    v_mfma_f32_16x16x32_bf16 v[234:237], v[94:97], a[44:47], v[234:237]
    s_mov_b32 s45, 573440
    buffer_load_dwordx4 a[216:219], v16, s[20:23], s45 offen offset:0 sc1
    v_mfma_f32_16x16x32_bf16 v[178:181], v[98:101], a[32:35], v[178:181]
    v_mfma_f32_16x16x32_bf16 v[178:181], v[118:121], a[48:51], v[178:181]
    ds_read_b128 v[158:161], v9 offset:8192
    v_mfma_f32_16x16x32_bf16 v[198:201], v[118:121], a[52:55], v[198:201]
    buffer_load_dwordx4 a[220:223], v16, s[20:23], s45 offen offset:1024 sc1
    v_mfma_f32_16x16x32_bf16 v[198:201], v[98:101], a[36:39], v[198:201]
    v_mfma_f32_16x16x32_bf16 v[218:221], v[98:101], a[40:43], v[218:221]
    ds_read_b128 v[162:165], v9 offset:9216
    v_mfma_f32_16x16x32_bf16 v[218:221], v[118:121], a[56:59], v[218:221]
    buffer_load_dwordx4 a[224:227], v16, s[20:23], s45 offen offset:2048 sc1
    v_mfma_f32_16x16x32_bf16 v[238:241], v[118:121], a[60:63], v[238:241]
    v_mfma_f32_16x16x32_bf16 v[238:241], v[98:101], a[44:47], v[238:241]
    v_mfma_f32_16x16x32_bf16 v[182:185], v[102:105], a[32:35], v[182:185]
    buffer_load_dwordx4 a[228:231], v16, s[20:23], s45 offen offset:3072 sc1
    v_mfma_f32_16x16x32_bf16 v[182:185], v[122:125], a[48:51], v[182:185]
    v_mfma_f32_16x16x32_bf16 v[202:205], v[122:125], a[52:55], v[202:205]
    v_mfma_f32_16x16x32_bf16 v[202:205], v[102:105], a[36:39], v[202:205]
    buffer_load_dwordx4 a[232:235], v17, s[20:23], s45 offen offset:0 sc1
    v_mfma_f32_16x16x32_bf16 v[222:225], v[102:105], a[40:43], v[222:225]
    v_mfma_f32_16x16x32_bf16 v[222:225], v[122:125], a[56:59], v[222:225]
    v_mfma_f32_16x16x32_bf16 v[242:245], v[122:125], a[60:63], v[242:245]
    s_cmp_eq_u32 s101, 0
    s_cbranch_scc1 L_no_fl
    v_lshlrev_b32 v1, 7, v19
    v_add_u32 v1, 0x290000, v1
    buffer_load_dwordx4 v[252:255], v1, s[76:79], 0 offen sc1
L_no_fl:
    v_mfma_f32_16x16x32_bf16 v[242:245], v[102:105], a[44:47], v[242:245]
    s_waitcnt vmcnt(18) lgkmcnt(0)
    v_mfma_f32_16x16x32_bf16 v[166:169], v[126:129], a[64:67], v[166:169]
    s_mov_b32 s44, 327680
    buffer_load_dwordx4 a[32:35], v4, s[8:11], s44 offen sc1
    v_mfma_f32_16x16x32_bf16 v[166:169], v[146:149], a[80:83], v[166:169]
    ds_read_b128 v[86:89], v9 offset:40960
    v_mfma_f32_16x16x32_bf16 v[186:189], v[146:149], a[84:87], v[186:189]
    buffer_load_dwordx4 a[36:39], v5, s[8:11], s44 offen sc1
    v_mfma_f32_16x16x32_bf16 v[186:189], v[126:129], a[68:71], v[186:189]
    v_mfma_f32_16x16x32_bf16 v[206:209], v[126:129], a[72:75], v[206:209]
    ds_read_b128 v[90:93], v9 offset:41984
    v_mfma_f32_16x16x32_bf16 v[206:209], v[146:149], a[88:91], v[206:209]
    buffer_load_dwordx4 a[40:43], v6, s[8:11], s44 offen sc1
    v_mfma_f32_16x16x32_bf16 v[226:229], v[146:149], a[92:95], v[226:229]
    v_mfma_f32_16x16x32_bf16 v[226:229], v[126:129], a[76:79], v[226:229]
    ds_read_b128 v[94:97], v9 offset:43008
    v_mfma_f32_16x16x32_bf16 v[170:173], v[130:133], a[64:67], v[170:173]
    buffer_load_dwordx4 a[44:47], v7, s[8:11], s44 offen sc1
    v_mfma_f32_16x16x32_bf16 v[170:173], v[150:153], a[80:83], v[170:173]
    v_mfma_f32_16x16x32_bf16 v[190:193], v[150:153], a[84:87], v[190:193]
    ds_read_b128 v[98:101], v9 offset:44032
    v_mfma_f32_16x16x32_bf16 v[190:193], v[130:133], a[68:71], v[190:193]
    s_mov_b32 s44, 344064
    buffer_load_dwordx4 a[48:51], v4, s[8:11], s44 offen sc1
    v_mfma_f32_16x16x32_bf16 v[210:213], v[130:133], a[72:75], v[210:213]
    v_mfma_f32_16x16x32_bf16 v[210:213], v[150:153], a[88:91], v[210:213]
    ds_read_b128 v[102:105], v9 offset:45056
    v_mfma_f32_16x16x32_bf16 v[230:233], v[150:153], a[92:95], v[230:233]
    buffer_load_dwordx4 a[52:55], v5, s[8:11], s44 offen sc1
    v_mfma_f32_16x16x32_bf16 v[230:233], v[130:133], a[76:79], v[230:233]
    v_mfma_f32_16x16x32_bf16 v[174:177], v[134:137], a[64:67], v[174:177]
    ds_read_b128 v[106:109], v9 offset:46080
    v_mfma_f32_16x16x32_bf16 v[174:177], v[154:157], a[80:83], v[174:177]
    buffer_load_dwordx4 a[56:59], v6, s[8:11], s44 offen sc1
    v_mfma_f32_16x16x32_bf16 v[194:197], v[154:157], a[84:87], v[194:197]
    v_mfma_f32_16x16x32_bf16 v[194:197], v[134:137], a[68:71], v[194:197]
    ds_read_b128 v[110:113], v9 offset:47104
    v_mfma_f32_16x16x32_bf16 v[214:217], v[134:137], a[72:75], v[214:217]
    buffer_load_dwordx4 a[60:63], v7, s[8:11], s44 offen sc1
    v_mfma_f32_16x16x32_bf16 v[214:217], v[154:157], a[88:91], v[214:217]
    v_mfma_f32_16x16x32_bf16 v[234:237], v[154:157], a[92:95], v[234:237]
    ds_read_b128 v[114:117], v9 offset:48128
    v_mfma_f32_16x16x32_bf16 v[234:237], v[134:137], a[76:79], v[234:237]
    s_mov_b32 s45, 593920
    buffer_load_dwordx4 a[236:239], v16, s[20:23], s45 offen offset:0 sc1
    v_mfma_f32_16x16x32_bf16 v[178:181], v[138:141], a[64:67], v[178:181]
    v_mfma_f32_16x16x32_bf16 v[178:181], v[158:161], a[80:83], v[178:181]
    ds_read_b128 v[118:121], v9 offset:49152
    v_mfma_f32_16x16x32_bf16 v[198:201], v[158:161], a[84:87], v[198:201]
    buffer_load_dwordx4 a[240:243], v16, s[20:23], s45 offen offset:1024 sc1
    v_mfma_f32_16x16x32_bf16 v[198:201], v[138:141], a[68:71], v[198:201]
    v_mfma_f32_16x16x32_bf16 v[218:221], v[138:141], a[72:75], v[218:221]
    ds_read_b128 v[122:125], v9 offset:50176
    v_mfma_f32_16x16x32_bf16 v[218:221], v[158:161], a[88:91], v[218:221]
    buffer_load_dwordx4 a[244:247], v16, s[20:23], s45 offen offset:2048 sc1
    v_mfma_f32_16x16x32_bf16 v[238:241], v[158:161], a[92:95], v[238:241]
    v_mfma_f32_16x16x32_bf16 v[238:241], v[138:141], a[76:79], v[238:241]
    v_mfma_f32_16x16x32_bf16 v[182:185], v[142:145], a[64:67], v[182:185]
    buffer_load_dwordx4 a[248:251], v16, s[20:23], s45 offen offset:3072 sc1
    v_mfma_f32_16x16x32_bf16 v[182:185], v[162:165], a[80:83], v[182:185]
    v_mfma_f32_16x16x32_bf16 v[202:205], v[162:165], a[84:87], v[202:205]
    v_mfma_f32_16x16x32_bf16 v[202:205], v[142:145], a[68:71], v[202:205]
    buffer_load_dwordx4 a[252:255], v17, s[20:23], s45 offen offset:0 sc1
    v_mfma_f32_16x16x32_bf16 v[222:225], v[142:145], a[72:75], v[222:225]
    v_mfma_f32_16x16x32_bf16 v[222:225], v[162:165], a[88:91], v[222:225]
    v_mfma_f32_16x16x32_bf16 v[242:245], v[162:165], a[92:95], v[242:245]
    v_mfma_f32_16x16x32_bf16 v[242:245], v[142:145], a[76:79], v[242:245]
    s_waitcnt vmcnt(18) lgkmcnt(0)
    v_mfma_f32_16x16x32_bf16 v[166:169], v[86:89], a[0:3], v[166:169]
    s_mov_b32 s44, 360448
    buffer_load_dwordx4 a[64:67], v4, s[8:11], s44 offen sc1
    v_mfma_f32_16x16x32_bf16 v[166:169], v[106:109], a[16:19], v[166:169]
    ds_read_b128 v[126:129], v10 offset:0
    v_mfma_f32_16x16x32_bf16 v[186:189], v[106:109], a[20:23], v[186:189]
    buffer_load_dwordx4 a[68:71], v5, s[8:11], s44 offen sc1
    v_mfma_f32_16x16x32_bf16 v[186:189], v[86:89], a[4:7], v[186:189]
    v_mfma_f32_16x16x32_bf16 v[206:209], v[86:89], a[8:11], v[206:209]
    ds_read_b128 v[130:133], v10 offset:1024
    v_mfma_f32_16x16x32_bf16 v[206:209], v[106:109], a[24:27], v[206:209]
    buffer_load_dwordx4 a[72:75], v6, s[8:11], s44 offen sc1
    v_mfma_f32_16x16x32_bf16 v[226:229], v[106:109], a[28:31], v[226:229]
    v_mfma_f32_16x16x32_bf16 v[226:229], v[86:89], a[12:15], v[226:229]
    ds_read_b128 v[134:137], v10 offset:2048
    v_mfma_f32_16x16x32_bf16 v[170:173], v[90:93], a[0:3], v[170:173]
    buffer_load_dwordx4 a[76:79], v7, s[8:11], s44 offen sc1
    v_mfma_f32_16x16x32_bf16 v[170:173], v[110:113], a[16:19], v[170:173]
    v_mfma_f32_16x16x32_bf16 v[190:193], v[110:113], a[20:23], v[190:193]
    ds_read_b128 v[138:141], v10 offset:3072
    v_mfma_f32_16x16x32_bf16 v[190:193], v[90:93], a[4:7], v[190:193]
    s_mov_b32 s44, 376832
    buffer_load_dwordx4 a[80:83], v4, s[8:11], s44 offen sc1
    v_mfma_f32_16x16x32_bf16 v[210:213], v[90:93], a[8:11], v[210:213]
    v_mfma_f32_16x16x32_bf16 v[210:213], v[110:113], a[24:27], v[210:213]
    ds_read_b128 v[142:145], v10 offset:4096
    v_mfma_f32_16x16x32_bf16 v[230:233], v[110:113], a[28:31], v[230:233]
    buffer_load_dwordx4 a[84:87], v5, s[8:11], s44 offen sc1
    v_mfma_f32_16x16x32_bf16 v[230:233], v[90:93], a[12:15], v[230:233]
    v_mfma_f32_16x16x32_bf16 v[174:177], v[94:97], a[0:3], v[174:177]
    ds_read_b128 v[146:149], v10 offset:5120
    v_mfma_f32_16x16x32_bf16 v[174:177], v[114:117], a[16:19], v[174:177]
    buffer_load_dwordx4 a[88:91], v6, s[8:11], s44 offen sc1
    v_mfma_f32_16x16x32_bf16 v[194:197], v[114:117], a[20:23], v[194:197]
    v_mfma_f32_16x16x32_bf16 v[194:197], v[94:97], a[4:7], v[194:197]
    ds_read_b128 v[150:153], v10 offset:6144
    v_mfma_f32_16x16x32_bf16 v[214:217], v[94:97], a[8:11], v[214:217]
    buffer_load_dwordx4 a[92:95], v7, s[8:11], s44 offen sc1
    v_mfma_f32_16x16x32_bf16 v[214:217], v[114:117], a[24:27], v[214:217]
    v_mfma_f32_16x16x32_bf16 v[234:237], v[114:117], a[28:31], v[234:237]
    ds_read_b128 v[154:157], v10 offset:7168
    v_mfma_f32_16x16x32_bf16 v[234:237], v[94:97], a[12:15], v[234:237]
    s_mov_b32 s45, 614400
    buffer_load_dwordx4 v[46:49], v16, s[20:23], s45 offen offset:0 sc1
    v_mfma_f32_16x16x32_bf16 v[178:181], v[98:101], a[0:3], v[178:181]
    v_mfma_f32_16x16x32_bf16 v[178:181], v[118:121], a[16:19], v[178:181]
    ds_read_b128 v[158:161], v10 offset:8192
    v_mfma_f32_16x16x32_bf16 v[198:201], v[118:121], a[20:23], v[198:201]
    buffer_load_dwordx4 v[50:53], v16, s[20:23], s45 offen offset:1024 sc1
    v_mfma_f32_16x16x32_bf16 v[198:201], v[98:101], a[4:7], v[198:201]
    v_mfma_f32_16x16x32_bf16 v[218:221], v[98:101], a[8:11], v[218:221]
    ds_read_b128 v[162:165], v10 offset:9216
    v_mfma_f32_16x16x32_bf16 v[218:221], v[118:121], a[24:27], v[218:221]
    buffer_load_dwordx4 v[54:57], v16, s[20:23], s45 offen offset:2048 sc1
    v_mfma_f32_16x16x32_bf16 v[238:241], v[118:121], a[28:31], v[238:241]
    v_mfma_f32_16x16x32_bf16 v[238:241], v[98:101], a[12:15], v[238:241]
    v_mfma_f32_16x16x32_bf16 v[182:185], v[102:105], a[0:3], v[182:185]
    buffer_load_dwordx4 v[58:61], v16, s[20:23], s45 offen offset:3072 sc1
    v_mfma_f32_16x16x32_bf16 v[182:185], v[122:125], a[16:19], v[182:185]
    v_mfma_f32_16x16x32_bf16 v[202:205], v[122:125], a[20:23], v[202:205]
    v_mfma_f32_16x16x32_bf16 v[202:205], v[102:105], a[4:7], v[202:205]
    buffer_load_dwordx4 v[62:65], v17, s[20:23], s45 offen offset:0 sc1
    v_mfma_f32_16x16x32_bf16 v[222:225], v[102:105], a[8:11], v[222:225]
    v_mfma_f32_16x16x32_bf16 v[222:225], v[122:125], a[24:27], v[222:225]
    v_mfma_f32_16x16x32_bf16 v[242:245], v[122:125], a[28:31], v[242:245]
    s_cmp_eq_u32 s101, 0
    s_cbranch_scc1 L_back_upd
    s_waitcnt vmcnt(26)
    v_min3_u32 v252, v252, v253, v254
    v_min_u32 v252, v252, v255
    v_cmp_gt_u32 vcc, 3, v252
    s_and_b64 vcc, vcc, exec
    s_cbranch_scc1 L_spin_upd
L_back_upd:
    buffer_load_dwordx2 v[86:87], v11, s[76:79], 0 offen offset:0 sc1
    buffer_load_dwordx2 v[88:89], v11, s[76:79], 0 offen offset:32 sc1
    buffer_load_dwordx2 v[90:91], v11, s[76:79], 0 offen offset:64 sc1
    buffer_load_dwordx2 v[92:93], v11, s[76:79], 0 offen offset:96 sc1
    buffer_load_dwordx2 v[94:95], v11, s[76:79], 0 offen offset:128 sc1
    v_mfma_f32_16x16x32_bf16 v[242:245], v[102:105], a[12:15], v[242:245]
    s_waitcnt vmcnt(23) lgkmcnt(0)
    v_mfma_f32_16x16x32_bf16 v[166:169], v[126:129], a[32:35], v[166:169]
    s_mov_b32 s44, 393216
    buffer_load_dwordx4 a[0:3], v4, s[8:11], s44 offen sc1
    v_mfma_f32_16x16x32_bf16 v[166:169], v[146:149], a[48:51], v[166:169]
    v_mfma_f32_16x16x32_bf16 v[186:189], v[146:149], a[52:55], v[186:189]
    buffer_load_dwordx4 a[4:7], v5, s[8:11], s44 offen sc1
    v_mfma_f32_16x16x32_bf16 v[186:189], v[126:129], a[36:39], v[186:189]
    v_mfma_f32_16x16x32_bf16 v[206:209], v[126:129], a[40:43], v[206:209]
    v_mfma_f32_16x16x32_bf16 v[206:209], v[146:149], a[56:59], v[206:209]
    buffer_load_dwordx4 a[8:11], v6, s[8:11], s44 offen sc1
    v_mfma_f32_16x16x32_bf16 v[226:229], v[146:149], a[60:63], v[226:229]
    v_mfma_f32_16x16x32_bf16 v[226:229], v[126:129], a[44:47], v[226:229]
    v_mfma_f32_16x16x32_bf16 v[170:173], v[130:133], a[32:35], v[170:173]
    buffer_load_dwordx4 a[12:15], v7, s[8:11], s44 offen sc1
    v_mfma_f32_16x16x32_bf16 v[170:173], v[150:153], a[48:51], v[170:173]
    v_mfma_f32_16x16x32_bf16 v[190:193], v[150:153], a[52:55], v[190:193]
    v_mfma_f32_16x16x32_bf16 v[190:193], v[130:133], a[36:39], v[190:193]
    s_mov_b32 s44, 409600
    buffer_load_dwordx4 a[16:19], v4, s[8:11], s44 offen sc1
    v_mfma_f32_16x16x32_bf16 v[210:213], v[130:133], a[40:43], v[210:213]
    v_mfma_f32_16x16x32_bf16 v[210:213], v[150:153], a[56:59], v[210:213]
    v_mfma_f32_16x16x32_bf16 v[230:233], v[150:153], a[60:63], v[230:233]
    buffer_load_dwordx4 a[20:23], v5, s[8:11], s44 offen sc1
    v_mfma_f32_16x16x32_bf16 v[230:233], v[130:133], a[44:47], v[230:233]
    v_mfma_f32_16x16x32_bf16 v[174:177], v[134:137], a[32:35], v[174:177]
    v_mfma_f32_16x16x32_bf16 v[174:177], v[154:157], a[48:51], v[174:177]
    buffer_load_dwordx4 a[24:27], v6, s[8:11], s44 offen sc1
    v_mfma_f32_16x16x32_bf16 v[194:197], v[154:157], a[52:55], v[194:197]
    v_mfma_f32_16x16x32_bf16 v[194:197], v[134:137], a[36:39], v[194:197]
    v_mfma_f32_16x16x32_bf16 v[214:217], v[134:137], a[40:43], v[214:217]
    buffer_load_dwordx4 a[28:31], v7, s[8:11], s44 offen sc1
    v_mfma_f32_16x16x32_bf16 v[214:217], v[154:157], a[56:59], v[214:217]
    v_mfma_f32_16x16x32_bf16 v[234:237], v[154:157], a[60:63], v[234:237]
    v_mfma_f32_16x16x32_bf16 v[234:237], v[134:137], a[44:47], v[234:237]
    s_mov_b32 s45, 634880
    buffer_load_dwordx4 v[66:69], v16, s[20:23], s45 offen offset:0 sc1
    v_mfma_f32_16x16x32_bf16 v[178:181], v[138:141], a[32:35], v[178:181]
    v_mfma_f32_16x16x32_bf16 v[178:181], v[158:161], a[48:51], v[178:181]
    v_mfma_f32_16x16x32_bf16 v[198:201], v[158:161], a[52:55], v[198:201]
    buffer_load_dwordx4 v[70:73], v16, s[20:23], s45 offen offset:1024 sc1
    v_mfma_f32_16x16x32_bf16 v[198:201], v[138:141], a[36:39], v[198:201]
    v_mfma_f32_16x16x32_bf16 v[218:221], v[138:141], a[40:43], v[218:221]
    v_mfma_f32_16x16x32_bf16 v[218:221], v[158:161], a[56:59], v[218:221]
    buffer_load_dwordx4 v[74:77], v16, s[20:23], s45 offen offset:2048 sc1
    v_mfma_f32_16x16x32_bf16 v[238:241], v[158:161], a[60:63], v[238:241]
    v_mfma_f32_16x16x32_bf16 v[238:241], v[138:141], a[44:47], v[238:241]
    v_mfma_f32_16x16x32_bf16 v[182:185], v[142:145], a[32:35], v[182:185]
    buffer_load_dwordx4 v[78:81], v16, s[20:23], s45 offen offset:3072 sc1
    v_mfma_f32_16x16x32_bf16 v[182:185], v[162:165], a[48:51], v[182:185]
    v_mfma_f32_16x16x32_bf16 v[202:205], v[162:165], a[52:55], v[202:205]
    v_mfma_f32_16x16x32_bf16 v[202:205], v[142:145], a[36:39], v[202:205]
    buffer_load_dwordx4 v[82:85], v17, s[20:23], s45 offen offset:0 sc1
    v_mfma_f32_16x16x32_bf16 v[222:225], v[142:145], a[40:43], v[222:225]
    v_mfma_f32_16x16x32_bf16 v[222:225], v[162:165], a[56:59], v[222:225]
    v_mfma_f32_16x16x32_bf16 v[242:245], v[162:165], a[60:63], v[242:245]
    v_mfma_f32_16x16x32_bf16 v[242:245], v[142:145], a[44:47], v[242:245]
    s_waitcnt vmcnt(23)
    v_mfma_f32_16x16x32_bf16 v[166:169], a[96:99], a[64:67], v[166:169]
    s_mov_b32 s44, 425984
    buffer_load_dwordx4 a[32:35], v4, s[8:11], s44 offen sc1
    v_mfma_f32_16x16x32_bf16 v[166:169], a[116:119], a[80:83], v[166:169]
    v_mfma_f32_16x16x32_bf16 v[186:189], a[116:119], a[84:87], v[186:189]
    v_mfma_f32_16x16x32_bf16 v[186:189], a[96:99], a[68:71], v[186:189]
    v_mfma_f32_16x16x32_bf16 v[206:209], a[96:99], a[72:75], v[206:209]
    buffer_load_dwordx4 a[36:39], v5, s[8:11], s44 offen sc1
    v_mfma_f32_16x16x32_bf16 v[206:209], a[116:119], a[88:91], v[206:209]
    v_mfma_f32_16x16x32_bf16 v[226:229], a[116:119], a[92:95], v[226:229]
    v_mfma_f32_16x16x32_bf16 v[226:229], a[96:99], a[76:79], v[226:229]
    v_mfma_f32_16x16x32_bf16 v[170:173], a[100:103], a[64:67], v[170:173]
    v_mfma_f32_16x16x32_bf16 v[170:173], a[120:123], a[80:83], v[170:173]
    buffer_load_dwordx4 a[40:43], v6, s[8:11], s44 offen sc1
    v_mfma_f32_16x16x32_bf16 v[190:193], a[120:123], a[84:87], v[190:193]
    v_mfma_f32_16x16x32_bf16 v[190:193], a[100:103], a[68:71], v[190:193]
    v_mfma_f32_16x16x32_bf16 v[210:213], a[100:103], a[72:75], v[210:213]
    v_mfma_f32_16x16x32_bf16 v[210:213], a[120:123], a[88:91], v[210:213]
    v_mfma_f32_16x16x32_bf16 v[230:233], a[120:123], a[92:95], v[230:233]
    buffer_load_dwordx4 a[44:47], v7, s[8:11], s44 offen sc1
    v_mfma_f32_16x16x32_bf16 v[230:233], a[100:103], a[76:79], v[230:233]
    v_mfma_f32_16x16x32_bf16 v[174:177], a[104:107], a[64:67], v[174:177]
    v_mfma_f32_16x16x32_bf16 v[174:177], a[124:127], a[80:83], v[174:177]
    v_mfma_f32_16x16x32_bf16 v[194:197], a[124:127], a[84:87], v[194:197]
    v_mfma_f32_16x16x32_bf16 v[194:197], a[104:107], a[68:71], v[194:197]
    s_mov_b32 s44, 442368
    buffer_load_dwordx4 a[48:51], v4, s[8:11], s44 offen sc1
    v_mfma_f32_16x16x32_bf16 v[214:217], a[104:107], a[72:75], v[214:217]
    v_mfma_f32_16x16x32_bf16 v[214:217], a[124:127], a[88:91], v[214:217]
    v_mfma_f32_16x16x32_bf16 v[234:237], a[124:127], a[92:95], v[234:237]
    v_mfma_f32_16x16x32_bf16 v[234:237], a[104:107], a[76:79], v[234:237]
    buffer_load_dwordx4 a[52:55], v5, s[8:11], s44 offen sc1
    v_mfma_f32_16x16x32_bf16 v[178:181], a[108:111], a[64:67], v[178:181]
    v_mfma_f32_16x16x32_bf16 v[178:181], a[128:131], a[80:83], v[178:181]
    v_mfma_f32_16x16x32_bf16 v[198:201], a[128:131], a[84:87], v[198:201]
    v_mfma_f32_16x16x32_bf16 v[198:201], a[108:111], a[68:71], v[198:201]
    v_mfma_f32_16x16x32_bf16 v[218:221], a[108:111], a[72:75], v[218:221]
    buffer_load_dwordx4 a[56:59], v6, s[8:11], s44 offen sc1
    v_mfma_f32_16x16x32_bf16 v[218:221], a[128:131], a[88:91], v[218:221]
    v_mfma_f32_16x16x32_bf16 v[238:241], a[128:131], a[92:95], v[238:241]
    v_mfma_f32_16x16x32_bf16 v[238:241], a[108:111], a[76:79], v[238:241]
    v_mfma_f32_16x16x32_bf16 v[182:185], a[112:115], a[64:67], v[182:185]
    v_mfma_f32_16x16x32_bf16 v[182:185], a[132:135], a[80:83], v[182:185]
    buffer_load_dwordx4 a[60:63], v7, s[8:11], s44 offen sc1
    v_mfma_f32_16x16x32_bf16 v[202:205], a[132:135], a[84:87], v[202:205]
    v_mfma_f32_16x16x32_bf16 v[202:205], a[112:115], a[68:71], v[202:205]
    v_mfma_f32_16x16x32_bf16 v[222:225], a[112:115], a[72:75], v[222:225]
    v_mfma_f32_16x16x32_bf16 v[222:225], a[132:135], a[88:91], v[222:225]
    v_mfma_f32_16x16x32_bf16 v[242:245], a[132:135], a[92:95], v[242:245]
    v_mfma_f32_16x16x32_bf16 v[242:245], a[112:115], a[76:79], v[242:245]
    s_waitcnt vmcnt(13)
    v_mfma_f32_16x16x32_bf16 v[166:169], a[136:139], a[0:3], v[166:169]
    s_mov_b32 s44, 458752
    buffer_load_dwordx4 a[64:67], v4, s[8:11], s44 offen sc1
    v_lshlrev_b32 v96, 16, v36
    v_mfma_f32_16x16x32_bf16 v[166:169], a[156:159], a[16:19], v[166:169]
    v_and_b32 v97, 0xffff0000, v36
    v_lshlrev_b32 v126, 16, v86
    v_mfma_f32_16x16x32_bf16 v[186:189], a[156:159], a[20:23], v[186:189]
    v_and_b32 v127, 0xffff0000, v86
    v_mfma_f32_16x16x32_bf16 v[186:189], a[136:139], a[4:7], v[186:189]
    v_lshlrev_b32 v98, 16, v37
    v_and_b32 v99, 0xffff0000, v37
    v_mfma_f32_16x16x32_bf16 v[206:209], a[136:139], a[8:11], v[206:209]
    buffer_load_dwordx4 a[68:71], v5, s[8:11], s44 offen sc1
    v_lshlrev_b32 v128, 16, v87
    v_and_b32 v129, 0xffff0000, v87
    v_mfma_f32_16x16x32_bf16 v[206:209], a[156:159], a[24:27], v[206:209]
    v_lshlrev_b32 v100, 16, v38
    v_mfma_f32_16x16x32_bf16 v[226:229], a[156:159], a[28:31], v[226:229]
    v_and_b32 v101, 0xffff0000, v38
    v_lshlrev_b32 v130, 16, v88
    v_mfma_f32_16x16x32_bf16 v[226:229], a[136:139], a[12:15], v[226:229]
    v_and_b32 v131, 0xffff0000, v88
    v_lshlrev_b32 v102, 16, v39
    v_mfma_f32_16x16x32_bf16 v[170:173], a[140:143], a[0:3], v[170:173]
    v_and_b32 v103, 0xffff0000, v39
    v_mfma_f32_16x16x32_bf16 v[170:173], a[160:163], a[16:19], v[170:173]
    buffer_load_dwordx4 a[72:75], v6, s[8:11], s44 offen sc1
    v_lshlrev_b32 v132, 16, v89
    v_and_b32 v133, 0xffff0000, v89
    v_mfma_f32_16x16x32_bf16 v[190:193], a[160:163], a[20:23], v[190:193]
    v_lshlrev_b32 v104, 16, v40
    v_and_b32 v105, 0xffff0000, v40
    v_mfma_f32_16x16x32_bf16 v[190:193], a[140:143], a[4:7], v[190:193]
    v_lshlrev_b32 v134, 16, v90
    v_mfma_f32_16x16x32_bf16 v[210:213], a[140:143], a[8:11], v[210:213]
    v_and_b32 v135, 0xffff0000, v90
    v_lshlrev_b32 v106, 16, v41
    v_mfma_f32_16x16x32_bf16 v[210:213], a[160:163], a[24:27], v[210:213]
    v_and_b32 v107, 0xffff0000, v41
    v_lshlrev_b32 v136, 16, v91
    v_mfma_f32_16x16x32_bf16 v[230:233], a[160:163], a[28:31], v[230:233]
    buffer_load_dwordx4 a[76:79], v7, s[8:11], s44 offen sc1
    v_and_b32 v137, 0xffff0000, v91
    v_mfma_f32_16x16x32_bf16 v[230:233], a[140:143], a[12:15], v[230:233]
    v_lshlrev_b32 v108, 16, v42
    v_and_b32 v109, 0xffff0000, v42
    v_mfma_f32_16x16x32_bf16 v[174:177], a[144:147], a[0:3], v[174:177]
    v_lshlrev_b32 v138, 16, v92
    v_and_b32 v139, 0xffff0000, v92
    v_mfma_f32_16x16x32_bf16 v[174:177], a[164:167], a[16:19], v[174:177]
    v_lshlrev_b32 v110, 16, v43
    v_mfma_f32_16x16x32_bf16 v[194:197], a[164:167], a[20:23], v[194:197]
    v_and_b32 v111, 0xffff0000, v43
    v_lshlrev_b32 v140, 16, v93
    v_mfma_f32_16x16x32_bf16 v[194:197], a[144:147], a[4:7], v[194:197]
    s_mov_b32 s44, 475136
    buffer_load_dwordx4 a[80:83], v4, s[8:11], s44 offen sc1
    v_and_b32 v141, 0xffff0000, v93
    v_lshlrev_b32 v112, 16, v44
    v_mfma_f32_16x16x32_bf16 v[214:217], a[144:147], a[8:11], v[214:217]
    v_and_b32 v113, 0xffff0000, v44
    v_mfma_f32_16x16x32_bf16 v[214:217], a[164:167], a[24:27], v[214:217]
    v_lshlrev_b32 v142, 16, v94
    v_and_b32 v143, 0xffff0000, v94
    v_mfma_f32_16x16x32_bf16 v[234:237], a[164:167], a[28:31], v[234:237]
    v_lshlrev_b32 v114, 16, v45
    v_mfma_f32_16x16x32_bf16 v[234:237], a[144:147], a[12:15], v[234:237]
    buffer_load_dwordx4 a[84:87], v5, s[8:11], s44 offen sc1
    v_and_b32 v115, 0xffff0000, v45
    v_lshlrev_b32 v144, 16, v95
    v_mfma_f32_16x16x32_bf16 v[178:181], a[148:151], a[0:3], v[178:181]
    v_and_b32 v145, 0xffff0000, v95
    v_add_f32 v96, v96, v126
    v_mfma_f32_16x16x32_bf16 v[178:181], a[168:171], a[16:19], v[178:181]
    v_add_f32 v97, v97, v127
    v_mfma_f32_16x16x32_bf16 v[198:201], a[168:171], a[20:23], v[198:201]
    v_add_f32 v98, v98, v128
    v_add_f32 v99, v99, v129
    v_mfma_f32_16x16x32_bf16 v[198:201], a[148:151], a[4:7], v[198:201]
    v_add_f32 v100, v100, v130
    v_add_f32 v101, v101, v131
    v_mfma_f32_16x16x32_bf16 v[218:221], a[148:151], a[8:11], v[218:221]
    buffer_load_dwordx4 a[88:91], v6, s[8:11], s44 offen sc1
    v_add_f32 v102, v102, v132
    v_mfma_f32_16x16x32_bf16 v[218:221], a[168:171], a[24:27], v[218:221]
    v_add_f32 v103, v103, v133
    v_add_f32 v104, v104, v134
    v_mfma_f32_16x16x32_bf16 v[238:241], a[168:171], a[28:31], v[238:241]
    v_add_f32 v105, v105, v135
    v_add_f32 v106, v106, v136
    v_mfma_f32_16x16x32_bf16 v[238:241], a[148:151], a[12:15], v[238:241]
    v_add_f32 v107, v107, v137
    v_mfma_f32_16x16x32_bf16 v[182:185], a[152:155], a[0:3], v[182:185]
    v_add_f32 v108, v108, v138
    v_add_f32 v109, v109, v139
    v_mfma_f32_16x16x32_bf16 v[182:185], a[172:175], a[16:19], v[182:185]
    buffer_load_dwordx4 a[92:95], v7, s[8:11], s44 offen sc1
    v_add_f32 v110, v110, v140
    v_add_f32 v111, v111, v141
    v_mfma_f32_16x16x32_bf16 v[202:205], a[172:175], a[20:23], v[202:205]
    v_add_f32 v112, v112, v142
    v_mfma_f32_16x16x32_bf16 v[202:205], a[152:155], a[4:7], v[202:205]
    v_add_f32 v113, v113, v143
    v_add_f32 v114, v114, v144
    v_mfma_f32_16x16x32_bf16 v[222:225], a[152:155], a[8:11], v[222:225]
    v_add_f32 v115, v115, v145
    v_cvt_pk_bf16_f32 v126, v96, v97
    v_mfma_f32_16x16x32_bf16 v[222:225], a[172:175], a[24:27], v[222:225]
    v_cvt_pk_bf16_f32 v127, v98, v99
    v_mfma_f32_16x16x32_bf16 v[242:245], a[172:175], a[28:31], v[242:245]
    v_cvt_pk_bf16_f32 v128, v100, v101
    v_cvt_pk_bf16_f32 v129, v102, v103
    v_mfma_f32_16x16x32_bf16 v[242:245], a[152:155], a[12:15], v[242:245]
    v_cvt_pk_bf16_f32 v130, v104, v105
    v_cvt_pk_bf16_f32 v131, v106, v107
    s_waitcnt vmcnt(8)
    v_mfma_f32_16x16x32_bf16 v[166:169], a[176:179], a[32:35], v[166:169]
    s_mov_b32 s44, 491520
    buffer_load_dwordx4 a[0:3], v4, s[8:11], s44 offen sc1
    v_cvt_pk_bf16_f32 v132, v108, v109
    v_mfma_f32_16x16x32_bf16 v[166:169], a[196:199], a[48:51], v[166:169]
    v_cvt_pk_bf16_f32 v133, v110, v111
    v_cvt_pk_bf16_f32 v134, v112, v113
    v_mfma_f32_16x16x32_bf16 v[186:189], a[196:199], a[52:55], v[186:189]
    v_cvt_pk_bf16_f32 v135, v114, v115
    v_lshlrev_b32 v96, 16, v126
    v_mfma_f32_16x16x32_bf16 v[186:189], a[176:179], a[36:39], v[186:189]
    v_and_b32 v97, 0xffff0000, v126
    v_mfma_f32_16x16x32_bf16 v[206:209], a[176:179], a[40:43], v[206:209]
    buffer_load_dwordx4 a[4:7], v5, s[8:11], s44 offen sc1
    v_lshlrev_b32 v98, 16, v127
    v_and_b32 v99, 0xffff0000, v127
    v_mfma_f32_16x16x32_bf16 v[206:209], a[196:199], a[56:59], v[206:209]
    v_lshlrev_b32 v100, 16, v128
    v_and_b32 v101, 0xffff0000, v128
    v_mfma_f32_16x16x32_bf16 v[226:229], a[196:199], a[60:63], v[226:229]
    v_lshlrev_b32 v102, 16, v129
    v_mfma_f32_16x16x32_bf16 v[226:229], a[176:179], a[44:47], v[226:229]
    v_and_b32 v103, 0xffff0000, v129
    v_lshlrev_b32 v104, 16, v130
    v_mfma_f32_16x16x32_bf16 v[170:173], a[180:183], a[32:35], v[170:173]
    v_and_b32 v105, 0xffff0000, v130
    v_lshlrev_b32 v106, 16, v131
    v_mfma_f32_16x16x32_bf16 v[170:173], a[200:203], a[48:51], v[170:173]
    buffer_load_dwordx4 a[8:11], v6, s[8:11], s44 offen sc1
    v_and_b32 v107, 0xffff0000, v131
    v_mfma_f32_16x16x32_bf16 v[190:193], a[200:203], a[52:55], v[190:193]
    v_lshlrev_b32 v108, 16, v132
    v_and_b32 v109, 0xffff0000, v132
    v_mfma_f32_16x16x32_bf16 v[190:193], a[180:183], a[36:39], v[190:193]
    v_lshlrev_b32 v110, 16, v133
    v_and_b32 v111, 0xffff0000, v133
    v_mfma_f32_16x16x32_bf16 v[210:213], a[180:183], a[40:43], v[210:213]
    v_lshlrev_b32 v112, 16, v134
    v_mfma_f32_16x16x32_bf16 v[210:213], a[200:203], a[56:59], v[210:213]
    v_and_b32 v113, 0xffff0000, v134
    v_lshlrev_b32 v114, 16, v135
    v_mfma_f32_16x16x32_bf16 v[230:233], a[200:203], a[60:63], v[230:233]
    buffer_load_dwordx4 a[12:15], v7, s[8:11], s44 offen sc1
    v_and_b32 v115, 0xffff0000, v135
    v_mul_f32 v126, 0xbfb8aa3b, v96
    v_mfma_f32_16x16x32_bf16 v[230:233], a[180:183], a[44:47], v[230:233]
    v_mul_f32 v127, 0xbfb8aa3b, v97
    v_mfma_f32_16x16x32_bf16 v[174:177], a[184:187], a[32:35], v[174:177]
    v_mul_f32 v128, 0xbfb8aa3b, v98
    v_mul_f32 v129, 0xbfb8aa3b, v99
    v_mfma_f32_16x16x32_bf16 v[174:177], a[204:207], a[48:51], v[174:177]
    v_mul_f32 v130, 0xbfb8aa3b, v100
    v_mul_f32 v131, 0xbfb8aa3b, v101
    v_mfma_f32_16x16x32_bf16 v[194:197], a[204:207], a[52:55], v[194:197]
    v_mul_f32 v132, 0xbfb8aa3b, v102
    v_mfma_f32_16x16x32_bf16 v[194:197], a[184:187], a[36:39], v[194:197]
    s_mov_b32 s44, 507904
    buffer_load_dwordx4 a[16:19], v4, s[8:11], s44 offen sc1
    v_mul_f32 v133, 0xbfb8aa3b, v103
    v_mul_f32 v134, 0xbfb8aa3b, v104
    v_mfma_f32_16x16x32_bf16 v[214:217], a[184:187], a[40:43], v[214:217]
    v_mul_f32 v135, 0xbfb8aa3b, v105
    v_mul_f32 v136, 0xbfb8aa3b, v106
    v_mfma_f32_16x16x32_bf16 v[214:217], a[204:207], a[56:59], v[214:217]
    v_mul_f32 v137, 0xbfb8aa3b, v107
    v_mfma_f32_16x16x32_bf16 v[234:237], a[204:207], a[60:63], v[234:237]
    v_mul_f32 v138, 0xbfb8aa3b, v108
    v_mul_f32 v139, 0xbfb8aa3b, v109
    v_mfma_f32_16x16x32_bf16 v[234:237], a[184:187], a[44:47], v[234:237]
    buffer_load_dwordx4 a[20:23], v5, s[8:11], s44 offen sc1
    v_mul_f32 v140, 0xbfb8aa3b, v110
    v_mul_f32 v141, 0xbfb8aa3b, v111
    v_mfma_f32_16x16x32_bf16 v[178:181], a[188:191], a[32:35], v[178:181]
    v_mul_f32 v142, 0xbfb8aa3b, v112
    v_mfma_f32_16x16x32_bf16 v[178:181], a[208:211], a[48:51], v[178:181]
    v_mul_f32 v143, 0xbfb8aa3b, v113
    v_mul_f32 v144, 0xbfb8aa3b, v114
    v_mfma_f32_16x16x32_bf16 v[198:201], a[208:211], a[52:55], v[198:201]
    v_mul_f32 v145, 0xbfb8aa3b, v115
    v_exp_f32 v126, v126
    v_mfma_f32_16x16x32_bf16 v[198:201], a[188:191], a[36:39], v[198:201]
    v_exp_f32 v127, v127
    v_mfma_f32_16x16x32_bf16 v[218:221], a[188:191], a[40:43], v[218:221]
    buffer_load_dwordx4 a[24:27], v6, s[8:11], s44 offen sc1
    v_exp_f32 v128, v128
    v_exp_f32 v129, v129
    v_mfma_f32_16x16x32_bf16 v[218:221], a[208:211], a[56:59], v[218:221]
    v_exp_f32 v130, v130
    v_exp_f32 v131, v131
    v_mfma_f32_16x16x32_bf16 v[238:241], a[208:211], a[60:63], v[238:241]
    v_exp_f32 v132, v132
    v_mfma_f32_16x16x32_bf16 v[238:241], a[188:191], a[44:47], v[238:241]
    v_exp_f32 v133, v133
    v_exp_f32 v134, v134
    v_mfma_f32_16x16x32_bf16 v[182:185], a[192:195], a[32:35], v[182:185]
    v_exp_f32 v135, v135
    v_exp_f32 v136, v136
    v_mfma_f32_16x16x32_bf16 v[182:185], a[212:215], a[48:51], v[182:185]
    buffer_load_dwordx4 a[28:31], v7, s[8:11], s44 offen sc1
    v_exp_f32 v137, v137
    v_mfma_f32_16x16x32_bf16 v[202:205], a[212:215], a[52:55], v[202:205]
    v_exp_f32 v138, v138
    v_exp_f32 v139, v139
    v_mfma_f32_16x16x32_bf16 v[202:205], a[192:195], a[36:39], v[202:205]
    v_exp_f32 v140, v140
    v_exp_f32 v141, v141
    v_mfma_f32_16x16x32_bf16 v[222:225], a[192:195], a[40:43], v[222:225]
    v_exp_f32 v142, v142
    v_mfma_f32_16x16x32_bf16 v[222:225], a[212:215], a[56:59], v[222:225]
    v_exp_f32 v143, v143
    v_exp_f32 v144, v144
    v_mfma_f32_16x16x32_bf16 v[242:245], a[212:215], a[60:63], v[242:245]
    v_exp_f32 v145, v145
    v_add_f32 v126, 1.0, v126
    v_mfma_f32_16x16x32_bf16 v[242:245], a[192:195], a[44:47], v[242:245]
    v_add_f32 v127, 1.0, v127
    v_add_f32 v128, 1.0, v128
    s_waitcnt vmcnt(8)
    v_mfma_f32_16x16x32_bf16 v[166:169], a[216:219], a[64:67], v[166:169]
    v_add_f32 v129, 1.0, v129
    v_mfma_f32_16x16x32_bf16 v[166:169], a[236:239], a[80:83], v[166:169]
    v_add_f32 v130, 1.0, v130
    v_add_f32 v131, 1.0, v131
    v_mfma_f32_16x16x32_bf16 v[186:189], a[236:239], a[84:87], v[186:189]
    v_add_f32 v132, 1.0, v132
    v_add_f32 v133, 1.0, v133
    v_mfma_f32_16x16x32_bf16 v[186:189], a[216:219], a[68:71], v[186:189]
    v_add_f32 v134, 1.0, v134
    v_mfma_f32_16x16x32_bf16 v[206:209], a[216:219], a[72:75], v[206:209]
    v_add_f32 v135, 1.0, v135
    v_add_f32 v136, 1.0, v136
    v_mfma_f32_16x16x32_bf16 v[206:209], a[236:239], a[88:91], v[206:209]
    v_add_f32 v137, 1.0, v137
    v_add_f32 v138, 1.0, v138
    v_mfma_f32_16x16x32_bf16 v[226:229], a[236:239], a[92:95], v[226:229]
    v_add_f32 v139, 1.0, v139
    v_mfma_f32_16x16x32_bf16 v[226:229], a[216:219], a[76:79], v[226:229]
    v_add_f32 v140, 1.0, v140
    v_add_f32 v141, 1.0, v141
    v_mfma_f32_16x16x32_bf16 v[170:173], a[220:223], a[64:67], v[170:173]
    v_add_f32 v142, 1.0, v142
    v_add_f32 v143, 1.0, v143
    v_mfma_f32_16x16x32_bf16 v[170:173], a[240:243], a[80:83], v[170:173]
    v_add_f32 v144, 1.0, v144
    v_mfma_f32_16x16x32_bf16 v[190:193], a[240:243], a[84:87], v[190:193]
    v_add_f32 v145, 1.0, v145
    v_rcp_f32 v126, v126
    v_mfma_f32_16x16x32_bf16 v[190:193], a[220:223], a[68:71], v[190:193]
    v_rcp_f32 v127, v127
    v_rcp_f32 v128, v128
    v_mfma_f32_16x16x32_bf16 v[210:213], a[220:223], a[72:75], v[210:213]
    v_rcp_f32 v129, v129
    v_mfma_f32_16x16x32_bf16 v[210:213], a[240:243], a[88:91], v[210:213]
    v_rcp_f32 v130, v130
    v_rcp_f32 v131, v131
    v_mfma_f32_16x16x32_bf16 v[230:233], a[240:243], a[92:95], v[230:233]
    v_rcp_f32 v132, v132
    v_rcp_f32 v133, v133
    v_mfma_f32_16x16x32_bf16 v[230:233], a[220:223], a[76:79], v[230:233]
    v_rcp_f32 v134, v134
    v_mfma_f32_16x16x32_bf16 v[174:177], a[224:227], a[64:67], v[174:177]
    v_rcp_f32 v135, v135
    v_rcp_f32 v136, v136
    v_mfma_f32_16x16x32_bf16 v[174:177], a[244:247], a[80:83], v[174:177]
    v_rcp_f32 v137, v137
    v_rcp_f32 v138, v138
    v_mfma_f32_16x16x32_bf16 v[194:197], a[244:247], a[84:87], v[194:197]
    v_rcp_f32 v139, v139
    v_mfma_f32_16x16x32_bf16 v[194:197], a[224:227], a[68:71], v[194:197]
    v_rcp_f32 v140, v140
    v_rcp_f32 v141, v141
    v_mfma_f32_16x16x32_bf16 v[214:217], a[224:227], a[72:75], v[214:217]
    v_rcp_f32 v142, v142
    v_rcp_f32 v143, v143
    v_mfma_f32_16x16x32_bf16 v[214:217], a[244:247], a[88:91], v[214:217]
    v_rcp_f32 v144, v144
    v_mfma_f32_16x16x32_bf16 v[234:237], a[244:247], a[92:95], v[234:237]
    v_rcp_f32 v145, v145
    v_mul_f32 v96, v96, v126
    v_mfma_f32_16x16x32_bf16 v[234:237], a[224:227], a[76:79], v[234:237]
    v_mul_f32 v97, v97, v127
    v_mul_f32 v98, v98, v128
    v_mfma_f32_16x16x32_bf16 v[178:181], a[228:231], a[64:67], v[178:181]
    v_mul_f32 v99, v99, v129
    v_mfma_f32_16x16x32_bf16 v[178:181], a[248:251], a[80:83], v[178:181]
    v_mul_f32 v100, v100, v130
    v_mul_f32 v101, v101, v131
    v_mfma_f32_16x16x32_bf16 v[198:201], a[248:251], a[84:87], v[198:201]
    v_mul_f32 v102, v102, v132
    v_mul_f32 v103, v103, v133
    v_mfma_f32_16x16x32_bf16 v[198:201], a[228:231], a[68:71], v[198:201]
    v_mul_f32 v104, v104, v134
    v_mfma_f32_16x16x32_bf16 v[218:221], a[228:231], a[72:75], v[218:221]
    v_mul_f32 v105, v105, v135
    v_mul_f32 v106, v106, v136
    v_mfma_f32_16x16x32_bf16 v[218:221], a[248:251], a[88:91], v[218:221]
    v_mul_f32 v107, v107, v137
    v_mul_f32 v108, v108, v138
    v_mfma_f32_16x16x32_bf16 v[238:241], a[248:251], a[92:95], v[238:241]
    v_mul_f32 v109, v109, v139
    v_mfma_f32_16x16x32_bf16 v[238:241], a[228:231], a[76:79], v[238:241]
    v_mul_f32 v110, v110, v140
    v_mul_f32 v111, v111, v141
    v_mfma_f32_16x16x32_bf16 v[182:185], a[232:235], a[64:67], v[182:185]
    v_mul_f32 v112, v112, v142
    v_mul_f32 v113, v113, v143
    v_mfma_f32_16x16x32_bf16 v[182:185], a[252:255], a[80:83], v[182:185]
    v_mul_f32 v114, v114, v144
    v_mfma_f32_16x16x32_bf16 v[202:205], a[252:255], a[84:87], v[202:205]
    v_mul_f32 v115, v115, v145
    v_cvt_pk_bf16_f32 v36, v96, v97
    v_mfma_f32_16x16x32_bf16 v[202:205], a[232:235], a[68:71], v[202:205]
    v_cvt_pk_bf16_f32 v37, v98, v99
    v_cvt_pk_bf16_f32 v38, v100, v101
    v_mfma_f32_16x16x32_bf16 v[222:225], a[232:235], a[72:75], v[222:225]
    v_cvt_pk_bf16_f32 v39, v102, v103
    v_mfma_f32_16x16x32_bf16 v[222:225], a[252:255], a[88:91], v[222:225]
    v_cvt_pk_bf16_f32 v40, v104, v105
    v_cvt_pk_bf16_f32 v41, v106, v107
    v_mfma_f32_16x16x32_bf16 v[242:245], a[252:255], a[92:95], v[242:245]
    v_cvt_pk_bf16_f32 v42, v108, v109
    v_cvt_pk_bf16_f32 v43, v110, v111
    s_sub_u32 s40, s5, 1
    s_and_b32 s40, s40, 3
    s_mul_i32 s40, s40, 10240
    v_lshl_add_u32 v5, v19, 4, s40
    s_sub_u32 s40, s5, 2
    s_and_b32 s40, s40, 3
    s_mul_i32 s40, s40, 10240
    v_lshl_add_u32 v6, v19, 4, s40
    s_sub_u32 s40, s5, 3
    s_and_b32 s40, s40, 3
    s_mul_i32 s40, s40, 10240
    v_lshl_add_u32 v7, v19, 4, s40
    v_mfma_f32_16x16x32_bf16 v[242:245], a[232:235], a[76:79], v[242:245]
    v_cvt_pk_bf16_f32 v44, v112, v113
    v_cvt_pk_bf16_f32 v45, v114, v115
    s_waitcnt vmcnt(0)
    v_mfma_f32_16x16x32_bf16 v[166:169], v[46:49], a[0:3], v[166:169]
    v_mfma_f32_16x16x32_bf16 v[166:169], v[66:69], a[16:19], v[166:169]
    v_mfma_f32_16x16x32_bf16 v[186:189], v[66:69], a[20:23], v[186:189]
    v_mfma_f32_16x16x32_bf16 v[186:189], v[46:49], a[4:7], v[186:189]
    v_mfma_f32_16x16x32_bf16 v[206:209], v[46:49], a[8:11], v[206:209]
    v_mfma_f32_16x16x32_bf16 v[206:209], v[66:69], a[24:27], v[206:209]
    v_mfma_f32_16x16x32_bf16 v[226:229], v[66:69], a[28:31], v[226:229]
    v_mfma_f32_16x16x32_bf16 v[226:229], v[46:49], a[12:15], v[226:229]
    v_mfma_f32_16x16x32_bf16 v[170:173], v[50:53], a[0:3], v[170:173]
    v_mfma_f32_16x16x32_bf16 v[170:173], v[70:73], a[16:19], v[170:173]
    v_mfma_f32_16x16x32_bf16 v[190:193], v[70:73], a[20:23], v[190:193]
    v_mfma_f32_16x16x32_bf16 v[190:193], v[50:53], a[4:7], v[190:193]
    v_mfma_f32_16x16x32_bf16 v[210:213], v[50:53], a[8:11], v[210:213]
    v_mfma_f32_16x16x32_bf16 v[210:213], v[70:73], a[24:27], v[210:213]
    v_mfma_f32_16x16x32_bf16 v[230:233], v[70:73], a[28:31], v[230:233]
    v_mfma_f32_16x16x32_bf16 v[230:233], v[50:53], a[12:15], v[230:233]
    v_mfma_f32_16x16x32_bf16 v[174:177], v[54:57], a[0:3], v[174:177]
    v_mfma_f32_16x16x32_bf16 v[174:177], v[74:77], a[16:19], v[174:177]
    v_mfma_f32_16x16x32_bf16 v[194:197], v[74:77], a[20:23], v[194:197]
    v_mfma_f32_16x16x32_bf16 v[194:197], v[54:57], a[4:7], v[194:197]
    v_mfma_f32_16x16x32_bf16 v[214:217], v[54:57], a[8:11], v[214:217]
    v_mfma_f32_16x16x32_bf16 v[214:217], v[74:77], a[24:27], v[214:217]
    v_mfma_f32_16x16x32_bf16 v[234:237], v[74:77], a[28:31], v[234:237]
    v_mfma_f32_16x16x32_bf16 v[234:237], v[54:57], a[12:15], v[234:237]
    v_mfma_f32_16x16x32_bf16 v[178:181], v[58:61], a[0:3], v[178:181]
    v_mfma_f32_16x16x32_bf16 v[178:181], v[78:81], a[16:19], v[178:181]
    v_mfma_f32_16x16x32_bf16 v[198:201], v[78:81], a[20:23], v[198:201]
    v_mfma_f32_16x16x32_bf16 v[198:201], v[58:61], a[4:7], v[198:201]
    v_mfma_f32_16x16x32_bf16 v[218:221], v[58:61], a[8:11], v[218:221]
    v_mfma_f32_16x16x32_bf16 v[218:221], v[78:81], a[24:27], v[218:221]
    v_mfma_f32_16x16x32_bf16 v[238:241], v[78:81], a[28:31], v[238:241]
    v_mfma_f32_16x16x32_bf16 v[238:241], v[58:61], a[12:15], v[238:241]
    v_mfma_f32_16x16x32_bf16 v[182:185], v[62:65], a[0:3], v[182:185]
    v_mfma_f32_16x16x32_bf16 v[182:185], v[82:85], a[16:19], v[182:185]
    v_mfma_f32_16x16x32_bf16 v[202:205], v[82:85], a[20:23], v[202:205]
    v_mfma_f32_16x16x32_bf16 v[202:205], v[62:65], a[4:7], v[202:205]
    v_mfma_f32_16x16x32_bf16 v[222:225], v[62:65], a[8:11], v[222:225]
    v_mfma_f32_16x16x32_bf16 v[222:225], v[82:85], a[24:27], v[222:225]
    v_mfma_f32_16x16x32_bf16 v[242:245], v[82:85], a[28:31], v[242:245]
    v_mfma_f32_16x16x32_bf16 v[242:245], v[62:65], a[12:15], v[242:245]
    s_nop 3
    ds_write_b128 v9, v[186:189] offset:0
    ds_write_b128 v9, v[190:193] offset:1024
    ds_write_b128 v9, v[194:197] offset:2048
    ds_write_b128 v9, v[198:201] offset:3072
    ds_write_b128 v9, v[202:205] offset:4096
    ds_write_b128 v9, v[206:209] offset:5120
    ds_write_b128 v9, v[210:213] offset:6144
    ds_write_b128 v9, v[214:217] offset:7168
    ds_write_b128 v9, v[218:221] offset:8192
    ds_write_b128 v9, v[222:225] offset:9216
    ds_write_b128 v9, v[226:229] offset:40960
    ds_write_b128 v9, v[230:233] offset:41984
    ds_write_b128 v9, v[234:237] offset:43008
    ds_write_b128 v9, v[238:241] offset:44032
    ds_write_b128 v9, v[242:245] offset:45056
    s_waitcnt lgkmcnt(0)
    s_barrier
    ds_read_b128 v[186:189], v5 offset:0
    ds_read_b128 v[190:193], v5 offset:1024
    ds_read_b128 v[194:197], v5 offset:2048
    ds_read_b128 v[198:201], v5 offset:3072
    ds_read_b128 v[202:205], v5 offset:4096
    ds_read_b128 v[206:209], v6 offset:5120
    ds_read_b128 v[210:213], v6 offset:6144
    ds_read_b128 v[214:217], v6 offset:7168
    ds_read_b128 v[218:221], v6 offset:8192
    ds_read_b128 v[222:225], v6 offset:9216
    ds_read_b128 v[226:229], v7 offset:40960
    ds_read_b128 v[230:233], v7 offset:41984
    ds_read_b128 v[234:237], v7 offset:43008
    ds_read_b128 v[238:241], v7 offset:44032
    ds_read_b128 v[242:245], v7 offset:45056
    v_lshlrev_b32 v66, 16, v36
    v_and_b32 v67, 0xffff0000, v36
    v_lshlrev_b32 v86, 16, v22
    v_and_b32 v87, 0xffff0000, v22
    v_lshlrev_b32 v68, 16, v37
    v_and_b32 v69, 0xffff0000, v37
    v_lshlrev_b32 v88, 16, v23
    v_and_b32 v89, 0xffff0000, v23
    v_lshlrev_b32 v70, 16, v38
    v_and_b32 v71, 0xffff0000, v38
    v_lshlrev_b32 v90, 16, v24
    v_and_b32 v91, 0xffff0000, v24
    v_lshlrev_b32 v72, 16, v39
    v_and_b32 v73, 0xffff0000, v39
    v_lshlrev_b32 v92, 16, v25
    v_and_b32 v93, 0xffff0000, v25
    v_lshlrev_b32 v74, 16, v40
    v_and_b32 v75, 0xffff0000, v40
    v_lshlrev_b32 v94, 16, v26
    v_and_b32 v95, 0xffff0000, v26
    v_lshlrev_b32 v76, 16, v41
    v_and_b32 v77, 0xffff0000, v41
    v_lshlrev_b32 v96, 16, v27
    v_and_b32 v97, 0xffff0000, v27
    v_lshlrev_b32 v78, 16, v42
    v_and_b32 v79, 0xffff0000, v42
    v_lshlrev_b32 v98, 16, v28
    v_and_b32 v99, 0xffff0000, v28
    v_lshlrev_b32 v80, 16, v43
    v_and_b32 v81, 0xffff0000, v43
    v_lshlrev_b32 v100, 16, v29
    v_and_b32 v101, 0xffff0000, v29
    v_lshlrev_b32 v82, 16, v44
    v_and_b32 v83, 0xffff0000, v44
    v_lshlrev_b32 v102, 16, v30
    v_and_b32 v103, 0xffff0000, v30
    v_lshlrev_b32 v84, 16, v45
    v_and_b32 v85, 0xffff0000, v45
    v_lshlrev_b32 v104, 16, v31
    v_and_b32 v105, 0xffff0000, v31
    s_waitcnt lgkmcnt(10)
    v_add_f32 v166, v166, v186
    v_add_f32 v167, v167, v187
    v_add_f32 v168, v168, v188
    v_add_f32 v169, v169, v189
    v_add_f32 v170, v170, v190
    v_add_f32 v171, v171, v191
    v_add_f32 v172, v172, v192
    v_add_f32 v173, v173, v193
    v_add_f32 v174, v174, v194
    v_add_f32 v175, v175, v195
    v_add_f32 v176, v176, v196
    v_add_f32 v177, v177, v197
    v_add_f32 v178, v178, v198
    v_add_f32 v179, v179, v199
    v_add_f32 v180, v180, v200
    v_add_f32 v181, v181, v201
    v_add_f32 v182, v182, v202
    v_add_f32 v183, v183, v203
    v_add_f32 v184, v184, v204
    v_add_f32 v185, v185, v205
    s_waitcnt lgkmcnt(5)
    v_add_f32 v166, v166, v206
    v_add_f32 v167, v167, v207
    v_add_f32 v168, v168, v208
    v_add_f32 v169, v169, v209
    v_add_f32 v170, v170, v210
    v_add_f32 v171, v171, v211
    v_add_f32 v172, v172, v212
    v_add_f32 v173, v173, v213
    v_add_f32 v174, v174, v214
    v_add_f32 v175, v175, v215
    v_add_f32 v176, v176, v216
    v_add_f32 v177, v177, v217
    v_add_f32 v178, v178, v218
    v_add_f32 v179, v179, v219
    v_add_f32 v180, v180, v220
    v_add_f32 v181, v181, v221
    v_add_f32 v182, v182, v222
    v_add_f32 v183, v183, v223
    v_add_f32 v184, v184, v224
    v_add_f32 v185, v185, v225
    s_waitcnt lgkmcnt(0)
    v_add_f32 v166, v166, v226
    v_add_f32 v167, v167, v227
    v_add_f32 v168, v168, v228
    v_add_f32 v169, v169, v229
    v_add_f32 v170, v170, v230
    v_add_f32 v171, v171, v231
    v_add_f32 v172, v172, v232
    v_add_f32 v173, v173, v233
    v_add_f32 v174, v174, v234
    v_add_f32 v175, v175, v235
    v_add_f32 v176, v176, v236
    v_add_f32 v177, v177, v237
    v_add_f32 v178, v178, v238
    v_add_f32 v179, v179, v239
    v_add_f32 v180, v180, v240
    v_add_f32 v181, v181, v241
    v_add_f32 v182, v182, v242
    v_add_f32 v183, v183, v243
    v_add_f32 v184, v184, v244
    v_add_f32 v185, v185, v245
    v_cvt_pk_bf16_f32 v46, v166, v167
    v_cvt_pk_bf16_f32 v47, v168, v169
    v_cvt_pk_bf16_f32 v48, v170, v171
    v_cvt_pk_bf16_f32 v49, v172, v173
    v_cvt_pk_bf16_f32 v50, v174, v175
    v_cvt_pk_bf16_f32 v51, v176, v177
    v_cvt_pk_bf16_f32 v52, v178, v179
    v_cvt_pk_bf16_f32 v53, v180, v181
    v_cvt_pk_bf16_f32 v54, v182, v183
    v_cvt_pk_bf16_f32 v55, v184, v185
    v_lshlrev_b32 v166, 16, v46
    v_and_b32 v167, 0xffff0000, v46
    v_lshlrev_b32 v168, 16, v47
    v_and_b32 v169, 0xffff0000, v47
    v_lshlrev_b32 v170, 16, v48
    v_and_b32 v171, 0xffff0000, v48
    v_lshlrev_b32 v172, 16, v49
    v_and_b32 v173, 0xffff0000, v49
    v_lshlrev_b32 v174, 16, v50
    v_and_b32 v175, 0xffff0000, v50
    v_lshlrev_b32 v176, 16, v51
    v_and_b32 v177, 0xffff0000, v51
    v_lshlrev_b32 v178, 16, v52
    v_and_b32 v179, 0xffff0000, v52
    v_lshlrev_b32 v180, 16, v53
    v_and_b32 v181, 0xffff0000, v53
    v_lshlrev_b32 v182, 16, v54
    v_and_b32 v183, 0xffff0000, v54
    v_lshlrev_b32 v184, 16, v55
    v_and_b32 v185, 0xffff0000, v55
    v_mul_f32 v166, v166, v66
    v_mul_f32 v167, v167, v67
    v_mul_f32 v168, v168, v68
    v_mul_f32 v169, v169, v69
    v_mul_f32 v170, v170, v70
    v_mul_f32 v171, v171, v71
    v_mul_f32 v172, v172, v72
    v_mul_f32 v173, v173, v73
    v_mul_f32 v174, v174, v74
    v_mul_f32 v175, v175, v75
    v_mul_f32 v176, v176, v76
    v_mul_f32 v177, v177, v77
    v_mul_f32 v178, v178, v78
    v_mul_f32 v179, v179, v79
    v_mul_f32 v180, v180, v80
    v_mul_f32 v181, v181, v81
    v_mul_f32 v182, v182, v82
    v_mul_f32 v183, v183, v83
    v_mul_f32 v184, v184, v84
    v_mul_f32 v185, v185, v85
    v_cvt_pk_bf16_f32 v46, v166, v167
    v_cvt_pk_bf16_f32 v47, v168, v169
    v_cvt_pk_bf16_f32 v48, v170, v171
    v_cvt_pk_bf16_f32 v49, v172, v173
    v_cvt_pk_bf16_f32 v50, v174, v175
    v_cvt_pk_bf16_f32 v51, v176, v177
    v_cvt_pk_bf16_f32 v52, v178, v179
    v_cvt_pk_bf16_f32 v53, v180, v181
    v_cvt_pk_bf16_f32 v54, v182, v183
    v_cvt_pk_bf16_f32 v55, v184, v185
    v_lshlrev_b32 v166, 16, v46
    v_and_b32 v167, 0xffff0000, v46
    v_lshlrev_b32 v168, 16, v47
    v_and_b32 v169, 0xffff0000, v47
    v_lshlrev_b32 v170, 16, v48
    v_and_b32 v171, 0xffff0000, v48
    v_lshlrev_b32 v172, 16, v49
    v_and_b32 v173, 0xffff0000, v49
    v_lshlrev_b32 v174, 16, v50
    v_and_b32 v175, 0xffff0000, v50
    v_lshlrev_b32 v176, 16, v51
    v_and_b32 v177, 0xffff0000, v51
    v_lshlrev_b32 v178, 16, v52
    v_and_b32 v179, 0xffff0000, v52
    v_lshlrev_b32 v180, 16, v53
    v_and_b32 v181, 0xffff0000, v53
    v_lshlrev_b32 v182, 16, v54
    v_and_b32 v183, 0xffff0000, v54
    v_lshlrev_b32 v184, 16, v55
    v_and_b32 v185, 0xffff0000, v55
    v_add_f32 v166, v166, v86
    v_add_f32 v167, v167, v87
    v_add_f32 v168, v168, v88
    v_add_f32 v169, v169, v89
    v_add_f32 v170, v170, v90
    v_add_f32 v171, v171, v91
    v_add_f32 v172, v172, v92
    v_add_f32 v173, v173, v93
    v_add_f32 v174, v174, v94
    v_add_f32 v175, v175, v95
    v_add_f32 v176, v176, v96
    v_add_f32 v177, v177, v97
    v_add_f32 v178, v178, v98
    v_add_f32 v179, v179, v99
    v_add_f32 v180, v180, v100
    v_add_f32 v181, v181, v101
    v_add_f32 v182, v182, v102
    v_add_f32 v183, v183, v103
    v_add_f32 v184, v184, v104
    v_add_f32 v185, v185, v105
    v_cvt_pk_bf16_f32 v46, v166, v167
    v_cvt_pk_bf16_f32 v47, v168, v169
    v_cvt_pk_bf16_f32 v48, v170, v171
    v_cvt_pk_bf16_f32 v49, v172, v173
    v_cvt_pk_bf16_f32 v50, v174, v175
    v_cvt_pk_bf16_f32 v51, v176, v177
    v_cvt_pk_bf16_f32 v52, v178, v179
    v_cvt_pk_bf16_f32 v53, v180, v181
    v_cvt_pk_bf16_f32 v54, v182, v183
    v_cvt_pk_bf16_f32 v55, v184, v185
    buffer_store_dwordx2 v[46:47], v34, s[12:15], 0 offen offset:0
    buffer_store_dwordx2 v[48:49], v34, s[12:15], 0 offen offset:32
    buffer_store_dwordx2 v[50:51], v34, s[12:15], 0 offen offset:64
    buffer_store_dwordx2 v[52:53], v34, s[12:15], 0 offen offset:96
    buffer_store_dwordx2 v[54:55], v34, s[12:15], 0 offen offset:128
L_end:
    s_endpgm
L_slow:
    s_cmp_lg_u32 s86, 0
    s_cbranch_scc1 L_publish
    s_mov_b32 s86, 1
    s_lshl_b32 s40, s5, 12
    v_subrev_u32 v13, s40, v13
    v_subrev_u32 v14, s40, v14
    v_subrev_u32 v15, s40, v15
    v_subrev_u32 v16, s40, v16
    v_subrev_u32 v17, s40, v17
    v_subrev_u32 v18, s40, v18
    s_and_b32 s40, s5, 1
    s_lshr_b32 s41, s5, 1
    s_mul_i32 s41, s41, 3
    s_add_u32 s40, s40, s41
    s_add_u32 s40, s40, 1
    s_lshl_b32 s34, s40, 13
    s_sub_u32 s40, s34, 98304
    v_add_u32 v1, s40, v1
    v_add_u32 v2, s40, v2
    v_add_u32 v3, s40, v3
    v_add_u32 v4, s40, v4
    v_add_u32 v5, s34, v5
    v_add_u32 v6, s34, v6
    v_add_u32 v7, s34, v7
    v_add_u32 v8, s34, v8
    v_add_u32 v9, s34, v9
    v_add_u32 v10, s34, v10
    v_add_u32 v11, s34, v11
    v_add_u32 v12, s34, v12
    v_mov_b32 v212, 0xff800000
    v_mov_b32 v216, 0
    v_mov_b32 v213, 0xff800000
    v_mov_b32 v217, 0
    v_mov_b32 v214, 0xff800000
    v_mov_b32 v218, 0
    v_mov_b32 v215, 0xff800000
    v_mov_b32 v219, 0
    v_accvgpr_write_b32 a0, 0
    v_accvgpr_write_b32 a1, 0
    v_accvgpr_write_b32 a2, 0
    v_accvgpr_write_b32 a3, 0
    v_accvgpr_write_b32 a4, 0
    v_accvgpr_write_b32 a5, 0
    v_accvgpr_write_b32 a6, 0
    v_accvgpr_write_b32 a7, 0
    v_accvgpr_write_b32 a8, 0
    v_accvgpr_write_b32 a9, 0
    v_accvgpr_write_b32 a10, 0
    v_accvgpr_write_b32 a11, 0
    v_accvgpr_write_b32 a12, 0
    v_accvgpr_write_b32 a13, 0
    v_accvgpr_write_b32 a14, 0
    v_accvgpr_write_b32 a15, 0
    v_accvgpr_write_b32 a16, 0
    v_accvgpr_write_b32 a17, 0
    v_accvgpr_write_b32 a18, 0
    v_accvgpr_write_b32 a19, 0
    v_accvgpr_write_b32 a20, 0
    v_accvgpr_write_b32 a21, 0
    v_accvgpr_write_b32 a22, 0
    v_accvgpr_write_b32 a23, 0
    v_accvgpr_write_b32 a24, 0
    v_accvgpr_write_b32 a25, 0
    v_accvgpr_write_b32 a26, 0
    v_accvgpr_write_b32 a27, 0
    v_accvgpr_write_b32 a28, 0
    v_accvgpr_write_b32 a29, 0
    v_accvgpr_write_b32 a30, 0
    v_accvgpr_write_b32 a31, 0
    v_accvgpr_write_b32 a32, 0
    v_accvgpr_write_b32 a33, 0
    v_accvgpr_write_b32 a34, 0
    v_accvgpr_write_b32 a35, 0
    v_accvgpr_write_b32 a36, 0
    v_accvgpr_write_b32 a37, 0
    v_accvgpr_write_b32 a38, 0
    v_accvgpr_write_b32 a39, 0
    v_accvgpr_write_b32 a40, 0
    v_accvgpr_write_b32 a41, 0
    v_accvgpr_write_b32 a42, 0
    v_accvgpr_write_b32 a43, 0
    v_accvgpr_write_b32 a44, 0
    v_accvgpr_write_b32 a45, 0
    v_accvgpr_write_b32 a46, 0
    v_accvgpr_write_b32 a47, 0
    v_accvgpr_write_b32 a48, 0
    v_accvgpr_write_b32 a49, 0
    v_accvgpr_write_b32 a50, 0
    v_accvgpr_write_b32 a51, 0
    v_accvgpr_write_b32 a52, 0
    v_accvgpr_write_b32 a53, 0
    v_accvgpr_write_b32 a54, 0
    v_accvgpr_write_b32 a55, 0
    v_accvgpr_write_b32 a56, 0
    v_accvgpr_write_b32 a57, 0
    v_accvgpr_write_b32 a58, 0
    v_accvgpr_write_b32 a59, 0
    v_accvgpr_write_b32 a60, 0
    v_accvgpr_write_b32 a61, 0
    v_accvgpr_write_b32 a62, 0
    v_accvgpr_write_b32 a63, 0
    v_accvgpr_write_b32 a64, 0
    v_accvgpr_write_b32 a65, 0
    v_accvgpr_write_b32 a66, 0
    v_accvgpr_write_b32 a67, 0
    v_accvgpr_write_b32 a68, 0
    v_accvgpr_write_b32 a69, 0
    v_accvgpr_write_b32 a70, 0
    v_accvgpr_write_b32 a71, 0
    v_accvgpr_write_b32 a72, 0
    v_accvgpr_write_b32 a73, 0
    v_accvgpr_write_b32 a74, 0
    v_accvgpr_write_b32 a75, 0
    v_accvgpr_write_b32 a76, 0
    v_accvgpr_write_b32 a77, 0
    v_accvgpr_write_b32 a78, 0
    v_accvgpr_write_b32 a79, 0
    v_accvgpr_write_b32 a80, 0
    v_accvgpr_write_b32 a81, 0
    v_accvgpr_write_b32 a82, 0
    v_accvgpr_write_b32 a83, 0
    v_accvgpr_write_b32 a84, 0
    v_accvgpr_write_b32 a85, 0
    v_accvgpr_write_b32 a86, 0
    v_accvgpr_write_b32 a87, 0
    v_accvgpr_write_b32 a88, 0
    v_accvgpr_write_b32 a89, 0
    v_accvgpr_write_b32 a90, 0
    v_accvgpr_write_b32 a91, 0
    v_accvgpr_write_b32 a92, 0
    v_accvgpr_write_b32 a93, 0
    v_accvgpr_write_b32 a94, 0
    v_accvgpr_write_b32 a95, 0
    v_accvgpr_write_b32 a96, 0
    v_accvgpr_write_b32 a97, 0
    v_accvgpr_write_b32 a98, 0
    v_accvgpr_write_b32 a99, 0
    v_accvgpr_write_b32 a100, 0
    v_accvgpr_write_b32 a101, 0
    v_accvgpr_write_b32 a102, 0
    v_accvgpr_write_b32 a103, 0
    v_accvgpr_write_b32 a104, 0
    v_accvgpr_write_b32 a105, 0
    v_accvgpr_write_b32 a106, 0
    v_accvgpr_write_b32 a107, 0
    v_accvgpr_write_b32 a108, 0
    v_accvgpr_write_b32 a109, 0
    v_accvgpr_write_b32 a110, 0
    v_accvgpr_write_b32 a111, 0
    v_accvgpr_write_b32 a112, 0
    v_accvgpr_write_b32 a113, 0
    v_accvgpr_write_b32 a114, 0
    v_accvgpr_write_b32 a115, 0
    v_accvgpr_write_b32 a116, 0
    v_accvgpr_write_b32 a117, 0
    v_accvgpr_write_b32 a118, 0
    v_accvgpr_write_b32 a119, 0
    v_accvgpr_write_b32 a120, 0
    v_accvgpr_write_b32 a121, 0
    v_accvgpr_write_b32 a122, 0
    v_accvgpr_write_b32 a123, 0
    v_accvgpr_write_b32 a124, 0
    v_accvgpr_write_b32 a125, 0
    v_accvgpr_write_b32 a126, 0
    v_accvgpr_write_b32 a127, 0
    s_mov_b32 s28, 0
L_slow_loop:
    s_add_u32 m0, s34, 0
    s_add_u32 s40, s28, 0
    buffer_load_dwordx4 v13, s[8:11], s40 offen offset:0 lds
    buffer_load_dwordx4 v14, s[8:11], s40 offen offset:1024 lds
    buffer_load_dwordx4 v15, s[8:11], s40 offen offset:2048 lds
    buffer_load_dwordx4 v16, s[8:11], s40 offen offset:3072 lds
    s_add_u32 m0, s34, 4096
    s_add_u32 s40, s28, 4096
    buffer_load_dwordx4 v13, s[8:11], s40 offen offset:0 lds
    buffer_load_dwordx4 v14, s[8:11], s40 offen offset:1024 lds
    buffer_load_dwordx4 v15, s[8:11], s40 offen offset:2048 lds
    buffer_load_dwordx4 v16, s[8:11], s40 offen offset:3072 lds
    s_waitcnt vmcnt(0)
    ds_read_b128 v[148:151], v1 offset:0
    ds_read_b128 v[152:155], v2 offset:0
    ds_read_b128 v[156:159], v3 offset:0
    ds_read_b128 v[160:163], v4 offset:0
    ds_read_b128 v[164:167], v1 offset:4096
    ds_read_b128 v[168:171], v2 offset:4096
    ds_read_b128 v[172:175], v3 offset:4096
    ds_read_b128 v[176:179], v4 offset:4096
    s_waitcnt lgkmcnt(0)
    s_add_u32 m0, s34, 0
    s_add_u32 s40, s28, 0
    buffer_load_dwordx4 v17, s[12:15], s40 offen offset:0 lds
    buffer_load_dwordx4 v18, s[12:15], s40 offen offset:1024 lds
    buffer_load_dwordx4 v17, s[12:15], s40 offen offset:2048 lds
    buffer_load_dwordx4 v18, s[12:15], s40 offen offset:3072 lds
    s_add_u32 m0, s34, 4096
    s_add_u32 s40, s28, 4096
    buffer_load_dwordx4 v17, s[12:15], s40 offen offset:0 lds
    buffer_load_dwordx4 v18, s[12:15], s40 offen offset:1024 lds
    buffer_load_dwordx4 v17, s[12:15], s40 offen offset:2048 lds
    buffer_load_dwordx4 v18, s[12:15], s40 offen offset:3072 lds
    s_waitcnt vmcnt(0)
    ds_read_b64_tr_b16 v[196:197], v5 offset:0
    ds_read_b64_tr_b16 v[198:199], v5 offset:4096
    ds_read_b64_tr_b16 v[200:201], v6 offset:0
    ds_read_b64_tr_b16 v[202:203], v6 offset:4096
    ds_read_b64_tr_b16 v[204:205], v7 offset:0
    ds_read_b64_tr_b16 v[206:207], v7 offset:4096
    ds_read_b64_tr_b16 v[208:209], v8 offset:0
    ds_read_b64_tr_b16 v[210:211], v8 offset:4096
    ds_read_b64_tr_b16 v[228:229], v9 offset:0
    ds_read_b64_tr_b16 v[230:231], v9 offset:4096
    ds_read_b64_tr_b16 v[232:233], v10 offset:0
    ds_read_b64_tr_b16 v[234:235], v10 offset:4096
    ds_read_b64_tr_b16 v[236:237], v11 offset:0
    ds_read_b64_tr_b16 v[238:239], v11 offset:4096
    ds_read_b64_tr_b16 v[240:241], v12 offset:0
    ds_read_b64_tr_b16 v[242:243], v12 offset:4096
    v_mfma_f32_16x16x32_bf16 v[116:119], v[148:151], v[36:39], 0
    v_mfma_f32_16x16x32_bf16 v[116:119], v[152:155], v[40:43], v[116:119]
    v_mfma_f32_16x16x32_bf16 v[116:119], v[156:159], v[44:47], v[116:119]
    v_mfma_f32_16x16x32_bf16 v[116:119], v[160:163], v[48:51], v[116:119]
    v_mfma_f32_16x16x32_bf16 v[132:135], v[164:167], v[36:39], 0
    v_mfma_f32_16x16x32_bf16 v[132:135], v[168:171], v[40:43], v[132:135]
    v_mfma_f32_16x16x32_bf16 v[132:135], v[172:175], v[44:47], v[132:135]
    v_mfma_f32_16x16x32_bf16 v[132:135], v[176:179], v[48:51], v[132:135]
    v_mfma_f32_16x16x32_bf16 v[120:123], v[160:163], v[64:67], 0
    v_mfma_f32_16x16x32_bf16 v[120:123], v[156:159], v[60:63], v[120:123]
    v_mfma_f32_16x16x32_bf16 v[120:123], v[152:155], v[56:59], v[120:123]
    v_mfma_f32_16x16x32_bf16 v[120:123], v[148:151], v[52:55], v[120:123]
    v_mfma_f32_16x16x32_bf16 v[136:139], v[176:179], v[64:67], 0
    v_mfma_f32_16x16x32_bf16 v[136:139], v[172:175], v[60:63], v[136:139]
    v_mfma_f32_16x16x32_bf16 v[136:139], v[168:171], v[56:59], v[136:139]
    v_mfma_f32_16x16x32_bf16 v[136:139], v[164:167], v[52:55], v[136:139]
    v_mfma_f32_16x16x32_bf16 v[124:127], v[148:151], v[68:71], 0
    v_mfma_f32_16x16x32_bf16 v[124:127], v[152:155], v[72:75], v[124:127]
    v_mfma_f32_16x16x32_bf16 v[124:127], v[156:159], v[76:79], v[124:127]
    v_mfma_f32_16x16x32_bf16 v[124:127], v[160:163], v[80:83], v[124:127]
    v_mfma_f32_16x16x32_bf16 v[140:143], v[164:167], v[68:71], 0
    v_mfma_f32_16x16x32_bf16 v[140:143], v[168:171], v[72:75], v[140:143]
    v_mfma_f32_16x16x32_bf16 v[140:143], v[172:175], v[76:79], v[140:143]
    v_mfma_f32_16x16x32_bf16 v[140:143], v[176:179], v[80:83], v[140:143]
    v_mfma_f32_16x16x32_bf16 v[128:131], v[160:163], v[96:99], 0
    v_mfma_f32_16x16x32_bf16 v[128:131], v[156:159], v[92:95], v[128:131]
    v_mfma_f32_16x16x32_bf16 v[128:131], v[152:155], v[88:91], v[128:131]
    v_mfma_f32_16x16x32_bf16 v[128:131], v[148:151], v[84:87], v[128:131]
    v_mfma_f32_16x16x32_bf16 v[144:147], v[176:179], v[96:99], 0
    v_mfma_f32_16x16x32_bf16 v[144:147], v[172:175], v[92:95], v[144:147]
    v_mfma_f32_16x16x32_bf16 v[144:147], v[168:171], v[88:91], v[144:147]
    v_mfma_f32_16x16x32_bf16 v[144:147], v[164:167], v[84:87], v[144:147]
    s_waitcnt lgkmcnt(0)
    s_nop 7
    v_max3_f32 v224, v116, v117, v118
    v_max3_f32 v224, v224, v119, v132
    v_max3_f32 v224, v224, v133, v134
    v_max3_f32 v224, v224, v135, v212
    v_mov_b32 v225, v224
    s_nop 1
    v_permlane32_swap_b32 v224, v225
    v_max_f32 v224, v224, v225
    v_mov_b32 v225, v224
    s_nop 1
    v_permlane16_swap_b32 v224, v225
    v_max_f32 v224, v224, v225
    v_sub_f32 v220, v212, v224
    v_exp_f32 v220, v220
    v_mov_b32 v212, v224
    v_sub_f32 v116, v116, v224
    v_sub_f32 v117, v117, v224
    v_sub_f32 v118, v118, v224
    v_sub_f32 v119, v119, v224
    v_sub_f32 v132, v132, v224
    v_sub_f32 v133, v133, v224
    v_sub_f32 v134, v134, v224
    v_sub_f32 v135, v135, v224
    v_mul_f32 v216, v216, v220
    v_exp_f32 v116, v116
    v_exp_f32 v117, v117
    v_exp_f32 v118, v118
    v_exp_f32 v119, v119
    v_exp_f32 v132, v132
    v_exp_f32 v133, v133
    v_exp_f32 v134, v134
    v_exp_f32 v135, v135
    v_accvgpr_read_b32 v224, a0
    v_accvgpr_read_b32 v225, a1
    v_accvgpr_read_b32 v226, a2
    v_accvgpr_read_b32 v227, a3
    v_mul_f32 v224, v224, v220
    v_mul_f32 v225, v225, v220
    v_mul_f32 v226, v226, v220
    v_mul_f32 v227, v227, v220
    v_accvgpr_write_b32 a0, v224
    v_accvgpr_write_b32 a1, v225
    v_accvgpr_write_b32 a2, v226
    v_accvgpr_write_b32 a3, v227
    v_accvgpr_read_b32 v224, a16
    v_accvgpr_read_b32 v225, a17
    v_accvgpr_read_b32 v226, a18
    v_accvgpr_read_b32 v227, a19
    v_mul_f32 v224, v224, v220
    v_mul_f32 v225, v225, v220
    v_mul_f32 v226, v226, v220
    v_mul_f32 v227, v227, v220
    v_accvgpr_write_b32 a16, v224
    v_accvgpr_write_b32 a17, v225
    v_accvgpr_write_b32 a18, v226
    v_accvgpr_write_b32 a19, v227
    v_accvgpr_read_b32 v224, a32
    v_accvgpr_read_b32 v225, a33
    v_accvgpr_read_b32 v226, a34
    v_accvgpr_read_b32 v227, a35
    v_mul_f32 v224, v224, v220
    v_mul_f32 v225, v225, v220
    v_mul_f32 v226, v226, v220
    v_mul_f32 v227, v227, v220
    v_accvgpr_write_b32 a32, v224
    v_accvgpr_write_b32 a33, v225
    v_accvgpr_write_b32 a34, v226
    v_accvgpr_write_b32 a35, v227
    v_accvgpr_read_b32 v224, a48
    v_accvgpr_read_b32 v225, a49
    v_accvgpr_read_b32 v226, a50
    v_accvgpr_read_b32 v227, a51
    v_mul_f32 v224, v224, v220
    v_mul_f32 v225, v225, v220
    v_mul_f32 v226, v226, v220
    v_mul_f32 v227, v227, v220
    v_accvgpr_write_b32 a48, v224
    v_accvgpr_write_b32 a49, v225
    v_accvgpr_write_b32 a50, v226
    v_accvgpr_write_b32 a51, v227
    v_accvgpr_read_b32 v224, a64
    v_accvgpr_read_b32 v225, a65
    v_accvgpr_read_b32 v226, a66
    v_accvgpr_read_b32 v227, a67
    v_mul_f32 v224, v224, v220
    v_mul_f32 v225, v225, v220
    v_mul_f32 v226, v226, v220
    v_mul_f32 v227, v227, v220
    v_accvgpr_write_b32 a64, v224
    v_accvgpr_write_b32 a65, v225
    v_accvgpr_write_b32 a66, v226
    v_accvgpr_write_b32 a67, v227
    v_accvgpr_read_b32 v224, a80
    v_accvgpr_read_b32 v225, a81
    v_accvgpr_read_b32 v226, a82
    v_accvgpr_read_b32 v227, a83
    v_mul_f32 v224, v224, v220
    v_mul_f32 v225, v225, v220
    v_mul_f32 v226, v226, v220
    v_mul_f32 v227, v227, v220
    v_accvgpr_write_b32 a80, v224
    v_accvgpr_write_b32 a81, v225
    v_accvgpr_write_b32 a82, v226
    v_accvgpr_write_b32 a83, v227
    v_accvgpr_read_b32 v224, a96
    v_accvgpr_read_b32 v225, a97
    v_accvgpr_read_b32 v226, a98
    v_accvgpr_read_b32 v227, a99
    v_mul_f32 v224, v224, v220
    v_mul_f32 v225, v225, v220
    v_mul_f32 v226, v226, v220
    v_mul_f32 v227, v227, v220
    v_accvgpr_write_b32 a96, v224
    v_accvgpr_write_b32 a97, v225
    v_accvgpr_write_b32 a98, v226
    v_accvgpr_write_b32 a99, v227
    v_accvgpr_read_b32 v224, a112
    v_accvgpr_read_b32 v225, a113
    v_accvgpr_read_b32 v226, a114
    v_accvgpr_read_b32 v227, a115
    v_mul_f32 v224, v224, v220
    v_mul_f32 v225, v225, v220
    v_mul_f32 v226, v226, v220
    v_mul_f32 v227, v227, v220
    v_accvgpr_write_b32 a112, v224
    v_accvgpr_write_b32 a113, v225
    v_accvgpr_write_b32 a114, v226
    v_accvgpr_write_b32 a115, v227
    v_add_f32 v216, v216, v116
    v_add_f32 v216, v216, v117
    v_add_f32 v216, v216, v118
    v_add_f32 v216, v216, v119
    v_add_f32 v216, v216, v132
    v_add_f32 v216, v216, v133
    v_add_f32 v216, v216, v134
    v_add_f32 v216, v216, v135
    v_cvt_pk_bf16_f32 v180, v116, v117
    v_cvt_pk_bf16_f32 v181, v118, v119
    v_cvt_pk_bf16_f32 v182, v132, v133
    v_cvt_pk_bf16_f32 v183, v134, v135
    s_nop 1
    v_mfma_f32_16x16x32_bf16 a[0:3], v[196:199], v[180:183], a[0:3]
    v_mfma_f32_16x16x32_bf16 a[16:19], v[200:203], v[180:183], a[16:19]
    v_mfma_f32_16x16x32_bf16 a[32:35], v[204:207], v[180:183], a[32:35]
    v_mfma_f32_16x16x32_bf16 a[48:51], v[208:211], v[180:183], a[48:51]
    v_mfma_f32_16x16x32_bf16 a[64:67], v[228:231], v[180:183], a[64:67]
    v_mfma_f32_16x16x32_bf16 a[80:83], v[232:235], v[180:183], a[80:83]
    v_mfma_f32_16x16x32_bf16 a[96:99], v[236:239], v[180:183], a[96:99]
    v_mfma_f32_16x16x32_bf16 a[112:115], v[240:243], v[180:183], a[112:115]
    v_max3_f32 v224, v120, v121, v122
    v_max3_f32 v224, v224, v123, v136
    v_max3_f32 v224, v224, v137, v138
    v_max3_f32 v224, v224, v139, v213
    v_mov_b32 v225, v224
    s_nop 1
    v_permlane32_swap_b32 v224, v225
    v_max_f32 v224, v224, v225
    v_mov_b32 v225, v224
    s_nop 1
    v_permlane16_swap_b32 v224, v225
    v_max_f32 v224, v224, v225
    v_sub_f32 v220, v213, v224
    v_exp_f32 v220, v220
    v_mov_b32 v213, v224
    v_sub_f32 v120, v120, v224
    v_sub_f32 v121, v121, v224
    v_sub_f32 v122, v122, v224
    v_sub_f32 v123, v123, v224
    v_sub_f32 v136, v136, v224
    v_sub_f32 v137, v137, v224
    v_sub_f32 v138, v138, v224
    v_sub_f32 v139, v139, v224
    v_mul_f32 v217, v217, v220
    v_exp_f32 v120, v120
    v_exp_f32 v121, v121
    v_exp_f32 v122, v122
    v_exp_f32 v123, v123
    v_exp_f32 v136, v136
    v_exp_f32 v137, v137
    v_exp_f32 v138, v138
    v_exp_f32 v139, v139
    v_accvgpr_read_b32 v224, a4
    v_accvgpr_read_b32 v225, a5
    v_accvgpr_read_b32 v226, a6
    v_accvgpr_read_b32 v227, a7
    v_mul_f32 v224, v224, v220
    v_mul_f32 v225, v225, v220
    v_mul_f32 v226, v226, v220
    v_mul_f32 v227, v227, v220
    v_accvgpr_write_b32 a4, v224
    v_accvgpr_write_b32 a5, v225
    v_accvgpr_write_b32 a6, v226
    v_accvgpr_write_b32 a7, v227
    v_accvgpr_read_b32 v224, a20
    v_accvgpr_read_b32 v225, a21
    v_accvgpr_read_b32 v226, a22
    v_accvgpr_read_b32 v227, a23
    v_mul_f32 v224, v224, v220
    v_mul_f32 v225, v225, v220
    v_mul_f32 v226, v226, v220
    v_mul_f32 v227, v227, v220
    v_accvgpr_write_b32 a20, v224
    v_accvgpr_write_b32 a21, v225
    v_accvgpr_write_b32 a22, v226
    v_accvgpr_write_b32 a23, v227
    v_accvgpr_read_b32 v224, a36
    v_accvgpr_read_b32 v225, a37
    v_accvgpr_read_b32 v226, a38
    v_accvgpr_read_b32 v227, a39
    v_mul_f32 v224, v224, v220
    v_mul_f32 v225, v225, v220
    v_mul_f32 v226, v226, v220
    v_mul_f32 v227, v227, v220
    v_accvgpr_write_b32 a36, v224
    v_accvgpr_write_b32 a37, v225
    v_accvgpr_write_b32 a38, v226
    v_accvgpr_write_b32 a39, v227
    v_accvgpr_read_b32 v224, a52
    v_accvgpr_read_b32 v225, a53
    v_accvgpr_read_b32 v226, a54
    v_accvgpr_read_b32 v227, a55
    v_mul_f32 v224, v224, v220
    v_mul_f32 v225, v225, v220
    v_mul_f32 v226, v226, v220
    v_mul_f32 v227, v227, v220
    v_accvgpr_write_b32 a52, v224
    v_accvgpr_write_b32 a53, v225
    v_accvgpr_write_b32 a54, v226
    v_accvgpr_write_b32 a55, v227
    v_accvgpr_read_b32 v224, a68
    v_accvgpr_read_b32 v225, a69
    v_accvgpr_read_b32 v226, a70
    v_accvgpr_read_b32 v227, a71
    v_mul_f32 v224, v224, v220
    v_mul_f32 v225, v225, v220
    v_mul_f32 v226, v226, v220
    v_mul_f32 v227, v227, v220
    v_accvgpr_write_b32 a68, v224
    v_accvgpr_write_b32 a69, v225
    v_accvgpr_write_b32 a70, v226
    v_accvgpr_write_b32 a71, v227
    v_accvgpr_read_b32 v224, a84
    v_accvgpr_read_b32 v225, a85
    v_accvgpr_read_b32 v226, a86
    v_accvgpr_read_b32 v227, a87
    v_mul_f32 v224, v224, v220
    v_mul_f32 v225, v225, v220
    v_mul_f32 v226, v226, v220
    v_mul_f32 v227, v227, v220
    v_accvgpr_write_b32 a84, v224
    v_accvgpr_write_b32 a85, v225
    v_accvgpr_write_b32 a86, v226
    v_accvgpr_write_b32 a87, v227
    v_accvgpr_read_b32 v224, a100
    v_accvgpr_read_b32 v225, a101
    v_accvgpr_read_b32 v226, a102
    v_accvgpr_read_b32 v227, a103
    v_mul_f32 v224, v224, v220
    v_mul_f32 v225, v225, v220
    v_mul_f32 v226, v226, v220
    v_mul_f32 v227, v227, v220
    v_accvgpr_write_b32 a100, v224
    v_accvgpr_write_b32 a101, v225
    v_accvgpr_write_b32 a102, v226
    v_accvgpr_write_b32 a103, v227
    v_accvgpr_read_b32 v224, a116
    v_accvgpr_read_b32 v225, a117
    v_accvgpr_read_b32 v226, a118
    v_accvgpr_read_b32 v227, a119
    v_mul_f32 v224, v224, v220
    v_mul_f32 v225, v225, v220
    v_mul_f32 v226, v226, v220
    v_mul_f32 v227, v227, v220
    v_accvgpr_write_b32 a116, v224
    v_accvgpr_write_b32 a117, v225
    v_accvgpr_write_b32 a118, v226
    v_accvgpr_write_b32 a119, v227
    v_add_f32 v217, v217, v120
    v_add_f32 v217, v217, v121
    v_add_f32 v217, v217, v122
    v_add_f32 v217, v217, v123
    v_add_f32 v217, v217, v136
    v_add_f32 v217, v217, v137
    v_add_f32 v217, v217, v138
    v_add_f32 v217, v217, v139
    v_cvt_pk_bf16_f32 v184, v120, v121
    v_cvt_pk_bf16_f32 v185, v122, v123
    v_cvt_pk_bf16_f32 v186, v136, v137
    v_cvt_pk_bf16_f32 v187, v138, v139
    s_nop 1
    v_mfma_f32_16x16x32_bf16 a[4:7], v[196:199], v[184:187], a[4:7]
    v_mfma_f32_16x16x32_bf16 a[20:23], v[200:203], v[184:187], a[20:23]
    v_mfma_f32_16x16x32_bf16 a[36:39], v[204:207], v[184:187], a[36:39]
    v_mfma_f32_16x16x32_bf16 a[52:55], v[208:211], v[184:187], a[52:55]
    v_mfma_f32_16x16x32_bf16 a[68:71], v[228:231], v[184:187], a[68:71]
    v_mfma_f32_16x16x32_bf16 a[84:87], v[232:235], v[184:187], a[84:87]
    v_mfma_f32_16x16x32_bf16 a[100:103], v[236:239], v[184:187], a[100:103]
    v_mfma_f32_16x16x32_bf16 a[116:119], v[240:243], v[184:187], a[116:119]
    v_max3_f32 v224, v124, v125, v126
    v_max3_f32 v224, v224, v127, v140
    v_max3_f32 v224, v224, v141, v142
    v_max3_f32 v224, v224, v143, v214
    v_mov_b32 v225, v224
    s_nop 1
    v_permlane32_swap_b32 v224, v225
    v_max_f32 v224, v224, v225
    v_mov_b32 v225, v224
    s_nop 1
    v_permlane16_swap_b32 v224, v225
    v_max_f32 v224, v224, v225
    v_sub_f32 v220, v214, v224
    v_exp_f32 v220, v220
    v_mov_b32 v214, v224
    v_sub_f32 v124, v124, v224
    v_sub_f32 v125, v125, v224
    v_sub_f32 v126, v126, v224
    v_sub_f32 v127, v127, v224
    v_sub_f32 v140, v140, v224
    v_sub_f32 v141, v141, v224
    v_sub_f32 v142, v142, v224
    v_sub_f32 v143, v143, v224
    v_mul_f32 v218, v218, v220
    v_exp_f32 v124, v124
    v_exp_f32 v125, v125
    v_exp_f32 v126, v126
    v_exp_f32 v127, v127
    v_exp_f32 v140, v140
    v_exp_f32 v141, v141
    v_exp_f32 v142, v142
    v_exp_f32 v143, v143
    v_accvgpr_read_b32 v224, a8
    v_accvgpr_read_b32 v225, a9
    v_accvgpr_read_b32 v226, a10
    v_accvgpr_read_b32 v227, a11
    v_mul_f32 v224, v224, v220
    v_mul_f32 v225, v225, v220
    v_mul_f32 v226, v226, v220
    v_mul_f32 v227, v227, v220
    v_accvgpr_write_b32 a8, v224
    v_accvgpr_write_b32 a9, v225
    v_accvgpr_write_b32 a10, v226
    v_accvgpr_write_b32 a11, v227
    v_accvgpr_read_b32 v224, a24
    v_accvgpr_read_b32 v225, a25
    v_accvgpr_read_b32 v226, a26
    v_accvgpr_read_b32 v227, a27
    v_mul_f32 v224, v224, v220
    v_mul_f32 v225, v225, v220
    v_mul_f32 v226, v226, v220
    v_mul_f32 v227, v227, v220
    v_accvgpr_write_b32 a24, v224
    v_accvgpr_write_b32 a25, v225
    v_accvgpr_write_b32 a26, v226
    v_accvgpr_write_b32 a27, v227
    v_accvgpr_read_b32 v224, a40
    v_accvgpr_read_b32 v225, a41
    v_accvgpr_read_b32 v226, a42
    v_accvgpr_read_b32 v227, a43
    v_mul_f32 v224, v224, v220
    v_mul_f32 v225, v225, v220
    v_mul_f32 v226, v226, v220
    v_mul_f32 v227, v227, v220
    v_accvgpr_write_b32 a40, v224
    v_accvgpr_write_b32 a41, v225
    v_accvgpr_write_b32 a42, v226
    v_accvgpr_write_b32 a43, v227
    v_accvgpr_read_b32 v224, a56
    v_accvgpr_read_b32 v225, a57
    v_accvgpr_read_b32 v226, a58
    v_accvgpr_read_b32 v227, a59
    v_mul_f32 v224, v224, v220
    v_mul_f32 v225, v225, v220
    v_mul_f32 v226, v226, v220
    v_mul_f32 v227, v227, v220
    v_accvgpr_write_b32 a56, v224
    v_accvgpr_write_b32 a57, v225
    v_accvgpr_write_b32 a58, v226
    v_accvgpr_write_b32 a59, v227
    v_accvgpr_read_b32 v224, a72
    v_accvgpr_read_b32 v225, a73
    v_accvgpr_read_b32 v226, a74
    v_accvgpr_read_b32 v227, a75
    v_mul_f32 v224, v224, v220
    v_mul_f32 v225, v225, v220
    v_mul_f32 v226, v226, v220
    v_mul_f32 v227, v227, v220
    v_accvgpr_write_b32 a72, v224
    v_accvgpr_write_b32 a73, v225
    v_accvgpr_write_b32 a74, v226
    v_accvgpr_write_b32 a75, v227
    v_accvgpr_read_b32 v224, a88
    v_accvgpr_read_b32 v225, a89
    v_accvgpr_read_b32 v226, a90
    v_accvgpr_read_b32 v227, a91
    v_mul_f32 v224, v224, v220
    v_mul_f32 v225, v225, v220
    v_mul_f32 v226, v226, v220
    v_mul_f32 v227, v227, v220
    v_accvgpr_write_b32 a88, v224
    v_accvgpr_write_b32 a89, v225
    v_accvgpr_write_b32 a90, v226
    v_accvgpr_write_b32 a91, v227
    v_accvgpr_read_b32 v224, a104
    v_accvgpr_read_b32 v225, a105
    v_accvgpr_read_b32 v226, a106
    v_accvgpr_read_b32 v227, a107
    v_mul_f32 v224, v224, v220
    v_mul_f32 v225, v225, v220
    v_mul_f32 v226, v226, v220
    v_mul_f32 v227, v227, v220
    v_accvgpr_write_b32 a104, v224
    v_accvgpr_write_b32 a105, v225
    v_accvgpr_write_b32 a106, v226
    v_accvgpr_write_b32 a107, v227
    v_accvgpr_read_b32 v224, a120
    v_accvgpr_read_b32 v225, a121
    v_accvgpr_read_b32 v226, a122
    v_accvgpr_read_b32 v227, a123
    v_mul_f32 v224, v224, v220
    v_mul_f32 v225, v225, v220
    v_mul_f32 v226, v226, v220
    v_mul_f32 v227, v227, v220
    v_accvgpr_write_b32 a120, v224
    v_accvgpr_write_b32 a121, v225
    v_accvgpr_write_b32 a122, v226
    v_accvgpr_write_b32 a123, v227
    v_add_f32 v218, v218, v124
    v_add_f32 v218, v218, v125
    v_add_f32 v218, v218, v126
    v_add_f32 v218, v218, v127
    v_add_f32 v218, v218, v140
    v_add_f32 v218, v218, v141
    v_add_f32 v218, v218, v142
    v_add_f32 v218, v218, v143
    v_cvt_pk_bf16_f32 v188, v124, v125
    v_cvt_pk_bf16_f32 v189, v126, v127
    v_cvt_pk_bf16_f32 v190, v140, v141
    v_cvt_pk_bf16_f32 v191, v142, v143
    s_nop 1
    v_mfma_f32_16x16x32_bf16 a[8:11], v[196:199], v[188:191], a[8:11]
    v_mfma_f32_16x16x32_bf16 a[24:27], v[200:203], v[188:191], a[24:27]
    v_mfma_f32_16x16x32_bf16 a[40:43], v[204:207], v[188:191], a[40:43]
    v_mfma_f32_16x16x32_bf16 a[56:59], v[208:211], v[188:191], a[56:59]
    v_mfma_f32_16x16x32_bf16 a[72:75], v[228:231], v[188:191], a[72:75]
    v_mfma_f32_16x16x32_bf16 a[88:91], v[232:235], v[188:191], a[88:91]
    v_mfma_f32_16x16x32_bf16 a[104:107], v[236:239], v[188:191], a[104:107]
    v_mfma_f32_16x16x32_bf16 a[120:123], v[240:243], v[188:191], a[120:123]
    v_max3_f32 v224, v128, v129, v130
    v_max3_f32 v224, v224, v131, v144
    v_max3_f32 v224, v224, v145, v146
    v_max3_f32 v224, v224, v147, v215
    v_mov_b32 v225, v224
    s_nop 1
    v_permlane32_swap_b32 v224, v225
    v_max_f32 v224, v224, v225
    v_mov_b32 v225, v224
    s_nop 1
    v_permlane16_swap_b32 v224, v225
    v_max_f32 v224, v224, v225
    v_sub_f32 v220, v215, v224
    v_exp_f32 v220, v220
    v_mov_b32 v215, v224
    v_sub_f32 v128, v128, v224
    v_sub_f32 v129, v129, v224
    v_sub_f32 v130, v130, v224
    v_sub_f32 v131, v131, v224
    v_sub_f32 v144, v144, v224
    v_sub_f32 v145, v145, v224
    v_sub_f32 v146, v146, v224
    v_sub_f32 v147, v147, v224
    v_mul_f32 v219, v219, v220
    v_exp_f32 v128, v128
    v_exp_f32 v129, v129
    v_exp_f32 v130, v130
    v_exp_f32 v131, v131
    v_exp_f32 v144, v144
    v_exp_f32 v145, v145
    v_exp_f32 v146, v146
    v_exp_f32 v147, v147
    v_accvgpr_read_b32 v224, a12
    v_accvgpr_read_b32 v225, a13
    v_accvgpr_read_b32 v226, a14
    v_accvgpr_read_b32 v227, a15
    v_mul_f32 v224, v224, v220
    v_mul_f32 v225, v225, v220
    v_mul_f32 v226, v226, v220
    v_mul_f32 v227, v227, v220
    v_accvgpr_write_b32 a12, v224
    v_accvgpr_write_b32 a13, v225
    v_accvgpr_write_b32 a14, v226
    v_accvgpr_write_b32 a15, v227
    v_accvgpr_read_b32 v224, a28
    v_accvgpr_read_b32 v225, a29
    v_accvgpr_read_b32 v226, a30
    v_accvgpr_read_b32 v227, a31
    v_mul_f32 v224, v224, v220
    v_mul_f32 v225, v225, v220
    v_mul_f32 v226, v226, v220
    v_mul_f32 v227, v227, v220
    v_accvgpr_write_b32 a28, v224
    v_accvgpr_write_b32 a29, v225
    v_accvgpr_write_b32 a30, v226
    v_accvgpr_write_b32 a31, v227
    v_accvgpr_read_b32 v224, a44
    v_accvgpr_read_b32 v225, a45
    v_accvgpr_read_b32 v226, a46
    v_accvgpr_read_b32 v227, a47
    v_mul_f32 v224, v224, v220
    v_mul_f32 v225, v225, v220
    v_mul_f32 v226, v226, v220
    v_mul_f32 v227, v227, v220
    v_accvgpr_write_b32 a44, v224
    v_accvgpr_write_b32 a45, v225
    v_accvgpr_write_b32 a46, v226
    v_accvgpr_write_b32 a47, v227
    v_accvgpr_read_b32 v224, a60
    v_accvgpr_read_b32 v225, a61
    v_accvgpr_read_b32 v226, a62
    v_accvgpr_read_b32 v227, a63
    v_mul_f32 v224, v224, v220
    v_mul_f32 v225, v225, v220
    v_mul_f32 v226, v226, v220
    v_mul_f32 v227, v227, v220
    v_accvgpr_write_b32 a60, v224
    v_accvgpr_write_b32 a61, v225
    v_accvgpr_write_b32 a62, v226
    v_accvgpr_write_b32 a63, v227
    v_accvgpr_read_b32 v224, a76
    v_accvgpr_read_b32 v225, a77
    v_accvgpr_read_b32 v226, a78
    v_accvgpr_read_b32 v227, a79
    v_mul_f32 v224, v224, v220
    v_mul_f32 v225, v225, v220
    v_mul_f32 v226, v226, v220
    v_mul_f32 v227, v227, v220
    v_accvgpr_write_b32 a76, v224
    v_accvgpr_write_b32 a77, v225
    v_accvgpr_write_b32 a78, v226
    v_accvgpr_write_b32 a79, v227
    v_accvgpr_read_b32 v224, a92
    v_accvgpr_read_b32 v225, a93
    v_accvgpr_read_b32 v226, a94
    v_accvgpr_read_b32 v227, a95
    v_mul_f32 v224, v224, v220
    v_mul_f32 v225, v225, v220
    v_mul_f32 v226, v226, v220
    v_mul_f32 v227, v227, v220
    v_accvgpr_write_b32 a92, v224
    v_accvgpr_write_b32 a93, v225
    v_accvgpr_write_b32 a94, v226
    v_accvgpr_write_b32 a95, v227
    v_accvgpr_read_b32 v224, a108
    v_accvgpr_read_b32 v225, a109
    v_accvgpr_read_b32 v226, a110
    v_accvgpr_read_b32 v227, a111
    v_mul_f32 v224, v224, v220
    v_mul_f32 v225, v225, v220
    v_mul_f32 v226, v226, v220
    v_mul_f32 v227, v227, v220
    v_accvgpr_write_b32 a108, v224
    v_accvgpr_write_b32 a109, v225
    v_accvgpr_write_b32 a110, v226
    v_accvgpr_write_b32 a111, v227
    v_accvgpr_read_b32 v224, a124
    v_accvgpr_read_b32 v225, a125
    v_accvgpr_read_b32 v226, a126
    v_accvgpr_read_b32 v227, a127
    v_mul_f32 v224, v224, v220
    v_mul_f32 v225, v225, v220
    v_mul_f32 v226, v226, v220
    v_mul_f32 v227, v227, v220
    v_accvgpr_write_b32 a124, v224
    v_accvgpr_write_b32 a125, v225
    v_accvgpr_write_b32 a126, v226
    v_accvgpr_write_b32 a127, v227
    v_add_f32 v219, v219, v128
    v_add_f32 v219, v219, v129
    v_add_f32 v219, v219, v130
    v_add_f32 v219, v219, v131
    v_add_f32 v219, v219, v144
    v_add_f32 v219, v219, v145
    v_add_f32 v219, v219, v146
    v_add_f32 v219, v219, v147
    v_cvt_pk_bf16_f32 v192, v128, v129
    v_cvt_pk_bf16_f32 v193, v130, v131
    v_cvt_pk_bf16_f32 v194, v144, v145
    v_cvt_pk_bf16_f32 v195, v146, v147
    s_nop 1
    v_mfma_f32_16x16x32_bf16 a[12:15], v[196:199], v[192:195], a[12:15]
    v_mfma_f32_16x16x32_bf16 a[28:31], v[200:203], v[192:195], a[28:31]
    v_mfma_f32_16x16x32_bf16 a[44:47], v[204:207], v[192:195], a[44:47]
    v_mfma_f32_16x16x32_bf16 a[60:63], v[208:211], v[192:195], a[60:63]
    v_mfma_f32_16x16x32_bf16 a[76:79], v[228:231], v[192:195], a[76:79]
    v_mfma_f32_16x16x32_bf16 a[92:95], v[232:235], v[192:195], a[92:95]
    v_mfma_f32_16x16x32_bf16 a[108:111], v[236:239], v[192:195], a[108:111]
    v_mfma_f32_16x16x32_bf16 a[124:127], v[240:243], v[192:195], a[124:127]
    s_add_u32 s28, s28, 8192
    s_cmp_lt_u32 s28, 524288
    s_cbranch_scc1 L_slow_loop
    v_mov_b32 v224, v216
    s_nop 1
    v_permlane32_swap_b32 v216, v224
    v_add_f32 v216, v216, v224
    v_mov_b32 v224, v216
    s_nop 1
    v_permlane16_swap_b32 v216, v224
    v_add_f32 v216, v216, v224
    v_mov_b32 v100, v216
    v_mov_b32 v224, v217
    s_nop 1
    v_permlane32_swap_b32 v217, v224
    v_add_f32 v217, v217, v224
    v_mov_b32 v224, v217
    s_nop 1
    v_permlane16_swap_b32 v217, v224
    v_add_f32 v217, v217, v224
    v_mov_b32 v102, v217
    v_mov_b32 v224, v218
    s_nop 1
    v_permlane32_swap_b32 v218, v224
    v_add_f32 v218, v218, v224
    v_mov_b32 v224, v218
    s_nop 1
    v_permlane16_swap_b32 v218, v224
    v_add_f32 v218, v218, v224
    v_mov_b32 v104, v218
    v_mov_b32 v224, v219
    s_nop 1
    v_permlane32_swap_b32 v219, v224
    v_add_f32 v219, v219, v224
    v_mov_b32 v224, v219
    s_nop 1
    v_permlane16_swap_b32 v219, v224
    v_add_f32 v219, v219, v224
    v_mov_b32 v106, v219
    s_branch L_norm
L_spin_rows:
    s_mov_b32 s7, 32768
L_retry_rows:
    s_sleep 2
    buffer_load_dword v252, off, s[92:95], s74 sc1
    s_waitcnt vmcnt(0)
    v_cmp_gt_u32 vcc, 32, v252
    s_and_b64 vcc, vcc, exec
    s_cbranch_scc0 L_back_rows
    s_sub_u32 s7, s7, 1
    s_cbranch_scc0 L_retry_rows
    s_branch L_back_rows
L_spin_all:
    s_mov_b32 s7, 32768
L_retry_all:
    s_sleep 2
    buffer_load_dword v252, v253, s[92:95], 0 offen sc1
    s_waitcnt vmcnt(0)
    v_cmp_gt_u32 vcc, 32, v252
    s_and_b64 vcc, vcc, exec
    s_cbranch_scc0 L_back_all
    s_sub_u32 s7, s7, 1
    s_cbranch_scc0 L_retry_all
    s_branch L_back_all
L_site0:
    s_mov_b32 s43, m0
    s_mov_b32 m0, s38
    s_add_u32 s38, s38, 1024
    buffer_load_dwordx4 v24, s[16:19], s37 offen lds
    s_mov_b32 m0, s43
    s_add_u32 s37, s37, 221184
    s_cmp_eq_u32 s35, 1
    s_cselect_b32 s36, 4, s36
    s_branch L_site_back0
L_once_pack:
    s_mov_b64 exec, 1
    buffer_store_dword v27, off, s[76:79], s75 sc1
    s_mov_b64 exec, -1
    s_branch L_once_back_pack
L_site1:
    s_mov_b32 s43, m0
    s_mov_b32 m0, s38
    s_add_u32 s38, s38, 1024
    buffer_load_dwordx4 v24, s[16:19], s37 offen lds
    s_mov_b32 m0, s43
    s_add_u32 s37, s37, 221184
    s_cmp_eq_u32 s35, 1
    s_cselect_b32 s36, 4, s36
    s_branch L_site_back1
L_site2:
    s_mov_b32 s43, m0
    s_mov_b32 m0, s38
    s_add_u32 s38, s38, 1024
    buffer_load_dwordx4 v24, s[16:19], s37 offen lds
    s_mov_b32 m0, s43
    s_add_u32 s37, s37, 221184
    s_cmp_eq_u32 s35, 1
    s_cselect_b32 s36, 4, s36
    s_branch L_site_back2
L_site3:
    s_mov_b32 s43, m0
    s_mov_b32 m0, s38
    s_add_u32 s38, s38, 1024
    buffer_load_dwordx4 v24, s[16:19], s37 offen lds
    s_mov_b32 m0, s43
    s_add_u32 s37, s37, 221184
    s_cmp_eq_u32 s35, 1
    s_cselect_b32 s36, 4, s36
    s_branch L_site_back3
L_spin_pack:
    s_mov_b32 s7, 32768
L_retry_pack:
    s_sleep 2
    buffer_load_dwordx4 v[28:31], v32, s[76:79], 0 offen sc1
    s_waitcnt vmcnt(0)
    v_min3_u32 v28, v28, v29, v30
    v_min_u32 v28, v28, v31
    v_cmp_gt_u32 vcc, 1, v28
    s_and_b64 vcc, vcc, exec
    s_cbranch_scc0 L_back_pack
    s_sub_u32 s7, s7, 1
    s_cbranch_scc0 L_retry_pack
    s_branch L_back_pack
L_spin_ffn:
    s_mov_b32 s7, 32768
L_retry_ffn:
    s_sleep 2
    buffer_load_dwordx4 v[252:255], v20, s[76:79], 0 offen sc1
    s_waitcnt vmcnt(0)
    v_min3_u32 v252, v252, v253, v254
    v_min_u32 v252, v252, v255
    v_cmp_gt_u32 vcc, 2, v252
    s_and_b64 vcc, vcc, exec
    s_cbranch_scc0 L_back_ffn
    s_sub_u32 s7, s7, 1
    s_cbranch_scc0 L_retry_ffn
    s_branch L_back_ffn
L_spin_o:
    s_mov_b32 s7, 32768
L_retry_o:
    s_sleep 2
    buffer_load_dwordx4 v[252:255], v1, s[76:79], 0 offen sc1
    s_waitcnt vmcnt(0)
    v_min3_u32 v252, v252, v253, v254
    v_min_u32 v252, v252, v255
    v_cmp_gt_u32 vcc, 1, v252
    s_and_b64 vcc, vcc, exec
    s_cbranch_scc0 L_back_o
    s_sub_u32 s7, s7, 1
    s_cbranch_scc0 L_retry_o
    s_branch L_back_o
L_spin_upd:
    s_mov_b32 s7, 32768
L_retry_upd:
    s_sleep 2
    buffer_load_dwordx4 v[252:255], v1, s[76:79], 0 offen sc1
    s_waitcnt vmcnt(0)
    v_min3_u32 v252, v252, v253, v254
    v_min_u32 v252, v252, v255
    v_cmp_gt_u32 vcc, 3, v252
    s_and_b64 vcc, vcc, exec
    s_cbranch_scc0 L_back_upd
    s_sub_u32 s7, s7, 1
    s_cbranch_scc0 L_retry_upd
    s_branch L_back_upd
L_code_end:
    s_endpgm

.section .rodata,"a"
.p2align 6
.amdhsa_kernel recurrent_scan__mha_block_cached__moe_arch_mod__prompt_kernel
  .amdhsa_next_free_vgpr 512
  .amdhsa_next_free_sgpr 102
  .amdhsa_accum_offset 256
  .amdhsa_group_segment_fixed_size 0
  .amdhsa_kernarg_size 104
  .amdhsa_user_sgpr_count 2
  .amdhsa_user_sgpr_kernarg_segment_ptr 1
  .amdhsa_system_sgpr_workgroup_id_x 1
  .amdhsa_float_denorm_mode_32 3
.end_amdhsa_kernel
```

```asm
; @launch grid=(256,1,1) block=(256,1,1) lds=163840
.amdgcn_target "amdgcn-amd-amdhsa--gfx950"
.text
.globl recurrent_scan__mha_block_cached__moe_arch_mod__prompt_kernel
.p2align 8
.type recurrent_scan__mha_block_cached__moe_arch_mod__prompt_kernel,@function
recurrent_scan__mha_block_cached__moe_arch_mod__prompt_kernel:
    s_cmp_ge_u32 s2, 256
    s_cbranch_scc1 L_end
    s_load_dwordx16 s[48:63], s[0:1], 0
    s_load_dwordx8 s[64:71], s[0:1], 64
    s_load_dwordx2 s[72:73], s[0:1], 96
    s_getpc_b64 s[40:41]
L_touch:
    s_bfe_u32 s42, s2, 0x20003
    s_lshl_b32 s42, s42, 8
    v_add_u32 v252, s42, v0
    v_min_u32 v252, (L_code_end - L_touch) / 128, v252
    v_lshlrev_b32 v252, 7, v252
    global_load_dword a120, v252, s[40:41]
    v_lshrrev_b32 v116, 6, v0
    v_and_b32 v19, 63, v0
    s_and_b32 s40, s2, 7
    v_readfirstlane_b32 s5, v116
    s_lshl_b32 s40, s40, 2
    s_bfe_u32 s41, s2, 0x20003
    s_add_u32 s3, s40, s41
    s_lshr_b32 s4, s2, 5
    s_lshl_b32 s74, s4, 5
    s_add_u32 s6, s74, s3
    v_lshrrev_b32 v118, 4, v19
    v_and_b32 v117, 15, v19
    v_lshlrev_b32 v119, 1, v118
    v_xor_b32 v119, v117, v119
    s_lshl_b32 s42, s5, 4
    v_add_u32 v120, s42, v118
    v_lshlrev_b32 v121, 4, v119
    v_xor_b32 v122, 0x80, v121
    v_lshl_add_u32 v123, v120, 13, v121
    v_lshl_add_u32 v116, v120, 13, v122
    v_add_u32 v44, 0, v123
    v_add_u32 v45, 31744, v123
    v_add_u32 v46, 63488, v116
    v_add_u32 v47, 95232, v116
    v_lshl_add_u32 v17, v120, 8, v121
    v_lshl_add_u32 v18, v120, 8, v122
    v_xor_b32 v117, v117, v118
    v_xor_b32 v121, 0, v117
    v_lshlrev_b32 v121, 4, v121
    v_lshl_add_u32 v13, v120, 8, v121
    v_xor_b32 v121, 4, v117
    v_lshlrev_b32 v121, 4, v121
    v_lshl_add_u32 v14, v120, 8, v121
    v_xor_b32 v121, 8, v117
    v_lshlrev_b32 v121, 4, v121
    v_lshl_add_u32 v15, v120, 8, v121
    v_xor_b32 v121, 12, v117
    v_lshlrev_b32 v121, 4, v121
    v_lshl_add_u32 v16, v120, 8, v121
    v_lshrrev_b32 v116, 3, v19
    v_and_b32 v117, 7, v19
    v_xor_b32 v117, v117, v118
    v_mul_u32_u24 v116, 1280, v116
    s_mul_i32 s42, s5, 81920
    v_lshl_add_u32 v119, v117, 4, v116
    v_xor_b32 v117, 4, v117
    v_lshl_add_u32 v120, v117, 4, v116
    v_add_u32 v119, s42, v119
    v_add_u32 v120, s42, v120
    v_add_u32 v36, 0, v119
    v_add_u32 v37, 9216, v120
    v_add_u32 v38, 18432, v119
    v_add_u32 v39, 27648, v120
    v_add_u32 v40, 40960, v119
    v_add_u32 v41, 50176, v120
    v_add_u32 v42, 59392, v119
    v_add_u32 v43, 68608, v120
    s_lshl_b32 s43, s6, 2
    s_add_u32 s43, s43, s5
    s_lshl_b32 s43, s43, 1
    s_mul_i32 s38, s5, 24576
    s_lshl_b32 s40, s5, 12
    s_add_u32 s39, s40, 98304
    s_mov_b32 s34, s39
    s_mov_b32 s28, 0
    s_mov_b32 s29, 0
    s_waitcnt lgkmcnt(0)
    s_mov_b32 s88, s48
    s_mov_b32 s89, s49
    s_mov_b32 s90, 0x280000
    s_mov_b32 s91, 0x20000
    s_mov_b32 s92, s60
    s_mov_b32 s93, s61
    s_mov_b32 s94, 0x500
    s_mov_b32 s95, 0x20000
    s_lshl_b32 s40, s3, 8
    s_add_u32 s20, s54, s40
    s_addc_u32 s21, s55, 0
    s_mov_b32 s22, 0x4fe100
    s_mov_b32 s23, 0x20000
    s_mul_i32 s40, s4, 327680
    s_add_u32 s16, s48, s40
    s_addc_u32 s17, s49, 0
    s_mov_b32 s18, 0x50000
    s_mov_b32 s19, 0x20000
    s_add_u32 m0, s39, 0
    s_mov_b32 s37, 0
    buffer_load_dwordx4 v44, s[20:23], s37 offen offset:0 lds
    buffer_load_dwordx4 v45, s[20:23], s37 offen offset:1024 lds
    buffer_load_dwordx4 v46, s[20:23], s37 offen offset:2048 lds
    buffer_load_dwordx4 v47, s[20:23], s37 offen offset:3072 lds
    s_add_u32 m0, s38, 0
    s_mov_b32 s36, 0
    buffer_load_dwordx4 v36, s[16:19], s36 offen offset:0 lds
    buffer_load_dwordx4 v37, s[16:19], s36 offen offset:1024 lds
    buffer_load_dwordx4 v38, s[16:19], s36 offen offset:2048 lds
    buffer_load_dwordx4 v39, s[16:19], s36 offen offset:3072 lds
    s_add_u32 m0, s38, 4096
    s_nop 0
    buffer_load_dwordx4 v40, s[16:19], s36 offen offset:0 lds
    buffer_load_dwordx4 v41, s[16:19], s36 offen offset:1024 lds
    buffer_load_dwordx4 v42, s[16:19], s36 offen offset:2048 lds
    buffer_load_dwordx4 v43, s[16:19], s36 offen offset:3072 lds
    v_lshrrev_b32 v108, 5, v19
    v_add_u32 v108, s43, v108
    v_and_b32 v110, 31, v19
    v_lshlrev_b32 v110, 3, v110
    v_mul_u32_u24 v109, 1280, v108
    v_add_u32 v109, v109, v110
    buffer_load_dwordx2 v[60:61], v109, s[88:91], 0 offen offset:0
    buffer_load_dwordx2 v[62:63], v109, s[88:91], 0 offen offset:256
    buffer_load_dwordx2 v[64:65], v109, s[88:91], 0 offen offset:512
    buffer_load_dwordx2 v[66:67], v109, s[88:91], 0 offen offset:768
    buffer_load_dwordx2 v[68:69], v109, s[88:91], 0 offen offset:1024
    buffer_load_dwordx2 v[70:71], v110, s[92:95], 0 offen offset:0
    buffer_load_dwordx2 v[72:73], v110, s[92:95], 0 offen offset:256
    buffer_load_dwordx2 v[74:75], v110, s[92:95], 0 offen offset:512
    buffer_load_dwordx2 v[76:77], v110, s[92:95], 0 offen offset:768
    buffer_load_dwordx2 v[78:79], v110, s[92:95], 0 offen offset:1024
    s_lshl_b32 s40, s3, 19
    s_add_u32 s8, s50, s40
    s_addc_u32 s9, s51, 0
    s_mov_b32 s10, 0x80000
    s_mov_b32 s11, 0x20000
    s_add_u32 s12, s52, s40
    s_addc_u32 s13, s53, 0
    s_mov_b32 s14, 0x80000
    s_mov_b32 s15, 0x20000
    s_and_b32 s40, s5, 1
    s_lshl_b32 s40, s40, 12
    s_cmp_ge_u32 s5, 2
    s_cselect_b32 s30, 32, 8
    s_cselect_b32 s31, 40, 16
    s_cselect_b32 s32, 0, 56
    s_cselect_b32 s33, 48, 24
    s_lshl_b32 s30, s30, 10
    s_add_u32 s30, s30, s40
    s_lshl_b32 s31, s31, 10
    s_add_u32 s31, s31, s40
    s_lshl_b32 s32, s32, 10
    s_add_u32 s32, s32, s40
    s_lshl_b32 s33, s33, 10
    s_add_u32 s33, s33, s40
    s_mov_b32 s44, 0x3e0293ee
    s_mov_b32 s45, 4096
    s_mov_b32 s76, s72
    s_mov_b32 s77, s73
    s_mov_b32 s78, 0x2000000
    s_mov_b32 s79, 0x20000
    s_mov_b32 s92, s70
    s_mov_b32 s93, s71
    s_mov_b32 s94, 0x100
    s_mov_b32 s95, 0x20000
    s_lshl_b32 s41, s4, 2
    s_add_u32 s41, s41, s5
    s_lshl_b32 s40, s41, 5
    s_add_u32 s40, s40, s3
    s_lshl_b32 s40, s40, 14
    s_add_u32 s40, s40, 0x400000
    s_add_u32 s24, s72, s40
    s_addc_u32 s25, s73, 0
    s_mov_b32 s26, 0x4000
    s_mov_b32 s27, 0x20000
    s_and_b32 s42, s3, 3
    s_lshl_b32 s42, s42, 2
    s_lshr_b32 s40, s6, 2
    s_lshl_b32 s40, s40, 7
    s_add_u32 s40, s40, s42
    s_add_u32 s75, s40, 0x290000
    s_lshr_b32 s40, s3, 2
    s_lshl_b32 s40, s40, 7
    s_add_u32 s40, s40, s42
    s_lshl_b32 s42, s41, 10
    s_add_u32 s40, s40, s42
    s_add_u32 s58, s40, 0x292000
    s_cmp_eq_u32 s5, 0
    s_cselect_b32 s59, 5, 8
    s_lshl_b32 s41, s41, 10
    s_add_u32 s46, s41, 0x280000
    v_lshrrev_b32 v116, 4, v19
    v_and_b32 v117, 15, v19
    v_lshlrev_b32 v59, 4, v117
    v_xor_b32 v118, v116, v117
    v_lshlrev_b32 v119, 8, v117
    v_add_u32 v119, 98304, v119
    s_add_u32 s41, s5, 0
    s_and_b32 s41, s41, 3
    s_lshl_b32 s41, s41, 2
    v_xor_b32 v120, s41, v118
    v_lshl_add_u32 v1, v120, 4, v119
    s_add_u32 s41, s5, 1
    s_and_b32 s41, s41, 3
    s_lshl_b32 s41, s41, 2
    v_xor_b32 v120, s41, v118
    v_lshl_add_u32 v2, v120, 4, v119
    s_add_u32 s41, s5, 2
    s_and_b32 s41, s41, 3
    s_lshl_b32 s41, s41, 2
    v_xor_b32 v120, s41, v118
    v_lshl_add_u32 v3, v120, 4, v119
    s_add_u32 s41, s5, 3
    s_and_b32 s41, s41, 3
    s_lshl_b32 s41, s41, 2
    v_xor_b32 v120, s41, v118
    v_lshl_add_u32 v4, v120, 4, v119
    v_lshrrev_b32 v118, 1, v117
    v_xor_b32 v118, v116, v118
    v_lshlrev_b32 v119, 7, v117
    v_add_u32 v119, s38, v119
    v_xor_b32 v120, 0, v118
    v_lshl_add_u32 v48, v120, 4, v119
    v_xor_b32 v120, 4, v118
    v_lshl_add_u32 v49, v120, 4, v119
    v_bfe_u32 v118, v19, 2, 2
    v_bfe_u32 v119, v19, 2, 3
    v_and_b32 v120, 3, v19
    v_lshlrev_b32 v120, 3, v120
    v_lshl_add_u32 v121, v116, 2, v118
    v_lshl_add_u32 v121, v121, 8, v120
    v_lshl_add_u32 v122, v116, 3, v118
    v_lshl_add_u32 v122, v122, 8, v120
    v_add_u32 v122, 98304, v122
    v_xor_b32 v123, 0, v119
    v_lshl_add_u32 v5, v123, 5, v121
    v_xor_b32 v123, 1, v119
    v_lshl_add_u32 v6, v123, 5, v121
    v_xor_b32 v123, 2, v119
    v_lshl_add_u32 v7, v123, 5, v121
    v_xor_b32 v123, 3, v119
    v_lshl_add_u32 v8, v123, 5, v121
    v_xor_b32 v123, 4, v119
    v_lshl_add_u32 v9, v123, 5, v121
    v_xor_b32 v123, 5, v119
    v_lshl_add_u32 v10, v123, 5, v121
    v_xor_b32 v123, 6, v119
    v_lshl_add_u32 v11, v123, 5, v121
    v_xor_b32 v123, 7, v119
    v_lshl_add_u32 v12, v123, 5, v121
    s_lshl_b32 s42, s5, 1
    s_add_u32 s41, s42, 0
    s_and_b32 s41, s41, 7
    v_xor_b32 v123, s41, v119
    v_lshl_add_u32 v50, v123, 5, v122
    s_add_u32 s41, s42, 1
    s_and_b32 s41, s41, 7
    v_xor_b32 v123, s41, v119
    v_lshl_add_u32 v51, v123, 5, v122
    s_add_u32 s41, s42, 2
    s_and_b32 s41, s41, 7
    v_xor_b32 v123, s41, v119
    v_lshl_add_u32 v52, v123, 5, v122
    s_add_u32 s41, s42, 3
    s_and_b32 s41, s41, 7
    v_xor_b32 v123, s41, v119
    v_lshl_add_u32 v53, v123, 5, v122
    s_add_u32 s41, s42, 4
    s_and_b32 s41, s41, 7
    v_xor_b32 v123, s41, v119
    v_lshl_add_u32 v54, v123, 5, v122
    s_add_u32 s41, s42, 5
    s_and_b32 s41, s41, 7
    v_xor_b32 v123, s41, v119
    v_lshl_add_u32 v55, v123, 5, v122
    s_add_u32 s41, s42, 6
    s_and_b32 s41, s41, 7
    v_xor_b32 v123, s41, v119
    v_lshl_add_u32 v56, v123, 5, v122
    s_add_u32 s41, s42, 7
    s_and_b32 s41, s41, 7
    v_xor_b32 v123, s41, v119
    v_lshl_add_u32 v57, v123, 5, v122
    s_lshl_b32 s41, s5, 7
    s_add_u32 s41, s41, 65536
    v_lshl_add_u32 v58, v116, 4, s41
    v_mov_b32 v32, 0x3f803f80
    v_mov_b32 v33, 0x3f803f80
    v_mov_b32 v34, 0x3f803f80
    v_mov_b32 v35, 0x3f803f80
    v_and_b32 v120, 1, v19
    v_cmp_eq_u32 vcc, 0, v120
    v_mov_b32 v121, 0x44444444
    v_mov_b32 v122, 0xeeeeeeee
    v_cndmask_b32 v248, v122, v121, vcc
    v_and_b32 v120, 2, v19
    v_cmp_eq_u32 vcc, 0, v120
    v_mov_b32 v27, 1
    v_mov_b32 v28, 0
    v_cndmask_b32 v244, 0, v32, vcc
    v_cndmask_b32 v245, 0, v32, vcc
    v_cndmask_b32 v246, 0, v32, vcc
    v_cndmask_b32 v247, 0, v32, vcc
    v_accvgpr_write_b32 a224, 0
    v_accvgpr_write_b32 a225, 0
    v_accvgpr_write_b32 a226, 0
    v_accvgpr_write_b32 a227, 0
    v_accvgpr_write_b32 a228, 0
    v_accvgpr_write_b32 a229, 0
    v_accvgpr_write_b32 a230, 0
    v_accvgpr_write_b32 a231, 0
    v_accvgpr_write_b32 a232, 0
    v_accvgpr_write_b32 a233, 0
    v_accvgpr_write_b32 a234, 0
    v_accvgpr_write_b32 a235, 0
    v_accvgpr_write_b32 a236, 0
    v_accvgpr_write_b32 a237, 0
    v_accvgpr_write_b32 a238, 0
    v_accvgpr_write_b32 a239, 0
    s_mul_i32 s47, s5, 5120
    s_mov_b32 s96, s56
    s_mov_b32 s97, s57
    s_mov_b32 s98, 0x500000
    s_mov_b32 s99, 0x20000
    s_lshr_b32 s40, s6, 1
    s_and_b32 s41, s6, 1
    s_lshl_b32 s41, s41, 2
    s_add_u32 s41, s41, s5
    s_add_u32 s47, s47, 65536
    s_mul_i32 s42, s40, 40960
    s_mul_i32 s43, s41, 160
    s_add_u32 s42, s42, s43
    v_add_u32 v25, 0, v19
    v_mul_u32_u24 v26, 6554, v25
    v_lshrrev_b32 v26, 16, v26
    v_mul_u32_u24 v20, 1120, v26
    v_lshl_add_u32 v20, v25, 4, v20
    v_add_u32 v20, s42, v20
    v_add_u32 v25, 64, v19
    v_mul_u32_u24 v26, 6554, v25
    v_lshrrev_b32 v26, 16, v26
    v_mul_u32_u24 v21, 1120, v26
    v_lshl_add_u32 v21, v25, 4, v21
    v_add_u32 v21, s42, v21
    v_add_u32 v25, 128, v19
    v_mul_u32_u24 v26, 6554, v25
    v_lshrrev_b32 v26, 16, v26
    v_mul_u32_u24 v22, 1120, v26
    v_lshl_add_u32 v22, v25, 4, v22
    v_add_u32 v22, s42, v22
    v_add_u32 v25, 192, v19
    v_mul_u32_u24 v26, 6554, v25
    v_lshrrev_b32 v26, 16, v26
    v_mul_u32_u24 v23, 1120, v26
    v_lshl_add_u32 v23, v25, 4, v23
    v_add_u32 v23, s42, v23
    v_add_u32 v25, 256, v19
    v_mul_u32_u24 v26, 6554, v25
    v_lshrrev_b32 v26, 16, v26
    v_mul_u32_u24 v24, 1120, v26
    v_lshl_add_u32 v24, v25, 4, v24
    v_add_u32 v24, s42, v24
    v_lshrrev_b32 v25, 2, v19
    v_mul_u32_u24 v25, 160, v25
    v_and_b32 v26, 3, v19
    v_lshl_add_u32 v25, v26, 3, v25
    v_add_u32 v25, s47, v25
    s_lshl_b32 s42, s41, 7
    s_add_u32 s42, s42, s40
    s_mul_i32 s42, s42, 5120
    s_add_u32 s42, s42, 0x1400000
    v_lshlrev_b32 v26, 4, v19
    v_add_u32 v26, s42, v26
    s_add_u32 m0, s39, 16384
    s_mov_b32 s37, 524288
    buffer_load_dwordx4 v44, s[20:23], s37 offen offset:0 lds
    buffer_load_dwordx4 v45, s[20:23], s37 offen offset:1024 lds
    buffer_load_dwordx4 v46, s[20:23], s37 offen offset:2048 lds
    buffer_load_dwordx4 v47, s[20:23], s37 offen offset:3072 lds
    s_add_u32 m0, s38, 8192
    s_mov_b32 s36, 128
    buffer_load_dwordx4 v36, s[16:19], s36 offen offset:0 lds
    buffer_load_dwordx4 v37, s[16:19], s36 offen offset:1024 lds
    buffer_load_dwordx4 v38, s[16:19], s36 offen offset:2048 lds
    buffer_load_dwordx4 v39, s[16:19], s36 offen offset:3072 lds
    s_add_u32 m0, s38, 12288
    s_nop 0
    buffer_load_dwordx4 v40, s[16:19], s36 offen offset:0 lds
    buffer_load_dwordx4 v41, s[16:19], s36 offen offset:1024 lds
    buffer_load_dwordx4 v42, s[16:19], s36 offen offset:2048 lds
    buffer_load_dwordx4 v43, s[16:19], s36 offen offset:3072 lds
    s_add_u32 m0, s39, 32768
    s_mov_b32 s37, 1048576
    buffer_load_dwordx4 v44, s[20:23], s37 offen offset:0 lds
    buffer_load_dwordx4 v45, s[20:23], s37 offen offset:1024 lds
    buffer_load_dwordx4 v46, s[20:23], s37 offen offset:2048 lds
    buffer_load_dwordx4 v47, s[20:23], s37 offen offset:3072 lds
    s_add_u32 m0, s38, 16384
    s_mov_b32 s36, 256
    buffer_load_dwordx4 v36, s[16:19], s36 offen offset:0 lds
    buffer_load_dwordx4 v37, s[16:19], s36 offen offset:1024 lds
    buffer_load_dwordx4 v38, s[16:19], s36 offen offset:2048 lds
    buffer_load_dwordx4 v39, s[16:19], s36 offen offset:3072 lds
    s_add_u32 m0, s38, 20480
    s_nop 0
    buffer_load_dwordx4 v40, s[16:19], s36 offen offset:0 lds
    buffer_load_dwordx4 v41, s[16:19], s36 offen offset:1024 lds
    s_waitcnt vmcnt(32)
    s_barrier
    ds_read_b64_tr_b16 a[0:1], v50 offset:0
    ds_read_b64_tr_b16 a[2:3], v50 offset:1024
    ds_read_b128 a[32:35], v48 offset:0
    ds_read_b128 a[36:39], v48 offset:2048
    ds_read_b128 a[40:43], v48 offset:4096
    ds_read_b128 a[44:47], v48 offset:6144
    ds_read_b64_tr_b16 a[4:5], v51 offset:0
    ds_read_b64_tr_b16 a[6:7], v51 offset:1024
    ds_read_b64_tr_b16 a[8:9], v52 offset:0
    ds_read_b64_tr_b16 a[10:11], v52 offset:1024
    ds_read_b64_tr_b16 a[12:13], v53 offset:0
    ds_read_b64_tr_b16 a[14:15], v53 offset:1024
    ds_read_b64_tr_b16 a[16:17], v54 offset:0
    ds_read_b64_tr_b16 a[18:19], v54 offset:1024
    ds_read_b64_tr_b16 a[20:21], v55 offset:0
    ds_read_b64_tr_b16 a[22:23], v55 offset:1024
    ds_read_b64_tr_b16 a[24:25], v56 offset:0
    ds_read_b64_tr_b16 a[26:27], v56 offset:1024
    ds_read_b64_tr_b16 a[28:29], v57 offset:0
    ds_read_b64_tr_b16 a[30:31], v57 offset:1024
    s_waitcnt lgkmcnt(0)
    v_mfma_f32_16x16x32_bf16 v[100:103], a[0:3], v[32:35], 0
    s_waitcnt vmcnt(22)
    ds_read_b64_tr_b16 a[48:49], v50 offset:8192
    v_mfma_f32_16x16x32_bf16 v[104:107], a[4:7], v[32:35], 0
    s_lshl_b32 s40, s6, 7
    ds_read_b64_tr_b16 a[50:51], v50 offset:9216
    v_mfma_f32_16x16x32_bf16 v[116:119], a[0:3], a[32:35], 0
    s_add_u32 s41, s40, 0x292000
    buffer_load_dwordx4 v42, s[16:19], s36 offen offset:2048 lds
    v_mfma_f32_16x16x32_bf16 v[148:151], a[0:3], a[36:39], 0
    s_add_u32 s40, s40, 0x290000
    ds_read_b128 a[80:83], v49 offset:0
    v_mfma_f32_16x16x32_bf16 v[180:183], a[0:3], a[40:43], 0
    s_cmp_lt_u32 s6, 64
    s_cselect_b32 s40, s40, 0x2000000
    ds_read_b128 a[84:87], v49 offset:2048
    v_mfma_f32_16x16x32_bf16 v[212:215], a[0:3], a[44:47], 0
    s_cmp_eq_u32 s5, 1
    s_cselect_b32 s40, s40, 0x2000000
    ds_read_b128 a[88:91], v49 offset:4096
    v_mfma_f32_16x16x32_bf16 v[216:219], a[4:7], a[44:47], 0
    s_cmp_eq_u32 s5, 0
    s_cselect_b32 s40, s41, s40
    ds_read_b128 a[92:95], v49 offset:6144
    v_mfma_f32_16x16x32_bf16 v[184:187], a[4:7], a[40:43], 0
    s_lshl_b32 s41, s6, 2
    ds_read_b64_tr_b16 a[52:53], v51 offset:8192
    v_mfma_f32_16x16x32_bf16 v[152:155], a[4:7], a[36:39], 0
    s_add_u32 s41, s41, s5
    ds_read_b64_tr_b16 a[54:55], v51 offset:9216
    v_mfma_f32_16x16x32_bf16 v[120:123], a[4:7], a[32:35], 0
    s_cmp_eq_u32 s41, 1022
    s_cselect_b32 s40, 0x29b000, s40
    ds_read_b64_tr_b16 a[56:57], v52 offset:8192
    v_lshlrev_b32 v29, 2, v19
    v_mfma_f32_16x16x32_bf16 v[124:127], a[8:11], a[32:35], 0
    ds_read_b64_tr_b16 a[58:59], v52 offset:9216
    s_mov_b32 exec_hi, 0
    buffer_store_dword v28, v29, s[76:79], s40 offen sc1
    s_mov_b32 exec_hi, -1
    v_lshlrev_b32 v80, 16, v60
    v_mfma_f32_16x16x32_bf16 v[156:159], a[8:11], a[36:39], 0
    ds_read_b64_tr_b16 a[60:61], v53 offset:8192
    v_and_b32 v81, 0xffff0000, v60
    v_mfma_f32_16x16x32_bf16 v[188:191], a[8:11], a[40:43], 0
    ds_read_b64_tr_b16 a[62:63], v53 offset:9216
    v_lshlrev_b32 v82, 16, v61
    v_mfma_f32_16x16x32_bf16 v[220:223], a[8:11], a[44:47], 0
    ds_read_b64_tr_b16 a[64:65], v54 offset:8192
    v_and_b32 v83, 0xffff0000, v61
    v_lshlrev_b32 v84, 16, v62
    v_mfma_f32_16x16x32_bf16 v[224:227], a[12:15], a[44:47], 0
    ds_read_b64_tr_b16 a[66:67], v54 offset:9216
    v_and_b32 v85, 0xffff0000, v62
    v_mfma_f32_16x16x32_bf16 v[192:195], a[12:15], a[40:43], 0
    ds_read_b64_tr_b16 a[68:69], v55 offset:8192
    v_lshlrev_b32 v86, 16, v63
    v_mfma_f32_16x16x32_bf16 v[160:163], a[12:15], a[36:39], 0
    ds_read_b64_tr_b16 a[70:71], v55 offset:9216
    v_and_b32 v87, 0xffff0000, v63
    v_lshlrev_b32 v88, 16, v64
    v_mfma_f32_16x16x32_bf16 v[128:131], a[12:15], a[32:35], 0
    buffer_load_dwordx4 v43, s[16:19], s36 offen offset:3072 lds
    v_and_b32 v89, 0xffff0000, v64
    v_mfma_f32_16x16x32_bf16 v[132:135], a[16:19], a[32:35], 0
    ds_read_b64_tr_b16 a[72:73], v56 offset:8192
    v_lshlrev_b32 v90, 16, v65
    v_mfma_f32_16x16x32_bf16 v[164:167], a[16:19], a[36:39], 0
    ds_read_b64_tr_b16 a[74:75], v56 offset:9216
    v_and_b32 v91, 0xffff0000, v65
    v_lshlrev_b32 v92, 16, v66
    v_mfma_f32_16x16x32_bf16 v[196:199], a[16:19], a[40:43], 0
    ds_read_b64_tr_b16 a[76:77], v57 offset:8192
    v_and_b32 v93, 0xffff0000, v66
    v_mfma_f32_16x16x32_bf16 v[228:231], a[16:19], a[44:47], 0
    ds_read_b64_tr_b16 a[78:79], v57 offset:9216
    v_lshlrev_b32 v94, 16, v67
    v_mfma_f32_16x16x32_bf16 v[232:235], a[20:23], a[44:47], 0
    v_and_b32 v95, 0xffff0000, v67
    v_lshlrev_b32 v96, 16, v68
    v_mfma_f32_16x16x32_bf16 v[200:203], a[20:23], a[40:43], 0
    v_and_b32 v97, 0xffff0000, v68
    v_lshlrev_b32 v98, 16, v69
    v_mfma_f32_16x16x32_bf16 v[168:171], a[20:23], a[36:39], 0
    v_and_b32 v99, 0xffff0000, v69
    v_add_f32 v109, v80, v81
    v_mfma_f32_16x16x32_bf16 v[136:139], a[20:23], a[32:35], 0
    v_add_f32 v110, v82, v83
    v_add_f32 v109, v109, v84
    v_mfma_f32_16x16x32_bf16 v[140:143], a[24:27], a[32:35], 0
    v_add_f32 v110, v110, v85
    v_add_f32 v109, v109, v86
    v_mfma_f32_16x16x32_bf16 v[172:175], a[24:27], a[36:39], 0
    v_add_f32 v110, v110, v87
    v_add_f32 v109, v109, v88
    v_mfma_f32_16x16x32_bf16 v[204:207], a[24:27], a[40:43], 0
    v_add_f32 v110, v110, v89
    v_add_f32 v109, v109, v90
    v_mfma_f32_16x16x32_bf16 v[236:239], a[24:27], a[44:47], 0
    v_add_f32 v110, v110, v91
    v_add_f32 v109, v109, v92
    v_mfma_f32_16x16x32_bf16 v[240:243], a[28:31], a[44:47], 0
    v_add_f32 v110, v110, v93
    v_add_f32 v109, v109, v94
    v_mfma_f32_16x16x32_bf16 v[208:211], a[28:31], a[40:43], 0
    v_add_f32 v110, v110, v95
    v_add_f32 v109, v109, v96
    v_mfma_f32_16x16x32_bf16 v[176:179], a[28:31], a[36:39], 0
    v_add_f32 v110, v110, v97
    v_add_f32 v109, v109, v98
    v_mfma_f32_16x16x32_bf16 v[144:147], a[28:31], a[32:35], 0
    v_add_f32 v110, v110, v99
    v_add_f32 v109, v109, v110
    s_waitcnt vmcnt(13) lgkmcnt(0)
    s_barrier
    v_mfma_f32_16x16x32_bf16 v[100:103], a[48:51], v[32:35], v[100:103]
    ds_read_b64_tr_b16 a[0:1], v50 offset:16384
    v_add_f32_dpp v109, v109, v109 quad_perm:[1,0,3,2] row_mask:0xf bank_mask:0xf
    v_mfma_f32_16x16x32_bf16 v[104:107], a[52:55], v[32:35], v[104:107]
    s_add_u32 m0, s39, 0
    s_mov_b32 s37, 1572864
    ds_read_b64_tr_b16 a[2:3], v50 offset:17408
    v_add_f32_dpp v109, v109, v109 quad_perm:[2,3,0,1] row_mask:0xf bank_mask:0xf
    v_mfma_f32_16x16x32_bf16 v[116:119], a[48:51], a[80:83], v[116:119]
    buffer_load_dwordx4 v44, s[20:23], s37 offen offset:0 lds
    v_mfma_f32_16x16x32_bf16 v[148:151], a[48:51], a[84:87], v[148:151]
    ds_read_b128 a[32:35], v48 offset:8192
    v_add_f32_dpp v109, v109, v109 row_half_mirror row_mask:0xf bank_mask:0xf
    v_mfma_f32_16x16x32_bf16 v[180:183], a[48:51], a[88:91], v[180:183]
    ds_read_b128 a[36:39], v48 offset:10240
    v_add_f32_dpp v109, v109, v109 row_mirror row_mask:0xf bank_mask:0xf
    v_mfma_f32_16x16x32_bf16 v[212:215], a[48:51], a[92:95], v[212:215]
    ds_read_b128 a[40:43], v48 offset:12288
    v_mov_b32 v110, v109
    v_mfma_f32_16x16x32_bf16 v[216:219], a[52:55], a[92:95], v[216:219]
    ds_read_b128 a[44:47], v48 offset:14336
    v_permlane16_swap_b32 v109, v110
    v_mfma_f32_16x16x32_bf16 v[184:187], a[52:55], a[88:91], v[184:187]
    buffer_load_dwordx4 v45, s[20:23], s37 offen offset:1024 lds
    v_mfma_f32_16x16x32_bf16 v[152:155], a[52:55], a[84:87], v[152:155]
    ds_read_b64_tr_b16 a[4:5], v51 offset:16384
    v_add_f32 v109, v109, v110
    v_mfma_f32_16x16x32_bf16 v[120:123], a[52:55], a[80:83], v[120:123]
    ds_read_b64_tr_b16 a[6:7], v51 offset:17408
    v_mul_f32 v111, 0x3acccccd, v109
    v_mfma_f32_16x16x32_bf16 v[124:127], a[56:59], a[80:83], v[124:127]
    ds_read_b64_tr_b16 a[8:9], v52 offset:16384
    v_sub_f32 v60, v80, v111
    v_mfma_f32_16x16x32_bf16 v[156:159], a[56:59], a[84:87], v[156:159]
    ds_read_b64_tr_b16 a[10:11], v52 offset:17408
    v_mul_f32 v109, v60, v60
    v_mfma_f32_16x16x32_bf16 v[188:191], a[56:59], a[88:91], v[188:191]
    buffer_load_dwordx4 v46, s[20:23], s37 offen offset:2048 lds
    v_mfma_f32_16x16x32_bf16 v[220:223], a[56:59], a[92:95], v[220:223]
    ds_read_b64_tr_b16 a[12:13], v53 offset:16384
    v_sub_f32 v61, v81, v111
    v_mfma_f32_16x16x32_bf16 v[224:227], a[60:63], a[92:95], v[224:227]
    ds_read_b64_tr_b16 a[14:15], v53 offset:17408
    v_mul_f32 v112, v61, v61
    v_mfma_f32_16x16x32_bf16 v[192:195], a[60:63], a[88:91], v[192:195]
    ds_read_b64_tr_b16 a[16:17], v54 offset:16384
    v_sub_f32 v60, v82, v111
    v_mfma_f32_16x16x32_bf16 v[160:163], a[60:63], a[84:87], v[160:163]
    ds_read_b64_tr_b16 a[18:19], v54 offset:17408
    v_fmac_f32 v109, v60, v60
    v_mfma_f32_16x16x32_bf16 v[128:131], a[60:63], a[80:83], v[128:131]
    buffer_load_dwordx4 v47, s[20:23], s37 offen offset:3072 lds
    v_sub_f32 v61, v83, v111
    v_mfma_f32_16x16x32_bf16 v[132:135], a[64:67], a[80:83], v[132:135]
    ds_read_b64_tr_b16 a[20:21], v55 offset:16384
    v_fmac_f32 v112, v61, v61
    v_mfma_f32_16x16x32_bf16 v[164:167], a[64:67], a[84:87], v[164:167]
    ds_read_b64_tr_b16 a[22:23], v55 offset:17408
    v_sub_f32 v60, v84, v111
    v_fmac_f32 v109, v60, v60
    v_mfma_f32_16x16x32_bf16 v[196:199], a[64:67], a[88:91], v[196:199]
    ds_read_b64_tr_b16 a[24:25], v56 offset:16384
    v_sub_f32 v61, v85, v111
    v_mfma_f32_16x16x32_bf16 v[228:231], a[64:67], a[92:95], v[228:231]
    s_add_u32 m0, s38, 0
    s_mov_b32 s36, 384
    ds_read_b64_tr_b16 a[26:27], v56 offset:17408
    v_fmac_f32 v112, v61, v61
    v_mfma_f32_16x16x32_bf16 v[232:235], a[68:71], a[92:95], v[232:235]
    buffer_load_dwordx4 v36, s[16:19], s36 offen offset:0 lds
    v_sub_f32 v60, v86, v111
    v_fmac_f32 v109, v60, v60
    v_mfma_f32_16x16x32_bf16 v[200:203], a[68:71], a[88:91], v[200:203]
    ds_read_b64_tr_b16 a[28:29], v57 offset:16384
    v_sub_f32 v61, v87, v111
    v_mfma_f32_16x16x32_bf16 v[168:171], a[68:71], a[84:87], v[168:171]
    ds_read_b64_tr_b16 a[30:31], v57 offset:17408
    v_fmac_f32 v112, v61, v61
    v_mfma_f32_16x16x32_bf16 v[136:139], a[68:71], a[80:83], v[136:139]
    v_sub_f32 v60, v88, v111
    v_fmac_f32 v109, v60, v60
    v_mfma_f32_16x16x32_bf16 v[140:143], a[72:75], a[80:83], v[140:143]
    v_sub_f32 v61, v89, v111
    v_fmac_f32 v112, v61, v61
    v_mfma_f32_16x16x32_bf16 v[172:175], a[72:75], a[84:87], v[172:175]
    buffer_load_dwordx4 v37, s[16:19], s36 offen offset:1024 lds
    v_sub_f32 v60, v90, v111
    v_mfma_f32_16x16x32_bf16 v[204:207], a[72:75], a[88:91], v[204:207]
    v_fmac_f32 v109, v60, v60
    v_sub_f32 v61, v91, v111
    v_mfma_f32_16x16x32_bf16 v[236:239], a[72:75], a[92:95], v[236:239]
    v_fmac_f32 v112, v61, v61
    v_sub_f32 v60, v92, v111
    v_mfma_f32_16x16x32_bf16 v[240:243], a[76:79], a[92:95], v[240:243]
    v_fmac_f32 v109, v60, v60
    v_sub_f32 v61, v93, v111
    v_mfma_f32_16x16x32_bf16 v[208:211], a[76:79], a[88:91], v[208:211]
    v_fmac_f32 v112, v61, v61
    v_sub_f32 v60, v94, v111
    v_mfma_f32_16x16x32_bf16 v[176:179], a[76:79], a[84:87], v[176:179]
    v_fmac_f32 v109, v60, v60
    v_sub_f32 v61, v95, v111
    v_mfma_f32_16x16x32_bf16 v[144:147], a[76:79], a[80:83], v[144:147]
    v_fmac_f32 v112, v61, v61
    v_sub_f32 v60, v96, v111
    s_waitcnt lgkmcnt(0)
    v_mfma_f32_16x16x32_bf16 v[100:103], a[0:3], v[32:35], v[100:103]
    ds_read_b64_tr_b16 a[48:49], v50 offset:24576
    v_fmac_f32 v109, v60, v60
    v_mfma_f32_16x16x32_bf16 v[104:107], a[4:7], v[32:35], v[104:107]
    ds_read_b64_tr_b16 a[50:51], v50 offset:25600
    v_sub_f32 v61, v97, v111
    v_mfma_f32_16x16x32_bf16 v[116:119], a[0:3], a[32:35], v[116:119]
    buffer_load_dwordx4 v38, s[16:19], s36 offen offset:2048 lds
    v_mfma_f32_16x16x32_bf16 v[148:151], a[0:3], a[36:39], v[148:151]
    ds_read_b128 a[80:83], v49 offset:8192
    v_fmac_f32 v112, v61, v61
    v_mfma_f32_16x16x32_bf16 v[180:183], a[0:3], a[40:43], v[180:183]
    ds_read_b128 a[84:87], v49 offset:10240
    v_sub_f32 v60, v98, v111
    v_mfma_f32_16x16x32_bf16 v[212:215], a[0:3], a[44:47], v[212:215]
    ds_read_b128 a[88:91], v49 offset:12288
    v_fmac_f32 v109, v60, v60
    v_mfma_f32_16x16x32_bf16 v[216:219], a[4:7], a[44:47], v[216:219]
    ds_read_b128 a[92:95], v49 offset:14336
    v_sub_f32 v61, v99, v111
    v_mfma_f32_16x16x32_bf16 v[184:187], a[4:7], a[40:43], v[184:187]
    buffer_load_dwordx4 v39, s[16:19], s36 offen offset:3072 lds
    v_mfma_f32_16x16x32_bf16 v[152:155], a[4:7], a[36:39], v[152:155]
    ds_read_b64_tr_b16 a[52:53], v51 offset:24576
    v_fmac_f32 v112, v61, v61
    v_mfma_f32_16x16x32_bf16 v[120:123], a[4:7], a[32:35], v[120:123]
    ds_read_b64_tr_b16 a[54:55], v51 offset:25600
    v_add_f32 v109, v109, v112
    v_mfma_f32_16x16x32_bf16 v[124:127], a[8:11], a[32:35], v[124:127]
    ds_read_b64_tr_b16 a[56:57], v52 offset:24576
    v_add_f32_dpp v109, v109, v109 quad_perm:[1,0,3,2] row_mask:0xf bank_mask:0xf
    v_mfma_f32_16x16x32_bf16 v[156:159], a[8:11], a[36:39], v[156:159]
    s_add_u32 m0, s38, 4096
    ds_read_b64_tr_b16 a[58:59], v52 offset:25600
    v_add_f32_dpp v109, v109, v109 quad_perm:[2,3,0,1] row_mask:0xf bank_mask:0xf
    v_mfma_f32_16x16x32_bf16 v[188:191], a[8:11], a[40:43], v[188:191]
    buffer_load_dwordx4 v40, s[16:19], s36 offen offset:0 lds
    v_add_f32_dpp v109, v109, v109 row_half_mirror row_mask:0xf bank_mask:0xf
    v_mfma_f32_16x16x32_bf16 v[220:223], a[8:11], a[44:47], v[220:223]
    ds_read_b64_tr_b16 a[60:61], v53 offset:24576
    v_add_f32_dpp v109, v109, v109 row_mirror row_mask:0xf bank_mask:0xf
    v_mov_b32 v110, v109
    v_mfma_f32_16x16x32_bf16 v[224:227], a[12:15], a[44:47], v[224:227]
    ds_read_b64_tr_b16 a[62:63], v53 offset:25600
    v_permlane16_swap_b32 v109, v110
    v_mfma_f32_16x16x32_bf16 v[192:195], a[12:15], a[40:43], v[192:195]
    ds_read_b64_tr_b16 a[64:65], v54 offset:24576
    v_add_f32 v109, v109, v110
    v_mul_f32 v109, 0x3acccccd, v109
    v_mfma_f32_16x16x32_bf16 v[160:163], a[12:15], a[36:39], v[160:163]
    ds_read_b64_tr_b16 a[66:67], v54 offset:25600
    v_cvt_pk_bf16_f32 v110, v111, v109
    v_mfma_f32_16x16x32_bf16 v[128:131], a[12:15], a[32:35], v[128:131]
    buffer_load_dwordx4 v41, s[16:19], s36 offen offset:1024 lds
    v_lshlrev_b32 v111, 16, v110
    v_mfma_f32_16x16x32_bf16 v[132:135], a[16:19], a[32:35], v[132:135]
    ds_read_b64_tr_b16 a[68:69], v55 offset:24576
    v_and_b32 v109, 0xffff0000, v110
    v_add_f32 v109, 0x3727c5ac, v109
    v_mfma_f32_16x16x32_bf16 v[164:167], a[16:19], a[36:39], v[164:167]
    ds_read_b64_tr_b16 a[70:71], v55 offset:25600
    v_cvt_pk_bf16_f32 v109, v109, v109
    v_mfma_f32_16x16x32_bf16 v[196:199], a[16:19], a[40:43], v[196:199]
    ds_read_b64_tr_b16 a[72:73], v56 offset:24576
    v_lshlrev_b32 v109, 16, v109
    v_mfma_f32_16x16x32_bf16 v[228:231], a[16:19], a[44:47], v[228:231]
    ds_read_b64_tr_b16 a[74:75], v56 offset:25600
    v_sqrt_f32 v109, v109
    v_sub_f32 v80, v80, v111
    v_mfma_f32_16x16x32_bf16 v[232:235], a[20:23], a[44:47], v[232:235]
    buffer_load_dwordx4 v42, s[16:19], s36 offen offset:2048 lds
    v_sub_f32 v81, v81, v111
    v_mfma_f32_16x16x32_bf16 v[200:203], a[20:23], a[40:43], v[200:203]
    ds_read_b64_tr_b16 a[76:77], v57 offset:24576
    v_sub_f32 v82, v82, v111
    v_mfma_f32_16x16x32_bf16 v[168:171], a[20:23], a[36:39], v[168:171]
    ds_read_b64_tr_b16 a[78:79], v57 offset:25600
    v_sub_f32 v83, v83, v111
    v_mfma_f32_16x16x32_bf16 v[136:139], a[20:23], a[32:35], v[136:139]
    v_sub_f32 v84, v84, v111
    v_sub_f32 v85, v85, v111
    v_mfma_f32_16x16x32_bf16 v[140:143], a[24:27], a[32:35], v[140:143]
    v_sub_f32 v86, v86, v111
    v_sub_f32 v87, v87, v111
    v_mfma_f32_16x16x32_bf16 v[172:175], a[24:27], a[36:39], v[172:175]
    buffer_load_dwordx4 v43, s[16:19], s36 offen offset:3072 lds
    v_sub_f32 v88, v88, v111
    v_mfma_f32_16x16x32_bf16 v[204:207], a[24:27], a[40:43], v[204:207]
    v_sub_f32 v89, v89, v111
    v_sub_f32 v90, v90, v111
    v_mfma_f32_16x16x32_bf16 v[236:239], a[24:27], a[44:47], v[236:239]
    v_sub_f32 v91, v91, v111
    v_sub_f32 v92, v92, v111
    v_mfma_f32_16x16x32_bf16 v[240:243], a[28:31], a[44:47], v[240:243]
    v_sub_f32 v93, v93, v111
    v_sub_f32 v94, v94, v111
    v_mfma_f32_16x16x32_bf16 v[208:211], a[28:31], a[40:43], v[208:211]
    v_sub_f32 v95, v95, v111
    v_sub_f32 v96, v96, v111
    v_mfma_f32_16x16x32_bf16 v[176:179], a[28:31], a[36:39], v[176:179]
    v_sub_f32 v97, v97, v111
    v_sub_f32 v98, v98, v111
    v_mfma_f32_16x16x32_bf16 v[144:147], a[28:31], a[32:35], v[144:147]
    v_sub_f32 v99, v99, v111
    v_cvt_pk_bf16_f32 v109, v109, v109
    s_waitcnt vmcnt(12) lgkmcnt(0)
    s_barrier
    v_mfma_f32_16x16x32_bf16 v[100:103], a[48:51], v[32:35], v[100:103]
    ds_read_b64_tr_b16 a[0:1], v50 offset:32768
    v_lshlrev_b32 v109, 16, v109
    v_mfma_f32_16x16x32_bf16 v[104:107], a[52:55], v[32:35], v[104:107]
    s_add_u32 m0, s39, 16384
    s_mov_b32 s37, 2097152
    ds_read_b64_tr_b16 a[2:3], v50 offset:33792
    v_mfma_f32_16x16x32_bf16 v[116:119], a[48:51], a[80:83], v[116:119]
    buffer_load_dwordx4 v44, s[20:23], s37 offen offset:0 lds
    v_mfma_f32_16x16x32_bf16 v[148:151], a[48:51], a[84:87], v[148:151]
    ds_read_b128 a[32:35], v48 offset:16384
    v_mfma_f32_16x16x32_bf16 v[180:183], a[48:51], a[88:91], v[180:183]
    ds_read_b128 a[36:39], v48 offset:18432
    v_rcp_f32 v112, v109
    v_mfma_f32_16x16x32_bf16 v[212:215], a[48:51], a[92:95], v[212:215]
    ds_read_b128 a[40:43], v48 offset:20480
    v_cvt_pk_bf16_f32 v60, v80, v81
    v_mfma_f32_16x16x32_bf16 v[216:219], a[52:55], a[92:95], v[216:219]
    ds_read_b128 a[44:47], v48 offset:22528
    v_cvt_pk_bf16_f32 v61, v82, v83
    v_mfma_f32_16x16x32_bf16 v[184:187], a[52:55], a[88:91], v[184:187]
    buffer_load_dwordx4 v45, s[20:23], s37 offen offset:1024 lds
    v_cvt_pk_bf16_f32 v62, v84, v85
    v_cvt_pk_bf16_f32 v63, v86, v87
    v_mfma_f32_16x16x32_bf16 v[152:155], a[52:55], a[84:87], v[152:155]
    ds_read_b64_tr_b16 a[4:5], v51 offset:32768
    v_cvt_pk_bf16_f32 v64, v88, v89
    v_mfma_f32_16x16x32_bf16 v[120:123], a[52:55], a[80:83], v[120:123]
    ds_read_b64_tr_b16 a[6:7], v51 offset:33792
    v_cvt_pk_bf16_f32 v65, v90, v91
    v_mfma_f32_16x16x32_bf16 v[124:127], a[56:59], a[80:83], v[124:127]
    ds_read_b64_tr_b16 a[8:9], v52 offset:32768
    v_cvt_pk_bf16_f32 v66, v92, v93
    v_mfma_f32_16x16x32_bf16 v[156:159], a[56:59], a[84:87], v[156:159]
    ds_read_b64_tr_b16 a[10:11], v52 offset:33792
    v_cvt_pk_bf16_f32 v67, v94, v95
    v_cvt_pk_bf16_f32 v68, v96, v97
    v_mfma_f32_16x16x32_bf16 v[188:191], a[56:59], a[88:91], v[188:191]
    buffer_load_dwordx4 v46, s[20:23], s37 offen offset:2048 lds
    v_cvt_pk_bf16_f32 v69, v98, v99
    v_mfma_f32_16x16x32_bf16 v[220:223], a[56:59], a[92:95], v[220:223]
    ds_read_b64_tr_b16 a[12:13], v53 offset:32768
    v_lshlrev_b32 v80, 16, v60
    v_mfma_f32_16x16x32_bf16 v[224:227], a[60:63], a[92:95], v[224:227]
    ds_read_b64_tr_b16 a[14:15], v53 offset:33792
    v_and_b32 v81, 0xffff0000, v60
    v_lshlrev_b32 v82, 16, v61
    v_mfma_f32_16x16x32_bf16 v[192:195], a[60:63], a[88:91], v[192:195]
    ds_read_b64_tr_b16 a[16:17], v54 offset:32768
    v_and_b32 v83, 0xffff0000, v61
    v_mfma_f32_16x16x32_bf16 v[160:163], a[60:63], a[84:87], v[160:163]
    ds_read_b64_tr_b16 a[18:19], v54 offset:33792
    v_lshlrev_b32 v84, 16, v62
    v_mfma_f32_16x16x32_bf16 v[128:131], a[60:63], a[80:83], v[128:131]
    buffer_load_dwordx4 v47, s[20:23], s37 offen offset:3072 lds
    v_and_b32 v85, 0xffff0000, v62
    v_lshlrev_b32 v86, 16, v63
    v_mfma_f32_16x16x32_bf16 v[132:135], a[64:67], a[80:83], v[132:135]
    ds_read_b64_tr_b16 a[20:21], v55 offset:32768
    v_and_b32 v87, 0xffff0000, v63
    v_mfma_f32_16x16x32_bf16 v[164:167], a[64:67], a[84:87], v[164:167]
    ds_read_b64_tr_b16 a[22:23], v55 offset:33792
    v_lshlrev_b32 v88, 16, v64
    v_mfma_f32_16x16x32_bf16 v[196:199], a[64:67], a[88:91], v[196:199]
    ds_read_b64_tr_b16 a[24:25], v56 offset:32768
    v_and_b32 v89, 0xffff0000, v64
    v_mfma_f32_16x16x32_bf16 v[228:231], a[64:67], a[92:95], v[228:231]
    s_add_u32 m0, s38, 8192
    s_mov_b32 s36, 512
    ds_read_b64_tr_b16 a[26:27], v56 offset:33792
    v_lshlrev_b32 v90, 16, v65
    v_and_b32 v91, 0xffff0000, v65
    v_mfma_f32_16x16x32_bf16 v[232:235], a[68:71], a[92:95], v[232:235]
    buffer_load_dwordx4 v36, s[16:19], s36 offen offset:0 lds
    v_lshlrev_b32 v92, 16, v66
    v_mfma_f32_16x16x32_bf16 v[200:203], a[68:71], a[88:91], v[200:203]
    ds_read_b64_tr_b16 a[28:29], v57 offset:32768
    v_and_b32 v93, 0xffff0000, v66
    v_mfma_f32_16x16x32_bf16 v[168:171], a[68:71], a[84:87], v[168:171]
    ds_read_b64_tr_b16 a[30:31], v57 offset:33792
    v_lshlrev_b32 v94, 16, v67
    v_and_b32 v95, 0xffff0000, v67
    v_mfma_f32_16x16x32_bf16 v[136:139], a[68:71], a[80:83], v[136:139]
    v_lshlrev_b32 v96, 16, v68
    v_and_b32 v97, 0xffff0000, v68
    v_mfma_f32_16x16x32_bf16 v[140:143], a[72:75], a[80:83], v[140:143]
    v_lshlrev_b32 v98, 16, v69
    v_and_b32 v99, 0xffff0000, v69
    v_mfma_f32_16x16x32_bf16 v[172:175], a[72:75], a[84:87], v[172:175]
    buffer_load_dwordx4 v37, s[16:19], s36 offen offset:1024 lds
    v_mul_f32 v80, v80, v112
    v_mfma_f32_16x16x32_bf16 v[204:207], a[72:75], a[88:91], v[204:207]
    v_mul_f32 v81, v81, v112
    v_mul_f32 v82, v82, v112
    v_mfma_f32_16x16x32_bf16 v[236:239], a[72:75], a[92:95], v[236:239]
    v_mul_f32 v83, v83, v112
    v_mul_f32 v84, v84, v112
    v_mfma_f32_16x16x32_bf16 v[240:243], a[76:79], a[92:95], v[240:243]
    v_mul_f32 v85, v85, v112
    v_mul_f32 v86, v86, v112
    v_mfma_f32_16x16x32_bf16 v[208:211], a[76:79], a[88:91], v[208:211]
    v_mul_f32 v87, v87, v112
    v_mul_f32 v88, v88, v112
    v_mfma_f32_16x16x32_bf16 v[176:179], a[76:79], a[84:87], v[176:179]
    v_mul_f32 v89, v89, v112
    v_mul_f32 v90, v90, v112
    v_mfma_f32_16x16x32_bf16 v[144:147], a[76:79], a[80:83], v[144:147]
    v_mul_f32 v91, v91, v112
    v_mul_f32 v92, v92, v112
    s_waitcnt lgkmcnt(0)
    v_mfma_f32_16x16x32_bf16 v[100:103], a[0:3], v[32:35], v[100:103]
    ds_read_b64_tr_b16 a[48:49], v50 offset:40960
    v_mul_f32 v93, v93, v112
    v_mfma_f32_16x16x32_bf16 v[104:107], a[4:7], v[32:35], v[104:107]
    ds_read_b64_tr_b16 a[50:51], v50 offset:41984
    v_mul_f32 v94, v94, v112
    v_mfma_f32_16x16x32_bf16 v[116:119], a[0:3], a[32:35], v[116:119]
    buffer_load_dwordx4 v38, s[16:19], s36 offen offset:2048 lds
    v_mfma_f32_16x16x32_bf16 v[148:151], a[0:3], a[36:39], v[148:151]
    ds_read_b128 a[80:83], v49 offset:16384
    v_mul_f32 v95, v95, v112
    v_mfma_f32_16x16x32_bf16 v[180:183], a[0:3], a[40:43], v[180:183]
    ds_read_b128 a[84:87], v49 offset:18432
    v_mul_f32 v96, v96, v112
    v_mfma_f32_16x16x32_bf16 v[212:215], a[0:3], a[44:47], v[212:215]
    ds_read_b128 a[88:91], v49 offset:20480
    v_mul_f32 v97, v97, v112
    v_mfma_f32_16x16x32_bf16 v[216:219], a[4:7], a[44:47], v[216:219]
    ds_read_b128 a[92:95], v49 offset:22528
    v_mul_f32 v98, v98, v112
    v_mfma_f32_16x16x32_bf16 v[184:187], a[4:7], a[40:43], v[184:187]
    buffer_load_dwordx4 v39, s[16:19], s36 offen offset:3072 lds
    v_mfma_f32_16x16x32_bf16 v[152:155], a[4:7], a[36:39], v[152:155]
    ds_read_b64_tr_b16 a[52:53], v51 offset:40960
    v_mul_f32 v99, v99, v112
    v_mfma_f32_16x16x32_bf16 v[120:123], a[4:7], a[32:35], v[120:123]
    ds_read_b64_tr_b16 a[54:55], v51 offset:41984
    v_cvt_pk_bf16_f32 v60, v80, v81
    v_mfma_f32_16x16x32_bf16 v[124:127], a[8:11], a[32:35], v[124:127]
    ds_read_b64_tr_b16 a[56:57], v52 offset:40960
    v_cvt_pk_bf16_f32 v61, v82, v83
    v_mfma_f32_16x16x32_bf16 v[156:159], a[8:11], a[36:39], v[156:159]
    s_add_u32 m0, s38, 12288
    ds_read_b64_tr_b16 a[58:59], v52 offset:41984
    v_cvt_pk_bf16_f32 v62, v84, v85
    v_mfma_f32_16x16x32_bf16 v[188:191], a[8:11], a[40:43], v[188:191]
    buffer_load_dwordx4 v40, s[16:19], s36 offen offset:0 lds
    v_cvt_pk_bf16_f32 v63, v86, v87
    v_mfma_f32_16x16x32_bf16 v[220:223], a[8:11], a[44:47], v[220:223]
    ds_read_b64_tr_b16 a[60:61], v53 offset:40960
    v_cvt_pk_bf16_f32 v64, v88, v89
    v_cvt_pk_bf16_f32 v65, v90, v91
    v_mfma_f32_16x16x32_bf16 v[224:227], a[12:15], a[44:47], v[224:227]
    ds_read_b64_tr_b16 a[62:63], v53 offset:41984
    v_cvt_pk_bf16_f32 v66, v92, v93
    v_mfma_f32_16x16x32_bf16 v[192:195], a[12:15], a[40:43], v[192:195]
    ds_read_b64_tr_b16 a[64:65], v54 offset:40960
    v_cvt_pk_bf16_f32 v67, v94, v95
    v_mfma_f32_16x16x32_bf16 v[160:163], a[12:15], a[36:39], v[160:163]
    ds_read_b64_tr_b16 a[66:67], v54 offset:41984
    v_cvt_pk_bf16_f32 v68, v96, v97
    v_mfma_f32_16x16x32_bf16 v[128:131], a[12:15], a[32:35], v[128:131]
    buffer_load_dwordx4 v41, s[16:19], s36 offen offset:1024 lds
    v_cvt_pk_bf16_f32 v69, v98, v99
    v_mov_b32 v109, 0
    v_mfma_f32_16x16x32_bf16 v[132:135], a[16:19], a[32:35], v[132:135]
    ds_read_b64_tr_b16 a[68:69], v55 offset:40960
    v_dot2c_f32_bf16 v109, v60, v70
    v_dot2c_f32_bf16 v109, v61, v71
    v_dot2c_f32_bf16 v109, v62, v72
    v_dot2c_f32_bf16 v109, v63, v73
    v_dot2c_f32_bf16 v109, v64, v74
    v_dot2c_f32_bf16 v109, v65, v75
    v_dot2c_f32_bf16 v109, v66, v76
    v_dot2c_f32_bf16 v109, v67, v77
    v_dot2c_f32_bf16 v109, v68, v78
    v_dot2c_f32_bf16 v109, v69, v79
    s_nop 2
    v_mfma_f32_16x16x32_bf16 v[164:167], a[16:19], a[36:39], v[164:167]
    ds_read_b64_tr_b16 a[70:71], v55 offset:41984
    v_add_f32_dpp v109, v109, v109 quad_perm:[1,0,3,2] row_mask:0xf bank_mask:0xf
    v_mfma_f32_16x16x32_bf16 v[196:199], a[16:19], a[40:43], v[196:199]
    ds_read_b64_tr_b16 a[72:73], v56 offset:40960
    v_add_f32_dpp v109, v109, v109 quad_perm:[2,3,0,1] row_mask:0xf bank_mask:0xf
    v_mfma_f32_16x16x32_bf16 v[228:231], a[16:19], a[44:47], v[228:231]
    ds_read_b64_tr_b16 a[74:75], v56 offset:41984
    v_add_f32_dpp v109, v109, v109 row_half_mirror row_mask:0xf bank_mask:0xf
    v_mfma_f32_16x16x32_bf16 v[232:235], a[20:23], a[44:47], v[232:235]
    buffer_load_dwordx4 v42, s[16:19], s36 offen offset:2048 lds
    v_add_f32_dpp v109, v109, v109 row_mirror row_mask:0xf bank_mask:0xf
    v_mov_b32 v110, v109
    v_mfma_f32_16x16x32_bf16 v[200:203], a[20:23], a[40:43], v[200:203]
    ds_read_b64_tr_b16 a[76:77], v57 offset:40960
    v_permlane16_swap_b32 v109, v110
    v_add_f32 v109, v109, v110
    v_mfma_f32_16x16x32_bf16 v[168:171], a[20:23], a[36:39], v[168:171]
    ds_read_b64_tr_b16 a[78:79], v57 offset:41984
    v_cvt_pk_bf16_f32 v109, v109, v109
    v_mfma_f32_16x16x32_bf16 v[136:139], a[20:23], a[32:35], v[136:139]
    v_lshlrev_b32 v109, 16, v109
    v_ashrrev_i32 v110, 31, v109
    v_mfma_f32_16x16x32_bf16 v[140:143], a[24:27], a[32:35], v[140:143]
    v_or_b32 v110, 0x80000000, v110
    v_xor_b32 v109, v109, v110
    v_mfma_f32_16x16x32_bf16 v[172:175], a[24:27], a[36:39], v[172:175]
    buffer_load_dwordx4 v43, s[16:19], s36 offen offset:3072 lds
    v_and_b32 v109, 0xffff0000, v109
    v_mfma_f32_16x16x32_bf16 v[204:207], a[24:27], a[40:43], v[204:207]
    v_sub_u32 v110, 0xffff, v108
    v_or_b32 v62, v109, v110
    v_mfma_f32_16x16x32_bf16 v[236:239], a[24:27], a[44:47], v[236:239]
    v_mov_b32 v60, v111
    v_mov_b32 v61, v112
    v_mfma_f32_16x16x32_bf16 v[240:243], a[28:31], a[44:47], v[240:243]
    v_mov_b32 v63, 0
    v_lshlrev_b32 v110, 4, v108
    v_mfma_f32_16x16x32_bf16 v[208:211], a[28:31], a[40:43], v[208:211]
    s_mov_b32 s40, 0x280000
    s_mov_b32 exec_lo, 1
    s_mov_b32 exec_hi, 1
    buffer_store_dwordx4 v[60:63], v110, s[76:79], s40 offen sc1
    s_mov_b64 exec, -1
    v_mfma_f32_16x16x32_bf16 v[176:179], a[28:31], a[36:39], v[176:179]
    v_mfma_f32_16x16x32_bf16 v[144:147], a[28:31], a[32:35], v[144:147]
    s_waitcnt vmcnt(13) lgkmcnt(0)
    s_barrier
    v_mfma_f32_16x16x32_bf16 v[100:103], a[48:51], v[32:35], v[100:103]
    ds_read_b64_tr_b16 a[0:1], v50 offset:0
    v_mfma_f32_16x16x32_bf16 v[104:107], a[52:55], v[32:35], v[104:107]
    s_add_u32 m0, s39, 32768
    s_mov_b32 s37, 2621440
    ds_read_b64_tr_b16 a[2:3], v50 offset:1024
    v_mfma_f32_16x16x32_bf16 v[116:119], a[48:51], a[80:83], v[116:119]
    buffer_load_dwordx4 v44, s[20:23], s37 offen offset:0 lds
    v_mfma_f32_16x16x32_bf16 v[148:151], a[48:51], a[84:87], v[148:151]
    ds_read_b128 a[32:35], v48 offset:0
    v_mfma_f32_16x16x32_bf16 v[180:183], a[48:51], a[88:91], v[180:183]
    ds_read_b128 a[36:39], v48 offset:2048
    v_mfma_f32_16x16x32_bf16 v[212:215], a[48:51], a[92:95], v[212:215]
    ds_read_b128 a[40:43], v48 offset:4096
    v_mfma_f32_16x16x32_bf16 v[216:219], a[52:55], a[92:95], v[216:219]
    ds_read_b128 a[44:47], v48 offset:6144
    v_mfma_f32_16x16x32_bf16 v[184:187], a[52:55], a[88:91], v[184:187]
    buffer_load_dwordx4 v45, s[20:23], s37 offen offset:1024 lds
    v_mfma_f32_16x16x32_bf16 v[152:155], a[52:55], a[84:87], v[152:155]
    ds_read_b64_tr_b16 a[4:5], v51 offset:0
    v_mfma_f32_16x16x32_bf16 v[120:123], a[52:55], a[80:83], v[120:123]
    ds_read_b64_tr_b16 a[6:7], v51 offset:1024
    v_mfma_f32_16x16x32_bf16 v[124:127], a[56:59], a[80:83], v[124:127]
    ds_read_b64_tr_b16 a[8:9], v52 offset:0
    v_mfma_f32_16x16x32_bf16 v[156:159], a[56:59], a[84:87], v[156:159]
    ds_read_b64_tr_b16 a[10:11], v52 offset:1024
    v_mfma_f32_16x16x32_bf16 v[188:191], a[56:59], a[88:91], v[188:191]
    buffer_load_dwordx4 v46, s[20:23], s37 offen offset:2048 lds
    v_mfma_f32_16x16x32_bf16 v[220:223], a[56:59], a[92:95], v[220:223]
    ds_read_b64_tr_b16 a[12:13], v53 offset:0
    v_mfma_f32_16x16x32_bf16 v[224:227], a[60:63], a[92:95], v[224:227]
    ds_read_b64_tr_b16 a[14:15], v53 offset:1024
    v_mfma_f32_16x16x32_bf16 v[192:195], a[60:63], a[88:91], v[192:195]
    ds_read_b64_tr_b16 a[16:17], v54 offset:0
    v_mfma_f32_16x16x32_bf16 v[160:163], a[60:63], a[84:87], v[160:163]
    ds_read_b64_tr_b16 a[18:19], v54 offset:1024
    v_mfma_f32_16x16x32_bf16 v[128:131], a[60:63], a[80:83], v[128:131]
    buffer_load_dwordx4 v47, s[20:23], s37 offen offset:3072 lds
    v_mfma_f32_16x16x32_bf16 v[132:135], a[64:67], a[80:83], v[132:135]
    ds_read_b64_tr_b16 a[20:21], v55 offset:0
    v_mfma_f32_16x16x32_bf16 v[164:167], a[64:67], a[84:87], v[164:167]
    ds_read_b64_tr_b16 a[22:23], v55 offset:1024
    v_mfma_f32_16x16x32_bf16 v[196:199], a[64:67], a[88:91], v[196:199]
    ds_read_b64_tr_b16 a[24:25], v56 offset:0
    v_mfma_f32_16x16x32_bf16 v[228:231], a[64:67], a[92:95], v[228:231]
    s_add_u32 m0, s38, 16384
    s_mov_b32 s36, 640
    ds_read_b64_tr_b16 a[26:27], v56 offset:1024
    v_mfma_f32_16x16x32_bf16 v[232:235], a[68:71], a[92:95], v[232:235]
    buffer_load_dwordx4 v36, s[16:19], s36 offen offset:0 lds
    v_mfma_f32_16x16x32_bf16 v[200:203], a[68:71], a[88:91], v[200:203]
    ds_read_b64_tr_b16 a[28:29], v57 offset:0
    v_mfma_f32_16x16x32_bf16 v[168:171], a[68:71], a[84:87], v[168:171]
    ds_read_b64_tr_b16 a[30:31], v57 offset:1024
    v_mfma_f32_16x16x32_bf16 v[136:139], a[68:71], a[80:83], v[136:139]
    v_mfma_f32_16x16x32_bf16 v[140:143], a[72:75], a[80:83], v[140:143]
    v_mfma_f32_16x16x32_bf16 v[172:175], a[72:75], a[84:87], v[172:175]
    buffer_load_dwordx4 v37, s[16:19], s36 offen offset:1024 lds
    v_mfma_f32_16x16x32_bf16 v[204:207], a[72:75], a[88:91], v[204:207]
    v_mfma_f32_16x16x32_bf16 v[236:239], a[72:75], a[92:95], v[236:239]
    v_mfma_f32_16x16x32_bf16 v[240:243], a[76:79], a[92:95], v[240:243]
    v_mfma_f32_16x16x32_bf16 v[208:211], a[76:79], a[88:91], v[208:211]
    v_mfma_f32_16x16x32_bf16 v[176:179], a[76:79], a[84:87], v[176:179]
    v_mfma_f32_16x16x32_bf16 v[144:147], a[76:79], a[80:83], v[144:147]
    s_waitcnt lgkmcnt(0)
    v_mfma_f32_16x16x32_bf16 v[100:103], a[0:3], v[32:35], v[100:103]
    ds_read_b64_tr_b16 a[48:49], v50 offset:8192
    v_mfma_f32_16x16x32_bf16 v[104:107], a[4:7], v[32:35], v[104:107]
    ds_read_b64_tr_b16 a[50:51], v50 offset:9216
    v_mfma_f32_16x16x32_bf16 v[116:119], a[0:3], a[32:35], v[116:119]
    buffer_load_dwordx4 v38, s[16:19], s36 offen offset:2048 lds
    v_mfma_f32_16x16x32_bf16 v[148:151], a[0:3], a[36:39], v[148:151]
    ds_read_b128 a[80:83], v49 offset:0
    v_mfma_f32_16x16x32_bf16 v[180:183], a[0:3], a[40:43], v[180:183]
    ds_read_b128 a[84:87], v49 offset:2048
    v_mfma_f32_16x16x32_bf16 v[212:215], a[0:3], a[44:47], v[212:215]
    ds_read_b128 a[88:91], v49 offset:4096
    v_mfma_f32_16x16x32_bf16 v[216:219], a[4:7], a[44:47], v[216:219]
    ds_read_b128 a[92:95], v49 offset:6144
    v_mfma_f32_16x16x32_bf16 v[184:187], a[4:7], a[40:43], v[184:187]
    buffer_load_dwordx4 v39, s[16:19], s36 offen offset:3072 lds
    v_mfma_f32_16x16x32_bf16 v[152:155], a[4:7], a[36:39], v[152:155]
    ds_read_b64_tr_b16 a[52:53], v51 offset:8192
    v_mfma_f32_16x16x32_bf16 v[120:123], a[4:7], a[32:35], v[120:123]
    ds_read_b64_tr_b16 a[54:55], v51 offset:9216
    v_mfma_f32_16x16x32_bf16 v[124:127], a[8:11], a[32:35], v[124:127]
    ds_read_b64_tr_b16 a[56:57], v52 offset:8192
    v_mfma_f32_16x16x32_bf16 v[156:159], a[8:11], a[36:39], v[156:159]
    s_add_u32 m0, s38, 20480
    ds_read_b64_tr_b16 a[58:59], v52 offset:9216
    v_mfma_f32_16x16x32_bf16 v[188:191], a[8:11], a[40:43], v[188:191]
    buffer_load_dwordx4 v40, s[16:19], s36 offen offset:0 lds
    v_mfma_f32_16x16x32_bf16 v[220:223], a[8:11], a[44:47], v[220:223]
    ds_read_b64_tr_b16 a[60:61], v53 offset:8192
    v_mfma_f32_16x16x32_bf16 v[224:227], a[12:15], a[44:47], v[224:227]
    ds_read_b64_tr_b16 a[62:63], v53 offset:9216
    v_mfma_f32_16x16x32_bf16 v[192:195], a[12:15], a[40:43], v[192:195]
    ds_read_b64_tr_b16 a[64:65], v54 offset:8192
    v_mfma_f32_16x16x32_bf16 v[160:163], a[12:15], a[36:39], v[160:163]
    ds_read_b64_tr_b16 a[66:67], v54 offset:9216
    v_mfma_f32_16x16x32_bf16 v[128:131], a[12:15], a[32:35], v[128:131]
    buffer_load_dwordx4 v41, s[16:19], s36 offen offset:1024 lds
    v_mfma_f32_16x16x32_bf16 v[132:135], a[16:19], a[32:35], v[132:135]
    ds_read_b64_tr_b16 a[68:69], v55 offset:8192
    v_mfma_f32_16x16x32_bf16 v[164:167], a[16:19], a[36:39], v[164:167]
    ds_read_b64_tr_b16 a[70:71], v55 offset:9216
    v_mfma_f32_16x16x32_bf16 v[196:199], a[16:19], a[40:43], v[196:199]
    ds_read_b64_tr_b16 a[72:73], v56 offset:8192
    v_mfma_f32_16x16x32_bf16 v[228:231], a[16:19], a[44:47], v[228:231]
    ds_read_b64_tr_b16 a[74:75], v56 offset:9216
    v_mfma_f32_16x16x32_bf16 v[232:235], a[20:23], a[44:47], v[232:235]
    buffer_load_dwordx4 v42, s[16:19], s36 offen offset:2048 lds
    v_mfma_f32_16x16x32_bf16 v[200:203], a[20:23], a[40:43], v[200:203]
    ds_read_b64_tr_b16 a[76:77], v57 offset:8192
    v_mfma_f32_16x16x32_bf16 v[168:171], a[20:23], a[36:39], v[168:171]
    ds_read_b64_tr_b16 a[78:79], v57 offset:9216
    v_mfma_f32_16x16x32_bf16 v[136:139], a[20:23], a[32:35], v[136:139]
    v_mfma_f32_16x16x32_bf16 v[140:143], a[24:27], a[32:35], v[140:143]
    v_mfma_f32_16x16x32_bf16 v[172:175], a[24:27], a[36:39], v[172:175]
    buffer_load_dwordx4 v43, s[16:19], s36 offen offset:3072 lds
    v_mfma_f32_16x16x32_bf16 v[204:207], a[24:27], a[40:43], v[204:207]
    v_mfma_f32_16x16x32_bf16 v[236:239], a[24:27], a[44:47], v[236:239]
    v_mfma_f32_16x16x32_bf16 v[240:243], a[28:31], a[44:47], v[240:243]
    v_mfma_f32_16x16x32_bf16 v[208:211], a[28:31], a[40:43], v[208:211]
    v_mfma_f32_16x16x32_bf16 v[176:179], a[28:31], a[36:39], v[176:179]
    v_mfma_f32_16x16x32_bf16 v[144:147], a[28:31], a[32:35], v[144:147]
    s_waitcnt vmcnt(13) lgkmcnt(0)
    s_barrier
    v_mfma_f32_16x16x32_bf16 v[100:103], a[48:51], v[32:35], v[100:103]
    ds_read_b64_tr_b16 a[0:1], v50 offset:16384
    v_mfma_f32_16x16x32_bf16 v[104:107], a[52:55], v[32:35], v[104:107]
    s_add_u32 m0, s39, 0
    s_mov_b32 s37, 3145728
    ds_read_b64_tr_b16 a[2:3], v50 offset:17408
    v_mfma_f32_16x16x32_bf16 v[116:119], a[48:51], a[80:83], v[116:119]
    buffer_load_dwordx4 v44, s[20:23], s37 offen offset:0 lds
    v_mfma_f32_16x16x32_bf16 v[148:151], a[48:51], a[84:87], v[148:151]
    ds_read_b128 a[32:35], v48 offset:8192
    v_mfma_f32_16x16x32_bf16 v[180:183], a[48:51], a[88:91], v[180:183]
    ds_read_b128 a[36:39], v48 offset:10240
    v_mfma_f32_16x16x32_bf16 v[212:215], a[48:51], a[92:95], v[212:215]
    ds_read_b128 a[40:43], v48 offset:12288
    v_mfma_f32_16x16x32_bf16 v[216:219], a[52:55], a[92:95], v[216:219]
    ds_read_b128 a[44:47], v48 offset:14336
    v_mfma_f32_16x16x32_bf16 v[184:187], a[52:55], a[88:91], v[184:187]
    buffer_load_dwordx4 v45, s[20:23], s37 offen offset:1024 lds
    v_mfma_f32_16x16x32_bf16 v[152:155], a[52:55], a[84:87], v[152:155]
    ds_read_b64_tr_b16 a[4:5], v51 offset:16384
    v_mfma_f32_16x16x32_bf16 v[120:123], a[52:55], a[80:83], v[120:123]
    ds_read_b64_tr_b16 a[6:7], v51 offset:17408
    v_mfma_f32_16x16x32_bf16 v[124:127], a[56:59], a[80:83], v[124:127]
    ds_read_b64_tr_b16 a[8:9], v52 offset:16384
    v_mfma_f32_16x16x32_bf16 v[156:159], a[56:59], a[84:87], v[156:159]
    ds_read_b64_tr_b16 a[10:11], v52 offset:17408
    v_mfma_f32_16x16x32_bf16 v[188:191], a[56:59], a[88:91], v[188:191]
    buffer_load_dwordx4 v46, s[20:23], s37 offen offset:2048 lds
    v_mfma_f32_16x16x32_bf16 v[220:223], a[56:59], a[92:95], v[220:223]
    ds_read_b64_tr_b16 a[12:13], v53 offset:16384
    v_mfma_f32_16x16x32_bf16 v[224:227], a[60:63], a[92:95], v[224:227]
    ds_read_b64_tr_b16 a[14:15], v53 offset:17408
    v_mfma_f32_16x16x32_bf16 v[192:195], a[60:63], a[88:91], v[192:195]
    ds_read_b64_tr_b16 a[16:17], v54 offset:16384
    v_mfma_f32_16x16x32_bf16 v[160:163], a[60:63], a[84:87], v[160:163]
    ds_read_b64_tr_b16 a[18:19], v54 offset:17408
    v_mfma_f32_16x16x32_bf16 v[128:131], a[60:63], a[80:83], v[128:131]
    buffer_load_dwordx4 v47, s[20:23], s37 offen offset:3072 lds
    v_mfma_f32_16x16x32_bf16 v[132:135], a[64:67], a[80:83], v[132:135]
    ds_read_b64_tr_b16 a[20:21], v55 offset:16384
    v_mfma_f32_16x16x32_bf16 v[164:167], a[64:67], a[84:87], v[164:167]
    ds_read_b64_tr_b16 a[22:23], v55 offset:17408
    v_mfma_f32_16x16x32_bf16 v[196:199], a[64:67], a[88:91], v[196:199]
    ds_read_b64_tr_b16 a[24:25], v56 offset:16384
    v_mfma_f32_16x16x32_bf16 v[228:231], a[64:67], a[92:95], v[228:231]
    s_add_u32 m0, s38, 0
    s_mov_b32 s36, 768
    ds_read_b64_tr_b16 a[26:27], v56 offset:17408
    v_mfma_f32_16x16x32_bf16 v[232:235], a[68:71], a[92:95], v[232:235]
    buffer_load_dwordx4 v36, s[16:19], s36 offen offset:0 lds
    v_mfma_f32_16x16x32_bf16 v[200:203], a[68:71], a[88:91], v[200:203]
    ds_read_b64_tr_b16 a[28:29], v57 offset:16384
    v_mfma_f32_16x16x32_bf16 v[168:171], a[68:71], a[84:87], v[168:171]
    ds_read_b64_tr_b16 a[30:31], v57 offset:17408
    v_mfma_f32_16x16x32_bf16 v[136:139], a[68:71], a[80:83], v[136:139]
    v_mfma_f32_16x16x32_bf16 v[140:143], a[72:75], a[80:83], v[140:143]
    v_mfma_f32_16x16x32_bf16 v[172:175], a[72:75], a[84:87], v[172:175]
    buffer_load_dwordx4 v37, s[16:19], s36 offen offset:1024 lds
    v_mfma_f32_16x16x32_bf16 v[204:207], a[72:75], a[88:91], v[204:207]
    v_mfma_f32_16x16x32_bf16 v[236:239], a[72:75], a[92:95], v[236:239]
    v_mfma_f32_16x16x32_bf16 v[240:243], a[76:79], a[92:95], v[240:243]
    v_mfma_f32_16x16x32_bf16 v[208:211], a[76:79], a[88:91], v[208:211]
    v_mfma_f32_16x16x32_bf16 v[176:179], a[76:79], a[84:87], v[176:179]
    v_mfma_f32_16x16x32_bf16 v[144:147], a[76:79], a[80:83], v[144:147]
    s_waitcnt lgkmcnt(0)
    v_mfma_f32_16x16x32_bf16 v[100:103], a[0:3], v[32:35], v[100:103]
    ds_read_b64_tr_b16 a[48:49], v50 offset:24576
    v_mfma_f32_16x16x32_bf16 v[104:107], a[4:7], v[32:35], v[104:107]
    ds_read_b64_tr_b16 a[50:51], v50 offset:25600
    v_mfma_f32_16x16x32_bf16 v[116:119], a[0:3], a[32:35], v[116:119]
    buffer_load_dwordx4 v38, s[16:19], s36 offen offset:2048 lds
    v_mfma_f32_16x16x32_bf16 v[148:151], a[0:3], a[36:39], v[148:151]
    ds_read_b128 a[80:83], v49 offset:8192
    v_mfma_f32_16x16x32_bf16 v[180:183], a[0:3], a[40:43], v[180:183]
    ds_read_b128 a[84:87], v49 offset:10240
    v_mfma_f32_16x16x32_bf16 v[212:215], a[0:3], a[44:47], v[212:215]
    ds_read_b128 a[88:91], v49 offset:12288
    v_mfma_f32_16x16x32_bf16 v[216:219], a[4:7], a[44:47], v[216:219]
    ds_read_b128 a[92:95], v49 offset:14336
    v_mfma_f32_16x16x32_bf16 v[184:187], a[4:7], a[40:43], v[184:187]
    buffer_load_dwordx4 v39, s[16:19], s36 offen offset:3072 lds
    v_mfma_f32_16x16x32_bf16 v[152:155], a[4:7], a[36:39], v[152:155]
    ds_read_b64_tr_b16 a[52:53], v51 offset:24576
    v_mfma_f32_16x16x32_bf16 v[120:123], a[4:7], a[32:35], v[120:123]
    ds_read_b64_tr_b16 a[54:55], v51 offset:25600
    v_mfma_f32_16x16x32_bf16 v[124:127], a[8:11], a[32:35], v[124:127]
    ds_read_b64_tr_b16 a[56:57], v52 offset:24576
    v_mfma_f32_16x16x32_bf16 v[156:159], a[8:11], a[36:39], v[156:159]
    s_add_u32 m0, s38, 4096
    ds_read_b64_tr_b16 a[58:59], v52 offset:25600
    v_mfma_f32_16x16x32_bf16 v[188:191], a[8:11], a[40:43], v[188:191]
    buffer_load_dwordx4 v40, s[16:19], s36 offen offset:0 lds
    v_mfma_f32_16x16x32_bf16 v[220:223], a[8:11], a[44:47], v[220:223]
    ds_read_b64_tr_b16 a[60:61], v53 offset:24576
    v_mfma_f32_16x16x32_bf16 v[224:227], a[12:15], a[44:47], v[224:227]
    ds_read_b64_tr_b16 a[62:63], v53 offset:25600
    v_mfma_f32_16x16x32_bf16 v[192:195], a[12:15], a[40:43], v[192:195]
    ds_read_b64_tr_b16 a[64:65], v54 offset:24576
    v_mfma_f32_16x16x32_bf16 v[160:163], a[12:15], a[36:39], v[160:163]
    ds_read_b64_tr_b16 a[66:67], v54 offset:25600
    v_mfma_f32_16x16x32_bf16 v[128:131], a[12:15], a[32:35], v[128:131]
    buffer_load_dwordx4 v41, s[16:19], s36 offen offset:1024 lds
    v_mfma_f32_16x16x32_bf16 v[132:135], a[16:19], a[32:35], v[132:135]
    ds_read_b64_tr_b16 a[68:69], v55 offset:24576
    v_mfma_f32_16x16x32_bf16 v[164:167], a[16:19], a[36:39], v[164:167]
    ds_read_b64_tr_b16 a[70:71], v55 offset:25600
    v_mfma_f32_16x16x32_bf16 v[196:199], a[16:19], a[40:43], v[196:199]
    ds_read_b64_tr_b16 a[72:73], v56 offset:24576
    v_mfma_f32_16x16x32_bf16 v[228:231], a[16:19], a[44:47], v[228:231]
    ds_read_b64_tr_b16 a[74:75], v56 offset:25600
    v_mfma_f32_16x16x32_bf16 v[232:235], a[20:23], a[44:47], v[232:235]
    buffer_load_dwordx4 v42, s[16:19], s36 offen offset:2048 lds
    v_mfma_f32_16x16x32_bf16 v[200:203], a[20:23], a[40:43], v[200:203]
    ds_read_b64_tr_b16 a[76:77], v57 offset:24576
    v_mfma_f32_16x16x32_bf16 v[168:171], a[20:23], a[36:39], v[168:171]
    ds_read_b64_tr_b16 a[78:79], v57 offset:25600
    v_mfma_f32_16x16x32_bf16 v[136:139], a[20:23], a[32:35], v[136:139]
    v_mfma_f32_16x16x32_bf16 v[140:143], a[24:27], a[32:35], v[140:143]
    v_mfma_f32_16x16x32_bf16 v[172:175], a[24:27], a[36:39], v[172:175]
    buffer_load_dwordx4 v43, s[16:19], s36 offen offset:3072 lds
    v_mfma_f32_16x16x32_bf16 v[204:207], a[24:27], a[40:43], v[204:207]
    v_mfma_f32_16x16x32_bf16 v[236:239], a[24:27], a[44:47], v[236:239]
    v_mfma_f32_16x16x32_bf16 v[240:243], a[28:31], a[44:47], v[240:243]
    v_mfma_f32_16x16x32_bf16 v[208:211], a[28:31], a[40:43], v[208:211]
    v_mfma_f32_16x16x32_bf16 v[176:179], a[28:31], a[36:39], v[176:179]
    v_mfma_f32_16x16x32_bf16 v[144:147], a[28:31], a[32:35], v[144:147]
    s_waitcnt vmcnt(12) lgkmcnt(0)
    s_barrier
    s_cmp_lg_u32 s5, 0
    s_cbranch_scc1 L_signalled
    s_mov_b64 exec, 1
    buffer_atomic_add v27, off, s[92:95], s74 sc1
    s_mov_b64 exec, -1
L_signalled:
    v_mfma_f32_16x16x32_bf16 v[100:103], a[48:51], v[32:35], v[100:103]
    ds_read_b64_tr_b16 a[0:1], v50 offset:32768
    v_mfma_f32_16x16x32_bf16 v[104:107], a[52:55], v[32:35], v[104:107]
    s_add_u32 m0, s39, 16384
    s_mov_b32 s37, 3670016
    ds_read_b64_tr_b16 a[2:3], v50 offset:33792
    v_mfma_f32_16x16x32_bf16 v[116:119], a[48:51], a[80:83], v[116:119]
    buffer_load_dwordx4 v44, s[20:23], s37 offen offset:0 lds
    v_mfma_f32_16x16x32_bf16 v[148:151], a[48:51], a[84:87], v[148:151]
    ds_read_b128 a[32:35], v48 offset:16384
    v_mfma_f32_16x16x32_bf16 v[180:183], a[48:51], a[88:91], v[180:183]
    ds_read_b128 a[36:39], v48 offset:18432
    v_mfma_f32_16x16x32_bf16 v[212:215], a[48:51], a[92:95], v[212:215]
    buffer_load_dwordx4 v45, s[20:23], s37 offen offset:1024 lds
    v_mfma_f32_16x16x32_bf16 v[216:219], a[52:55], a[92:95], v[216:219]
    ds_read_b128 a[40:43], v48 offset:20480
    v_mfma_f32_16x16x32_bf16 v[184:187], a[52:55], a[88:91], v[184:187]
    ds_read_b128 a[44:47], v48 offset:22528
    v_mfma_f32_16x16x32_bf16 v[152:155], a[52:55], a[84:87], v[152:155]
    ds_read_b64_tr_b16 a[4:5], v51 offset:32768
    v_mfma_f32_16x16x32_bf16 v[120:123], a[52:55], a[80:83], v[120:123]
    buffer_load_dwordx4 v46, s[20:23], s37 offen offset:2048 lds
    v_mfma_f32_16x16x32_bf16 v[124:127], a[56:59], a[80:83], v[124:127]
    ds_read_b64_tr_b16 a[6:7], v51 offset:33792
    v_mfma_f32_16x16x32_bf16 v[156:159], a[56:59], a[84:87], v[156:159]
    ds_read_b64_tr_b16 a[8:9], v52 offset:32768
    v_mfma_f32_16x16x32_bf16 v[188:191], a[56:59], a[88:91], v[188:191]
    ds_read_b64_tr_b16 a[10:11], v52 offset:33792
    v_mfma_f32_16x16x32_bf16 v[220:223], a[56:59], a[92:95], v[220:223]
    buffer_load_dwordx4 v47, s[20:23], s37 offen offset:3072 lds
    v_mfma_f32_16x16x32_bf16 v[224:227], a[60:63], a[92:95], v[224:227]
    ds_read_b64_tr_b16 a[12:13], v53 offset:32768
    v_mfma_f32_16x16x32_bf16 v[192:195], a[60:63], a[88:91], v[192:195]
    ds_read_b64_tr_b16 a[14:15], v53 offset:33792
    v_mfma_f32_16x16x32_bf16 v[160:163], a[60:63], a[84:87], v[160:163]
    s_add_u32 m0, s38, 8192
    s_mov_b32 s36, 896
    ds_read_b64_tr_b16 a[16:17], v54 offset:32768
    v_mfma_f32_16x16x32_bf16 v[128:131], a[60:63], a[80:83], v[128:131]
    buffer_load_dwordx4 v36, s[16:19], s36 offen offset:0 lds
    v_mfma_f32_16x16x32_bf16 v[132:135], a[64:67], a[80:83], v[132:135]
    ds_read_b64_tr_b16 a[18:19], v54 offset:33792
    v_mfma_f32_16x16x32_bf16 v[164:167], a[64:67], a[84:87], v[164:167]
    ds_read_b64_tr_b16 a[20:21], v55 offset:32768
    v_mfma_f32_16x16x32_bf16 v[196:199], a[64:67], a[88:91], v[196:199]
    buffer_load_dwordx4 v37, s[16:19], s36 offen offset:1024 lds
    v_mfma_f32_16x16x32_bf16 v[228:231], a[64:67], a[92:95], v[228:231]
    ds_read_b64_tr_b16 a[22:23], v55 offset:33792
    v_mfma_f32_16x16x32_bf16 v[232:235], a[68:71], a[92:95], v[232:235]
    ds_read_b64_tr_b16 a[24:25], v56 offset:32768
    v_mfma_f32_16x16x32_bf16 v[200:203], a[68:71], a[88:91], v[200:203]
    ds_read_b64_tr_b16 a[26:27], v56 offset:33792
    v_mfma_f32_16x16x32_bf16 v[168:171], a[68:71], a[84:87], v[168:171]
    buffer_load_dwordx4 v38, s[16:19], s36 offen offset:2048 lds
    v_mfma_f32_16x16x32_bf16 v[136:139], a[68:71], a[80:83], v[136:139]
    ds_read_b64_tr_b16 a[28:29], v57 offset:32768
    v_mfma_f32_16x16x32_bf16 v[140:143], a[72:75], a[80:83], v[140:143]
    ds_read_b64_tr_b16 a[30:31], v57 offset:33792
    v_mfma_f32_16x16x32_bf16 v[172:175], a[72:75], a[84:87], v[172:175]
    v_mfma_f32_16x16x32_bf16 v[204:207], a[72:75], a[88:91], v[204:207]
    buffer_load_dwordx4 v39, s[16:19], s36 offen offset:3072 lds
    v_mfma_f32_16x16x32_bf16 v[236:239], a[72:75], a[92:95], v[236:239]
    v_mfma_f32_16x16x32_bf16 v[240:243], a[76:79], a[92:95], v[240:243]
    v_mfma_f32_16x16x32_bf16 v[208:211], a[76:79], a[88:91], v[208:211]
    v_mfma_f32_16x16x32_bf16 v[176:179], a[76:79], a[84:87], v[176:179]
    v_mfma_f32_16x16x32_bf16 v[144:147], a[76:79], a[80:83], v[144:147]
    s_waitcnt lgkmcnt(0)
    v_mfma_f32_16x16x32_bf16 v[100:103], a[0:3], v[32:35], v[100:103]
    ds_read_b64_tr_b16 a[48:49], v50 offset:40960
    v_mfma_f32_16x16x32_bf16 v[104:107], a[4:7], v[32:35], v[104:107]
    s_add_u32 m0, s38, 12288
    ds_read_b64_tr_b16 a[50:51], v50 offset:41984
    v_mfma_f32_16x16x32_bf16 v[116:119], a[0:3], a[32:35], v[116:119]
    buffer_load_dwordx4 v40, s[16:19], s36 offen offset:0 lds
    v_mfma_f32_16x16x32_bf16 v[148:151], a[0:3], a[36:39], v[148:151]
    ds_read_b128 a[80:83], v49 offset:16384
    v_mfma_f32_16x16x32_bf16 v[180:183], a[0:3], a[40:43], v[180:183]
    ds_read_b128 a[84:87], v49 offset:18432
    v_mfma_f32_16x16x32_bf16 v[212:215], a[0:3], a[44:47], v[212:215]
    buffer_load_dwordx4 v41, s[16:19], s36 offen offset:1024 lds
    v_mfma_f32_16x16x32_bf16 v[216:219], a[4:7], a[44:47], v[216:219]
    ds_read_b128 a[88:91], v49 offset:20480
    v_mfma_f32_16x16x32_bf16 v[184:187], a[4:7], a[40:43], v[184:187]
    ds_read_b128 a[92:95], v49 offset:22528
    v_mfma_f32_16x16x32_bf16 v[152:155], a[4:7], a[36:39], v[152:155]
    ds_read_b64_tr_b16 a[52:53], v51 offset:40960
    v_mfma_f32_16x16x32_bf16 v[120:123], a[4:7], a[32:35], v[120:123]
    buffer_load_dwordx4 v42, s[16:19], s36 offen offset:2048 lds
    v_mfma_f32_16x16x32_bf16 v[124:127], a[8:11], a[32:35], v[124:127]
    ds_read_b64_tr_b16 a[54:55], v51 offset:41984
    v_mfma_f32_16x16x32_bf16 v[156:159], a[8:11], a[36:39], v[156:159]
    ds_read_b64_tr_b16 a[56:57], v52 offset:40960
    v_mfma_f32_16x16x32_bf16 v[188:191], a[8:11], a[40:43], v[188:191]
    ds_read_b64_tr_b16 a[58:59], v52 offset:41984
    v_mfma_f32_16x16x32_bf16 v[220:223], a[8:11], a[44:47], v[220:223]
    buffer_load_dwordx4 v43, s[16:19], s36 offen offset:3072 lds
    v_mfma_f32_16x16x32_bf16 v[224:227], a[12:15], a[44:47], v[224:227]
    ds_read_b64_tr_b16 a[60:61], v53 offset:40960
    v_mfma_f32_16x16x32_bf16 v[192:195], a[12:15], a[40:43], v[192:195]
    ds_read_b64_tr_b16 a[62:63], v53 offset:41984
    v_mfma_f32_16x16x32_bf16 v[160:163], a[12:15], a[36:39], v[160:163]
    s_add_u32 m0, s34, 49152
    ds_read_b64_tr_b16 a[64:65], v54 offset:40960
    v_mfma_f32_16x16x32_bf16 v[128:131], a[12:15], a[32:35], v[128:131]
    buffer_load_dwordx4 v13, s[8:11], s28 offen offset:0 lds
    v_mfma_f32_16x16x32_bf16 v[132:135], a[16:19], a[32:35], v[132:135]
    ds_read_b64_tr_b16 a[66:67], v54 offset:41984
    v_mfma_f32_16x16x32_bf16 v[164:167], a[16:19], a[36:39], v[164:167]
    ds_read_b64_tr_b16 a[68:69], v55 offset:40960
    v_mfma_f32_16x16x32_bf16 v[196:199], a[16:19], a[40:43], v[196:199]
    buffer_load_dwordx4 v14, s[8:11], s28 offen offset:1024 lds
    v_mfma_f32_16x16x32_bf16 v[228:231], a[16:19], a[44:47], v[228:231]
    ds_read_b64_tr_b16 a[70:71], v55 offset:41984
    v_mfma_f32_16x16x32_bf16 v[232:235], a[20:23], a[44:47], v[232:235]
    ds_read_b64_tr_b16 a[72:73], v56 offset:40960
    v_mfma_f32_16x16x32_bf16 v[200:203], a[20:23], a[40:43], v[200:203]
    ds_read_b64_tr_b16 a[74:75], v56 offset:41984
    v_mfma_f32_16x16x32_bf16 v[168:171], a[20:23], a[36:39], v[168:171]
    buffer_load_dwordx4 v15, s[8:11], s28 offen offset:2048 lds
    v_mfma_f32_16x16x32_bf16 v[136:139], a[20:23], a[32:35], v[136:139]
    ds_read_b64_tr_b16 a[76:77], v57 offset:40960
    v_mfma_f32_16x16x32_bf16 v[140:143], a[24:27], a[32:35], v[140:143]
    ds_read_b64_tr_b16 a[78:79], v57 offset:41984
    v_mfma_f32_16x16x32_bf16 v[172:175], a[24:27], a[36:39], v[172:175]
    v_mfma_f32_16x16x32_bf16 v[204:207], a[24:27], a[40:43], v[204:207]
    buffer_load_dwordx4 v16, s[8:11], s28 offen offset:3072 lds
    v_mfma_f32_16x16x32_bf16 v[236:239], a[24:27], a[44:47], v[236:239]
    v_mfma_f32_16x16x32_bf16 v[240:243], a[28:31], a[44:47], v[240:243]
    v_mfma_f32_16x16x32_bf16 v[208:211], a[28:31], a[40:43], v[208:211]
    v_mfma_f32_16x16x32_bf16 v[176:179], a[28:31], a[36:39], v[176:179]
    v_mfma_f32_16x16x32_bf16 v[144:147], a[28:31], a[32:35], v[144:147]
    s_add_u32 s28, s28, 16384
    s_waitcnt vmcnt(16) lgkmcnt(0)
    s_barrier
    v_mfma_f32_16x16x32_bf16 v[100:103], a[48:51], v[32:35], v[100:103]
    ds_read_b64_tr_b16 a[0:1], v50 offset:0
    v_mfma_f32_16x16x32_bf16 v[104:107], a[52:55], v[32:35], v[104:107]
    s_add_u32 m0, s39, 32768
    s_mov_b32 s37, 4194304
    ds_read_b64_tr_b16 a[2:3], v50 offset:1024
    v_mfma_f32_16x16x32_bf16 v[116:119], a[48:51], a[80:83], v[116:119]
    buffer_load_dwordx4 v44, s[20:23], s37 offen offset:0 lds
    v_mfma_f32_16x16x32_bf16 v[148:151], a[48:51], a[84:87], v[148:151]
    ds_read_b128 a[32:35], v48 offset:0
    v_mfma_f32_16x16x32_bf16 v[180:183], a[48:51], a[88:91], v[180:183]
    ds_read_b128 a[36:39], v48 offset:2048
    v_mfma_f32_16x16x32_bf16 v[212:215], a[48:51], a[92:95], v[212:215]
    ds_read_b128 a[40:43], v48 offset:4096
    v_mfma_f32_16x16x32_bf16 v[216:219], a[52:55], a[92:95], v[216:219]
    ds_read_b128 a[44:47], v48 offset:6144
    v_mfma_f32_16x16x32_bf16 v[184:187], a[52:55], a[88:91], v[184:187]
    buffer_load_dwordx4 v45, s[20:23], s37 offen offset:1024 lds
    v_mfma_f32_16x16x32_bf16 v[152:155], a[52:55], a[84:87], v[152:155]
    ds_read_b64_tr_b16 a[4:5], v51 offset:0
    v_mfma_f32_16x16x32_bf16 v[120:123], a[52:55], a[80:83], v[120:123]
    ds_read_b64_tr_b16 a[6:7], v51 offset:1024
    v_mfma_f32_16x16x32_bf16 v[124:127], a[56:59], a[80:83], v[124:127]
    ds_read_b64_tr_b16 a[8:9], v52 offset:0
    v_mfma_f32_16x16x32_bf16 v[156:159], a[56:59], a[84:87], v[156:159]
    ds_read_b64_tr_b16 a[10:11], v52 offset:1024
    v_mfma_f32_16x16x32_bf16 v[188:191], a[56:59], a[88:91], v[188:191]
    buffer_load_dwordx4 v46, s[20:23], s37 offen offset:2048 lds
    v_mfma_f32_16x16x32_bf16 v[220:223], a[56:59], a[92:95], v[220:223]
    ds_read_b64_tr_b16 a[12:13], v53 offset:0
    v_mfma_f32_16x16x32_bf16 v[224:227], a[60:63], a[92:95], v[224:227]
    ds_read_b64_tr_b16 a[14:15], v53 offset:1024
    v_mfma_f32_16x16x32_bf16 v[192:195], a[60:63], a[88:91], v[192:195]
    ds_read_b64_tr_b16 a[16:17], v54 offset:0
    v_mfma_f32_16x16x32_bf16 v[160:163], a[60:63], a[84:87], v[160:163]
    ds_read_b64_tr_b16 a[18:19], v54 offset:1024
    v_mfma_f32_16x16x32_bf16 v[128:131], a[60:63], a[80:83], v[128:131]
    buffer_load_dwordx4 v47, s[20:23], s37 offen offset:3072 lds
    v_mfma_f32_16x16x32_bf16 v[132:135], a[64:67], a[80:83], v[132:135]
    ds_read_b64_tr_b16 a[20:21], v55 offset:0
    v_mfma_f32_16x16x32_bf16 v[164:167], a[64:67], a[84:87], v[164:167]
    ds_read_b64_tr_b16 a[22:23], v55 offset:1024
    v_mfma_f32_16x16x32_bf16 v[196:199], a[64:67], a[88:91], v[196:199]
    ds_read_b64_tr_b16 a[24:25], v56 offset:0
    v_mfma_f32_16x16x32_bf16 v[228:231], a[64:67], a[92:95], v[228:231]
    s_add_u32 m0, s38, 16384
    s_mov_b32 s36, 1024
    ds_read_b64_tr_b16 a[26:27], v56 offset:1024
    v_mfma_f32_16x16x32_bf16 v[232:235], a[68:71], a[92:95], v[232:235]
    buffer_load_dwordx4 v36, s[16:19], s36 offen offset:0 lds
    v_mfma_f32_16x16x32_bf16 v[200:203], a[68:71], a[88:91], v[200:203]
    ds_read_b64_tr_b16 a[28:29], v57 offset:0
    v_mfma_f32_16x16x32_bf16 v[168:171], a[68:71], a[84:87], v[168:171]
    ds_read_b64_tr_b16 a[30:31], v57 offset:1024
    v_mfma_f32_16x16x32_bf16 v[136:139], a[68:71], a[80:83], v[136:139]
    v_mfma_f32_16x16x32_bf16 v[140:143], a[72:75], a[80:83], v[140:143]
    v_mfma_f32_16x16x32_bf16 v[172:175], a[72:75], a[84:87], v[172:175]
    buffer_load_dwordx4 v37, s[16:19], s36 offen offset:1024 lds
    v_mfma_f32_16x16x32_bf16 v[204:207], a[72:75], a[88:91], v[204:207]
    v_mfma_f32_16x16x32_bf16 v[236:239], a[72:75], a[92:95], v[236:239]
    v_mfma_f32_16x16x32_bf16 v[240:243], a[76:79], a[92:95], v[240:243]
    v_mfma_f32_16x16x32_bf16 v[208:211], a[76:79], a[88:91], v[208:211]
    v_mfma_f32_16x16x32_bf16 v[176:179], a[76:79], a[84:87], v[176:179]
    v_mfma_f32_16x16x32_bf16 v[144:147], a[76:79], a[80:83], v[144:147]
    s_waitcnt lgkmcnt(0)
    v_mfma_f32_16x16x32_bf16 v[100:103], a[0:3], v[32:35], v[100:103]
    ds_read_b64_tr_b16 a[48:49], v50 offset:8192
    v_mfma_f32_16x16x32_bf16 v[104:107], a[4:7], v[32:35], v[104:107]
    ds_read_b64_tr_b16 a[50:51], v50 offset:9216
    v_mfma_f32_16x16x32_bf16 v[116:119], a[0:3], a[32:35], v[116:119]
    buffer_load_dwordx4 v38, s[16:19], s36 offen offset:2048 lds
    v_mfma_f32_16x16x32_bf16 v[148:151], a[0:3], a[36:39], v[148:151]
    ds_read_b128 a[80:83], v49 offset:0
    v_mfma_f32_16x16x32_bf16 v[180:183], a[0:3], a[40:43], v[180:183]
    ds_read_b128 a[84:87], v49 offset:2048
    v_mfma_f32_16x16x32_bf16 v[212:215], a[0:3], a[44:47], v[212:215]
    ds_read_b128 a[88:91], v49 offset:4096
    v_mfma_f32_16x16x32_bf16 v[216:219], a[4:7], a[44:47], v[216:219]
    ds_read_b128 a[92:95], v49 offset:6144
    v_mfma_f32_16x16x32_bf16 v[184:187], a[4:7], a[40:43], v[184:187]
    buffer_load_dwordx4 v39, s[16:19], s36 offen offset:3072 lds
    v_mfma_f32_16x16x32_bf16 v[152:155], a[4:7], a[36:39], v[152:155]
    ds_read_b64_tr_b16 a[52:53], v51 offset:8192
    v_mfma_f32_16x16x32_bf16 v[120:123], a[4:7], a[32:35], v[120:123]
    ds_read_b64_tr_b16 a[54:55], v51 offset:9216
    v_mfma_f32_16x16x32_bf16 v[124:127], a[8:11], a[32:35], v[124:127]
    ds_read_b64_tr_b16 a[56:57], v52 offset:8192
    v_mfma_f32_16x16x32_bf16 v[156:159], a[8:11], a[36:39], v[156:159]
    s_add_u32 m0, s38, 20480
    ds_read_b64_tr_b16 a[58:59], v52 offset:9216
    v_mfma_f32_16x16x32_bf16 v[188:191], a[8:11], a[40:43], v[188:191]
    buffer_load_dwordx4 v40, s[16:19], s36 offen offset:0 lds
    v_mfma_f32_16x16x32_bf16 v[220:223], a[8:11], a[44:47], v[220:223]
    ds_read_b64_tr_b16 a[60:61], v53 offset:8192
    v_mfma_f32_16x16x32_bf16 v[224:227], a[12:15], a[44:47], v[224:227]
    ds_read_b64_tr_b16 a[62:63], v53 offset:9216
    v_mfma_f32_16x16x32_bf16 v[192:195], a[12:15], a[40:43], v[192:195]
    ds_read_b64_tr_b16 a[64:65], v54 offset:8192
    v_mfma_f32_16x16x32_bf16 v[160:163], a[12:15], a[36:39], v[160:163]
    ds_read_b64_tr_b16 a[66:67], v54 offset:9216
    v_mfma_f32_16x16x32_bf16 v[128:131], a[12:15], a[32:35], v[128:131]
    buffer_load_dwordx4 v41, s[16:19], s36 offen offset:1024 lds
    v_mfma_f32_16x16x32_bf16 v[132:135], a[16:19], a[32:35], v[132:135]
    ds_read_b64_tr_b16 a[68:69], v55 offset:8192
    v_mfma_f32_16x16x32_bf16 v[164:167], a[16:19], a[36:39], v[164:167]
    ds_read_b64_tr_b16 a[70:71], v55 offset:9216
    v_mfma_f32_16x16x32_bf16 v[196:199], a[16:19], a[40:43], v[196:199]
    ds_read_b64_tr_b16 a[72:73], v56 offset:8192
    v_mfma_f32_16x16x32_bf16 v[228:231], a[16:19], a[44:47], v[228:231]
    ds_read_b64_tr_b16 a[74:75], v56 offset:9216
    v_mfma_f32_16x16x32_bf16 v[232:235], a[20:23], a[44:47], v[232:235]
    buffer_load_dwordx4 v42, s[16:19], s36 offen offset:2048 lds
    v_mfma_f32_16x16x32_bf16 v[200:203], a[20:23], a[40:43], v[200:203]
    ds_read_b64_tr_b16 a[76:77], v57 offset:8192
    v_mfma_f32_16x16x32_bf16 v[168:171], a[20:23], a[36:39], v[168:171]
    ds_read_b64_tr_b16 a[78:79], v57 offset:9216
    v_mfma_f32_16x16x32_bf16 v[136:139], a[20:23], a[32:35], v[136:139]
    v_mfma_f32_16x16x32_bf16 v[140:143], a[24:27], a[32:35], v[140:143]
    v_mfma_f32_16x16x32_bf16 v[172:175], a[24:27], a[36:39], v[172:175]
    buffer_load_dwordx4 v43, s[16:19], s36 offen offset:3072 lds
    v_mfma_f32_16x16x32_bf16 v[204:207], a[24:27], a[40:43], v[204:207]
    v_mfma_f32_16x16x32_bf16 v[236:239], a[24:27], a[44:47], v[236:239]
    v_mfma_f32_16x16x32_bf16 v[240:243], a[28:31], a[44:47], v[240:243]
    v_mfma_f32_16x16x32_bf16 v[208:211], a[28:31], a[40:43], v[208:211]
    v_mfma_f32_16x16x32_bf16 v[176:179], a[28:31], a[36:39], v[176:179]
    v_mfma_f32_16x16x32_bf16 v[144:147], a[28:31], a[32:35], v[144:147]
    s_waitcnt vmcnt(16) lgkmcnt(0)
    s_barrier
    v_mfma_f32_16x16x32_bf16 v[100:103], a[48:51], v[32:35], v[100:103]
    ds_read_b64_tr_b16 a[0:1], v50 offset:16384
    v_mfma_f32_16x16x32_bf16 v[104:107], a[52:55], v[32:35], v[104:107]
    s_add_u32 m0, s39, 0
    s_mov_b32 s37, 4718592
    ds_read_b64_tr_b16 a[2:3], v50 offset:17408
    v_mfma_f32_16x16x32_bf16 v[116:119], a[48:51], a[80:83], v[116:119]
    buffer_load_dwordx4 v44, s[20:23], s37 offen offset:0 lds
    v_mfma_f32_16x16x32_bf16 v[148:151], a[48:51], a[84:87], v[148:151]
    ds_read_b128 a[32:35], v48 offset:8192
    v_mfma_f32_16x16x32_bf16 v[180:183], a[48:51], a[88:91], v[180:183]
    ds_read_b128 a[36:39], v48 offset:10240
    v_mfma_f32_16x16x32_bf16 v[212:215], a[48:51], a[92:95], v[212:215]
    ds_read_b128 a[40:43], v48 offset:12288
    v_mfma_f32_16x16x32_bf16 v[216:219], a[52:55], a[92:95], v[216:219]
    ds_read_b128 a[44:47], v48 offset:14336
    v_mfma_f32_16x16x32_bf16 v[184:187], a[52:55], a[88:91], v[184:187]
    buffer_load_dwordx4 v45, s[20:23], s37 offen offset:1024 lds
    v_mfma_f32_16x16x32_bf16 v[152:155], a[52:55], a[84:87], v[152:155]
    ds_read_b64_tr_b16 a[4:5], v51 offset:16384
    v_mfma_f32_16x16x32_bf16 v[120:123], a[52:55], a[80:83], v[120:123]
    ds_read_b64_tr_b16 a[6:7], v51 offset:17408
    v_mfma_f32_16x16x32_bf16 v[124:127], a[56:59], a[80:83], v[124:127]
    ds_read_b64_tr_b16 a[8:9], v52 offset:16384
    v_mfma_f32_16x16x32_bf16 v[156:159], a[56:59], a[84:87], v[156:159]
    ds_read_b64_tr_b16 a[10:11], v52 offset:17408
    v_mfma_f32_16x16x32_bf16 v[188:191], a[56:59], a[88:91], v[188:191]
    buffer_load_dwordx4 v46, s[20:23], s37 offen offset:2048 lds
    v_mfma_f32_16x16x32_bf16 v[220:223], a[56:59], a[92:95], v[220:223]
    ds_read_b64_tr_b16 a[12:13], v53 offset:16384
    v_mfma_f32_16x16x32_bf16 v[224:227], a[60:63], a[92:95], v[224:227]
    ds_read_b64_tr_b16 a[14:15], v53 offset:17408
    v_mfma_f32_16x16x32_bf16 v[192:195], a[60:63], a[88:91], v[192:195]
    ds_read_b64_tr_b16 a[16:17], v54 offset:16384
    v_mfma_f32_16x16x32_bf16 v[160:163], a[60:63], a[84:87], v[160:163]
    ds_read_b64_tr_b16 a[18:19], v54 offset:17408
    v_mfma_f32_16x16x32_bf16 v[128:131], a[60:63], a[80:83], v[128:131]
    buffer_load_dwordx4 v47, s[20:23], s37 offen offset:3072 lds
    v_mfma_f32_16x16x32_bf16 v[132:135], a[64:67], a[80:83], v[132:135]
    ds_read_b64_tr_b16 a[20:21], v55 offset:16384
    v_mfma_f32_16x16x32_bf16 v[164:167], a[64:67], a[84:87], v[164:167]
    ds_read_b64_tr_b16 a[22:23], v55 offset:17408
    v_mfma_f32_16x16x32_bf16 v[196:199], a[64:67], a[88:91], v[196:199]
    ds_read_b64_tr_b16 a[24:25], v56 offset:16384
    v_mfma_f32_16x16x32_bf16 v[228:231], a[64:67], a[92:95], v[228:231]
    s_add_u32 m0, s38, 0
    s_mov_b32 s36, 1152
    ds_read_b64_tr_b16 a[26:27], v56 offset:17408
    v_mfma_f32_16x16x32_bf16 v[232:235], a[68:71], a[92:95], v[232:235]
    buffer_load_dword v252, off, s[92:95], s74 sc1
    buffer_load_dwordx4 v36, s[16:19], s36 offen offset:0 lds
    v_mfma_f32_16x16x32_bf16 v[200:203], a[68:71], a[88:91], v[200:203]
    ds_read_b64_tr_b16 a[28:29], v57 offset:16384
    v_mfma_f32_16x16x32_bf16 v[168:171], a[68:71], a[84:87], v[168:171]
    ds_read_b64_tr_b16 a[30:31], v57 offset:17408
    v_mfma_f32_16x16x32_bf16 v[136:139], a[68:71], a[80:83], v[136:139]
    v_mfma_f32_16x16x32_bf16 v[140:143], a[72:75], a[80:83], v[140:143]
    v_mfma_f32_16x16x32_bf16 v[172:175], a[72:75], a[84:87], v[172:175]
    buffer_load_dwordx4 v37, s[16:19], s36 offen offset:1024 lds
    v_mfma_f32_16x16x32_bf16 v[204:207], a[72:75], a[88:91], v[204:207]
    v_mfma_f32_16x16x32_bf16 v[236:239], a[72:75], a[92:95], v[236:239]
    v_mfma_f32_16x16x32_bf16 v[240:243], a[76:79], a[92:95], v[240:243]
    v_mfma_f32_16x16x32_bf16 v[208:211], a[76:79], a[88:91], v[208:211]
    v_mfma_f32_16x16x32_bf16 v[176:179], a[76:79], a[84:87], v[176:179]
    v_mfma_f32_16x16x32_bf16 v[144:147], a[76:79], a[80:83], v[144:147]
    s_waitcnt lgkmcnt(0)
    v_mfma_f32_16x16x32_bf16 v[100:103], a[0:3], v[32:35], v[100:103]
    ds_read_b64_tr_b16 a[48:49], v50 offset:24576
    v_mfma_f32_16x16x32_bf16 v[104:107], a[4:7], v[32:35], v[104:107]
    ds_read_b64_tr_b16 a[50:51], v50 offset:25600
    v_mfma_f32_16x16x32_bf16 v[116:119], a[0:3], a[32:35], v[116:119]
    buffer_load_dwordx4 v38, s[16:19], s36 offen offset:2048 lds
    v_mfma_f32_16x16x32_bf16 v[148:151], a[0:3], a[36:39], v[148:151]
    ds_read_b128 a[80:83], v49 offset:8192
    v_mfma_f32_16x16x32_bf16 v[180:183], a[0:3], a[40:43], v[180:183]
    ds_read_b128 a[84:87], v49 offset:10240
    v_mfma_f32_16x16x32_bf16 v[212:215], a[0:3], a[44:47], v[212:215]
    ds_read_b128 a[88:91], v49 offset:12288
    v_mfma_f32_16x16x32_bf16 v[216:219], a[4:7], a[44:47], v[216:219]
    ds_read_b128 a[92:95], v49 offset:14336
    v_mfma_f32_16x16x32_bf16 v[184:187], a[4:7], a[40:43], v[184:187]
    buffer_load_dwordx4 v39, s[16:19], s36 offen offset:3072 lds
    v_mfma_f32_16x16x32_bf16 v[152:155], a[4:7], a[36:39], v[152:155]
    ds_read_b64_tr_b16 a[52:53], v51 offset:24576
    v_mfma_f32_16x16x32_bf16 v[120:123], a[4:7], a[32:35], v[120:123]
    ds_read_b64_tr_b16 a[54:55], v51 offset:25600
    v_mfma_f32_16x16x32_bf16 v[124:127], a[8:11], a[32:35], v[124:127]
    ds_read_b64_tr_b16 a[56:57], v52 offset:24576
    v_mfma_f32_16x16x32_bf16 v[156:159], a[8:11], a[36:39], v[156:159]
    s_add_u32 m0, s38, 4096
    ds_read_b64_tr_b16 a[58:59], v52 offset:25600
    v_mfma_f32_16x16x32_bf16 v[188:191], a[8:11], a[40:43], v[188:191]
    buffer_load_dwordx4 v40, s[16:19], s36 offen offset:0 lds
    v_mfma_f32_16x16x32_bf16 v[220:223], a[8:11], a[44:47], v[220:223]
    ds_read_b64_tr_b16 a[60:61], v53 offset:24576
    v_mfma_f32_16x16x32_bf16 v[224:227], a[12:15], a[44:47], v[224:227]
    ds_read_b64_tr_b16 a[62:63], v53 offset:25600
    v_mfma_f32_16x16x32_bf16 v[192:195], a[12:15], a[40:43], v[192:195]
    ds_read_b64_tr_b16 a[64:65], v54 offset:24576
    v_mfma_f32_16x16x32_bf16 v[160:163], a[12:15], a[36:39], v[160:163]
    ds_read_b64_tr_b16 a[66:67], v54 offset:25600
    v_mfma_f32_16x16x32_bf16 v[128:131], a[12:15], a[32:35], v[128:131]
    buffer_load_dwordx4 v41, s[16:19], s36 offen offset:1024 lds
    v_mfma_f32_16x16x32_bf16 v[132:135], a[16:19], a[32:35], v[132:135]
    ds_read_b64_tr_b16 a[68:69], v55 offset:24576
    v_mfma_f32_16x16x32_bf16 v[164:167], a[16:19], a[36:39], v[164:167]
    ds_read_b64_tr_b16 a[70:71], v55 offset:25600
    v_mfma_f32_16x16x32_bf16 v[196:199], a[16:19], a[40:43], v[196:199]
    ds_read_b64_tr_b16 a[72:73], v56 offset:24576
    v_mfma_f32_16x16x32_bf16 v[228:231], a[16:19], a[44:47], v[228:231]
    ds_read_b64_tr_b16 a[74:75], v56 offset:25600
    v_mfma_f32_16x16x32_bf16 v[232:235], a[20:23], a[44:47], v[232:235]
    buffer_load_dwordx4 v42, s[16:19], s36 offen offset:2048 lds
    v_mfma_f32_16x16x32_bf16 v[200:203], a[20:23], a[40:43], v[200:203]
    ds_read_b64_tr_b16 a[76:77], v57 offset:24576
    v_mfma_f32_16x16x32_bf16 v[168:171], a[20:23], a[36:39], v[168:171]
    ds_read_b64_tr_b16 a[78:79], v57 offset:25600
    v_mfma_f32_16x16x32_bf16 v[136:139], a[20:23], a[32:35], v[136:139]
    v_mfma_f32_16x16x32_bf16 v[140:143], a[24:27], a[32:35], v[140:143]
    v_mfma_f32_16x16x32_bf16 v[172:175], a[24:27], a[36:39], v[172:175]
    buffer_load_dwordx4 v43, s[16:19], s36 offen offset:3072 lds
    v_mfma_f32_16x16x32_bf16 v[204:207], a[24:27], a[40:43], v[204:207]
    v_mfma_f32_16x16x32_bf16 v[236:239], a[24:27], a[44:47], v[236:239]
    v_mfma_f32_16x16x32_bf16 v[240:243], a[28:31], a[44:47], v[240:243]
    v_mfma_f32_16x16x32_bf16 v[208:211], a[28:31], a[40:43], v[208:211]
    v_mfma_f32_16x16x32_bf16 v[176:179], a[28:31], a[36:39], v[176:179]
    v_mfma_f32_16x16x32_bf16 v[144:147], a[28:31], a[32:35], v[144:147]
    s_waitcnt vmcnt(13) lgkmcnt(0)
    s_barrier
    v_mfma_f32_16x16x32_bf16 v[100:103], a[48:51], v[32:35], v[100:103]
    ds_read_b64_tr_b16 a[0:1], v50 offset:32768
    v_mfma_f32_16x16x32_bf16 v[104:107], a[52:55], v[32:35], v[104:107]
    s_add_u32 m0, s34, 16384
    ds_read_b64_tr_b16 a[2:3], v50 offset:33792
    v_mfma_f32_16x16x32_bf16 v[116:119], a[48:51], a[80:83], v[116:119]
    buffer_load_dwordx4 v13, s[8:11], s28 offen offset:0 lds
    v_mfma_f32_16x16x32_bf16 v[148:151], a[48:51], a[84:87], v[148:151]
    ds_read_b128 a[32:35], v48 offset:16384
    v_mfma_f32_16x16x32_bf16 v[180:183], a[48:51], a[88:91], v[180:183]
    ds_read_b128 a[36:39], v48 offset:18432
    v_mfma_f32_16x16x32_bf16 v[212:215], a[48:51], a[92:95], v[212:215]
    ds_read_b128 a[40:43], v48 offset:20480
    v_mfma_f32_16x16x32_bf16 v[216:219], a[52:55], a[92:95], v[216:219]
    ds_read_b128 a[44:47], v48 offset:22528
    v_mfma_f32_16x16x32_bf16 v[184:187], a[52:55], a[88:91], v[184:187]
    ds_read_b64_tr_b16 a[4:5], v51 offset:32768
    v_mfma_f32_16x16x32_bf16 v[152:155], a[52:55], a[84:87], v[152:155]
    ds_read_b64_tr_b16 a[6:7], v51 offset:33792
    v_mfma_f32_16x16x32_bf16 v[120:123], a[52:55], a[80:83], v[120:123]
    ds_read_b64_tr_b16 a[8:9], v52 offset:32768
    v_mfma_f32_16x16x32_bf16 v[124:127], a[56:59], a[80:83], v[124:127]
    ds_read_b64_tr_b16 a[10:11], v52 offset:33792
    v_mfma_f32_16x16x32_bf16 v[156:159], a[56:59], a[84:87], v[156:159]
    ds_read_b64_tr_b16 a[12:13], v53 offset:32768
    v_mfma_f32_16x16x32_bf16 v[188:191], a[56:59], a[88:91], v[188:191]
    ds_read_b64_tr_b16 a[14:15], v53 offset:33792
    v_mfma_f32_16x16x32_bf16 v[220:223], a[56:59], a[92:95], v[220:223]
    ds_read_b64_tr_b16 a[16:17], v54 offset:32768
    v_mfma_f32_16x16x32_bf16 v[224:227], a[60:63], a[92:95], v[224:227]
    ds_read_b64_tr_b16 a[18:19], v54 offset:33792
    v_mfma_f32_16x16x32_bf16 v[192:195], a[60:63], a[88:91], v[192:195]
    ds_read_b64_tr_b16 a[20:21], v55 offset:32768
    v_mfma_f32_16x16x32_bf16 v[160:163], a[60:63], a[84:87], v[160:163]
    ds_read_b64_tr_b16 a[22:23], v55 offset:33792
    v_mfma_f32_16x16x32_bf16 v[128:131], a[60:63], a[80:83], v[128:131]
    buffer_load_dwordx4 v14, s[8:11], s28 offen offset:1024 lds
    v_mfma_f32_16x16x32_bf16 v[132:135], a[64:67], a[80:83], v[132:135]
    ds_read_b64_tr_b16 a[24:25], v56 offset:32768
    v_mfma_f32_16x16x32_bf16 v[164:167], a[64:67], a[84:87], v[164:167]
    ds_read_b64_tr_b16 a[26:27], v56 offset:33792
    v_mfma_f32_16x16x32_bf16 v[196:199], a[64:67], a[88:91], v[196:199]
    ds_read_b64_tr_b16 a[28:29], v57 offset:32768
    v_mfma_f32_16x16x32_bf16 v[228:231], a[64:67], a[92:95], v[228:231]
    s_waitcnt vmcnt(10)
    v_cmp_gt_u32 vcc, 32, v252
    s_and_b64 vcc, vcc, exec
    s_cbranch_scc1 L_spin_rows
L_back_rows:
    buffer_load_dwordx2 v[108:109], v59, s[76:79], s46 offen offset:0 sc1
    buffer_load_dwordx2 v[110:111], v59, s[76:79], s46 offen offset:256 sc1
    buffer_load_dwordx2 v[112:113], v59, s[76:79], s46 offen offset:512 sc1
    buffer_load_dwordx2 v[114:115], v59, s[76:79], s46 offen offset:768 sc1
    ds_read_b64_tr_b16 a[30:31], v57 offset:33792
    v_mfma_f32_16x16x32_bf16 v[232:235], a[68:71], a[92:95], v[232:235]
    v_mfma_f32_16x16x32_bf16 v[200:203], a[68:71], a[88:91], v[200:203]
    v_mfma_f32_16x16x32_bf16 v[168:171], a[68:71], a[84:87], v[168:171]
    v_mfma_f32_16x16x32_bf16 v[136:139], a[68:71], a[80:83], v[136:139]
    v_mfma_f32_16x16x32_bf16 v[140:143], a[72:75], a[80:83], v[140:143]
    v_mfma_f32_16x16x32_bf16 v[172:175], a[72:75], a[84:87], v[172:175]
    v_mfma_f32_16x16x32_bf16 v[204:207], a[72:75], a[88:91], v[204:207]
    v_mfma_f32_16x16x32_bf16 v[236:239], a[72:75], a[92:95], v[236:239]
    v_mfma_f32_16x16x32_bf16 v[240:243], a[76:79], a[92:95], v[240:243]
    v_mfma_f32_16x16x32_bf16 v[208:211], a[76:79], a[88:91], v[208:211]
    v_mfma_f32_16x16x32_bf16 v[176:179], a[76:79], a[84:87], v[176:179]
    v_mfma_f32_16x16x32_bf16 v[144:147], a[76:79], a[80:83], v[144:147]
    s_waitcnt lgkmcnt(0)
    v_mfma_f32_16x16x32_bf16 v[100:103], a[0:3], v[32:35], v[100:103]
    ds_read_b64_tr_b16 a[48:49], v50 offset:40960
    v_mfma_f32_16x16x32_bf16 v[104:107], a[4:7], v[32:35], v[104:107]
    ds_read_b64_tr_b16 a[50:51], v50 offset:41984
    v_mfma_f32_16x16x32_bf16 v[116:119], a[0:3], a[32:35], v[116:119]
    buffer_load_dwordx4 v15, s[8:11], s28 offen offset:2048 lds
    v_mfma_f32_16x16x32_bf16 v[148:151], a[0:3], a[36:39], v[148:151]
    ds_read_b128 a[80:83], v49 offset:16384
    v_mfma_f32_16x16x32_bf16 v[180:183], a[0:3], a[40:43], v[180:183]
    ds_read_b128 a[84:87], v49 offset:18432
    v_mfma_f32_16x16x32_bf16 v[212:215], a[0:3], a[44:47], v[212:215]
    ds_read_b128 a[88:91], v49 offset:20480
    v_mfma_f32_16x16x32_bf16 v[216:219], a[4:7], a[44:47], v[216:219]
    ds_read_b128 a[92:95], v49 offset:22528
    v_mfma_f32_16x16x32_bf16 v[184:187], a[4:7], a[40:43], v[184:187]
    ds_read_b64_tr_b16 a[52:53], v51 offset:40960
    v_mfma_f32_16x16x32_bf16 v[152:155], a[4:7], a[36:39], v[152:155]
    ds_read_b64_tr_b16 a[54:55], v51 offset:41984
    v_mfma_f32_16x16x32_bf16 v[120:123], a[4:7], a[32:35], v[120:123]
    ds_read_b64_tr_b16 a[56:57], v52 offset:40960
    v_mfma_f32_16x16x32_bf16 v[124:127], a[8:11], a[32:35], v[124:127]
    ds_read_b64_tr_b16 a[58:59], v52 offset:41984
    v_mfma_f32_16x16x32_bf16 v[156:159], a[8:11], a[36:39], v[156:159]
    ds_read_b64_tr_b16 a[60:61], v53 offset:40960
    v_mfma_f32_16x16x32_bf16 v[188:191], a[8:11], a[40:43], v[188:191]
    ds_read_b64_tr_b16 a[62:63], v53 offset:41984
    v_mfma_f32_16x16x32_bf16 v[220:223], a[8:11], a[44:47], v[220:223]
    ds_read_b64_tr_b16 a[64:65], v54 offset:40960
    v_mfma_f32_16x16x32_bf16 v[224:227], a[12:15], a[44:47], v[224:227]
    ds_read_b64_tr_b16 a[66:67], v54 offset:41984
    v_mfma_f32_16x16x32_bf16 v[192:195], a[12:15], a[40:43], v[192:195]
    ds_read_b64_tr_b16 a[68:69], v55 offset:40960
    v_mfma_f32_16x16x32_bf16 v[160:163], a[12:15], a[36:39], v[160:163]
    ds_read_b64_tr_b16 a[70:71], v55 offset:41984
    v_mfma_f32_16x16x32_bf16 v[128:131], a[12:15], a[32:35], v[128:131]
    buffer_load_dwordx4 v16, s[8:11], s28 offen offset:3072 lds
    v_mfma_f32_16x16x32_bf16 v[132:135], a[16:19], a[32:35], v[132:135]
    ds_read_b64_tr_b16 a[72:73], v56 offset:40960
    v_mfma_f32_16x16x32_bf16 v[164:167], a[16:19], a[36:39], v[164:167]
    ds_read_b64_tr_b16 a[74:75], v56 offset:41984
    v_mfma_f32_16x16x32_bf16 v[196:199], a[16:19], a[40:43], v[196:199]
    ds_read_b64_tr_b16 a[76:77], v57 offset:40960
    v_mfma_f32_16x16x32_bf16 v[228:231], a[16:19], a[44:47], v[228:231]
    ds_read_b64_tr_b16 a[78:79], v57 offset:41984
    v_mfma_f32_16x16x32_bf16 v[232:235], a[20:23], a[44:47], v[232:235]
    v_mfma_f32_16x16x32_bf16 v[200:203], a[20:23], a[40:43], v[200:203]
    v_mfma_f32_16x16x32_bf16 v[168:171], a[20:23], a[36:39], v[168:171]
    v_mfma_f32_16x16x32_bf16 v[136:139], a[20:23], a[32:35], v[136:139]
    v_mfma_f32_16x16x32_bf16 v[140:143], a[24:27], a[32:35], v[140:143]
    v_mfma_f32_16x16x32_bf16 v[172:175], a[24:27], a[36:39], v[172:175]
    v_mfma_f32_16x16x32_bf16 v[204:207], a[24:27], a[40:43], v[204:207]
    v_mfma_f32_16x16x32_bf16 v[236:239], a[24:27], a[44:47], v[236:239]
    v_mfma_f32_16x16x32_bf16 v[240:243], a[28:31], a[44:47], v[240:243]
    v_mfma_f32_16x16x32_bf16 v[208:211], a[28:31], a[40:43], v[208:211]
    v_mfma_f32_16x16x32_bf16 v[176:179], a[28:31], a[36:39], v[176:179]
    v_mfma_f32_16x16x32_bf16 v[144:147], a[28:31], a[32:35], v[144:147]
    s_add_u32 s28, s28, 16384
    s_waitcnt vmcnt(8) lgkmcnt(0)
    s_barrier
    v_mfma_f32_16x16x32_bf16 v[100:103], a[48:51], v[32:35], v[100:103]
    ds_read_b64_tr_b16 a[0:1], v50 offset:0
    v_mfma_f32_16x16x32_bf16 v[104:107], a[52:55], v[32:35], v[104:107]
    s_add_u32 m0, s34, 32768
    ds_read_b64_tr_b16 a[2:3], v50 offset:1024
    v_mfma_f32_16x16x32_bf16 v[116:119], a[48:51], a[80:83], v[116:119]
    buffer_load_dwordx4 v13, s[8:11], s28 offen offset:0 lds
    v_mfma_f32_16x16x32_bf16 v[148:151], a[48:51], a[84:87], v[148:151]
    ds_read_b128 a[32:35], v48 offset:0
    v_mfma_f32_16x16x32_bf16 v[180:183], a[48:51], a[88:91], v[180:183]
    ds_read_b128 a[36:39], v48 offset:2048
    v_mfma_f32_16x16x32_bf16 v[212:215], a[48:51], a[92:95], v[212:215]
    ds_read_b128 a[40:43], v48 offset:4096
    v_mfma_f32_16x16x32_bf16 v[216:219], a[52:55], a[92:95], v[216:219]
    ds_read_b128 a[44:47], v48 offset:6144
    v_mfma_f32_16x16x32_bf16 v[184:187], a[52:55], a[88:91], v[184:187]
    ds_read_b64_tr_b16 a[4:5], v51 offset:0
    v_mfma_f32_16x16x32_bf16 v[152:155], a[52:55], a[84:87], v[152:155]
    ds_read_b64_tr_b16 a[6:7], v51 offset:1024
    v_mfma_f32_16x16x32_bf16 v[120:123], a[52:55], a[80:83], v[120:123]
    buffer_load_dwordx4 v14, s[8:11], s28 offen offset:1024 lds
    v_mfma_f32_16x16x32_bf16 v[124:127], a[56:59], a[80:83], v[124:127]
    ds_read_b64_tr_b16 a[8:9], v52 offset:0
    v_mfma_f32_16x16x32_bf16 v[156:159], a[56:59], a[84:87], v[156:159]
    ds_read_b64_tr_b16 a[10:11], v52 offset:1024
    v_mfma_f32_16x16x32_bf16 v[188:191], a[56:59], a[88:91], v[188:191]
    ds_read_b64_tr_b16 a[12:13], v53 offset:0
    v_mfma_f32_16x16x32_bf16 v[220:223], a[56:59], a[92:95], v[220:223]
    ds_read_b64_tr_b16 a[14:15], v53 offset:1024
    v_mfma_f32_16x16x32_bf16 v[224:227], a[60:63], a[92:95], v[224:227]
    ds_read_b64_tr_b16 a[16:17], v54 offset:0
    v_mfma_f32_16x16x32_bf16 v[192:195], a[60:63], a[88:91], v[192:195]
    ds_read_b64_tr_b16 a[18:19], v54 offset:1024
    v_mfma_f32_16x16x32_bf16 v[160:163], a[60:63], a[84:87], v[160:163]
    ds_read_b64_tr_b16 a[20:21], v55 offset:0
    v_mfma_f32_16x16x32_bf16 v[128:131], a[60:63], a[80:83], v[128:131]
    buffer_load_dwordx4 v15, s[8:11], s28 offen offset:2048 lds
    v_mfma_f32_16x16x32_bf16 v[132:135], a[64:67], a[80:83], v[132:135]
    ds_read_b64_tr_b16 a[22:23], v55 offset:1024
    v_mfma_f32_16x16x32_bf16 v[164:167], a[64:67], a[84:87], v[164:167]
    ds_read_b64_tr_b16 a[24:25], v56 offset:0
    v_mfma_f32_16x16x32_bf16 v[196:199], a[64:67], a[88:91], v[196:199]
    ds_read_b64_tr_b16 a[26:27], v56 offset:1024
    v_mfma_f32_16x16x32_bf16 v[228:231], a[64:67], a[92:95], v[228:231]
    ds_read_b64_tr_b16 a[28:29], v57 offset:0
    v_mfma_f32_16x16x32_bf16 v[232:235], a[68:71], a[92:95], v[232:235]
    ds_read_b64_tr_b16 a[30:31], v57 offset:1024
    v_mfma_f32_16x16x32_bf16 v[200:203], a[68:71], a[88:91], v[200:203]
    v_mfma_f32_16x16x32_bf16 v[168:171], a[68:71], a[84:87], v[168:171]
    buffer_load_dwordx4 v16, s[8:11], s28 offen offset:3072 lds
    v_mfma_f32_16x16x32_bf16 v[136:139], a[68:71], a[80:83], v[136:139]
    v_mfma_f32_16x16x32_bf16 v[140:143], a[72:75], a[80:83], v[140:143]
    v_mfma_f32_16x16x32_bf16 v[172:175], a[72:75], a[84:87], v[172:175]
    v_mfma_f32_16x16x32_bf16 v[204:207], a[72:75], a[88:91], v[204:207]
    v_mfma_f32_16x16x32_bf16 v[236:239], a[72:75], a[92:95], v[236:239]
    v_mfma_f32_16x16x32_bf16 v[240:243], a[76:79], a[92:95], v[240:243]
    v_mfma_f32_16x16x32_bf16 v[208:211], a[76:79], a[88:91], v[208:211]
    v_mfma_f32_16x16x32_bf16 v[176:179], a[76:79], a[84:87], v[176:179]
    v_mfma_f32_16x16x32_bf16 v[144:147], a[76:79], a[80:83], v[144:147]
    s_waitcnt lgkmcnt(0)
    v_mfma_f32_16x16x32_bf16 v[100:103], a[0:3], v[32:35], v[100:103]
    ds_read_b64_tr_b16 a[48:49], v50 offset:8192
    v_mfma_f32_16x16x32_bf16 v[104:107], a[4:7], v[32:35], v[104:107]
    s_add_u32 s28, s28, 16384
    s_mov_b32 m0, s30
    ds_read_b64_tr_b16 a[50:51], v50 offset:9216
    v_mfma_f32_16x16x32_bf16 v[116:119], a[0:3], a[32:35], v[116:119]
    buffer_load_dwordx4 v17, s[12:15], s29 offen offset:0 lds
    v_mfma_f32_16x16x32_bf16 v[148:151], a[0:3], a[36:39], v[148:151]
    ds_read_b64_tr_b16 a[52:53], v51 offset:8192
    v_mfma_f32_16x16x32_bf16 v[180:183], a[0:3], a[40:43], v[180:183]
    ds_read_b64_tr_b16 a[54:55], v51 offset:9216
    v_mfma_f32_16x16x32_bf16 v[212:215], a[0:3], a[44:47], v[212:215]
    ds_read_b128 a[80:83], v49 offset:0
    v_mfma_f32_16x16x32_bf16 v[216:219], a[4:7], a[44:47], v[216:219]
    ds_read_b128 a[84:87], v49 offset:2048
    v_mfma_f32_16x16x32_bf16 v[184:187], a[4:7], a[40:43], v[184:187]
    ds_read_b128 a[88:91], v49 offset:4096
    v_mfma_f32_16x16x32_bf16 v[152:155], a[4:7], a[36:39], v[152:155]
    ds_read_b128 a[92:95], v49 offset:6144
    v_mfma_f32_16x16x32_bf16 v[120:123], a[4:7], a[32:35], v[120:123]
    buffer_load_dwordx4 v18, s[12:15], s29 offen offset:1024 lds
    v_mfma_f32_16x16x32_bf16 v[124:127], a[8:11], a[32:35], v[124:127]
    ds_read_b64_tr_b16 a[56:57], v52 offset:8192
    v_mfma_f32_16x16x32_bf16 v[156:159], a[8:11], a[36:39], v[156:159]
    ds_read_b64_tr_b16 a[58:59], v52 offset:9216
    v_mfma_f32_16x16x32_bf16 v[188:191], a[8:11], a[40:43], v[188:191]
    ds_read_b64_tr_b16 a[60:61], v53 offset:8192
    v_mfma_f32_16x16x32_bf16 v[220:223], a[8:11], a[44:47], v[220:223]
    ds_read_b64_tr_b16 a[62:63], v53 offset:9216
    v_mfma_f32_16x16x32_bf16 v[224:227], a[12:15], a[44:47], v[224:227]
    ds_read_b64_tr_b16 a[64:65], v54 offset:8192
    v_mfma_f32_16x16x32_bf16 v[192:195], a[12:15], a[40:43], v[192:195]
    s_waitcnt lgkmcnt(9)
    ds_read_b64_tr_b16 a[66:67], v54 offset:9216
    v_mfma_f32_16x16x32_bf16 v[100:103], a[48:51], v[32:35], v[100:103]
    ds_read_b64_tr_b16 a[68:69], v55 offset:8192
    v_mfma_f32_16x16x32_bf16 v[104:107], a[52:55], v[32:35], v[104:107]
    buffer_load_dwordx4 v17, s[12:15], s29 offen offset:2048 lds
    v_mfma_f32_16x16x32_bf16 v[160:163], a[12:15], a[36:39], v[160:163]
    ds_read_b64_tr_b16 a[70:71], v55 offset:9216
    v_mfma_f32_16x16x32_bf16 v[128:131], a[12:15], a[32:35], v[128:131]
    ds_read_b64_tr_b16 a[72:73], v56 offset:8192
    v_mfma_f32_16x16x32_bf16 v[132:135], a[16:19], a[32:35], v[132:135]
    ds_read_b64_tr_b16 a[74:75], v56 offset:9216
    v_mfma_f32_16x16x32_bf16 v[164:167], a[16:19], a[36:39], v[164:167]
    ds_read_b64_tr_b16 a[76:77], v57 offset:8192
    v_mfma_f32_16x16x32_bf16 v[196:199], a[16:19], a[40:43], v[196:199]
    ds_read_b64_tr_b16 a[78:79], v57 offset:9216
    v_mfma_f32_16x16x32_bf16 v[228:231], a[16:19], a[44:47], v[228:231]
    ds_write_b128 v58, v[100:103] offset:0
    v_mfma_f32_16x16x32_bf16 v[232:235], a[20:23], a[44:47], v[232:235]
    buffer_load_dwordx4 v18, s[12:15], s29 offen offset:3072 lds
    v_mfma_f32_16x16x32_bf16 v[200:203], a[20:23], a[40:43], v[200:203]
    ds_write_b128 v58, v[104:107] offset:64
    v_mfma_f32_16x16x32_bf16 v[168:171], a[20:23], a[36:39], v[168:171]
    ds_write_b128 v58, v[100:103] offset:512
    v_mfma_f32_16x16x32_bf16 v[136:139], a[20:23], a[32:35], v[136:139]
    ds_write_b128 v58, v[104:107] offset:576
    v_mfma_f32_16x16x32_bf16 v[140:143], a[24:27], a[32:35], v[140:143]
    v_mfma_f32_16x16x32_bf16 v[172:175], a[24:27], a[36:39], v[172:175]
    v_mfma_f32_16x16x32_bf16 v[204:207], a[24:27], a[40:43], v[204:207]
    v_mfma_f32_16x16x32_bf16 v[236:239], a[24:27], a[44:47], v[236:239]
    v_mfma_f32_16x16x32_bf16 v[240:243], a[28:31], a[44:47], v[240:243]
    v_mfma_f32_16x16x32_bf16 v[208:211], a[28:31], a[40:43], v[208:211]
    v_mfma_f32_16x16x32_bf16 v[176:179], a[28:31], a[36:39], v[176:179]
    v_mfma_f32_16x16x32_bf16 v[144:147], a[28:31], a[32:35], v[144:147]
    s_add_u32 s29, s29, 16384
    s_waitcnt vmcnt(10) lgkmcnt(0)
    s_barrier
    v_mfma_f32_16x16x32_bf16 v[116:119], a[48:51], a[80:83], v[116:119]
    ds_read_b128 v[68:71], v58 offset:0
    v_mfma_f32_16x16x32_bf16 v[120:123], a[52:55], a[80:83], v[120:123]
    ds_read_b128 v[72:75], v58 offset:64
    v_mul_f32 v109, s44, v109
    v_mfma_f32_16x16x32_bf16 v[124:127], a[56:59], a[80:83], v[124:127]
    ds_read_b128 v[76:79], v58 offset:128
    v_mul_f32 v111, s44, v111
    v_mfma_f32_16x16x32_bf16 v[128:131], a[60:63], a[80:83], v[128:131]
    ds_read_b128 v[80:83], v58 offset:192
    v_mul_f32 v113, s44, v113
    v_mfma_f32_16x16x32_bf16 v[132:135], a[64:67], a[80:83], v[132:135]
    ds_read_b128 v[84:87], v58 offset:256
    v_mfma_f32_16x16x32_bf16 v[136:139], a[68:71], a[80:83], v[136:139]
    ds_read_b128 v[88:91], v58 offset:320
    v_mul_f32 v115, s44, v115
    v_mfma_f32_16x16x32_bf16 v[140:143], a[72:75], a[80:83], v[140:143]
    ds_read_b128 v[92:95], v58 offset:384
    v_and_b32 v253, 7, v19
    v_mfma_f32_16x16x32_bf16 v[144:147], a[76:79], a[80:83], v[144:147]
    ds_read_b128 v[96:99], v58 offset:448
    v_lshlrev_b32 v253, 5, v253
    v_mfma_f32_16x16x32_bf16 v[148:151], a[48:51], a[84:87], v[148:151]
    ds_read_b128 a[128:131], v1 offset:49152
    v_mfma_f32_16x16x32_bf16 v[152:155], a[52:55], a[84:87], v[152:155]
    ds_read_b128 a[132:135], v2 offset:49152
    v_mfma_f32_16x16x32_bf16 v[156:159], a[56:59], a[84:87], v[156:159]
    ds_read_b128 a[136:139], v3 offset:49152
    v_mfma_f32_16x16x32_bf16 v[160:163], a[60:63], a[84:87], v[160:163]
    ds_read_b128 a[140:143], v4 offset:49152
    v_mfma_f32_16x16x32_bf16 v[164:167], a[64:67], a[84:87], v[164:167]
    ds_read_b128 a[144:147], v1 offset:53248
    v_mfma_f32_16x16x32_bf16 v[168:171], a[68:71], a[84:87], v[168:171]
    ds_read_b128 a[148:151], v2 offset:53248
    v_mfma_f32_16x16x32_bf16 v[172:175], a[72:75], a[84:87], v[172:175]
    ds_read_b128 a[152:155], v3 offset:53248
    v_mfma_f32_16x16x32_bf16 v[176:179], a[76:79], a[84:87], v[176:179]
    ds_read_b128 a[156:159], v4 offset:53248
    buffer_load_dword v252, v253, s[92:95], 0 offen sc1
    s_waitcnt lgkmcnt(8)
    v_pk_fma_f32 v[116:117], v[108:109], v[68:69], v[116:117] op_sel_hi:[0,1,1] neg_lo:[1,0,0] neg_hi:[1,0,0]
    v_pk_fma_f32 v[118:119], v[108:109], v[70:71], v[118:119] op_sel_hi:[0,1,1] neg_lo:[1,0,0] neg_hi:[1,0,0]
    v_pk_fma_f32 v[120:121], v[108:109], v[72:73], v[120:121] op_sel_hi:[0,1,1] neg_lo:[1,0,0] neg_hi:[1,0,0]
    v_pk_fma_f32 v[122:123], v[108:109], v[74:75], v[122:123] op_sel_hi:[0,1,1] neg_lo:[1,0,0] neg_hi:[1,0,0]
    v_pk_fma_f32 v[124:125], v[108:109], v[76:77], v[124:125] op_sel_hi:[0,1,1] neg_lo:[1,0,0] neg_hi:[1,0,0]
    v_pk_fma_f32 v[126:127], v[108:109], v[78:79], v[126:127] op_sel_hi:[0,1,1] neg_lo:[1,0,0] neg_hi:[1,0,0]
    v_pk_fma_f32 v[128:129], v[108:109], v[80:81], v[128:129] op_sel_hi:[0,1,1] neg_lo:[1,0,0] neg_hi:[1,0,0]
    v_pk_fma_f32 v[130:131], v[108:109], v[82:83], v[130:131] op_sel_hi:[0,1,1] neg_lo:[1,0,0] neg_hi:[1,0,0]
    v_pk_fma_f32 v[132:133], v[108:109], v[84:85], v[132:133] op_sel_hi:[0,1,1] neg_lo:[1,0,0] neg_hi:[1,0,0]
    v_pk_fma_f32 v[134:135], v[108:109], v[86:87], v[134:135] op_sel_hi:[0,1,1] neg_lo:[1,0,0] neg_hi:[1,0,0]
    v_pk_fma_f32 v[136:137], v[108:109], v[88:89], v[136:137] op_sel_hi:[0,1,1] neg_lo:[1,0,0] neg_hi:[1,0,0]
    v_pk_fma_f32 v[138:139], v[108:109], v[90:91], v[138:139] op_sel_hi:[0,1,1] neg_lo:[1,0,0] neg_hi:[1,0,0]
    v_pk_fma_f32 v[140:141], v[108:109], v[92:93], v[140:141] op_sel_hi:[0,1,1] neg_lo:[1,0,0] neg_hi:[1,0,0]
    v_pk_fma_f32 v[142:143], v[108:109], v[94:95], v[142:143] op_sel_hi:[0,1,1] neg_lo:[1,0,0] neg_hi:[1,0,0]
    v_pk_fma_f32 v[144:145], v[108:109], v[96:97], v[144:145] op_sel_hi:[0,1,1] neg_lo:[1,0,0] neg_hi:[1,0,0]
    v_pk_fma_f32 v[146:147], v[108:109], v[98:99], v[146:147] op_sel_hi:[0,1,1] neg_lo:[1,0,0] neg_hi:[1,0,0]
    v_pk_mul_f32 v[116:117], v[116:117], v[108:109] op_sel:[0,1] op_sel_hi:[1,1]
    v_pk_mul_f32 v[118:119], v[118:119], v[108:109] op_sel:[0,1] op_sel_hi:[1,1]
    v_pk_mul_f32 v[120:121], v[120:121], v[108:109] op_sel:[0,1] op_sel_hi:[1,1]
    v_pk_mul_f32 v[122:123], v[122:123], v[108:109] op_sel:[0,1] op_sel_hi:[1,1]
    v_pk_mul_f32 v[124:125], v[124:125], v[108:109] op_sel:[0,1] op_sel_hi:[1,1]
    v_pk_mul_f32 v[126:127], v[126:127], v[108:109] op_sel:[0,1] op_sel_hi:[1,1]
    v_pk_mul_f32 v[128:129], v[128:129], v[108:109] op_sel:[0,1] op_sel_hi:[1,1]
    v_pk_mul_f32 v[130:131], v[130:131], v[108:109] op_sel:[0,1] op_sel_hi:[1,1]
    v_pk_mul_f32 v[132:133], v[132:133], v[108:109] op_sel:[0,1] op_sel_hi:[1,1]
    v_pk_mul_f32 v[134:135], v[134:135], v[108:109] op_sel:[0,1] op_sel_hi:[1,1]
    v_pk_mul_f32 v[136:137], v[136:137], v[108:109] op_sel:[0,1] op_sel_hi:[1,1]
    v_pk_mul_f32 v[138:139], v[138:139], v[108:109] op_sel:[0,1] op_sel_hi:[1,1]
    v_pk_mul_f32 v[140:141], v[140:141], v[108:109] op_sel:[0,1] op_sel_hi:[1,1]
    v_pk_mul_f32 v[142:143], v[142:143], v[108:109] op_sel:[0,1] op_sel_hi:[1,1]
    v_pk_mul_f32 v[144:145], v[144:145], v[108:109] op_sel:[0,1] op_sel_hi:[1,1]
    v_pk_mul_f32 v[146:147], v[146:147], v[108:109] op_sel:[0,1] op_sel_hi:[1,1]
    v_mfma_f32_16x16x32_bf16 v[180:183], a[48:51], a[88:91], v[180:183]
    ds_read_b128 a[160:163], v1 offset:57344
    v_cvt_pk_bf16_f32 v36, v116, v117
    v_cvt_pk_bf16_f32 v37, v118, v119
    v_cvt_pk_bf16_f32 v38, v120, v121
    v_cvt_pk_bf16_f32 v39, v122, v123
    v_mfma_f32_16x16x32_bf16 v[184:187], a[52:55], a[88:91], v[184:187]
    ds_read_b128 a[164:167], v2 offset:57344
    v_cvt_pk_bf16_f32 v40, v124, v125
    v_cvt_pk_bf16_f32 v41, v126, v127
    v_cvt_pk_bf16_f32 v42, v128, v129
    v_cvt_pk_bf16_f32 v43, v130, v131
    v_mfma_f32_16x16x32_bf16 v[188:191], a[56:59], a[88:91], v[188:191]
    ds_read_b128 a[168:171], v3 offset:57344
    v_cvt_pk_bf16_f32 v44, v132, v133
    v_cvt_pk_bf16_f32 v45, v134, v135
    v_cvt_pk_bf16_f32 v46, v136, v137
    v_cvt_pk_bf16_f32 v47, v138, v139
    v_mfma_f32_16x16x32_bf16 v[192:195], a[60:63], a[88:91], v[192:195]
    ds_read_b128 a[172:175], v4 offset:57344
    v_cvt_pk_bf16_f32 v48, v140, v141
    v_cvt_pk_bf16_f32 v49, v142, v143
    v_cvt_pk_bf16_f32 v50, v144, v145
    v_cvt_pk_bf16_f32 v51, v146, v147
    v_mfma_f32_16x16x32_bf16 v[196:199], a[64:67], a[88:91], v[196:199]
    ds_read_b128 a[176:179], v1 offset:61440
    v_permlane32_swap_b32 v36, v38
    v_permlane32_swap_b32 v37, v39
    v_permlane32_swap_b32 v40, v42
    v_permlane32_swap_b32 v41, v43
    v_mfma_f32_16x16x32_bf16 v[200:203], a[68:71], a[88:91], v[200:203]
    ds_read_b128 a[180:183], v2 offset:61440
    v_permlane32_swap_b32 v44, v46
    v_permlane32_swap_b32 v45, v47
    v_permlane32_swap_b32 v48, v50
    v_permlane32_swap_b32 v49, v51
    v_mfma_f32_16x16x32_bf16 v[204:207], a[72:75], a[88:91], v[204:207]
    ds_read_b128 a[184:187], v3 offset:61440
    v_permlane16_swap_b32 v36, v38
    v_permlane16_swap_b32 v37, v39
    v_permlane16_swap_b32 v40, v42
    v_permlane16_swap_b32 v41, v43
    v_mfma_f32_16x16x32_bf16 v[208:211], a[76:79], a[88:91], v[208:211]
    ds_read_b128 a[188:191], v4 offset:61440
    v_permlane16_swap_b32 v44, v46
    v_permlane16_swap_b32 v45, v47
    v_permlane16_swap_b32 v48, v50
    v_permlane16_swap_b32 v49, v51
    v_pk_fma_f32 v[148:149], v[110:111], v[68:69], v[148:149] op_sel_hi:[0,1,1] neg_lo:[1,0,0] neg_hi:[1,0,0]
    v_pk_fma_f32 v[150:151], v[110:111], v[70:71], v[150:151] op_sel_hi:[0,1,1] neg_lo:[1,0,0] neg_hi:[1,0,0]
    v_pk_fma_f32 v[152:153], v[110:111], v[72:73], v[152:153] op_sel_hi:[0,1,1] neg_lo:[1,0,0] neg_hi:[1,0,0]
    v_pk_fma_f32 v[154:155], v[110:111], v[74:75], v[154:155] op_sel_hi:[0,1,1] neg_lo:[1,0,0] neg_hi:[1,0,0]
    v_pk_fma_f32 v[156:157], v[110:111], v[76:77], v[156:157] op_sel_hi:[0,1,1] neg_lo:[1,0,0] neg_hi:[1,0,0]
    v_pk_fma_f32 v[158:159], v[110:111], v[78:79], v[158:159] op_sel_hi:[0,1,1] neg_lo:[1,0,0] neg_hi:[1,0,0]
    v_pk_fma_f32 v[160:161], v[110:111], v[80:81], v[160:161] op_sel_hi:[0,1,1] neg_lo:[1,0,0] neg_hi:[1,0,0]
    v_pk_fma_f32 v[162:163], v[110:111], v[82:83], v[162:163] op_sel_hi:[0,1,1] neg_lo:[1,0,0] neg_hi:[1,0,0]
    v_pk_fma_f32 v[164:165], v[110:111], v[84:85], v[164:165] op_sel_hi:[0,1,1] neg_lo:[1,0,0] neg_hi:[1,0,0]
    v_pk_fma_f32 v[166:167], v[110:111], v[86:87], v[166:167] op_sel_hi:[0,1,1] neg_lo:[1,0,0] neg_hi:[1,0,0]
    v_pk_fma_f32 v[168:169], v[110:111], v[88:89], v[168:169] op_sel_hi:[0,1,1] neg_lo:[1,0,0] neg_hi:[1,0,0]
    v_pk_fma_f32 v[170:171], v[110:111], v[90:91], v[170:171] op_sel_hi:[0,1,1] neg_lo:[1,0,0] neg_hi:[1,0,0]
    v_pk_fma_f32 v[172:173], v[110:111], v[92:93], v[172:173] op_sel_hi:[0,1,1] neg_lo:[1,0,0] neg_hi:[1,0,0]
    v_pk_fma_f32 v[174:175], v[110:111], v[94:95], v[174:175] op_sel_hi:[0,1,1] neg_lo:[1,0,0] neg_hi:[1,0,0]
    v_pk_fma_f32 v[176:177], v[110:111], v[96:97], v[176:177] op_sel_hi:[0,1,1] neg_lo:[1,0,0] neg_hi:[1,0,0]
    v_pk_fma_f32 v[178:179], v[110:111], v[98:99], v[178:179] op_sel_hi:[0,1,1] neg_lo:[1,0,0] neg_hi:[1,0,0]
    v_pk_mul_f32 v[148:149], v[148:149], v[110:111] op_sel:[0,1] op_sel_hi:[1,1]
    v_pk_mul_f32 v[150:151], v[150:151], v[110:111] op_sel:[0,1] op_sel_hi:[1,1]
    v_pk_mul_f32 v[152:153], v[152:153], v[110:111] op_sel:[0,1] op_sel_hi:[1,1]
    v_pk_mul_f32 v[154:155], v[154:155], v[110:111] op_sel:[0,1] op_sel_hi:[1,1]
    v_pk_mul_f32 v[156:157], v[156:157], v[110:111] op_sel:[0,1] op_sel_hi:[1,1]
    v_pk_mul_f32 v[158:159], v[158:159], v[110:111] op_sel:[0,1] op_sel_hi:[1,1]
    v_pk_mul_f32 v[160:161], v[160:161], v[110:111] op_sel:[0,1] op_sel_hi:[1,1]
    v_pk_mul_f32 v[162:163], v[162:163], v[110:111] op_sel:[0,1] op_sel_hi:[1,1]
    v_pk_mul_f32 v[164:165], v[164:165], v[110:111] op_sel:[0,1] op_sel_hi:[1,1]
    v_pk_mul_f32 v[166:167], v[166:167], v[110:111] op_sel:[0,1] op_sel_hi:[1,1]
    v_pk_mul_f32 v[168:169], v[168:169], v[110:111] op_sel:[0,1] op_sel_hi:[1,1]
    v_pk_mul_f32 v[170:171], v[170:171], v[110:111] op_sel:[0,1] op_sel_hi:[1,1]
    v_pk_mul_f32 v[172:173], v[172:173], v[110:111] op_sel:[0,1] op_sel_hi:[1,1]
    v_pk_mul_f32 v[174:175], v[174:175], v[110:111] op_sel:[0,1] op_sel_hi:[1,1]
    v_pk_mul_f32 v[176:177], v[176:177], v[110:111] op_sel:[0,1] op_sel_hi:[1,1]
    v_pk_mul_f32 v[178:179], v[178:179], v[110:111] op_sel:[0,1] op_sel_hi:[1,1]
    v_mfma_f32_16x16x32_bf16 v[212:215], a[48:51], a[92:95], v[212:215]
    v_cvt_pk_bf16_f32 v52, v148, v149
    v_cvt_pk_bf16_f32 v53, v150, v151
    v_cvt_pk_bf16_f32 v54, v152, v153
    v_cvt_pk_bf16_f32 v55, v154, v155
    v_mfma_f32_16x16x32_bf16 v[216:219], a[52:55], a[92:95], v[216:219]
    v_cvt_pk_bf16_f32 v56, v156, v157
    v_cvt_pk_bf16_f32 v57, v158, v159
    v_cvt_pk_bf16_f32 v58, v160, v161
    v_cvt_pk_bf16_f32 v59, v162, v163
    v_mfma_f32_16x16x32_bf16 v[220:223], a[56:59], a[92:95], v[220:223]
    v_cvt_pk_bf16_f32 v60, v164, v165
    v_cvt_pk_bf16_f32 v61, v166, v167
    v_cvt_pk_bf16_f32 v62, v168, v169
    v_cvt_pk_bf16_f32 v63, v170, v171
    v_mfma_f32_16x16x32_bf16 v[224:227], a[60:63], a[92:95], v[224:227]
    v_cvt_pk_bf16_f32 v64, v172, v173
    v_cvt_pk_bf16_f32 v65, v174, v175
    v_cvt_pk_bf16_f32 v66, v176, v177
    v_cvt_pk_bf16_f32 v67, v178, v179
    v_mfma_f32_16x16x32_bf16 v[228:231], a[64:67], a[92:95], v[228:231]
    v_permlane32_swap_b32 v52, v54
    v_permlane32_swap_b32 v53, v55
    v_permlane32_swap_b32 v56, v58
    v_permlane32_swap_b32 v57, v59
    v_mfma_f32_16x16x32_bf16 v[232:235], a[68:71], a[92:95], v[232:235]
    v_permlane32_swap_b32 v60, v62
    v_permlane32_swap_b32 v61, v63
    v_permlane32_swap_b32 v64, v66
    v_permlane32_swap_b32 v65, v67
    v_mfma_f32_16x16x32_bf16 v[236:239], a[72:75], a[92:95], v[236:239]
    v_permlane16_swap_b32 v52, v54
    v_permlane16_swap_b32 v53, v55
    v_permlane16_swap_b32 v56, v58
    v_permlane16_swap_b32 v57, v59
    v_mfma_f32_16x16x32_bf16 v[240:243], a[76:79], a[92:95], v[240:243]
    v_permlane16_swap_b32 v60, v62
    v_permlane16_swap_b32 v61, v63
    v_permlane16_swap_b32 v64, v66
    v_permlane16_swap_b32 v65, v67
    v_pk_fma_f32 v[180:181], v[112:113], v[68:69], v[180:181] op_sel_hi:[0,1,1] neg_lo:[1,0,0] neg_hi:[1,0,0]
    v_pk_fma_f32 v[182:183], v[112:113], v[70:71], v[182:183] op_sel_hi:[0,1,1] neg_lo:[1,0,0] neg_hi:[1,0,0]
    v_pk_fma_f32 v[184:185], v[112:113], v[72:73], v[184:185] op_sel_hi:[0,1,1] neg_lo:[1,0,0] neg_hi:[1,0,0]
    v_pk_fma_f32 v[186:187], v[112:113], v[74:75], v[186:187] op_sel_hi:[0,1,1] neg_lo:[1,0,0] neg_hi:[1,0,0]
    v_pk_fma_f32 v[188:189], v[112:113], v[76:77], v[188:189] op_sel_hi:[0,1,1] neg_lo:[1,0,0] neg_hi:[1,0,0]
    v_pk_fma_f32 v[190:191], v[112:113], v[78:79], v[190:191] op_sel_hi:[0,1,1] neg_lo:[1,0,0] neg_hi:[1,0,0]
    v_pk_fma_f32 v[192:193], v[112:113], v[80:81], v[192:193] op_sel_hi:[0,1,1] neg_lo:[1,0,0] neg_hi:[1,0,0]
    v_pk_fma_f32 v[194:195], v[112:113], v[82:83], v[194:195] op_sel_hi:[0,1,1] neg_lo:[1,0,0] neg_hi:[1,0,0]
    v_pk_fma_f32 v[196:197], v[112:113], v[84:85], v[196:197] op_sel_hi:[0,1,1] neg_lo:[1,0,0] neg_hi:[1,0,0]
    v_pk_fma_f32 v[198:199], v[112:113], v[86:87], v[198:199] op_sel_hi:[0,1,1] neg_lo:[1,0,0] neg_hi:[1,0,0]
    v_pk_fma_f32 v[200:201], v[112:113], v[88:89], v[200:201] op_sel_hi:[0,1,1] neg_lo:[1,0,0] neg_hi:[1,0,0]
    v_pk_fma_f32 v[202:203], v[112:113], v[90:91], v[202:203] op_sel_hi:[0,1,1] neg_lo:[1,0,0] neg_hi:[1,0,0]
    v_pk_fma_f32 v[204:205], v[112:113], v[92:93], v[204:205] op_sel_hi:[0,1,1] neg_lo:[1,0,0] neg_hi:[1,0,0]
    v_pk_fma_f32 v[206:207], v[112:113], v[94:95], v[206:207] op_sel_hi:[0,1,1] neg_lo:[1,0,0] neg_hi:[1,0,0]
    v_pk_fma_f32 v[208:209], v[112:113], v[96:97], v[208:209] op_sel_hi:[0,1,1] neg_lo:[1,0,0] neg_hi:[1,0,0]
    v_pk_fma_f32 v[210:211], v[112:113], v[98:99], v[210:211] op_sel_hi:[0,1,1] neg_lo:[1,0,0] neg_hi:[1,0,0]
    v_pk_mul_f32 v[180:181], v[180:181], v[112:113] op_sel:[0,1] op_sel_hi:[1,1]
    v_pk_mul_f32 v[182:183], v[182:183], v[112:113] op_sel:[0,1] op_sel_hi:[1,1]
    v_pk_mul_f32 v[184:185], v[184:185], v[112:113] op_sel:[0,1] op_sel_hi:[1,1]
    v_pk_mul_f32 v[186:187], v[186:187], v[112:113] op_sel:[0,1] op_sel_hi:[1,1]
    v_pk_mul_f32 v[188:189], v[188:189], v[112:113] op_sel:[0,1] op_sel_hi:[1,1]
    v_pk_mul_f32 v[190:191], v[190:191], v[112:113] op_sel:[0,1] op_sel_hi:[1,1]
    v_pk_mul_f32 v[192:193], v[192:193], v[112:113] op_sel:[0,1] op_sel_hi:[1,1]
    v_pk_mul_f32 v[194:195], v[194:195], v[112:113] op_sel:[0,1] op_sel_hi:[1,1]
    v_pk_mul_f32 v[196:197], v[196:197], v[112:113] op_sel:[0,1] op_sel_hi:[1,1]
    v_pk_mul_f32 v[198:199], v[198:199], v[112:113] op_sel:[0,1] op_sel_hi:[1,1]
    v_pk_mul_f32 v[200:201], v[200:201], v[112:113] op_sel:[0,1] op_sel_hi:[1,1]
    v_pk_mul_f32 v[202:203], v[202:203], v[112:113] op_sel:[0,1] op_sel_hi:[1,1]
    v_pk_mul_f32 v[204:205], v[204:205], v[112:113] op_sel:[0,1] op_sel_hi:[1,1]
    v_pk_mul_f32 v[206:207], v[206:207], v[112:113] op_sel:[0,1] op_sel_hi:[1,1]
    v_pk_mul_f32 v[208:209], v[208:209], v[112:113] op_sel:[0,1] op_sel_hi:[1,1]
    v_pk_mul_f32 v[210:211], v[210:211], v[112:113] op_sel:[0,1] op_sel_hi:[1,1]
    v_pk_fma_f32 v[212:213], v[114:115], v[68:69], v[212:213] op_sel_hi:[0,1,1] neg_lo:[1,0,0] neg_hi:[1,0,0]
    v_pk_fma_f32 v[214:215], v[114:115], v[70:71], v[214:215] op_sel_hi:[0,1,1] neg_lo:[1,0,0] neg_hi:[1,0,0]
    v_pk_fma_f32 v[216:217], v[114:115], v[72:73], v[216:217] op_sel_hi:[0,1,1] neg_lo:[1,0,0] neg_hi:[1,0,0]
    v_pk_fma_f32 v[218:219], v[114:115], v[74:75], v[218:219] op_sel_hi:[0,1,1] neg_lo:[1,0,0] neg_hi:[1,0,0]
    v_pk_fma_f32 v[220:221], v[114:115], v[76:77], v[220:221] op_sel_hi:[0,1,1] neg_lo:[1,0,0] neg_hi:[1,0,0]
    v_pk_fma_f32 v[222:223], v[114:115], v[78:79], v[222:223] op_sel_hi:[0,1,1] neg_lo:[1,0,0] neg_hi:[1,0,0]
    v_pk_fma_f32 v[224:225], v[114:115], v[80:81], v[224:225] op_sel_hi:[0,1,1] neg_lo:[1,0,0] neg_hi:[1,0,0]
    v_pk_fma_f32 v[226:227], v[114:115], v[82:83], v[226:227] op_sel_hi:[0,1,1] neg_lo:[1,0,0] neg_hi:[1,0,0]
    v_pk_fma_f32 v[228:229], v[114:115], v[84:85], v[228:229] op_sel_hi:[0,1,1] neg_lo:[1,0,0] neg_hi:[1,0,0]
    v_pk_fma_f32 v[230:231], v[114:115], v[86:87], v[230:231] op_sel_hi:[0,1,1] neg_lo:[1,0,0] neg_hi:[1,0,0]
    v_pk_fma_f32 v[232:233], v[114:115], v[88:89], v[232:233] op_sel_hi:[0,1,1] neg_lo:[1,0,0] neg_hi:[1,0,0]
    v_pk_fma_f32 v[234:235], v[114:115], v[90:91], v[234:235] op_sel_hi:[0,1,1] neg_lo:[1,0,0] neg_hi:[1,0,0]
    v_pk_fma_f32 v[236:237], v[114:115], v[92:93], v[236:237] op_sel_hi:[0,1,1] neg_lo:[1,0,0] neg_hi:[1,0,0]
    v_pk_fma_f32 v[238:239], v[114:115], v[94:95], v[238:239] op_sel_hi:[0,1,1] neg_lo:[1,0,0] neg_hi:[1,0,0]
    v_pk_fma_f32 v[240:241], v[114:115], v[96:97], v[240:241] op_sel_hi:[0,1,1] neg_lo:[1,0,0] neg_hi:[1,0,0]
    v_pk_fma_f32 v[242:243], v[114:115], v[98:99], v[242:243] op_sel_hi:[0,1,1] neg_lo:[1,0,0] neg_hi:[1,0,0]
    s_waitcnt lgkmcnt(0)
    v_mfma_f32_16x16x32_bf16 v[116:119], a[128:131], v[36:39], 0
    v_cvt_pk_bf16_f32 v68, v180, v181
    v_cvt_pk_bf16_f32 v69, v182, v183
    v_cvt_pk_bf16_f32 v70, v184, v185
    v_cvt_pk_bf16_f32 v71, v186, v187
    v_mfma_f32_16x16x32_bf16 v[116:119], a[132:135], v[40:43], v[116:119]
    v_cvt_pk_bf16_f32 v72, v188, v189
    v_cvt_pk_bf16_f32 v73, v190, v191
    v_cvt_pk_bf16_f32 v74, v192, v193
    v_cvt_pk_bf16_f32 v75, v194, v195
    v_mfma_f32_16x16x32_bf16 v[116:119], a[136:139], v[44:47], v[116:119]
    v_cvt_pk_bf16_f32 v76, v196, v197
    v_cvt_pk_bf16_f32 v77, v198, v199
    v_cvt_pk_bf16_f32 v78, v200, v201
    v_cvt_pk_bf16_f32 v79, v202, v203
    v_mfma_f32_16x16x32_bf16 v[116:119], a[140:143], v[48:51], v[116:119]
    v_cvt_pk_bf16_f32 v80, v204, v205
    v_cvt_pk_bf16_f32 v81, v206, v207
    v_cvt_pk_bf16_f32 v82, v208, v209
    v_cvt_pk_bf16_f32 v83, v210, v211
    v_mfma_f32_16x16x32_bf16 v[132:135], a[144:147], v[36:39], 0
    v_permlane32_swap_b32 v68, v70
    v_permlane32_swap_b32 v69, v71
    v_permlane32_swap_b32 v72, v74
    v_permlane32_swap_b32 v73, v75
    v_mfma_f32_16x16x32_bf16 v[132:135], a[148:151], v[40:43], v[132:135]
    v_permlane32_swap_b32 v76, v78
    v_permlane32_swap_b32 v77, v79
    v_permlane32_swap_b32 v80, v82
    v_permlane32_swap_b32 v81, v83
    v_mfma_f32_16x16x32_bf16 v[132:135], a[152:155], v[44:47], v[132:135]
    v_permlane16_swap_b32 v68, v70
    v_permlane16_swap_b32 v69, v71
    v_permlane16_swap_b32 v72, v74
    v_permlane16_swap_b32 v73, v75
    v_mfma_f32_16x16x32_bf16 v[132:135], a[156:159], v[48:51], v[132:135]
    v_permlane16_swap_b32 v76, v78
    v_permlane16_swap_b32 v77, v79
    v_permlane16_swap_b32 v80, v82
    v_permlane16_swap_b32 v81, v83
    v_pk_mul_f32 v[212:213], v[212:213], v[114:115] op_sel:[0,1] op_sel_hi:[1,1]
    v_pk_mul_f32 v[214:215], v[214:215], v[114:115] op_sel:[0,1] op_sel_hi:[1,1]
    v_pk_mul_f32 v[216:217], v[216:217], v[114:115] op_sel:[0,1] op_sel_hi:[1,1]
    v_pk_mul_f32 v[218:219], v[218:219], v[114:115] op_sel:[0,1] op_sel_hi:[1,1]
    v_pk_mul_f32 v[220:221], v[220:221], v[114:115] op_sel:[0,1] op_sel_hi:[1,1]
    v_pk_mul_f32 v[222:223], v[222:223], v[114:115] op_sel:[0,1] op_sel_hi:[1,1]
    v_pk_mul_f32 v[224:225], v[224:225], v[114:115] op_sel:[0,1] op_sel_hi:[1,1]
    v_pk_mul_f32 v[226:227], v[226:227], v[114:115] op_sel:[0,1] op_sel_hi:[1,1]
    v_pk_mul_f32 v[228:229], v[228:229], v[114:115] op_sel:[0,1] op_sel_hi:[1,1]
    v_pk_mul_f32 v[230:231], v[230:231], v[114:115] op_sel:[0,1] op_sel_hi:[1,1]
    v_pk_mul_f32 v[232:233], v[232:233], v[114:115] op_sel:[0,1] op_sel_hi:[1,1]
    v_pk_mul_f32 v[234:235], v[234:235], v[114:115] op_sel:[0,1] op_sel_hi:[1,1]
    v_pk_mul_f32 v[236:237], v[236:237], v[114:115] op_sel:[0,1] op_sel_hi:[1,1]
    v_pk_mul_f32 v[238:239], v[238:239], v[114:115] op_sel:[0,1] op_sel_hi:[1,1]
    v_pk_mul_f32 v[240:241], v[240:241], v[114:115] op_sel:[0,1] op_sel_hi:[1,1]
    v_pk_mul_f32 v[242:243], v[242:243], v[114:115] op_sel:[0,1] op_sel_hi:[1,1]
    v_mfma_f32_16x16x32_bf16 v[120:123], a[140:143], v[64:67], 0
    v_cvt_pk_bf16_f32 v84, v212, v213
    v_cvt_pk_bf16_f32 v85, v214, v215
    v_cvt_pk_bf16_f32 v86, v216, v217
    v_cvt_pk_bf16_f32 v87, v218, v219
    v_mfma_f32_16x16x32_bf16 v[120:123], a[136:139], v[60:63], v[120:123]
    v_cvt_pk_bf16_f32 v88, v220, v221
    v_cvt_pk_bf16_f32 v89, v222, v223
    v_cvt_pk_bf16_f32 v90, v224, v225
    v_cvt_pk_bf16_f32 v91, v226, v227
    v_mfma_f32_16x16x32_bf16 v[120:123], a[132:135], v[56:59], v[120:123]
    v_cvt_pk_bf16_f32 v92, v228, v229
    v_cvt_pk_bf16_f32 v93, v230, v231
    v_cvt_pk_bf16_f32 v94, v232, v233
    v_cvt_pk_bf16_f32 v95, v234, v235
    v_mfma_f32_16x16x32_bf16 v[120:123], a[128:131], v[52:55], v[120:123]
    v_cvt_pk_bf16_f32 v96, v236, v237
    v_cvt_pk_bf16_f32 v97, v238, v239
    v_cvt_pk_bf16_f32 v98, v240, v241
    v_cvt_pk_bf16_f32 v99, v242, v243
    v_mfma_f32_16x16x32_bf16 v[136:139], a[156:159], v[64:67], 0
    v_permlane32_swap_b32 v84, v86
    v_permlane32_swap_b32 v85, v87
    v_permlane32_swap_b32 v88, v90
    v_permlane32_swap_b32 v89, v91
    v_mfma_f32_16x16x32_bf16 v[136:139], a[152:155], v[60:63], v[136:139]
    v_permlane32_swap_b32 v92, v94
    v_permlane32_swap_b32 v93, v95
    v_permlane32_swap_b32 v96, v98
    v_permlane32_swap_b32 v97, v99
    v_mfma_f32_16x16x32_bf16 v[136:139], a[148:151], v[56:59], v[136:139]
    v_permlane16_swap_b32 v84, v86
    v_permlane16_swap_b32 v85, v87
    v_permlane16_swap_b32 v88, v90
    v_permlane16_swap_b32 v89, v91
    v_mfma_f32_16x16x32_bf16 v[136:139], a[144:147], v[52:55], v[136:139]
    v_permlane16_swap_b32 v92, v94
    v_permlane16_swap_b32 v93, v95
    v_permlane16_swap_b32 v96, v98
    v_permlane16_swap_b32 v97, v99
    v_mfma_f32_16x16x32_bf16 v[124:127], a[128:131], v[68:71], 0
    v_max3_f32 v28, v116, v117, v118
    v_max3_f32 v30, v120, v121, v122
    v_mfma_f32_16x16x32_bf16 v[124:127], a[132:135], v[72:75], v[124:127]
    v_max3_f32 v29, v119, v132, v133
    v_max3_f32 v31, v123, v136, v137
    v_max3_f32 v28, v28, v134, v135
    v_mfma_f32_16x16x32_bf16 v[124:127], a[136:139], v[76:79], v[124:127]
    v_max3_f32 v30, v30, v138, v139
    v_max_f32 v28, v28, v29
    v_max_f32 v30, v30, v31
    v_mfma_f32_16x16x32_bf16 v[124:127], a[140:143], v[80:83], v[124:127]
    v_mov_b32 v29, v28
    v_mov_b32 v31, v30
    s_nop 0
    v_permlane32_swap_b32 v28, v29
    v_mfma_f32_16x16x32_bf16 v[140:143], a[144:147], v[68:71], 0
    v_permlane32_swap_b32 v30, v31
    v_max_f32 v28, v28, v29
    v_mfma_f32_16x16x32_bf16 v[140:143], a[148:151], v[72:75], v[140:143]
    v_max_f32 v30, v30, v31
    v_mov_b32 v29, v28
    v_mov_b32 v31, v30
    v_mfma_f32_16x16x32_bf16 v[140:143], a[152:155], v[76:79], v[140:143]
    v_permlane16_swap_b32 v28, v29
    v_permlane16_swap_b32 v30, v31
    v_max_f32 v28, v28, v29
    v_mfma_f32_16x16x32_bf16 v[140:143], a[156:159], v[80:83], v[140:143]
    v_max_f32 v30, v30, v31
    v_sub_f32 v100, 0, v28
    v_sub_f32 v104, 0, v30
    v_mfma_f32_16x16x32_bf16 v[128:131], a[140:143], v[96:99], 0
    v_sub_f32 v101, 0, v28
    v_sub_f32 v105, 0, v30
    v_mfma_f32_16x16x32_bf16 v[128:131], a[136:139], v[92:95], v[128:131]
    v_sub_f32 v102, 0, v28
    v_sub_f32 v106, 0, v30
    v_sub_f32 v103, 0, v28
    v_mfma_f32_16x16x32_bf16 v[128:131], a[132:135], v[88:91], v[128:131]
    v_sub_f32 v107, 0, v30
    v_sub_f32 v116, v116, v28
    v_sub_f32 v120, v120, v30
    v_mfma_f32_16x16x32_bf16 v[128:131], a[128:131], v[84:87], v[128:131]
    v_sub_f32 v117, v117, v28
    v_sub_f32 v121, v121, v30
    v_sub_f32 v118, v118, v28
    v_mfma_f32_16x16x32_bf16 v[144:147], a[156:159], v[96:99], 0
    v_sub_f32 v122, v122, v30
    v_sub_f32 v119, v119, v28
    v_mfma_f32_16x16x32_bf16 v[144:147], a[152:155], v[92:95], v[144:147]
    v_sub_f32 v123, v123, v30
    v_sub_f32 v132, v132, v28
    v_sub_f32 v136, v136, v30
    v_mfma_f32_16x16x32_bf16 v[144:147], a[148:151], v[88:91], v[144:147]
    v_sub_f32 v133, v133, v28
    v_sub_f32 v137, v137, v30
    v_sub_f32 v134, v134, v28
    v_mfma_f32_16x16x32_bf16 v[144:147], a[144:147], v[84:87], v[144:147]
    v_sub_f32 v138, v138, v30
    v_sub_f32 v135, v135, v28
    v_sub_f32 v139, v139, v30
    s_waitcnt vmcnt(9)
    s_barrier
    v_mfma_f32_16x16x32_bf16 v[148:151], a[160:163], v[36:39], v[100:103]
    s_add_u32 m0, s34, 0
    s_nop 0
    s_nop 0
    s_nop 0
    v_mfma_f32_16x16x32_bf16 v[148:151], a[164:167], v[40:43], v[148:151]
    ds_read_b128 a[128:131], v1 offset:16384
    s_nop 0
    v_max3_f32 v32, v124, v125, v126
    v_max3_f32 v34, v128, v129, v130
    v_mfma_f32_16x16x32_bf16 v[148:151], a[168:171], v[44:47], v[148:151]
    ds_read_b128 a[132:135], v2 offset:16384
    v_max3_f32 v33, v127, v140, v141
    v_max3_f32 v35, v131, v144, v145
    v_max3_f32 v32, v32, v142, v143
    v_mfma_f32_16x16x32_bf16 v[148:151], a[172:175], v[48:51], v[148:151]
    buffer_load_dwordx4 v13, s[8:11], s28 offen offset:0 lds
    v_max3_f32 v34, v34, v146, v147
    v_max_f32 v32, v32, v33
    v_max_f32 v34, v34, v35
    v_mfma_f32_16x16x32_bf16 v[152:155], a[172:175], v[64:67], v[104:107]
    v_mov_b32 v33, v32
    v_mov_b32 v35, v34
    s_nop 0
    v_permlane32_swap_b32 v32, v33
    v_mfma_f32_16x16x32_bf16 v[152:155], a[168:171], v[60:63], v[152:155]
    v_permlane32_swap_b32 v34, v35
    v_max_f32 v32, v32, v33
    v_max_f32 v34, v34, v35
    v_mfma_f32_16x16x32_bf16 v[152:155], a[164:167], v[56:59], v[152:155]
    v_mov_b32 v33, v32
    v_mov_b32 v35, v34
    s_nop 0
    v_permlane16_swap_b32 v32, v33
    v_mfma_f32_16x16x32_bf16 v[152:155], a[160:163], v[52:55], v[152:155]
    v_permlane16_swap_b32 v34, v35
    v_max_f32 v32, v32, v33
    v_max_f32 v34, v34, v35
    v_mfma_f32_16x16x32_bf16 v[164:167], a[176:179], v[36:39], v[100:103]
    v_sub_f32 v108, 0, v32
    v_sub_f32 v112, 0, v34
    v_sub_f32 v109, 0, v32
    v_mfma_f32_16x16x32_bf16 v[164:167], a[180:183], v[40:43], v[164:167]
    v_sub_f32 v113, 0, v34
    v_sub_f32 v110, 0, v32
    v_sub_f32 v114, 0, v34
    v_mfma_f32_16x16x32_bf16 v[164:167], a[184:187], v[44:47], v[164:167]
    v_sub_f32 v111, 0, v32
    v_sub_f32 v115, 0, v34
    v_sub_f32 v124, v124, v32
    v_mfma_f32_16x16x32_bf16 v[164:167], a[188:191], v[48:51], v[164:167]
    v_sub_f32 v128, v128, v34
    v_sub_f32 v125, v125, v32
    v_sub_f32 v129, v129, v34
    v_mfma_f32_16x16x32_bf16 v[168:171], a[188:191], v[64:67], v[104:107]
    v_sub_f32 v126, v126, v32
    v_sub_f32 v130, v130, v34
    v_sub_f32 v127, v127, v32
    v_mfma_f32_16x16x32_bf16 v[168:171], a[184:187], v[60:63], v[168:171]
    v_sub_f32 v131, v131, v34
    v_sub_f32 v140, v140, v32
    v_sub_f32 v144, v144, v34
    v_mfma_f32_16x16x32_bf16 v[168:171], a[180:183], v[56:59], v[168:171]
    v_sub_f32 v141, v141, v32
    v_sub_f32 v145, v145, v34
    v_sub_f32 v142, v142, v32
    v_mfma_f32_16x16x32_bf16 v[168:171], a[176:179], v[52:55], v[168:171]
    v_sub_f32 v146, v146, v34
    v_sub_f32 v143, v143, v32
    v_sub_f32 v147, v147, v34
    s_nop 0
    v_mfma_f32_16x16x32_bf16 v[156:159], a[160:163], v[68:71], v[108:111]
    ds_read_b128 a[136:139], v3 offset:16384
    v_mfma_f32_16x16x32_bf16 v[156:159], a[164:167], v[72:75], v[156:159]
    ds_read_b128 a[140:143], v4 offset:16384
    v_mfma_f32_16x16x32_bf16 v[156:159], a[168:171], v[76:79], v[156:159]
    buffer_load_dwordx4 v14, s[8:11], s28 offen offset:1024 lds
    v_mfma_f32_16x16x32_bf16 v[156:159], a[172:175], v[80:83], v[156:159]
    v_mfma_f32_16x16x32_bf16 v[160:163], a[172:175], v[96:99], v[112:115]
    v_mfma_f32_16x16x32_bf16 v[160:163], a[168:171], v[92:95], v[160:163]
    v_mfma_f32_16x16x32_bf16 v[160:163], a[164:167], v[88:91], v[160:163]
    v_mfma_f32_16x16x32_bf16 v[160:163], a[160:163], v[84:87], v[160:163]
    s_waitcnt lgkmcnt(2)
    v_mfma_f32_16x16x32_bf16 v[172:175], a[176:179], v[68:71], v[108:111]
    s_waitcnt vmcnt(2)
    ds_read_b128 a[144:147], v1 offset:20480
    v_exp_f32 v116, v116
    v_mfma_f32_16x16x32_bf16 v[172:175], a[180:183], v[72:75], v[172:175]
    ds_read_b128 a[148:151], v2 offset:20480
    v_exp_f32 v117, v117
    v_mfma_f32_16x16x32_bf16 v[172:175], a[184:187], v[76:79], v[172:175]
    v_cvt_pk_bf16_f32 v180, v116, v117
    v_exp_f32 v118, v118
    v_mfma_f32_16x16x32_bf16 v[172:175], a[188:191], v[80:83], v[172:175]
    v_exp_f32 v119, v119
    v_mfma_f32_16x16x32_bf16 v[176:179], a[188:191], v[96:99], v[112:115]
    v_cvt_pk_bf16_f32 v181, v118, v119
    v_exp_f32 v120, v120
    v_mfma_f32_16x16x32_bf16 v[176:179], a[184:187], v[92:95], v[176:179]
    v_exp_f32 v121, v121
    v_mfma_f32_16x16x32_bf16 v[176:179], a[180:183], v[88:91], v[176:179]
    buffer_load_dwordx4 v15, s[8:11], s28 offen offset:2048 lds
    v_cvt_pk_bf16_f32 v188, v120, v121
    v_exp_f32 v122, v122
    v_mfma_f32_16x16x32_bf16 v[176:179], a[176:179], v[84:87], v[176:179]
    s_waitcnt lgkmcnt(2)
    s_mov_b32 s43, m0
    s_add_u32 m0, s47, 0
    s_nop 0
    buffer_load_dwordx4 v20, s[96:99], 0 offen lds
    s_mov_b32 m0, s43
    v_exp_f32 v123, v123
    v_mfma_f32_16x16x32_bf16 v[116:119], a[128:131], v[36:39], v[100:103]
    ds_read_b128 a[152:155], v3 offset:20480
    v_cvt_pk_bf16_f32 v189, v122, v123
    v_exp_f32 v124, v124
    v_mfma_f32_16x16x32_bf16 v[116:119], a[132:135], v[40:43], v[116:119]
    ds_read_b128 a[156:159], v4 offset:20480
    v_exp_f32 v125, v125
    v_mfma_f32_16x16x32_bf16 v[116:119], a[136:139], v[44:47], v[116:119]
    v_cvt_pk_bf16_f32 v196, v124, v125
    v_exp_f32 v126, v126
    v_cmp_gt_u32 vcc, 32, v252
    s_and_b64 vcc, vcc, exec
    s_cbranch_scc1 L_spin_all
L_back_all:
    v_mfma_f32_16x16x32_bf16 v[116:119], a[140:143], v[48:51], v[116:119]
    s_cmp_eq_u32 s6, 255
    s_cbranch_scc1 L_rt_keys
L_rt_back_keys:
    v_exp_f32 v127, v127
    v_mfma_f32_16x16x32_bf16 v[120:123], a[140:143], v[64:67], v[104:107]
    v_cvt_pk_bf16_f32 v197, v126, v127
    v_exp_f32 v128, v128
    v_mfma_f32_16x16x32_bf16 v[120:123], a[136:139], v[60:63], v[120:123]
    v_exp_f32 v129, v129
    v_mfma_f32_16x16x32_bf16 v[120:123], a[132:135], v[56:59], v[120:123]
    buffer_load_dwordx4 v16, s[8:11], s28 offen offset:3072 lds
    v_cvt_pk_bf16_f32 v204, v128, v129
    v_exp_f32 v130, v130
    v_mfma_f32_16x16x32_bf16 v[120:123], a[128:131], v[52:55], v[120:123]
    s_waitcnt lgkmcnt(2)
    s_mov_b32 s43, m0
    s_add_u32 m0, s47, 1024
    s_nop 0
    buffer_load_dwordx4 v21, s[96:99], 0 offen lds
    s_mov_b32 m0, s43
    v_exp_f32 v131, v131
    v_mfma_f32_16x16x32_bf16 v[124:127], a[128:131], v[68:71], v[108:111]
    ds_read_b128 a[160:163], v1 offset:24576
    v_cvt_pk_bf16_f32 v205, v130, v131
    v_exp_f32 v132, v132
    v_mfma_f32_16x16x32_bf16 v[124:127], a[132:135], v[72:75], v[124:127]
    ds_read_b128 a[164:167], v2 offset:24576
    v_exp_f32 v133, v133
    v_mfma_f32_16x16x32_bf16 v[124:127], a[136:139], v[76:79], v[124:127]
    v_cvt_pk_bf16_f32 v182, v132, v133
    v_exp_f32 v134, v134
    v_mfma_f32_16x16x32_bf16 v[124:127], a[140:143], v[80:83], v[124:127]
    v_exp_f32 v135, v135
    v_mfma_f32_16x16x32_bf16 v[128:131], a[140:143], v[96:99], v[112:115]
    v_cvt_pk_bf16_f32 v183, v134, v135
    v_exp_f32 v136, v136
    v_mfma_f32_16x16x32_bf16 v[128:131], a[136:139], v[92:95], v[128:131]
    s_add_u32 s28, s28, 16384
    s_mov_b32 m0, s31
    v_exp_f32 v137, v137
    v_mfma_f32_16x16x32_bf16 v[128:131], a[132:135], v[88:91], v[128:131]
    buffer_load_dwordx4 v17, s[12:15], s29 offen offset:0 lds
    v_cvt_pk_bf16_f32 v190, v136, v137
    v_exp_f32 v138, v138
    v_mfma_f32_16x16x32_bf16 v[128:131], a[128:131], v[84:87], v[128:131]
    s_waitcnt lgkmcnt(2)
    s_mov_b32 s43, m0
    s_add_u32 m0, s47, 2048
    s_nop 0
    buffer_load_dwordx4 v22, s[96:99], 0 offen lds
    s_mov_b32 m0, s43
    v_exp_f32 v139, v139
    v_mfma_f32_16x16x32_bf16 v[132:135], a[144:147], v[36:39], v[100:103]
    ds_read_b128 a[168:171], v3 offset:24576
    v_cvt_pk_bf16_f32 v191, v138, v139
    v_exp_f32 v140, v140
    v_mfma_f32_16x16x32_bf16 v[132:135], a[148:151], v[40:43], v[132:135]
    ds_read_b128 a[172:175], v4 offset:24576
    v_exp_f32 v141, v141
    v_mfma_f32_16x16x32_bf16 v[132:135], a[152:155], v[44:47], v[132:135]
    v_cvt_pk_bf16_f32 v198, v140, v141
    v_exp_f32 v142, v142
    v_mfma_f32_16x16x32_bf16 v[132:135], a[156:159], v[48:51], v[132:135]
    v_exp_f32 v143, v143
    v_mfma_f32_16x16x32_bf16 v[136:139], a[156:159], v[64:67], v[104:107]
    v_cvt_pk_bf16_f32 v199, v142, v143
    v_exp_f32 v144, v144
    v_mfma_f32_16x16x32_bf16 v[136:139], a[152:155], v[60:63], v[136:139]
    v_exp_f32 v145, v145
    v_mfma_f32_16x16x32_bf16 v[136:139], a[148:151], v[56:59], v[136:139]
    buffer_load_dwordx4 v18, s[12:15], s29 offen offset:1024 lds
    v_cvt_pk_bf16_f32 v206, v144, v145
    v_exp_f32 v146, v146
    v_mfma_f32_16x16x32_bf16 v[136:139], a[144:147], v[52:55], v[136:139]
    s_waitcnt lgkmcnt(2)
    s_mov_b32 s43, m0
    s_add_u32 m0, s47, 3072
    s_nop 0
    buffer_load_dwordx4 v23, s[96:99], 0 offen lds
    s_mov_b32 m0, s43
    v_exp_f32 v147, v147
    v_mfma_f32_16x16x32_bf16 v[140:143], a[144:147], v[68:71], v[108:111]
    ds_read_b128 a[176:179], v1 offset:28672
    v_cvt_pk_bf16_f32 v207, v146, v147
    v_exp_f32 v148, v148
    v_mfma_f32_16x16x32_bf16 v[140:143], a[148:151], v[72:75], v[140:143]
    ds_read_b128 a[180:183], v2 offset:28672
    v_exp_f32 v149, v149
    v_mfma_f32_16x16x32_bf16 v[140:143], a[152:155], v[76:79], v[140:143]
    v_cvt_pk_bf16_f32 v184, v148, v149
    v_exp_f32 v150, v150
    v_mfma_f32_16x16x32_bf16 v[140:143], a[156:159], v[80:83], v[140:143]
    v_exp_f32 v151, v151
    v_mfma_f32_16x16x32_bf16 v[144:147], a[156:159], v[96:99], v[112:115]
    v_cvt_pk_bf16_f32 v185, v150, v151
    v_exp_f32 v152, v152
    v_mfma_f32_16x16x32_bf16 v[144:147], a[152:155], v[92:95], v[144:147]
    v_exp_f32 v153, v153
    v_mfma_f32_16x16x32_bf16 v[144:147], a[148:151], v[88:91], v[144:147]
    buffer_load_dwordx4 v17, s[12:15], s29 offen offset:2048 lds
    v_cvt_pk_bf16_f32 v192, v152, v153
    v_exp_f32 v154, v154
    v_mfma_f32_16x16x32_bf16 v[144:147], a[144:147], v[84:87], v[144:147]
    s_waitcnt lgkmcnt(2)
    s_mov_b32 s43, m0
    s_add_u32 m0, s47, 4096
    s_nop 0
    buffer_load_dwordx4 v24, s[96:99], 0 offen lds
    s_mov_b32 m0, s43
    v_exp_f32 v155, v155
    v_mfma_f32_16x16x32_bf16 v[148:151], a[160:163], v[36:39], v[100:103]
    ds_read_b128 a[184:187], v3 offset:28672
    v_cvt_pk_bf16_f32 v193, v154, v155
    v_exp_f32 v156, v156
    v_mfma_f32_16x16x32_bf16 v[148:151], a[164:167], v[40:43], v[148:151]
    ds_read_b128 a[188:191], v4 offset:28672
    v_exp_f32 v157, v157
    v_mfma_f32_16x16x32_bf16 v[148:151], a[168:171], v[44:47], v[148:151]
    v_cvt_pk_bf16_f32 v200, v156, v157
    v_exp_f32 v158, v158
    v_mfma_f32_16x16x32_bf16 v[148:151], a[172:175], v[48:51], v[148:151]
    v_exp_f32 v159, v159
    v_mfma_f32_16x16x32_bf16 v[152:155], a[172:175], v[64:67], v[104:107]
    v_cvt_pk_bf16_f32 v201, v158, v159
    v_exp_f32 v160, v160
    v_mfma_f32_16x16x32_bf16 v[152:155], a[168:171], v[60:63], v[152:155]
    v_exp_f32 v161, v161
    v_mfma_f32_16x16x32_bf16 v[152:155], a[164:167], v[56:59], v[152:155]
    buffer_load_dwordx4 v18, s[12:15], s29 offen offset:3072 lds
    v_cvt_pk_bf16_f32 v208, v160, v161
    v_exp_f32 v162, v162
    v_mfma_f32_16x16x32_bf16 v[152:155], a[160:163], v[52:55], v[152:155]
    s_waitcnt vmcnt(14) lgkmcnt(2)
    s_barrier
    s_add_u32 s29, s29, 16384
    v_exp_f32 v163, v163
    v_mfma_f32_16x16x32_bf16 v[156:159], a[160:163], v[68:71], v[108:111]
    ds_read_b64_tr_b16 a[192:193], v5 offset:8192
    v_cvt_pk_bf16_f32 v209, v162, v163
    v_exp_f32 v164, v164
    v_mfma_f32_16x16x32_bf16 v[156:159], a[164:167], v[72:75], v[156:159]
    ds_read_b64_tr_b16 a[194:195], v5 offset:12288
    v_exp_f32 v165, v165
    v_mfma_f32_16x16x32_bf16 v[156:159], a[168:171], v[76:79], v[156:159]
    ds_read_b128 a[128:131], v1 offset:32768
    v_cvt_pk_bf16_f32 v186, v164, v165
    v_exp_f32 v166, v166
    v_mfma_f32_16x16x32_bf16 v[156:159], a[172:175], v[80:83], v[156:159]
    ds_read_b64_tr_b16 a[196:197], v5 offset:32768
    v_exp_f32 v167, v167
    v_mfma_f32_16x16x32_bf16 v[160:163], a[172:175], v[96:99], v[112:115]
    ds_read_b64_tr_b16 a[198:199], v5 offset:36864
    v_cvt_pk_bf16_f32 v187, v166, v167
    v_exp_f32 v168, v168
    v_mfma_f32_16x16x32_bf16 v[160:163], a[168:171], v[92:95], v[160:163]
    s_add_u32 m0, s34, 49152
    ds_read_b128 a[132:135], v2 offset:32768
    v_exp_f32 v169, v169
    v_mfma_f32_16x16x32_bf16 v[160:163], a[164:167], v[88:91], v[160:163]
    buffer_load_dwordx4 v13, s[8:11], s28 offen offset:0 lds
    v_cvt_pk_bf16_f32 v194, v168, v169
    v_exp_f32 v170, v170
    v_mfma_f32_16x16x32_bf16 v[160:163], a[160:163], v[84:87], v[160:163]
    s_waitcnt lgkmcnt(6)
    v_exp_f32 v171, v171
    v_mfma_f32_16x16x32_bf16 v[164:167], a[176:179], v[36:39], v[100:103]
    ds_read_b64_tr_b16 a[200:201], v6 offset:8192
    v_cvt_pk_bf16_f32 v195, v170, v171
    v_exp_f32 v172, v172
    v_mfma_f32_16x16x32_bf16 v[164:167], a[180:183], v[40:43], v[164:167]
    ds_read_b64_tr_b16 a[202:203], v6 offset:12288
    v_exp_f32 v173, v173
    v_mfma_f32_16x16x32_bf16 v[164:167], a[184:187], v[44:47], v[164:167]
    ds_read_b128 a[136:139], v3 offset:32768
    v_cvt_pk_bf16_f32 v202, v172, v173
    v_exp_f32 v174, v174
    v_mfma_f32_16x16x32_bf16 v[164:167], a[188:191], v[48:51], v[164:167]
    ds_read_b64_tr_b16 a[204:205], v6 offset:32768
    v_exp_f32 v175, v175
    v_mfma_f32_16x16x32_bf16 v[168:171], a[188:191], v[64:67], v[104:107]
    ds_read_b64_tr_b16 a[206:207], v6 offset:36864
    v_cvt_pk_bf16_f32 v203, v174, v175
    v_exp_f32 v176, v176
    v_mfma_f32_16x16x32_bf16 v[168:171], a[184:187], v[60:63], v[168:171]
    ds_read_b128 a[140:143], v4 offset:32768
    v_exp_f32 v177, v177
    v_mfma_f32_16x16x32_bf16 v[168:171], a[180:183], v[56:59], v[168:171]
    buffer_load_dwordx4 v14, s[8:11], s28 offen offset:1024 lds
    v_cvt_pk_bf16_f32 v210, v176, v177
    v_exp_f32 v178, v178
    v_mfma_f32_16x16x32_bf16 v[168:171], a[176:179], v[52:55], v[168:171]
    s_waitcnt lgkmcnt(6)
    v_exp_f32 v179, v179
    v_mfma_f32_16x16x32_bf16 v[172:175], a[176:179], v[68:71], v[108:111]
    s_mov_b32 s16, s62
    v_exp_f32 v116, v116
    v_mfma_f32_16x16x32_bf16 v[172:175], a[180:183], v[72:75], v[172:175]
    s_mov_b32 s17, s63
    ds_read_b64_tr_b16 a[208:209], v7 offset:8192
    v_cvt_pk_bf16_f32 v211, v178, v179
    v_mfma_f32_16x16x32_bf16 v[172:175], a[184:187], v[76:79], v[172:175]
    s_mov_b32 s18, 0x21c000
    v_exp_f32 v117, v117
    v_mfma_f32_16x16x32_bf16 v[172:175], a[188:191], v[80:83], v[172:175]
    s_mov_b32 s19, 0x20000
    ds_read_b64_tr_b16 a[210:211], v7 offset:12288
    v_mfma_f32_16x16x32_bf16 v[176:179], a[188:191], v[96:99], v[112:115]
    s_mov_b32 s20, s64
    v_exp_f32 v118, v118
    v_mfma_f32_16x16x32_bf16 v[176:179], a[184:187], v[92:95], v[176:179]
    s_mov_b32 s21, s65
    ds_read_b128 a[144:147], v1 offset:36864
    v_cvt_pk_bf16_f32 v212, v116, v117
    v_mfma_f32_16x16x32_bf16 v[176:179], a[180:183], v[88:91], v[176:179]
    s_mov_b32 s22, 0x21c000
    v_exp_f32 v119, v119
    v_mfma_f32_16x16x32_bf16 v[176:179], a[176:179], v[84:87], v[176:179]
    s_mov_b32 s23, 0x20000
    ds_read_b64_tr_b16 a[212:213], v7 offset:32768
    v_mfma_f32_16x16x32_bf16 a[0:3], a[192:195], v[180:183], 0
    s_mov_b32 s96, s66
    v_exp_f32 v120, v120
    v_mfma_f32_16x16x32_bf16 a[0:3], a[196:199], v[184:187], a[0:3]
    s_mov_b32 s97, s67
    ds_read_b64_tr_b16 a[214:215], v7 offset:36864
    v_cvt_pk_bf16_f32 v213, v118, v119
    v_mfma_f32_16x16x32_bf16 a[4:7], a[196:199], v[192:195], 0
    s_mov_b32 s98, 0x21c000
    v_exp_f32 v121, v121
    v_mfma_f32_16x16x32_bf16 a[4:7], a[192:195], v[188:191], a[4:7]
    s_mov_b32 s99, 0x20000
    ds_read_b128 a[148:151], v2 offset:36864
    v_cvt_pk_bf16_f32 v220, v120, v121
    v_mfma_f32_16x16x32_bf16 a[8:11], a[192:195], v[196:199], 0
    v_exp_f32 v122, v122
    v_mfma_f32_16x16x32_bf16 a[8:11], a[196:199], v[200:203], a[8:11]
    buffer_load_dwordx4 v15, s[8:11], s28 offen offset:2048 lds
    v_mfma_f32_16x16x32_bf16 a[12:15], a[196:199], v[208:211], 0
    v_exp_f32 v123, v123
    v_mfma_f32_16x16x32_bf16 a[12:15], a[192:195], v[204:207], a[12:15]
    s_waitcnt lgkmcnt(6)
    v_mul_u32_u24 v24, 3456, v19
    v_mfma_f32_16x16x32_bf16 v[116:119], a[128:131], v[36:39], v[100:103]
    s_lshl_b32 s40, s6, 4
    v_exp_f32 v124, v124
    v_mfma_f32_16x16x32_bf16 v[116:119], a[132:135], v[40:43], v[116:119]
    ds_read_b64_tr_b16 a[216:217], v8 offset:8192
    v_cvt_pk_bf16_f32 v221, v122, v123
    v_mfma_f32_16x16x32_bf16 v[116:119], a[136:139], v[44:47], v[116:119]
    v_exp_f32 v125, v125
    v_mfma_f32_16x16x32_bf16 v[116:119], a[140:143], v[48:51], v[116:119]
    ds_read_b64_tr_b16 a[218:219], v8 offset:12288
    v_add_u32 v24, s40, v24
    v_mfma_f32_16x16x32_bf16 v[120:123], a[140:143], v[64:67], v[104:107]
    s_cmp_ge_u32 s5, 2
    s_cselect_b32 s16, s20, s16
    s_cselect_b32 s17, s21, s17
    v_exp_f32 v126, v126
    v_mfma_f32_16x16x32_bf16 v[120:123], a[136:139], v[60:63], v[120:123]
    s_cmp_ge_u32 s6, 216
    s_cselect_b32 s18, 0, s18
    ds_read_b128 a[152:155], v3 offset:36864
    v_cvt_pk_bf16_f32 v228, v124, v125
    v_mfma_f32_16x16x32_bf16 v[120:123], a[132:135], v[56:59], v[120:123]
    s_and_b32 s40, s5, 1
    v_exp_f32 v127, v127
    v_mfma_f32_16x16x32_bf16 v[120:123], a[128:131], v[52:55], v[120:123]
    s_mul_i32 s37, s40, 1105920
    ds_read_b64_tr_b16 a[220:221], v8 offset:32768
    v_mfma_f32_16x16x32_bf16 a[16:19], a[200:203], v[180:183], 0
    s_mul_i32 s38, s5, 5120
    v_exp_f32 v128, v128
    v_mfma_f32_16x16x32_bf16 a[16:19], a[204:207], v[184:187], a[16:19]
    s_add_u32 s38, s38, 65536
    ds_read_b64_tr_b16 a[222:223], v8 offset:36864
    v_cvt_pk_bf16_f32 v229, v126, v127
    v_mfma_f32_16x16x32_bf16 a[20:23], a[204:207], v[192:195], 0
    s_mov_b32 s36, s5
    v_exp_f32 v129, v129
    v_mfma_f32_16x16x32_bf16 a[20:23], a[200:203], v[188:191], a[20:23]
    ds_read_b128 a[156:159], v4 offset:36864
    v_mfma_f32_16x16x32_bf16 a[24:27], a[200:203], v[196:199], 0
    v_exp_f32 v130, v130
    v_mfma_f32_16x16x32_bf16 a[24:27], a[204:207], v[200:203], a[24:27]
    v_cvt_pk_bf16_f32 v236, v128, v129
    v_mfma_f32_16x16x32_bf16 a[28:31], a[204:207], v[208:211], 0
    v_exp_f32 v131, v131
    v_mfma_f32_16x16x32_bf16 a[28:31], a[200:203], v[204:207], a[28:31]
    buffer_load_dwordx4 v16, s[8:11], s28 offen offset:3072 lds
    v_smfmac_f32_16x16x64_bf16 a[224:227], v[244:247], v[180:187], v248
    s_waitcnt lgkmcnt(6)
    v_mfma_f32_16x16x32_bf16 v[124:127], a[128:131], v[68:71], v[108:111]
    v_exp_f32 v132, v132
    v_mfma_f32_16x16x32_bf16 v[124:127], a[132:135], v[72:75], v[124:127]
    ds_read_b64_tr_b16 a[192:193], v9 offset:8192
    v_cvt_pk_bf16_f32 v237, v130, v131
    v_mfma_f32_16x16x32_bf16 v[124:127], a[136:139], v[76:79], v[124:127]
    v_exp_f32 v133, v133
    v_mfma_f32_16x16x32_bf16 v[124:127], a[140:143], v[80:83], v[124:127]
    ds_read_b64_tr_b16 a[194:195], v9 offset:12288
    v_mfma_f32_16x16x32_bf16 v[128:131], a[140:143], v[96:99], v[112:115]
    v_exp_f32 v134, v134
    v_mfma_f32_16x16x32_bf16 v[128:131], a[136:139], v[92:95], v[128:131]
    ds_read_b128 a[160:163], v1 offset:40960
    v_cvt_pk_bf16_f32 v214, v132, v133
    v_mfma_f32_16x16x32_bf16 v[128:131], a[132:135], v[88:91], v[128:131]
    v_exp_f32 v135, v135
    v_mfma_f32_16x16x32_bf16 v[128:131], a[128:131], v[84:87], v[128:131]
    ds_read_b64_tr_b16 a[196:197], v9 offset:32768
    v_mfma_f32_16x16x32_bf16 a[32:35], a[208:211], v[180:183], 0
    v_exp_f32 v136, v136
    v_mfma_f32_16x16x32_bf16 a[32:35], a[212:215], v[184:187], a[32:35]
    ds_read_b64_tr_b16 a[198:199], v9 offset:36864
    v_cvt_pk_bf16_f32 v215, v134, v135
    v_mfma_f32_16x16x32_bf16 a[36:39], a[212:215], v[192:195], 0
    v_exp_f32 v137, v137
    v_mfma_f32_16x16x32_bf16 a[36:39], a[208:211], v[188:191], a[36:39]
    ds_read_b128 a[164:167], v2 offset:40960
    v_cvt_pk_bf16_f32 v222, v136, v137
    v_mfma_f32_16x16x32_bf16 a[40:43], a[208:211], v[196:199], 0
    s_add_u32 s28, s28, 16384
    s_mov_b32 m0, s32
    v_exp_f32 v138, v138
    v_mfma_f32_16x16x32_bf16 a[40:43], a[212:215], v[200:203], a[40:43]
    buffer_load_dwordx4 v17, s[12:15], s29 offen offset:0 lds
    v_mfma_f32_16x16x32_bf16 a[44:47], a[212:215], v[208:211], 0
    v_exp_f32 v139, v139
    v_mfma_f32_16x16x32_bf16 a[44:47], a[208:211], v[204:207], a[44:47]
    s_waitcnt lgkmcnt(6)
    v_mfma_f32_16x16x32_bf16 v[132:135], a[144:147], v[36:39], v[100:103]
    s_waitcnt vmcnt(6)
    v_exp_f32 v140, v140
    v_mfma_f32_16x16x32_bf16 v[132:135], a[148:151], v[40:43], v[132:135]
    ds_read_b64_tr_b16 a[200:201], v10 offset:8192
    v_cvt_pk_bf16_f32 v223, v138, v139
    v_mfma_f32_16x16x32_bf16 v[132:135], a[152:155], v[44:47], v[132:135]
    v_exp_f32 v141, v141
    v_mfma_f32_16x16x32_bf16 v[132:135], a[156:159], v[48:51], v[132:135]
    ds_read_b64_tr_b16 a[202:203], v10 offset:12288
    v_mfma_f32_16x16x32_bf16 v[136:139], a[156:159], v[64:67], v[104:107]
    v_exp_f32 v142, v142
    v_mfma_f32_16x16x32_bf16 v[136:139], a[152:155], v[60:63], v[136:139]
    ds_read_b128 a[168:171], v3 offset:40960
    v_cvt_pk_bf16_f32 v230, v140, v141
    v_mfma_f32_16x16x32_bf16 v[136:139], a[148:151], v[56:59], v[136:139]
    v_exp_f32 v143, v143
    v_mfma_f32_16x16x32_bf16 v[136:139], a[144:147], v[52:55], v[136:139]
    ds_read_b64_tr_b16 a[204:205], v10 offset:32768
    v_mfma_f32_16x16x32_bf16 a[48:51], a[216:219], v[180:183], 0
    v_exp_f32 v144, v144
    v_mfma_f32_16x16x32_bf16 a[48:51], a[220:223], v[184:187], a[48:51]
    ds_read_b64_tr_b16 a[206:207], v10 offset:36864
    v_cvt_pk_bf16_f32 v231, v142, v143
    v_mfma_f32_16x16x32_bf16 a[52:55], a[220:223], v[192:195], 0
    v_exp_f32 v145, v145
    v_mfma_f32_16x16x32_bf16 a[52:55], a[216:219], v[188:191], a[52:55]
    ds_read_b128 a[172:175], v4 offset:40960
    ds_read_b64_tr_b16 a[240:241], v25 offset:0
    v_mfma_f32_16x16x32_bf16 a[56:59], a[216:219], v[196:199], 0
    v_exp_f32 v146, v146
    v_mfma_f32_16x16x32_bf16 a[56:59], a[220:223], v[200:203], a[56:59]
    ds_read_b64_tr_b16 a[242:243], v25 offset:2560
    v_cvt_pk_bf16_f32 v238, v144, v145
    v_mfma_f32_16x16x32_bf16 a[60:63], a[220:223], v[208:211], 0
    v_exp_f32 v147, v147
    v_mfma_f32_16x16x32_bf16 a[60:63], a[216:219], v[204:207], a[60:63]
    buffer_load_dwordx4 v18, s[12:15], s29 offen offset:1024 lds
    v_smfmac_f32_16x16x64_bf16 a[228:231], v[244:247], v[188:195], v248
    s_waitcnt lgkmcnt(6)
    ds_read_b64_tr_b16 a[244:245], v25 offset:32
    v_mfma_f32_16x16x32_bf16 v[140:143], a[144:147], v[68:71], v[108:111]
    s_cmp_eq_u32 s6, 255
    s_cbranch_scc1 L_rt_local
L_rt_back_local:
    v_exp_f32 v148, v148
    v_mfma_f32_16x16x32_bf16 v[140:143], a[148:151], v[72:75], v[140:143]
    ds_read_b64_tr_b16 a[208:209], v11 offset:8192
    v_cvt_pk_bf16_f32 v239, v146, v147
    v_mfma_f32_16x16x32_bf16 v[140:143], a[152:155], v[76:79], v[140:143]
    v_exp_f32 v149, v149
    v_mfma_f32_16x16x32_bf16 v[140:143], a[156:159], v[80:83], v[140:143]
    ds_read_b64_tr_b16 a[210:211], v11 offset:12288
    v_mfma_f32_16x16x32_bf16 v[144:147], a[156:159], v[96:99], v[112:115]
    v_exp_f32 v150, v150
    v_mfma_f32_16x16x32_bf16 v[144:147], a[152:155], v[92:95], v[144:147]
    ds_read_b128 a[176:179], v1 offset:45056
    v_cvt_pk_bf16_f32 v216, v148, v149
    v_mfma_f32_16x16x32_bf16 v[144:147], a[148:151], v[88:91], v[144:147]
    v_exp_f32 v151, v151
    v_mfma_f32_16x16x32_bf16 v[144:147], a[144:147], v[84:87], v[144:147]
    ds_read_b64_tr_b16 a[212:213], v11 offset:32768
    ds_read_b64_tr_b16 a[246:247], v25 offset:2592
    v_mfma_f32_16x16x32_bf16 a[64:67], a[192:195], v[180:183], 0
    v_exp_f32 v152, v152
    v_mfma_f32_16x16x32_bf16 a[64:67], a[196:199], v[184:187], a[64:67]
    ds_read_b64_tr_b16 a[214:215], v11 offset:36864
    v_cvt_pk_bf16_f32 v217, v150, v151
    v_mfma_f32_16x16x32_bf16 a[68:71], a[196:199], v[192:195], 0
    v_exp_f32 v153, v153
    v_mfma_f32_16x16x32_bf16 a[68:71], a[192:195], v[188:191], a[68:71]
    ds_read_b128 a[180:183], v2 offset:45056
    v_cvt_pk_bf16_f32 v224, v152, v153
    v_mfma_f32_16x16x32_bf16 a[72:75], a[192:195], v[196:199], 0
    v_exp_f32 v154, v154
    v_mfma_f32_16x16x32_bf16 a[72:75], a[196:199], v[200:203], a[72:75]
    buffer_load_dwordx4 v17, s[12:15], s29 offen offset:2048 lds
    v_mfma_f32_16x16x32_bf16 a[76:79], a[196:199], v[208:211], 0
    v_exp_f32 v155, v155
    v_mfma_f32_16x16x32_bf16 a[76:79], a[192:195], v[204:207], a[76:79]
    s_waitcnt lgkmcnt(6)
    ds_read_b64_tr_b16 a[248:249], v25 offset:64
    ds_read_b64_tr_b16 a[250:251], v25 offset:2624
    v_mfma_f32_16x16x32_bf16 v[148:151], a[160:163], v[36:39], v[100:103]
    v_exp_f32 v156, v156
    v_mfma_f32_16x16x32_bf16 v[148:151], a[164:167], v[40:43], v[148:151]
    ds_read_b64_tr_b16 a[216:217], v12 offset:8192
    v_cvt_pk_bf16_f32 v225, v154, v155
    v_mfma_f32_16x16x32_bf16 v[148:151], a[168:171], v[44:47], v[148:151]
    v_exp_f32 v157, v157
    v_mfma_f32_16x16x32_bf16 v[148:151], a[172:175], v[48:51], v[148:151]
    ds_read_b64_tr_b16 a[218:219], v12 offset:12288
    ds_read_b64_tr_b16 a[252:253], v25 offset:96
    v_mfma_f32_16x16x32_bf16 v[152:155], a[172:175], v[64:67], v[104:107]
    v_exp_f32 v158, v158
    v_mfma_f32_16x16x32_bf16 v[152:155], a[168:171], v[60:63], v[152:155]
    ds_read_b128 a[184:187], v3 offset:45056
    v_cvt_pk_bf16_f32 v232, v156, v157
    v_mfma_f32_16x16x32_bf16 v[152:155], a[164:167], v[56:59], v[152:155]
    v_exp_f32 v159, v159
    v_mfma_f32_16x16x32_bf16 v[152:155], a[160:163], v[52:55], v[152:155]
    ds_read_b64_tr_b16 a[220:221], v12 offset:32768
    ds_read_b64_tr_b16 a[254:255], v25 offset:2656
    v_mfma_f32_16x16x32_bf16 a[80:83], a[200:203], v[180:183], 0
    v_exp_f32 v160, v160
    v_mfma_f32_16x16x32_bf16 a[80:83], a[204:207], v[184:187], a[80:83]
    ds_read_b64_tr_b16 a[222:223], v12 offset:36864
    v_cvt_pk_bf16_f32 v233, v158, v159
    v_mfma_f32_16x16x32_bf16 a[84:87], a[204:207], v[192:195], 0
    v_exp_f32 v161, v161
    v_mfma_f32_16x16x32_bf16 a[84:87], a[200:203], v[188:191], a[84:87]
    ds_read_b128 a[188:191], v4 offset:45056
    v_mfma_f32_16x16x32_bf16 a[88:91], a[200:203], v[196:199], 0
    v_exp_f32 v162, v162
    v_mfma_f32_16x16x32_bf16 a[88:91], a[204:207], v[200:203], a[88:91]
    ds_read_b64_tr_b16 v[252:253], v25 offset:128
    v_cvt_pk_bf16_f32 v240, v160, v161
    v_mfma_f32_16x16x32_bf16 a[92:95], a[204:207], v[208:211], 0
    v_exp_f32 v163, v163
    v_mfma_f32_16x16x32_bf16 a[92:95], a[200:203], v[204:207], a[92:95]
    buffer_load_dwordx4 v18, s[12:15], s29 offen offset:3072 lds
    v_smfmac_f32_16x16x64_bf16 a[232:235], v[244:247], v[196:203], v248
    s_waitcnt vmcnt(8) lgkmcnt(6)
    s_barrier
    s_add_u32 s29, s29, 16384
    ds_read_b64_tr_b16 v[254:255], v25 offset:2688
    v_mfma_f32_16x16x32_bf16 v[156:159], a[160:163], v[68:71], v[108:111]
    v_exp_f32 v164, v164
    v_mfma_f32_16x16x32_bf16 v[156:159], a[164:167], v[72:75], v[156:159]
    ds_read_b64_tr_b16 a[192:193], v5 offset:16384
    v_cvt_pk_bf16_f32 v241, v162, v163
    v_mfma_f32_16x16x32_bf16 v[156:159], a[168:171], v[76:79], v[156:159]
    v_exp_f32 v165, v165
    v_mfma_f32_16x16x32_bf16 v[156:159], a[172:175], v[80:83], v[156:159]
    ds_read_b64_tr_b16 a[194:195], v5 offset:20480
    v_mfma_f32_16x16x32_bf16 v[160:163], a[172:175], v[96:99], v[112:115]
    v_exp_f32 v166, v166
    v_mfma_f32_16x16x32_bf16 v[160:163], a[168:171], v[92:95], v[160:163]
    ds_read_b128 a[128:131], v1 offset:0
    v_cvt_pk_bf16_f32 v218, v164, v165
    v_mfma_f32_16x16x32_bf16 v[160:163], a[164:167], v[88:91], v[160:163]
    v_exp_f32 v167, v167
    v_mfma_f32_16x16x32_bf16 v[160:163], a[160:163], v[84:87], v[160:163]
    ds_read_b64_tr_b16 a[196:197], v5 offset:40960
    v_mfma_f32_16x16x32_bf16 a[96:99], a[208:211], v[180:183], 0
    v_exp_f32 v168, v168
    v_mfma_f32_16x16x32_bf16 a[96:99], a[212:215], v[184:187], a[96:99]
    ds_read_b64_tr_b16 a[198:199], v5 offset:45056
    v_cvt_pk_bf16_f32 v219, v166, v167
    v_mfma_f32_16x16x32_bf16 a[100:103], a[212:215], v[192:195], 0
    v_exp_f32 v169, v169
    v_mfma_f32_16x16x32_bf16 a[100:103], a[208:211], v[188:191], a[100:103]
    ds_read_b128 a[132:135], v2 offset:0
    v_cvt_pk_bf16_f32 v226, v168, v169
    v_mfma_f32_16x16x32_bf16 a[104:107], a[208:211], v[196:199], 0
    s_add_u32 m0, s34, 16384
    v_exp_f32 v170, v170
    v_mfma_f32_16x16x32_bf16 a[104:107], a[212:215], v[200:203], a[104:107]
    buffer_load_dwordx4 v13, s[8:11], s28 offen offset:0 lds
    v_mfma_f32_16x16x32_bf16 a[108:111], a[212:215], v[208:211], 0
    v_exp_f32 v171, v171
    v_mfma_f32_16x16x32_bf16 a[108:111], a[208:211], v[204:207], a[108:111]
    s_waitcnt lgkmcnt(6)
    v_mfma_f32_16x16x32_bf16 v[164:167], a[176:179], v[36:39], v[100:103]
    s_cmp_eq_u32 s6, 255
    s_cbranch_scc1 L_rt_merge
L_rt_back_merge:
    v_exp_f32 v172, v172
    v_mfma_f32_16x16x32_bf16 v[164:167], a[180:183], v[40:43], v[164:167]
    ds_read_b64_tr_b16 a[200:201], v6 offset:16384
    v_cvt_pk_bf16_f32 v227, v170, v171
    v_mfma_f32_16x16x32_bf16 v[164:167], a[184:187], v[44:47], v[164:167]
    v_exp_f32 v173, v173
    v_mfma_f32_16x16x32_bf16 v[164:167], a[188:191], v[48:51], v[164:167]
    ds_read_b64_tr_b16 a[202:203], v6 offset:20480
    buffer_store_dwordx4 a[240:243], v26, s[76:79], 0 offen offset:0 sc1
    v_mfma_f32_16x16x32_bf16 v[168:171], a[188:191], v[64:67], v[104:107]
    v_exp_f32 v174, v174
    v_mfma_f32_16x16x32_bf16 v[168:171], a[184:187], v[60:63], v[168:171]
    ds_read_b128 a[136:139], v3 offset:0
    v_cvt_pk_bf16_f32 v234, v172, v173
    v_mfma_f32_16x16x32_bf16 v[168:171], a[180:183], v[56:59], v[168:171]
    buffer_store_dwordx4 a[244:247], v26, s[76:79], 0 offen offset:1024 sc1
    v_exp_f32 v175, v175
    v_mfma_f32_16x16x32_bf16 v[168:171], a[176:179], v[52:55], v[168:171]
    ds_read_b64_tr_b16 a[204:205], v6 offset:40960
    v_mfma_f32_16x16x32_bf16 a[112:115], a[216:219], v[180:183], 0
    v_exp_f32 v176, v176
    v_mfma_f32_16x16x32_bf16 a[112:115], a[220:223], v[184:187], a[112:115]
    ds_read_b64_tr_b16 a[206:207], v6 offset:45056
    v_cvt_pk_bf16_f32 v235, v174, v175
    v_mfma_f32_16x16x32_bf16 a[116:119], a[220:223], v[192:195], 0
    buffer_store_dwordx4 a[248:251], v26, s[76:79], 0 offen offset:2048 sc1
    v_exp_f32 v177, v177
    v_mfma_f32_16x16x32_bf16 a[116:119], a[216:219], v[188:191], a[116:119]
    ds_read_b128 a[140:143], v4 offset:0
    v_mfma_f32_16x16x32_bf16 a[120:123], a[216:219], v[196:199], 0
    v_exp_f32 v178, v178
    v_mfma_f32_16x16x32_bf16 a[120:123], a[220:223], v[200:203], a[120:123]
    buffer_store_dwordx4 a[252:255], v26, s[76:79], 0 offen offset:3072 sc1
    v_cvt_pk_bf16_f32 v242, v176, v177
    v_mfma_f32_16x16x32_bf16 a[124:127], a[220:223], v[208:211], 0
    v_exp_f32 v179, v179
    v_mfma_f32_16x16x32_bf16 a[124:127], a[216:219], v[204:207], a[124:127]
    buffer_load_dwordx4 v14, s[8:11], s28 offen offset:1024 lds
    v_smfmac_f32_16x16x64_bf16 a[236:239], v[244:247], v[204:211], v248
    s_waitcnt lgkmcnt(6)
    buffer_store_dwordx4 v[252:255], v26, s[76:79], s45 offen offset:0 sc1
    s_mov_b32 s35, 5
.p2align 6
L_attn_loop:
    v_mfma_f32_16x16x32_bf16 v[172:175], a[176:179], v[68:71], v[108:111]
    v_exp_f32 v116, v116
    v_mfma_f32_16x16x32_bf16 v[172:175], a[180:183], v[72:75], v[172:175]
    ds_read_b64_tr_b16 a[208:209], v7 offset:16384
    v_cvt_pk_bf16_f32 v243, v178, v179
    v_mfma_f32_16x16x32_bf16 v[172:175], a[184:187], v[76:79], v[172:175]
    v_exp_f32 v117, v117
    v_mfma_f32_16x16x32_bf16 v[172:175], a[188:191], v[80:83], v[172:175]
    ds_read_b64_tr_b16 a[210:211], v7 offset:20480
    v_mfma_f32_16x16x32_bf16 v[176:179], a[188:191], v[96:99], v[112:115]
    v_exp_f32 v118, v118
    v_mfma_f32_16x16x32_bf16 v[176:179], a[184:187], v[92:95], v[176:179]
    ds_read_b128 a[144:147], v1 offset:4096
    v_cvt_pk_bf16_f32 v180, v116, v117
    v_mfma_f32_16x16x32_bf16 v[176:179], a[180:183], v[88:91], v[176:179]
    v_exp_f32 v119, v119
    v_mfma_f32_16x16x32_bf16 v[176:179], a[176:179], v[84:87], v[176:179]
    ds_read_b64_tr_b16 a[212:213], v7 offset:40960
    v_mfma_f32_16x16x32_bf16 a[0:3], a[192:195], v[212:215], a[0:3]
    v_exp_f32 v120, v120
    v_mfma_f32_16x16x32_bf16 a[0:3], a[196:199], v[216:219], a[0:3]
    ds_read_b64_tr_b16 a[214:215], v7 offset:45056
    v_cvt_pk_bf16_f32 v181, v118, v119
    v_mfma_f32_16x16x32_bf16 a[4:7], a[196:199], v[224:227], a[4:7]
    v_exp_f32 v121, v121
    v_mfma_f32_16x16x32_bf16 a[4:7], a[192:195], v[220:223], a[4:7]
    ds_read_b128 a[148:151], v2 offset:4096
    v_cvt_pk_bf16_f32 v188, v120, v121
    v_mfma_f32_16x16x32_bf16 a[8:11], a[192:195], v[228:231], a[8:11]
    v_exp_f32 v122, v122
    v_mfma_f32_16x16x32_bf16 a[8:11], a[196:199], v[232:235], a[8:11]
    buffer_load_dwordx4 v15, s[8:11], s28 offen offset:2048 lds
    v_mfma_f32_16x16x32_bf16 a[12:15], a[196:199], v[240:243], a[12:15]
    v_exp_f32 v123, v123
    v_mfma_f32_16x16x32_bf16 a[12:15], a[192:195], v[236:239], a[12:15]
    s_waitcnt lgkmcnt(6)
    v_mfma_f32_16x16x32_bf16 v[116:119], a[128:131], v[36:39], v[100:103]
    v_exp_f32 v124, v124
    v_mfma_f32_16x16x32_bf16 v[116:119], a[132:135], v[40:43], v[116:119]
    ds_read_b64_tr_b16 a[216:217], v8 offset:16384
    v_cvt_pk_bf16_f32 v189, v122, v123
    v_mfma_f32_16x16x32_bf16 v[116:119], a[136:139], v[44:47], v[116:119]
    v_exp_f32 v125, v125
    v_mfma_f32_16x16x32_bf16 v[116:119], a[140:143], v[48:51], v[116:119]
    ds_read_b64_tr_b16 a[218:219], v8 offset:20480
    v_mfma_f32_16x16x32_bf16 v[120:123], a[140:143], v[64:67], v[104:107]
    v_exp_f32 v126, v126
    v_mfma_f32_16x16x32_bf16 v[120:123], a[136:139], v[60:63], v[120:123]
    ds_read_b128 a[152:155], v3 offset:4096
    v_cvt_pk_bf16_f32 v196, v124, v125
    v_mfma_f32_16x16x32_bf16 v[120:123], a[132:135], v[56:59], v[120:123]
    v_exp_f32 v127, v127
    v_mfma_f32_16x16x32_bf16 v[120:123], a[128:131], v[52:55], v[120:123]
    ds_read_b64_tr_b16 a[220:221], v8 offset:40960
    v_mfma_f32_16x16x32_bf16 a[16:19], a[200:203], v[212:215], a[16:19]
    v_exp_f32 v128, v128
    v_mfma_f32_16x16x32_bf16 a[16:19], a[204:207], v[216:219], a[16:19]
    ds_read_b64_tr_b16 a[222:223], v8 offset:45056
    v_cvt_pk_bf16_f32 v197, v126, v127
    v_mfma_f32_16x16x32_bf16 a[20:23], a[204:207], v[224:227], a[20:23]
    v_exp_f32 v129, v129
    v_mfma_f32_16x16x32_bf16 a[20:23], a[200:203], v[220:223], a[20:23]
    ds_read_b128 a[156:159], v4 offset:4096
    v_mfma_f32_16x16x32_bf16 a[24:27], a[200:203], v[228:231], a[24:27]
    v_exp_f32 v130, v130
    v_mfma_f32_16x16x32_bf16 a[24:27], a[204:207], v[232:235], a[24:27]
    v_cvt_pk_bf16_f32 v204, v128, v129
    v_mfma_f32_16x16x32_bf16 a[28:31], a[204:207], v[240:243], a[28:31]
    v_exp_f32 v131, v131
    v_mfma_f32_16x16x32_bf16 a[28:31], a[200:203], v[236:239], a[28:31]
    buffer_load_dwordx4 v16, s[8:11], s28 offen offset:3072 lds
    v_smfmac_f32_16x16x64_bf16 a[224:227], v[244:247], v[212:219], v248
    s_waitcnt lgkmcnt(6)
    v_mfma_f32_16x16x32_bf16 v[124:127], a[128:131], v[68:71], v[108:111]
    s_cmp_eq_u32 s36, 0
    s_cbranch_scc1 L_site0
L_site_back0:
    v_exp_f32 v132, v132
    v_mfma_f32_16x16x32_bf16 v[124:127], a[132:135], v[72:75], v[124:127]
    ds_read_b64_tr_b16 a[192:193], v9 offset:16384
    v_cvt_pk_bf16_f32 v205, v130, v131
    v_mfma_f32_16x16x32_bf16 v[124:127], a[136:139], v[76:79], v[124:127]
    v_exp_f32 v133, v133
    v_mfma_f32_16x16x32_bf16 v[124:127], a[140:143], v[80:83], v[124:127]
    ds_read_b64_tr_b16 a[194:195], v9 offset:20480
    v_mfma_f32_16x16x32_bf16 v[128:131], a[140:143], v[96:99], v[112:115]
    v_exp_f32 v134, v134
    v_mfma_f32_16x16x32_bf16 v[128:131], a[136:139], v[92:95], v[128:131]
    ds_read_b128 a[160:163], v1 offset:8192
    v_cvt_pk_bf16_f32 v182, v132, v133
    v_mfma_f32_16x16x32_bf16 v[128:131], a[132:135], v[88:91], v[128:131]
    v_exp_f32 v135, v135
    v_mfma_f32_16x16x32_bf16 v[128:131], a[128:131], v[84:87], v[128:131]
    ds_read_b64_tr_b16 a[196:197], v9 offset:40960
    v_mfma_f32_16x16x32_bf16 a[32:35], a[208:211], v[212:215], a[32:35]
    v_exp_f32 v136, v136
    v_mfma_f32_16x16x32_bf16 a[32:35], a[212:215], v[216:219], a[32:35]
    ds_read_b64_tr_b16 a[198:199], v9 offset:45056
    v_cvt_pk_bf16_f32 v183, v134, v135
    v_mfma_f32_16x16x32_bf16 a[36:39], a[212:215], v[224:227], a[36:39]
    v_exp_f32 v137, v137
    v_mfma_f32_16x16x32_bf16 a[36:39], a[208:211], v[220:223], a[36:39]
    ds_read_b128 a[164:167], v2 offset:8192
    v_cvt_pk_bf16_f32 v190, v136, v137
    v_mfma_f32_16x16x32_bf16 a[40:43], a[208:211], v[228:231], a[40:43]
    s_add_u32 s28, s28, 16384
    s_mov_b32 m0, s33
    v_exp_f32 v138, v138
    v_mfma_f32_16x16x32_bf16 a[40:43], a[212:215], v[232:235], a[40:43]
    buffer_load_dwordx4 v17, s[12:15], s29 offen offset:0 lds
    v_mfma_f32_16x16x32_bf16 a[44:47], a[212:215], v[240:243], a[44:47]
    v_exp_f32 v139, v139
    v_mfma_f32_16x16x32_bf16 a[44:47], a[208:211], v[236:239], a[44:47]
    s_waitcnt lgkmcnt(6)
    v_mfma_f32_16x16x32_bf16 v[132:135], a[144:147], v[36:39], v[100:103]
    v_exp_f32 v140, v140
    v_mfma_f32_16x16x32_bf16 v[132:135], a[148:151], v[40:43], v[132:135]
    ds_read_b64_tr_b16 a[200:201], v10 offset:16384
    v_cvt_pk_bf16_f32 v191, v138, v139
    v_mfma_f32_16x16x32_bf16 v[132:135], a[152:155], v[44:47], v[132:135]
    v_exp_f32 v141, v141
    v_mfma_f32_16x16x32_bf16 v[132:135], a[156:159], v[48:51], v[132:135]
    ds_read_b64_tr_b16 a[202:203], v10 offset:20480
    v_mfma_f32_16x16x32_bf16 v[136:139], a[156:159], v[64:67], v[104:107]
    v_exp_f32 v142, v142
    v_mfma_f32_16x16x32_bf16 v[136:139], a[152:155], v[60:63], v[136:139]
    ds_read_b128 a[168:171], v3 offset:8192
    v_cvt_pk_bf16_f32 v198, v140, v141
    v_mfma_f32_16x16x32_bf16 v[136:139], a[148:151], v[56:59], v[136:139]
    v_exp_f32 v143, v143
    v_mfma_f32_16x16x32_bf16 v[136:139], a[144:147], v[52:55], v[136:139]
    ds_read_b64_tr_b16 a[204:205], v10 offset:40960
    v_mfma_f32_16x16x32_bf16 a[48:51], a[216:219], v[212:215], a[48:51]
    v_exp_f32 v144, v144
    v_mfma_f32_16x16x32_bf16 a[48:51], a[220:223], v[216:219], a[48:51]
    ds_read_b64_tr_b16 a[206:207], v10 offset:45056
    v_cvt_pk_bf16_f32 v199, v142, v143
    v_mfma_f32_16x16x32_bf16 a[52:55], a[220:223], v[224:227], a[52:55]
    v_exp_f32 v145, v145
    v_mfma_f32_16x16x32_bf16 a[52:55], a[216:219], v[220:223], a[52:55]
    ds_read_b128 a[172:175], v4 offset:8192
    v_mfma_f32_16x16x32_bf16 a[56:59], a[216:219], v[228:231], a[56:59]
    v_exp_f32 v146, v146
    v_mfma_f32_16x16x32_bf16 a[56:59], a[220:223], v[232:235], a[56:59]
    v_cvt_pk_bf16_f32 v206, v144, v145
    v_mfma_f32_16x16x32_bf16 a[60:63], a[220:223], v[240:243], a[60:63]
    v_exp_f32 v147, v147
    v_mfma_f32_16x16x32_bf16 a[60:63], a[216:219], v[236:239], a[60:63]
    buffer_load_dwordx4 v18, s[12:15], s29 offen offset:1024 lds
    v_smfmac_f32_16x16x64_bf16 a[228:231], v[244:247], v[220:227], v248
    s_waitcnt lgkmcnt(6)
    v_mfma_f32_16x16x32_bf16 v[140:143], a[144:147], v[68:71], v[108:111]
    v_exp_f32 v148, v148
    v_mfma_f32_16x16x32_bf16 v[140:143], a[148:151], v[72:75], v[140:143]
    ds_read_b64_tr_b16 a[208:209], v11 offset:16384
    v_cvt_pk_bf16_f32 v207, v146, v147
    v_mfma_f32_16x16x32_bf16 v[140:143], a[152:155], v[76:79], v[140:143]
    v_exp_f32 v149, v149
    v_mfma_f32_16x16x32_bf16 v[140:143], a[156:159], v[80:83], v[140:143]
    ds_read_b64_tr_b16 a[210:211], v11 offset:20480
    v_mfma_f32_16x16x32_bf16 v[144:147], a[156:159], v[96:99], v[112:115]
    v_exp_f32 v150, v150
    v_mfma_f32_16x16x32_bf16 v[144:147], a[152:155], v[92:95], v[144:147]
    ds_read_b128 a[176:179], v1 offset:12288
    v_cvt_pk_bf16_f32 v184, v148, v149
    v_mfma_f32_16x16x32_bf16 v[144:147], a[148:151], v[88:91], v[144:147]
    v_exp_f32 v151, v151
    v_mfma_f32_16x16x32_bf16 v[144:147], a[144:147], v[84:87], v[144:147]
    ds_read_b64_tr_b16 a[212:213], v11 offset:40960
    v_mfma_f32_16x16x32_bf16 a[64:67], a[192:195], v[212:215], a[64:67]
    v_exp_f32 v152, v152
    v_mfma_f32_16x16x32_bf16 a[64:67], a[196:199], v[216:219], a[64:67]
    ds_read_b64_tr_b16 a[214:215], v11 offset:45056
    v_cvt_pk_bf16_f32 v185, v150, v151
    v_mfma_f32_16x16x32_bf16 a[68:71], a[196:199], v[224:227], a[68:71]
    v_exp_f32 v153, v153
    v_mfma_f32_16x16x32_bf16 a[68:71], a[192:195], v[220:223], a[68:71]
    ds_read_b128 a[180:183], v2 offset:12288
    v_cvt_pk_bf16_f32 v192, v152, v153
    v_mfma_f32_16x16x32_bf16 a[72:75], a[192:195], v[228:231], a[72:75]
    v_exp_f32 v154, v154
    v_mfma_f32_16x16x32_bf16 a[72:75], a[196:199], v[232:235], a[72:75]
    buffer_load_dwordx4 v17, s[12:15], s29 offen offset:2048 lds
    v_mfma_f32_16x16x32_bf16 a[76:79], a[196:199], v[240:243], a[76:79]
    v_exp_f32 v155, v155
    v_mfma_f32_16x16x32_bf16 a[76:79], a[192:195], v[236:239], a[76:79]
    s_waitcnt lgkmcnt(6)
    v_mfma_f32_16x16x32_bf16 v[148:151], a[160:163], v[36:39], v[100:103]
    v_exp_f32 v156, v156
    v_mfma_f32_16x16x32_bf16 v[148:151], a[164:167], v[40:43], v[148:151]
    ds_read_b64_tr_b16 a[216:217], v12 offset:16384
    v_cvt_pk_bf16_f32 v193, v154, v155
    v_mfma_f32_16x16x32_bf16 v[148:151], a[168:171], v[44:47], v[148:151]
    v_exp_f32 v157, v157
    v_mfma_f32_16x16x32_bf16 v[148:151], a[172:175], v[48:51], v[148:151]
    ds_read_b64_tr_b16 a[218:219], v12 offset:20480
    v_mfma_f32_16x16x32_bf16 v[152:155], a[172:175], v[64:67], v[104:107]
    v_exp_f32 v158, v158
    v_mfma_f32_16x16x32_bf16 v[152:155], a[168:171], v[60:63], v[152:155]
    ds_read_b128 a[184:187], v3 offset:12288
    v_cvt_pk_bf16_f32 v200, v156, v157
    v_mfma_f32_16x16x32_bf16 v[152:155], a[164:167], v[56:59], v[152:155]
    v_exp_f32 v159, v159
    v_mfma_f32_16x16x32_bf16 v[152:155], a[160:163], v[52:55], v[152:155]
    ds_read_b64_tr_b16 a[220:221], v12 offset:40960
    v_mfma_f32_16x16x32_bf16 a[80:83], a[200:203], v[212:215], a[80:83]
    v_exp_f32 v160, v160
    v_mfma_f32_16x16x32_bf16 a[80:83], a[204:207], v[216:219], a[80:83]
    ds_read_b64_tr_b16 a[222:223], v12 offset:45056
    v_cvt_pk_bf16_f32 v201, v158, v159
    v_mfma_f32_16x16x32_bf16 a[84:87], a[204:207], v[224:227], a[84:87]
    v_exp_f32 v161, v161
    v_mfma_f32_16x16x32_bf16 a[84:87], a[200:203], v[220:223], a[84:87]
    ds_read_b128 a[188:191], v4 offset:12288
    v_mfma_f32_16x16x32_bf16 a[88:91], a[200:203], v[228:231], a[88:91]
    v_exp_f32 v162, v162
    v_mfma_f32_16x16x32_bf16 a[88:91], a[204:207], v[232:235], a[88:91]
    v_cvt_pk_bf16_f32 v208, v160, v161
    v_mfma_f32_16x16x32_bf16 a[92:95], a[204:207], v[240:243], a[92:95]
    v_exp_f32 v163, v163
    v_mfma_f32_16x16x32_bf16 a[92:95], a[200:203], v[236:239], a[92:95]
    buffer_load_dwordx4 v18, s[12:15], s29 offen offset:3072 lds
    v_smfmac_f32_16x16x64_bf16 a[232:235], v[244:247], v[228:235], v248
    s_waitcnt vmcnt(8) lgkmcnt(6)
    s_barrier
    s_add_u32 s29, s29, 16384
    v_mfma_f32_16x16x32_bf16 v[156:159], a[160:163], v[68:71], v[108:111]
    v_exp_f32 v164, v164
    v_mfma_f32_16x16x32_bf16 v[156:159], a[164:167], v[72:75], v[156:159]
    ds_read_b64_tr_b16 a[192:193], v5 offset:57344
    v_cvt_pk_bf16_f32 v209, v162, v163
    v_mfma_f32_16x16x32_bf16 v[156:159], a[168:171], v[76:79], v[156:159]
    v_exp_f32 v165, v165
    v_mfma_f32_16x16x32_bf16 v[156:159], a[172:175], v[80:83], v[156:159]
    ds_read_b64_tr_b16 a[194:195], v5 offset:61440
    v_mfma_f32_16x16x32_bf16 v[160:163], a[172:175], v[96:99], v[112:115]
    v_exp_f32 v166, v166
    v_mfma_f32_16x16x32_bf16 v[160:163], a[168:171], v[92:95], v[160:163]
    ds_read_b128 a[128:131], v1 offset:49152
    v_cvt_pk_bf16_f32 v186, v164, v165
    v_mfma_f32_16x16x32_bf16 v[160:163], a[164:167], v[88:91], v[160:163]
    v_exp_f32 v167, v167
    v_mfma_f32_16x16x32_bf16 v[160:163], a[160:163], v[84:87], v[160:163]
    ds_read_b64_tr_b16 a[196:197], v5 offset:0
    v_mfma_f32_16x16x32_bf16 a[96:99], a[208:211], v[212:215], a[96:99]
    v_exp_f32 v168, v168
    v_mfma_f32_16x16x32_bf16 a[96:99], a[212:215], v[216:219], a[96:99]
    ds_read_b64_tr_b16 a[198:199], v5 offset:4096
    v_cvt_pk_bf16_f32 v187, v166, v167
    v_mfma_f32_16x16x32_bf16 a[100:103], a[212:215], v[224:227], a[100:103]
    v_exp_f32 v169, v169
    v_mfma_f32_16x16x32_bf16 a[100:103], a[208:211], v[220:223], a[100:103]
    ds_read_b128 a[132:135], v2 offset:49152
    v_cvt_pk_bf16_f32 v194, v168, v169
    v_mfma_f32_16x16x32_bf16 a[104:107], a[208:211], v[228:231], a[104:107]
    s_add_u32 m0, s34, 32768
    v_exp_f32 v170, v170
    v_mfma_f32_16x16x32_bf16 a[104:107], a[212:215], v[232:235], a[104:107]
    buffer_load_dwordx4 v13, s[8:11], s28 offen offset:0 lds
    v_mfma_f32_16x16x32_bf16 a[108:111], a[212:215], v[240:243], a[108:111]
    v_exp_f32 v171, v171
    v_mfma_f32_16x16x32_bf16 a[108:111], a[208:211], v[236:239], a[108:111]
    s_waitcnt lgkmcnt(6)
    v_mfma_f32_16x16x32_bf16 v[164:167], a[176:179], v[36:39], v[100:103]
    v_exp_f32 v172, v172
    v_mfma_f32_16x16x32_bf16 v[164:167], a[180:183], v[40:43], v[164:167]
    ds_read_b64_tr_b16 a[200:201], v6 offset:57344
    v_cvt_pk_bf16_f32 v195, v170, v171
    v_mfma_f32_16x16x32_bf16 v[164:167], a[184:187], v[44:47], v[164:167]
    v_exp_f32 v173, v173
    v_mfma_f32_16x16x32_bf16 v[164:167], a[188:191], v[48:51], v[164:167]
    ds_read_b64_tr_b16 a[202:203], v6 offset:61440
    v_mfma_f32_16x16x32_bf16 v[168:171], a[188:191], v[64:67], v[104:107]
    v_exp_f32 v174, v174
    v_mfma_f32_16x16x32_bf16 v[168:171], a[184:187], v[60:63], v[168:171]
    ds_read_b128 a[136:139], v3 offset:49152
    v_cvt_pk_bf16_f32 v202, v172, v173
    v_mfma_f32_16x16x32_bf16 v[168:171], a[180:183], v[56:59], v[168:171]
    v_exp_f32 v175, v175
    v_mfma_f32_16x16x32_bf16 v[168:171], a[176:179], v[52:55], v[168:171]
    ds_read_b64_tr_b16 a[204:205], v6 offset:0
    v_mfma_f32_16x16x32_bf16 a[112:115], a[216:219], v[212:215], a[112:115]
    v_exp_f32 v176, v176
    v_mfma_f32_16x16x32_bf16 a[112:115], a[220:223], v[216:219], a[112:115]
    ds_read_b64_tr_b16 a[206:207], v6 offset:4096
    v_cvt_pk_bf16_f32 v203, v174, v175
    v_mfma_f32_16x16x32_bf16 a[116:119], a[220:223], v[224:227], a[116:119]
    v_exp_f32 v177, v177
    v_mfma_f32_16x16x32_bf16 a[116:119], a[216:219], v[220:223], a[116:119]
    ds_read_b128 a[140:143], v4 offset:49152
    v_mfma_f32_16x16x32_bf16 a[120:123], a[216:219], v[228:231], a[120:123]
    v_exp_f32 v178, v178
    v_mfma_f32_16x16x32_bf16 a[120:123], a[220:223], v[232:235], a[120:123]
    v_cvt_pk_bf16_f32 v210, v176, v177
    v_mfma_f32_16x16x32_bf16 a[124:127], a[220:223], v[240:243], a[124:127]
    v_exp_f32 v179, v179
    v_mfma_f32_16x16x32_bf16 a[124:127], a[216:219], v[236:239], a[124:127]
    buffer_load_dwordx4 v14, s[8:11], s28 offen offset:1024 lds
    v_smfmac_f32_16x16x64_bf16 a[236:239], v[244:247], v[236:243], v248
    s_waitcnt lgkmcnt(6)
    v_mfma_f32_16x16x32_bf16 v[172:175], a[176:179], v[68:71], v[108:111]
    v_exp_f32 v116, v116
    v_mfma_f32_16x16x32_bf16 v[172:175], a[180:183], v[72:75], v[172:175]
    ds_read_b64_tr_b16 a[208:209], v7 offset:57344
    v_cvt_pk_bf16_f32 v211, v178, v179
    v_mfma_f32_16x16x32_bf16 v[172:175], a[184:187], v[76:79], v[172:175]
    v_exp_f32 v117, v117
    v_mfma_f32_16x16x32_bf16 v[172:175], a[188:191], v[80:83], v[172:175]
    ds_read_b64_tr_b16 a[210:211], v7 offset:61440
    v_mfma_f32_16x16x32_bf16 v[176:179], a[188:191], v[96:99], v[112:115]
    v_exp_f32 v118, v118
    v_mfma_f32_16x16x32_bf16 v[176:179], a[184:187], v[92:95], v[176:179]
    ds_read_b128 a[144:147], v1 offset:53248
    v_cvt_pk_bf16_f32 v212, v116, v117
    v_mfma_f32_16x16x32_bf16 v[176:179], a[180:183], v[88:91], v[176:179]
    v_exp_f32 v119, v119
    v_mfma_f32_16x16x32_bf16 v[176:179], a[176:179], v[84:87], v[176:179]
    ds_read_b64_tr_b16 a[212:213], v7 offset:0
    v_mfma_f32_16x16x32_bf16 a[0:3], a[192:195], v[180:183], a[0:3]
    v_exp_f32 v120, v120
    v_mfma_f32_16x16x32_bf16 a[0:3], a[196:199], v[184:187], a[0:3]
    ds_read_b64_tr_b16 a[214:215], v7 offset:4096
    v_cvt_pk_bf16_f32 v213, v118, v119
    v_mfma_f32_16x16x32_bf16 a[4:7], a[196:199], v[192:195], a[4:7]
    v_exp_f32 v121, v121
    v_mfma_f32_16x16x32_bf16 a[4:7], a[192:195], v[188:191], a[4:7]
    ds_read_b128 a[148:151], v2 offset:53248
    v_cvt_pk_bf16_f32 v220, v120, v121
    v_mfma_f32_16x16x32_bf16 a[8:11], a[192:195], v[196:199], a[8:11]
    v_exp_f32 v122, v122
    v_mfma_f32_16x16x32_bf16 a[8:11], a[196:199], v[200:203], a[8:11]
    buffer_load_dwordx4 v15, s[8:11], s28 offen offset:2048 lds
    v_mfma_f32_16x16x32_bf16 a[12:15], a[196:199], v[208:211], a[12:15]
    v_exp_f32 v123, v123
    v_mfma_f32_16x16x32_bf16 a[12:15], a[192:195], v[204:207], a[12:15]
    s_waitcnt lgkmcnt(6)
    v_mfma_f32_16x16x32_bf16 v[116:119], a[128:131], v[36:39], v[100:103]
    v_exp_f32 v124, v124
    v_mfma_f32_16x16x32_bf16 v[116:119], a[132:135], v[40:43], v[116:119]
    ds_read_b64_tr_b16 a[216:217], v8 offset:57344
    v_cvt_pk_bf16_f32 v221, v122, v123
    v_mfma_f32_16x16x32_bf16 v[116:119], a[136:139], v[44:47], v[116:119]
    v_exp_f32 v125, v125
    v_mfma_f32_16x16x32_bf16 v[116:119], a[140:143], v[48:51], v[116:119]
    ds_read_b64_tr_b16 a[218:219], v8 offset:61440
    v_mfma_f32_16x16x32_bf16 v[120:123], a[140:143], v[64:67], v[104:107]
    v_exp_f32 v126, v126
    v_mfma_f32_16x16x32_bf16 v[120:123], a[136:139], v[60:63], v[120:123]
    ds_read_b128 a[152:155], v3 offset:53248
    v_cvt_pk_bf16_f32 v228, v124, v125
    v_mfma_f32_16x16x32_bf16 v[120:123], a[132:135], v[56:59], v[120:123]
    v_exp_f32 v127, v127
    v_mfma_f32_16x16x32_bf16 v[120:123], a[128:131], v[52:55], v[120:123]
    ds_read_b64_tr_b16 a[220:221], v8 offset:0
    v_mfma_f32_16x16x32_bf16 a[16:19], a[200:203], v[180:183], a[16:19]
    v_exp_f32 v128, v128
    v_mfma_f32_16x16x32_bf16 a[16:19], a[204:207], v[184:187], a[16:19]
    ds_read_b64_tr_b16 a[222:223], v8 offset:4096
    v_cvt_pk_bf16_f32 v229, v126, v127
    v_mfma_f32_16x16x32_bf16 a[20:23], a[204:207], v[192:195], a[20:23]
    v_exp_f32 v129, v129
    v_mfma_f32_16x16x32_bf16 a[20:23], a[200:203], v[188:191], a[20:23]
    ds_read_b128 a[156:159], v4 offset:53248
    v_mfma_f32_16x16x32_bf16 a[24:27], a[200:203], v[196:199], a[24:27]
    v_exp_f32 v130, v130
    v_mfma_f32_16x16x32_bf16 a[24:27], a[204:207], v[200:203], a[24:27]
    v_cvt_pk_bf16_f32 v236, v128, v129
    v_mfma_f32_16x16x32_bf16 a[28:31], a[204:207], v[208:211], a[28:31]
    v_exp_f32 v131, v131
    v_mfma_f32_16x16x32_bf16 a[28:31], a[200:203], v[204:207], a[28:31]
    buffer_load_dwordx4 v16, s[8:11], s28 offen offset:3072 lds
    v_smfmac_f32_16x16x64_bf16 a[224:227], v[244:247], v[180:187], v248
    s_waitcnt lgkmcnt(6)
    v_mfma_f32_16x16x32_bf16 v[124:127], a[128:131], v[68:71], v[108:111]
    s_cmp_eq_u32 s36, 1
    s_cbranch_scc1 L_site1
L_site_back1:
    v_exp_f32 v132, v132
    v_mfma_f32_16x16x32_bf16 v[124:127], a[132:135], v[72:75], v[124:127]
    ds_read_b64_tr_b16 a[192:193], v9 offset:57344
    v_cvt_pk_bf16_f32 v237, v130, v131
    v_mfma_f32_16x16x32_bf16 v[124:127], a[136:139], v[76:79], v[124:127]
    v_exp_f32 v133, v133
    v_mfma_f32_16x16x32_bf16 v[124:127], a[140:143], v[80:83], v[124:127]
    ds_read_b64_tr_b16 a[194:195], v9 offset:61440
    v_mfma_f32_16x16x32_bf16 v[128:131], a[140:143], v[96:99], v[112:115]
    v_exp_f32 v134, v134
    v_mfma_f32_16x16x32_bf16 v[128:131], a[136:139], v[92:95], v[128:131]
    ds_read_b128 a[160:163], v1 offset:57344
    v_cvt_pk_bf16_f32 v214, v132, v133
    v_mfma_f32_16x16x32_bf16 v[128:131], a[132:135], v[88:91], v[128:131]
    v_exp_f32 v135, v135
    v_mfma_f32_16x16x32_bf16 v[128:131], a[128:131], v[84:87], v[128:131]
    ds_read_b64_tr_b16 a[196:197], v9 offset:0
    v_mfma_f32_16x16x32_bf16 a[32:35], a[208:211], v[180:183], a[32:35]
    v_exp_f32 v136, v136
    v_mfma_f32_16x16x32_bf16 a[32:35], a[212:215], v[184:187], a[32:35]
    ds_read_b64_tr_b16 a[198:199], v9 offset:4096
    v_cvt_pk_bf16_f32 v215, v134, v135
    v_mfma_f32_16x16x32_bf16 a[36:39], a[212:215], v[192:195], a[36:39]
    v_exp_f32 v137, v137
    v_mfma_f32_16x16x32_bf16 a[36:39], a[208:211], v[188:191], a[36:39]
    ds_read_b128 a[164:167], v2 offset:57344
    v_cvt_pk_bf16_f32 v222, v136, v137
    v_mfma_f32_16x16x32_bf16 a[40:43], a[208:211], v[196:199], a[40:43]
    s_add_u32 s28, s28, 16384
    s_mov_b32 m0, s30
    v_exp_f32 v138, v138
    v_mfma_f32_16x16x32_bf16 a[40:43], a[212:215], v[200:203], a[40:43]
    buffer_load_dwordx4 v17, s[12:15], s29 offen offset:0 lds
    v_mfma_f32_16x16x32_bf16 a[44:47], a[212:215], v[208:211], a[44:47]
    v_exp_f32 v139, v139
    v_mfma_f32_16x16x32_bf16 a[44:47], a[208:211], v[204:207], a[44:47]
    s_waitcnt lgkmcnt(6)
    v_mfma_f32_16x16x32_bf16 v[132:135], a[144:147], v[36:39], v[100:103]
    v_exp_f32 v140, v140
    v_mfma_f32_16x16x32_bf16 v[132:135], a[148:151], v[40:43], v[132:135]
    ds_read_b64_tr_b16 a[200:201], v10 offset:57344
    v_cvt_pk_bf16_f32 v223, v138, v139
    v_mfma_f32_16x16x32_bf16 v[132:135], a[152:155], v[44:47], v[132:135]
    v_exp_f32 v141, v141
    v_mfma_f32_16x16x32_bf16 v[132:135], a[156:159], v[48:51], v[132:135]
    ds_read_b64_tr_b16 a[202:203], v10 offset:61440
    v_mfma_f32_16x16x32_bf16 v[136:139], a[156:159], v[64:67], v[104:107]
    v_exp_f32 v142, v142
    v_mfma_f32_16x16x32_bf16 v[136:139], a[152:155], v[60:63], v[136:139]
    ds_read_b128 a[168:171], v3 offset:57344
    v_cvt_pk_bf16_f32 v230, v140, v141
    v_mfma_f32_16x16x32_bf16 v[136:139], a[148:151], v[56:59], v[136:139]
    v_exp_f32 v143, v143
    v_mfma_f32_16x16x32_bf16 v[136:139], a[144:147], v[52:55], v[136:139]
    ds_read_b64_tr_b16 a[204:205], v10 offset:0
    v_mfma_f32_16x16x32_bf16 a[48:51], a[216:219], v[180:183], a[48:51]
    v_exp_f32 v144, v144
    v_mfma_f32_16x16x32_bf16 a[48:51], a[220:223], v[184:187], a[48:51]
    ds_read_b64_tr_b16 a[206:207], v10 offset:4096
    v_cvt_pk_bf16_f32 v231, v142, v143
    v_mfma_f32_16x16x32_bf16 a[52:55], a[220:223], v[192:195], a[52:55]
    v_exp_f32 v145, v145
    v_mfma_f32_16x16x32_bf16 a[52:55], a[216:219], v[188:191], a[52:55]
    ds_read_b128 a[172:175], v4 offset:57344
    v_mfma_f32_16x16x32_bf16 a[56:59], a[216:219], v[196:199], a[56:59]
    v_exp_f32 v146, v146
    v_mfma_f32_16x16x32_bf16 a[56:59], a[220:223], v[200:203], a[56:59]
    v_cvt_pk_bf16_f32 v238, v144, v145
    v_mfma_f32_16x16x32_bf16 a[60:63], a[220:223], v[208:211], a[60:63]
    v_exp_f32 v147, v147
    v_mfma_f32_16x16x32_bf16 a[60:63], a[216:219], v[204:207], a[60:63]
    buffer_load_dwordx4 v18, s[12:15], s29 offen offset:1024 lds
    v_smfmac_f32_16x16x64_bf16 a[228:231], v[244:247], v[188:195], v248
    s_waitcnt lgkmcnt(6)
    v_mfma_f32_16x16x32_bf16 v[140:143], a[144:147], v[68:71], v[108:111]
    v_exp_f32 v148, v148
    v_mfma_f32_16x16x32_bf16 v[140:143], a[148:151], v[72:75], v[140:143]
    ds_read_b64_tr_b16 a[208:209], v11 offset:57344
    v_cvt_pk_bf16_f32 v239, v146, v147
    v_mfma_f32_16x16x32_bf16 v[140:143], a[152:155], v[76:79], v[140:143]
    v_exp_f32 v149, v149
    v_mfma_f32_16x16x32_bf16 v[140:143], a[156:159], v[80:83], v[140:143]
    ds_read_b64_tr_b16 a[210:211], v11 offset:61440
    v_mfma_f32_16x16x32_bf16 v[144:147], a[156:159], v[96:99], v[112:115]
    v_exp_f32 v150, v150
    v_mfma_f32_16x16x32_bf16 v[144:147], a[152:155], v[92:95], v[144:147]
    ds_read_b128 a[176:179], v1 offset:61440
    v_cvt_pk_bf16_f32 v216, v148, v149
    v_mfma_f32_16x16x32_bf16 v[144:147], a[148:151], v[88:91], v[144:147]
    v_exp_f32 v151, v151
    v_mfma_f32_16x16x32_bf16 v[144:147], a[144:147], v[84:87], v[144:147]
    ds_read_b64_tr_b16 a[212:213], v11 offset:0
    v_mfma_f32_16x16x32_bf16 a[64:67], a[192:195], v[180:183], a[64:67]
    v_exp_f32 v152, v152
    v_mfma_f32_16x16x32_bf16 a[64:67], a[196:199], v[184:187], a[64:67]
    ds_read_b64_tr_b16 a[214:215], v11 offset:4096
    v_cvt_pk_bf16_f32 v217, v150, v151
    v_mfma_f32_16x16x32_bf16 a[68:71], a[196:199], v[192:195], a[68:71]
    v_exp_f32 v153, v153
    v_mfma_f32_16x16x32_bf16 a[68:71], a[192:195], v[188:191], a[68:71]
    ds_read_b128 a[180:183], v2 offset:61440
    v_cvt_pk_bf16_f32 v224, v152, v153
    v_mfma_f32_16x16x32_bf16 a[72:75], a[192:195], v[196:199], a[72:75]
    v_exp_f32 v154, v154
    v_mfma_f32_16x16x32_bf16 a[72:75], a[196:199], v[200:203], a[72:75]
    buffer_load_dwordx4 v17, s[12:15], s29 offen offset:2048 lds
    v_mfma_f32_16x16x32_bf16 a[76:79], a[196:199], v[208:211], a[76:79]
    v_exp_f32 v155, v155
    v_mfma_f32_16x16x32_bf16 a[76:79], a[192:195], v[204:207], a[76:79]
    s_waitcnt lgkmcnt(6)
    v_mfma_f32_16x16x32_bf16 v[148:151], a[160:163], v[36:39], v[100:103]
    v_exp_f32 v156, v156
    v_mfma_f32_16x16x32_bf16 v[148:151], a[164:167], v[40:43], v[148:151]
    ds_read_b64_tr_b16 a[216:217], v12 offset:57344
    v_cvt_pk_bf16_f32 v225, v154, v155
    v_mfma_f32_16x16x32_bf16 v[148:151], a[168:171], v[44:47], v[148:151]
    v_exp_f32 v157, v157
    v_mfma_f32_16x16x32_bf16 v[148:151], a[172:175], v[48:51], v[148:151]
    ds_read_b64_tr_b16 a[218:219], v12 offset:61440
    v_mfma_f32_16x16x32_bf16 v[152:155], a[172:175], v[64:67], v[104:107]
    v_exp_f32 v158, v158
    v_mfma_f32_16x16x32_bf16 v[152:155], a[168:171], v[60:63], v[152:155]
    ds_read_b128 a[184:187], v3 offset:61440
    v_cvt_pk_bf16_f32 v232, v156, v157
    v_mfma_f32_16x16x32_bf16 v[152:155], a[164:167], v[56:59], v[152:155]
    v_exp_f32 v159, v159
    v_mfma_f32_16x16x32_bf16 v[152:155], a[160:163], v[52:55], v[152:155]
    ds_read_b64_tr_b16 a[220:221], v12 offset:0
    v_mfma_f32_16x16x32_bf16 a[80:83], a[200:203], v[180:183], a[80:83]
    v_exp_f32 v160, v160
    v_mfma_f32_16x16x32_bf16 a[80:83], a[204:207], v[184:187], a[80:83]
    ds_read_b64_tr_b16 a[222:223], v12 offset:4096
    v_cvt_pk_bf16_f32 v233, v158, v159
    v_mfma_f32_16x16x32_bf16 a[84:87], a[204:207], v[192:195], a[84:87]
    v_exp_f32 v161, v161
    v_mfma_f32_16x16x32_bf16 a[84:87], a[200:203], v[188:191], a[84:87]
    ds_read_b128 a[188:191], v4 offset:61440
    v_mfma_f32_16x16x32_bf16 a[88:91], a[200:203], v[196:199], a[88:91]
    v_exp_f32 v162, v162
    v_mfma_f32_16x16x32_bf16 a[88:91], a[204:207], v[200:203], a[88:91]
    v_cvt_pk_bf16_f32 v240, v160, v161
    v_mfma_f32_16x16x32_bf16 a[92:95], a[204:207], v[208:211], a[92:95]
    v_exp_f32 v163, v163
    v_mfma_f32_16x16x32_bf16 a[92:95], a[200:203], v[204:207], a[92:95]
    buffer_load_dwordx4 v18, s[12:15], s29 offen offset:3072 lds
    v_smfmac_f32_16x16x64_bf16 a[232:235], v[244:247], v[196:203], v248
    s_waitcnt vmcnt(8) lgkmcnt(6)
    s_barrier
    s_add_u32 s29, s29, 16384
    v_mfma_f32_16x16x32_bf16 v[156:159], a[160:163], v[68:71], v[108:111]
    v_exp_f32 v164, v164
    v_mfma_f32_16x16x32_bf16 v[156:159], a[164:167], v[72:75], v[156:159]
    ds_read_b64_tr_b16 a[192:193], v5 offset:24576
    v_cvt_pk_bf16_f32 v241, v162, v163
    v_mfma_f32_16x16x32_bf16 v[156:159], a[168:171], v[76:79], v[156:159]
    v_exp_f32 v165, v165
    v_mfma_f32_16x16x32_bf16 v[156:159], a[172:175], v[80:83], v[156:159]
    ds_read_b64_tr_b16 a[194:195], v5 offset:28672
    v_mfma_f32_16x16x32_bf16 v[160:163], a[172:175], v[96:99], v[112:115]
    v_exp_f32 v166, v166
    v_mfma_f32_16x16x32_bf16 v[160:163], a[168:171], v[92:95], v[160:163]
    ds_read_b128 a[128:131], v1 offset:16384
    v_cvt_pk_bf16_f32 v218, v164, v165
    v_mfma_f32_16x16x32_bf16 v[160:163], a[164:167], v[88:91], v[160:163]
    v_exp_f32 v167, v167
    v_mfma_f32_16x16x32_bf16 v[160:163], a[160:163], v[84:87], v[160:163]
    ds_read_b64_tr_b16 a[196:197], v5 offset:49152
    v_mfma_f32_16x16x32_bf16 a[96:99], a[208:211], v[180:183], a[96:99]
    v_exp_f32 v168, v168
    v_mfma_f32_16x16x32_bf16 a[96:99], a[212:215], v[184:187], a[96:99]
    ds_read_b64_tr_b16 a[198:199], v5 offset:53248
    v_cvt_pk_bf16_f32 v219, v166, v167
    v_mfma_f32_16x16x32_bf16 a[100:103], a[212:215], v[192:195], a[100:103]
    v_exp_f32 v169, v169
    v_mfma_f32_16x16x32_bf16 a[100:103], a[208:211], v[188:191], a[100:103]
    ds_read_b128 a[132:135], v2 offset:16384
    v_cvt_pk_bf16_f32 v226, v168, v169
    v_mfma_f32_16x16x32_bf16 a[104:107], a[208:211], v[196:199], a[104:107]
    s_add_u32 m0, s34, 0
    v_exp_f32 v170, v170
    v_mfma_f32_16x16x32_bf16 a[104:107], a[212:215], v[200:203], a[104:107]
    buffer_load_dwordx4 v13, s[8:11], s28 offen offset:0 lds
    v_mfma_f32_16x16x32_bf16 a[108:111], a[212:215], v[208:211], a[108:111]
    v_exp_f32 v171, v171
    v_mfma_f32_16x16x32_bf16 a[108:111], a[208:211], v[204:207], a[108:111]
    s_waitcnt lgkmcnt(6)
    v_mfma_f32_16x16x32_bf16 v[164:167], a[176:179], v[36:39], v[100:103]
    s_cmp_eq_u32 s59, s35
    s_cbranch_scc1 L_once_pack
L_once_back_pack:
    v_exp_f32 v172, v172
    v_mfma_f32_16x16x32_bf16 v[164:167], a[180:183], v[40:43], v[164:167]
    ds_read_b64_tr_b16 a[200:201], v6 offset:24576
    v_cvt_pk_bf16_f32 v227, v170, v171
    v_mfma_f32_16x16x32_bf16 v[164:167], a[184:187], v[44:47], v[164:167]
    v_exp_f32 v173, v173
    v_mfma_f32_16x16x32_bf16 v[164:167], a[188:191], v[48:51], v[164:167]
    ds_read_b64_tr_b16 a[202:203], v6 offset:28672
    v_mfma_f32_16x16x32_bf16 v[168:171], a[188:191], v[64:67], v[104:107]
    v_exp_f32 v174, v174
    v_mfma_f32_16x16x32_bf16 v[168:171], a[184:187], v[60:63], v[168:171]
    ds_read_b128 a[136:139], v3 offset:16384
    v_cvt_pk_bf16_f32 v234, v172, v173
    v_mfma_f32_16x16x32_bf16 v[168:171], a[180:183], v[56:59], v[168:171]
    v_exp_f32 v175, v175
    v_mfma_f32_16x16x32_bf16 v[168:171], a[176:179], v[52:55], v[168:171]
    ds_read_b64_tr_b16 a[204:205], v6 offset:49152
    v_mfma_f32_16x16x32_bf16 a[112:115], a[216:219], v[180:183], a[112:115]
    v_exp_f32 v176, v176
    v_mfma_f32_16x16x32_bf16 a[112:115], a[220:223], v[184:187], a[112:115]
    ds_read_b64_tr_b16 a[206:207], v6 offset:53248
    v_cvt_pk_bf16_f32 v235, v174, v175
    v_mfma_f32_16x16x32_bf16 a[116:119], a[220:223], v[192:195], a[116:119]
    v_exp_f32 v177, v177
    v_mfma_f32_16x16x32_bf16 a[116:119], a[216:219], v[188:191], a[116:119]
    ds_read_b128 a[140:143], v4 offset:16384
    v_mfma_f32_16x16x32_bf16 a[120:123], a[216:219], v[196:199], a[120:123]
    v_exp_f32 v178, v178
    v_mfma_f32_16x16x32_bf16 a[120:123], a[220:223], v[200:203], a[120:123]
    v_cvt_pk_bf16_f32 v242, v176, v177
    v_mfma_f32_16x16x32_bf16 a[124:127], a[220:223], v[208:211], a[124:127]
    v_exp_f32 v179, v179
    v_mfma_f32_16x16x32_bf16 a[124:127], a[216:219], v[204:207], a[124:127]
    buffer_load_dwordx4 v14, s[8:11], s28 offen offset:1024 lds
    v_smfmac_f32_16x16x64_bf16 a[236:239], v[244:247], v[204:211], v248
    s_waitcnt lgkmcnt(6)
    v_mfma_f32_16x16x32_bf16 v[172:175], a[176:179], v[68:71], v[108:111]
    v_exp_f32 v116, v116
    v_mfma_f32_16x16x32_bf16 v[172:175], a[180:183], v[72:75], v[172:175]
    ds_read_b64_tr_b16 a[208:209], v7 offset:24576
    v_cvt_pk_bf16_f32 v243, v178, v179
    v_mfma_f32_16x16x32_bf16 v[172:175], a[184:187], v[76:79], v[172:175]
    v_exp_f32 v117, v117
    v_mfma_f32_16x16x32_bf16 v[172:175], a[188:191], v[80:83], v[172:175]
    ds_read_b64_tr_b16 a[210:211], v7 offset:28672
    v_mfma_f32_16x16x32_bf16 v[176:179], a[188:191], v[96:99], v[112:115]
    v_exp_f32 v118, v118
    v_mfma_f32_16x16x32_bf16 v[176:179], a[184:187], v[92:95], v[176:179]
    ds_read_b128 a[144:147], v1 offset:20480
    v_cvt_pk_bf16_f32 v180, v116, v117
    v_mfma_f32_16x16x32_bf16 v[176:179], a[180:183], v[88:91], v[176:179]
    v_exp_f32 v119, v119
    v_mfma_f32_16x16x32_bf16 v[176:179], a[176:179], v[84:87], v[176:179]
    ds_read_b64_tr_b16 a[212:213], v7 offset:49152
    v_mfma_f32_16x16x32_bf16 a[0:3], a[192:195], v[212:215], a[0:3]
    v_exp_f32 v120, v120
    v_mfma_f32_16x16x32_bf16 a[0:3], a[196:199], v[216:219], a[0:3]
    ds_read_b64_tr_b16 a[214:215], v7 offset:53248
    v_cvt_pk_bf16_f32 v181, v118, v119
    v_mfma_f32_16x16x32_bf16 a[4:7], a[196:199], v[224:227], a[4:7]
    v_exp_f32 v121, v121
    v_mfma_f32_16x16x32_bf16 a[4:7], a[192:195], v[220:223], a[4:7]
    ds_read_b128 a[148:151], v2 offset:20480
    v_cvt_pk_bf16_f32 v188, v120, v121
    v_mfma_f32_16x16x32_bf16 a[8:11], a[192:195], v[228:231], a[8:11]
    v_exp_f32 v122, v122
    v_mfma_f32_16x16x32_bf16 a[8:11], a[196:199], v[232:235], a[8:11]
    buffer_load_dwordx4 v15, s[8:11], s28 offen offset:2048 lds
    v_mfma_f32_16x16x32_bf16 a[12:15], a[196:199], v[240:243], a[12:15]
    v_exp_f32 v123, v123
    v_mfma_f32_16x16x32_bf16 a[12:15], a[192:195], v[236:239], a[12:15]
    s_waitcnt lgkmcnt(6)
    v_mfma_f32_16x16x32_bf16 v[116:119], a[128:131], v[36:39], v[100:103]
    v_exp_f32 v124, v124
    v_mfma_f32_16x16x32_bf16 v[116:119], a[132:135], v[40:43], v[116:119]
    ds_read_b64_tr_b16 a[216:217], v8 offset:24576
    v_cvt_pk_bf16_f32 v189, v122, v123
    v_mfma_f32_16x16x32_bf16 v[116:119], a[136:139], v[44:47], v[116:119]
    v_exp_f32 v125, v125
    v_mfma_f32_16x16x32_bf16 v[116:119], a[140:143], v[48:51], v[116:119]
    ds_read_b64_tr_b16 a[218:219], v8 offset:28672
    v_mfma_f32_16x16x32_bf16 v[120:123], a[140:143], v[64:67], v[104:107]
    v_exp_f32 v126, v126
    v_mfma_f32_16x16x32_bf16 v[120:123], a[136:139], v[60:63], v[120:123]
    ds_read_b128 a[152:155], v3 offset:20480
    v_cvt_pk_bf16_f32 v196, v124, v125
    v_mfma_f32_16x16x32_bf16 v[120:123], a[132:135], v[56:59], v[120:123]
    v_exp_f32 v127, v127
    v_mfma_f32_16x16x32_bf16 v[120:123], a[128:131], v[52:55], v[120:123]
    ds_read_b64_tr_b16 a[220:221], v8 offset:49152
    v_mfma_f32_16x16x32_bf16 a[16:19], a[200:203], v[212:215], a[16:19]
    v_exp_f32 v128, v128
    v_mfma_f32_16x16x32_bf16 a[16:19], a[204:207], v[216:219], a[16:19]
    ds_read_b64_tr_b16 a[222:223], v8 offset:53248
    v_cvt_pk_bf16_f32 v197, v126, v127
    v_mfma_f32_16x16x32_bf16 a[20:23], a[204:207], v[224:227], a[20:23]
    v_exp_f32 v129, v129
    v_mfma_f32_16x16x32_bf16 a[20:23], a[200:203], v[220:223], a[20:23]
    ds_read_b128 a[156:159], v4 offset:20480
    v_mfma_f32_16x16x32_bf16 a[24:27], a[200:203], v[228:231], a[24:27]
    v_exp_f32 v130, v130
    v_mfma_f32_16x16x32_bf16 a[24:27], a[204:207], v[232:235], a[24:27]
    v_cvt_pk_bf16_f32 v204, v128, v129
    v_mfma_f32_16x16x32_bf16 a[28:31], a[204:207], v[240:243], a[28:31]
    v_exp_f32 v131, v131
    v_mfma_f32_16x16x32_bf16 a[28:31], a[200:203], v[236:239], a[28:31]
    buffer_load_dwordx4 v16, s[8:11], s28 offen offset:3072 lds
    v_smfmac_f32_16x16x64_bf16 a[224:227], v[244:247], v[212:219], v248
    s_waitcnt lgkmcnt(6)
    v_mfma_f32_16x16x32_bf16 v[124:127], a[128:131], v[68:71], v[108:111]
    s_cmp_eq_u32 s36, 2
    s_cbranch_scc1 L_site2
L_site_back2:
    v_exp_f32 v132, v132
    v_mfma_f32_16x16x32_bf16 v[124:127], a[132:135], v[72:75], v[124:127]
    ds_read_b64_tr_b16 a[192:193], v9 offset:24576
    v_cvt_pk_bf16_f32 v205, v130, v131
    v_mfma_f32_16x16x32_bf16 v[124:127], a[136:139], v[76:79], v[124:127]
    v_exp_f32 v133, v133
    v_mfma_f32_16x16x32_bf16 v[124:127], a[140:143], v[80:83], v[124:127]
    ds_read_b64_tr_b16 a[194:195], v9 offset:28672
    v_mfma_f32_16x16x32_bf16 v[128:131], a[140:143], v[96:99], v[112:115]
    v_exp_f32 v134, v134
    v_mfma_f32_16x16x32_bf16 v[128:131], a[136:139], v[92:95], v[128:131]
    ds_read_b128 a[160:163], v1 offset:24576
    v_cvt_pk_bf16_f32 v182, v132, v133
    v_mfma_f32_16x16x32_bf16 v[128:131], a[132:135], v[88:91], v[128:131]
    v_exp_f32 v135, v135
    v_mfma_f32_16x16x32_bf16 v[128:131], a[128:131], v[84:87], v[128:131]
    ds_read_b64_tr_b16 a[196:197], v9 offset:49152
    v_mfma_f32_16x16x32_bf16 a[32:35], a[208:211], v[212:215], a[32:35]
    v_exp_f32 v136, v136
    v_mfma_f32_16x16x32_bf16 a[32:35], a[212:215], v[216:219], a[32:35]
    ds_read_b64_tr_b16 a[198:199], v9 offset:53248
    v_cvt_pk_bf16_f32 v183, v134, v135
    v_mfma_f32_16x16x32_bf16 a[36:39], a[212:215], v[224:227], a[36:39]
    v_exp_f32 v137, v137
    v_mfma_f32_16x16x32_bf16 a[36:39], a[208:211], v[220:223], a[36:39]
    ds_read_b128 a[164:167], v2 offset:24576
    v_cvt_pk_bf16_f32 v190, v136, v137
    v_mfma_f32_16x16x32_bf16 a[40:43], a[208:211], v[228:231], a[40:43]
    s_add_u32 s28, s28, 16384
    s_mov_b32 m0, s31
    v_exp_f32 v138, v138
    v_mfma_f32_16x16x32_bf16 a[40:43], a[212:215], v[232:235], a[40:43]
    buffer_load_dwordx4 v17, s[12:15], s29 offen offset:0 lds
    v_mfma_f32_16x16x32_bf16 a[44:47], a[212:215], v[240:243], a[44:47]
    v_exp_f32 v139, v139
    v_mfma_f32_16x16x32_bf16 a[44:47], a[208:211], v[236:239], a[44:47]
    s_waitcnt lgkmcnt(6)
    v_mfma_f32_16x16x32_bf16 v[132:135], a[144:147], v[36:39], v[100:103]
    v_exp_f32 v140, v140
    v_mfma_f32_16x16x32_bf16 v[132:135], a[148:151], v[40:43], v[132:135]
    ds_read_b64_tr_b16 a[200:201], v10 offset:24576
    v_cvt_pk_bf16_f32 v191, v138, v139
    v_mfma_f32_16x16x32_bf16 v[132:135], a[152:155], v[44:47], v[132:135]
    v_exp_f32 v141, v141
    v_mfma_f32_16x16x32_bf16 v[132:135], a[156:159], v[48:51], v[132:135]
    ds_read_b64_tr_b16 a[202:203], v10 offset:28672
    v_mfma_f32_16x16x32_bf16 v[136:139], a[156:159], v[64:67], v[104:107]
    v_exp_f32 v142, v142
    v_mfma_f32_16x16x32_bf16 v[136:139], a[152:155], v[60:63], v[136:139]
    ds_read_b128 a[168:171], v3 offset:24576
    v_cvt_pk_bf16_f32 v198, v140, v141
    v_mfma_f32_16x16x32_bf16 v[136:139], a[148:151], v[56:59], v[136:139]
    v_exp_f32 v143, v143
    v_mfma_f32_16x16x32_bf16 v[136:139], a[144:147], v[52:55], v[136:139]
    ds_read_b64_tr_b16 a[204:205], v10 offset:49152
    v_mfma_f32_16x16x32_bf16 a[48:51], a[216:219], v[212:215], a[48:51]
    v_exp_f32 v144, v144
    v_mfma_f32_16x16x32_bf16 a[48:51], a[220:223], v[216:219], a[48:51]
    ds_read_b64_tr_b16 a[206:207], v10 offset:53248
    v_cvt_pk_bf16_f32 v199, v142, v143
    v_mfma_f32_16x16x32_bf16 a[52:55], a[220:223], v[224:227], a[52:55]
    v_exp_f32 v145, v145
    v_mfma_f32_16x16x32_bf16 a[52:55], a[216:219], v[220:223], a[52:55]
    ds_read_b128 a[172:175], v4 offset:24576
    v_mfma_f32_16x16x32_bf16 a[56:59], a[216:219], v[228:231], a[56:59]
    v_exp_f32 v146, v146
    v_mfma_f32_16x16x32_bf16 a[56:59], a[220:223], v[232:235], a[56:59]
    v_cvt_pk_bf16_f32 v206, v144, v145
    v_mfma_f32_16x16x32_bf16 a[60:63], a[220:223], v[240:243], a[60:63]
    v_exp_f32 v147, v147
    v_mfma_f32_16x16x32_bf16 a[60:63], a[216:219], v[236:239], a[60:63]
    buffer_load_dwordx4 v18, s[12:15], s29 offen offset:1024 lds
    v_smfmac_f32_16x16x64_bf16 a[228:231], v[244:247], v[220:227], v248
    s_waitcnt lgkmcnt(6)
    v_mfma_f32_16x16x32_bf16 v[140:143], a[144:147], v[68:71], v[108:111]
    v_exp_f32 v148, v148
    v_mfma_f32_16x16x32_bf16 v[140:143], a[148:151], v[72:75], v[140:143]
    ds_read_b64_tr_b16 a[208:209], v11 offset:24576
    v_cvt_pk_bf16_f32 v207, v146, v147
    v_mfma_f32_16x16x32_bf16 v[140:143], a[152:155], v[76:79], v[140:143]
    v_exp_f32 v149, v149
    v_mfma_f32_16x16x32_bf16 v[140:143], a[156:159], v[80:83], v[140:143]
    ds_read_b64_tr_b16 a[210:211], v11 offset:28672
    v_mfma_f32_16x16x32_bf16 v[144:147], a[156:159], v[96:99], v[112:115]
    v_exp_f32 v150, v150
    v_mfma_f32_16x16x32_bf16 v[144:147], a[152:155], v[92:95], v[144:147]
    ds_read_b128 a[176:179], v1 offset:28672
    v_cvt_pk_bf16_f32 v184, v148, v149
    v_mfma_f32_16x16x32_bf16 v[144:147], a[148:151], v[88:91], v[144:147]
    v_exp_f32 v151, v151
    v_mfma_f32_16x16x32_bf16 v[144:147], a[144:147], v[84:87], v[144:147]
    ds_read_b64_tr_b16 a[212:213], v11 offset:49152
    v_mfma_f32_16x16x32_bf16 a[64:67], a[192:195], v[212:215], a[64:67]
    v_exp_f32 v152, v152
    v_mfma_f32_16x16x32_bf16 a[64:67], a[196:199], v[216:219], a[64:67]
    ds_read_b64_tr_b16 a[214:215], v11 offset:53248
    v_cvt_pk_bf16_f32 v185, v150, v151
    v_mfma_f32_16x16x32_bf16 a[68:71], a[196:199], v[224:227], a[68:71]
    v_exp_f32 v153, v153
    v_mfma_f32_16x16x32_bf16 a[68:71], a[192:195], v[220:223], a[68:71]
    ds_read_b128 a[180:183], v2 offset:28672
    v_cvt_pk_bf16_f32 v192, v152, v153
    v_mfma_f32_16x16x32_bf16 a[72:75], a[192:195], v[228:231], a[72:75]
    v_exp_f32 v154, v154
    v_mfma_f32_16x16x32_bf16 a[72:75], a[196:199], v[232:235], a[72:75]
    buffer_load_dwordx4 v17, s[12:15], s29 offen offset:2048 lds
    v_mfma_f32_16x16x32_bf16 a[76:79], a[196:199], v[240:243], a[76:79]
    v_exp_f32 v155, v155
    v_mfma_f32_16x16x32_bf16 a[76:79], a[192:195], v[236:239], a[76:79]
    s_waitcnt lgkmcnt(6)
    v_mfma_f32_16x16x32_bf16 v[148:151], a[160:163], v[36:39], v[100:103]
    v_exp_f32 v156, v156
    v_mfma_f32_16x16x32_bf16 v[148:151], a[164:167], v[40:43], v[148:151]
    ds_read_b64_tr_b16 a[216:217], v12 offset:24576
    v_cvt_pk_bf16_f32 v193, v154, v155
    v_mfma_f32_16x16x32_bf16 v[148:151], a[168:171], v[44:47], v[148:151]
    v_exp_f32 v157, v157
    v_mfma_f32_16x16x32_bf16 v[148:151], a[172:175], v[48:51], v[148:151]
    ds_read_b64_tr_b16 a[218:219], v12 offset:28672
    v_mfma_f32_16x16x32_bf16 v[152:155], a[172:175], v[64:67], v[104:107]
    v_exp_f32 v158, v158
    v_mfma_f32_16x16x32_bf16 v[152:155], a[168:171], v[60:63], v[152:155]
    ds_read_b128 a[184:187], v3 offset:28672
    v_cvt_pk_bf16_f32 v200, v156, v157
    v_mfma_f32_16x16x32_bf16 v[152:155], a[164:167], v[56:59], v[152:155]
    v_exp_f32 v159, v159
    v_mfma_f32_16x16x32_bf16 v[152:155], a[160:163], v[52:55], v[152:155]
    ds_read_b64_tr_b16 a[220:221], v12 offset:49152
    v_mfma_f32_16x16x32_bf16 a[80:83], a[200:203], v[212:215], a[80:83]
    v_exp_f32 v160, v160
    v_mfma_f32_16x16x32_bf16 a[80:83], a[204:207], v[216:219], a[80:83]
    ds_read_b64_tr_b16 a[222:223], v12 offset:53248
    v_cvt_pk_bf16_f32 v201, v158, v159
    v_mfma_f32_16x16x32_bf16 a[84:87], a[204:207], v[224:227], a[84:87]
    v_exp_f32 v161, v161
    v_mfma_f32_16x16x32_bf16 a[84:87], a[200:203], v[220:223], a[84:87]
    ds_read_b128 a[188:191], v4 offset:28672
    v_mfma_f32_16x16x32_bf16 a[88:91], a[200:203], v[228:231], a[88:91]
    v_exp_f32 v162, v162
    v_mfma_f32_16x16x32_bf16 a[88:91], a[204:207], v[232:235], a[88:91]
    v_cvt_pk_bf16_f32 v208, v160, v161
    v_mfma_f32_16x16x32_bf16 a[92:95], a[204:207], v[240:243], a[92:95]
    v_exp_f32 v163, v163
    v_mfma_f32_16x16x32_bf16 a[92:95], a[200:203], v[236:239], a[92:95]
    buffer_load_dwordx4 v18, s[12:15], s29 offen offset:3072 lds
    v_smfmac_f32_16x16x64_bf16 a[232:235], v[244:247], v[228:235], v248
    s_waitcnt vmcnt(8) lgkmcnt(6)
    s_barrier
    s_add_u32 s29, s29, 16384
    v_mfma_f32_16x16x32_bf16 v[156:159], a[160:163], v[68:71], v[108:111]
    v_exp_f32 v164, v164
    v_mfma_f32_16x16x32_bf16 v[156:159], a[164:167], v[72:75], v[156:159]
    ds_read_b64_tr_b16 a[192:193], v5 offset:8192
    v_cvt_pk_bf16_f32 v209, v162, v163
    v_mfma_f32_16x16x32_bf16 v[156:159], a[168:171], v[76:79], v[156:159]
    v_exp_f32 v165, v165
    v_mfma_f32_16x16x32_bf16 v[156:159], a[172:175], v[80:83], v[156:159]
    ds_read_b64_tr_b16 a[194:195], v5 offset:12288
    v_mfma_f32_16x16x32_bf16 v[160:163], a[172:175], v[96:99], v[112:115]
    v_exp_f32 v166, v166
    v_mfma_f32_16x16x32_bf16 v[160:163], a[168:171], v[92:95], v[160:163]
    ds_read_b128 a[128:131], v1 offset:32768
    v_cvt_pk_bf16_f32 v186, v164, v165
    v_mfma_f32_16x16x32_bf16 v[160:163], a[164:167], v[88:91], v[160:163]
    v_exp_f32 v167, v167
    v_mfma_f32_16x16x32_bf16 v[160:163], a[160:163], v[84:87], v[160:163]
    ds_read_b64_tr_b16 a[196:197], v5 offset:32768
    v_mfma_f32_16x16x32_bf16 a[96:99], a[208:211], v[212:215], a[96:99]
    v_exp_f32 v168, v168
    v_mfma_f32_16x16x32_bf16 a[96:99], a[212:215], v[216:219], a[96:99]
    ds_read_b64_tr_b16 a[198:199], v5 offset:36864
    v_cvt_pk_bf16_f32 v187, v166, v167
    v_mfma_f32_16x16x32_bf16 a[100:103], a[212:215], v[224:227], a[100:103]
    v_exp_f32 v169, v169
    v_mfma_f32_16x16x32_bf16 a[100:103], a[208:211], v[220:223], a[100:103]
    ds_read_b128 a[132:135], v2 offset:32768
    v_cvt_pk_bf16_f32 v194, v168, v169
    v_mfma_f32_16x16x32_bf16 a[104:107], a[208:211], v[228:231], a[104:107]
    s_add_u32 m0, s34, 49152
    v_exp_f32 v170, v170
    v_mfma_f32_16x16x32_bf16 a[104:107], a[212:215], v[232:235], a[104:107]
    buffer_load_dwordx4 v13, s[8:11], s28 offen offset:0 lds
    v_mfma_f32_16x16x32_bf16 a[108:111], a[212:215], v[240:243], a[108:111]
    v_exp_f32 v171, v171
    v_mfma_f32_16x16x32_bf16 a[108:111], a[208:211], v[236:239], a[108:111]
    s_waitcnt lgkmcnt(6)
    v_mfma_f32_16x16x32_bf16 v[164:167], a[176:179], v[36:39], v[100:103]
    v_exp_f32 v172, v172
    v_mfma_f32_16x16x32_bf16 v[164:167], a[180:183], v[40:43], v[164:167]
    ds_read_b64_tr_b16 a[200:201], v6 offset:8192
    v_cvt_pk_bf16_f32 v195, v170, v171
    v_mfma_f32_16x16x32_bf16 v[164:167], a[184:187], v[44:47], v[164:167]
    v_exp_f32 v173, v173
    v_mfma_f32_16x16x32_bf16 v[164:167], a[188:191], v[48:51], v[164:167]
    ds_read_b64_tr_b16 a[202:203], v6 offset:12288
    v_mfma_f32_16x16x32_bf16 v[168:171], a[188:191], v[64:67], v[104:107]
    v_exp_f32 v174, v174
    v_mfma_f32_16x16x32_bf16 v[168:171], a[184:187], v[60:63], v[168:171]
    ds_read_b128 a[136:139], v3 offset:32768
    v_cvt_pk_bf16_f32 v202, v172, v173
    v_mfma_f32_16x16x32_bf16 v[168:171], a[180:183], v[56:59], v[168:171]
    v_exp_f32 v175, v175
    v_mfma_f32_16x16x32_bf16 v[168:171], a[176:179], v[52:55], v[168:171]
    ds_read_b64_tr_b16 a[204:205], v6 offset:32768
    v_mfma_f32_16x16x32_bf16 a[112:115], a[216:219], v[212:215], a[112:115]
    v_exp_f32 v176, v176
    v_mfma_f32_16x16x32_bf16 a[112:115], a[220:223], v[216:219], a[112:115]
    ds_read_b64_tr_b16 a[206:207], v6 offset:36864
    v_cvt_pk_bf16_f32 v203, v174, v175
    v_mfma_f32_16x16x32_bf16 a[116:119], a[220:223], v[224:227], a[116:119]
    v_exp_f32 v177, v177
    v_mfma_f32_16x16x32_bf16 a[116:119], a[216:219], v[220:223], a[116:119]
    ds_read_b128 a[140:143], v4 offset:32768
    v_mfma_f32_16x16x32_bf16 a[120:123], a[216:219], v[228:231], a[120:123]
    v_exp_f32 v178, v178
    v_mfma_f32_16x16x32_bf16 a[120:123], a[220:223], v[232:235], a[120:123]
    v_cvt_pk_bf16_f32 v210, v176, v177
    v_mfma_f32_16x16x32_bf16 a[124:127], a[220:223], v[240:243], a[124:127]
    v_exp_f32 v179, v179
    v_mfma_f32_16x16x32_bf16 a[124:127], a[216:219], v[236:239], a[124:127]
    buffer_load_dwordx4 v14, s[8:11], s28 offen offset:1024 lds
    v_smfmac_f32_16x16x64_bf16 a[236:239], v[244:247], v[236:243], v248
    s_waitcnt lgkmcnt(6)
    v_mfma_f32_16x16x32_bf16 v[172:175], a[176:179], v[68:71], v[108:111]
    v_exp_f32 v116, v116
    v_mfma_f32_16x16x32_bf16 v[172:175], a[180:183], v[72:75], v[172:175]
    ds_read_b64_tr_b16 a[208:209], v7 offset:8192
    v_cvt_pk_bf16_f32 v211, v178, v179
    v_mfma_f32_16x16x32_bf16 v[172:175], a[184:187], v[76:79], v[172:175]
    v_exp_f32 v117, v117
    v_mfma_f32_16x16x32_bf16 v[172:175], a[188:191], v[80:83], v[172:175]
    ds_read_b64_tr_b16 a[210:211], v7 offset:12288
    v_mfma_f32_16x16x32_bf16 v[176:179], a[188:191], v[96:99], v[112:115]
    v_exp_f32 v118, v118
    v_mfma_f32_16x16x32_bf16 v[176:179], a[184:187], v[92:95], v[176:179]
    ds_read_b128 a[144:147], v1 offset:36864
    v_cvt_pk_bf16_f32 v212, v116, v117
    v_mfma_f32_16x16x32_bf16 v[176:179], a[180:183], v[88:91], v[176:179]
    v_exp_f32 v119, v119
    v_mfma_f32_16x16x32_bf16 v[176:179], a[176:179], v[84:87], v[176:179]
    ds_read_b64_tr_b16 a[212:213], v7 offset:32768
    v_mfma_f32_16x16x32_bf16 a[0:3], a[192:195], v[180:183], a[0:3]
    v_exp_f32 v120, v120
    v_mfma_f32_16x16x32_bf16 a[0:3], a[196:199], v[184:187], a[0:3]
    ds_read_b64_tr_b16 a[214:215], v7 offset:36864
    v_cvt_pk_bf16_f32 v213, v118, v119
    v_mfma_f32_16x16x32_bf16 a[4:7], a[196:199], v[192:195], a[4:7]
    v_exp_f32 v121, v121
    v_mfma_f32_16x16x32_bf16 a[4:7], a[192:195], v[188:191], a[4:7]
    ds_read_b128 a[148:151], v2 offset:36864
    v_cvt_pk_bf16_f32 v220, v120, v121
    v_mfma_f32_16x16x32_bf16 a[8:11], a[192:195], v[196:199], a[8:11]
    v_exp_f32 v122, v122
    v_mfma_f32_16x16x32_bf16 a[8:11], a[196:199], v[200:203], a[8:11]
    buffer_load_dwordx4 v15, s[8:11], s28 offen offset:2048 lds
    v_mfma_f32_16x16x32_bf16 a[12:15], a[196:199], v[208:211], a[12:15]
    v_exp_f32 v123, v123
    v_mfma_f32_16x16x32_bf16 a[12:15], a[192:195], v[204:207], a[12:15]
    s_waitcnt lgkmcnt(6)
    v_mfma_f32_16x16x32_bf16 v[116:119], a[128:131], v[36:39], v[100:103]
    v_exp_f32 v124, v124
    v_mfma_f32_16x16x32_bf16 v[116:119], a[132:135], v[40:43], v[116:119]
    ds_read_b64_tr_b16 a[216:217], v8 offset:8192
    v_cvt_pk_bf16_f32 v221, v122, v123
    v_mfma_f32_16x16x32_bf16 v[116:119], a[136:139], v[44:47], v[116:119]
    v_exp_f32 v125, v125
    v_mfma_f32_16x16x32_bf16 v[116:119], a[140:143], v[48:51], v[116:119]
    ds_read_b64_tr_b16 a[218:219], v8 offset:12288
    v_mfma_f32_16x16x32_bf16 v[120:123], a[140:143], v[64:67], v[104:107]
    v_exp_f32 v126, v126
    v_mfma_f32_16x16x32_bf16 v[120:123], a[136:139], v[60:63], v[120:123]
    ds_read_b128 a[152:155], v3 offset:36864
    v_cvt_pk_bf16_f32 v228, v124, v125
    v_mfma_f32_16x16x32_bf16 v[120:123], a[132:135], v[56:59], v[120:123]
    v_exp_f32 v127, v127
    v_mfma_f32_16x16x32_bf16 v[120:123], a[128:131], v[52:55], v[120:123]
    ds_read_b64_tr_b16 a[220:221], v8 offset:32768
    v_mfma_f32_16x16x32_bf16 a[16:19], a[200:203], v[180:183], a[16:19]
    v_exp_f32 v128, v128
    v_mfma_f32_16x16x32_bf16 a[16:19], a[204:207], v[184:187], a[16:19]
    ds_read_b64_tr_b16 a[222:223], v8 offset:36864
    v_cvt_pk_bf16_f32 v229, v126, v127
    v_mfma_f32_16x16x32_bf16 a[20:23], a[204:207], v[192:195], a[20:23]
    v_exp_f32 v129, v129
    v_mfma_f32_16x16x32_bf16 a[20:23], a[200:203], v[188:191], a[20:23]
    ds_read_b128 a[156:159], v4 offset:36864
    v_mfma_f32_16x16x32_bf16 a[24:27], a[200:203], v[196:199], a[24:27]
    v_exp_f32 v130, v130
    v_mfma_f32_16x16x32_bf16 a[24:27], a[204:207], v[200:203], a[24:27]
    v_cvt_pk_bf16_f32 v236, v128, v129
    v_mfma_f32_16x16x32_bf16 a[28:31], a[204:207], v[208:211], a[28:31]
    v_exp_f32 v131, v131
    v_mfma_f32_16x16x32_bf16 a[28:31], a[200:203], v[204:207], a[28:31]
    buffer_load_dwordx4 v16, s[8:11], s28 offen offset:3072 lds
    v_smfmac_f32_16x16x64_bf16 a[224:227], v[244:247], v[180:187], v248
    s_waitcnt lgkmcnt(6)
    v_mfma_f32_16x16x32_bf16 v[124:127], a[128:131], v[68:71], v[108:111]
    s_cmp_eq_u32 s36, 3
    s_cbranch_scc1 L_site3
L_site_back3:
    v_exp_f32 v132, v132
    v_mfma_f32_16x16x32_bf16 v[124:127], a[132:135], v[72:75], v[124:127]
    ds_read_b64_tr_b16 a[192:193], v9 offset:8192
    v_cvt_pk_bf16_f32 v237, v130, v131
    v_mfma_f32_16x16x32_bf16 v[124:127], a[136:139], v[76:79], v[124:127]
    v_exp_f32 v133, v133
    v_mfma_f32_16x16x32_bf16 v[124:127], a[140:143], v[80:83], v[124:127]
    ds_read_b64_tr_b16 a[194:195], v9 offset:12288
    v_mfma_f32_16x16x32_bf16 v[128:131], a[140:143], v[96:99], v[112:115]
    v_exp_f32 v134, v134
    v_mfma_f32_16x16x32_bf16 v[128:131], a[136:139], v[92:95], v[128:131]
    ds_read_b128 a[160:163], v1 offset:40960
    v_cvt_pk_bf16_f32 v214, v132, v133
    v_mfma_f32_16x16x32_bf16 v[128:131], a[132:135], v[88:91], v[128:131]
    v_exp_f32 v135, v135
    v_mfma_f32_16x16x32_bf16 v[128:131], a[128:131], v[84:87], v[128:131]
    ds_read_b64_tr_b16 a[196:197], v9 offset:32768
    v_mfma_f32_16x16x32_bf16 a[32:35], a[208:211], v[180:183], a[32:35]
    v_exp_f32 v136, v136
    v_mfma_f32_16x16x32_bf16 a[32:35], a[212:215], v[184:187], a[32:35]
    ds_read_b64_tr_b16 a[198:199], v9 offset:36864
    v_cvt_pk_bf16_f32 v215, v134, v135
    v_mfma_f32_16x16x32_bf16 a[36:39], a[212:215], v[192:195], a[36:39]
    v_exp_f32 v137, v137
    v_mfma_f32_16x16x32_bf16 a[36:39], a[208:211], v[188:191], a[36:39]
    ds_read_b128 a[164:167], v2 offset:40960
    v_cvt_pk_bf16_f32 v222, v136, v137
    v_mfma_f32_16x16x32_bf16 a[40:43], a[208:211], v[196:199], a[40:43]
    s_add_u32 s28, s28, 16384
    s_mov_b32 m0, s32
    v_exp_f32 v138, v138
    v_mfma_f32_16x16x32_bf16 a[40:43], a[212:215], v[200:203], a[40:43]
    buffer_load_dwordx4 v17, s[12:15], s29 offen offset:0 lds
    v_mfma_f32_16x16x32_bf16 a[44:47], a[212:215], v[208:211], a[44:47]
    v_exp_f32 v139, v139
    v_mfma_f32_16x16x32_bf16 a[44:47], a[208:211], v[204:207], a[44:47]
    s_waitcnt lgkmcnt(6)
    v_mfma_f32_16x16x32_bf16 v[132:135], a[144:147], v[36:39], v[100:103]
    v_exp_f32 v140, v140
    v_mfma_f32_16x16x32_bf16 v[132:135], a[148:151], v[40:43], v[132:135]
    ds_read_b64_tr_b16 a[200:201], v10 offset:8192
    v_cvt_pk_bf16_f32 v223, v138, v139
    v_mfma_f32_16x16x32_bf16 v[132:135], a[152:155], v[44:47], v[132:135]
    v_exp_f32 v141, v141
    v_mfma_f32_16x16x32_bf16 v[132:135], a[156:159], v[48:51], v[132:135]
    ds_read_b64_tr_b16 a[202:203], v10 offset:12288
    v_mfma_f32_16x16x32_bf16 v[136:139], a[156:159], v[64:67], v[104:107]
    v_exp_f32 v142, v142
    v_mfma_f32_16x16x32_bf16 v[136:139], a[152:155], v[60:63], v[136:139]
    ds_read_b128 a[168:171], v3 offset:40960
    v_cvt_pk_bf16_f32 v230, v140, v141
    v_mfma_f32_16x16x32_bf16 v[136:139], a[148:151], v[56:59], v[136:139]
    v_exp_f32 v143, v143
    v_mfma_f32_16x16x32_bf16 v[136:139], a[144:147], v[52:55], v[136:139]
    ds_read_b64_tr_b16 a[204:205], v10 offset:32768
    v_mfma_f32_16x16x32_bf16 a[48:51], a[216:219], v[180:183], a[48:51]
    v_exp_f32 v144, v144
    v_mfma_f32_16x16x32_bf16 a[48:51], a[220:223], v[184:187], a[48:51]
    ds_read_b64_tr_b16 a[206:207], v10 offset:36864
    v_cvt_pk_bf16_f32 v231, v142, v143
    v_mfma_f32_16x16x32_bf16 a[52:55], a[220:223], v[192:195], a[52:55]
    v_exp_f32 v145, v145
    v_mfma_f32_16x16x32_bf16 a[52:55], a[216:219], v[188:191], a[52:55]
    ds_read_b128 a[172:175], v4 offset:40960
    v_mfma_f32_16x16x32_bf16 a[56:59], a[216:219], v[196:199], a[56:59]
    v_exp_f32 v146, v146
    v_mfma_f32_16x16x32_bf16 a[56:59], a[220:223], v[200:203], a[56:59]
    v_cvt_pk_bf16_f32 v238, v144, v145
    v_mfma_f32_16x16x32_bf16 a[60:63], a[220:223], v[208:211], a[60:63]
    v_exp_f32 v147, v147
    v_mfma_f32_16x16x32_bf16 a[60:63], a[216:219], v[204:207], a[60:63]
    buffer_load_dwordx4 v18, s[12:15], s29 offen offset:1024 lds
    v_smfmac_f32_16x16x64_bf16 a[228:231], v[244:247], v[188:195], v248
    s_waitcnt lgkmcnt(6)
    v_mfma_f32_16x16x32_bf16 v[140:143], a[144:147], v[68:71], v[108:111]
    v_exp_f32 v148, v148
    v_mfma_f32_16x16x32_bf16 v[140:143], a[148:151], v[72:75], v[140:143]
    ds_read_b64_tr_b16 a[208:209], v11 offset:8192
    v_cvt_pk_bf16_f32 v239, v146, v147
    v_mfma_f32_16x16x32_bf16 v[140:143], a[152:155], v[76:79], v[140:143]
    v_exp_f32 v149, v149
    v_mfma_f32_16x16x32_bf16 v[140:143], a[156:159], v[80:83], v[140:143]
    ds_read_b64_tr_b16 a[210:211], v11 offset:12288
    v_mfma_f32_16x16x32_bf16 v[144:147], a[156:159], v[96:99], v[112:115]
    v_exp_f32 v150, v150
    v_mfma_f32_16x16x32_bf16 v[144:147], a[152:155], v[92:95], v[144:147]
    ds_read_b128 a[176:179], v1 offset:45056
    v_cvt_pk_bf16_f32 v216, v148, v149
    v_mfma_f32_16x16x32_bf16 v[144:147], a[148:151], v[88:91], v[144:147]
    v_exp_f32 v151, v151
    v_mfma_f32_16x16x32_bf16 v[144:147], a[144:147], v[84:87], v[144:147]
    ds_read_b64_tr_b16 a[212:213], v11 offset:32768
    v_mfma_f32_16x16x32_bf16 a[64:67], a[192:195], v[180:183], a[64:67]
    v_exp_f32 v152, v152
    v_mfma_f32_16x16x32_bf16 a[64:67], a[196:199], v[184:187], a[64:67]
    ds_read_b64_tr_b16 a[214:215], v11 offset:36864
    v_cvt_pk_bf16_f32 v217, v150, v151
    v_mfma_f32_16x16x32_bf16 a[68:71], a[196:199], v[192:195], a[68:71]
    v_exp_f32 v153, v153
    v_mfma_f32_16x16x32_bf16 a[68:71], a[192:195], v[188:191], a[68:71]
    ds_read_b128 a[180:183], v2 offset:45056
    v_cvt_pk_bf16_f32 v224, v152, v153
    v_mfma_f32_16x16x32_bf16 a[72:75], a[192:195], v[196:199], a[72:75]
    v_exp_f32 v154, v154
    v_mfma_f32_16x16x32_bf16 a[72:75], a[196:199], v[200:203], a[72:75]
    buffer_load_dwordx4 v17, s[12:15], s29 offen offset:2048 lds
    v_mfma_f32_16x16x32_bf16 a[76:79], a[196:199], v[208:211], a[76:79]
    v_exp_f32 v155, v155
    v_mfma_f32_16x16x32_bf16 a[76:79], a[192:195], v[204:207], a[76:79]
    s_waitcnt lgkmcnt(6)
    v_mfma_f32_16x16x32_bf16 v[148:151], a[160:163], v[36:39], v[100:103]
    v_exp_f32 v156, v156
    v_mfma_f32_16x16x32_bf16 v[148:151], a[164:167], v[40:43], v[148:151]
    ds_read_b64_tr_b16 a[216:217], v12 offset:8192
    v_cvt_pk_bf16_f32 v225, v154, v155
    v_mfma_f32_16x16x32_bf16 v[148:151], a[168:171], v[44:47], v[148:151]
    v_exp_f32 v157, v157
    v_mfma_f32_16x16x32_bf16 v[148:151], a[172:175], v[48:51], v[148:151]
    ds_read_b64_tr_b16 a[218:219], v12 offset:12288
    v_mfma_f32_16x16x32_bf16 v[152:155], a[172:175], v[64:67], v[104:107]
    v_exp_f32 v158, v158
    v_mfma_f32_16x16x32_bf16 v[152:155], a[168:171], v[60:63], v[152:155]
    ds_read_b128 a[184:187], v3 offset:45056
    v_cvt_pk_bf16_f32 v232, v156, v157
    v_mfma_f32_16x16x32_bf16 v[152:155], a[164:167], v[56:59], v[152:155]
    v_exp_f32 v159, v159
    v_mfma_f32_16x16x32_bf16 v[152:155], a[160:163], v[52:55], v[152:155]
    ds_read_b64_tr_b16 a[220:221], v12 offset:32768
    v_mfma_f32_16x16x32_bf16 a[80:83], a[200:203], v[180:183], a[80:83]
    v_exp_f32 v160, v160
    v_mfma_f32_16x16x32_bf16 a[80:83], a[204:207], v[184:187], a[80:83]
    ds_read_b64_tr_b16 a[222:223], v12 offset:36864
    v_cvt_pk_bf16_f32 v233, v158, v159
    v_mfma_f32_16x16x32_bf16 a[84:87], a[204:207], v[192:195], a[84:87]
    v_exp_f32 v161, v161
    v_mfma_f32_16x16x32_bf16 a[84:87], a[200:203], v[188:191], a[84:87]
    ds_read_b128 a[188:191], v4 offset:45056
    v_mfma_f32_16x16x32_bf16 a[88:91], a[200:203], v[196:199], a[88:91]
    v_exp_f32 v162, v162
    v_mfma_f32_16x16x32_bf16 a[88:91], a[204:207], v[200:203], a[88:91]
    v_cvt_pk_bf16_f32 v240, v160, v161
    v_mfma_f32_16x16x32_bf16 a[92:95], a[204:207], v[208:211], a[92:95]
    v_exp_f32 v163, v163
    v_mfma_f32_16x16x32_bf16 a[92:95], a[200:203], v[204:207], a[92:95]
    buffer_load_dwordx4 v18, s[12:15], s29 offen offset:3072 lds
    v_smfmac_f32_16x16x64_bf16 a[232:235], v[244:247], v[196:203], v248
    s_waitcnt vmcnt(8) lgkmcnt(6)
    s_barrier
    s_add_u32 s29, s29, 16384
    v_mfma_f32_16x16x32_bf16 v[156:159], a[160:163], v[68:71], v[108:111]
    v_exp_f32 v164, v164
    v_mfma_f32_16x16x32_bf16 v[156:159], a[164:167], v[72:75], v[156:159]
    ds_read_b64_tr_b16 a[192:193], v5 offset:16384
    v_cvt_pk_bf16_f32 v241, v162, v163
    v_mfma_f32_16x16x32_bf16 v[156:159], a[168:171], v[76:79], v[156:159]
    v_exp_f32 v165, v165
    v_mfma_f32_16x16x32_bf16 v[156:159], a[172:175], v[80:83], v[156:159]
    ds_read_b64_tr_b16 a[194:195], v5 offset:20480
    v_mfma_f32_16x16x32_bf16 v[160:163], a[172:175], v[96:99], v[112:115]
    v_exp_f32 v166, v166
    v_mfma_f32_16x16x32_bf16 v[160:163], a[168:171], v[92:95], v[160:163]
    ds_read_b128 a[128:131], v1 offset:0
    v_cvt_pk_bf16_f32 v218, v164, v165
    v_mfma_f32_16x16x32_bf16 v[160:163], a[164:167], v[88:91], v[160:163]
    v_exp_f32 v167, v167
    v_mfma_f32_16x16x32_bf16 v[160:163], a[160:163], v[84:87], v[160:163]
    ds_read_b64_tr_b16 a[196:197], v5 offset:40960
    v_mfma_f32_16x16x32_bf16 a[96:99], a[208:211], v[180:183], a[96:99]
    v_exp_f32 v168, v168
    v_mfma_f32_16x16x32_bf16 a[96:99], a[212:215], v[184:187], a[96:99]
    ds_read_b64_tr_b16 a[198:199], v5 offset:45056
    v_cvt_pk_bf16_f32 v219, v166, v167
    v_mfma_f32_16x16x32_bf16 a[100:103], a[212:215], v[192:195], a[100:103]
    v_exp_f32 v169, v169
    v_mfma_f32_16x16x32_bf16 a[100:103], a[208:211], v[188:191], a[100:103]
    ds_read_b128 a[132:135], v2 offset:0
    v_cvt_pk_bf16_f32 v226, v168, v169
    v_mfma_f32_16x16x32_bf16 a[104:107], a[208:211], v[196:199], a[104:107]
    s_add_u32 m0, s34, 16384
    v_exp_f32 v170, v170
    v_mfma_f32_16x16x32_bf16 a[104:107], a[212:215], v[200:203], a[104:107]
    buffer_load_dwordx4 v13, s[8:11], s28 offen offset:0 lds
    v_mfma_f32_16x16x32_bf16 a[108:111], a[212:215], v[208:211], a[108:111]
    v_exp_f32 v171, v171
    v_mfma_f32_16x16x32_bf16 a[108:111], a[208:211], v[204:207], a[108:111]
    s_waitcnt lgkmcnt(6)
    v_mfma_f32_16x16x32_bf16 v[164:167], a[176:179], v[36:39], v[100:103]
    v_exp_f32 v172, v172
    v_mfma_f32_16x16x32_bf16 v[164:167], a[180:183], v[40:43], v[164:167]
    ds_read_b64_tr_b16 a[200:201], v6 offset:16384
    v_cvt_pk_bf16_f32 v227, v170, v171
    v_mfma_f32_16x16x32_bf16 v[164:167], a[184:187], v[44:47], v[164:167]
    v_exp_f32 v173, v173
    v_mfma_f32_16x16x32_bf16 v[164:167], a[188:191], v[48:51], v[164:167]
    ds_read_b64_tr_b16 a[202:203], v6 offset:20480
    v_mfma_f32_16x16x32_bf16 v[168:171], a[188:191], v[64:67], v[104:107]
    v_exp_f32 v174, v174
    v_mfma_f32_16x16x32_bf16 v[168:171], a[184:187], v[60:63], v[168:171]
    ds_read_b128 a[136:139], v3 offset:0
    v_cvt_pk_bf16_f32 v234, v172, v173
    v_mfma_f32_16x16x32_bf16 v[168:171], a[180:183], v[56:59], v[168:171]
    v_exp_f32 v175, v175
    v_mfma_f32_16x16x32_bf16 v[168:171], a[176:179], v[52:55], v[168:171]
    ds_read_b64_tr_b16 a[204:205], v6 offset:40960
    v_mfma_f32_16x16x32_bf16 a[112:115], a[216:219], v[180:183], a[112:115]
    v_exp_f32 v176, v176
    v_mfma_f32_16x16x32_bf16 a[112:115], a[220:223], v[184:187], a[112:115]
    ds_read_b64_tr_b16 a[206:207], v6 offset:45056
    v_cvt_pk_bf16_f32 v235, v174, v175
    v_mfma_f32_16x16x32_bf16 a[116:119], a[220:223], v[192:195], a[116:119]
    v_exp_f32 v177, v177
    v_mfma_f32_16x16x32_bf16 a[116:119], a[216:219], v[188:191], a[116:119]
    ds_read_b128 a[140:143], v4 offset:0
    v_mfma_f32_16x16x32_bf16 a[120:123], a[216:219], v[196:199], a[120:123]
    v_exp_f32 v178, v178
    v_mfma_f32_16x16x32_bf16 a[120:123], a[220:223], v[200:203], a[120:123]
    v_cvt_pk_bf16_f32 v242, v176, v177
    v_mfma_f32_16x16x32_bf16 a[124:127], a[220:223], v[208:211], a[124:127]
    v_exp_f32 v179, v179
    v_mfma_f32_16x16x32_bf16 a[124:127], a[216:219], v[204:207], a[124:127]
    buffer_load_dwordx4 v14, s[8:11], s28 offen offset:1024 lds
    v_smfmac_f32_16x16x64_bf16 a[236:239], v[244:247], v[204:211], v248
    s_waitcnt lgkmcnt(6)
    s_sub_u32 s35, s35, 1
    s_cbranch_scc0 L_attn_loop
    v_mfma_f32_16x16x32_bf16 v[172:175], a[176:179], v[68:71], v[108:111]
    s_bfe_u32 s40, s2, 0x20001
    v_exp_f32 v116, v116
    v_mfma_f32_16x16x32_bf16 v[172:175], a[180:183], v[72:75], v[172:175]
    s_lshl_b32 s40, s40, 3
    ds_read_b64_tr_b16 a[208:209], v7 offset:16384
    v_cvt_pk_bf16_f32 v243, v178, v179
    v_mfma_f32_16x16x32_bf16 v[172:175], a[184:187], v[76:79], v[172:175]
    s_bfe_u32 s41, s2, 0x30003
    v_exp_f32 v117, v117
    v_mfma_f32_16x16x32_bf16 v[172:175], a[188:191], v[80:83], v[172:175]
    s_add_u32 s87, s40, s41
    ds_read_b64_tr_b16 a[210:211], v7 offset:20480
    v_and_b32 v21, 7, v19
    v_mfma_f32_16x16x32_bf16 v[176:179], a[188:191], v[96:99], v[112:115]
    s_and_b32 s40, s2, 1
    v_exp_f32 v118, v118
    v_mfma_f32_16x16x32_bf16 v[176:179], a[184:187], v[92:95], v[176:179]
    s_lshl_b32 s40, s40, 2
    ds_read_b128 a[144:147], v1 offset:4096
    v_cvt_pk_bf16_f32 v180, v116, v117
    v_mfma_f32_16x16x32_bf16 v[176:179], a[180:183], v[88:91], v[176:179]
    s_lshr_b32 s41, s2, 6
    v_exp_f32 v119, v119
    v_mfma_f32_16x16x32_bf16 v[176:179], a[176:179], v[84:87], v[176:179]
    s_add_u32 s100, s40, s41
    ds_read_b64_tr_b16 a[212:213], v7 offset:40960
    v_lshlrev_b32 v21, 2, v21
    v_mfma_f32_16x16x32_bf16 a[0:3], a[192:195], v[212:215], a[0:3]
    s_add_u32 s16, s72, 0x1a00000
    s_addc_u32 s17, s73, 0
    v_exp_f32 v120, v120
    v_mfma_f32_16x16x32_bf16 a[0:3], a[196:199], v[216:219], a[0:3]
    s_mov_b32 s18, 0x438000
    ds_read_b64_tr_b16 a[214:215], v7 offset:45056
    v_cvt_pk_bf16_f32 v181, v118, v119
    v_mfma_f32_16x16x32_bf16 a[4:7], a[196:199], v[224:227], a[4:7]
    s_mov_b32 s19, 0x20000
    v_exp_f32 v121, v121
    v_mfma_f32_16x16x32_bf16 a[4:7], a[192:195], v[220:223], a[4:7]
    ds_read_b128 a[148:151], v2 offset:4096
    v_cvt_pk_bf16_f32 v188, v120, v121
    v_mfma_f32_16x16x32_bf16 a[8:11], a[192:195], v[228:231], a[8:11]
    v_exp_f32 v122, v122
    v_mfma_f32_16x16x32_bf16 a[8:11], a[196:199], v[232:235], a[8:11]
    buffer_load_dwordx4 v15, s[8:11], s28 offen offset:2048 lds
    v_add_u32 v21, 0x29b000, v21
    v_mfma_f32_16x16x32_bf16 a[12:15], a[196:199], v[240:243], a[12:15]
    v_exp_f32 v123, v123
    v_mfma_f32_16x16x32_bf16 a[12:15], a[192:195], v[236:239], a[12:15]
    s_waitcnt lgkmcnt(6)
    buffer_load_dword v249, v21, s[76:79], 0 offen sc1
    v_mfma_f32_16x16x32_bf16 v[116:119], a[128:131], v[36:39], v[100:103]
    v_exp_f32 v124, v124
    v_mfma_f32_16x16x32_bf16 v[116:119], a[132:135], v[40:43], v[116:119]
    ds_read_b64_tr_b16 a[216:217], v8 offset:16384
    v_cvt_pk_bf16_f32 v189, v122, v123
    v_mfma_f32_16x16x32_bf16 v[116:119], a[136:139], v[44:47], v[116:119]
    v_exp_f32 v125, v125
    v_mfma_f32_16x16x32_bf16 v[116:119], a[140:143], v[48:51], v[116:119]
    ds_read_b64_tr_b16 a[218:219], v8 offset:20480
    v_lshlrev_b32 v32, 7, v19
    v_mfma_f32_16x16x32_bf16 v[120:123], a[140:143], v[64:67], v[104:107]
    v_exp_f32 v126, v126
    v_mfma_f32_16x16x32_bf16 v[120:123], a[136:139], v[60:63], v[120:123]
    ds_read_b128 a[152:155], v3 offset:4096
    v_cvt_pk_bf16_f32 v196, v124, v125
    v_mfma_f32_16x16x32_bf16 v[120:123], a[132:135], v[56:59], v[120:123]
    v_exp_f32 v127, v127
    v_mfma_f32_16x16x32_bf16 v[120:123], a[128:131], v[52:55], v[120:123]
    ds_read_b64_tr_b16 a[220:221], v8 offset:40960
    v_add_u32 v32, 0x290000, v32
    v_mfma_f32_16x16x32_bf16 a[16:19], a[200:203], v[212:215], a[16:19]
    v_exp_f32 v128, v128
    v_mfma_f32_16x16x32_bf16 a[16:19], a[204:207], v[216:219], a[16:19]
    ds_read_b64_tr_b16 a[222:223], v8 offset:45056
    v_cvt_pk_bf16_f32 v197, v126, v127
    v_mfma_f32_16x16x32_bf16 a[20:23], a[204:207], v[224:227], a[20:23]
    v_exp_f32 v129, v129
    v_mfma_f32_16x16x32_bf16 a[20:23], a[200:203], v[220:223], a[20:23]
    ds_read_b128 a[156:159], v4 offset:4096
    v_mfma_f32_16x16x32_bf16 a[24:27], a[200:203], v[228:231], a[24:27]
    v_exp_f32 v130, v130
    v_mfma_f32_16x16x32_bf16 a[24:27], a[204:207], v[232:235], a[24:27]
    v_cvt_pk_bf16_f32 v204, v128, v129
    v_mfma_f32_16x16x32_bf16 a[28:31], a[204:207], v[240:243], a[28:31]
    v_exp_f32 v131, v131
    v_mfma_f32_16x16x32_bf16 a[28:31], a[200:203], v[236:239], a[28:31]
    buffer_load_dwordx4 v16, s[8:11], s28 offen offset:3072 lds
    v_smfmac_f32_16x16x64_bf16 a[224:227], v[244:247], v[212:219], v248
    s_waitcnt lgkmcnt(6)
    buffer_load_dwordx4 v[28:31], v32, s[76:79], 0 offen sc1
    v_mfma_f32_16x16x32_bf16 v[124:127], a[128:131], v[68:71], v[108:111]
    v_exp_f32 v132, v132
    v_mfma_f32_16x16x32_bf16 v[124:127], a[132:135], v[72:75], v[124:127]
    ds_read_b64_tr_b16 a[192:193], v9 offset:16384
    v_cvt_pk_bf16_f32 v205, v130, v131
    v_mfma_f32_16x16x32_bf16 v[124:127], a[136:139], v[76:79], v[124:127]
    v_exp_f32 v133, v133
    v_mfma_f32_16x16x32_bf16 v[124:127], a[140:143], v[80:83], v[124:127]
    ds_read_b64_tr_b16 a[194:195], v9 offset:20480
    v_mov_b32 v24, 0x3f803f80
    v_mfma_f32_16x16x32_bf16 v[128:131], a[140:143], v[96:99], v[112:115]
    v_exp_f32 v134, v134
    v_mfma_f32_16x16x32_bf16 v[128:131], a[136:139], v[92:95], v[128:131]
    ds_read_b128 a[160:163], v1 offset:8192
    v_cvt_pk_bf16_f32 v182, v132, v133
    v_mfma_f32_16x16x32_bf16 v[128:131], a[132:135], v[88:91], v[128:131]
    v_exp_f32 v135, v135
    v_accvgpr_write_b32 a240, v24
    v_mfma_f32_16x16x32_bf16 v[128:131], a[128:131], v[84:87], v[128:131]
    ds_read_b64_tr_b16 a[196:197], v9 offset:40960
    v_accvgpr_write_b32 a241, v24
    v_mfma_f32_16x16x32_bf16 a[32:35], a[208:211], v[212:215], a[32:35]
    v_exp_f32 v136, v136
    v_mfma_f32_16x16x32_bf16 a[32:35], a[212:215], v[216:219], a[32:35]
    ds_read_b64_tr_b16 a[198:199], v9 offset:45056
    v_cvt_pk_bf16_f32 v183, v134, v135
    v_lshlrev_b32 v25, 4, v19
    v_mfma_f32_16x16x32_bf16 a[36:39], a[212:215], v[224:227], a[36:39]
    s_mul_i32 s40, s5, 3072
    v_exp_f32 v137, v137
    v_mfma_f32_16x16x32_bf16 a[36:39], a[208:211], v[220:223], a[36:39]
    s_mul_i32 s41, s6, 10240
    ds_read_b128 a[164:167], v2 offset:8192
    v_cvt_pk_bf16_f32 v190, v136, v137
    v_mfma_f32_16x16x32_bf16 a[40:43], a[208:211], v[228:231], a[40:43]
    s_add_u32 s28, s28, 16384
    s_mov_b32 m0, s33
    v_exp_f32 v138, v138
    v_accvgpr_write_b32 a242, v24
    v_mfma_f32_16x16x32_bf16 a[40:43], a[212:215], v[232:235], a[40:43]
    s_add_u32 s41, s41, s40
    buffer_load_dwordx4 v17, s[12:15], s29 offen offset:0 lds
    v_mfma_f32_16x16x32_bf16 a[44:47], a[212:215], v[240:243], a[44:47]
    v_exp_f32 v139, v139
    v_mfma_f32_16x16x32_bf16 a[44:47], a[208:211], v[236:239], a[44:47]
    s_waitcnt lgkmcnt(6)
    v_accvgpr_write_b32 a243, v24
    v_accvgpr_write_b32 a244, v24
    v_mfma_f32_16x16x32_bf16 v[132:135], a[144:147], v[36:39], v[100:103]
    v_exp_f32 v140, v140
    v_mfma_f32_16x16x32_bf16 v[132:135], a[148:151], v[40:43], v[132:135]
    ds_read_b64_tr_b16 a[200:201], v10 offset:16384
    v_cvt_pk_bf16_f32 v191, v138, v139
    v_mfma_f32_16x16x32_bf16 v[132:135], a[152:155], v[44:47], v[132:135]
    v_exp_f32 v141, v141
    v_mfma_f32_16x16x32_bf16 v[132:135], a[156:159], v[48:51], v[132:135]
    ds_read_b64_tr_b16 a[202:203], v10 offset:20480
    v_accvgpr_write_b32 a245, v24
    v_mfma_f32_16x16x32_bf16 v[136:139], a[156:159], v[64:67], v[104:107]
    v_exp_f32 v142, v142
    v_mfma_f32_16x16x32_bf16 v[136:139], a[152:155], v[60:63], v[136:139]
    ds_read_b128 a[168:171], v3 offset:8192
    v_cvt_pk_bf16_f32 v198, v140, v141
    v_mfma_f32_16x16x32_bf16 v[136:139], a[148:151], v[56:59], v[136:139]
    v_exp_f32 v143, v143
    v_mfma_f32_16x16x32_bf16 v[136:139], a[144:147], v[52:55], v[136:139]
    ds_read_b64_tr_b16 a[204:205], v10 offset:40960
    v_accvgpr_write_b32 a246, v24
    v_mfma_f32_16x16x32_bf16 a[48:51], a[216:219], v[212:215], a[48:51]
    v_exp_f32 v144, v144
    v_mfma_f32_16x16x32_bf16 a[48:51], a[220:223], v[216:219], a[48:51]
    ds_read_b64_tr_b16 a[206:207], v10 offset:45056
    v_cvt_pk_bf16_f32 v199, v142, v143
    v_mfma_f32_16x16x32_bf16 a[52:55], a[220:223], v[224:227], a[52:55]
    v_exp_f32 v145, v145
    v_mfma_f32_16x16x32_bf16 a[52:55], a[216:219], v[220:223], a[52:55]
    ds_read_b128 a[172:175], v4 offset:8192
    v_accvgpr_write_b32 a247, v24
    v_mfma_f32_16x16x32_bf16 a[56:59], a[216:219], v[228:231], a[56:59]
    v_exp_f32 v146, v146
    v_mfma_f32_16x16x32_bf16 a[56:59], a[220:223], v[232:235], a[56:59]
    v_cvt_pk_bf16_f32 v206, v144, v145
    v_accvgpr_write_b32 a248, v24
    v_mfma_f32_16x16x32_bf16 a[60:63], a[220:223], v[240:243], a[60:63]
    v_exp_f32 v147, v147
    v_mfma_f32_16x16x32_bf16 a[60:63], a[216:219], v[236:239], a[60:63]
    buffer_load_dwordx4 v18, s[12:15], s29 offen offset:1024 lds
    v_smfmac_f32_16x16x64_bf16 a[228:231], v[244:247], v[220:227], v248
    s_waitcnt lgkmcnt(6)
    v_accvgpr_write_b32 a249, v24
    v_accvgpr_write_b32 a250, v24
    v_mfma_f32_16x16x32_bf16 v[140:143], a[144:147], v[68:71], v[108:111]
    v_exp_f32 v148, v148
    v_mfma_f32_16x16x32_bf16 v[140:143], a[148:151], v[72:75], v[140:143]
    ds_read_b64_tr_b16 a[208:209], v11 offset:16384
    v_cvt_pk_bf16_f32 v207, v146, v147
    v_mfma_f32_16x16x32_bf16 v[140:143], a[152:155], v[76:79], v[140:143]
    v_exp_f32 v149, v149
    v_mfma_f32_16x16x32_bf16 v[140:143], a[156:159], v[80:83], v[140:143]
    ds_read_b64_tr_b16 a[210:211], v11 offset:20480
    v_accvgpr_write_b32 a251, v24
    v_mfma_f32_16x16x32_bf16 v[144:147], a[156:159], v[96:99], v[112:115]
    v_exp_f32 v150, v150
    v_mfma_f32_16x16x32_bf16 v[144:147], a[152:155], v[92:95], v[144:147]
    ds_read_b128 a[176:179], v1 offset:12288
    v_cvt_pk_bf16_f32 v184, v148, v149
    v_mfma_f32_16x16x32_bf16 v[144:147], a[148:151], v[88:91], v[144:147]
    v_exp_f32 v151, v151
    v_mfma_f32_16x16x32_bf16 v[144:147], a[144:147], v[84:87], v[144:147]
    ds_read_b64_tr_b16 a[212:213], v11 offset:40960
    v_accvgpr_write_b32 a252, v24
    v_mfma_f32_16x16x32_bf16 a[64:67], a[192:195], v[212:215], a[64:67]
    v_exp_f32 v152, v152
    v_mfma_f32_16x16x32_bf16 a[64:67], a[196:199], v[216:219], a[64:67]
    ds_read_b64_tr_b16 a[214:215], v11 offset:45056
    v_cvt_pk_bf16_f32 v185, v150, v151
    v_mfma_f32_16x16x32_bf16 a[68:71], a[196:199], v[224:227], a[68:71]
    v_exp_f32 v153, v153
    v_mfma_f32_16x16x32_bf16 a[68:71], a[192:195], v[220:223], a[68:71]
    ds_read_b128 a[180:183], v2 offset:12288
    v_cvt_pk_bf16_f32 v192, v152, v153
    v_mfma_f32_16x16x32_bf16 a[72:75], a[192:195], v[228:231], a[72:75]
    v_exp_f32 v154, v154
    v_mfma_f32_16x16x32_bf16 a[72:75], a[196:199], v[232:235], a[72:75]
    buffer_load_dwordx4 v17, s[12:15], s29 offen offset:2048 lds
    s_mov_b32 s43, m0
    s_add_u32 m0, s40, 86016
    s_nop 0
    buffer_load_dwordx4 v25, s[96:99], s41 offen offset:0 lds
    s_mov_b32 m0, s43
    v_accvgpr_write_b32 a253, v24
    v_mfma_f32_16x16x32_bf16 a[76:79], a[196:199], v[240:243], a[76:79]
    v_exp_f32 v155, v155
    v_mfma_f32_16x16x32_bf16 a[76:79], a[192:195], v[236:239], a[76:79]
    s_waitcnt lgkmcnt(6)
    v_accvgpr_write_b32 a254, v24
    v_accvgpr_write_b32 a255, v24
    v_mfma_f32_16x16x32_bf16 v[148:151], a[160:163], v[36:39], v[100:103]
    v_exp_f32 v156, v156
    v_mfma_f32_16x16x32_bf16 v[148:151], a[164:167], v[40:43], v[148:151]
    ds_read_b64_tr_b16 a[216:217], v12 offset:16384
    v_cvt_pk_bf16_f32 v193, v154, v155
    v_mfma_f32_16x16x32_bf16 v[148:151], a[168:171], v[44:47], v[148:151]
    v_exp_f32 v157, v157
    v_mfma_f32_16x16x32_bf16 v[148:151], a[172:175], v[48:51], v[148:151]
    ds_read_b64_tr_b16 a[218:219], v12 offset:20480
    v_mov_b32 v252, v24
    v_mfma_f32_16x16x32_bf16 v[152:155], a[172:175], v[64:67], v[104:107]
    v_exp_f32 v158, v158
    v_mfma_f32_16x16x32_bf16 v[152:155], a[168:171], v[60:63], v[152:155]
    ds_read_b128 a[184:187], v3 offset:12288
    v_cvt_pk_bf16_f32 v200, v156, v157
    v_mfma_f32_16x16x32_bf16 v[152:155], a[164:167], v[56:59], v[152:155]
    v_exp_f32 v159, v159
    v_mfma_f32_16x16x32_bf16 v[152:155], a[160:163], v[52:55], v[152:155]
    ds_read_b64_tr_b16 a[220:221], v12 offset:40960
    s_mov_b32 s43, m0
    s_add_u32 m0, s40, 86016
    s_nop 0
    buffer_load_dwordx4 v25, s[96:99], s41 offen offset:1024 lds
    s_mov_b32 m0, s43
    v_mov_b32 v253, v24
    v_mfma_f32_16x16x32_bf16 a[80:83], a[200:203], v[212:215], a[80:83]
    v_exp_f32 v160, v160
    v_mfma_f32_16x16x32_bf16 a[80:83], a[204:207], v[216:219], a[80:83]
    ds_read_b64_tr_b16 a[222:223], v12 offset:45056
    v_cvt_pk_bf16_f32 v201, v158, v159
    v_mfma_f32_16x16x32_bf16 a[84:87], a[204:207], v[224:227], a[84:87]
    v_exp_f32 v161, v161
    v_mfma_f32_16x16x32_bf16 a[84:87], a[200:203], v[220:223], a[84:87]
    ds_read_b128 a[188:191], v4 offset:12288
    v_mov_b32 v254, v24
    v_mfma_f32_16x16x32_bf16 a[88:91], a[200:203], v[228:231], a[88:91]
    v_exp_f32 v162, v162
    v_mfma_f32_16x16x32_bf16 a[88:91], a[204:207], v[232:235], a[88:91]
    v_cvt_pk_bf16_f32 v208, v160, v161
    v_mov_b32 v255, v24
    v_mfma_f32_16x16x32_bf16 a[92:95], a[204:207], v[240:243], a[92:95]
    v_exp_f32 v163, v163
    v_mfma_f32_16x16x32_bf16 a[92:95], a[200:203], v[236:239], a[92:95]
    buffer_load_dwordx4 v18, s[12:15], s29 offen offset:3072 lds
    v_smfmac_f32_16x16x64_bf16 a[232:235], v[244:247], v[228:235], v248
    s_waitcnt vmcnt(12) lgkmcnt(6)
    s_barrier
    s_add_u32 s29, s29, 16384
    s_mov_b32 s43, m0
    s_add_u32 m0, s40, 86016
    s_nop 0
    buffer_load_dwordx4 v25, s[96:99], s41 offen offset:2048 lds
    s_mov_b32 m0, s43
    v_mfma_f32_16x16x32_bf16 v[156:159], a[160:163], v[68:71], v[108:111]
    s_waitcnt vmcnt(7)
    v_exp_f32 v164, v164
    v_mfma_f32_16x16x32_bf16 v[156:159], a[164:167], v[72:75], v[156:159]
    ds_read_b64_tr_b16 a[192:193], v5 offset:57344
    v_cvt_pk_bf16_f32 v209, v162, v163
    v_mfma_f32_16x16x32_bf16 v[156:159], a[168:171], v[76:79], v[156:159]
    v_exp_f32 v165, v165
    v_mfma_f32_16x16x32_bf16 v[156:159], a[172:175], v[80:83], v[156:159]
    ds_read_b64_tr_b16 a[194:195], v5 offset:61440
    v_cmp_eq_u32 vcc, 0, v249
    s_and_b64 vcc, vcc, exec
    s_cbranch_scc1 L_spin_sel
L_back_sel:
    v_mfma_f32_16x16x32_bf16 v[160:163], a[172:175], v[96:99], v[112:115]
    v_exp_f32 v166, v166
    v_mfma_f32_16x16x32_bf16 v[160:163], a[168:171], v[92:95], v[160:163]
    ds_read_b128 a[128:131], v1 offset:49152
    v_cvt_pk_bf16_f32 v186, v164, v165
    v_mfma_f32_16x16x32_bf16 v[160:163], a[164:167], v[88:91], v[160:163]
    v_exp_f32 v167, v167
    v_mfma_f32_16x16x32_bf16 v[160:163], a[160:163], v[84:87], v[160:163]
    ds_read_b64_tr_b16 a[196:197], v5 offset:0
    v_min3_u32 v28, v28, v29, v30
    v_mfma_f32_16x16x32_bf16 a[96:99], a[208:211], v[212:215], a[96:99]
    v_exp_f32 v168, v168
    v_mfma_f32_16x16x32_bf16 a[96:99], a[212:215], v[216:219], a[96:99]
    ds_read_b64_tr_b16 a[198:199], v5 offset:4096
    v_cvt_pk_bf16_f32 v187, v166, v167
    v_mfma_f32_16x16x32_bf16 a[100:103], a[212:215], v[224:227], a[100:103]
    v_exp_f32 v169, v169
    v_mfma_f32_16x16x32_bf16 a[100:103], a[208:211], v[220:223], a[100:103]
    ds_read_b128 a[132:135], v2 offset:49152
    v_cvt_pk_bf16_f32 v194, v168, v169
    v_mfma_f32_16x16x32_bf16 a[104:107], a[208:211], v[228:231], a[104:107]
    s_add_u32 m0, s34, 32768
    v_exp_f32 v170, v170
    v_mfma_f32_16x16x32_bf16 a[104:107], a[212:215], v[232:235], a[104:107]
    buffer_load_dwordx4 v13, s[8:11], s28 offen offset:0 lds
    v_mfma_f32_16x16x32_bf16 a[108:111], a[212:215], v[240:243], a[108:111]
    v_exp_f32 v171, v171
    v_mfma_f32_16x16x32_bf16 a[108:111], a[208:211], v[236:239], a[108:111]
    s_waitcnt lgkmcnt(6)
    v_min_u32 v28, v28, v31
    v_cmp_gt_u32 vcc, 1, v28
    s_and_b64 vcc, vcc, exec
    s_cbranch_scc1 L_spin_pack
L_back_pack:
    v_mfma_f32_16x16x32_bf16 v[164:167], a[176:179], v[36:39], v[100:103]
    v_exp_f32 v172, v172
    v_mfma_f32_16x16x32_bf16 v[164:167], a[180:183], v[40:43], v[164:167]
    ds_read_b64_tr_b16 a[200:201], v6 offset:57344
    v_cvt_pk_bf16_f32 v195, v170, v171
    v_mfma_f32_16x16x32_bf16 v[164:167], a[184:187], v[44:47], v[164:167]
    v_exp_f32 v173, v173
    v_mfma_f32_16x16x32_bf16 v[164:167], a[188:191], v[48:51], v[164:167]
    ds_read_b64_tr_b16 a[202:203], v6 offset:61440
    v_mfma_f32_16x16x32_bf16 v[168:171], a[188:191], v[64:67], v[104:107]
    v_exp_f32 v174, v174
    v_mfma_f32_16x16x32_bf16 v[168:171], a[184:187], v[60:63], v[168:171]
    ds_read_b128 a[136:139], v3 offset:49152
    v_cvt_pk_bf16_f32 v202, v172, v173
    v_mfma_f32_16x16x32_bf16 v[168:171], a[180:183], v[56:59], v[168:171]
    v_exp_f32 v175, v175
    v_mfma_f32_16x16x32_bf16 v[168:171], a[176:179], v[52:55], v[168:171]
    ds_read_b64_tr_b16 a[204:205], v6 offset:0
    v_mfma_f32_16x16x32_bf16 a[112:115], a[216:219], v[212:215], a[112:115]
    v_exp_f32 v176, v176
    v_mfma_f32_16x16x32_bf16 a[112:115], a[220:223], v[216:219], a[112:115]
    ds_read_b64_tr_b16 a[206:207], v6 offset:4096
    v_cvt_pk_bf16_f32 v203, v174, v175
    v_mfma_f32_16x16x32_bf16 a[116:119], a[220:223], v[224:227], a[116:119]
    v_exp_f32 v177, v177
    v_mfma_f32_16x16x32_bf16 a[116:119], a[216:219], v[220:223], a[116:119]
    ds_read_b128 a[140:143], v4 offset:49152
    v_mfma_f32_16x16x32_bf16 a[120:123], a[216:219], v[228:231], a[120:123]
    v_exp_f32 v178, v178
    v_mfma_f32_16x16x32_bf16 a[120:123], a[220:223], v[232:235], a[120:123]
    v_cvt_pk_bf16_f32 v210, v176, v177
    v_mfma_f32_16x16x32_bf16 a[124:127], a[220:223], v[240:243], a[124:127]
    v_exp_f32 v179, v179
    v_mfma_f32_16x16x32_bf16 a[124:127], a[216:219], v[236:239], a[124:127]
    buffer_load_dwordx4 v14, s[8:11], s28 offen offset:1024 lds
    v_smfmac_f32_16x16x64_bf16 a[236:239], v[244:247], v[236:243], v248
    s_waitcnt lgkmcnt(6)
    v_mfma_f32_16x16x32_bf16 v[172:175], a[176:179], v[68:71], v[108:111]
    v_exp_f32 v116, v116
    v_mfma_f32_16x16x32_bf16 v[172:175], a[180:183], v[72:75], v[172:175]
    ds_read_b64_tr_b16 a[208:209], v7 offset:57344
    v_cvt_pk_bf16_f32 v211, v178, v179
    v_mfma_f32_16x16x32_bf16 v[172:175], a[184:187], v[76:79], v[172:175]
    v_exp_f32 v117, v117
    v_mfma_f32_16x16x32_bf16 v[172:175], a[188:191], v[80:83], v[172:175]
    ds_read_b64_tr_b16 a[210:211], v7 offset:61440
    v_mov_b32 v22, v249
    v_mfma_f32_16x16x32_bf16 v[176:179], a[188:191], v[96:99], v[112:115]
    v_exp_f32 v118, v118
    v_mfma_f32_16x16x32_bf16 v[176:179], a[184:187], v[92:95], v[176:179]
    ds_read_b128 a[144:147], v1 offset:53248
    v_cvt_pk_bf16_f32 v212, v116, v117
    v_mfma_f32_16x16x32_bf16 v[176:179], a[180:183], v[88:91], v[176:179]
    v_exp_f32 v119, v119
    v_mfma_f32_16x16x32_bf16 v[176:179], a[176:179], v[84:87], v[176:179]
    ds_read_b64_tr_b16 a[212:213], v7 offset:0
    v_not_b32 v22, v22
    v_mfma_f32_16x16x32_bf16 a[0:3], a[192:195], v[180:183], a[0:3]
    v_exp_f32 v120, v120
    v_mfma_f32_16x16x32_bf16 a[0:3], a[196:199], v[184:187], a[0:3]
    ds_read_b64_tr_b16 a[214:215], v7 offset:4096
    v_cvt_pk_bf16_f32 v213, v118, v119
    v_mfma_f32_16x16x32_bf16 a[4:7], a[196:199], v[192:195], a[4:7]
    v_exp_f32 v121, v121
    v_mfma_f32_16x16x32_bf16 a[4:7], a[192:195], v[188:191], a[4:7]
    ds_read_b128 a[148:151], v2 offset:53248
    v_cvt_pk_bf16_f32 v220, v120, v121
    v_mfma_f32_16x16x32_bf16 a[8:11], a[192:195], v[196:199], a[8:11]
    v_exp_f32 v122, v122
    v_and_b32 v22, 0x7ff, v22
    v_mfma_f32_16x16x32_bf16 a[8:11], a[196:199], v[200:203], a[8:11]
    buffer_load_dwordx4 v15, s[8:11], s28 offen offset:2048 lds
    v_mfma_f32_16x16x32_bf16 a[12:15], a[196:199], v[208:211], a[12:15]
    v_exp_f32 v123, v123
    v_mfma_f32_16x16x32_bf16 a[12:15], a[192:195], v[204:207], a[12:15]
    s_waitcnt lgkmcnt(6)
    v_lshrrev_b32 v24, 4, v19
    v_lshlrev_b32 v23, 4, v22
    v_mfma_f32_16x16x32_bf16 v[116:119], a[128:131], v[36:39], v[100:103]
    v_exp_f32 v124, v124
    v_mfma_f32_16x16x32_bf16 v[116:119], a[132:135], v[40:43], v[116:119]
    ds_read_b64_tr_b16 a[216:217], v8 offset:57344
    v_cvt_pk_bf16_f32 v221, v122, v123
    v_mfma_f32_16x16x32_bf16 v[116:119], a[136:139], v[44:47], v[116:119]
    v_exp_f32 v125, v125
    v_mfma_f32_16x16x32_bf16 v[116:119], a[140:143], v[48:51], v[116:119]
    ds_read_b64_tr_b16 a[218:219], v8 offset:61440
    v_mul_u32_u24 v22, 1280, v22
    v_mfma_f32_16x16x32_bf16 v[120:123], a[140:143], v[64:67], v[104:107]
    v_exp_f32 v126, v126
    v_mfma_f32_16x16x32_bf16 v[120:123], a[136:139], v[60:63], v[120:123]
    ds_read_b128 a[152:155], v3 offset:53248
    v_cvt_pk_bf16_f32 v228, v124, v125
    v_mfma_f32_16x16x32_bf16 v[120:123], a[132:135], v[56:59], v[120:123]
    v_exp_f32 v127, v127
    v_mfma_f32_16x16x32_bf16 v[120:123], a[128:131], v[52:55], v[120:123]
    ds_read_b64_tr_b16 a[220:221], v8 offset:0
    v_lshl_add_u32 v22, v24, 4, v22
    v_mfma_f32_16x16x32_bf16 a[16:19], a[200:203], v[180:183], a[16:19]
    s_mul_i32 s40, s5, 320
    v_exp_f32 v128, v128
    v_mfma_f32_16x16x32_bf16 a[16:19], a[204:207], v[184:187], a[16:19]
    s_mov_b32 s41, 0x280000
    ds_read_b64_tr_b16 a[222:223], v8 offset:4096
    v_cvt_pk_bf16_f32 v229, v126, v127
    v_mfma_f32_16x16x32_bf16 a[20:23], a[204:207], v[192:195], a[20:23]
    v_exp_f32 v129, v129
    v_mfma_f32_16x16x32_bf16 a[20:23], a[200:203], v[188:191], a[20:23]
    ds_read_b128 a[156:159], v4 offset:53248
    v_mfma_f32_16x16x32_bf16 a[24:27], a[200:203], v[196:199], a[24:27]
    v_exp_f32 v130, v130
    v_mfma_f32_16x16x32_bf16 a[24:27], a[204:207], v[200:203], a[24:27]
    v_cvt_pk_bf16_f32 v236, v128, v129
    v_mfma_f32_16x16x32_bf16 a[28:31], a[204:207], v[208:211], a[28:31]
    v_exp_f32 v131, v131
    v_mfma_f32_16x16x32_bf16 a[28:31], a[200:203], v[204:207], a[28:31]
    buffer_load_dwordx4 v16, s[8:11], s28 offen offset:3072 lds
    v_smfmac_f32_16x16x64_bf16 a[224:227], v[244:247], v[180:187], v248
    s_waitcnt lgkmcnt(6)
    buffer_load_dwordx2 v[20:21], v23, s[76:79], s41 offen sc1
    v_mfma_f32_16x16x32_bf16 v[124:127], a[128:131], v[68:71], v[108:111]
    v_exp_f32 v132, v132
    v_mfma_f32_16x16x32_bf16 v[124:127], a[132:135], v[72:75], v[124:127]
    ds_read_b64_tr_b16 a[192:193], v9 offset:57344
    v_cvt_pk_bf16_f32 v237, v130, v131
    v_mfma_f32_16x16x32_bf16 v[124:127], a[136:139], v[76:79], v[124:127]
    v_exp_f32 v133, v133
    v_mfma_f32_16x16x32_bf16 v[124:127], a[140:143], v[80:83], v[124:127]
    ds_read_b64_tr_b16 a[194:195], v9 offset:61440
    v_mfma_f32_16x16x32_bf16 v[128:131], a[140:143], v[96:99], v[112:115]
    v_exp_f32 v134, v134
    v_mfma_f32_16x16x32_bf16 v[128:131], a[136:139], v[92:95], v[128:131]
    ds_read_b128 a[160:163], v1 offset:57344
    v_cvt_pk_bf16_f32 v214, v132, v133
    v_mfma_f32_16x16x32_bf16 v[128:131], a[132:135], v[88:91], v[128:131]
    v_exp_f32 v135, v135
    v_mfma_f32_16x16x32_bf16 v[128:131], a[128:131], v[84:87], v[128:131]
    ds_read_b64_tr_b16 a[196:197], v9 offset:0
    v_mfma_f32_16x16x32_bf16 a[32:35], a[208:211], v[180:183], a[32:35]
    v_exp_f32 v136, v136
    v_mfma_f32_16x16x32_bf16 a[32:35], a[212:215], v[184:187], a[32:35]
    ds_read_b64_tr_b16 a[198:199], v9 offset:4096
    v_cvt_pk_bf16_f32 v215, v134, v135
    v_mfma_f32_16x16x32_bf16 a[36:39], a[212:215], v[192:195], a[36:39]
    v_exp_f32 v137, v137
    v_mfma_f32_16x16x32_bf16 a[36:39], a[208:211], v[188:191], a[36:39]
    ds_read_b128 a[164:167], v2 offset:57344
    v_cvt_pk_bf16_f32 v222, v136, v137
    v_mfma_f32_16x16x32_bf16 a[40:43], a[208:211], v[196:199], a[40:43]
    s_add_u32 s28, s28, 16384
    s_mov_b32 m0, s30
    v_exp_f32 v138, v138
    v_mfma_f32_16x16x32_bf16 a[40:43], a[212:215], v[200:203], a[40:43]
    buffer_load_dwordx4 v17, s[12:15], s29 offen offset:0 lds
    v_mfma_f32_16x16x32_bf16 a[44:47], a[212:215], v[208:211], a[44:47]
    s_mov_b32 exec_lo, 0x00ff00ff
    s_mov_b32 exec_hi, 0x00ff00ff
    buffer_load_dwordx4 a[240:243], v22, s[88:91], s40 offen offset:0
    s_mov_b64 exec, -1
    v_exp_f32 v139, v139
    v_mfma_f32_16x16x32_bf16 a[44:47], a[208:211], v[204:207], a[44:47]
    s_waitcnt lgkmcnt(6)
    s_mov_b32 exec_lo, 0x00ff00ff
    s_mov_b32 exec_hi, 0x00ff00ff
    buffer_load_dwordx4 a[244:247], v22, s[88:91], s40 offen offset:64
    s_mov_b64 exec, -1
    v_mfma_f32_16x16x32_bf16 v[132:135], a[144:147], v[36:39], v[100:103]
    v_exp_f32 v140, v140
    v_mfma_f32_16x16x32_bf16 v[132:135], a[148:151], v[40:43], v[132:135]
    ds_read_b64_tr_b16 a[200:201], v10 offset:57344
    v_cvt_pk_bf16_f32 v223, v138, v139
    v_mfma_f32_16x16x32_bf16 v[132:135], a[152:155], v[44:47], v[132:135]
    v_exp_f32 v141, v141
    v_mfma_f32_16x16x32_bf16 v[132:135], a[156:159], v[48:51], v[132:135]
    ds_read_b64_tr_b16 a[202:203], v10 offset:61440
    v_mfma_f32_16x16x32_bf16 v[136:139], a[156:159], v[64:67], v[104:107]
    v_exp_f32 v142, v142
    v_mfma_f32_16x16x32_bf16 v[136:139], a[152:155], v[60:63], v[136:139]
    ds_read_b128 a[168:171], v3 offset:57344
    v_cvt_pk_bf16_f32 v230, v140, v141
    v_mfma_f32_16x16x32_bf16 v[136:139], a[148:151], v[56:59], v[136:139]
    v_exp_f32 v143, v143
    v_mfma_f32_16x16x32_bf16 v[136:139], a[144:147], v[52:55], v[136:139]
    ds_read_b64_tr_b16 a[204:205], v10 offset:0
    s_mov_b32 exec_lo, 0x00ff00ff
    s_mov_b32 exec_hi, 0x00ff00ff
    buffer_load_dwordx4 a[248:251], v22, s[88:91], s40 offen offset:128
    s_mov_b64 exec, -1
    v_mfma_f32_16x16x32_bf16 a[48:51], a[216:219], v[180:183], a[48:51]
    v_exp_f32 v144, v144
    v_mfma_f32_16x16x32_bf16 a[48:51], a[220:223], v[184:187], a[48:51]
    ds_read_b64_tr_b16 a[206:207], v10 offset:4096
    v_cvt_pk_bf16_f32 v231, v142, v143
    v_mfma_f32_16x16x32_bf16 a[52:55], a[220:223], v[192:195], a[52:55]
    v_exp_f32 v145, v145
    v_mfma_f32_16x16x32_bf16 a[52:55], a[216:219], v[188:191], a[52:55]
    ds_read_b128 a[172:175], v4 offset:57344
    v_mfma_f32_16x16x32_bf16 a[56:59], a[216:219], v[196:199], a[56:59]
    s_mov_b32 exec_lo, 0x00ff00ff
    s_mov_b32 exec_hi, 0x00ff00ff
    buffer_load_dwordx4 a[252:255], v22, s[88:91], s40 offen offset:192
    s_mov_b64 exec, -1
    v_exp_f32 v146, v146
    v_mfma_f32_16x16x32_bf16 a[56:59], a[220:223], v[200:203], a[56:59]
    v_cvt_pk_bf16_f32 v238, v144, v145
    v_mfma_f32_16x16x32_bf16 a[60:63], a[220:223], v[208:211], a[60:63]
    v_exp_f32 v147, v147
    v_mfma_f32_16x16x32_bf16 a[60:63], a[216:219], v[204:207], a[60:63]
    buffer_load_dwordx4 v18, s[12:15], s29 offen offset:1024 lds
    v_smfmac_f32_16x16x64_bf16 a[228:231], v[244:247], v[188:195], v248
    s_waitcnt lgkmcnt(6)
    s_mov_b32 exec_lo, 0x00ff00ff
    s_mov_b32 exec_hi, 0x00ff00ff
    buffer_load_dwordx4 v[252:255], v22, s[88:91], s40 offen offset:256
    s_mov_b64 exec, -1
    v_mfma_f32_16x16x32_bf16 v[140:143], a[144:147], v[68:71], v[108:111]
    v_exp_f32 v148, v148
    v_mfma_f32_16x16x32_bf16 v[140:143], a[148:151], v[72:75], v[140:143]
    ds_read_b64_tr_b16 a[208:209], v11 offset:57344
    v_cvt_pk_bf16_f32 v239, v146, v147
    v_mfma_f32_16x16x32_bf16 v[140:143], a[152:155], v[76:79], v[140:143]
    v_exp_f32 v149, v149
    v_lshrrev_b32 v22, 4, v19
    v_mfma_f32_16x16x32_bf16 v[140:143], a[156:159], v[80:83], v[140:143]
    ds_read_b64_tr_b16 a[210:211], v11 offset:61440
    v_bfe_u32 v24, v19, 2, 2
    v_mfma_f32_16x16x32_bf16 v[144:147], a[156:159], v[96:99], v[112:115]
    v_exp_f32 v150, v150
    v_mfma_f32_16x16x32_bf16 v[144:147], a[152:155], v[92:95], v[144:147]
    ds_read_b128 a[176:179], v1 offset:61440
    v_cvt_pk_bf16_f32 v216, v148, v149
    v_mfma_f32_16x16x32_bf16 v[144:147], a[148:151], v[88:91], v[144:147]
    v_exp_f32 v151, v151
    v_lshl_add_u32 v22, v22, 3, v24
    v_mfma_f32_16x16x32_bf16 v[144:147], a[144:147], v[84:87], v[144:147]
    ds_read_b64_tr_b16 a[212:213], v11 offset:0
    v_and_b32 v24, 1, v19
    v_mfma_f32_16x16x32_bf16 a[64:67], a[192:195], v[180:183], a[64:67]
    v_exp_f32 v152, v152
    v_mfma_f32_16x16x32_bf16 a[64:67], a[196:199], v[184:187], a[64:67]
    ds_read_b64_tr_b16 a[214:215], v11 offset:4096
    v_cvt_pk_bf16_f32 v217, v150, v151
    v_mfma_f32_16x16x32_bf16 a[68:71], a[196:199], v[192:195], a[68:71]
    v_exp_f32 v153, v153
    v_mfma_f32_16x16x32_bf16 a[68:71], a[192:195], v[188:191], a[68:71]
    ds_read_b128 a[180:183], v2 offset:61440
    v_cvt_pk_bf16_f32 v224, v152, v153
    v_lshl_add_u32 v22, v22, 1, v24
    v_mfma_f32_16x16x32_bf16 a[72:75], a[192:195], v[196:199], a[72:75]
    v_exp_f32 v154, v154
    v_mfma_f32_16x16x32_bf16 a[72:75], a[196:199], v[200:203], a[72:75]
    buffer_load_dwordx4 v17, s[12:15], s29 offen offset:2048 lds
    v_bfe_u32 v24, v19, 1, 1
    v_mfma_f32_16x16x32_bf16 a[76:79], a[196:199], v[208:211], a[76:79]
    v_exp_f32 v155, v155
    v_mfma_f32_16x16x32_bf16 a[76:79], a[192:195], v[204:207], a[76:79]
    s_waitcnt lgkmcnt(6)
    v_mul_u32_u24 v24, 10240, v24
    v_lshl_add_u32 v22, v22, 3, v24
    v_mfma_f32_16x16x32_bf16 v[148:151], a[160:163], v[36:39], v[100:103]
    s_mul_i32 s42, s5, 2560
    v_exp_f32 v156, v156
    v_mfma_f32_16x16x32_bf16 v[148:151], a[164:167], v[40:43], v[148:151]
    s_add_u32 s42, s42, 65536
    ds_read_b64_tr_b16 a[216:217], v12 offset:57344
    v_cvt_pk_bf16_f32 v225, v154, v155
    v_mfma_f32_16x16x32_bf16 v[148:151], a[168:171], v[44:47], v[148:151]
    v_exp_f32 v157, v157
    v_mfma_f32_16x16x32_bf16 v[148:151], a[172:175], v[48:51], v[148:151]
    ds_read_b64_tr_b16 a[218:219], v12 offset:61440
    v_add_u32 v22, s42, v22
    v_mfma_f32_16x16x32_bf16 v[152:155], a[172:175], v[64:67], v[104:107]
    s_mov_b32 s42, 65536
    v_exp_f32 v158, v158
    v_mfma_f32_16x16x32_bf16 v[152:155], a[168:171], v[60:63], v[152:155]
    ds_read_b128 a[184:187], v3 offset:61440
    v_cvt_pk_bf16_f32 v232, v156, v157
    v_mfma_f32_16x16x32_bf16 v[152:155], a[164:167], v[56:59], v[152:155]
    v_exp_f32 v159, v159
    v_mfma_f32_16x16x32_bf16 v[152:155], a[160:163], v[52:55], v[152:155]
    ds_read_b64_tr_b16 a[220:221], v12 offset:0
    v_lshl_add_u32 v23, v19, 4, s42
    v_mfma_f32_16x16x32_bf16 a[80:83], a[200:203], v[180:183], a[80:83]
    v_exp_f32 v160, v160
    v_mfma_f32_16x16x32_bf16 a[80:83], a[204:207], v[184:187], a[80:83]
    ds_read_b64_tr_b16 a[222:223], v12 offset:4096
    v_cvt_pk_bf16_f32 v233, v158, v159
    v_mfma_f32_16x16x32_bf16 a[84:87], a[204:207], v[192:195], a[84:87]
    v_exp_f32 v161, v161
    v_mfma_f32_16x16x32_bf16 a[84:87], a[200:203], v[188:191], a[84:87]
    ds_read_b128 a[188:191], v4 offset:61440
    v_readlane_b32 s50, v249, 0
    v_mfma_f32_16x16x32_bf16 a[88:91], a[200:203], v[196:199], a[88:91]
    v_exp_f32 v162, v162
    v_mfma_f32_16x16x32_bf16 a[88:91], a[204:207], v[200:203], a[88:91]
    v_cvt_pk_bf16_f32 v240, v160, v161
    v_readlane_b32 s51, v249, 1
    v_mfma_f32_16x16x32_bf16 a[92:95], a[204:207], v[208:211], a[92:95]
    v_exp_f32 v163, v163
    v_mfma_f32_16x16x32_bf16 a[92:95], a[200:203], v[204:207], a[92:95]
    buffer_load_dwordx4 v18, s[12:15], s29 offen offset:3072 lds
    v_smfmac_f32_16x16x64_bf16 a[232:235], v[244:247], v[196:203], v248
    s_waitcnt vmcnt(15) lgkmcnt(6)
    s_barrier
    s_add_u32 s29, s29, 16384
    v_readlane_b32 s52, v249, 2
    v_mfma_f32_16x16x32_bf16 v[156:159], a[160:163], v[68:71], v[108:111]
    v_exp_f32 v164, v164
    v_mfma_f32_16x16x32_bf16 v[156:159], a[164:167], v[72:75], v[156:159]
    ds_read_b64_tr_b16 a[192:193], v5 offset:24576
    v_cvt_pk_bf16_f32 v241, v162, v163
    v_mfma_f32_16x16x32_bf16 v[156:159], a[168:171], v[76:79], v[156:159]
    v_exp_f32 v165, v165
    v_mfma_f32_16x16x32_bf16 v[156:159], a[172:175], v[80:83], v[156:159]
    ds_read_b64_tr_b16 a[194:195], v5 offset:28672
    v_readlane_b32 s53, v249, 3
    v_mfma_f32_16x16x32_bf16 v[160:163], a[172:175], v[96:99], v[112:115]
    v_exp_f32 v166, v166
    v_mfma_f32_16x16x32_bf16 v[160:163], a[168:171], v[92:95], v[160:163]
    ds_read_b128 a[128:131], v1 offset:16384
    v_cvt_pk_bf16_f32 v218, v164, v165
    v_mfma_f32_16x16x32_bf16 v[160:163], a[164:167], v[88:91], v[160:163]
    v_exp_f32 v167, v167
    v_mfma_f32_16x16x32_bf16 v[160:163], a[160:163], v[84:87], v[160:163]
    ds_read_b64_tr_b16 a[196:197], v5 offset:49152
    v_readlane_b32 s54, v249, 4
    v_mfma_f32_16x16x32_bf16 a[96:99], a[208:211], v[180:183], a[96:99]
    v_exp_f32 v168, v168
    v_mfma_f32_16x16x32_bf16 a[96:99], a[212:215], v[184:187], a[96:99]
    ds_read_b64_tr_b16 a[198:199], v5 offset:53248
    v_cvt_pk_bf16_f32 v219, v166, v167
    v_mfma_f32_16x16x32_bf16 a[100:103], a[212:215], v[192:195], a[100:103]
    v_exp_f32 v169, v169
    v_mfma_f32_16x16x32_bf16 a[100:103], a[208:211], v[188:191], a[100:103]
    ds_read_b128 a[132:135], v2 offset:16384
    v_cvt_pk_bf16_f32 v226, v168, v169
    v_readlane_b32 s55, v249, 5
    v_mfma_f32_16x16x32_bf16 a[104:107], a[208:211], v[196:199], a[104:107]
    s_add_u32 m0, s34, 0
    v_exp_f32 v170, v170
    v_mfma_f32_16x16x32_bf16 a[104:107], a[212:215], v[200:203], a[104:107]
    buffer_load_dwordx4 v13, s[8:11], s28 offen offset:0 lds
    v_readlane_b32 s56, v249, 6
    v_mfma_f32_16x16x32_bf16 a[108:111], a[212:215], v[208:211], a[108:111]
    v_exp_f32 v171, v171
    v_mfma_f32_16x16x32_bf16 a[108:111], a[208:211], v[204:207], a[108:111]
    s_waitcnt lgkmcnt(6)
    v_readlane_b32 s57, v249, 7
    v_mfma_f32_16x16x32_bf16 v[164:167], a[176:179], v[36:39], v[100:103]
    v_exp_f32 v172, v172
    v_mfma_f32_16x16x32_bf16 v[164:167], a[180:183], v[40:43], v[164:167]
    ds_read_b64_tr_b16 a[200:201], v6 offset:24576
    v_cvt_pk_bf16_f32 v227, v170, v171
    v_mfma_f32_16x16x32_bf16 v[164:167], a[184:187], v[44:47], v[164:167]
    v_exp_f32 v173, v173
    v_mfma_f32_16x16x32_bf16 v[164:167], a[188:191], v[48:51], v[164:167]
    ds_read_b64_tr_b16 a[202:203], v6 offset:28672
    v_mfma_f32_16x16x32_bf16 v[168:171], a[188:191], v[64:67], v[104:107]
    v_exp_f32 v174, v174
    v_mfma_f32_16x16x32_bf16 v[168:171], a[184:187], v[60:63], v[168:171]
    ds_read_b128 a[136:139], v3 offset:16384
    v_cvt_pk_bf16_f32 v234, v172, v173
    v_mfma_f32_16x16x32_bf16 v[168:171], a[180:183], v[56:59], v[168:171]
    v_exp_f32 v175, v175
    v_mfma_f32_16x16x32_bf16 v[168:171], a[176:179], v[52:55], v[168:171]
    ds_read_b64_tr_b16 a[204:205], v6 offset:49152
    ds_read_b64_tr_b16 v[24:25], v22 offset:0
    v_mfma_f32_16x16x32_bf16 a[112:115], a[216:219], v[180:183], a[112:115]
    v_exp_f32 v176, v176
    v_mfma_f32_16x16x32_bf16 a[112:115], a[220:223], v[184:187], a[112:115]
    ds_read_b64_tr_b16 a[206:207], v6 offset:53248
    v_cvt_pk_bf16_f32 v235, v174, v175
    v_mfma_f32_16x16x32_bf16 a[116:119], a[220:223], v[192:195], a[116:119]
    v_exp_f32 v177, v177
    v_mfma_f32_16x16x32_bf16 a[116:119], a[216:219], v[188:191], a[116:119]
    ds_read_b128 a[140:143], v4 offset:16384
    ds_read_b64_tr_b16 v[26:27], v22 offset:64
    v_mfma_f32_16x16x32_bf16 a[120:123], a[216:219], v[196:199], a[120:123]
    v_exp_f32 v178, v178
    v_mfma_f32_16x16x32_bf16 a[120:123], a[220:223], v[200:203], a[120:123]
    ds_read_b64_tr_b16 v[28:29], v22 offset:512
    v_cvt_pk_bf16_f32 v242, v176, v177
    v_mfma_f32_16x16x32_bf16 a[124:127], a[220:223], v[208:211], a[124:127]
    v_exp_f32 v179, v179
    v_mfma_f32_16x16x32_bf16 a[124:127], a[216:219], v[204:207], a[124:127]
    buffer_load_dwordx4 v14, s[8:11], s28 offen offset:1024 lds
    v_smfmac_f32_16x16x64_bf16 a[236:239], v[244:247], v[204:211], v248
    s_waitcnt lgkmcnt(6)
    ds_read_b64_tr_b16 v[30:31], v22 offset:576
    v_mfma_f32_16x16x32_bf16 v[172:175], a[176:179], v[68:71], v[108:111]
    v_exp_f32 v116, v116
    v_mfma_f32_16x16x32_bf16 v[172:175], a[180:183], v[72:75], v[172:175]
    ds_read_b64_tr_b16 a[208:209], v7 offset:24576
    v_cvt_pk_bf16_f32 v243, v178, v179
    v_mfma_f32_16x16x32_bf16 v[172:175], a[184:187], v[76:79], v[172:175]
    v_exp_f32 v117, v117
    v_mfma_f32_16x16x32_bf16 v[172:175], a[188:191], v[80:83], v[172:175]
    ds_read_b64_tr_b16 a[210:211], v7 offset:28672
    v_mfma_f32_16x16x32_bf16 v[176:179], a[188:191], v[96:99], v[112:115]
    v_exp_f32 v118, v118
    v_mfma_f32_16x16x32_bf16 v[176:179], a[184:187], v[92:95], v[176:179]
    ds_read_b128 a[144:147], v1 offset:20480
    v_cvt_pk_bf16_f32 v180, v116, v117
    v_mfma_f32_16x16x32_bf16 v[176:179], a[180:183], v[88:91], v[176:179]
    v_exp_f32 v119, v119
    v_mfma_f32_16x16x32_bf16 v[176:179], a[176:179], v[84:87], v[176:179]
    ds_read_b64_tr_b16 a[212:213], v7 offset:49152
    v_mfma_f32_16x16x32_bf16 a[0:3], a[192:195], v[212:215], a[0:3]
    v_exp_f32 v120, v120
    v_mfma_f32_16x16x32_bf16 a[0:3], a[196:199], v[216:219], a[0:3]
    ds_read_b64_tr_b16 a[214:215], v7 offset:53248
    v_cvt_pk_bf16_f32 v181, v118, v119
    v_mfma_f32_16x16x32_bf16 a[4:7], a[196:199], v[224:227], a[4:7]
    v_exp_f32 v121, v121
    v_mfma_f32_16x16x32_bf16 a[4:7], a[192:195], v[220:223], a[4:7]
    ds_read_b128 a[148:151], v2 offset:20480
    v_cvt_pk_bf16_f32 v188, v120, v121
    v_mfma_f32_16x16x32_bf16 a[8:11], a[192:195], v[228:231], a[8:11]
    v_exp_f32 v122, v122
    v_mfma_f32_16x16x32_bf16 a[8:11], a[196:199], v[232:235], a[8:11]
    buffer_load_dwordx4 v15, s[8:11], s28 offen offset:2048 lds
    v_mfma_f32_16x16x32_bf16 a[12:15], a[196:199], v[240:243], a[12:15]
    v_exp_f32 v123, v123
    v_mfma_f32_16x16x32_bf16 a[12:15], a[192:195], v[236:239], a[12:15]
    s_waitcnt lgkmcnt(6)
    v_mfma_f32_16x16x32_bf16 v[116:119], a[128:131], v[36:39], v[100:103]
    s_waitcnt vmcnt(5)
    v_exp_f32 v124, v124
    v_mfma_f32_16x16x32_bf16 v[32:35], v[24:27], a[240:243], 0
    v_mfma_f32_16x16x32_bf16 v[32:35], v[28:31], a[244:247], v[32:35]
    ds_read_b64_tr_b16 v[24:25], v22 offset:1024
    v_mfma_f32_16x16x32_bf16 v[116:119], a[132:135], v[40:43], v[116:119]
    ds_read_b64_tr_b16 a[216:217], v8 offset:24576
    v_cvt_pk_bf16_f32 v189, v122, v123
    v_mfma_f32_16x16x32_bf16 v[116:119], a[136:139], v[44:47], v[116:119]
    v_exp_f32 v125, v125
    v_mfma_f32_16x16x32_bf16 v[116:119], a[140:143], v[48:51], v[116:119]
    ds_read_b64_tr_b16 a[218:219], v8 offset:28672
    v_mfma_f32_16x16x32_bf16 v[120:123], a[140:143], v[64:67], v[104:107]
    v_exp_f32 v126, v126
    v_mfma_f32_16x16x32_bf16 v[120:123], a[136:139], v[60:63], v[120:123]
    ds_read_b128 a[152:155], v3 offset:20480
    v_cvt_pk_bf16_f32 v196, v124, v125
    v_mfma_f32_16x16x32_bf16 v[120:123], a[132:135], v[56:59], v[120:123]
    v_exp_f32 v127, v127
    v_mfma_f32_16x16x32_bf16 v[120:123], a[128:131], v[52:55], v[120:123]
    ds_read_b64_tr_b16 a[220:221], v8 offset:49152
    v_mfma_f32_16x16x32_bf16 a[16:19], a[200:203], v[212:215], a[16:19]
    v_exp_f32 v128, v128
    v_mfma_f32_16x16x32_bf16 a[16:19], a[204:207], v[216:219], a[16:19]
    ds_read_b64_tr_b16 a[222:223], v8 offset:53248
    v_cvt_pk_bf16_f32 v197, v126, v127
    v_mfma_f32_16x16x32_bf16 a[20:23], a[204:207], v[224:227], a[20:23]
    v_exp_f32 v129, v129
    v_mfma_f32_16x16x32_bf16 a[20:23], a[200:203], v[220:223], a[20:23]
    ds_read_b128 a[156:159], v4 offset:20480
    v_mfma_f32_16x16x32_bf16 a[24:27], a[200:203], v[228:231], a[24:27]
    v_exp_f32 v130, v130
    v_mfma_f32_16x16x32_bf16 a[24:27], a[204:207], v[232:235], a[24:27]
    ds_read_b64_tr_b16 v[26:27], v22 offset:1088
    v_cvt_pk_bf16_f32 v204, v128, v129
    v_mfma_f32_16x16x32_bf16 a[28:31], a[204:207], v[240:243], a[28:31]
    v_exp_f32 v131, v131
    v_mfma_f32_16x16x32_bf16 a[28:31], a[200:203], v[236:239], a[28:31]
    buffer_load_dwordx4 v16, s[8:11], s28 offen offset:3072 lds
    v_smfmac_f32_16x16x64_bf16 a[224:227], v[244:247], v[212:219], v248
    s_waitcnt lgkmcnt(6)
    ds_read_b64_tr_b16 v[28:29], v22 offset:1536
    ds_read_b64_tr_b16 v[30:31], v22 offset:1600
    v_mfma_f32_16x16x32_bf16 v[124:127], a[128:131], v[68:71], v[108:111]
    s_mul_i32 s40, s5, 2560
    v_exp_f32 v132, v132
    v_mfma_f32_16x16x32_bf16 v[124:127], a[132:135], v[72:75], v[124:127]
    ds_read_b64_tr_b16 a[192:193], v9 offset:24576
    v_cvt_pk_bf16_f32 v205, v130, v131
    v_mfma_f32_16x16x32_bf16 v[124:127], a[136:139], v[76:79], v[124:127]
    v_exp_f32 v133, v133
    v_add_u32 v0, s40, v23
    v_mfma_f32_16x16x32_bf16 v[124:127], a[140:143], v[80:83], v[124:127]
    s_nop 0
    ds_read_b64_tr_b16 a[194:195], v9 offset:28672
    v_mfma_f32_16x16x32_bf16 v[128:131], a[140:143], v[96:99], v[112:115]
    s_nop 0
    v_exp_f32 v134, v134
    v_mfma_f32_16x16x32_bf16 v[128:131], a[136:139], v[92:95], v[128:131]
    s_nop 0
    ds_read_b128 a[160:163], v1 offset:24576
    v_cvt_pk_bf16_f32 v182, v132, v133
    v_mfma_f32_16x16x32_bf16 v[128:131], a[132:135], v[88:91], v[128:131]
    s_nop 0
    v_exp_f32 v135, v135
    v_mfma_f32_16x16x32_bf16 v[128:131], a[128:131], v[84:87], v[128:131]
    s_nop 0
    ds_read_b64_tr_b16 a[196:197], v9 offset:49152
    v_mfma_f32_16x16x32_bf16 a[32:35], a[208:211], v[212:215], a[32:35]
    s_nop 0
    v_exp_f32 v136, v136
    v_mfma_f32_16x16x32_bf16 a[32:35], a[212:215], v[216:219], a[32:35]
    s_waitcnt lgkmcnt(4)
    ds_read_b64_tr_b16 a[198:199], v9 offset:53248
    v_cvt_pk_bf16_f32 v183, v134, v135
    v_mfma_f32_16x16x32_bf16 v[32:35], v[24:27], a[248:251], v[32:35]
    v_mfma_f32_16x16x32_bf16 v[32:35], v[28:31], a[252:255], v[32:35]
    ds_read_b64_tr_b16 v[24:25], v22 offset:2048
    v_mfma_f32_16x16x32_bf16 a[36:39], a[212:215], v[224:227], a[36:39]
    v_exp_f32 v137, v137
    v_mfma_f32_16x16x32_bf16 a[36:39], a[208:211], v[220:223], a[36:39]
    ds_read_b128 a[164:167], v2 offset:24576
    v_cvt_pk_bf16_f32 v190, v136, v137
    v_mfma_f32_16x16x32_bf16 a[40:43], a[208:211], v[228:231], a[40:43]
    s_add_u32 s28, s28, 16384
    s_mov_b32 m0, s31
    v_exp_f32 v138, v138
    v_mfma_f32_16x16x32_bf16 a[40:43], a[212:215], v[232:235], a[40:43]
    buffer_load_dwordx4 v17, s[12:15], s29 offen offset:0 lds
    v_mfma_f32_16x16x32_bf16 a[44:47], a[212:215], v[240:243], a[44:47]
    v_exp_f32 v139, v139
    v_mfma_f32_16x16x32_bf16 a[44:47], a[208:211], v[236:239], a[44:47]
    s_waitcnt lgkmcnt(6)
    ds_read_b64_tr_b16 v[26:27], v22 offset:2112
    v_mfma_f32_16x16x32_bf16 v[132:135], a[144:147], v[36:39], v[100:103]
    s_nop 0
    v_exp_f32 v140, v140
    v_mfma_f32_16x16x32_bf16 v[132:135], a[148:151], v[40:43], v[132:135]
    s_nop 0
    ds_read_b64_tr_b16 a[200:201], v10 offset:24576
    v_cvt_pk_bf16_f32 v191, v138, v139
    v_mfma_f32_16x16x32_bf16 v[132:135], a[152:155], v[44:47], v[132:135]
    s_nop 0
    v_exp_f32 v141, v141
    v_mfma_f32_16x16x32_bf16 v[132:135], a[156:159], v[48:51], v[132:135]
    s_nop 0
    ds_read_b64_tr_b16 a[202:203], v10 offset:28672
    v_mfma_f32_16x16x32_bf16 v[136:139], a[156:159], v[64:67], v[104:107]
    s_nop 0
    v_exp_f32 v142, v142
    v_mfma_f32_16x16x32_bf16 v[136:139], a[152:155], v[60:63], v[136:139]
    s_nop 0
    ds_read_b128 a[168:171], v3 offset:24576
    v_cvt_pk_bf16_f32 v198, v140, v141
    v_mfma_f32_16x16x32_bf16 v[136:139], a[148:151], v[56:59], v[136:139]
    s_nop 0
    v_exp_f32 v143, v143
    v_mfma_f32_16x16x32_bf16 v[136:139], a[144:147], v[52:55], v[136:139]
    s_nop 0
    ds_read_b64_tr_b16 a[204:205], v10 offset:49152
    v_mfma_f32_16x16x32_bf16 a[48:51], a[216:219], v[212:215], a[48:51]
    s_waitcnt lgkmcnt(4)
    v_exp_f32 v144, v144
    v_mfma_f32_16x16x32_bf16 v[32:35], v[24:27], v[252:255], v[32:35]
    v_mfma_f32_16x16x32_bf16 a[48:51], a[220:223], v[216:219], a[48:51]
    ds_read_b64_tr_b16 a[206:207], v10 offset:53248
    v_cvt_pk_bf16_f32 v199, v142, v143
    v_mfma_f32_16x16x32_bf16 a[52:55], a[220:223], v[224:227], a[52:55]
    v_exp_f32 v145, v145
    v_mfma_f32_16x16x32_bf16 a[52:55], a[216:219], v[220:223], a[52:55]
    ds_read_b128 a[172:175], v4 offset:24576
    v_mfma_f32_16x16x32_bf16 a[56:59], a[216:219], v[228:231], a[56:59]
    v_exp_f32 v146, v146
    v_mfma_f32_16x16x32_bf16 a[56:59], a[220:223], v[232:235], a[56:59]
    v_cvt_pk_bf16_f32 v206, v144, v145
    v_mfma_f32_16x16x32_bf16 a[60:63], a[220:223], v[240:243], a[60:63]
    v_exp_f32 v147, v147
    v_mfma_f32_16x16x32_bf16 a[60:63], a[216:219], v[236:239], a[60:63]
    buffer_load_dwordx4 v18, s[12:15], s29 offen offset:1024 lds
    v_smfmac_f32_16x16x64_bf16 a[228:231], v[244:247], v[220:227], v248
    s_waitcnt lgkmcnt(6)
    v_mfma_f32_16x16x32_bf16 v[140:143], a[144:147], v[68:71], v[108:111]
    s_nop 0
    v_exp_f32 v148, v148
    v_mfma_f32_16x16x32_bf16 v[140:143], a[148:151], v[72:75], v[140:143]
    s_nop 0
    ds_read_b64_tr_b16 a[208:209], v11 offset:24576
    v_cvt_pk_bf16_f32 v207, v146, v147
    v_mfma_f32_16x16x32_bf16 v[140:143], a[152:155], v[76:79], v[140:143]
    s_nop 0
    v_exp_f32 v149, v149
    v_mfma_f32_16x16x32_bf16 v[140:143], a[156:159], v[80:83], v[140:143]
    ds_read_b64_tr_b16 a[210:211], v11 offset:28672
    v_mfma_f32_16x16x32_bf16 v[144:147], a[156:159], v[96:99], v[112:115]
    v_exp_f32 v150, v150
    v_mfma_f32_16x16x32_bf16 v[144:147], a[152:155], v[92:95], v[144:147]
    ds_read_b128 a[176:179], v1 offset:28672
    v_cvt_pk_bf16_f32 v184, v148, v149
    v_mfma_f32_16x16x32_bf16 v[144:147], a[148:151], v[88:91], v[144:147]
    v_exp_f32 v151, v151
    v_mfma_f32_16x16x32_bf16 v[144:147], a[144:147], v[84:87], v[144:147]
    ds_read_b64_tr_b16 a[212:213], v11 offset:49152
    ds_write_b128 v0, v[32:35]
    v_bfe_u32 v22, v19, 2, 3
    v_mfma_f32_16x16x32_bf16 a[64:67], a[192:195], v[212:215], a[64:67]
    v_exp_f32 v152, v152
    v_mul_u32_u24 v22, 160, v22
    v_mfma_f32_16x16x32_bf16 a[64:67], a[196:199], v[216:219], a[64:67]
    ds_read_b64_tr_b16 a[214:215], v11 offset:53248
    v_cvt_pk_bf16_f32 v185, v150, v151
    v_mfma_f32_16x16x32_bf16 a[68:71], a[196:199], v[224:227], a[68:71]
    v_exp_f32 v153, v153
    v_and_b32 v28, 3, v19
    v_mfma_f32_16x16x32_bf16 a[68:71], a[192:195], v[220:223], a[68:71]
    ds_read_b128 a[180:183], v2 offset:28672
    v_cvt_pk_bf16_f32 v192, v152, v153
    v_add_u32 v22, v22, v28
    v_mfma_f32_16x16x32_bf16 a[72:75], a[192:195], v[228:231], a[72:75]
    s_mul_i32 s42, s5, 320
    v_exp_f32 v154, v154
    v_mfma_f32_16x16x32_bf16 a[72:75], a[196:199], v[232:235], a[72:75]
    s_add_u32 s42, s42, 86016
    buffer_load_dwordx4 v17, s[12:15], s29 offen offset:2048 lds
    v_mfma_f32_16x16x32_bf16 a[76:79], a[196:199], v[240:243], a[76:79]
    v_exp_f32 v155, v155
    v_mfma_f32_16x16x32_bf16 a[76:79], a[192:195], v[236:239], a[76:79]
    s_waitcnt lgkmcnt(6)
    v_lshl_add_u32 v22, v22, 3, s42
    v_mfma_f32_16x16x32_bf16 v[148:151], a[160:163], v[36:39], v[100:103]
    v_exp_f32 v156, v156
    v_mfma_f32_16x16x32_bf16 v[148:151], a[164:167], v[40:43], v[148:151]
    ds_read_b64_tr_b16 a[216:217], v12 offset:24576
    v_cvt_pk_bf16_f32 v193, v154, v155
    v_mfma_f32_16x16x32_bf16 v[148:151], a[168:171], v[44:47], v[148:151]
    v_exp_f32 v157, v157
    v_mfma_f32_16x16x32_bf16 v[148:151], a[172:175], v[48:51], v[148:151]
    ds_read_b64_tr_b16 a[218:219], v12 offset:28672
    v_mfma_f32_16x16x32_bf16 v[152:155], a[172:175], v[64:67], v[104:107]
    v_exp_f32 v158, v158
    v_mfma_f32_16x16x32_bf16 v[152:155], a[168:171], v[60:63], v[152:155]
    ds_read_b128 a[184:187], v3 offset:28672
    v_cvt_pk_bf16_f32 v200, v156, v157
    v_mfma_f32_16x16x32_bf16 v[152:155], a[164:167], v[56:59], v[152:155]
    v_exp_f32 v159, v159
    v_mfma_f32_16x16x32_bf16 v[152:155], a[160:163], v[52:55], v[152:155]
    ds_read_b64_tr_b16 a[220:221], v12 offset:49152
    v_mfma_f32_16x16x32_bf16 a[80:83], a[200:203], v[212:215], a[80:83]
    v_exp_f32 v160, v160
    v_mfma_f32_16x16x32_bf16 a[80:83], a[204:207], v[216:219], a[80:83]
    ds_read_b64_tr_b16 a[222:223], v12 offset:53248
    v_cvt_pk_bf16_f32 v201, v158, v159
    v_mfma_f32_16x16x32_bf16 a[84:87], a[204:207], v[224:227], a[84:87]
    v_exp_f32 v161, v161
    v_mfma_f32_16x16x32_bf16 a[84:87], a[200:203], v[220:223], a[84:87]
    ds_read_b128 a[188:191], v4 offset:28672
    v_mfma_f32_16x16x32_bf16 a[88:91], a[200:203], v[228:231], a[88:91]
    v_exp_f32 v162, v162
    v_mfma_f32_16x16x32_bf16 a[88:91], a[204:207], v[232:235], a[88:91]
    v_cvt_pk_bf16_f32 v208, v160, v161
    v_mfma_f32_16x16x32_bf16 a[92:95], a[204:207], v[240:243], a[92:95]
    v_exp_f32 v163, v163
    v_mfma_f32_16x16x32_bf16 a[92:95], a[200:203], v[236:239], a[92:95]
    buffer_load_dwordx4 v18, s[12:15], s29 offen offset:3072 lds
    v_smfmac_f32_16x16x64_bf16 a[232:235], v[244:247], v[228:235], v248
    s_waitcnt vmcnt(8) lgkmcnt(6)
    s_barrier
    s_add_u32 s29, s29, 16384
    v_mfma_f32_16x16x32_bf16 v[156:159], a[160:163], v[68:71], v[108:111]
    v_exp_f32 v164, v164
    v_mfma_f32_16x16x32_bf16 v[156:159], a[164:167], v[72:75], v[156:159]
    ds_read_b64_tr_b16 a[192:193], v5 offset:8192
    v_cvt_pk_bf16_f32 v209, v162, v163
    v_mfma_f32_16x16x32_bf16 v[156:159], a[168:171], v[76:79], v[156:159]
    v_exp_f32 v165, v165
    v_mfma_f32_16x16x32_bf16 v[156:159], a[172:175], v[80:83], v[156:159]
    ds_read_b64_tr_b16 a[194:195], v5 offset:12288
    ds_read_b128 v[24:27], v23 offset:0
    v_mfma_f32_16x16x32_bf16 v[160:163], a[172:175], v[96:99], v[112:115]
    v_exp_f32 v166, v166
    v_mfma_f32_16x16x32_bf16 v[160:163], a[168:171], v[92:95], v[160:163]
    ds_read_b128 a[128:131], v1 offset:32768
    v_cvt_pk_bf16_f32 v186, v164, v165
    v_mfma_f32_16x16x32_bf16 v[160:163], a[164:167], v[88:91], v[160:163]
    v_exp_f32 v167, v167
    v_mfma_f32_16x16x32_bf16 v[160:163], a[160:163], v[84:87], v[160:163]
    ds_read_b64_tr_b16 a[196:197], v5 offset:32768
    ds_read_b128 v[28:31], v23 offset:2560
    v_mfma_f32_16x16x32_bf16 a[96:99], a[208:211], v[212:215], a[96:99]
    v_exp_f32 v168, v168
    v_mfma_f32_16x16x32_bf16 a[96:99], a[212:215], v[216:219], a[96:99]
    ds_read_b64_tr_b16 a[198:199], v5 offset:36864
    v_cvt_pk_bf16_f32 v187, v166, v167
    v_mfma_f32_16x16x32_bf16 a[100:103], a[212:215], v[224:227], a[100:103]
    v_exp_f32 v169, v169
    v_mfma_f32_16x16x32_bf16 a[100:103], a[208:211], v[220:223], a[100:103]
    ds_read_b128 a[132:135], v2 offset:32768
    v_cvt_pk_bf16_f32 v194, v168, v169
    v_mfma_f32_16x16x32_bf16 a[104:107], a[208:211], v[228:231], a[104:107]
    s_mov_b32 m0, s32
    v_exp_f32 v170, v170
    v_mfma_f32_16x16x32_bf16 a[104:107], a[212:215], v[232:235], a[104:107]
    buffer_load_dwordx4 v17, s[12:15], s29 offen offset:0 lds
    v_mfma_f32_16x16x32_bf16 a[108:111], a[212:215], v[240:243], a[108:111]
    v_exp_f32 v171, v171
    v_mfma_f32_16x16x32_bf16 a[108:111], a[208:211], v[236:239], a[108:111]
    s_waitcnt lgkmcnt(6)
    ds_read_b128 v[32:35], v23 offset:5120
    ds_read_b128 v[252:255], v23 offset:7680
    v_mfma_f32_16x16x32_bf16 v[164:167], a[176:179], v[36:39], v[100:103]
    v_exp_f32 v172, v172
    v_mfma_f32_16x16x32_bf16 v[164:167], a[180:183], v[40:43], v[164:167]
    ds_read_b64_tr_b16 a[200:201], v6 offset:8192
    v_cvt_pk_bf16_f32 v195, v170, v171
    v_mfma_f32_16x16x32_bf16 v[164:167], a[184:187], v[44:47], v[164:167]
    v_exp_f32 v173, v173
    v_mfma_f32_16x16x32_bf16 v[164:167], a[188:191], v[48:51], v[164:167]
    ds_read_b64_tr_b16 a[202:203], v6 offset:12288
    v_mfma_f32_16x16x32_bf16 v[168:171], a[188:191], v[64:67], v[104:107]
    v_exp_f32 v174, v174
    v_mfma_f32_16x16x32_bf16 v[168:171], a[184:187], v[60:63], v[168:171]
    ds_read_b128 a[136:139], v3 offset:32768
    v_cvt_pk_bf16_f32 v202, v172, v173
    v_mfma_f32_16x16x32_bf16 v[168:171], a[180:183], v[56:59], v[168:171]
    v_exp_f32 v175, v175
    v_mfma_f32_16x16x32_bf16 v[168:171], a[176:179], v[52:55], v[168:171]
    ds_read_b64_tr_b16 a[204:205], v6 offset:32768
    ds_read_b64_tr_b16 a[240:241], v22 offset:0
    v_mfma_f32_16x16x32_bf16 a[112:115], a[216:219], v[212:215], a[112:115]
    v_exp_f32 v176, v176
    v_mfma_f32_16x16x32_bf16 a[112:115], a[220:223], v[216:219], a[112:115]
    ds_read_b64_tr_b16 a[206:207], v6 offset:36864
    v_cvt_pk_bf16_f32 v203, v174, v175
    v_mfma_f32_16x16x32_bf16 a[116:119], a[220:223], v[224:227], a[116:119]
    v_exp_f32 v177, v177
    v_mfma_f32_16x16x32_bf16 a[116:119], a[216:219], v[220:223], a[116:119]
    ds_read_b128 a[140:143], v4 offset:32768
    ds_read_b64_tr_b16 a[242:243], v22 offset:32
    v_mfma_f32_16x16x32_bf16 a[120:123], a[216:219], v[228:231], a[120:123]
    v_exp_f32 v178, v178
    v_mfma_f32_16x16x32_bf16 a[120:123], a[220:223], v[232:235], a[120:123]
    ds_read_b64_tr_b16 a[244:245], v22 offset:64
    v_cvt_pk_bf16_f32 v210, v176, v177
    v_mfma_f32_16x16x32_bf16 a[124:127], a[220:223], v[240:243], a[124:127]
    v_exp_f32 v179, v179
    v_mfma_f32_16x16x32_bf16 a[124:127], a[216:219], v[236:239], a[124:127]
    buffer_load_dwordx4 v18, s[12:15], s29 offen offset:1024 lds
    v_smfmac_f32_16x16x64_bf16 a[236:239], v[244:247], v[236:243], v248
    s_waitcnt lgkmcnt(6)
    ds_read_b64_tr_b16 a[246:247], v22 offset:96
    v_mfma_f32_16x16x32_bf16 v[172:175], a[176:179], v[68:71], v[108:111]
    v_exp_f32 v116, v116
    v_mfma_f32_16x16x32_bf16 v[172:175], a[180:183], v[72:75], v[172:175]
    ds_read_b64_tr_b16 a[208:209], v7 offset:8192
    v_cvt_pk_bf16_f32 v211, v178, v179
    v_add_f32 v24, v24, v28
    v_mfma_f32_16x16x32_bf16 v[172:175], a[184:187], v[76:79], v[172:175]
    v_exp_f32 v117, v117
    v_add_f32 v25, v25, v29
    v_mfma_f32_16x16x32_bf16 v[172:175], a[188:191], v[80:83], v[172:175]
    ds_read_b64_tr_b16 a[210:211], v7 offset:12288
    v_add_f32 v26, v26, v30
    v_mfma_f32_16x16x32_bf16 v[176:179], a[188:191], v[96:99], v[112:115]
    v_exp_f32 v118, v118
    v_mfma_f32_16x16x32_bf16 v[176:179], a[184:187], v[92:95], v[176:179]
    ds_read_b128 a[144:147], v1 offset:36864
    v_cvt_pk_bf16_f32 v212, v116, v117
    v_add_f32 v27, v27, v31
    v_mfma_f32_16x16x32_bf16 v[176:179], a[180:183], v[88:91], v[176:179]
    v_exp_f32 v119, v119
    v_add_f32 v24, v24, v32
    v_mfma_f32_16x16x32_bf16 v[176:179], a[176:179], v[84:87], v[176:179]
    ds_read_b64_tr_b16 a[212:213], v7 offset:32768
    v_add_f32 v25, v25, v33
    v_mfma_f32_16x16x32_bf16 a[0:3], a[192:195], v[180:183], a[0:3]
    v_exp_f32 v120, v120
    v_mfma_f32_16x16x32_bf16 a[0:3], a[196:199], v[184:187], a[0:3]
    ds_read_b64_tr_b16 a[214:215], v7 offset:36864
    v_cvt_pk_bf16_f32 v213, v118, v119
    v_add_f32 v26, v26, v34
    v_mfma_f32_16x16x32_bf16 a[4:7], a[196:199], v[192:195], a[4:7]
    v_exp_f32 v121, v121
    v_add_f32 v27, v27, v35
    v_mfma_f32_16x16x32_bf16 a[4:7], a[192:195], v[188:191], a[4:7]
    ds_read_b128 a[148:151], v2 offset:36864
    v_cvt_pk_bf16_f32 v220, v120, v121
    v_add_f32 v24, v24, v252
    v_mfma_f32_16x16x32_bf16 a[8:11], a[192:195], v[196:199], a[8:11]
    v_exp_f32 v122, v122
    v_mfma_f32_16x16x32_bf16 a[8:11], a[196:199], v[200:203], a[8:11]
    buffer_load_dwordx4 v17, s[12:15], s29 offen offset:2048 lds
    v_add_f32 v25, v25, v253
    v_mfma_f32_16x16x32_bf16 a[12:15], a[196:199], v[208:211], a[12:15]
    v_exp_f32 v123, v123
    v_add_f32 v26, v26, v254
    v_mfma_f32_16x16x32_bf16 a[12:15], a[192:195], v[204:207], a[12:15]
    s_waitcnt lgkmcnt(6)
    ds_read_b64_tr_b16 a[248:249], v22 offset:128
    v_add_f32 v27, v27, v255
    v_mfma_f32_16x16x32_bf16 v[116:119], a[128:131], v[36:39], v[100:103]
    v_exp_f32 v124, v124
    v_mfma_f32_16x16x32_bf16 v[116:119], a[132:135], v[40:43], v[116:119]
    ds_read_b64_tr_b16 a[216:217], v8 offset:8192
    v_cvt_pk_bf16_f32 v221, v122, v123
    v_mov_b32_dpp v28, v24 row_newbcast:8 row_mask:0xf bank_mask:0xf
    v_mfma_f32_16x16x32_bf16 v[116:119], a[136:139], v[44:47], v[116:119]
    v_exp_f32 v125, v125
    v_mov_b32_dpp v29, v25 row_newbcast:8 row_mask:0xf bank_mask:0xf
    v_mfma_f32_16x16x32_bf16 v[116:119], a[140:143], v[48:51], v[116:119]
    ds_read_b64_tr_b16 a[218:219], v8 offset:12288
    v_mov_b32_dpp v30, v26 row_newbcast:8 row_mask:0xf bank_mask:0xf
    v_mfma_f32_16x16x32_bf16 v[120:123], a[140:143], v[64:67], v[104:107]
    v_exp_f32 v126, v126
    v_mfma_f32_16x16x32_bf16 v[120:123], a[136:139], v[60:63], v[120:123]
    ds_read_b128 a[152:155], v3 offset:36864
    v_cvt_pk_bf16_f32 v228, v124, v125
    v_mov_b32_dpp v31, v27 row_newbcast:8 row_mask:0xf bank_mask:0xf
    v_mfma_f32_16x16x32_bf16 v[120:123], a[132:135], v[56:59], v[120:123]
    v_exp_f32 v127, v127
    v_mfma_f32_16x16x32_bf16 v[120:123], a[128:131], v[52:55], v[120:123]
    ds_read_b64_tr_b16 a[220:221], v8 offset:32768
    v_fma_f32 v24, -v20, v28, v24
    v_mfma_f32_16x16x32_bf16 a[16:19], a[200:203], v[180:183], a[16:19]
    v_exp_f32 v128, v128
    v_fma_f32 v25, -v20, v29, v25
    v_mfma_f32_16x16x32_bf16 a[16:19], a[204:207], v[184:187], a[16:19]
    ds_read_b64_tr_b16 a[222:223], v8 offset:36864
    v_cvt_pk_bf16_f32 v229, v126, v127
    v_fma_f32 v26, -v20, v30, v26
    v_mfma_f32_16x16x32_bf16 a[20:23], a[204:207], v[192:195], a[20:23]
    v_exp_f32 v129, v129
    v_mfma_f32_16x16x32_bf16 a[20:23], a[200:203], v[188:191], a[20:23]
    ds_read_b128 a[156:159], v4 offset:36864
    v_fma_f32 v27, -v20, v31, v27
    v_mfma_f32_16x16x32_bf16 a[24:27], a[200:203], v[196:199], a[24:27]
    v_exp_f32 v130, v130
    v_mul_f32 v24, v24, v21
    v_mfma_f32_16x16x32_bf16 a[24:27], a[204:207], v[200:203], a[24:27]
    v_cvt_pk_bf16_f32 v236, v128, v129
    v_mul_f32 v25, v25, v21
    v_mfma_f32_16x16x32_bf16 a[28:31], a[204:207], v[208:211], a[28:31]
    v_exp_f32 v131, v131
    v_mfma_f32_16x16x32_bf16 a[28:31], a[200:203], v[204:207], a[28:31]
    buffer_load_dwordx4 v18, s[12:15], s29 offen offset:3072 lds
    v_mul_f32 v26, v26, v21
    v_smfmac_f32_16x16x64_bf16 a[224:227], v[244:247], v[180:187], v248
    s_waitcnt lgkmcnt(6)
    s_add_u32 s29, s29, 16384
    ds_read_b64_tr_b16 a[250:251], v22 offset:160
    ds_read_b64_tr_b16 a[252:253], v22 offset:192
    ds_read_b64_tr_b16 a[254:255], v22 offset:224
    v_mul_f32 v27, v27, v21
    v_cvt_pk_bf16_f32 v28, v24, v25
    v_mfma_f32_16x16x32_bf16 v[124:127], a[128:131], v[68:71], v[108:111]
    v_exp_f32 v132, v132
    v_mfma_f32_16x16x32_bf16 v[124:127], a[132:135], v[72:75], v[124:127]
    ds_read_b64_tr_b16 a[192:193], v9 offset:8192
    v_cvt_pk_bf16_f32 v237, v130, v131
    v_mfma_f32_16x16x32_bf16 v[124:127], a[136:139], v[76:79], v[124:127]
    v_exp_f32 v133, v133
    v_cvt_pk_bf16_f32 v29, v26, v27
    v_mfma_f32_16x16x32_bf16 v[124:127], a[140:143], v[80:83], v[124:127]
    ds_read_b64_tr_b16 a[194:195], v9 offset:12288
    v_lshlrev_b32 v24, 16, v28
    v_mfma_f32_16x16x32_bf16 v[128:131], a[140:143], v[96:99], v[112:115]
    v_exp_f32 v134, v134
    v_mfma_f32_16x16x32_bf16 v[128:131], a[136:139], v[92:95], v[128:131]
    ds_read_b128 a[160:163], v1 offset:40960
    v_cvt_pk_bf16_f32 v214, v132, v133
    v_and_b32 v25, 0xffff0000, v28
    v_mfma_f32_16x16x32_bf16 v[128:131], a[132:135], v[88:91], v[128:131]
    v_exp_f32 v135, v135
    v_lshlrev_b32 v26, 16, v29
    v_mfma_f32_16x16x32_bf16 v[128:131], a[128:131], v[84:87], v[128:131]
    ds_read_b64_tr_b16 a[196:197], v9 offset:32768
    v_and_b32 v27, 0xffff0000, v29
    v_mfma_f32_16x16x32_bf16 a[32:35], a[208:211], v[180:183], a[32:35]
    v_exp_f32 v136, v136
    v_mfma_f32_16x16x32_bf16 a[32:35], a[212:215], v[184:187], a[32:35]
    ds_read_b64_tr_b16 a[198:199], v9 offset:36864
    v_cvt_pk_bf16_f32 v215, v134, v135
    v_mov_b32 v32, v24
    v_mfma_f32_16x16x32_bf16 a[36:39], a[212:215], v[192:195], a[36:39]
    v_exp_f32 v137, v137
    v_mov_b32 v33, v25
    v_mfma_f32_16x16x32_bf16 a[36:39], a[208:211], v[188:191], a[36:39]
    ds_read_b128 a[164:167], v2 offset:40960
    v_mov_b32 v34, v26
    v_mfma_f32_16x16x32_bf16 a[40:43], a[208:211], v[196:199], a[40:43]
    v_exp_f32 v138, v138
    v_mfma_f32_16x16x32_bf16 a[40:43], a[212:215], v[200:203], a[40:43]
    v_cvt_pk_bf16_f32 v222, v136, v137
    v_mov_b32 v35, v27
    v_mfma_f32_16x16x32_bf16 a[44:47], a[212:215], v[208:211], a[44:47]
    v_exp_f32 v139, v139
    v_permlane32_swap_b32 v24, v32
    v_mfma_f32_16x16x32_bf16 a[44:47], a[208:211], v[204:207], a[44:47]
    s_waitcnt lgkmcnt(6)
    v_permlane32_swap_b32 v25, v33
    v_mfma_f32_16x16x32_bf16 v[132:135], a[144:147], v[36:39], v[100:103]
    v_exp_f32 v140, v140
    v_mfma_f32_16x16x32_bf16 v[132:135], a[148:151], v[40:43], v[132:135]
    ds_read_b64_tr_b16 a[200:201], v10 offset:8192
    v_cvt_pk_bf16_f32 v223, v138, v139
    v_permlane32_swap_b32 v26, v34
    v_mfma_f32_16x16x32_bf16 v[132:135], a[152:155], v[44:47], v[132:135]
    v_exp_f32 v141, v141
    v_permlane32_swap_b32 v27, v35
    v_mfma_f32_16x16x32_bf16 v[132:135], a[156:159], v[48:51], v[132:135]
    ds_read_b64_tr_b16 a[202:203], v10 offset:12288
    v_mul_f32 v28, 0xbfb8aa3b, v24
    v_mfma_f32_16x16x32_bf16 v[136:139], a[156:159], v[64:67], v[104:107]
    v_exp_f32 v142, v142
    v_mfma_f32_16x16x32_bf16 v[136:139], a[152:155], v[60:63], v[136:139]
    ds_read_b128 a[168:171], v3 offset:40960
    v_cvt_pk_bf16_f32 v230, v140, v141
    v_mul_f32 v29, 0xbfb8aa3b, v25
    v_mfma_f32_16x16x32_bf16 v[136:139], a[148:151], v[56:59], v[136:139]
    v_exp_f32 v143, v143
    v_mfma_f32_16x16x32_bf16 v[136:139], a[144:147], v[52:55], v[136:139]
    ds_read_b64_tr_b16 a[204:205], v10 offset:32768
    v_mul_f32 v30, 0xbfb8aa3b, v26
    v_mfma_f32_16x16x32_bf16 a[48:51], a[216:219], v[180:183], a[48:51]
    v_exp_f32 v144, v144
    v_mul_f32 v31, 0xbfb8aa3b, v27
    v_mfma_f32_16x16x32_bf16 a[48:51], a[220:223], v[184:187], a[48:51]
    ds_read_b64_tr_b16 a[206:207], v10 offset:36864
    v_cvt_pk_bf16_f32 v231, v142, v143
    v_exp_f32 v28, v28
    v_mfma_f32_16x16x32_bf16 a[52:55], a[220:223], v[192:195], a[52:55]
    v_exp_f32 v145, v145
    v_mfma_f32_16x16x32_bf16 a[52:55], a[216:219], v[188:191], a[52:55]
    ds_read_b128 a[172:175], v4 offset:40960
    v_exp_f32 v29, v29
    v_mfma_f32_16x16x32_bf16 a[56:59], a[216:219], v[196:199], a[56:59]
    v_exp_f32 v146, v146
    v_exp_f32 v30, v30
    v_mfma_f32_16x16x32_bf16 a[56:59], a[220:223], v[200:203], a[56:59]
    v_cvt_pk_bf16_f32 v238, v144, v145
    v_mfma_f32_16x16x32_bf16 a[60:63], a[220:223], v[208:211], a[60:63]
    v_exp_f32 v147, v147
    v_exp_f32 v31, v31
    v_mfma_f32_16x16x32_bf16 a[60:63], a[216:219], v[204:207], a[60:63]
    v_add_f32 v28, 1.0, v28
    v_add_f32 v29, 1.0, v29
    v_smfmac_f32_16x16x64_bf16 a[228:231], v[244:247], v[188:195], v248
    s_waitcnt lgkmcnt(6)
    v_add_f32 v30, 1.0, v30
    v_add_f32 v31, 1.0, v31
    v_mfma_f32_16x16x32_bf16 v[140:143], a[144:147], v[68:71], v[108:111]
    v_exp_f32 v148, v148
    v_mfma_f32_16x16x32_bf16 v[140:143], a[148:151], v[72:75], v[140:143]
    ds_read_b64_tr_b16 a[208:209], v11 offset:8192
    v_cvt_pk_bf16_f32 v239, v146, v147
    v_mfma_f32_16x16x32_bf16 v[140:143], a[152:155], v[76:79], v[140:143]
    v_exp_f32 v149, v149
    v_mfma_f32_16x16x32_bf16 v[140:143], a[156:159], v[80:83], v[140:143]
    ds_read_b64_tr_b16 a[210:211], v11 offset:12288
    v_rcp_f32 v28, v28
    v_mfma_f32_16x16x32_bf16 v[144:147], a[156:159], v[96:99], v[112:115]
    v_exp_f32 v150, v150
    v_mfma_f32_16x16x32_bf16 v[144:147], a[152:155], v[92:95], v[144:147]
    ds_read_b128 a[176:179], v1 offset:45056
    v_cvt_pk_bf16_f32 v216, v148, v149
    v_rcp_f32 v29, v29
    v_mfma_f32_16x16x32_bf16 v[144:147], a[148:151], v[88:91], v[144:147]
    v_exp_f32 v151, v151
    v_rcp_f32 v30, v30
    v_mfma_f32_16x16x32_bf16 v[144:147], a[144:147], v[84:87], v[144:147]
    ds_read_b64_tr_b16 a[212:213], v11 offset:32768
    v_rcp_f32 v31, v31
    v_mfma_f32_16x16x32_bf16 a[64:67], a[192:195], v[180:183], a[64:67]
    v_exp_f32 v152, v152
    v_mfma_f32_16x16x32_bf16 a[64:67], a[196:199], v[184:187], a[64:67]
    ds_read_b64_tr_b16 a[214:215], v11 offset:36864
    v_cvt_pk_bf16_f32 v217, v150, v151
    v_mul_f32 v24, v24, v28
    v_mfma_f32_16x16x32_bf16 a[68:71], a[196:199], v[192:195], a[68:71]
    v_exp_f32 v153, v153
    v_mul_f32 v25, v25, v29
    v_mfma_f32_16x16x32_bf16 a[68:71], a[192:195], v[188:191], a[68:71]
    ds_read_b128 a[180:183], v2 offset:45056
    v_mul_f32 v26, v26, v30
    v_mfma_f32_16x16x32_bf16 a[72:75], a[192:195], v[196:199], a[72:75]
    v_exp_f32 v154, v154
    v_mfma_f32_16x16x32_bf16 a[72:75], a[196:199], v[200:203], a[72:75]
    v_cvt_pk_bf16_f32 v224, v152, v153
    v_mul_f32 v27, v27, v31
    v_mfma_f32_16x16x32_bf16 a[76:79], a[196:199], v[208:211], a[76:79]
    v_exp_f32 v155, v155
    v_cvt_pk_bf16_f32 v28, v24, v25
    v_mfma_f32_16x16x32_bf16 a[76:79], a[192:195], v[204:207], a[76:79]
    s_waitcnt lgkmcnt(6)
    v_cvt_pk_bf16_f32 v29, v26, v27
    v_lshlrev_b32 v24, 16, v28
    v_mfma_f32_16x16x32_bf16 v[148:151], a[160:163], v[36:39], v[100:103]
    v_exp_f32 v156, v156
    v_mfma_f32_16x16x32_bf16 v[148:151], a[164:167], v[40:43], v[148:151]
    ds_read_b64_tr_b16 a[216:217], v12 offset:8192
    v_cvt_pk_bf16_f32 v225, v154, v155
    v_mfma_f32_16x16x32_bf16 v[148:151], a[168:171], v[44:47], v[148:151]
    v_exp_f32 v157, v157
    v_and_b32 v25, 0xffff0000, v28
    v_mfma_f32_16x16x32_bf16 v[148:151], a[172:175], v[48:51], v[148:151]
    ds_read_b64_tr_b16 a[218:219], v12 offset:12288
    v_lshlrev_b32 v26, 16, v29
    v_mfma_f32_16x16x32_bf16 v[152:155], a[172:175], v[64:67], v[104:107]
    v_exp_f32 v158, v158
    v_mfma_f32_16x16x32_bf16 v[152:155], a[168:171], v[60:63], v[152:155]
    ds_read_b128 a[184:187], v3 offset:45056
    v_cvt_pk_bf16_f32 v232, v156, v157
    v_and_b32 v27, 0xffff0000, v29
    v_mfma_f32_16x16x32_bf16 v[152:155], a[164:167], v[56:59], v[152:155]
    v_exp_f32 v159, v159
    v_mfma_f32_16x16x32_bf16 v[152:155], a[160:163], v[52:55], v[152:155]
    ds_read_b64_tr_b16 a[220:221], v12 offset:32768
    v_mul_f32 v24, v24, v32
    v_mfma_f32_16x16x32_bf16 a[80:83], a[200:203], v[180:183], a[80:83]
    v_exp_f32 v160, v160
    v_mul_f32 v25, v25, v33
    v_mfma_f32_16x16x32_bf16 a[80:83], a[204:207], v[184:187], a[80:83]
    ds_read_b64_tr_b16 a[222:223], v12 offset:36864
    v_cvt_pk_bf16_f32 v233, v158, v159
    v_mul_f32 v26, v26, v34
    v_mfma_f32_16x16x32_bf16 a[84:87], a[204:207], v[192:195], a[84:87]
    v_exp_f32 v161, v161
    v_mfma_f32_16x16x32_bf16 a[84:87], a[200:203], v[188:191], a[84:87]
    ds_read_b128 a[188:191], v4 offset:45056
    v_mul_f32 v27, v27, v35
    v_mfma_f32_16x16x32_bf16 a[88:91], a[200:203], v[196:199], a[88:91]
    v_exp_f32 v162, v162
    v_cmp_gt_u32 vcc, 32, v19
    v_mfma_f32_16x16x32_bf16 a[88:91], a[204:207], v[200:203], a[88:91]
    v_cvt_pk_bf16_f32 v240, v160, v161
    v_cvt_pk_bf16_f32 v252, v24, v25
    v_mfma_f32_16x16x32_bf16 a[92:95], a[204:207], v[208:211], a[92:95]
    v_exp_f32 v163, v163
    v_mfma_f32_16x16x32_bf16 a[92:95], a[200:203], v[204:207], a[92:95]
    v_cvt_pk_bf16_f32 v253, v26, v27
    v_cndmask_b32 v252, 0, v252, vcc
    v_smfmac_f32_16x16x64_bf16 a[232:235], v[244:247], v[196:203], v248
    s_waitcnt vmcnt(4) lgkmcnt(0)
    s_barrier
    v_cndmask_b32 v253, 0, v253, vcc
    v_and_b32 v23, 7, v19
    v_mfma_f32_16x16x32_bf16 v[156:159], a[160:163], v[68:71], v[108:111]
    v_exp_f32 v164, v164
    v_mfma_f32_16x16x32_bf16 v[156:159], a[164:167], v[72:75], v[156:159]
    ds_read_b64_tr_b16 a[192:193], v5 offset:16384
    v_cvt_pk_bf16_f32 v241, v162, v163
    v_mfma_f32_16x16x32_bf16 v[156:159], a[168:171], v[76:79], v[156:159]
    v_exp_f32 v165, v165
    v_mfma_f32_16x16x32_bf16 v[156:159], a[172:175], v[80:83], v[156:159]
    ds_read_b64_tr_b16 a[194:195], v5 offset:20480
    v_mul_u32_u24 v23, 34560, v23
    v_mfma_f32_16x16x32_bf16 v[160:163], a[172:175], v[96:99], v[112:115]
    v_exp_f32 v166, v166
    v_mfma_f32_16x16x32_bf16 v[160:163], a[168:171], v[92:95], v[160:163]
    ds_read_b128 a[128:131], v1 offset:0
    v_cvt_pk_bf16_f32 v218, v164, v165
    v_lshrrev_b32 v0, 4, v19
    v_mfma_f32_16x16x32_bf16 v[160:163], a[164:167], v[88:91], v[160:163]
    v_exp_f32 v167, v167
    v_add_u32 v23, v23, v0
    v_mfma_f32_16x16x32_bf16 v[160:163], a[160:163], v[84:87], v[160:163]
    ds_read_b64_tr_b16 a[196:197], v5 offset:40960
    v_and_b32 v0, 8, v19
    v_mfma_f32_16x16x32_bf16 a[96:99], a[208:211], v[180:183], a[96:99]
    v_exp_f32 v168, v168
    v_mfma_f32_16x16x32_bf16 a[96:99], a[212:215], v[184:187], a[96:99]
    ds_read_b64_tr_b16 a[198:199], v5 offset:45056
    v_cvt_pk_bf16_f32 v219, v166, v167
    v_lshrrev_b32 v0, 1, v0
    v_mfma_f32_16x16x32_bf16 a[100:103], a[212:215], v[192:195], a[100:103]
    v_exp_f32 v169, v169
    v_add_lshl_u32 v23, v23, v0, 4
    v_mfma_f32_16x16x32_bf16 a[100:103], a[208:211], v[188:191], a[100:103]
    s_mul_i32 s42, s5, 1080
    ds_read_b128 a[132:135], v2 offset:0
    v_cvt_pk_bf16_f32 v226, v168, v169
    v_mfma_f32_16x16x32_bf16 a[104:107], a[208:211], v[196:199], a[104:107]
    s_mov_b32 m0, s33
    v_exp_f32 v170, v170
    v_mfma_f32_16x16x32_bf16 a[104:107], a[212:215], v[200:203], a[104:107]
    s_add_u32 s42, s42, s6
    buffer_load_dwordx4 v17, s[12:15], s29 offen offset:0 lds
    v_mfma_f32_16x16x32_bf16 a[108:111], a[212:215], v[208:211], a[108:111]
    s_lshl_b32 s42, s42, 7
    v_exp_f32 v171, v171
    v_mfma_f32_16x16x32_bf16 a[108:111], a[208:211], v[204:207], a[108:111]
    s_waitcnt lgkmcnt(6)
    s_cmp_lt_u32 s6, 216
    s_cselect_b32 s42, s42, 0x438000
    v_mfma_f32_16x16x32_bf16 v[164:167], a[176:179], v[36:39], v[100:103]
    v_exp_f32 v172, v172
    v_mfma_f32_16x16x16_bf16 v[24:27], a[240:241], v[252:253], 0
    v_mfma_f32_16x16x16_bf16 v[28:31], a[242:243], v[252:253], 0
    s_nop 0
    v_mfma_f32_16x16x32_bf16 v[164:167], a[180:183], v[40:43], v[164:167]
    s_nop 0
    ds_read_b64_tr_b16 a[200:201], v6 offset:16384
    v_cvt_pk_bf16_f32 v227, v170, v171
    v_mfma_f32_16x16x32_bf16 v[164:167], a[184:187], v[44:47], v[164:167]
    s_nop 0
    v_exp_f32 v173, v173
    v_mfma_f32_16x16x32_bf16 v[164:167], a[188:191], v[48:51], v[164:167]
    s_nop 0
    ds_read_b64_tr_b16 a[202:203], v6 offset:20480
    v_mov_b32_dpp v24, v28 row_shr:8 row_mask:0xf bank_mask:0xc
    v_mfma_f32_16x16x32_bf16 v[168:171], a[188:191], v[64:67], v[104:107]
    v_exp_f32 v174, v174
    v_mfma_f32_16x16x32_bf16 v[168:171], a[184:187], v[60:63], v[168:171]
    ds_read_b128 a[136:139], v3 offset:0
    v_cvt_pk_bf16_f32 v234, v172, v173
    v_mfma_f32_16x16x32_bf16 v[168:171], a[180:183], v[56:59], v[168:171]
    v_exp_f32 v175, v175
    v_mfma_f32_16x16x32_bf16 v[168:171], a[176:179], v[52:55], v[168:171]
    ds_read_b64_tr_b16 a[204:205], v6 offset:40960
    v_mov_b32_dpp v25, v29 row_shr:8 row_mask:0xf bank_mask:0xc
    v_mfma_f32_16x16x32_bf16 a[112:115], a[216:219], v[180:183], a[112:115]
    v_exp_f32 v176, v176
    v_mfma_f32_16x16x32_bf16 a[112:115], a[220:223], v[184:187], a[112:115]
    ds_read_b64_tr_b16 a[206:207], v6 offset:45056
    v_cvt_pk_bf16_f32 v235, v174, v175
    v_mfma_f32_16x16x32_bf16 a[116:119], a[220:223], v[192:195], a[116:119]
    v_exp_f32 v177, v177
    v_mov_b32_dpp v26, v30 row_shr:8 row_mask:0xf bank_mask:0xc
    v_mfma_f32_16x16x32_bf16 a[116:119], a[216:219], v[188:191], a[116:119]
    ds_read_b128 a[140:143], v4 offset:0
    v_mov_b32_dpp v27, v31 row_shr:8 row_mask:0xf bank_mask:0xc
    v_mfma_f32_16x16x32_bf16 a[120:123], a[216:219], v[196:199], a[120:123]
    v_exp_f32 v178, v178
    v_mfma_f32_16x16x32_bf16 a[120:123], a[220:223], v[200:203], a[120:123]
    buffer_store_dwordx4 v[24:27], v23, s[16:19], s42 offen sc1
    v_cvt_pk_bf16_f32 v242, v176, v177
    v_mfma_f32_16x16x32_bf16 a[124:127], a[220:223], v[208:211], a[124:127]
    s_add_u32 s42, s42, 27648
    v_exp_f32 v179, v179
    v_mfma_f32_16x16x32_bf16 a[124:127], a[216:219], v[204:207], a[124:127]
    buffer_load_dwordx4 v18, s[12:15], s29 offen offset:1024 lds
    v_smfmac_f32_16x16x64_bf16 a[236:239], v[244:247], v[204:211], v248
    s_waitcnt lgkmcnt(6)
    ds_read_b64_tr_b16 a[240:241], v22 offset:256
    ds_read_b64_tr_b16 a[242:243], v22 offset:288
    v_mfma_f32_16x16x32_bf16 v[172:175], a[176:179], v[68:71], v[108:111]
    v_exp_f32 v116, v116
    v_mfma_f32_16x16x16_bf16 v[32:35], a[244:245], v[252:253], 0
    v_mfma_f32_16x16x16_bf16 v[28:31], a[246:247], v[252:253], 0
    s_nop 0
    v_mfma_f32_16x16x32_bf16 v[172:175], a[180:183], v[72:75], v[172:175]
    s_nop 0
    ds_read_b64_tr_b16 a[208:209], v7 offset:16384
    v_cvt_pk_bf16_f32 v243, v178, v179
    v_mfma_f32_16x16x32_bf16 v[172:175], a[184:187], v[76:79], v[172:175]
    s_nop 0
    v_exp_f32 v117, v117
    v_mfma_f32_16x16x32_bf16 v[172:175], a[188:191], v[80:83], v[172:175]
    s_nop 0
    ds_read_b64_tr_b16 a[210:211], v7 offset:20480
    v_mov_b32_dpp v32, v28 row_shr:8 row_mask:0xf bank_mask:0xc
    v_mfma_f32_16x16x32_bf16 v[176:179], a[188:191], v[96:99], v[112:115]
    s_mul_i32 s46, s5, 10240
    v_exp_f32 v118, v118
    v_mfma_f32_16x16x32_bf16 v[176:179], a[184:187], v[92:95], v[176:179]
    s_mul_i32 s40, s100, 655360
    ds_read_b128 a[144:147], v1 offset:4096
    v_cvt_pk_bf16_f32 v180, v116, v117
    v_mfma_f32_16x16x32_bf16 v[176:179], a[180:183], v[88:91], v[176:179]
    s_add_u32 s40, s40, 0x1400000
    v_exp_f32 v119, v119
    v_mfma_f32_16x16x32_bf16 v[176:179], a[176:179], v[84:87], v[176:179]
    s_add_u32 s20, s72, s40
    s_addc_u32 s21, s73, 0
    ds_read_b64_tr_b16 a[212:213], v7 offset:40960
    v_mov_b32_dpp v33, v29 row_shr:8 row_mask:0xf bank_mask:0xc
    v_mfma_f32_16x16x32_bf16 a[0:3], a[192:195], v[212:215], a[0:3]
    s_mov_b32 s22, 0xa0000
    v_exp_f32 v120, v120
    v_mfma_f32_16x16x32_bf16 a[0:3], a[196:199], v[216:219], a[0:3]
    s_mov_b32 s23, 0x20000
    ds_read_b64_tr_b16 a[214:215], v7 offset:45056
    v_cvt_pk_bf16_f32 v181, v118, v119
    v_mfma_f32_16x16x32_bf16 a[4:7], a[196:199], v[224:227], a[4:7]
    s_mul_i32 s40, s5, 5120
    v_exp_f32 v121, v121
    v_mfma_f32_16x16x32_bf16 a[4:7], a[192:195], v[220:223], a[4:7]
    ds_read_b128 a[148:151], v2 offset:4096
    v_cvt_pk_bf16_f32 v188, v120, v121
    v_mov_b32_dpp v34, v30 row_shr:8 row_mask:0xf bank_mask:0xc
    v_mfma_f32_16x16x32_bf16 a[8:11], a[192:195], v[228:231], a[8:11]
    v_exp_f32 v122, v122
    v_mfma_f32_16x16x32_bf16 a[8:11], a[196:199], v[232:235], a[8:11]
    buffer_load_dwordx4 v17, s[12:15], s29 offen offset:2048 lds
    v_mov_b32_dpp v35, v31 row_shr:8 row_mask:0xf bank_mask:0xc
    v_mfma_f32_16x16x32_bf16 a[12:15], a[196:199], v[240:243], a[12:15]
    buffer_store_dwordx4 v[32:35], v23, s[16:19], s42 offen sc1
    v_exp_f32 v123, v123
    v_mfma_f32_16x16x32_bf16 a[12:15], a[192:195], v[236:239], a[12:15]
    s_waitcnt lgkmcnt(6)
    s_add_u32 s42, s42, 27648
    v_lshl_add_u32 v20, v19, 4, s40
    v_add_u32 v21, 4096, v20
    v_mfma_f32_16x16x32_bf16 v[116:119], a[128:131], v[36:39], v[100:103]
    v_exp_f32 v124, v124
    v_mfma_f32_16x16x16_bf16 v[24:27], a[248:249], v[252:253], 0
    v_mfma_f32_16x16x16_bf16 v[28:31], a[250:251], v[252:253], 0
    s_nop 0
    v_mfma_f32_16x16x32_bf16 v[116:119], a[132:135], v[40:43], v[116:119]
    s_nop 0
    ds_read_b64_tr_b16 a[216:217], v8 offset:16384
    v_cvt_pk_bf16_f32 v189, v122, v123
    v_mfma_f32_16x16x32_bf16 v[116:119], a[136:139], v[44:47], v[116:119]
    s_nop 0
    v_exp_f32 v125, v125
    v_mfma_f32_16x16x32_bf16 v[116:119], a[140:143], v[48:51], v[116:119]
    s_nop 0
    ds_read_b64_tr_b16 a[218:219], v8 offset:20480
    v_mov_b32_dpp v24, v28 row_shr:8 row_mask:0xf bank_mask:0xc
    v_mfma_f32_16x16x32_bf16 v[120:123], a[140:143], v[64:67], v[104:107]
    v_exp_f32 v126, v126
    v_mfma_f32_16x16x32_bf16 v[120:123], a[136:139], v[60:63], v[120:123]
    ds_read_b128 a[152:155], v3 offset:4096
    v_cvt_pk_bf16_f32 v196, v124, v125
    v_mfma_f32_16x16x32_bf16 v[120:123], a[132:135], v[56:59], v[120:123]
    v_exp_f32 v127, v127
    v_mfma_f32_16x16x32_bf16 v[120:123], a[128:131], v[52:55], v[120:123]
    ds_read_b64_tr_b16 a[220:221], v8 offset:40960
    v_mov_b32_dpp v25, v29 row_shr:8 row_mask:0xf bank_mask:0xc
    v_mfma_f32_16x16x32_bf16 a[16:19], a[200:203], v[212:215], a[16:19]
    v_exp_f32 v128, v128
    v_mfma_f32_16x16x32_bf16 a[16:19], a[204:207], v[216:219], a[16:19]
    ds_read_b64_tr_b16 a[222:223], v8 offset:45056
    v_cvt_pk_bf16_f32 v197, v126, v127
    v_mfma_f32_16x16x32_bf16 a[20:23], a[204:207], v[224:227], a[20:23]
    v_exp_f32 v129, v129
    v_mfma_f32_16x16x32_bf16 a[20:23], a[200:203], v[220:223], a[20:23]
    ds_read_b128 a[156:159], v4 offset:4096
    v_mov_b32_dpp v26, v30 row_shr:8 row_mask:0xf bank_mask:0xc
    v_mfma_f32_16x16x32_bf16 a[24:27], a[200:203], v[228:231], a[24:27]
    v_exp_f32 v130, v130
    v_mfma_f32_16x16x32_bf16 a[24:27], a[204:207], v[232:235], a[24:27]
    v_cvt_pk_bf16_f32 v204, v128, v129
    v_mov_b32_dpp v27, v31 row_shr:8 row_mask:0xf bank_mask:0xc
    v_mfma_f32_16x16x32_bf16 a[28:31], a[204:207], v[240:243], a[28:31]
    v_exp_f32 v131, v131
    v_mfma_f32_16x16x32_bf16 a[28:31], a[200:203], v[236:239], a[28:31]
    buffer_load_dwordx4 v18, s[12:15], s29 offen offset:3072 lds
    buffer_store_dwordx4 v[24:27], v23, s[16:19], s42 offen sc1
    v_smfmac_f32_16x16x64_bf16 a[224:227], v[244:247], v[212:219], v248
    s_waitcnt lgkmcnt(6)
    s_add_u32 s29, s29, 16384
    s_add_u32 s42, s42, 27648
    v_mfma_f32_16x16x32_bf16 v[124:127], a[128:131], v[68:71], v[108:111]
    v_exp_f32 v132, v132
    v_mfma_f32_16x16x16_bf16 v[32:35], a[252:253], v[252:253], 0
    v_mfma_f32_16x16x16_bf16 v[28:31], a[254:255], v[252:253], 0
    s_nop 0
    v_mfma_f32_16x16x32_bf16 v[124:127], a[132:135], v[72:75], v[124:127]
    s_nop 0
    ds_read_b64_tr_b16 a[192:193], v9 offset:16384
    v_cvt_pk_bf16_f32 v205, v130, v131
    v_mfma_f32_16x16x32_bf16 v[124:127], a[136:139], v[76:79], v[124:127]
    s_nop 0
    v_exp_f32 v133, v133
    v_mfma_f32_16x16x32_bf16 v[124:127], a[140:143], v[80:83], v[124:127]
    s_nop 0
    ds_read_b64_tr_b16 a[194:195], v9 offset:20480
    v_mov_b32_dpp v32, v28 row_shr:8 row_mask:0xf bank_mask:0xc
    v_mfma_f32_16x16x32_bf16 v[128:131], a[140:143], v[96:99], v[112:115]
    s_add_u32 m0, s46, 122880
    v_exp_f32 v134, v134
    v_mfma_f32_16x16x32_bf16 v[128:131], a[136:139], v[92:95], v[128:131]
    s_mov_b32 s45, 286720
    ds_read_b128 a[160:163], v1 offset:8192
    v_cvt_pk_bf16_f32 v182, v132, v133
    v_mfma_f32_16x16x32_bf16 v[128:131], a[132:135], v[88:91], v[128:131]
    v_exp_f32 v135, v135
    v_mfma_f32_16x16x32_bf16 v[128:131], a[128:131], v[84:87], v[128:131]
    ds_read_b64_tr_b16 a[196:197], v9 offset:40960
    v_mov_b32_dpp v33, v29 row_shr:8 row_mask:0xf bank_mask:0xc
    v_mfma_f32_16x16x32_bf16 a[32:35], a[208:211], v[212:215], a[32:35]
    v_exp_f32 v136, v136
    v_mfma_f32_16x16x32_bf16 a[32:35], a[212:215], v[216:219], a[32:35]
    ds_read_b64_tr_b16 a[198:199], v9 offset:45056
    v_cvt_pk_bf16_f32 v183, v134, v135
    v_mfma_f32_16x16x32_bf16 a[36:39], a[212:215], v[224:227], a[36:39]
    v_exp_f32 v137, v137
    v_mfma_f32_16x16x32_bf16 a[36:39], a[208:211], v[220:223], a[36:39]
    ds_read_b128 a[164:167], v2 offset:8192
    v_mov_b32_dpp v34, v30 row_shr:8 row_mask:0xf bank_mask:0xc
    v_mfma_f32_16x16x32_bf16 a[40:43], a[208:211], v[228:231], a[40:43]
    v_exp_f32 v138, v138
    v_mfma_f32_16x16x32_bf16 a[40:43], a[212:215], v[232:235], a[40:43]
    v_cvt_pk_bf16_f32 v190, v136, v137
    v_mov_b32_dpp v35, v31 row_shr:8 row_mask:0xf bank_mask:0xc
    v_mfma_f32_16x16x32_bf16 a[44:47], a[212:215], v[240:243], a[44:47]
    buffer_store_dwordx4 v[32:35], v23, s[16:19], s42 offen sc1
    v_exp_f32 v139, v139
    v_mfma_f32_16x16x32_bf16 a[44:47], a[208:211], v[236:239], a[44:47]
    s_waitcnt lgkmcnt(6)
    s_add_u32 s42, s42, 27648
    buffer_load_dwordx4 v20, s[20:23], s45 offen offset:0 sc1 lds
    v_mfma_f32_16x16x32_bf16 v[132:135], a[144:147], v[36:39], v[100:103]
    v_exp_f32 v140, v140
    v_mfma_f32_16x16x16_bf16 v[24:27], a[240:241], v[252:253], 0
    v_mfma_f32_16x16x16_bf16 v[28:31], a[242:243], v[252:253], 0
    s_nop 0
    buffer_load_dwordx4 v20, s[20:23], s45 offen offset:1024 sc1 lds
    v_mfma_f32_16x16x32_bf16 v[132:135], a[148:151], v[40:43], v[132:135]
    s_nop 0
    ds_read_b64_tr_b16 a[200:201], v10 offset:16384
    v_cvt_pk_bf16_f32 v191, v138, v139
    v_mfma_f32_16x16x32_bf16 v[132:135], a[152:155], v[44:47], v[132:135]
    s_nop 0
    v_exp_f32 v141, v141
    v_mfma_f32_16x16x32_bf16 v[132:135], a[156:159], v[48:51], v[132:135]
    s_nop 0
    ds_read_b64_tr_b16 a[202:203], v10 offset:20480
    v_mov_b32_dpp v24, v28 row_shr:8 row_mask:0xf bank_mask:0xc
    v_mfma_f32_16x16x32_bf16 v[136:139], a[156:159], v[64:67], v[104:107]
    v_exp_f32 v142, v142
    v_mfma_f32_16x16x32_bf16 v[136:139], a[152:155], v[60:63], v[136:139]
    ds_read_b128 a[168:171], v3 offset:8192
    v_cvt_pk_bf16_f32 v198, v140, v141
    v_mfma_f32_16x16x32_bf16 v[136:139], a[148:151], v[56:59], v[136:139]
    v_exp_f32 v143, v143
    v_mfma_f32_16x16x32_bf16 v[136:139], a[144:147], v[52:55], v[136:139]
    ds_read_b64_tr_b16 a[204:205], v10 offset:40960
    v_mov_b32_dpp v25, v29 row_shr:8 row_mask:0xf bank_mask:0xc
    v_mfma_f32_16x16x32_bf16 a[48:51], a[216:219], v[212:215], a[48:51]
    v_exp_f32 v144, v144
    v_mfma_f32_16x16x32_bf16 a[48:51], a[220:223], v[216:219], a[48:51]
    ds_read_b64_tr_b16 a[206:207], v10 offset:45056
    v_cvt_pk_bf16_f32 v199, v142, v143
    v_mfma_f32_16x16x32_bf16 a[52:55], a[220:223], v[224:227], a[52:55]
    v_exp_f32 v145, v145
    v_mfma_f32_16x16x32_bf16 a[52:55], a[216:219], v[220:223], a[52:55]
    ds_read_b128 a[172:175], v4 offset:8192
    v_mov_b32_dpp v26, v30 row_shr:8 row_mask:0xf bank_mask:0xc
    v_mfma_f32_16x16x32_bf16 a[56:59], a[216:219], v[228:231], a[56:59]
    v_exp_f32 v146, v146
    v_mfma_f32_16x16x32_bf16 a[56:59], a[220:223], v[232:235], a[56:59]
    v_cvt_pk_bf16_f32 v206, v144, v145
    v_mov_b32_dpp v27, v31 row_shr:8 row_mask:0xf bank_mask:0xc
    v_mfma_f32_16x16x32_bf16 a[60:63], a[220:223], v[240:243], a[60:63]
    buffer_load_dwordx4 v20, s[20:23], s45 offen offset:2048 sc1 lds
    v_exp_f32 v147, v147
    v_mfma_f32_16x16x32_bf16 a[60:63], a[216:219], v[236:239], a[60:63]
    buffer_store_dwordx4 v[24:27], v23, s[16:19], s42 offen sc1
    v_smfmac_f32_16x16x64_bf16 a[228:231], v[244:247], v[220:227], v248
    s_waitcnt lgkmcnt(6)
    s_add_u32 s42, s42, 27648
    buffer_load_dwordx4 v20, s[20:23], s45 offen offset:3072 sc1 lds
    v_mfma_f32_16x16x32_bf16 v[140:143], a[144:147], v[68:71], v[108:111]
    s_mov_b32 s101, 0
    v_exp_f32 v148, v148
    v_mfma_f32_16x16x32_bf16 v[140:143], a[148:151], v[72:75], v[140:143]
    s_not_b32 s40, s50
    ds_read_b64_tr_b16 a[208:209], v11 offset:16384
    v_cvt_pk_bf16_f32 v207, v146, v147
    v_mfma_f32_16x16x32_bf16 v[140:143], a[152:155], v[76:79], v[140:143]
    s_bfe_u32 s40, s40, 0x50006
    v_exp_f32 v149, v149
    v_mfma_f32_16x16x32_bf16 v[140:143], a[156:159], v[80:83], v[140:143]
    s_cmp_eq_u32 s40, s87
    s_cselect_b32 s40, 1, 0
    ds_read_b64_tr_b16 a[210:211], v11 offset:20480
    v_mfma_f32_16x16x32_bf16 v[144:147], a[156:159], v[96:99], v[112:115]
    s_lshl_b32 s40, s40, 0
    v_exp_f32 v150, v150
    v_mfma_f32_16x16x32_bf16 v[144:147], a[152:155], v[92:95], v[144:147]
    s_or_b32 s101, s101, s40
    ds_read_b128 a[176:179], v1 offset:12288
    v_cvt_pk_bf16_f32 v184, v148, v149
    v_mfma_f32_16x16x32_bf16 v[144:147], a[148:151], v[88:91], v[144:147]
    s_not_b32 s40, s51
    v_exp_f32 v151, v151
    v_mfma_f32_16x16x32_bf16 v[144:147], a[144:147], v[84:87], v[144:147]
    s_bfe_u32 s40, s40, 0x50006
    ds_read_b64_tr_b16 a[212:213], v11 offset:40960
    v_mfma_f32_16x16x32_bf16 a[64:67], a[192:195], v[212:215], a[64:67]
    s_cmp_eq_u32 s40, s87
    s_cselect_b32 s40, 1, 0
    v_exp_f32 v152, v152
    v_mfma_f32_16x16x32_bf16 a[64:67], a[196:199], v[216:219], a[64:67]
    s_lshl_b32 s40, s40, 1
    ds_read_b64_tr_b16 a[214:215], v11 offset:45056
    v_cvt_pk_bf16_f32 v185, v150, v151
    v_mfma_f32_16x16x32_bf16 a[68:71], a[196:199], v[224:227], a[68:71]
    s_or_b32 s101, s101, s40
    v_exp_f32 v153, v153
    v_mfma_f32_16x16x32_bf16 a[68:71], a[192:195], v[220:223], a[68:71]
    s_not_b32 s40, s52
    ds_read_b128 a[180:183], v2 offset:12288
    v_mfma_f32_16x16x32_bf16 a[72:75], a[192:195], v[228:231], a[72:75]
    s_bfe_u32 s40, s40, 0x50006
    v_exp_f32 v154, v154
    v_mfma_f32_16x16x32_bf16 a[72:75], a[196:199], v[232:235], a[72:75]
    s_cmp_eq_u32 s40, s87
    s_cselect_b32 s40, 1, 0
    v_cvt_pk_bf16_f32 v192, v152, v153
    v_mfma_f32_16x16x32_bf16 a[76:79], a[196:199], v[240:243], a[76:79]
    s_lshl_b32 s40, s40, 2
    v_exp_f32 v155, v155
    v_mfma_f32_16x16x32_bf16 a[76:79], a[192:195], v[236:239], a[76:79]
    s_waitcnt lgkmcnt(6)
    v_mfma_f32_16x16x32_bf16 v[148:151], a[160:163], v[36:39], v[100:103]
    s_or_b32 s101, s101, s40
    v_exp_f32 v156, v156
    v_mfma_f32_16x16x32_bf16 v[148:151], a[164:167], v[40:43], v[148:151]
    s_not_b32 s40, s53
    ds_read_b64_tr_b16 a[216:217], v12 offset:16384
    v_cvt_pk_bf16_f32 v193, v154, v155
    v_mfma_f32_16x16x32_bf16 v[148:151], a[168:171], v[44:47], v[148:151]
    s_bfe_u32 s40, s40, 0x50006
    v_exp_f32 v157, v157
    v_mfma_f32_16x16x32_bf16 v[148:151], a[172:175], v[48:51], v[148:151]
    s_cmp_eq_u32 s40, s87
    s_cselect_b32 s40, 1, 0
    ds_read_b64_tr_b16 a[218:219], v12 offset:20480
    v_mfma_f32_16x16x32_bf16 v[152:155], a[172:175], v[64:67], v[104:107]
    s_lshl_b32 s40, s40, 3
    v_exp_f32 v158, v158
    v_mfma_f32_16x16x32_bf16 v[152:155], a[168:171], v[60:63], v[152:155]
    s_or_b32 s101, s101, s40
    ds_read_b128 a[184:187], v3 offset:12288
    v_cvt_pk_bf16_f32 v200, v156, v157
    v_mfma_f32_16x16x32_bf16 v[152:155], a[164:167], v[56:59], v[152:155]
    s_not_b32 s40, s54
    v_exp_f32 v159, v159
    v_mfma_f32_16x16x32_bf16 v[152:155], a[160:163], v[52:55], v[152:155]
    s_bfe_u32 s40, s40, 0x50006
    ds_read_b64_tr_b16 a[220:221], v12 offset:40960
    v_mfma_f32_16x16x32_bf16 a[80:83], a[200:203], v[212:215], a[80:83]
    s_cmp_eq_u32 s40, s87
    s_cselect_b32 s40, 1, 0
    v_exp_f32 v160, v160
    v_mfma_f32_16x16x32_bf16 a[80:83], a[204:207], v[216:219], a[80:83]
    s_lshl_b32 s40, s40, 4
    ds_read_b64_tr_b16 a[222:223], v12 offset:45056
    v_cvt_pk_bf16_f32 v201, v158, v159
    v_mfma_f32_16x16x32_bf16 a[84:87], a[204:207], v[224:227], a[84:87]
    s_or_b32 s101, s101, s40
    v_exp_f32 v161, v161
    v_mfma_f32_16x16x32_bf16 a[84:87], a[200:203], v[220:223], a[84:87]
    s_not_b32 s40, s55
    ds_read_b128 a[188:191], v4 offset:12288
    v_mfma_f32_16x16x32_bf16 a[88:91], a[200:203], v[228:231], a[88:91]
    s_bfe_u32 s40, s40, 0x50006
    v_exp_f32 v162, v162
    v_mfma_f32_16x16x32_bf16 a[88:91], a[204:207], v[232:235], a[88:91]
    s_cmp_eq_u32 s40, s87
    s_cselect_b32 s40, 1, 0
    v_cvt_pk_bf16_f32 v208, v160, v161
    v_mfma_f32_16x16x32_bf16 a[92:95], a[204:207], v[240:243], a[92:95]
    s_lshl_b32 s40, s40, 5
    v_exp_f32 v163, v163
    v_mfma_f32_16x16x32_bf16 a[92:95], a[200:203], v[236:239], a[92:95]
    s_or_b32 s101, s101, s40
    v_smfmac_f32_16x16x64_bf16 a[232:235], v[244:247], v[228:235], v248
    s_waitcnt vmcnt(13) lgkmcnt(6)
    s_barrier
    v_mfma_f32_16x16x32_bf16 v[156:159], a[160:163], v[68:71], v[108:111]
    s_not_b32 s40, s56
    v_exp_f32 v164, v164
    v_mfma_f32_16x16x32_bf16 v[156:159], a[164:167], v[72:75], v[156:159]
    s_bfe_u32 s40, s40, 0x50006
    ds_read_b64_tr_b16 a[192:193], v5 offset:57344
    v_cvt_pk_bf16_f32 v209, v162, v163
    v_mfma_f32_16x16x32_bf16 v[156:159], a[168:171], v[76:79], v[156:159]
    s_cmp_eq_u32 s40, s87
    s_cselect_b32 s40, 1, 0
    v_exp_f32 v165, v165
    v_mfma_f32_16x16x32_bf16 v[156:159], a[172:175], v[80:83], v[156:159]
    s_lshl_b32 s40, s40, 6
    ds_read_b64_tr_b16 a[194:195], v5 offset:61440
    v_mfma_f32_16x16x32_bf16 v[160:163], a[172:175], v[96:99], v[112:115]
    s_or_b32 s101, s101, s40
    v_exp_f32 v166, v166
    v_mfma_f32_16x16x32_bf16 v[160:163], a[168:171], v[92:95], v[160:163]
    s_not_b32 s40, s57
    ds_read_b64_tr_b16 a[196:197], v5 offset:0
    v_cvt_pk_bf16_f32 v186, v164, v165
    v_mfma_f32_16x16x32_bf16 v[160:163], a[164:167], v[88:91], v[160:163]
    s_bfe_u32 s40, s40, 0x50006
    v_exp_f32 v167, v167
    v_mfma_f32_16x16x32_bf16 v[160:163], a[160:163], v[84:87], v[160:163]
    s_cmp_eq_u32 s40, s87
    s_cselect_b32 s40, 1, 0
    ds_read_b64_tr_b16 a[198:199], v5 offset:4096
    v_mfma_f32_16x16x32_bf16 a[96:99], a[208:211], v[212:215], a[96:99]
    s_lshl_b32 s40, s40, 7
    v_exp_f32 v168, v168
    v_mfma_f32_16x16x32_bf16 a[96:99], a[212:215], v[216:219], a[96:99]
    s_or_b32 s101, s101, s40
    v_cvt_pk_bf16_f32 v187, v166, v167
    v_mfma_f32_16x16x32_bf16 a[100:103], a[212:215], v[224:227], a[100:103]
    s_add_u32 m0, s46, 126976
    s_nop 0
    buffer_load_dwordx4 v21, s[20:23], s45 offen offset:0 sc1 lds
    v_exp_f32 v169, v169
    v_mfma_f32_16x16x32_bf16 a[100:103], a[208:211], v[220:223], a[100:103]
    s_add_u32 m0, s46, 128000
    v_mfma_f32_16x16x32_bf16 a[104:107], a[208:211], v[228:231], a[104:107]
    s_mov_b32 s45, 307200
    buffer_load_dwordx4 v20, s[20:23], s45 offen offset:0 sc1 lds
    buffer_load_dwordx4 v20, s[20:23], s45 offen offset:1024 sc1 lds
    v_exp_f32 v170, v170
    v_mfma_f32_16x16x32_bf16 a[104:107], a[212:215], v[232:235], a[104:107]
    buffer_load_dwordx4 v20, s[20:23], s45 offen offset:2048 sc1 lds
    v_cvt_pk_bf16_f32 v194, v168, v169
    v_mfma_f32_16x16x32_bf16 a[108:111], a[212:215], v[240:243], a[108:111]
    v_exp_f32 v171, v171
    v_mfma_f32_16x16x32_bf16 a[108:111], a[208:211], v[236:239], a[108:111]
    s_waitcnt lgkmcnt(4)
    buffer_load_dwordx4 v20, s[20:23], s45 offen offset:3072 sc1 lds
    v_mfma_f32_16x16x32_bf16 v[164:167], a[176:179], v[36:39], v[100:103]
    s_add_u32 m0, s46, 132096
    v_exp_f32 v172, v172
    v_mfma_f32_16x16x32_bf16 v[164:167], a[180:183], v[40:43], v[164:167]
    ds_read_b64_tr_b16 a[200:201], v6 offset:57344
    v_cvt_pk_bf16_f32 v195, v170, v171
    v_mfma_f32_16x16x32_bf16 v[164:167], a[184:187], v[44:47], v[164:167]
    v_exp_f32 v173, v173
    v_mfma_f32_16x16x32_bf16 v[164:167], a[188:191], v[48:51], v[164:167]
    ds_read_b64_tr_b16 a[202:203], v6 offset:61440
    v_mfma_f32_16x16x32_bf16 v[168:171], a[188:191], v[64:67], v[104:107]
    v_exp_f32 v174, v174
    v_mfma_f32_16x16x32_bf16 v[168:171], a[184:187], v[60:63], v[168:171]
    ds_read_b64_tr_b16 a[204:205], v6 offset:0
    v_cvt_pk_bf16_f32 v202, v172, v173
    v_mfma_f32_16x16x32_bf16 v[168:171], a[180:183], v[56:59], v[168:171]
    v_exp_f32 v175, v175
    v_mfma_f32_16x16x32_bf16 v[168:171], a[176:179], v[52:55], v[168:171]
    ds_read_b64_tr_b16 a[206:207], v6 offset:4096
    v_mfma_f32_16x16x32_bf16 a[112:115], a[216:219], v[212:215], a[112:115]
    v_exp_f32 v176, v176
    v_mfma_f32_16x16x32_bf16 a[112:115], a[220:223], v[216:219], a[112:115]
    v_cvt_pk_bf16_f32 v203, v174, v175
    v_mfma_f32_16x16x32_bf16 a[116:119], a[220:223], v[224:227], a[116:119]
    v_exp_f32 v177, v177
    v_mfma_f32_16x16x32_bf16 a[116:119], a[216:219], v[220:223], a[116:119]
    buffer_load_dwordx4 v21, s[20:23], s45 offen offset:0 sc1 lds
    v_mfma_f32_16x16x32_bf16 a[120:123], a[216:219], v[228:231], a[120:123]
    v_exp_f32 v178, v178
    v_mfma_f32_16x16x32_bf16 a[120:123], a[220:223], v[232:235], a[120:123]
    v_cvt_pk_bf16_f32 v210, v176, v177
    v_mfma_f32_16x16x32_bf16 a[124:127], a[220:223], v[240:243], a[124:127]
    v_exp_f32 v179, v179
    v_mfma_f32_16x16x32_bf16 a[124:127], a[216:219], v[236:239], a[124:127]
    v_smfmac_f32_16x16x64_bf16 a[236:239], v[244:247], v[236:243], v248
    s_waitcnt lgkmcnt(4)
    v_mfma_f32_16x16x32_bf16 v[172:175], a[176:179], v[68:71], v[108:111]
    v_exp_f32 v116, v116
    v_mfma_f32_16x16x32_bf16 v[172:175], a[180:183], v[72:75], v[172:175]
    ds_read_b64_tr_b16 a[208:209], v7 offset:57344
    v_cvt_pk_bf16_f32 v211, v178, v179
    v_mfma_f32_16x16x32_bf16 v[172:175], a[184:187], v[76:79], v[172:175]
    v_exp_f32 v117, v117
    v_mfma_f32_16x16x32_bf16 v[172:175], a[188:191], v[80:83], v[172:175]
    ds_read_b64_tr_b16 a[210:211], v7 offset:61440
    v_mfma_f32_16x16x32_bf16 v[176:179], a[188:191], v[96:99], v[112:115]
    v_exp_f32 v118, v118
    v_mfma_f32_16x16x32_bf16 v[176:179], a[184:187], v[92:95], v[176:179]
    ds_read_b64_tr_b16 a[212:213], v7 offset:0
    v_cvt_pk_bf16_f32 v212, v116, v117
    v_mfma_f32_16x16x32_bf16 v[176:179], a[180:183], v[88:91], v[176:179]
    v_exp_f32 v119, v119
    v_mfma_f32_16x16x32_bf16 v[176:179], a[176:179], v[84:87], v[176:179]
    ds_read_b64_tr_b16 a[214:215], v7 offset:4096
    v_mfma_f32_16x16x32_bf16 a[0:3], a[192:195], v[180:183], a[0:3]
    v_exp_f32 v120, v120
    v_mfma_f32_16x16x32_bf16 a[0:3], a[196:199], v[184:187], a[0:3]
    v_cvt_pk_bf16_f32 v213, v118, v119
    v_mfma_f32_16x16x32_bf16 a[4:7], a[196:199], v[192:195], a[4:7]
    v_exp_f32 v121, v121
    v_mfma_f32_16x16x32_bf16 a[4:7], a[192:195], v[188:191], a[4:7]
    v_mfma_f32_16x16x32_bf16 a[8:11], a[192:195], v[196:199], a[8:11]
    v_exp_f32 v122, v122
    v_mfma_f32_16x16x32_bf16 a[8:11], a[196:199], v[200:203], a[8:11]
    v_cvt_pk_bf16_f32 v220, v120, v121
    v_mfma_f32_16x16x32_bf16 a[12:15], a[196:199], v[208:211], a[12:15]
    v_exp_f32 v123, v123
    v_mfma_f32_16x16x32_bf16 a[12:15], a[192:195], v[204:207], a[12:15]
    s_waitcnt lgkmcnt(4)
    v_mfma_f32_16x16x32_bf16 a[16:19], a[200:203], v[180:183], a[16:19]
    ds_read_b64_tr_b16 a[216:217], v8 offset:57344
    v_cvt_pk_bf16_f32 v221, v122, v123
    v_exp_f32 v124, v124
    v_mfma_f32_16x16x32_bf16 a[16:19], a[204:207], v[184:187], a[16:19]
    ds_read_b64_tr_b16 a[218:219], v8 offset:61440
    v_exp_f32 v125, v125
    v_mfma_f32_16x16x32_bf16 a[20:23], a[204:207], v[192:195], a[20:23]
    ds_read_b64_tr_b16 a[220:221], v8 offset:0
    v_cvt_pk_bf16_f32 v228, v124, v125
    v_exp_f32 v126, v126
    v_mov_b32 v114, v20
    v_mfma_f32_16x16x32_bf16 a[20:23], a[200:203], v[188:191], a[20:23]
    ds_read_b64_tr_b16 a[222:223], v8 offset:4096
    v_exp_f32 v127, v127
    v_mfma_f32_16x16x32_bf16 a[24:27], a[200:203], v[196:199], a[24:27]
    v_cvt_pk_bf16_f32 v229, v126, v127
    v_exp_f32 v128, v128
    v_mfma_f32_16x16x32_bf16 a[24:27], a[204:207], v[200:203], a[24:27]
    v_exp_f32 v129, v129
    v_mov_b32 v115, v21
    v_mfma_f32_16x16x32_bf16 a[28:31], a[204:207], v[208:211], a[28:31]
    v_cvt_pk_bf16_f32 v236, v128, v129
    v_exp_f32 v130, v130
    v_mfma_f32_16x16x32_bf16 a[28:31], a[200:203], v[204:207], a[28:31]
    v_exp_f32 v131, v131
    v_smfmac_f32_16x16x64_bf16 a[224:227], v[244:247], v[180:187], v248
    s_waitcnt lgkmcnt(4)
    v_mov_b32 v0, 2
    v_mfma_f32_16x16x32_bf16 a[32:35], a[208:211], v[180:183], a[32:35]
    s_mov_b32 s45, 40960
    ds_read_b64_tr_b16 a[192:193], v9 offset:57344
    v_cvt_pk_bf16_f32 v237, v130, v131
    v_exp_f32 v132, v132
    v_mfma_f32_16x16x32_bf16 a[32:35], a[212:215], v[184:187], a[32:35]
    ds_read_b64_tr_b16 a[194:195], v9 offset:61440
    v_exp_f32 v133, v133
    v_mfma_f32_16x16x32_bf16 a[36:39], a[212:215], v[192:195], a[36:39]
    ds_read_b64_tr_b16 a[196:197], v9 offset:0
    v_cvt_pk_bf16_f32 v214, v132, v133
    v_exp_f32 v134, v134
    v_mfma_f32_16x16x32_bf16 a[36:39], a[208:211], v[188:191], a[36:39]
    ds_read_b64_tr_b16 a[198:199], v9 offset:4096
    v_exp_f32 v135, v135
    v_mfma_f32_16x16x32_bf16 a[40:43], a[208:211], v[196:199], a[40:43]
    v_cvt_pk_bf16_f32 v215, v134, v135
    v_exp_f32 v136, v136
    v_mfma_f32_16x16x32_bf16 a[40:43], a[212:215], v[200:203], a[40:43]
    v_exp_f32 v137, v137
    v_mfma_f32_16x16x32_bf16 a[44:47], a[212:215], v[208:211], a[44:47]
    v_cvt_pk_bf16_f32 v222, v136, v137
    v_exp_f32 v138, v138
    v_mfma_f32_16x16x32_bf16 a[44:47], a[208:211], v[204:207], a[44:47]
    s_waitcnt lgkmcnt(4)
    buffer_load_dwordx4 a[136:139], v114, s[20:23], s45 offen offset:0 sc1
    v_exp_f32 v139, v139
    v_mfma_f32_16x16x32_bf16 a[48:51], a[216:219], v[180:183], a[48:51]
    ds_read_b64_tr_b16 a[200:201], v10 offset:57344
    v_cvt_pk_bf16_f32 v223, v138, v139
    v_exp_f32 v140, v140
    v_mfma_f32_16x16x32_bf16 a[48:51], a[220:223], v[184:187], a[48:51]
    ds_read_b64_tr_b16 a[202:203], v10 offset:61440
    v_exp_f32 v141, v141
    v_mfma_f32_16x16x32_bf16 a[52:55], a[220:223], v[192:195], a[52:55]
    ds_read_b64_tr_b16 a[204:205], v10 offset:0
    v_cvt_pk_bf16_f32 v230, v140, v141
    v_exp_f32 v142, v142
    v_mfma_f32_16x16x32_bf16 a[52:55], a[216:219], v[188:191], a[52:55]
    ds_read_b64_tr_b16 a[206:207], v10 offset:4096
    v_exp_f32 v143, v143
    v_mfma_f32_16x16x32_bf16 a[56:59], a[216:219], v[196:199], a[56:59]
    buffer_load_dwordx4 a[140:143], v114, s[20:23], s45 offen offset:1024 sc1
    v_cvt_pk_bf16_f32 v231, v142, v143
    v_exp_f32 v144, v144
    v_mfma_f32_16x16x32_bf16 a[56:59], a[220:223], v[200:203], a[56:59]
    v_exp_f32 v145, v145
    v_mfma_f32_16x16x32_bf16 a[60:63], a[220:223], v[208:211], a[60:63]
    v_cvt_pk_bf16_f32 v238, v144, v145
    v_exp_f32 v146, v146
    v_mfma_f32_16x16x32_bf16 a[60:63], a[216:219], v[204:207], a[60:63]
    v_exp_f32 v147, v147
    v_smfmac_f32_16x16x64_bf16 a[228:231], v[244:247], v[188:195], v248
    s_waitcnt lgkmcnt(4)
    buffer_load_dwordx4 a[144:147], v114, s[20:23], s45 offen offset:2048 sc1
    v_mfma_f32_16x16x32_bf16 a[64:67], a[192:195], v[180:183], a[64:67]
    ds_read_b64_tr_b16 a[208:209], v11 offset:57344
    v_cvt_pk_bf16_f32 v239, v146, v147
    v_exp_f32 v148, v148
    v_mfma_f32_16x16x32_bf16 a[64:67], a[196:199], v[184:187], a[64:67]
    ds_read_b64_tr_b16 a[210:211], v11 offset:61440
    v_exp_f32 v149, v149
    v_mfma_f32_16x16x32_bf16 a[68:71], a[196:199], v[192:195], a[68:71]
    ds_read_b64_tr_b16 a[212:213], v11 offset:0
    v_cvt_pk_bf16_f32 v216, v148, v149
    v_exp_f32 v150, v150
    v_mfma_f32_16x16x32_bf16 a[68:71], a[192:195], v[188:191], a[68:71]
    ds_read_b64_tr_b16 a[214:215], v11 offset:4096
    buffer_load_dwordx4 a[148:151], v114, s[20:23], s45 offen offset:3072 sc1
    v_exp_f32 v151, v151
    v_mfma_f32_16x16x32_bf16 a[72:75], a[192:195], v[196:199], a[72:75]
    v_cvt_pk_bf16_f32 v217, v150, v151
    v_exp_f32 v152, v152
    v_mfma_f32_16x16x32_bf16 a[72:75], a[196:199], v[200:203], a[72:75]
    v_exp_f32 v153, v153
    v_mfma_f32_16x16x32_bf16 a[76:79], a[196:199], v[208:211], a[76:79]
    v_cvt_pk_bf16_f32 v224, v152, v153
    v_exp_f32 v154, v154
    v_mfma_f32_16x16x32_bf16 a[76:79], a[192:195], v[204:207], a[76:79]
    s_waitcnt lgkmcnt(4)
    buffer_load_dwordx4 a[152:155], v115, s[20:23], s45 offen offset:0 sc1
    v_exp_f32 v155, v155
    v_mfma_f32_16x16x32_bf16 a[80:83], a[200:203], v[180:183], a[80:83]
    s_mov_b32 s45, 61440
    ds_read_b64_tr_b16 a[216:217], v12 offset:57344
    v_cvt_pk_bf16_f32 v225, v154, v155
    v_exp_f32 v156, v156
    v_mfma_f32_16x16x32_bf16 a[80:83], a[204:207], v[184:187], a[80:83]
    ds_read_b64_tr_b16 a[218:219], v12 offset:61440
    v_exp_f32 v157, v157
    v_mfma_f32_16x16x32_bf16 a[84:87], a[204:207], v[192:195], a[84:87]
    ds_read_b64_tr_b16 a[220:221], v12 offset:0
    v_cvt_pk_bf16_f32 v232, v156, v157
    v_exp_f32 v158, v158
    v_mfma_f32_16x16x32_bf16 a[84:87], a[200:203], v[188:191], a[84:87]
    ds_read_b64_tr_b16 a[222:223], v12 offset:4096
    v_exp_f32 v159, v159
    v_mfma_f32_16x16x32_bf16 a[88:91], a[200:203], v[196:199], a[88:91]
    v_cvt_pk_bf16_f32 v233, v158, v159
    v_exp_f32 v160, v160
    v_mfma_f32_16x16x32_bf16 a[88:91], a[204:207], v[200:203], a[88:91]
    v_exp_f32 v161, v161
    v_mfma_f32_16x16x32_bf16 a[92:95], a[204:207], v[208:211], a[92:95]
    v_cvt_pk_bf16_f32 v240, v160, v161
    v_exp_f32 v162, v162
    v_mfma_f32_16x16x32_bf16 a[92:95], a[200:203], v[204:207], a[92:95]
    v_exp_f32 v163, v163
    v_smfmac_f32_16x16x64_bf16 a[232:235], v[244:247], v[196:203], v248
    s_waitcnt vmcnt(12) lgkmcnt(4)
    s_barrier
    buffer_load_dwordx4 a[156:159], v114, s[20:23], s45 offen offset:0 sc1
    v_mfma_f32_16x16x32_bf16 a[96:99], a[208:211], v[180:183], a[96:99]
    ds_read_b64_tr_b16 a[192:193], v5 offset:24576
    v_cvt_pk_bf16_f32 v241, v162, v163
    v_exp_f32 v164, v164
    v_mfma_f32_16x16x32_bf16 a[96:99], a[212:215], v[184:187], a[96:99]
    ds_read_b64_tr_b16 a[194:195], v5 offset:28672
    v_exp_f32 v165, v165
    v_mfma_f32_16x16x32_bf16 a[100:103], a[212:215], v[192:195], a[100:103]
    ds_read_b64_tr_b16 a[196:197], v5 offset:49152
    v_cvt_pk_bf16_f32 v218, v164, v165
    v_exp_f32 v166, v166
    v_mfma_f32_16x16x32_bf16 a[100:103], a[208:211], v[188:191], a[100:103]
    ds_read_b64_tr_b16 a[198:199], v5 offset:53248
    buffer_load_dwordx4 a[160:163], v114, s[20:23], s45 offen offset:1024 sc1
    v_exp_f32 v167, v167
    v_mfma_f32_16x16x32_bf16 a[104:107], a[208:211], v[196:199], a[104:107]
    v_cvt_pk_bf16_f32 v219, v166, v167
    v_exp_f32 v168, v168
    v_mfma_f32_16x16x32_bf16 a[104:107], a[212:215], v[200:203], a[104:107]
    v_exp_f32 v169, v169
    v_mfma_f32_16x16x32_bf16 a[108:111], a[212:215], v[208:211], a[108:111]
    v_cvt_pk_bf16_f32 v226, v168, v169
    v_exp_f32 v170, v170
    v_mfma_f32_16x16x32_bf16 a[108:111], a[208:211], v[204:207], a[108:111]
    s_waitcnt lgkmcnt(4)
    buffer_load_dwordx4 a[164:167], v114, s[20:23], s45 offen offset:2048 sc1
    s_cmp_lg_u32 s5, 0
    s_cbranch_scc1 L_ffn_flagged
    s_mov_b64 exec, 1
    buffer_store_dword v0, off, s[76:79], s75 sc1
    s_mov_b64 exec, -1
L_ffn_flagged:
    v_exp_f32 v171, v171
    v_mfma_f32_16x16x32_bf16 a[112:115], a[216:219], v[180:183], a[112:115]
    ds_read_b64_tr_b16 a[200:201], v6 offset:24576
    v_cvt_pk_bf16_f32 v227, v170, v171
    v_exp_f32 v172, v172
    v_mfma_f32_16x16x32_bf16 a[112:115], a[220:223], v[184:187], a[112:115]
    ds_read_b64_tr_b16 a[202:203], v6 offset:28672
    v_exp_f32 v173, v173
    v_mfma_f32_16x16x32_bf16 a[116:119], a[220:223], v[192:195], a[116:119]
    ds_read_b64_tr_b16 a[204:205], v6 offset:49152
    v_cvt_pk_bf16_f32 v234, v172, v173
    v_exp_f32 v174, v174
    v_mfma_f32_16x16x32_bf16 a[116:119], a[216:219], v[188:191], a[116:119]
    ds_read_b64_tr_b16 a[206:207], v6 offset:53248
    v_exp_f32 v175, v175
    v_mfma_f32_16x16x32_bf16 a[120:123], a[216:219], v[196:199], a[120:123]
    buffer_load_dwordx4 a[168:171], v114, s[20:23], s45 offen offset:3072 sc1
    v_cvt_pk_bf16_f32 v235, v174, v175
    v_exp_f32 v176, v176
    v_mfma_f32_16x16x32_bf16 a[120:123], a[220:223], v[200:203], a[120:123]
    v_exp_f32 v177, v177
    v_mfma_f32_16x16x32_bf16 a[124:127], a[220:223], v[208:211], a[124:127]
    v_cvt_pk_bf16_f32 v242, v176, v177
    v_exp_f32 v178, v178
    v_mfma_f32_16x16x32_bf16 a[124:127], a[216:219], v[204:207], a[124:127]
    v_exp_f32 v179, v179
    v_smfmac_f32_16x16x64_bf16 a[236:239], v[244:247], v[204:211], v248
    s_waitcnt lgkmcnt(4)
    buffer_load_dwordx4 a[172:175], v115, s[20:23], s45 offen offset:0 sc1
    v_mfma_f32_16x16x32_bf16 a[0:3], a[192:195], v[212:215], a[0:3]
    s_lshl_b32 s40, s87, 2
    ds_read_b64_tr_b16 a[208:209], v7 offset:24576
    v_cvt_pk_bf16_f32 v243, v178, v179
    v_mfma_f32_16x16x32_bf16 a[0:3], a[196:199], v[216:219], a[0:3]
    s_add_u32 s40, s40, s5
    ds_read_b64_tr_b16 a[210:211], v7 offset:28672
    v_smfmac_f32_16x16x64_bf16 a[224:227], v[244:247], v[212:219], v248
    s_lshl_b32 s40, s40, 4
    ds_read_b64_tr_b16 a[212:213], v7 offset:49152
    v_and_b32 v35, 15, v19
    v_smfmac_f32_16x16x64_bf16 a[228:231], v[244:247], v[220:227], v248
    ds_read_b64_tr_b16 a[214:215], v7 offset:53248
    v_add_u32 v35, s40, v35
    v_smfmac_f32_16x16x64_bf16 a[232:235], v[244:247], v[228:235], v248
    v_mul_u32_u24 v34, 1280, v35
    v_lshrrev_b32 v116, 4, v19
    v_smfmac_f32_16x16x64_bf16 a[236:239], v[244:247], v[236:243], v248
    v_lshl_add_u32 v34, v116, 3, v34
    v_mfma_f32_16x16x32_bf16 a[4:7], a[196:199], v[224:227], a[4:7]
    s_mul_i32 s40, s100, 160
    v_add_u32 v34, s40, v34
    v_lshlrev_b32 v116, 4, v35
    v_mfma_f32_16x16x32_bf16 a[4:7], a[192:195], v[220:223], a[4:7]
    s_mov_b32 s40, 0x280000
    buffer_load_dwordx2 v[32:33], v116, s[76:79], s40 offen sc1
    v_mfma_f32_16x16x32_bf16 a[8:11], a[192:195], v[228:231], a[8:11]
    buffer_load_dwordx2 v[22:23], v34, s[88:91], 0 offen offset:0
    v_mfma_f32_16x16x32_bf16 a[8:11], a[196:199], v[232:235], a[8:11]
    buffer_load_dwordx2 v[24:25], v34, s[88:91], 0 offen offset:32
    v_mfma_f32_16x16x32_bf16 a[12:15], a[196:199], v[240:243], a[12:15]
    buffer_load_dwordx2 v[26:27], v34, s[88:91], 0 offen offset:64
    v_mfma_f32_16x16x32_bf16 a[12:15], a[192:195], v[236:239], a[12:15]
    s_waitcnt lgkmcnt(4)
    buffer_load_dwordx2 v[28:29], v34, s[88:91], 0 offen offset:96
    v_mfma_f32_16x16x32_bf16 a[16:19], a[200:203], v[212:215], a[16:19]
    ds_read_b64_tr_b16 a[216:217], v8 offset:24576
    v_accvgpr_read_b32 v100, a224
    v_mfma_f32_16x16x32_bf16 a[16:19], a[204:207], v[216:219], a[16:19]
    ds_read_b64_tr_b16 a[218:219], v8 offset:28672
    v_accvgpr_read_b32 v104, a225
    v_accvgpr_read_b32 v101, a228
    v_accvgpr_read_b32 v105, a229
    v_mfma_f32_16x16x32_bf16 a[20:23], a[204:207], v[224:227], a[20:23]
    ds_read_b64_tr_b16 a[220:221], v8 offset:49152
    v_accvgpr_read_b32 v102, a232
    v_accvgpr_read_b32 v106, a233
    v_mfma_f32_16x16x32_bf16 a[20:23], a[200:203], v[220:223], a[20:23]
    ds_read_b64_tr_b16 a[222:223], v8 offset:53248
    v_accvgpr_read_b32 v103, a236
    v_accvgpr_read_b32 v107, a237
    v_add_f32 v100, v100, v104
    v_mfma_f32_16x16x32_bf16 a[24:27], a[200:203], v[228:231], a[24:27]
    buffer_load_dwordx2 v[30:31], v34, s[88:91], 0 offen offset:128
    v_add_f32 v101, v101, v105
    v_add_f32 v102, v102, v106
    v_add_f32 v103, v103, v107
    v_mfma_f32_16x16x32_bf16 a[24:27], a[204:207], v[232:235], a[24:27]
    v_lshlrev_b32 v20, 7, v19
    v_add_u32 v20, 0x290000, v20
    v_maximum3_f32 v108, v100, v101, v102
    v_maximum3_f32 v108, v108, v103, v103
    v_mfma_f32_16x16x32_bf16 a[28:31], a[204:207], v[240:243], a[28:31]
    buffer_load_dwordx4 v[252:255], v20, s[76:79], 0 offen sc1
    v_mul_f32 v108, 0x6b800000, v108
    v_mov_b32 v109, 0
    v_lshlrev_b32 v110, 4, v19
    v_mfma_f32_16x16x32_bf16 a[28:31], a[200:203], v[236:239], a[28:31]
    s_waitcnt lgkmcnt(4)
    v_rcp_f32 v100, v100
    v_rcp_f32 v101, v101
    v_rcp_f32 v102, v102
    v_rcp_f32 v103, v103
    v_mfma_f32_16x16x32_bf16 a[32:35], a[208:211], v[212:215], a[32:35]
    s_mov_b32 s36, 0
    ds_read_b64_tr_b16 a[192:193], v9 offset:24576
    v_accvgpr_read_b32 v120, a0
    v_accvgpr_read_b32 v121, a1
    v_accvgpr_read_b32 v122, a2
    v_accvgpr_read_b32 v123, a3
    v_mfma_f32_16x16x32_bf16 a[32:35], a[212:215], v[216:219], a[32:35]
    ds_read_b64_tr_b16 a[194:195], v9 offset:28672
    v_accvgpr_read_b32 v124, a16
    v_accvgpr_read_b32 v125, a17
    v_accvgpr_read_b32 v126, a18
    v_accvgpr_read_b32 v127, a19
    v_maximum3_f32 v108, v108, |v120|, |v121|
    v_maximum3_f32 v109, v109, |v122|, |v123|
    v_mfma_f32_16x16x32_bf16 a[36:39], a[212:215], v[224:227], a[36:39]
    ds_read_b64_tr_b16 a[196:197], v9 offset:49152
    v_maximum3_f32 v108, v108, |v124|, |v125|
    v_maximum3_f32 v109, v109, |v126|, |v127|
    v_mul_f32 v120, v120, v100
    v_mul_f32 v121, v121, v100
    v_mul_f32 v122, v122, v100
    v_mul_f32 v123, v123, v100
    v_mfma_f32_16x16x32_bf16 a[36:39], a[208:211], v[220:223], a[36:39]
    ds_read_b64_tr_b16 a[198:199], v9 offset:53248
    v_mul_f32 v124, v124, v100
    v_mul_f32 v125, v125, v100
    v_mul_f32 v126, v126, v100
    v_mul_f32 v127, v127, v100
    v_cvt_pk_bf16_f32 v152, v120, v121
    v_cvt_pk_bf16_f32 v153, v122, v123
    v_cvt_pk_bf16_f32 v154, v124, v125
    v_mfma_f32_16x16x32_bf16 a[40:43], a[208:211], v[228:231], a[40:43]
    v_cvt_pk_bf16_f32 v155, v126, v127
    v_mfma_f32_16x16x32_bf16 a[40:43], a[212:215], v[232:235], a[40:43]
    buffer_store_dwordx4 v[152:155], v110, s[24:27], s36 offen offset:0 sc1
    v_accvgpr_read_b32 v128, a4
    v_accvgpr_read_b32 v129, a5
    v_accvgpr_read_b32 v130, a6
    v_accvgpr_read_b32 v131, a7
    v_accvgpr_read_b32 v132, a20
    v_accvgpr_read_b32 v133, a21
    v_accvgpr_read_b32 v134, a22
    v_accvgpr_read_b32 v135, a23
    v_maximum3_f32 v108, v108, |v128|, |v129|
    v_maximum3_f32 v109, v109, |v130|, |v131|
    v_mfma_f32_16x16x32_bf16 a[44:47], a[212:215], v[240:243], a[44:47]
    v_maximum3_f32 v108, v108, |v132|, |v133|
    v_maximum3_f32 v109, v109, |v134|, |v135|
    v_mul_f32 v128, v128, v101
    v_mul_f32 v129, v129, v101
    v_mul_f32 v130, v130, v101
    v_mul_f32 v131, v131, v101
    v_mul_f32 v132, v132, v101
    v_mfma_f32_16x16x32_bf16 a[44:47], a[208:211], v[236:239], a[44:47]
    s_waitcnt lgkmcnt(4)
    v_mul_f32 v133, v133, v101
    v_mul_f32 v134, v134, v101
    v_mul_f32 v135, v135, v101
    v_cvt_pk_bf16_f32 v156, v128, v129
    v_cvt_pk_bf16_f32 v157, v130, v131
    v_cvt_pk_bf16_f32 v158, v132, v133
    v_mfma_f32_16x16x32_bf16 a[48:51], a[216:219], v[212:215], a[48:51]
    ds_read_b64_tr_b16 a[200:201], v10 offset:24576
    v_cvt_pk_bf16_f32 v159, v134, v135
    v_mfma_f32_16x16x32_bf16 a[48:51], a[220:223], v[216:219], a[48:51]
    ds_read_b64_tr_b16 a[202:203], v10 offset:28672
    buffer_store_dwordx4 v[156:159], v110, s[24:27], s36 offen offset:1024 sc1
    v_accvgpr_read_b32 v136, a8
    v_accvgpr_read_b32 v137, a9
    v_accvgpr_read_b32 v138, a10
    v_accvgpr_read_b32 v139, a11
    v_accvgpr_read_b32 v140, a24
    v_accvgpr_read_b32 v141, a25
    v_accvgpr_read_b32 v142, a26
    v_accvgpr_read_b32 v143, a27
    v_maximum3_f32 v108, v108, |v136|, |v137|
    v_maximum3_f32 v109, v109, |v138|, |v139|
    v_maximum3_f32 v108, v108, |v140|, |v141|
    v_mfma_f32_16x16x32_bf16 a[52:55], a[220:223], v[224:227], a[52:55]
    ds_read_b64_tr_b16 a[204:205], v10 offset:49152
    v_maximum3_f32 v109, v109, |v142|, |v143|
    v_mul_f32 v136, v136, v102
    v_mul_f32 v137, v137, v102
    v_mul_f32 v138, v138, v102
    v_mul_f32 v139, v139, v102
    v_mul_f32 v140, v140, v102
    v_mfma_f32_16x16x32_bf16 a[52:55], a[216:219], v[220:223], a[52:55]
    ds_read_b64_tr_b16 a[206:207], v10 offset:53248
    v_mul_f32 v141, v141, v102
    v_mul_f32 v142, v142, v102
    v_mul_f32 v143, v143, v102
    v_cvt_pk_bf16_f32 v160, v136, v137
    v_cvt_pk_bf16_f32 v161, v138, v139
    v_cvt_pk_bf16_f32 v162, v140, v141
    v_mfma_f32_16x16x32_bf16 a[56:59], a[216:219], v[228:231], a[56:59]
    v_cvt_pk_bf16_f32 v163, v142, v143
    v_mfma_f32_16x16x32_bf16 a[56:59], a[220:223], v[232:235], a[56:59]
    buffer_store_dwordx4 v[160:163], v110, s[24:27], s36 offen offset:2048 sc1
    v_accvgpr_read_b32 v144, a12
    v_accvgpr_read_b32 v145, a13
    v_accvgpr_read_b32 v146, a14
    v_accvgpr_read_b32 v147, a15
    v_accvgpr_read_b32 v148, a28
    v_accvgpr_read_b32 v149, a29
    v_accvgpr_read_b32 v150, a30
    v_accvgpr_read_b32 v151, a31
    v_maximum3_f32 v108, v108, |v144|, |v145|
    v_maximum3_f32 v109, v109, |v146|, |v147|
    v_maximum3_f32 v108, v108, |v148|, |v149|
    v_mfma_f32_16x16x32_bf16 a[60:63], a[220:223], v[240:243], a[60:63]
    v_maximum3_f32 v109, v109, |v150|, |v151|
    v_mul_f32 v144, v144, v103
    v_mul_f32 v145, v145, v103
    v_mul_f32 v146, v146, v103
    v_mul_f32 v147, v147, v103
    v_mul_f32 v148, v148, v103
    v_mfma_f32_16x16x32_bf16 a[60:63], a[216:219], v[236:239], a[60:63]
    s_waitcnt lgkmcnt(4)
    v_mul_f32 v149, v149, v103
    v_mul_f32 v150, v150, v103
    v_mul_f32 v151, v151, v103
    v_cvt_pk_bf16_f32 v164, v144, v145
    v_cvt_pk_bf16_f32 v165, v146, v147
    v_cvt_pk_bf16_f32 v166, v148, v149
    v_cvt_pk_bf16_f32 v167, v150, v151
    buffer_store_dwordx4 v[164:167], v110, s[24:27], s36 offen offset:3072 sc1
    v_mfma_f32_16x16x32_bf16 a[64:67], a[192:195], v[212:215], a[64:67]
    s_mov_b32 s36, 4096
    ds_read_b64_tr_b16 a[208:209], v11 offset:24576
    v_accvgpr_read_b32 v120, a32
    v_accvgpr_read_b32 v121, a33
    v_accvgpr_read_b32 v122, a34
    v_accvgpr_read_b32 v123, a35
    v_mfma_f32_16x16x32_bf16 a[64:67], a[196:199], v[216:219], a[64:67]
    ds_read_b64_tr_b16 a[210:211], v11 offset:28672
    v_accvgpr_read_b32 v124, a48
    v_accvgpr_read_b32 v125, a49
    v_accvgpr_read_b32 v126, a50
    v_accvgpr_read_b32 v127, a51
    v_maximum3_f32 v108, v108, |v120|, |v121|
    v_maximum3_f32 v109, v109, |v122|, |v123|
    v_mfma_f32_16x16x32_bf16 a[68:71], a[196:199], v[224:227], a[68:71]
    ds_read_b64_tr_b16 a[212:213], v11 offset:49152
    v_maximum3_f32 v108, v108, |v124|, |v125|
    v_maximum3_f32 v109, v109, |v126|, |v127|
    v_mul_f32 v120, v120, v100
    v_mul_f32 v121, v121, v100
    v_mul_f32 v122, v122, v100
    v_mul_f32 v123, v123, v100
    v_mfma_f32_16x16x32_bf16 a[68:71], a[192:195], v[220:223], a[68:71]
    ds_read_b64_tr_b16 a[214:215], v11 offset:53248
    v_mul_f32 v124, v124, v100
    v_mul_f32 v125, v125, v100
    v_mul_f32 v126, v126, v100
    v_mul_f32 v127, v127, v100
    v_cvt_pk_bf16_f32 v152, v120, v121
    v_cvt_pk_bf16_f32 v153, v122, v123
    v_cvt_pk_bf16_f32 v154, v124, v125
    v_mfma_f32_16x16x32_bf16 a[72:75], a[192:195], v[228:231], a[72:75]
    v_cvt_pk_bf16_f32 v155, v126, v127
    v_mfma_f32_16x16x32_bf16 a[72:75], a[196:199], v[232:235], a[72:75]
    buffer_store_dwordx4 v[152:155], v110, s[24:27], s36 offen offset:0 sc1
    v_accvgpr_read_b32 v128, a36
    v_accvgpr_read_b32 v129, a37
    v_accvgpr_read_b32 v130, a38
    v_accvgpr_read_b32 v131, a39
    v_accvgpr_read_b32 v132, a52
    v_accvgpr_read_b32 v133, a53
    v_accvgpr_read_b32 v134, a54
    v_accvgpr_read_b32 v135, a55
    v_maximum3_f32 v108, v108, |v128|, |v129|
    v_maximum3_f32 v109, v109, |v130|, |v131|
    v_mfma_f32_16x16x32_bf16 a[76:79], a[196:199], v[240:243], a[76:79]
    v_maximum3_f32 v108, v108, |v132|, |v133|
    v_maximum3_f32 v109, v109, |v134|, |v135|
    v_mul_f32 v128, v128, v101
    v_mul_f32 v129, v129, v101
    v_mul_f32 v130, v130, v101
    v_mul_f32 v131, v131, v101
    v_mul_f32 v132, v132, v101
    v_mfma_f32_16x16x32_bf16 a[76:79], a[192:195], v[236:239], a[76:79]
    s_waitcnt lgkmcnt(4)
    v_mul_f32 v133, v133, v101
    v_mul_f32 v134, v134, v101
    v_mul_f32 v135, v135, v101
    v_cvt_pk_bf16_f32 v156, v128, v129
    v_cvt_pk_bf16_f32 v157, v130, v131
    v_cvt_pk_bf16_f32 v158, v132, v133
    v_mfma_f32_16x16x32_bf16 a[80:83], a[200:203], v[212:215], a[80:83]
    ds_read_b64_tr_b16 a[216:217], v12 offset:24576
    v_cvt_pk_bf16_f32 v159, v134, v135
    v_mfma_f32_16x16x32_bf16 a[80:83], a[204:207], v[216:219], a[80:83]
    ds_read_b64_tr_b16 a[218:219], v12 offset:28672
    buffer_store_dwordx4 v[156:159], v110, s[24:27], s36 offen offset:1024 sc1
    v_accvgpr_read_b32 v136, a40
    v_accvgpr_read_b32 v137, a41
    v_accvgpr_read_b32 v138, a42
    v_accvgpr_read_b32 v139, a43
    v_accvgpr_read_b32 v140, a56
    v_accvgpr_read_b32 v141, a57
    v_accvgpr_read_b32 v142, a58
    v_accvgpr_read_b32 v143, a59
    v_maximum3_f32 v108, v108, |v136|, |v137|
    v_maximum3_f32 v109, v109, |v138|, |v139|
    v_maximum3_f32 v108, v108, |v140|, |v141|
    v_mfma_f32_16x16x32_bf16 a[84:87], a[204:207], v[224:227], a[84:87]
    ds_read_b64_tr_b16 a[220:221], v12 offset:49152
    v_maximum3_f32 v109, v109, |v142|, |v143|
    v_mul_f32 v136, v136, v102
    v_mul_f32 v137, v137, v102
    v_mul_f32 v138, v138, v102
    v_mul_f32 v139, v139, v102
    v_mul_f32 v140, v140, v102
    v_mfma_f32_16x16x32_bf16 a[84:87], a[200:203], v[220:223], a[84:87]
    ds_read_b64_tr_b16 a[222:223], v12 offset:53248
    v_mul_f32 v141, v141, v102
    v_mul_f32 v142, v142, v102
    v_mul_f32 v143, v143, v102
    v_cvt_pk_bf16_f32 v160, v136, v137
    v_cvt_pk_bf16_f32 v161, v138, v139
    v_cvt_pk_bf16_f32 v162, v140, v141
    v_mfma_f32_16x16x32_bf16 a[88:91], a[200:203], v[228:231], a[88:91]
    v_cvt_pk_bf16_f32 v163, v142, v143
    v_mfma_f32_16x16x32_bf16 a[88:91], a[204:207], v[232:235], a[88:91]
    buffer_store_dwordx4 v[160:163], v110, s[24:27], s36 offen offset:2048 sc1
    v_accvgpr_read_b32 v144, a44
    v_accvgpr_read_b32 v145, a45
    v_accvgpr_read_b32 v146, a46
    v_accvgpr_read_b32 v147, a47
    v_accvgpr_read_b32 v148, a60
    v_accvgpr_read_b32 v149, a61
    v_accvgpr_read_b32 v150, a62
    v_accvgpr_read_b32 v151, a63
    v_maximum3_f32 v108, v108, |v144|, |v145|
    v_maximum3_f32 v109, v109, |v146|, |v147|
    v_maximum3_f32 v108, v108, |v148|, |v149|
    v_mfma_f32_16x16x32_bf16 a[92:95], a[204:207], v[240:243], a[92:95]
    v_maximum3_f32 v109, v109, |v150|, |v151|
    v_mul_f32 v144, v144, v103
    v_mul_f32 v145, v145, v103
    v_mul_f32 v146, v146, v103
    v_mul_f32 v147, v147, v103
    v_mul_f32 v148, v148, v103
    v_mfma_f32_16x16x32_bf16 a[92:95], a[200:203], v[236:239], a[92:95]
    s_waitcnt lgkmcnt(4)
    v_mul_f32 v149, v149, v103
    v_mul_f32 v150, v150, v103
    v_mul_f32 v151, v151, v103
    v_cvt_pk_bf16_f32 v164, v144, v145
    v_cvt_pk_bf16_f32 v165, v146, v147
    v_cvt_pk_bf16_f32 v166, v148, v149
    v_cvt_pk_bf16_f32 v167, v150, v151
    buffer_store_dwordx4 v[164:167], v110, s[24:27], s36 offen offset:3072 sc1
    v_mfma_f32_16x16x32_bf16 a[96:99], a[208:211], v[212:215], a[96:99]
    s_mov_b32 s36, 8192
    v_accvgpr_read_b32 v120, a64
    v_accvgpr_read_b32 v121, a65
    v_accvgpr_read_b32 v122, a66
    v_accvgpr_read_b32 v123, a67
    v_mfma_f32_16x16x32_bf16 a[96:99], a[212:215], v[216:219], a[96:99]
    v_accvgpr_read_b32 v124, a80
    v_accvgpr_read_b32 v125, a81
    v_accvgpr_read_b32 v126, a82
    v_accvgpr_read_b32 v127, a83
    v_maximum3_f32 v108, v108, |v120|, |v121|
    v_maximum3_f32 v109, v109, |v122|, |v123|
    v_mfma_f32_16x16x32_bf16 a[100:103], a[212:215], v[224:227], a[100:103]
    v_maximum3_f32 v108, v108, |v124|, |v125|
    v_maximum3_f32 v109, v109, |v126|, |v127|
    v_mul_f32 v120, v120, v100
    v_mul_f32 v121, v121, v100
    v_mul_f32 v122, v122, v100
    v_mul_f32 v123, v123, v100
    v_mfma_f32_16x16x32_bf16 a[100:103], a[208:211], v[220:223], a[100:103]
    v_mul_f32 v124, v124, v100
    v_mul_f32 v125, v125, v100
    v_mul_f32 v126, v126, v100
    v_mul_f32 v127, v127, v100
    v_cvt_pk_bf16_f32 v152, v120, v121
    v_cvt_pk_bf16_f32 v153, v122, v123
    v_cvt_pk_bf16_f32 v154, v124, v125
    v_mfma_f32_16x16x32_bf16 a[104:107], a[208:211], v[228:231], a[104:107]
    v_cvt_pk_bf16_f32 v155, v126, v127
    v_mfma_f32_16x16x32_bf16 a[104:107], a[212:215], v[232:235], a[104:107]
    buffer_store_dwordx4 v[152:155], v110, s[24:27], s36 offen offset:0 sc1
    v_accvgpr_read_b32 v128, a68
    v_accvgpr_read_b32 v129, a69
    v_accvgpr_read_b32 v130, a70
    v_accvgpr_read_b32 v131, a71
    v_accvgpr_read_b32 v132, a84
    v_accvgpr_read_b32 v133, a85
    v_accvgpr_read_b32 v134, a86
    v_accvgpr_read_b32 v135, a87
    v_maximum3_f32 v108, v108, |v128|, |v129|
    v_maximum3_f32 v109, v109, |v130|, |v131|
    v_mfma_f32_16x16x32_bf16 a[108:111], a[212:215], v[240:243], a[108:111]
    v_maximum3_f32 v108, v108, |v132|, |v133|
    v_maximum3_f32 v109, v109, |v134|, |v135|
    v_mul_f32 v128, v128, v101
    v_mul_f32 v129, v129, v101
    v_mul_f32 v130, v130, v101
    v_mul_f32 v131, v131, v101
    v_mul_f32 v132, v132, v101
    v_mfma_f32_16x16x32_bf16 a[108:111], a[208:211], v[236:239], a[108:111]
    s_waitcnt lgkmcnt(0)
    v_mul_f32 v133, v133, v101
    v_mul_f32 v134, v134, v101
    v_mul_f32 v135, v135, v101
    v_cvt_pk_bf16_f32 v156, v128, v129
    v_cvt_pk_bf16_f32 v157, v130, v131
    v_cvt_pk_bf16_f32 v158, v132, v133
    v_mfma_f32_16x16x32_bf16 a[112:115], a[216:219], v[212:215], a[112:115]
    v_cvt_pk_bf16_f32 v159, v134, v135
    v_mfma_f32_16x16x32_bf16 a[112:115], a[220:223], v[216:219], a[112:115]
    buffer_store_dwordx4 v[156:159], v110, s[24:27], s36 offen offset:1024 sc1
    v_accvgpr_read_b32 v136, a72
    v_accvgpr_read_b32 v137, a73
    v_accvgpr_read_b32 v138, a74
    v_accvgpr_read_b32 v139, a75
    v_accvgpr_read_b32 v140, a88
    v_accvgpr_read_b32 v141, a89
    v_accvgpr_read_b32 v142, a90
    v_accvgpr_read_b32 v143, a91
    v_maximum3_f32 v108, v108, |v136|, |v137|
    v_maximum3_f32 v109, v109, |v138|, |v139|
    v_maximum3_f32 v108, v108, |v140|, |v141|
    v_mfma_f32_16x16x32_bf16 a[116:119], a[220:223], v[224:227], a[116:119]
    v_maximum3_f32 v109, v109, |v142|, |v143|
    v_mul_f32 v136, v136, v102
    v_mul_f32 v137, v137, v102
    v_mul_f32 v138, v138, v102
    v_mul_f32 v139, v139, v102
    v_mul_f32 v140, v140, v102
    v_mfma_f32_16x16x32_bf16 a[116:119], a[216:219], v[220:223], a[116:119]
    v_mul_f32 v141, v141, v102
    v_mul_f32 v142, v142, v102
    v_mul_f32 v143, v143, v102
    v_cvt_pk_bf16_f32 v160, v136, v137
    v_cvt_pk_bf16_f32 v161, v138, v139
    v_cvt_pk_bf16_f32 v162, v140, v141
    v_mfma_f32_16x16x32_bf16 a[120:123], a[216:219], v[228:231], a[120:123]
    v_cvt_pk_bf16_f32 v163, v142, v143
    v_mfma_f32_16x16x32_bf16 a[120:123], a[220:223], v[232:235], a[120:123]
    buffer_store_dwordx4 v[160:163], v110, s[24:27], s36 offen offset:2048 sc1
    v_accvgpr_read_b32 v144, a76
    v_accvgpr_read_b32 v145, a77
    v_accvgpr_read_b32 v146, a78
    v_accvgpr_read_b32 v147, a79
    v_accvgpr_read_b32 v148, a92
    v_accvgpr_read_b32 v149, a93
    v_accvgpr_read_b32 v150, a94
    v_accvgpr_read_b32 v151, a95
    v_maximum3_f32 v108, v108, |v144|, |v145|
    v_maximum3_f32 v109, v109, |v146|, |v147|
    v_maximum3_f32 v108, v108, |v148|, |v149|
    v_mfma_f32_16x16x32_bf16 a[124:127], a[220:223], v[240:243], a[124:127]
    v_maximum3_f32 v109, v109, |v150|, |v151|
    v_mul_f32 v144, v144, v103
    v_mul_f32 v145, v145, v103
    v_mul_f32 v146, v146, v103
    v_mul_f32 v147, v147, v103
    v_mul_f32 v148, v148, v103
    v_mfma_f32_16x16x32_bf16 a[124:127], a[216:219], v[236:239], a[124:127]
    v_mul_f32 v149, v149, v103
    v_mul_f32 v150, v150, v103
    v_mul_f32 v151, v151, v103
    v_cvt_pk_bf16_f32 v164, v144, v145
    v_cvt_pk_bf16_f32 v165, v146, v147
    v_cvt_pk_bf16_f32 v166, v148, v149
    v_cvt_pk_bf16_f32 v167, v150, v151
    buffer_store_dwordx4 v[164:167], v110, s[24:27], s36 offen offset:3072 sc1
    s_mov_b32 s36, 12288
    v_accvgpr_read_b32 v120, a96
    v_accvgpr_read_b32 v121, a97
    v_accvgpr_read_b32 v122, a98
    v_accvgpr_read_b32 v123, a99
    v_accvgpr_read_b32 v124, a112
    v_accvgpr_read_b32 v125, a113
    v_accvgpr_read_b32 v126, a114
    v_accvgpr_read_b32 v127, a115
    v_maximum3_f32 v108, v108, |v120|, |v121|
    v_maximum3_f32 v109, v109, |v122|, |v123|
    v_maximum3_f32 v108, v108, |v124|, |v125|
    v_maximum3_f32 v109, v109, |v126|, |v127|
    v_mul_f32 v120, v120, v100
    v_mul_f32 v121, v121, v100
    v_mul_f32 v122, v122, v100
    v_mul_f32 v123, v123, v100
    v_mul_f32 v124, v124, v100
    v_mul_f32 v125, v125, v100
    v_mul_f32 v126, v126, v100
    v_mul_f32 v127, v127, v100
    v_cvt_pk_bf16_f32 v152, v120, v121
    v_cvt_pk_bf16_f32 v153, v122, v123
    v_cvt_pk_bf16_f32 v154, v124, v125
    v_cvt_pk_bf16_f32 v155, v126, v127
    buffer_store_dwordx4 v[152:155], v110, s[24:27], s36 offen offset:0 sc1
    v_accvgpr_read_b32 v128, a100
    v_accvgpr_read_b32 v129, a101
    v_accvgpr_read_b32 v130, a102
    v_accvgpr_read_b32 v131, a103
    v_accvgpr_read_b32 v132, a116
    v_accvgpr_read_b32 v133, a117
    v_accvgpr_read_b32 v134, a118
    v_accvgpr_read_b32 v135, a119
    v_maximum3_f32 v108, v108, |v128|, |v129|
    v_maximum3_f32 v109, v109, |v130|, |v131|
    v_maximum3_f32 v108, v108, |v132|, |v133|
    v_maximum3_f32 v109, v109, |v134|, |v135|
    v_mul_f32 v128, v128, v101
    v_mul_f32 v129, v129, v101
    v_mul_f32 v130, v130, v101
    v_mul_f32 v131, v131, v101
    v_mul_f32 v132, v132, v101
    v_mul_f32 v133, v133, v101
    v_mul_f32 v134, v134, v101
    v_mul_f32 v135, v135, v101
    v_cvt_pk_bf16_f32 v156, v128, v129
    v_cvt_pk_bf16_f32 v157, v130, v131
    v_cvt_pk_bf16_f32 v158, v132, v133
    v_cvt_pk_bf16_f32 v159, v134, v135
    buffer_store_dwordx4 v[156:159], v110, s[24:27], s36 offen offset:1024 sc1
    v_accvgpr_read_b32 v136, a104
    v_accvgpr_read_b32 v137, a105
    v_accvgpr_read_b32 v138, a106
    v_accvgpr_read_b32 v139, a107
    v_accvgpr_read_b32 v140, a120
    v_accvgpr_read_b32 v141, a121
    v_accvgpr_read_b32 v142, a122
    v_accvgpr_read_b32 v143, a123
    v_maximum3_f32 v108, v108, |v136|, |v137|
    v_maximum3_f32 v109, v109, |v138|, |v139|
    v_maximum3_f32 v108, v108, |v140|, |v141|
    v_maximum3_f32 v109, v109, |v142|, |v143|
    v_mul_f32 v136, v136, v102
    v_mul_f32 v137, v137, v102
    v_mul_f32 v138, v138, v102
    v_mul_f32 v139, v139, v102
    v_mul_f32 v140, v140, v102
    v_mul_f32 v141, v141, v102
    v_mul_f32 v142, v142, v102
    v_mul_f32 v143, v143, v102
    v_cvt_pk_bf16_f32 v160, v136, v137
    v_cvt_pk_bf16_f32 v161, v138, v139
    v_cvt_pk_bf16_f32 v162, v140, v141
    v_cvt_pk_bf16_f32 v163, v142, v143
    buffer_store_dwordx4 v[160:163], v110, s[24:27], s36 offen offset:2048 sc1
    v_accvgpr_read_b32 v144, a108
    v_accvgpr_read_b32 v145, a109
    v_accvgpr_read_b32 v146, a110
    v_accvgpr_read_b32 v147, a111
    v_accvgpr_read_b32 v148, a124
    v_accvgpr_read_b32 v149, a125
    v_accvgpr_read_b32 v150, a126
    v_accvgpr_read_b32 v151, a127
    v_maximum3_f32 v108, v108, |v144|, |v145|
    v_maximum3_f32 v109, v109, |v146|, |v147|
    v_maximum3_f32 v108, v108, |v148|, |v149|
    v_maximum3_f32 v109, v109, |v150|, |v151|
    v_mul_f32 v144, v144, v103
    v_mul_f32 v145, v145, v103
    v_mul_f32 v146, v146, v103
    v_mul_f32 v147, v147, v103
    v_mul_f32 v148, v148, v103
    v_mul_f32 v149, v149, v103
    v_mul_f32 v150, v150, v103
    v_mul_f32 v151, v151, v103
    v_cvt_pk_bf16_f32 v164, v144, v145
    v_cvt_pk_bf16_f32 v165, v146, v147
    v_cvt_pk_bf16_f32 v166, v148, v149
    v_cvt_pk_bf16_f32 v167, v150, v151
    buffer_store_dwordx4 v[164:167], v110, s[24:27], s36 offen offset:3072 sc1
    v_maximum3_f32 v108, v108, v109, v109
    v_cmp_ngt_f32 vcc, 0x7f800000, v108
    s_and_b64 vcc, vcc, exec
    s_cbranch_scc1 L_slow
L_published:
    v_mov_b32 v16, v114
    v_mov_b32 v17, v115
    v_mov_b32 v3, v249
    v_mov_b32 v2, 1
    s_waitcnt vmcnt(16)
    v_lshlrev_b32 v166, 16, v22
    v_and_b32 v167, 0xffff0000, v22
    v_lshlrev_b32 v168, 16, v23
    v_and_b32 v169, 0xffff0000, v23
    v_lshlrev_b32 v170, 16, v24
    v_and_b32 v171, 0xffff0000, v24
    v_lshlrev_b32 v172, 16, v25
    v_and_b32 v173, 0xffff0000, v25
    v_lshlrev_b32 v174, 16, v26
    v_and_b32 v175, 0xffff0000, v26
    v_lshlrev_b32 v176, 16, v27
    v_and_b32 v177, 0xffff0000, v27
    v_lshlrev_b32 v178, 16, v28
    v_and_b32 v179, 0xffff0000, v28
    v_lshlrev_b32 v180, 16, v29
    v_and_b32 v181, 0xffff0000, v29
    v_lshlrev_b32 v182, 16, v30
    v_and_b32 v183, 0xffff0000, v30
    v_lshlrev_b32 v184, 16, v31
    v_and_b32 v185, 0xffff0000, v31
    v_pk_add_f32 v[166:167], v[166:167], v[32:33] op_sel_hi:[1,0] neg_lo:[0,1] neg_hi:[0,1]
    v_pk_add_f32 v[168:169], v[168:169], v[32:33] op_sel_hi:[1,0] neg_lo:[0,1] neg_hi:[0,1]
    v_pk_add_f32 v[170:171], v[170:171], v[32:33] op_sel_hi:[1,0] neg_lo:[0,1] neg_hi:[0,1]
    v_pk_add_f32 v[172:173], v[172:173], v[32:33] op_sel_hi:[1,0] neg_lo:[0,1] neg_hi:[0,1]
    v_pk_add_f32 v[174:175], v[174:175], v[32:33] op_sel_hi:[1,0] neg_lo:[0,1] neg_hi:[0,1]
    v_pk_add_f32 v[176:177], v[176:177], v[32:33] op_sel_hi:[1,0] neg_lo:[0,1] neg_hi:[0,1]
    v_pk_add_f32 v[178:179], v[178:179], v[32:33] op_sel_hi:[1,0] neg_lo:[0,1] neg_hi:[0,1]
    v_pk_add_f32 v[180:181], v[180:181], v[32:33] op_sel_hi:[1,0] neg_lo:[0,1] neg_hi:[0,1]
    v_pk_add_f32 v[182:183], v[182:183], v[32:33] op_sel_hi:[1,0] neg_lo:[0,1] neg_hi:[0,1]
    v_pk_add_f32 v[184:185], v[184:185], v[32:33] op_sel_hi:[1,0] neg_lo:[0,1] neg_hi:[0,1]
    v_cvt_pk_bf16_f32 v36, v166, v167
    v_cvt_pk_bf16_f32 v37, v168, v169
    v_cvt_pk_bf16_f32 v38, v170, v171
    v_cvt_pk_bf16_f32 v39, v172, v173
    v_cvt_pk_bf16_f32 v40, v174, v175
    v_cvt_pk_bf16_f32 v41, v176, v177
    v_cvt_pk_bf16_f32 v42, v178, v179
    v_cvt_pk_bf16_f32 v43, v180, v181
    v_cvt_pk_bf16_f32 v44, v182, v183
    v_cvt_pk_bf16_f32 v45, v184, v185
    v_lshlrev_b32 v166, 16, v36
    v_and_b32 v167, 0xffff0000, v36
    v_lshlrev_b32 v168, 16, v37
    v_and_b32 v169, 0xffff0000, v37
    v_lshlrev_b32 v170, 16, v38
    v_and_b32 v171, 0xffff0000, v38
    v_lshlrev_b32 v172, 16, v39
    v_and_b32 v173, 0xffff0000, v39
    v_lshlrev_b32 v174, 16, v40
    v_and_b32 v175, 0xffff0000, v40
    v_lshlrev_b32 v176, 16, v41
    v_and_b32 v177, 0xffff0000, v41
    v_lshlrev_b32 v178, 16, v42
    v_and_b32 v179, 0xffff0000, v42
    v_lshlrev_b32 v180, 16, v43
    v_and_b32 v181, 0xffff0000, v43
    v_lshlrev_b32 v182, 16, v44
    v_and_b32 v183, 0xffff0000, v44
    v_lshlrev_b32 v184, 16, v45
    v_and_b32 v185, 0xffff0000, v45
    v_pk_mul_f32 v[166:167], v[166:167], v[32:33] op_sel:[0,1] op_sel_hi:[1,1]
    v_pk_mul_f32 v[168:169], v[168:169], v[32:33] op_sel:[0,1] op_sel_hi:[1,1]
    v_pk_mul_f32 v[170:171], v[170:171], v[32:33] op_sel:[0,1] op_sel_hi:[1,1]
    v_pk_mul_f32 v[172:173], v[172:173], v[32:33] op_sel:[0,1] op_sel_hi:[1,1]
    v_pk_mul_f32 v[174:175], v[174:175], v[32:33] op_sel:[0,1] op_sel_hi:[1,1]
    v_pk_mul_f32 v[176:177], v[176:177], v[32:33] op_sel:[0,1] op_sel_hi:[1,1]
    v_pk_mul_f32 v[178:179], v[178:179], v[32:33] op_sel:[0,1] op_sel_hi:[1,1]
    v_pk_mul_f32 v[180:181], v[180:181], v[32:33] op_sel:[0,1] op_sel_hi:[1,1]
    v_pk_mul_f32 v[182:183], v[182:183], v[32:33] op_sel:[0,1] op_sel_hi:[1,1]
    v_pk_mul_f32 v[184:185], v[184:185], v[32:33] op_sel:[0,1] op_sel_hi:[1,1]
    v_cvt_pk_bf16_f32 v36, v166, v167
    v_cvt_pk_bf16_f32 v37, v168, v169
    v_cvt_pk_bf16_f32 v38, v170, v171
    v_cvt_pk_bf16_f32 v39, v172, v173
    v_cvt_pk_bf16_f32 v40, v174, v175
    v_cvt_pk_bf16_f32 v41, v176, v177
    v_cvt_pk_bf16_f32 v42, v178, v179
    v_cvt_pk_bf16_f32 v43, v180, v181
    v_cvt_pk_bf16_f32 v44, v182, v183
    v_cvt_pk_bf16_f32 v45, v184, v185
    s_lshl_b32 s40, s87, 19
    s_add_u32 s40, s40, 0x400000
    s_add_u32 s8, s72, s40
    s_addc_u32 s9, s73, 0
    s_mov_b32 s10, 0x80000
    s_mov_b32 s11, 0x20000
    s_mov_b32 s12, s68
    s_mov_b32 s13, s69
    s_mov_b32 s14, 0x280000
    s_mov_b32 s15, 0x20000
    s_add_u32 s40, s5, 0
    s_and_b32 s40, s40, 3
    s_lshl_b32 s41, s5, 2
    s_add_u32 s41, s41, s40
    s_lshl_b32 s41, s41, 10
    v_lshl_add_u32 v4, v19, 4, s41
    s_add_u32 s40, s5, 1
    s_and_b32 s40, s40, 3
    s_lshl_b32 s41, s5, 2
    s_add_u32 s41, s41, s40
    s_lshl_b32 s41, s41, 10
    v_lshl_add_u32 v5, v19, 4, s41
    s_add_u32 s40, s5, 2
    s_and_b32 s40, s40, 3
    s_lshl_b32 s41, s5, 2
    s_add_u32 s41, s41, s40
    s_lshl_b32 s41, s41, 10
    v_lshl_add_u32 v6, v19, 4, s41
    s_add_u32 s40, s5, 3
    s_and_b32 s40, s40, 3
    s_lshl_b32 s41, s5, 2
    s_add_u32 s41, s41, s40
    s_lshl_b32 s41, s41, 10
    v_lshl_add_u32 v7, v19, 4, s41
    v_lshl_add_u32 v9, v19, 4, s46
    v_add_u32 v10, 81920, v9
    s_waitcnt vmcnt(0)
    s_mov_b64 exec, 1
    buffer_store_dword v2, off, s[76:79], s58 sc1
    s_mov_b64 exec, -1
    s_mov_b32 s45, 0
    buffer_load_dwordx4 a[96:99], v16, s[20:23], s45 offen offset:0 sc1
    buffer_load_dwordx4 a[100:103], v16, s[20:23], s45 offen offset:1024 sc1
    buffer_load_dwordx4 a[104:107], v16, s[20:23], s45 offen offset:2048 sc1
    buffer_load_dwordx4 a[108:111], v16, s[20:23], s45 offen offset:3072 sc1
    buffer_load_dwordx4 a[112:115], v17, s[20:23], s45 offen offset:0 sc1
    s_mov_b32 s45, 20480
    buffer_load_dwordx4 a[116:119], v16, s[20:23], s45 offen offset:0 sc1
    buffer_load_dwordx4 a[120:123], v16, s[20:23], s45 offen offset:1024 sc1
    buffer_load_dwordx4 a[124:127], v16, s[20:23], s45 offen offset:2048 sc1
    buffer_load_dwordx4 a[128:131], v16, s[20:23], s45 offen offset:3072 sc1
    buffer_load_dwordx4 a[132:135], v17, s[20:23], s45 offen offset:0 sc1
    v_min3_u32 v252, v252, v253, v254
    v_min_u32 v252, v252, v255
    v_cmp_gt_u32 vcc, 2, v252
    s_and_b64 vcc, vcc, exec
    s_cbranch_scc1 L_spin_ffn
L_back_ffn:
    s_mul_i32 s40, s6, 27648
    s_lshl_b32 s41, s5, 10
    s_add_u32 s40, s40, s41
    v_lshlrev_b32 v194, 4, v19
    buffer_load_dwordx4 v[166:169], v194, s[16:19], s40 offen sc1
    s_add_u32 s40, s40, 4096
    buffer_load_dwordx4 v[170:173], v194, s[16:19], s40 offen sc1
    s_add_u32 s40, s40, 4096
    buffer_load_dwordx4 v[174:177], v194, s[16:19], s40 offen sc1
    s_add_u32 s40, s40, 4096
    buffer_load_dwordx4 v[178:181], v194, s[16:19], s40 offen sc1
    s_add_u32 s40, s40, 4096
    buffer_load_dwordx4 v[182:185], v194, s[16:19], s40 offen sc1
    s_add_u32 s40, s40, 4096
    buffer_load_dwordx4 v[186:189], v194, s[16:19], s40 offen sc1
    s_add_u32 s40, s40, 4096
    s_cmp_eq_u32 s5, 3
    s_cselect_b32 s40, 0x438000, s40
    buffer_load_dwordx4 v[190:193], v194, s[16:19], s40 offen sc1
    v_mov_b32 v11, 0x2000000
    s_not_b32 s40, s50
    s_and_b32 s40, s40, 0x7ff
    v_cmp_eq_u32 vcc, s40, v35
    s_mov_b32 s45, 81920
    buffer_load_dwordx4 a[176:179], v16, s[20:23], s45 offen offset:0 sc1
    v_mov_b32 v12, 0x29c000
    s_nop 0
    v_cndmask_b32 v11, v11, v12, vcc
    s_not_b32 s40, s51
    buffer_load_dwordx4 a[180:183], v16, s[20:23], s45 offen offset:1024 sc1
    s_and_b32 s40, s40, 0x7ff
    v_cmp_eq_u32 vcc, s40, v35
    v_mov_b32 v12, 0x29c500
    s_nop 0
    buffer_load_dwordx4 a[184:187], v16, s[20:23], s45 offen offset:2048 sc1
    v_cndmask_b32 v11, v11, v12, vcc
    s_not_b32 s40, s52
    s_and_b32 s40, s40, 0x7ff
    v_cmp_eq_u32 vcc, s40, v35
    buffer_load_dwordx4 a[188:191], v16, s[20:23], s45 offen offset:3072 sc1
    v_mov_b32 v12, 0x29ca00
    s_nop 0
    v_cndmask_b32 v11, v11, v12, vcc
    s_not_b32 s40, s53
    buffer_load_dwordx4 a[192:195], v17, s[20:23], s45 offen offset:0 sc1
    s_and_b32 s40, s40, 0x7ff
    v_cmp_eq_u32 vcc, s40, v35
    v_mov_b32 v12, 0x29cf00
    s_nop 0
    s_mov_b32 s45, 102400
    buffer_load_dwordx4 a[196:199], v16, s[20:23], s45 offen offset:0 sc1
    v_cndmask_b32 v11, v11, v12, vcc
    s_not_b32 s40, s54
    s_and_b32 s40, s40, 0x7ff
    v_cmp_eq_u32 vcc, s40, v35
    buffer_load_dwordx4 a[200:203], v16, s[20:23], s45 offen offset:1024 sc1
    v_mov_b32 v12, 0x29d400
    s_nop 0
    v_cndmask_b32 v11, v11, v12, vcc
    s_not_b32 s40, s55
    buffer_load_dwordx4 a[204:207], v16, s[20:23], s45 offen offset:2048 sc1
    s_and_b32 s40, s40, 0x7ff
    v_cmp_eq_u32 vcc, s40, v35
    v_mov_b32 v12, 0x29d900
    s_nop 0
    buffer_load_dwordx4 a[208:211], v16, s[20:23], s45 offen offset:3072 sc1
    v_cndmask_b32 v11, v11, v12, vcc
    s_not_b32 s40, s56
    s_and_b32 s40, s40, 0x7ff
    v_cmp_eq_u32 vcc, s40, v35
    buffer_load_dwordx4 a[212:215], v17, s[20:23], s45 offen offset:0 sc1
    v_mov_b32 v12, 0x29de00
    s_nop 0
    v_cndmask_b32 v11, v11, v12, vcc
    s_not_b32 s40, s57
    s_mov_b32 s45, 163840
    buffer_load_dwordx4 v[46:49], v16, s[20:23], s45 offen offset:0 sc1
    s_and_b32 s40, s40, 0x7ff
    v_cmp_eq_u32 vcc, s40, v35
    v_mov_b32 v12, 0x29e300
    s_nop 0
    buffer_load_dwordx4 v[50:53], v16, s[20:23], s45 offen offset:1024 sc1
    v_cndmask_b32 v11, v11, v12, vcc
    v_mul_u32_u24 v12, 1280, v35
    v_sub_u32 v12, v34, v12
    v_add_u32 v11, v11, v12
    buffer_load_dwordx4 v[54:57], v16, s[20:23], s45 offen offset:2048 sc1
    buffer_load_dwordx4 v[58:61], v16, s[20:23], s45 offen offset:3072 sc1
    buffer_load_dwordx4 v[62:65], v17, s[20:23], s45 offen offset:0 sc1
    s_waitcnt vmcnt(15)
    v_add_f32 v166, v166, v170
    v_add_f32 v167, v167, v171
    v_add_f32 v168, v168, v172
    v_add_f32 v169, v169, v173
    v_add_f32 v166, v166, v174
    v_add_f32 v167, v167, v175
    v_add_f32 v168, v168, v176
    v_add_f32 v169, v169, v177
    s_mov_b32 s45, 184320
    buffer_load_dwordx4 v[66:69], v16, s[20:23], s45 offen offset:0 sc1
    v_add_f32 v166, v166, v178
    v_add_f32 v167, v167, v179
    v_add_f32 v168, v168, v180
    v_add_f32 v169, v169, v181
    v_add_f32 v166, v166, v182
    v_add_f32 v167, v167, v183
    v_add_f32 v168, v168, v184
    v_add_f32 v169, v169, v185
    buffer_load_dwordx4 v[70:73], v16, s[20:23], s45 offen offset:1024 sc1
    v_add_f32 v166, v166, v186
    v_add_f32 v167, v167, v187
    v_add_f32 v168, v168, v188
    v_add_f32 v169, v169, v189
    v_add_f32 v166, v166, v190
    v_add_f32 v167, v167, v191
    v_add_f32 v168, v168, v192
    v_add_f32 v169, v169, v193
    buffer_load_dwordx4 v[74:77], v16, s[20:23], s45 offen offset:2048 sc1
    v_add_f32_dpp v166, v166, v166 row_ror:8 row_mask:0xf bank_mask:0xf
    v_add_f32_dpp v167, v167, v167 row_ror:8 row_mask:0xf bank_mask:0xf
    v_add_f32_dpp v168, v168, v168 row_ror:8 row_mask:0xf bank_mask:0xf
    v_add_f32_dpp v169, v169, v169 row_ror:8 row_mask:0xf bank_mask:0xf
    v_mov_b32 v170, v166
    v_mov_b32 v171, v167
    v_mov_b32 v172, v168
    v_mov_b32 v173, v169
    buffer_load_dwordx4 v[78:81], v16, s[20:23], s45 offen offset:3072 sc1
    v_permlane16_swap_b32 v166, v170
    v_permlane16_swap_b32 v167, v171
    v_permlane16_swap_b32 v168, v172
    v_permlane16_swap_b32 v169, v173
    v_add_f32 v166, v166, v170
    v_add_f32 v167, v167, v171
    v_add_f32 v168, v168, v172
    v_add_f32 v169, v169, v173
    buffer_load_dwordx4 v[82:85], v17, s[20:23], s45 offen offset:0 sc1
    v_mov_b32 v170, v166
    v_mov_b32 v171, v167
    v_mov_b32 v172, v168
    v_mov_b32 v173, v169
    v_permlane32_swap_b32 v166, v170
    v_permlane32_swap_b32 v167, v171
    v_permlane32_swap_b32 v168, v172
    v_permlane32_swap_b32 v169, v173
    v_add_f32 v166, v166, v170
    v_add_f32 v167, v167, v171
    v_add_f32 v168, v168, v172
    v_add_f32 v169, v169, v173
    v_and_b32 v194, 7, v19
    v_lshlrev_b32 v194, 4, v194
    v_add_u32 v194, 81920, v194
    s_lshl_b32 s40, s5, 7
    v_add_u32 v195, s40, v194
    ds_write_b128 v195, v[166:169]
    s_waitcnt lgkmcnt(0)
    s_barrier
    s_mov_b32 s45, 204800
    buffer_load_dwordx4 v[86:89], v16, s[20:23], s45 offen offset:0 sc1
    buffer_load_dwordx4 v[90:93], v16, s[20:23], s45 offen offset:1024 sc1
    buffer_load_dwordx4 v[94:97], v16, s[20:23], s45 offen offset:2048 sc1
    buffer_load_dwordx4 v[98:101], v16, s[20:23], s45 offen offset:3072 sc1
    buffer_load_dwordx4 v[102:105], v17, s[20:23], s45 offen offset:0 sc1
    s_mov_b32 s45, 225280
    buffer_load_dwordx4 v[106:109], v16, s[20:23], s45 offen offset:0 sc1
    buffer_load_dwordx4 v[110:113], v16, s[20:23], s45 offen offset:1024 sc1
    buffer_load_dwordx4 v[114:117], v16, s[20:23], s45 offen offset:2048 sc1
    buffer_load_dwordx4 v[118:121], v16, s[20:23], s45 offen offset:3072 sc1
    buffer_load_dwordx4 v[122:125], v17, s[20:23], s45 offen offset:0 sc1
    s_cmp_lg_u32 s5, 0
    s_cbranch_scc1 L_summed
    ds_read_b128 v[166:169], v194 offset:0
    ds_read_b128 v[170:173], v194 offset:128
    ds_read_b128 v[174:177], v194 offset:256
    ds_read_b128 v[178:181], v194 offset:384
    s_mul_i32 s42, s6, 3277
    s_lshr_b32 s42, s42, 16
    s_min_u32 s42, s42, 7
    v_readlane_b32 s40, v3, s42
    s_and_b32 s40, s40, 0xffff0000
    s_ashr_i32 s41, s40, 31
    s_andn2_b32 s41, 0x7fff0000, s41
    s_or_b32 s41, s41, 0x80000000
    s_xor_b32 s40, s40, s41
    v_mov_b32 v182, 0xbfb8aa3b
    v_mul_f32 v182, s40, v182
    v_exp_f32 v182, v182
    s_nop 0
    v_add_f32 v182, 1.0, v182
    v_rcp_f32 v182, v182
    s_nop 0
    v_cvt_pk_bf16_f32 v182, v182, v182
    v_lshlrev_b32 v182, 16, v182
    s_lshl_b32 s40, s6, 6
    s_add_u32 s40, s40, 0x29c000
    s_cmp_lt_u32 s6, 160
    s_cselect_b32 s40, s40, 0x2000000
    v_lshlrev_b32 v183, 3, v19
    s_waitcnt lgkmcnt(0)
    v_add_f32 v166, v166, v170
    v_add_f32 v167, v167, v171
    v_add_f32 v168, v168, v172
    v_add_f32 v169, v169, v173
    v_add_f32 v166, v166, v174
    v_add_f32 v167, v167, v175
    v_add_f32 v168, v168, v176
    v_add_f32 v169, v169, v177
    v_add_f32 v166, v166, v178
    v_add_f32 v167, v167, v179
    v_add_f32 v168, v168, v180
    v_add_f32 v169, v169, v181
    v_cvt_pk_bf16_f32 v170, v166, v167
    v_cvt_pk_bf16_f32 v171, v168, v169
    v_lshlrev_b32 v166, 16, v170
    v_and_b32 v167, 0xffff0000, v170
    v_lshlrev_b32 v168, 16, v171
    v_and_b32 v169, 0xffff0000, v171
    v_mul_f32 v166, v166, v182
    v_mul_f32 v167, v167, v182
    v_mul_f32 v168, v168, v182
    v_mul_f32 v169, v169, v182
    v_cvt_pk_bf16_f32 v170, v166, v167
    v_cvt_pk_bf16_f32 v171, v168, v169
    s_mov_b64 exec, 0xff
    buffer_store_dwordx2 v[170:171], v183, s[76:79], s40 offen sc1
    s_mov_b64 exec, -1
L_summed:
    s_mov_b32 s45, 245760
    buffer_load_dwordx4 v[126:129], v16, s[20:23], s45 offen offset:0 sc1
    buffer_load_dwordx4 v[130:133], v16, s[20:23], s45 offen offset:1024 sc1
    buffer_load_dwordx4 v[134:137], v16, s[20:23], s45 offen offset:2048 sc1
    buffer_load_dwordx4 v[138:141], v16, s[20:23], s45 offen offset:3072 sc1
    buffer_load_dwordx4 v[142:145], v17, s[20:23], s45 offen offset:0 sc1
    s_mov_b32 s45, 266240
    buffer_load_dwordx4 v[146:149], v16, s[20:23], s45 offen offset:0 sc1
    buffer_load_dwordx4 v[150:153], v16, s[20:23], s45 offen offset:1024 sc1
    buffer_load_dwordx4 v[154:157], v16, s[20:23], s45 offen offset:2048 sc1
    buffer_load_dwordx4 v[158:161], v16, s[20:23], s45 offen offset:3072 sc1
    buffer_load_dwordx4 v[162:165], v17, s[20:23], s45 offen offset:0 sc1
    s_mov_b32 s45, 122880
    buffer_load_dwordx4 a[216:219], v16, s[20:23], s45 offen offset:0 sc1
    buffer_load_dwordx4 a[220:223], v16, s[20:23], s45 offen offset:1024 sc1
    buffer_load_dwordx4 a[224:227], v16, s[20:23], s45 offen offset:2048 sc1
    buffer_load_dwordx4 a[228:231], v16, s[20:23], s45 offen offset:3072 sc1
    buffer_load_dwordx4 a[232:235], v17, s[20:23], s45 offen offset:0 sc1
    s_mov_b32 s45, 143360
    buffer_load_dwordx4 a[236:239], v16, s[20:23], s45 offen offset:0 sc1
    buffer_load_dwordx4 a[240:243], v16, s[20:23], s45 offen offset:1024 sc1
    buffer_load_dwordx4 a[244:247], v16, s[20:23], s45 offen offset:2048 sc1
    buffer_load_dwordx4 a[248:251], v16, s[20:23], s45 offen offset:3072 sc1
    buffer_load_dwordx4 a[252:255], v17, s[20:23], s45 offen offset:0 sc1
    v_mov_b32 v2, 3
    s_cmp_lg_u32 s5, 0
    s_cbranch_scc1 L_sum_flagged
    s_waitcnt vmcnt(20)
    s_mov_b64 exec, 1
    buffer_store_dword v2, off, s[76:79], s75 sc1
    s_mov_b64 exec, -1
L_sum_flagged:
    s_lshl_b32 s40, s87, 10
    s_add_u32 s40, s40, 0x292000
    v_and_b32 v1, 7, v19
    v_lshl_add_u32 v1, v1, 7, s40
    s_add_u32 m0, s46, 0
    s_mov_b32 s45, 327680
    buffer_load_dwordx4 v16, s[20:23], s45 offen offset:0 sc1 lds
    buffer_load_dwordx4 v16, s[20:23], s45 offen offset:1024 sc1 lds
    buffer_load_dwordx4 v16, s[20:23], s45 offen offset:2048 sc1 lds
    buffer_load_dwordx4 v16, s[20:23], s45 offen offset:3072 sc1 lds
    s_add_u32 m0, s46, 4096
    s_nop 0
    buffer_load_dwordx4 v17, s[20:23], s45 offen offset:0 sc1 lds
    s_add_u32 m0, s46, 5120
    s_mov_b32 s45, 348160
    buffer_load_dwordx4 v16, s[20:23], s45 offen offset:0 sc1 lds
    buffer_load_dwordx4 v16, s[20:23], s45 offen offset:1024 sc1 lds
    buffer_load_dwordx4 v16, s[20:23], s45 offen offset:2048 sc1 lds
    buffer_load_dwordx4 v16, s[20:23], s45 offen offset:3072 sc1 lds
    s_add_u32 m0, s46, 9216
    s_nop 0
    buffer_load_dwordx4 v17, s[20:23], s45 offen offset:0 sc1 lds
    buffer_load_dwordx4 v[252:255], v1, s[76:79], 0 offen sc1
    s_add_u32 m0, s46, 40960
    s_mov_b32 s45, 368640
    buffer_load_dwordx4 v16, s[20:23], s45 offen offset:0 sc1 lds
    buffer_load_dwordx4 v16, s[20:23], s45 offen offset:1024 sc1 lds
    buffer_load_dwordx4 v16, s[20:23], s45 offen offset:2048 sc1 lds
    buffer_load_dwordx4 v16, s[20:23], s45 offen offset:3072 sc1 lds
    s_add_u32 m0, s46, 45056
    s_nop 0
    buffer_load_dwordx4 v17, s[20:23], s45 offen offset:0 sc1 lds
    s_add_u32 m0, s46, 46080
    s_mov_b32 s45, 389120
    buffer_load_dwordx4 v16, s[20:23], s45 offen offset:0 sc1 lds
    buffer_load_dwordx4 v16, s[20:23], s45 offen offset:1024 sc1 lds
    buffer_load_dwordx4 v16, s[20:23], s45 offen offset:2048 sc1 lds
    buffer_load_dwordx4 v16, s[20:23], s45 offen offset:3072 sc1 lds
    s_add_u32 m0, s46, 50176
    s_nop 0
    buffer_load_dwordx4 v17, s[20:23], s45 offen offset:0 sc1 lds
    s_add_u32 m0, s46, 81920
    s_mov_b32 s45, 409600
    buffer_load_dwordx4 v16, s[20:23], s45 offen offset:0 sc1 lds
    buffer_load_dwordx4 v16, s[20:23], s45 offen offset:1024 sc1 lds
    buffer_load_dwordx4 v16, s[20:23], s45 offen offset:2048 sc1 lds
    buffer_load_dwordx4 v16, s[20:23], s45 offen offset:3072 sc1 lds
    s_add_u32 m0, s46, 86016
    s_nop 0
    buffer_load_dwordx4 v17, s[20:23], s45 offen offset:0 sc1 lds
    s_add_u32 m0, s46, 87040
    s_mov_b32 s45, 430080
    buffer_load_dwordx4 v16, s[20:23], s45 offen offset:0 sc1 lds
    buffer_load_dwordx4 v16, s[20:23], s45 offen offset:1024 sc1 lds
    buffer_load_dwordx4 v16, s[20:23], s45 offen offset:2048 sc1 lds
    buffer_load_dwordx4 v16, s[20:23], s45 offen offset:3072 sc1 lds
    s_add_u32 m0, s46, 91136
    s_nop 0
    buffer_load_dwordx4 v17, s[20:23], s45 offen offset:0 sc1 lds
    s_cmp_lg_u32 s5, 0
    s_cbranch_scc1 L_back_o
    s_waitcnt vmcnt(20)
    v_min3_u32 v252, v252, v253, v254
    v_min_u32 v252, v252, v255
    v_cmp_gt_u32 vcc, 1, v252
    s_and_b64 vcc, vcc, exec
    s_cbranch_scc1 L_spin_o
L_back_o:
    s_barrier
    s_mov_b32 s44, 0
    buffer_load_dwordx4 a[0:3], v4, s[8:11], s44 offen sc1
    buffer_load_dwordx4 a[4:7], v5, s[8:11], s44 offen sc1
    buffer_load_dwordx4 a[8:11], v6, s[8:11], s44 offen sc1
    buffer_load_dwordx4 a[12:15], v7, s[8:11], s44 offen sc1
    s_mov_b32 s44, 16384
    buffer_load_dwordx4 a[16:19], v4, s[8:11], s44 offen sc1
    buffer_load_dwordx4 a[20:23], v5, s[8:11], s44 offen sc1
    buffer_load_dwordx4 a[24:27], v6, s[8:11], s44 offen sc1
    buffer_load_dwordx4 a[28:31], v7, s[8:11], s44 offen sc1
    s_mov_b32 s44, 32768
    buffer_load_dwordx4 a[32:35], v4, s[8:11], s44 offen sc1
    buffer_load_dwordx4 a[36:39], v5, s[8:11], s44 offen sc1
    buffer_load_dwordx4 a[40:43], v6, s[8:11], s44 offen sc1
    buffer_load_dwordx4 a[44:47], v7, s[8:11], s44 offen sc1
    s_mov_b32 s44, 49152
    buffer_load_dwordx4 a[48:51], v4, s[8:11], s44 offen sc1
    buffer_load_dwordx4 a[52:55], v5, s[8:11], s44 offen sc1
    buffer_load_dwordx4 a[56:59], v6, s[8:11], s44 offen sc1
    buffer_load_dwordx4 a[60:63], v7, s[8:11], s44 offen sc1
    s_waitcnt vmcnt(8)
    v_mfma_f32_16x16x32_bf16 v[166:169], a[96:99], a[0:3], 0
    s_mov_b32 s44, 65536
    buffer_load_dwordx4 a[64:67], v4, s[8:11], s44 offen sc1
    v_mfma_f32_16x16x32_bf16 v[166:169], a[116:119], a[16:19], v[166:169]
    v_mfma_f32_16x16x32_bf16 v[186:189], a[116:119], a[20:23], 0
    v_mfma_f32_16x16x32_bf16 v[186:189], a[96:99], a[4:7], v[186:189]
    buffer_load_dwordx4 a[68:71], v5, s[8:11], s44 offen sc1
    v_mfma_f32_16x16x32_bf16 v[206:209], a[96:99], a[8:11], 0
    v_mfma_f32_16x16x32_bf16 v[206:209], a[116:119], a[24:27], v[206:209]
    v_mfma_f32_16x16x32_bf16 v[226:229], a[116:119], a[28:31], 0
    v_mfma_f32_16x16x32_bf16 v[226:229], a[96:99], a[12:15], v[226:229]
    buffer_load_dwordx4 a[72:75], v6, s[8:11], s44 offen sc1
    v_mfma_f32_16x16x32_bf16 v[170:173], a[100:103], a[0:3], 0
    v_mfma_f32_16x16x32_bf16 v[170:173], a[120:123], a[16:19], v[170:173]
    v_mfma_f32_16x16x32_bf16 v[190:193], a[120:123], a[20:23], 0
    v_mfma_f32_16x16x32_bf16 v[190:193], a[100:103], a[4:7], v[190:193]
    buffer_load_dwordx4 a[76:79], v7, s[8:11], s44 offen sc1
    v_mfma_f32_16x16x32_bf16 v[210:213], a[100:103], a[8:11], 0
    v_mfma_f32_16x16x32_bf16 v[210:213], a[120:123], a[24:27], v[210:213]
    v_mfma_f32_16x16x32_bf16 v[230:233], a[120:123], a[28:31], 0
    v_mfma_f32_16x16x32_bf16 v[230:233], a[100:103], a[12:15], v[230:233]
    s_mov_b32 s44, 81920
    buffer_load_dwordx4 a[80:83], v4, s[8:11], s44 offen sc1
    v_mfma_f32_16x16x32_bf16 v[174:177], a[104:107], a[0:3], 0
    v_mfma_f32_16x16x32_bf16 v[174:177], a[124:127], a[16:19], v[174:177]
    v_mfma_f32_16x16x32_bf16 v[194:197], a[124:127], a[20:23], 0
    buffer_load_dwordx4 a[84:87], v5, s[8:11], s44 offen sc1
    v_mfma_f32_16x16x32_bf16 v[194:197], a[104:107], a[4:7], v[194:197]
    v_mfma_f32_16x16x32_bf16 v[214:217], a[104:107], a[8:11], 0
    v_mfma_f32_16x16x32_bf16 v[214:217], a[124:127], a[24:27], v[214:217]
    v_mfma_f32_16x16x32_bf16 v[234:237], a[124:127], a[28:31], 0
    buffer_load_dwordx4 a[88:91], v6, s[8:11], s44 offen sc1
    v_mfma_f32_16x16x32_bf16 v[234:237], a[104:107], a[12:15], v[234:237]
    v_mfma_f32_16x16x32_bf16 v[178:181], a[108:111], a[0:3], 0
    v_mfma_f32_16x16x32_bf16 v[178:181], a[128:131], a[16:19], v[178:181]
    v_mfma_f32_16x16x32_bf16 v[198:201], a[128:131], a[20:23], 0
    buffer_load_dwordx4 a[92:95], v7, s[8:11], s44 offen sc1
    v_mfma_f32_16x16x32_bf16 v[198:201], a[108:111], a[4:7], v[198:201]
    v_mfma_f32_16x16x32_bf16 v[218:221], a[108:111], a[8:11], 0
    v_mfma_f32_16x16x32_bf16 v[218:221], a[128:131], a[24:27], v[218:221]
    v_mfma_f32_16x16x32_bf16 v[238:241], a[128:131], a[28:31], 0
    v_mfma_f32_16x16x32_bf16 v[238:241], a[108:111], a[12:15], v[238:241]
    v_mfma_f32_16x16x32_bf16 v[182:185], a[112:115], a[0:3], 0
    v_mfma_f32_16x16x32_bf16 v[182:185], a[132:135], a[16:19], v[182:185]
    v_mfma_f32_16x16x32_bf16 v[202:205], a[132:135], a[20:23], 0
    v_mfma_f32_16x16x32_bf16 v[202:205], a[112:115], a[4:7], v[202:205]
    v_mfma_f32_16x16x32_bf16 v[222:225], a[112:115], a[8:11], 0
    v_mfma_f32_16x16x32_bf16 v[222:225], a[132:135], a[24:27], v[222:225]
    v_mfma_f32_16x16x32_bf16 v[242:245], a[132:135], a[28:31], 0
    v_mfma_f32_16x16x32_bf16 v[242:245], a[112:115], a[12:15], v[242:245]
    s_waitcnt vmcnt(8)
    v_mfma_f32_16x16x32_bf16 v[166:169], a[136:139], a[32:35], v[166:169]
    s_mov_b32 s44, 98304
    buffer_load_dwordx4 a[0:3], v4, s[8:11], s44 offen sc1
    v_mfma_f32_16x16x32_bf16 v[166:169], a[156:159], a[48:51], v[166:169]
    v_mfma_f32_16x16x32_bf16 v[186:189], a[156:159], a[52:55], v[186:189]
    buffer_load_dwordx4 a[4:7], v5, s[8:11], s44 offen sc1
    v_mfma_f32_16x16x32_bf16 v[186:189], a[136:139], a[36:39], v[186:189]
    v_mfma_f32_16x16x32_bf16 v[206:209], a[136:139], a[40:43], v[206:209]
    v_mfma_f32_16x16x32_bf16 v[206:209], a[156:159], a[56:59], v[206:209]
    buffer_load_dwordx4 a[8:11], v6, s[8:11], s44 offen sc1
    v_mfma_f32_16x16x32_bf16 v[226:229], a[156:159], a[60:63], v[226:229]
    v_mfma_f32_16x16x32_bf16 v[226:229], a[136:139], a[44:47], v[226:229]
    buffer_load_dwordx4 a[12:15], v7, s[8:11], s44 offen sc1
    v_mfma_f32_16x16x32_bf16 v[170:173], a[140:143], a[32:35], v[170:173]
    v_mfma_f32_16x16x32_bf16 v[170:173], a[160:163], a[48:51], v[170:173]
    v_mfma_f32_16x16x32_bf16 v[190:193], a[160:163], a[52:55], v[190:193]
    s_mov_b32 s44, 114688
    buffer_load_dwordx4 a[16:19], v4, s[8:11], s44 offen sc1
    v_mfma_f32_16x16x32_bf16 v[190:193], a[140:143], a[36:39], v[190:193]
    v_mfma_f32_16x16x32_bf16 v[210:213], a[140:143], a[40:43], v[210:213]
    buffer_load_dwordx4 a[20:23], v5, s[8:11], s44 offen sc1
    v_mfma_f32_16x16x32_bf16 v[210:213], a[160:163], a[56:59], v[210:213]
    v_mfma_f32_16x16x32_bf16 v[230:233], a[160:163], a[60:63], v[230:233]
    v_mfma_f32_16x16x32_bf16 v[230:233], a[140:143], a[44:47], v[230:233]
    buffer_load_dwordx4 a[24:27], v6, s[8:11], s44 offen sc1
    v_mfma_f32_16x16x32_bf16 v[174:177], a[144:147], a[32:35], v[174:177]
    v_mfma_f32_16x16x32_bf16 v[174:177], a[164:167], a[48:51], v[174:177]
    buffer_load_dwordx4 a[28:31], v7, s[8:11], s44 offen sc1
    v_mfma_f32_16x16x32_bf16 v[194:197], a[164:167], a[52:55], v[194:197]
    v_mfma_f32_16x16x32_bf16 v[194:197], a[144:147], a[36:39], v[194:197]
    v_mfma_f32_16x16x32_bf16 v[214:217], a[144:147], a[40:43], v[214:217]
    s_mov_b32 s45, 450560
    buffer_load_dwordx4 a[96:99], v16, s[20:23], s45 offen offset:0 sc1
    v_mfma_f32_16x16x32_bf16 v[214:217], a[164:167], a[56:59], v[214:217]
    v_mfma_f32_16x16x32_bf16 v[234:237], a[164:167], a[60:63], v[234:237]
    buffer_load_dwordx4 a[100:103], v16, s[20:23], s45 offen offset:1024 sc1
    v_mfma_f32_16x16x32_bf16 v[234:237], a[144:147], a[44:47], v[234:237]
    v_mfma_f32_16x16x32_bf16 v[178:181], a[148:151], a[32:35], v[178:181]
    v_mfma_f32_16x16x32_bf16 v[178:181], a[168:171], a[48:51], v[178:181]
    buffer_load_dwordx4 a[104:107], v16, s[20:23], s45 offen offset:2048 sc1
    v_mfma_f32_16x16x32_bf16 v[198:201], a[168:171], a[52:55], v[198:201]
    v_mfma_f32_16x16x32_bf16 v[198:201], a[148:151], a[36:39], v[198:201]
    buffer_load_dwordx4 a[108:111], v16, s[20:23], s45 offen offset:3072 sc1
    v_mfma_f32_16x16x32_bf16 v[218:221], a[148:151], a[40:43], v[218:221]
    v_mfma_f32_16x16x32_bf16 v[218:221], a[168:171], a[56:59], v[218:221]
    v_mfma_f32_16x16x32_bf16 v[238:241], a[168:171], a[60:63], v[238:241]
    v_mfma_f32_16x16x32_bf16 v[238:241], a[148:151], a[44:47], v[238:241]
    v_mfma_f32_16x16x32_bf16 v[182:185], a[152:155], a[32:35], v[182:185]
    v_mfma_f32_16x16x32_bf16 v[182:185], a[172:175], a[48:51], v[182:185]
    v_mfma_f32_16x16x32_bf16 v[202:205], a[172:175], a[52:55], v[202:205]
    v_mfma_f32_16x16x32_bf16 v[202:205], a[152:155], a[36:39], v[202:205]
    v_mfma_f32_16x16x32_bf16 v[222:225], a[152:155], a[40:43], v[222:225]
    v_mfma_f32_16x16x32_bf16 v[222:225], a[172:175], a[56:59], v[222:225]
    v_mfma_f32_16x16x32_bf16 v[242:245], a[172:175], a[60:63], v[242:245]
    v_mfma_f32_16x16x32_bf16 v[242:245], a[152:155], a[44:47], v[242:245]
    s_waitcnt vmcnt(12)
    v_mfma_f32_16x16x32_bf16 v[166:169], a[176:179], a[64:67], v[166:169]
    s_mov_b32 s44, 131072
    buffer_load_dwordx4 a[32:35], v4, s[8:11], s44 offen sc1
    v_mfma_f32_16x16x32_bf16 v[166:169], a[196:199], a[80:83], v[166:169]
    v_mfma_f32_16x16x32_bf16 v[186:189], a[196:199], a[84:87], v[186:189]
    buffer_load_dwordx4 a[36:39], v5, s[8:11], s44 offen sc1
    v_mfma_f32_16x16x32_bf16 v[186:189], a[176:179], a[68:71], v[186:189]
    v_mfma_f32_16x16x32_bf16 v[206:209], a[176:179], a[72:75], v[206:209]
    v_mfma_f32_16x16x32_bf16 v[206:209], a[196:199], a[88:91], v[206:209]
    buffer_load_dwordx4 a[40:43], v6, s[8:11], s44 offen sc1
    v_mfma_f32_16x16x32_bf16 v[226:229], a[196:199], a[92:95], v[226:229]
    v_mfma_f32_16x16x32_bf16 v[226:229], a[176:179], a[76:79], v[226:229]
    buffer_load_dwordx4 a[44:47], v7, s[8:11], s44 offen sc1
    v_mfma_f32_16x16x32_bf16 v[170:173], a[180:183], a[64:67], v[170:173]
    v_mfma_f32_16x16x32_bf16 v[170:173], a[200:203], a[80:83], v[170:173]
    v_mfma_f32_16x16x32_bf16 v[190:193], a[200:203], a[84:87], v[190:193]
    s_mov_b32 s44, 147456
    buffer_load_dwordx4 a[48:51], v4, s[8:11], s44 offen sc1
    v_mfma_f32_16x16x32_bf16 v[190:193], a[180:183], a[68:71], v[190:193]
    v_mfma_f32_16x16x32_bf16 v[210:213], a[180:183], a[72:75], v[210:213]
    buffer_load_dwordx4 a[52:55], v5, s[8:11], s44 offen sc1
    v_mfma_f32_16x16x32_bf16 v[210:213], a[200:203], a[88:91], v[210:213]
    v_mfma_f32_16x16x32_bf16 v[230:233], a[200:203], a[92:95], v[230:233]
    v_mfma_f32_16x16x32_bf16 v[230:233], a[180:183], a[76:79], v[230:233]
    buffer_load_dwordx4 a[56:59], v6, s[8:11], s44 offen sc1
    v_mfma_f32_16x16x32_bf16 v[174:177], a[184:187], a[64:67], v[174:177]
    v_mfma_f32_16x16x32_bf16 v[174:177], a[204:207], a[80:83], v[174:177]
    buffer_load_dwordx4 a[60:63], v7, s[8:11], s44 offen sc1
    v_mfma_f32_16x16x32_bf16 v[194:197], a[204:207], a[84:87], v[194:197]
    v_mfma_f32_16x16x32_bf16 v[194:197], a[184:187], a[68:71], v[194:197]
    v_mfma_f32_16x16x32_bf16 v[214:217], a[184:187], a[72:75], v[214:217]
    buffer_load_dwordx4 a[112:115], v17, s[20:23], s45 offen offset:0 sc1
    v_mfma_f32_16x16x32_bf16 v[214:217], a[204:207], a[88:91], v[214:217]
    v_mfma_f32_16x16x32_bf16 v[234:237], a[204:207], a[92:95], v[234:237]
    s_mov_b32 s45, 471040
    buffer_load_dwordx4 a[116:119], v16, s[20:23], s45 offen offset:0 sc1
    v_mfma_f32_16x16x32_bf16 v[234:237], a[184:187], a[76:79], v[234:237]
    v_mfma_f32_16x16x32_bf16 v[178:181], a[188:191], a[64:67], v[178:181]
    v_mfma_f32_16x16x32_bf16 v[178:181], a[208:211], a[80:83], v[178:181]
    buffer_load_dwordx4 a[120:123], v16, s[20:23], s45 offen offset:1024 sc1
    v_mfma_f32_16x16x32_bf16 v[198:201], a[208:211], a[84:87], v[198:201]
    v_mfma_f32_16x16x32_bf16 v[198:201], a[188:191], a[68:71], v[198:201]
    buffer_load_dwordx4 a[124:127], v16, s[20:23], s45 offen offset:2048 sc1
    v_mfma_f32_16x16x32_bf16 v[218:221], a[188:191], a[72:75], v[218:221]
    v_mfma_f32_16x16x32_bf16 v[218:221], a[208:211], a[88:91], v[218:221]
    v_mfma_f32_16x16x32_bf16 v[238:241], a[208:211], a[92:95], v[238:241]
    v_mfma_f32_16x16x32_bf16 v[238:241], a[188:191], a[76:79], v[238:241]
    v_mfma_f32_16x16x32_bf16 v[182:185], a[192:195], a[64:67], v[182:185]
    v_mfma_f32_16x16x32_bf16 v[182:185], a[212:215], a[80:83], v[182:185]
    v_mfma_f32_16x16x32_bf16 v[202:205], a[212:215], a[84:87], v[202:205]
    v_mfma_f32_16x16x32_bf16 v[202:205], a[192:195], a[68:71], v[202:205]
    v_mfma_f32_16x16x32_bf16 v[222:225], a[192:195], a[72:75], v[222:225]
    v_mfma_f32_16x16x32_bf16 v[222:225], a[212:215], a[88:91], v[222:225]
    v_mfma_f32_16x16x32_bf16 v[242:245], a[212:215], a[92:95], v[242:245]
    v_mfma_f32_16x16x32_bf16 v[242:245], a[192:195], a[76:79], v[242:245]
    s_waitcnt vmcnt(16)
    v_mfma_f32_16x16x32_bf16 v[166:169], a[216:219], a[0:3], v[166:169]
    s_mov_b32 s44, 163840
    buffer_load_dwordx4 a[64:67], v4, s[8:11], s44 offen sc1
    v_mfma_f32_16x16x32_bf16 v[166:169], a[236:239], a[16:19], v[166:169]
    v_mfma_f32_16x16x32_bf16 v[186:189], a[236:239], a[20:23], v[186:189]
    buffer_load_dwordx4 a[68:71], v5, s[8:11], s44 offen sc1
    v_mfma_f32_16x16x32_bf16 v[186:189], a[216:219], a[4:7], v[186:189]
    v_mfma_f32_16x16x32_bf16 v[206:209], a[216:219], a[8:11], v[206:209]
    v_mfma_f32_16x16x32_bf16 v[206:209], a[236:239], a[24:27], v[206:209]
    buffer_load_dwordx4 a[72:75], v6, s[8:11], s44 offen sc1
    v_mfma_f32_16x16x32_bf16 v[226:229], a[236:239], a[28:31], v[226:229]
    v_mfma_f32_16x16x32_bf16 v[226:229], a[216:219], a[12:15], v[226:229]
    buffer_load_dwordx4 a[76:79], v7, s[8:11], s44 offen sc1
    v_mfma_f32_16x16x32_bf16 v[170:173], a[220:223], a[0:3], v[170:173]
    v_mfma_f32_16x16x32_bf16 v[170:173], a[240:243], a[16:19], v[170:173]
    v_mfma_f32_16x16x32_bf16 v[190:193], a[240:243], a[20:23], v[190:193]
    s_mov_b32 s44, 180224
    buffer_load_dwordx4 a[80:83], v4, s[8:11], s44 offen sc1
    v_mfma_f32_16x16x32_bf16 v[190:193], a[220:223], a[4:7], v[190:193]
    v_mfma_f32_16x16x32_bf16 v[210:213], a[220:223], a[8:11], v[210:213]
    buffer_load_dwordx4 a[84:87], v5, s[8:11], s44 offen sc1
    v_mfma_f32_16x16x32_bf16 v[210:213], a[240:243], a[24:27], v[210:213]
    v_mfma_f32_16x16x32_bf16 v[230:233], a[240:243], a[28:31], v[230:233]
    v_mfma_f32_16x16x32_bf16 v[230:233], a[220:223], a[12:15], v[230:233]
    buffer_load_dwordx4 a[88:91], v6, s[8:11], s44 offen sc1
    v_mfma_f32_16x16x32_bf16 v[174:177], a[224:227], a[0:3], v[174:177]
    v_mfma_f32_16x16x32_bf16 v[174:177], a[244:247], a[16:19], v[174:177]
    buffer_load_dwordx4 a[92:95], v7, s[8:11], s44 offen sc1
    v_mfma_f32_16x16x32_bf16 v[194:197], a[244:247], a[20:23], v[194:197]
    v_mfma_f32_16x16x32_bf16 v[194:197], a[224:227], a[4:7], v[194:197]
    v_mfma_f32_16x16x32_bf16 v[214:217], a[224:227], a[8:11], v[214:217]
    buffer_load_dwordx4 a[128:131], v16, s[20:23], s45 offen offset:3072 sc1
    v_mfma_f32_16x16x32_bf16 v[214:217], a[244:247], a[24:27], v[214:217]
    v_mfma_f32_16x16x32_bf16 v[234:237], a[244:247], a[28:31], v[234:237]
    buffer_load_dwordx4 a[132:135], v17, s[20:23], s45 offen offset:0 sc1
    v_mfma_f32_16x16x32_bf16 v[234:237], a[224:227], a[12:15], v[234:237]
    v_mfma_f32_16x16x32_bf16 v[178:181], a[228:231], a[0:3], v[178:181]
    v_mfma_f32_16x16x32_bf16 v[178:181], a[248:251], a[16:19], v[178:181]
    s_mov_b32 s45, 491520
    buffer_load_dwordx4 a[136:139], v16, s[20:23], s45 offen offset:0 sc1
    v_mfma_f32_16x16x32_bf16 v[198:201], a[248:251], a[20:23], v[198:201]
    v_mfma_f32_16x16x32_bf16 v[198:201], a[228:231], a[4:7], v[198:201]
    buffer_load_dwordx4 a[140:143], v16, s[20:23], s45 offen offset:1024 sc1
    v_mfma_f32_16x16x32_bf16 v[218:221], a[228:231], a[8:11], v[218:221]
    v_mfma_f32_16x16x32_bf16 v[218:221], a[248:251], a[24:27], v[218:221]
    v_mfma_f32_16x16x32_bf16 v[238:241], a[248:251], a[28:31], v[238:241]
    v_mfma_f32_16x16x32_bf16 v[238:241], a[228:231], a[12:15], v[238:241]
    v_mfma_f32_16x16x32_bf16 v[182:185], a[232:235], a[0:3], v[182:185]
    v_mfma_f32_16x16x32_bf16 v[182:185], a[252:255], a[16:19], v[182:185]
    v_mfma_f32_16x16x32_bf16 v[202:205], a[252:255], a[20:23], v[202:205]
    v_mfma_f32_16x16x32_bf16 v[202:205], a[232:235], a[4:7], v[202:205]
    v_mfma_f32_16x16x32_bf16 v[222:225], a[232:235], a[8:11], v[222:225]
    v_mfma_f32_16x16x32_bf16 v[222:225], a[252:255], a[24:27], v[222:225]
    v_mfma_f32_16x16x32_bf16 v[242:245], a[252:255], a[28:31], v[242:245]
    v_mfma_f32_16x16x32_bf16 v[242:245], a[232:235], a[12:15], v[242:245]
    s_waitcnt vmcnt(16)
    v_mfma_f32_16x16x32_bf16 v[166:169], v[46:49], a[32:35], v[166:169]
    s_mov_b32 s44, 196608
    buffer_load_dwordx4 a[0:3], v4, s[8:11], s44 offen sc1
    v_mfma_f32_16x16x32_bf16 v[166:169], v[66:69], a[48:51], v[166:169]
    v_mfma_f32_16x16x32_bf16 v[186:189], v[66:69], a[52:55], v[186:189]
    buffer_load_dwordx4 a[4:7], v5, s[8:11], s44 offen sc1
    v_mfma_f32_16x16x32_bf16 v[186:189], v[46:49], a[36:39], v[186:189]
    v_mfma_f32_16x16x32_bf16 v[206:209], v[46:49], a[40:43], v[206:209]
    v_mfma_f32_16x16x32_bf16 v[206:209], v[66:69], a[56:59], v[206:209]
    buffer_load_dwordx4 a[8:11], v6, s[8:11], s44 offen sc1
    v_mfma_f32_16x16x32_bf16 v[226:229], v[66:69], a[60:63], v[226:229]
    v_mfma_f32_16x16x32_bf16 v[226:229], v[46:49], a[44:47], v[226:229]
    buffer_load_dwordx4 a[12:15], v7, s[8:11], s44 offen sc1
    v_mfma_f32_16x16x32_bf16 v[170:173], v[50:53], a[32:35], v[170:173]
    v_mfma_f32_16x16x32_bf16 v[170:173], v[70:73], a[48:51], v[170:173]
    v_mfma_f32_16x16x32_bf16 v[190:193], v[70:73], a[52:55], v[190:193]
    s_mov_b32 s44, 212992
    buffer_load_dwordx4 a[16:19], v4, s[8:11], s44 offen sc1
    v_mfma_f32_16x16x32_bf16 v[190:193], v[50:53], a[36:39], v[190:193]
    v_mfma_f32_16x16x32_bf16 v[210:213], v[50:53], a[40:43], v[210:213]
    buffer_load_dwordx4 a[20:23], v5, s[8:11], s44 offen sc1
    v_mfma_f32_16x16x32_bf16 v[210:213], v[70:73], a[56:59], v[210:213]
    v_mfma_f32_16x16x32_bf16 v[230:233], v[70:73], a[60:63], v[230:233]
    v_mfma_f32_16x16x32_bf16 v[230:233], v[50:53], a[44:47], v[230:233]
    buffer_load_dwordx4 a[24:27], v6, s[8:11], s44 offen sc1
    v_mfma_f32_16x16x32_bf16 v[174:177], v[54:57], a[32:35], v[174:177]
    v_mfma_f32_16x16x32_bf16 v[174:177], v[74:77], a[48:51], v[174:177]
    buffer_load_dwordx4 a[28:31], v7, s[8:11], s44 offen sc1
    v_mfma_f32_16x16x32_bf16 v[194:197], v[74:77], a[52:55], v[194:197]
    v_mfma_f32_16x16x32_bf16 v[194:197], v[54:57], a[36:39], v[194:197]
    v_mfma_f32_16x16x32_bf16 v[214:217], v[54:57], a[40:43], v[214:217]
    buffer_load_dwordx4 a[144:147], v16, s[20:23], s45 offen offset:2048 sc1
    v_mfma_f32_16x16x32_bf16 v[214:217], v[74:77], a[56:59], v[214:217]
    v_mfma_f32_16x16x32_bf16 v[234:237], v[74:77], a[60:63], v[234:237]
    buffer_load_dwordx4 a[148:151], v16, s[20:23], s45 offen offset:3072 sc1
    v_mfma_f32_16x16x32_bf16 v[234:237], v[54:57], a[44:47], v[234:237]
    v_mfma_f32_16x16x32_bf16 v[178:181], v[58:61], a[32:35], v[178:181]
    v_mfma_f32_16x16x32_bf16 v[178:181], v[78:81], a[48:51], v[178:181]
    buffer_load_dwordx4 a[152:155], v17, s[20:23], s45 offen offset:0 sc1
    v_mfma_f32_16x16x32_bf16 v[198:201], v[78:81], a[52:55], v[198:201]
    v_mfma_f32_16x16x32_bf16 v[198:201], v[58:61], a[36:39], v[198:201]
    s_mov_b32 s45, 512000
    buffer_load_dwordx4 a[156:159], v16, s[20:23], s45 offen offset:0 sc1
    v_mfma_f32_16x16x32_bf16 v[218:221], v[58:61], a[40:43], v[218:221]
    v_mfma_f32_16x16x32_bf16 v[218:221], v[78:81], a[56:59], v[218:221]
    v_mfma_f32_16x16x32_bf16 v[238:241], v[78:81], a[60:63], v[238:241]
    v_mfma_f32_16x16x32_bf16 v[238:241], v[58:61], a[44:47], v[238:241]
    v_mfma_f32_16x16x32_bf16 v[182:185], v[62:65], a[32:35], v[182:185]
    v_mfma_f32_16x16x32_bf16 v[182:185], v[82:85], a[48:51], v[182:185]
    v_mfma_f32_16x16x32_bf16 v[202:205], v[82:85], a[52:55], v[202:205]
    v_mfma_f32_16x16x32_bf16 v[202:205], v[62:65], a[36:39], v[202:205]
    v_mfma_f32_16x16x32_bf16 v[222:225], v[62:65], a[40:43], v[222:225]
    v_mfma_f32_16x16x32_bf16 v[222:225], v[82:85], a[56:59], v[222:225]
    v_mfma_f32_16x16x32_bf16 v[242:245], v[82:85], a[60:63], v[242:245]
    v_mfma_f32_16x16x32_bf16 v[242:245], v[62:65], a[44:47], v[242:245]
    s_waitcnt vmcnt(16)
    v_mfma_f32_16x16x32_bf16 v[166:169], v[86:89], a[64:67], v[166:169]
    s_mov_b32 s44, 229376
    buffer_load_dwordx4 a[32:35], v4, s[8:11], s44 offen sc1
    v_mfma_f32_16x16x32_bf16 v[166:169], v[106:109], a[80:83], v[166:169]
    v_mfma_f32_16x16x32_bf16 v[186:189], v[106:109], a[84:87], v[186:189]
    buffer_load_dwordx4 a[36:39], v5, s[8:11], s44 offen sc1
    v_mfma_f32_16x16x32_bf16 v[186:189], v[86:89], a[68:71], v[186:189]
    v_mfma_f32_16x16x32_bf16 v[206:209], v[86:89], a[72:75], v[206:209]
    v_mfma_f32_16x16x32_bf16 v[206:209], v[106:109], a[88:91], v[206:209]
    buffer_load_dwordx4 a[40:43], v6, s[8:11], s44 offen sc1
    v_mfma_f32_16x16x32_bf16 v[226:229], v[106:109], a[92:95], v[226:229]
    v_mfma_f32_16x16x32_bf16 v[226:229], v[86:89], a[76:79], v[226:229]
    buffer_load_dwordx4 a[44:47], v7, s[8:11], s44 offen sc1
    v_mfma_f32_16x16x32_bf16 v[170:173], v[90:93], a[64:67], v[170:173]
    v_mfma_f32_16x16x32_bf16 v[170:173], v[110:113], a[80:83], v[170:173]
    v_mfma_f32_16x16x32_bf16 v[190:193], v[110:113], a[84:87], v[190:193]
    s_mov_b32 s44, 245760
    buffer_load_dwordx4 a[48:51], v4, s[8:11], s44 offen sc1
    v_mfma_f32_16x16x32_bf16 v[190:193], v[90:93], a[68:71], v[190:193]
    v_mfma_f32_16x16x32_bf16 v[210:213], v[90:93], a[72:75], v[210:213]
    buffer_load_dwordx4 a[52:55], v5, s[8:11], s44 offen sc1
    v_mfma_f32_16x16x32_bf16 v[210:213], v[110:113], a[88:91], v[210:213]
    v_mfma_f32_16x16x32_bf16 v[230:233], v[110:113], a[92:95], v[230:233]
    v_mfma_f32_16x16x32_bf16 v[230:233], v[90:93], a[76:79], v[230:233]
    buffer_load_dwordx4 a[56:59], v6, s[8:11], s44 offen sc1
    v_mfma_f32_16x16x32_bf16 v[174:177], v[94:97], a[64:67], v[174:177]
    v_mfma_f32_16x16x32_bf16 v[174:177], v[114:117], a[80:83], v[174:177]
    buffer_load_dwordx4 a[60:63], v7, s[8:11], s44 offen sc1
    v_mfma_f32_16x16x32_bf16 v[194:197], v[114:117], a[84:87], v[194:197]
    v_mfma_f32_16x16x32_bf16 v[194:197], v[94:97], a[68:71], v[194:197]
    v_mfma_f32_16x16x32_bf16 v[214:217], v[94:97], a[72:75], v[214:217]
    buffer_load_dwordx4 a[160:163], v16, s[20:23], s45 offen offset:1024 sc1
    v_mfma_f32_16x16x32_bf16 v[214:217], v[114:117], a[88:91], v[214:217]
    v_mfma_f32_16x16x32_bf16 v[234:237], v[114:117], a[92:95], v[234:237]
    buffer_load_dwordx4 a[164:167], v16, s[20:23], s45 offen offset:2048 sc1
    v_mfma_f32_16x16x32_bf16 v[234:237], v[94:97], a[76:79], v[234:237]
    v_mfma_f32_16x16x32_bf16 v[178:181], v[98:101], a[64:67], v[178:181]
    v_mfma_f32_16x16x32_bf16 v[178:181], v[118:121], a[80:83], v[178:181]
    buffer_load_dwordx4 a[168:171], v16, s[20:23], s45 offen offset:3072 sc1
    v_mfma_f32_16x16x32_bf16 v[198:201], v[118:121], a[84:87], v[198:201]
    v_mfma_f32_16x16x32_bf16 v[198:201], v[98:101], a[68:71], v[198:201]
    buffer_load_dwordx4 a[172:175], v17, s[20:23], s45 offen offset:0 sc1
    v_mfma_f32_16x16x32_bf16 v[218:221], v[98:101], a[72:75], v[218:221]
    v_mfma_f32_16x16x32_bf16 v[218:221], v[118:121], a[88:91], v[218:221]
    v_mfma_f32_16x16x32_bf16 v[238:241], v[118:121], a[92:95], v[238:241]
    v_mfma_f32_16x16x32_bf16 v[238:241], v[98:101], a[76:79], v[238:241]
    v_mfma_f32_16x16x32_bf16 v[182:185], v[102:105], a[64:67], v[182:185]
    v_mfma_f32_16x16x32_bf16 v[182:185], v[122:125], a[80:83], v[182:185]
    v_mfma_f32_16x16x32_bf16 v[202:205], v[122:125], a[84:87], v[202:205]
    v_mfma_f32_16x16x32_bf16 v[202:205], v[102:105], a[68:71], v[202:205]
    v_mfma_f32_16x16x32_bf16 v[222:225], v[102:105], a[72:75], v[222:225]
    v_mfma_f32_16x16x32_bf16 v[222:225], v[122:125], a[88:91], v[222:225]
    v_mfma_f32_16x16x32_bf16 v[242:245], v[122:125], a[92:95], v[242:245]
    s_cmp_eq_u32 s101, 0
    s_cbranch_scc1 L_no_fl
    v_lshlrev_b32 v1, 7, v19
    v_add_u32 v1, 0x290000, v1
    buffer_load_dwordx4 v[252:255], v1, s[76:79], 0 offen sc1
L_no_fl:
    v_mfma_f32_16x16x32_bf16 v[242:245], v[102:105], a[76:79], v[242:245]
    s_waitcnt vmcnt(16)
    v_mfma_f32_16x16x32_bf16 v[166:169], v[126:129], a[0:3], v[166:169]
    s_mov_b32 s44, 262144
    buffer_load_dwordx4 a[64:67], v4, s[8:11], s44 offen sc1
    v_mfma_f32_16x16x32_bf16 v[166:169], v[146:149], a[16:19], v[166:169]
    ds_read_b128 v[86:89], v10 offset:40960
    v_mfma_f32_16x16x32_bf16 v[186:189], v[146:149], a[20:23], v[186:189]
    buffer_load_dwordx4 a[68:71], v5, s[8:11], s44 offen sc1
    v_mfma_f32_16x16x32_bf16 v[186:189], v[126:129], a[4:7], v[186:189]
    v_mfma_f32_16x16x32_bf16 v[206:209], v[126:129], a[8:11], v[206:209]
    ds_read_b128 v[90:93], v10 offset:41984
    v_mfma_f32_16x16x32_bf16 v[206:209], v[146:149], a[24:27], v[206:209]
    buffer_load_dwordx4 a[72:75], v6, s[8:11], s44 offen sc1
    v_mfma_f32_16x16x32_bf16 v[226:229], v[146:149], a[28:31], v[226:229]
    v_mfma_f32_16x16x32_bf16 v[226:229], v[126:129], a[12:15], v[226:229]
    buffer_load_dwordx4 a[76:79], v7, s[8:11], s44 offen sc1
    v_mfma_f32_16x16x32_bf16 v[170:173], v[130:133], a[0:3], v[170:173]
    ds_read_b128 v[94:97], v10 offset:43008
    v_mfma_f32_16x16x32_bf16 v[170:173], v[150:153], a[16:19], v[170:173]
    v_mfma_f32_16x16x32_bf16 v[190:193], v[150:153], a[20:23], v[190:193]
    s_mov_b32 s44, 278528
    buffer_load_dwordx4 a[80:83], v4, s[8:11], s44 offen sc1
    v_mfma_f32_16x16x32_bf16 v[190:193], v[130:133], a[4:7], v[190:193]
    ds_read_b128 v[98:101], v10 offset:44032
    v_mfma_f32_16x16x32_bf16 v[210:213], v[130:133], a[8:11], v[210:213]
    buffer_load_dwordx4 a[84:87], v5, s[8:11], s44 offen sc1
    v_mfma_f32_16x16x32_bf16 v[210:213], v[150:153], a[24:27], v[210:213]
    v_mfma_f32_16x16x32_bf16 v[230:233], v[150:153], a[28:31], v[230:233]
    ds_read_b128 v[102:105], v10 offset:45056
    v_mfma_f32_16x16x32_bf16 v[230:233], v[130:133], a[12:15], v[230:233]
    buffer_load_dwordx4 a[88:91], v6, s[8:11], s44 offen sc1
    v_mfma_f32_16x16x32_bf16 v[174:177], v[134:137], a[0:3], v[174:177]
    v_mfma_f32_16x16x32_bf16 v[174:177], v[154:157], a[16:19], v[174:177]
    buffer_load_dwordx4 a[92:95], v7, s[8:11], s44 offen sc1
    v_mfma_f32_16x16x32_bf16 v[194:197], v[154:157], a[20:23], v[194:197]
    ds_read_b128 v[106:109], v10 offset:46080
    v_mfma_f32_16x16x32_bf16 v[194:197], v[134:137], a[4:7], v[194:197]
    v_mfma_f32_16x16x32_bf16 v[214:217], v[134:137], a[8:11], v[214:217]
    s_mov_b32 s45, 532480
    buffer_load_dwordx4 a[176:179], v16, s[20:23], s45 offen offset:0 sc1
    v_mfma_f32_16x16x32_bf16 v[214:217], v[154:157], a[24:27], v[214:217]
    ds_read_b128 v[110:113], v10 offset:47104
    v_mfma_f32_16x16x32_bf16 v[234:237], v[154:157], a[28:31], v[234:237]
    buffer_load_dwordx4 a[180:183], v16, s[20:23], s45 offen offset:1024 sc1
    v_mfma_f32_16x16x32_bf16 v[234:237], v[134:137], a[12:15], v[234:237]
    v_mfma_f32_16x16x32_bf16 v[178:181], v[138:141], a[0:3], v[178:181]
    ds_read_b128 v[114:117], v10 offset:48128
    v_mfma_f32_16x16x32_bf16 v[178:181], v[158:161], a[16:19], v[178:181]
    buffer_load_dwordx4 a[184:187], v16, s[20:23], s45 offen offset:2048 sc1
    v_mfma_f32_16x16x32_bf16 v[198:201], v[158:161], a[20:23], v[198:201]
    v_mfma_f32_16x16x32_bf16 v[198:201], v[138:141], a[4:7], v[198:201]
    buffer_load_dwordx4 a[188:191], v16, s[20:23], s45 offen offset:3072 sc1
    v_mfma_f32_16x16x32_bf16 v[218:221], v[138:141], a[8:11], v[218:221]
    ds_read_b128 v[118:121], v10 offset:49152
    v_mfma_f32_16x16x32_bf16 v[218:221], v[158:161], a[24:27], v[218:221]
    v_mfma_f32_16x16x32_bf16 v[238:241], v[158:161], a[28:31], v[238:241]
    ds_read_b128 v[122:125], v10 offset:50176
    v_mfma_f32_16x16x32_bf16 v[238:241], v[138:141], a[12:15], v[238:241]
    v_mfma_f32_16x16x32_bf16 v[182:185], v[142:145], a[0:3], v[182:185]
    v_mfma_f32_16x16x32_bf16 v[182:185], v[162:165], a[16:19], v[182:185]
    v_mfma_f32_16x16x32_bf16 v[202:205], v[162:165], a[20:23], v[202:205]
    v_mfma_f32_16x16x32_bf16 v[202:205], v[142:145], a[4:7], v[202:205]
    v_mfma_f32_16x16x32_bf16 v[222:225], v[142:145], a[8:11], v[222:225]
    v_mfma_f32_16x16x32_bf16 v[222:225], v[162:165], a[24:27], v[222:225]
    v_mfma_f32_16x16x32_bf16 v[242:245], v[162:165], a[28:31], v[242:245]
    v_mfma_f32_16x16x32_bf16 v[242:245], v[142:145], a[12:15], v[242:245]
    s_waitcnt vmcnt(16) lgkmcnt(0)
    v_mfma_f32_16x16x32_bf16 v[166:169], v[86:89], a[32:35], v[166:169]
    s_mov_b32 s44, 294912
    buffer_load_dwordx4 a[0:3], v4, s[8:11], s44 offen sc1
    v_mfma_f32_16x16x32_bf16 v[166:169], v[106:109], a[48:51], v[166:169]
    ds_read_b128 v[126:129], v9 offset:0
    v_mfma_f32_16x16x32_bf16 v[186:189], v[106:109], a[52:55], v[186:189]
    buffer_load_dwordx4 a[4:7], v5, s[8:11], s44 offen sc1
    v_mfma_f32_16x16x32_bf16 v[186:189], v[86:89], a[36:39], v[186:189]
    v_mfma_f32_16x16x32_bf16 v[206:209], v[86:89], a[40:43], v[206:209]
    ds_read_b128 v[130:133], v9 offset:1024
    v_mfma_f32_16x16x32_bf16 v[206:209], v[106:109], a[56:59], v[206:209]
    buffer_load_dwordx4 a[8:11], v6, s[8:11], s44 offen sc1
    v_mfma_f32_16x16x32_bf16 v[226:229], v[106:109], a[60:63], v[226:229]
    v_mfma_f32_16x16x32_bf16 v[226:229], v[86:89], a[44:47], v[226:229]
    buffer_load_dwordx4 a[12:15], v7, s[8:11], s44 offen sc1
    v_mfma_f32_16x16x32_bf16 v[170:173], v[90:93], a[32:35], v[170:173]
    ds_read_b128 v[134:137], v9 offset:2048
    v_mfma_f32_16x16x32_bf16 v[170:173], v[110:113], a[48:51], v[170:173]
    v_mfma_f32_16x16x32_bf16 v[190:193], v[110:113], a[52:55], v[190:193]
    s_mov_b32 s44, 311296
    buffer_load_dwordx4 a[16:19], v4, s[8:11], s44 offen sc1
    v_mfma_f32_16x16x32_bf16 v[190:193], v[90:93], a[36:39], v[190:193]
    ds_read_b128 v[138:141], v9 offset:3072
    v_mfma_f32_16x16x32_bf16 v[210:213], v[90:93], a[40:43], v[210:213]
    buffer_load_dwordx4 a[20:23], v5, s[8:11], s44 offen sc1
    v_mfma_f32_16x16x32_bf16 v[210:213], v[110:113], a[56:59], v[210:213]
    v_mfma_f32_16x16x32_bf16 v[230:233], v[110:113], a[60:63], v[230:233]
    ds_read_b128 v[142:145], v9 offset:4096
    v_mfma_f32_16x16x32_bf16 v[230:233], v[90:93], a[44:47], v[230:233]
    buffer_load_dwordx4 a[24:27], v6, s[8:11], s44 offen sc1
    v_mfma_f32_16x16x32_bf16 v[174:177], v[94:97], a[32:35], v[174:177]
    v_mfma_f32_16x16x32_bf16 v[174:177], v[114:117], a[48:51], v[174:177]
    buffer_load_dwordx4 a[28:31], v7, s[8:11], s44 offen sc1
    v_mfma_f32_16x16x32_bf16 v[194:197], v[114:117], a[52:55], v[194:197]
    ds_read_b128 v[146:149], v9 offset:5120
    v_mfma_f32_16x16x32_bf16 v[194:197], v[94:97], a[36:39], v[194:197]
    v_mfma_f32_16x16x32_bf16 v[214:217], v[94:97], a[40:43], v[214:217]
    buffer_load_dwordx4 a[192:195], v17, s[20:23], s45 offen offset:0 sc1
    v_mfma_f32_16x16x32_bf16 v[214:217], v[114:117], a[56:59], v[214:217]
    ds_read_b128 v[150:153], v9 offset:6144
    v_mfma_f32_16x16x32_bf16 v[234:237], v[114:117], a[60:63], v[234:237]
    s_mov_b32 s45, 552960
    buffer_load_dwordx4 a[196:199], v16, s[20:23], s45 offen offset:0 sc1
    v_mfma_f32_16x16x32_bf16 v[234:237], v[94:97], a[44:47], v[234:237]
    v_mfma_f32_16x16x32_bf16 v[178:181], v[98:101], a[32:35], v[178:181]
    ds_read_b128 v[154:157], v9 offset:7168
    v_mfma_f32_16x16x32_bf16 v[178:181], v[118:121], a[48:51], v[178:181]
    buffer_load_dwordx4 a[200:203], v16, s[20:23], s45 offen offset:1024 sc1
    v_mfma_f32_16x16x32_bf16 v[198:201], v[118:121], a[52:55], v[198:201]
    v_mfma_f32_16x16x32_bf16 v[198:201], v[98:101], a[36:39], v[198:201]
    buffer_load_dwordx4 a[204:207], v16, s[20:23], s45 offen offset:2048 sc1
    v_mfma_f32_16x16x32_bf16 v[218:221], v[98:101], a[40:43], v[218:221]
    ds_read_b128 v[158:161], v9 offset:8192
    v_mfma_f32_16x16x32_bf16 v[218:221], v[118:121], a[56:59], v[218:221]
    v_mfma_f32_16x16x32_bf16 v[238:241], v[118:121], a[60:63], v[238:241]
    ds_read_b128 v[162:165], v9 offset:9216
    v_mfma_f32_16x16x32_bf16 v[238:241], v[98:101], a[44:47], v[238:241]
    v_mfma_f32_16x16x32_bf16 v[182:185], v[102:105], a[32:35], v[182:185]
    v_mfma_f32_16x16x32_bf16 v[182:185], v[122:125], a[48:51], v[182:185]
    v_mfma_f32_16x16x32_bf16 v[202:205], v[122:125], a[52:55], v[202:205]
    v_mfma_f32_16x16x32_bf16 v[202:205], v[102:105], a[36:39], v[202:205]
    v_mfma_f32_16x16x32_bf16 v[222:225], v[102:105], a[40:43], v[222:225]
    v_mfma_f32_16x16x32_bf16 v[222:225], v[122:125], a[56:59], v[222:225]
    v_mfma_f32_16x16x32_bf16 v[242:245], v[122:125], a[60:63], v[242:245]
    s_cmp_eq_u32 s101, 0
    s_cbranch_scc1 L_back_upd
    s_waitcnt vmcnt(24)
    v_min3_u32 v252, v252, v253, v254
    v_min_u32 v252, v252, v255
    v_cmp_gt_u32 vcc, 3, v252
    s_and_b64 vcc, vcc, exec
    s_cbranch_scc1 L_spin_upd
L_back_upd:
    buffer_load_dwordx2 v[20:21], v11, s[76:79], 0 offen offset:0 sc1
    buffer_load_dwordx2 v[246:247], v11, s[76:79], 0 offen offset:32 sc1
    buffer_load_dwordx2 v[248:249], v11, s[76:79], 0 offen offset:64 sc1
    buffer_load_dwordx2 v[252:253], v11, s[76:79], 0 offen offset:96 sc1
    buffer_load_dwordx2 v[254:255], v11, s[76:79], 0 offen offset:128 sc1
    v_mfma_f32_16x16x32_bf16 v[242:245], v[102:105], a[44:47], v[242:245]
    s_waitcnt vmcnt(21) lgkmcnt(0)
    v_mfma_f32_16x16x32_bf16 v[166:169], v[126:129], a[64:67], v[166:169]
    s_mov_b32 s44, 327680
    buffer_load_dwordx4 a[32:35], v4, s[8:11], s44 offen sc1
    v_mfma_f32_16x16x32_bf16 v[166:169], v[146:149], a[80:83], v[166:169]
    ds_read_b128 v[86:89], v9 offset:40960
    v_mfma_f32_16x16x32_bf16 v[186:189], v[146:149], a[84:87], v[186:189]
    buffer_load_dwordx4 a[36:39], v5, s[8:11], s44 offen sc1
    v_mfma_f32_16x16x32_bf16 v[186:189], v[126:129], a[68:71], v[186:189]
    v_mfma_f32_16x16x32_bf16 v[206:209], v[126:129], a[72:75], v[206:209]
    ds_read_b128 v[90:93], v9 offset:41984
    v_mfma_f32_16x16x32_bf16 v[206:209], v[146:149], a[88:91], v[206:209]
    buffer_load_dwordx4 a[40:43], v6, s[8:11], s44 offen sc1
    v_mfma_f32_16x16x32_bf16 v[226:229], v[146:149], a[92:95], v[226:229]
    v_mfma_f32_16x16x32_bf16 v[226:229], v[126:129], a[76:79], v[226:229]
    buffer_load_dwordx4 a[44:47], v7, s[8:11], s44 offen sc1
    v_mfma_f32_16x16x32_bf16 v[170:173], v[130:133], a[64:67], v[170:173]
    ds_read_b128 v[94:97], v9 offset:43008
    v_mfma_f32_16x16x32_bf16 v[170:173], v[150:153], a[80:83], v[170:173]
    v_mfma_f32_16x16x32_bf16 v[190:193], v[150:153], a[84:87], v[190:193]
    s_mov_b32 s44, 344064
    buffer_load_dwordx4 a[48:51], v4, s[8:11], s44 offen sc1
    v_mfma_f32_16x16x32_bf16 v[190:193], v[130:133], a[68:71], v[190:193]
    ds_read_b128 v[98:101], v9 offset:44032
    v_mfma_f32_16x16x32_bf16 v[210:213], v[130:133], a[72:75], v[210:213]
    buffer_load_dwordx4 a[52:55], v5, s[8:11], s44 offen sc1
    v_mfma_f32_16x16x32_bf16 v[210:213], v[150:153], a[88:91], v[210:213]
    v_mfma_f32_16x16x32_bf16 v[230:233], v[150:153], a[92:95], v[230:233]
    ds_read_b128 v[102:105], v9 offset:45056
    v_mfma_f32_16x16x32_bf16 v[230:233], v[130:133], a[76:79], v[230:233]
    buffer_load_dwordx4 a[56:59], v6, s[8:11], s44 offen sc1
    v_mfma_f32_16x16x32_bf16 v[174:177], v[134:137], a[64:67], v[174:177]
    v_mfma_f32_16x16x32_bf16 v[174:177], v[154:157], a[80:83], v[174:177]
    buffer_load_dwordx4 a[60:63], v7, s[8:11], s44 offen sc1
    v_mfma_f32_16x16x32_bf16 v[194:197], v[154:157], a[84:87], v[194:197]
    ds_read_b128 v[106:109], v9 offset:46080
    v_mfma_f32_16x16x32_bf16 v[194:197], v[134:137], a[68:71], v[194:197]
    v_mfma_f32_16x16x32_bf16 v[214:217], v[134:137], a[72:75], v[214:217]
    buffer_load_dwordx4 a[208:211], v16, s[20:23], s45 offen offset:3072 sc1
    v_mfma_f32_16x16x32_bf16 v[214:217], v[154:157], a[88:91], v[214:217]
    ds_read_b128 v[110:113], v9 offset:47104
    v_mfma_f32_16x16x32_bf16 v[234:237], v[154:157], a[92:95], v[234:237]
    buffer_load_dwordx4 a[212:215], v17, s[20:23], s45 offen offset:0 sc1
    v_mfma_f32_16x16x32_bf16 v[234:237], v[134:137], a[76:79], v[234:237]
    v_mfma_f32_16x16x32_bf16 v[178:181], v[138:141], a[64:67], v[178:181]
    ds_read_b128 v[114:117], v9 offset:48128
    v_mfma_f32_16x16x32_bf16 v[178:181], v[158:161], a[80:83], v[178:181]
    s_mov_b32 s45, 573440
    buffer_load_dwordx4 a[216:219], v16, s[20:23], s45 offen offset:0 sc1
    v_mfma_f32_16x16x32_bf16 v[198:201], v[158:161], a[84:87], v[198:201]
    v_mfma_f32_16x16x32_bf16 v[198:201], v[138:141], a[68:71], v[198:201]
    buffer_load_dwordx4 a[220:223], v16, s[20:23], s45 offen offset:1024 sc1
    v_mfma_f32_16x16x32_bf16 v[218:221], v[138:141], a[72:75], v[218:221]
    ds_read_b128 v[118:121], v9 offset:49152
    v_mfma_f32_16x16x32_bf16 v[218:221], v[158:161], a[88:91], v[218:221]
    v_mfma_f32_16x16x32_bf16 v[238:241], v[158:161], a[92:95], v[238:241]
    ds_read_b128 v[122:125], v9 offset:50176
    v_mfma_f32_16x16x32_bf16 v[238:241], v[138:141], a[76:79], v[238:241]
    v_mfma_f32_16x16x32_bf16 v[182:185], v[142:145], a[64:67], v[182:185]
    v_mfma_f32_16x16x32_bf16 v[182:185], v[162:165], a[80:83], v[182:185]
    v_mfma_f32_16x16x32_bf16 v[202:205], v[162:165], a[84:87], v[202:205]
    v_mfma_f32_16x16x32_bf16 v[202:205], v[142:145], a[68:71], v[202:205]
    v_mfma_f32_16x16x32_bf16 v[222:225], v[142:145], a[72:75], v[222:225]
    v_mfma_f32_16x16x32_bf16 v[222:225], v[162:165], a[88:91], v[222:225]
    v_mfma_f32_16x16x32_bf16 v[242:245], v[162:165], a[92:95], v[242:245]
    v_mfma_f32_16x16x32_bf16 v[242:245], v[142:145], a[76:79], v[242:245]
    s_waitcnt vmcnt(21) lgkmcnt(0)
    v_mfma_f32_16x16x32_bf16 v[166:169], v[86:89], a[0:3], v[166:169]
    s_mov_b32 s44, 360448
    buffer_load_dwordx4 a[64:67], v4, s[8:11], s44 offen sc1
    v_mfma_f32_16x16x32_bf16 v[166:169], v[106:109], a[16:19], v[166:169]
    ds_read_b128 v[126:129], v10 offset:0
    v_mfma_f32_16x16x32_bf16 v[186:189], v[106:109], a[20:23], v[186:189]
    buffer_load_dwordx4 a[68:71], v5, s[8:11], s44 offen sc1
    v_mfma_f32_16x16x32_bf16 v[186:189], v[86:89], a[4:7], v[186:189]
    v_mfma_f32_16x16x32_bf16 v[206:209], v[86:89], a[8:11], v[206:209]
    ds_read_b128 v[130:133], v10 offset:1024
    v_mfma_f32_16x16x32_bf16 v[206:209], v[106:109], a[24:27], v[206:209]
    buffer_load_dwordx4 a[72:75], v6, s[8:11], s44 offen sc1
    v_mfma_f32_16x16x32_bf16 v[226:229], v[106:109], a[28:31], v[226:229]
    v_mfma_f32_16x16x32_bf16 v[226:229], v[86:89], a[12:15], v[226:229]
    buffer_load_dwordx4 a[76:79], v7, s[8:11], s44 offen sc1
    v_mfma_f32_16x16x32_bf16 v[170:173], v[90:93], a[0:3], v[170:173]
    ds_read_b128 v[134:137], v10 offset:2048
    v_mfma_f32_16x16x32_bf16 v[170:173], v[110:113], a[16:19], v[170:173]
    v_mfma_f32_16x16x32_bf16 v[190:193], v[110:113], a[20:23], v[190:193]
    s_mov_b32 s44, 376832
    buffer_load_dwordx4 a[80:83], v4, s[8:11], s44 offen sc1
    v_mfma_f32_16x16x32_bf16 v[190:193], v[90:93], a[4:7], v[190:193]
    ds_read_b128 v[138:141], v10 offset:3072
    v_mfma_f32_16x16x32_bf16 v[210:213], v[90:93], a[8:11], v[210:213]
    buffer_load_dwordx4 a[84:87], v5, s[8:11], s44 offen sc1
    v_mfma_f32_16x16x32_bf16 v[210:213], v[110:113], a[24:27], v[210:213]
    v_mfma_f32_16x16x32_bf16 v[230:233], v[110:113], a[28:31], v[230:233]
    ds_read_b128 v[142:145], v10 offset:4096
    v_mfma_f32_16x16x32_bf16 v[230:233], v[90:93], a[12:15], v[230:233]
    buffer_load_dwordx4 a[88:91], v6, s[8:11], s44 offen sc1
    v_mfma_f32_16x16x32_bf16 v[174:177], v[94:97], a[0:3], v[174:177]
    v_mfma_f32_16x16x32_bf16 v[174:177], v[114:117], a[16:19], v[174:177]
    buffer_load_dwordx4 a[92:95], v7, s[8:11], s44 offen sc1
    v_mfma_f32_16x16x32_bf16 v[194:197], v[114:117], a[20:23], v[194:197]
    ds_read_b128 v[146:149], v10 offset:5120
    v_mfma_f32_16x16x32_bf16 v[194:197], v[94:97], a[4:7], v[194:197]
    v_mfma_f32_16x16x32_bf16 v[214:217], v[94:97], a[8:11], v[214:217]
    buffer_load_dwordx4 a[224:227], v16, s[20:23], s45 offen offset:2048 sc1
    v_mfma_f32_16x16x32_bf16 v[214:217], v[114:117], a[24:27], v[214:217]
    ds_read_b128 v[150:153], v10 offset:6144
    v_mfma_f32_16x16x32_bf16 v[234:237], v[114:117], a[28:31], v[234:237]
    buffer_load_dwordx4 a[228:231], v16, s[20:23], s45 offen offset:3072 sc1
    v_mfma_f32_16x16x32_bf16 v[234:237], v[94:97], a[12:15], v[234:237]
    v_mfma_f32_16x16x32_bf16 v[178:181], v[98:101], a[0:3], v[178:181]
    ds_read_b128 v[154:157], v10 offset:7168
    v_mfma_f32_16x16x32_bf16 v[178:181], v[118:121], a[16:19], v[178:181]
    buffer_load_dwordx4 a[232:235], v17, s[20:23], s45 offen offset:0 sc1
    v_mfma_f32_16x16x32_bf16 v[198:201], v[118:121], a[20:23], v[198:201]
    v_mfma_f32_16x16x32_bf16 v[198:201], v[98:101], a[4:7], v[198:201]
    s_mov_b32 s45, 593920
    buffer_load_dwordx4 a[236:239], v16, s[20:23], s45 offen offset:0 sc1
    v_mfma_f32_16x16x32_bf16 v[218:221], v[98:101], a[8:11], v[218:221]
    ds_read_b128 v[158:161], v10 offset:8192
    v_mfma_f32_16x16x32_bf16 v[218:221], v[118:121], a[24:27], v[218:221]
    v_mfma_f32_16x16x32_bf16 v[238:241], v[118:121], a[28:31], v[238:241]
    ds_read_b128 v[162:165], v10 offset:9216
    v_mfma_f32_16x16x32_bf16 v[238:241], v[98:101], a[12:15], v[238:241]
    v_mfma_f32_16x16x32_bf16 v[182:185], v[102:105], a[0:3], v[182:185]
    v_mfma_f32_16x16x32_bf16 v[182:185], v[122:125], a[16:19], v[182:185]
    v_mfma_f32_16x16x32_bf16 v[202:205], v[122:125], a[20:23], v[202:205]
    v_mfma_f32_16x16x32_bf16 v[202:205], v[102:105], a[4:7], v[202:205]
    v_mfma_f32_16x16x32_bf16 v[222:225], v[102:105], a[8:11], v[222:225]
    v_mfma_f32_16x16x32_bf16 v[222:225], v[122:125], a[24:27], v[222:225]
    v_mfma_f32_16x16x32_bf16 v[242:245], v[122:125], a[28:31], v[242:245]
    v_mfma_f32_16x16x32_bf16 v[242:245], v[102:105], a[12:15], v[242:245]
    s_waitcnt vmcnt(16) lgkmcnt(0)
    v_mfma_f32_16x16x32_bf16 v[166:169], v[126:129], a[32:35], v[166:169]
    s_mov_b32 s44, 393216
    buffer_load_dwordx4 a[0:3], v4, s[8:11], s44 offen sc1
    v_lshlrev_b32 v86, 16, v36
    v_mfma_f32_16x16x32_bf16 v[166:169], v[146:149], a[48:51], v[166:169]
    v_and_b32 v87, 0xffff0000, v36
    v_mfma_f32_16x16x32_bf16 v[186:189], v[146:149], a[52:55], v[186:189]
    buffer_load_dwordx4 a[4:7], v5, s[8:11], s44 offen sc1
    v_lshlrev_b32 v106, 16, v20
    v_mfma_f32_16x16x32_bf16 v[186:189], v[126:129], a[36:39], v[186:189]
    v_and_b32 v107, 0xffff0000, v20
    v_lshlrev_b32 v88, 16, v37
    v_mfma_f32_16x16x32_bf16 v[206:209], v[126:129], a[40:43], v[206:209]
    v_and_b32 v89, 0xffff0000, v37
    v_mfma_f32_16x16x32_bf16 v[206:209], v[146:149], a[56:59], v[206:209]
    buffer_load_dwordx4 a[8:11], v6, s[8:11], s44 offen sc1
    v_lshlrev_b32 v108, 16, v21
    v_mfma_f32_16x16x32_bf16 v[226:229], v[146:149], a[60:63], v[226:229]
    v_and_b32 v109, 0xffff0000, v21
    v_mfma_f32_16x16x32_bf16 v[226:229], v[126:129], a[44:47], v[226:229]
    buffer_load_dwordx4 a[12:15], v7, s[8:11], s44 offen sc1
    v_lshlrev_b32 v90, 16, v38
    v_and_b32 v91, 0xffff0000, v38
    v_mfma_f32_16x16x32_bf16 v[170:173], v[130:133], a[32:35], v[170:173]
    v_lshlrev_b32 v110, 16, v246
    v_mfma_f32_16x16x32_bf16 v[170:173], v[150:153], a[48:51], v[170:173]
    v_and_b32 v111, 0xffff0000, v246
    v_mfma_f32_16x16x32_bf16 v[190:193], v[150:153], a[52:55], v[190:193]
    s_mov_b32 s44, 409600
    buffer_load_dwordx4 a[16:19], v4, s[8:11], s44 offen sc1
    v_lshlrev_b32 v92, 16, v39
    v_mfma_f32_16x16x32_bf16 v[190:193], v[130:133], a[36:39], v[190:193]
    v_and_b32 v93, 0xffff0000, v39
    v_lshlrev_b32 v112, 16, v247
    v_mfma_f32_16x16x32_bf16 v[210:213], v[130:133], a[40:43], v[210:213]
    buffer_load_dwordx4 a[20:23], v5, s[8:11], s44 offen sc1
    v_and_b32 v113, 0xffff0000, v247
    v_mfma_f32_16x16x32_bf16 v[210:213], v[150:153], a[56:59], v[210:213]
    v_lshlrev_b32 v94, 16, v40
    v_mfma_f32_16x16x32_bf16 v[230:233], v[150:153], a[60:63], v[230:233]
    v_and_b32 v95, 0xffff0000, v40
    v_mfma_f32_16x16x32_bf16 v[230:233], v[130:133], a[44:47], v[230:233]
    buffer_load_dwordx4 a[24:27], v6, s[8:11], s44 offen sc1
    v_lshlrev_b32 v114, 16, v248
    v_and_b32 v115, 0xffff0000, v248
    v_mfma_f32_16x16x32_bf16 v[174:177], v[134:137], a[32:35], v[174:177]
    v_lshlrev_b32 v96, 16, v41
    v_mfma_f32_16x16x32_bf16 v[174:177], v[154:157], a[48:51], v[174:177]
    buffer_load_dwordx4 a[28:31], v7, s[8:11], s44 offen sc1
    v_and_b32 v97, 0xffff0000, v41
    v_mfma_f32_16x16x32_bf16 v[194:197], v[154:157], a[52:55], v[194:197]
    v_lshlrev_b32 v116, 16, v249
    v_mfma_f32_16x16x32_bf16 v[194:197], v[134:137], a[36:39], v[194:197]
    v_and_b32 v117, 0xffff0000, v249
    v_lshlrev_b32 v98, 16, v42
    v_mfma_f32_16x16x32_bf16 v[214:217], v[134:137], a[40:43], v[214:217]
    buffer_load_dwordx4 a[240:243], v16, s[20:23], s45 offen offset:1024 sc1
    v_and_b32 v99, 0xffff0000, v42
    v_mfma_f32_16x16x32_bf16 v[214:217], v[154:157], a[56:59], v[214:217]
    v_lshlrev_b32 v118, 16, v252
    v_mfma_f32_16x16x32_bf16 v[234:237], v[154:157], a[60:63], v[234:237]
    buffer_load_dwordx4 a[244:247], v16, s[20:23], s45 offen offset:2048 sc1
    v_and_b32 v119, 0xffff0000, v252
    v_mfma_f32_16x16x32_bf16 v[234:237], v[134:137], a[44:47], v[234:237]
    v_lshlrev_b32 v100, 16, v43
    v_and_b32 v101, 0xffff0000, v43
    v_mfma_f32_16x16x32_bf16 v[178:181], v[138:141], a[32:35], v[178:181]
    v_lshlrev_b32 v120, 16, v253
    v_mfma_f32_16x16x32_bf16 v[178:181], v[158:161], a[48:51], v[178:181]
    buffer_load_dwordx4 a[248:251], v16, s[20:23], s45 offen offset:3072 sc1
    v_and_b32 v121, 0xffff0000, v253
    v_mfma_f32_16x16x32_bf16 v[198:201], v[158:161], a[52:55], v[198:201]
    v_lshlrev_b32 v102, 16, v44
    v_mfma_f32_16x16x32_bf16 v[198:201], v[138:141], a[36:39], v[198:201]
    buffer_load_dwordx4 a[252:255], v17, s[20:23], s45 offen offset:0 sc1
    v_and_b32 v103, 0xffff0000, v44
    v_lshlrev_b32 v122, 16, v254
    v_mfma_f32_16x16x32_bf16 v[218:221], v[138:141], a[40:43], v[218:221]
    v_and_b32 v123, 0xffff0000, v254
    v_mfma_f32_16x16x32_bf16 v[218:221], v[158:161], a[56:59], v[218:221]
    v_lshlrev_b32 v104, 16, v45
    v_mfma_f32_16x16x32_bf16 v[238:241], v[158:161], a[60:63], v[238:241]
    v_and_b32 v105, 0xffff0000, v45
    v_mfma_f32_16x16x32_bf16 v[238:241], v[138:141], a[44:47], v[238:241]
    v_lshlrev_b32 v124, 16, v255
    v_and_b32 v125, 0xffff0000, v255
    v_mfma_f32_16x16x32_bf16 v[182:185], v[142:145], a[32:35], v[182:185]
    v_add_f32 v86, v86, v106
    v_mfma_f32_16x16x32_bf16 v[182:185], v[162:165], a[48:51], v[182:185]
    v_add_f32 v87, v87, v107
    v_mfma_f32_16x16x32_bf16 v[202:205], v[162:165], a[52:55], v[202:205]
    v_add_f32 v88, v88, v108
    v_mfma_f32_16x16x32_bf16 v[202:205], v[142:145], a[36:39], v[202:205]
    v_add_f32 v89, v89, v109
    v_add_f32 v90, v90, v110
    v_mfma_f32_16x16x32_bf16 v[222:225], v[142:145], a[40:43], v[222:225]
    v_add_f32 v91, v91, v111
    v_mfma_f32_16x16x32_bf16 v[222:225], v[162:165], a[56:59], v[222:225]
    v_add_f32 v92, v92, v112
    v_mfma_f32_16x16x32_bf16 v[242:245], v[162:165], a[60:63], v[242:245]
    v_add_f32 v93, v93, v113
    v_mfma_f32_16x16x32_bf16 v[242:245], v[142:145], a[44:47], v[242:245]
    v_add_f32 v94, v94, v114
    v_add_f32 v95, v95, v115
    s_waitcnt vmcnt(16)
    v_mfma_f32_16x16x32_bf16 v[166:169], a[96:99], a[64:67], v[166:169]
    s_mov_b32 s44, 425984
    buffer_load_dwordx4 a[32:35], v4, s[8:11], s44 offen sc1
    v_add_f32 v96, v96, v116
    v_mfma_f32_16x16x32_bf16 v[166:169], a[116:119], a[80:83], v[166:169]
    v_add_f32 v97, v97, v117
    v_mfma_f32_16x16x32_bf16 v[186:189], a[116:119], a[84:87], v[186:189]
    buffer_load_dwordx4 a[36:39], v5, s[8:11], s44 offen sc1
    v_add_f32 v98, v98, v118
    v_mfma_f32_16x16x32_bf16 v[186:189], a[96:99], a[68:71], v[186:189]
    v_add_f32 v99, v99, v119
    v_add_f32 v100, v100, v120
    v_mfma_f32_16x16x32_bf16 v[206:209], a[96:99], a[72:75], v[206:209]
    v_add_f32 v101, v101, v121
    v_mfma_f32_16x16x32_bf16 v[206:209], a[116:119], a[88:91], v[206:209]
    buffer_load_dwordx4 a[40:43], v6, s[8:11], s44 offen sc1
    v_add_f32 v102, v102, v122
    v_mfma_f32_16x16x32_bf16 v[226:229], a[116:119], a[92:95], v[226:229]
    v_add_f32 v103, v103, v123
    v_mfma_f32_16x16x32_bf16 v[226:229], a[96:99], a[76:79], v[226:229]
    buffer_load_dwordx4 a[44:47], v7, s[8:11], s44 offen sc1
    v_add_f32 v104, v104, v124
    v_add_f32 v105, v105, v125
    v_mfma_f32_16x16x32_bf16 v[170:173], a[100:103], a[64:67], v[170:173]
    v_cvt_pk_bf16_f32 v106, v86, v87
    v_mfma_f32_16x16x32_bf16 v[170:173], a[120:123], a[80:83], v[170:173]
    v_cvt_pk_bf16_f32 v107, v88, v89
    v_mfma_f32_16x16x32_bf16 v[190:193], a[120:123], a[84:87], v[190:193]
    s_mov_b32 s44, 442368
    buffer_load_dwordx4 a[48:51], v4, s[8:11], s44 offen sc1
    v_cvt_pk_bf16_f32 v108, v90, v91
    v_mfma_f32_16x16x32_bf16 v[190:193], a[100:103], a[68:71], v[190:193]
    v_cvt_pk_bf16_f32 v109, v92, v93
    v_cvt_pk_bf16_f32 v110, v94, v95
    v_mfma_f32_16x16x32_bf16 v[210:213], a[100:103], a[72:75], v[210:213]
    buffer_load_dwordx4 a[52:55], v5, s[8:11], s44 offen sc1
    v_cvt_pk_bf16_f32 v111, v96, v97
    v_mfma_f32_16x16x32_bf16 v[210:213], a[120:123], a[88:91], v[210:213]
    v_cvt_pk_bf16_f32 v112, v98, v99
    v_mfma_f32_16x16x32_bf16 v[230:233], a[120:123], a[92:95], v[230:233]
    v_cvt_pk_bf16_f32 v113, v100, v101
    v_mfma_f32_16x16x32_bf16 v[230:233], a[100:103], a[76:79], v[230:233]
    buffer_load_dwordx4 a[56:59], v6, s[8:11], s44 offen sc1
    v_cvt_pk_bf16_f32 v114, v102, v103
    v_cvt_pk_bf16_f32 v115, v104, v105
    v_mfma_f32_16x16x32_bf16 v[174:177], a[104:107], a[64:67], v[174:177]
    v_lshlrev_b32 v86, 16, v106
    v_mfma_f32_16x16x32_bf16 v[174:177], a[124:127], a[80:83], v[174:177]
    buffer_load_dwordx4 a[60:63], v7, s[8:11], s44 offen sc1
    v_and_b32 v87, 0xffff0000, v106
    v_mfma_f32_16x16x32_bf16 v[194:197], a[124:127], a[84:87], v[194:197]
    v_lshlrev_b32 v88, 16, v107
    v_mfma_f32_16x16x32_bf16 v[194:197], a[104:107], a[68:71], v[194:197]
    v_and_b32 v89, 0xffff0000, v107
    v_lshlrev_b32 v90, 16, v108
    v_mfma_f32_16x16x32_bf16 v[214:217], a[104:107], a[72:75], v[214:217]
    s_mov_b32 s45, 614400
    buffer_load_dwordx4 v[46:49], v16, s[20:23], s45 offen offset:0 sc1
    v_and_b32 v91, 0xffff0000, v108
    v_mfma_f32_16x16x32_bf16 v[214:217], a[124:127], a[88:91], v[214:217]
    v_lshlrev_b32 v92, 16, v109
    v_mfma_f32_16x16x32_bf16 v[234:237], a[124:127], a[92:95], v[234:237]
    buffer_load_dwordx4 v[50:53], v16, s[20:23], s45 offen offset:1024 sc1
    v_and_b32 v93, 0xffff0000, v109
    v_mfma_f32_16x16x32_bf16 v[234:237], a[104:107], a[76:79], v[234:237]
    v_lshlrev_b32 v94, 16, v110
    v_and_b32 v95, 0xffff0000, v110
    v_mfma_f32_16x16x32_bf16 v[178:181], a[108:111], a[64:67], v[178:181]
    v_lshlrev_b32 v96, 16, v111
    v_mfma_f32_16x16x32_bf16 v[178:181], a[128:131], a[80:83], v[178:181]
    buffer_load_dwordx4 v[54:57], v16, s[20:23], s45 offen offset:2048 sc1
    v_and_b32 v97, 0xffff0000, v111
    v_mfma_f32_16x16x32_bf16 v[198:201], a[128:131], a[84:87], v[198:201]
    v_lshlrev_b32 v98, 16, v112
    v_mfma_f32_16x16x32_bf16 v[198:201], a[108:111], a[68:71], v[198:201]
    buffer_load_dwordx4 v[58:61], v16, s[20:23], s45 offen offset:3072 sc1
    v_and_b32 v99, 0xffff0000, v112
    v_lshlrev_b32 v100, 16, v113
    v_mfma_f32_16x16x32_bf16 v[218:221], a[108:111], a[72:75], v[218:221]
    v_and_b32 v101, 0xffff0000, v113
    v_mfma_f32_16x16x32_bf16 v[218:221], a[128:131], a[88:91], v[218:221]
    v_lshlrev_b32 v102, 16, v114
    v_mfma_f32_16x16x32_bf16 v[238:241], a[128:131], a[92:95], v[238:241]
    v_and_b32 v103, 0xffff0000, v114
    v_mfma_f32_16x16x32_bf16 v[238:241], a[108:111], a[76:79], v[238:241]
    v_lshlrev_b32 v104, 16, v115
    v_and_b32 v105, 0xffff0000, v115
    v_mfma_f32_16x16x32_bf16 v[182:185], a[112:115], a[64:67], v[182:185]
    v_mul_f32 v106, 0xbfb8aa3b, v86
    v_mfma_f32_16x16x32_bf16 v[182:185], a[132:135], a[80:83], v[182:185]
    v_mul_f32 v107, 0xbfb8aa3b, v87
    v_mfma_f32_16x16x32_bf16 v[202:205], a[132:135], a[84:87], v[202:205]
    v_mul_f32 v108, 0xbfb8aa3b, v88
    v_mfma_f32_16x16x32_bf16 v[202:205], a[112:115], a[68:71], v[202:205]
    v_mul_f32 v109, 0xbfb8aa3b, v89
    v_mul_f32 v110, 0xbfb8aa3b, v90
    v_mfma_f32_16x16x32_bf16 v[222:225], a[112:115], a[72:75], v[222:225]
    v_mul_f32 v111, 0xbfb8aa3b, v91
    v_mfma_f32_16x16x32_bf16 v[222:225], a[132:135], a[88:91], v[222:225]
    v_mul_f32 v112, 0xbfb8aa3b, v92
    v_mfma_f32_16x16x32_bf16 v[242:245], a[132:135], a[92:95], v[242:245]
    v_mul_f32 v113, 0xbfb8aa3b, v93
    v_mfma_f32_16x16x32_bf16 v[242:245], a[112:115], a[76:79], v[242:245]
    v_mul_f32 v114, 0xbfb8aa3b, v94
    v_mul_f32 v115, 0xbfb8aa3b, v95
    s_waitcnt vmcnt(16)
    v_mfma_f32_16x16x32_bf16 v[166:169], a[136:139], a[0:3], v[166:169]
    s_mov_b32 s44, 458752
    buffer_load_dwordx4 a[64:67], v4, s[8:11], s44 offen sc1
    v_mul_f32 v116, 0xbfb8aa3b, v96
    v_mfma_f32_16x16x32_bf16 v[166:169], a[156:159], a[16:19], v[166:169]
    v_mul_f32 v117, 0xbfb8aa3b, v97
    v_mfma_f32_16x16x32_bf16 v[186:189], a[156:159], a[20:23], v[186:189]
    buffer_load_dwordx4 a[68:71], v5, s[8:11], s44 offen sc1
    v_mul_f32 v118, 0xbfb8aa3b, v98
    v_mfma_f32_16x16x32_bf16 v[186:189], a[136:139], a[4:7], v[186:189]
    v_mul_f32 v119, 0xbfb8aa3b, v99
    v_mul_f32 v120, 0xbfb8aa3b, v100
    v_mfma_f32_16x16x32_bf16 v[206:209], a[136:139], a[8:11], v[206:209]
    v_mul_f32 v121, 0xbfb8aa3b, v101
    v_mfma_f32_16x16x32_bf16 v[206:209], a[156:159], a[24:27], v[206:209]
    buffer_load_dwordx4 a[72:75], v6, s[8:11], s44 offen sc1
    v_mul_f32 v122, 0xbfb8aa3b, v102
    v_mfma_f32_16x16x32_bf16 v[226:229], a[156:159], a[28:31], v[226:229]
    v_mul_f32 v123, 0xbfb8aa3b, v103
    v_mfma_f32_16x16x32_bf16 v[226:229], a[136:139], a[12:15], v[226:229]
    buffer_load_dwordx4 a[76:79], v7, s[8:11], s44 offen sc1
    v_mul_f32 v124, 0xbfb8aa3b, v104
    v_mul_f32 v125, 0xbfb8aa3b, v105
    v_mfma_f32_16x16x32_bf16 v[170:173], a[140:143], a[0:3], v[170:173]
    v_exp_f32 v106, v106
    v_mfma_f32_16x16x32_bf16 v[170:173], a[160:163], a[16:19], v[170:173]
    v_exp_f32 v107, v107
    v_mfma_f32_16x16x32_bf16 v[190:193], a[160:163], a[20:23], v[190:193]
    s_mov_b32 s44, 475136
    buffer_load_dwordx4 a[80:83], v4, s[8:11], s44 offen sc1
    v_exp_f32 v108, v108
    v_mfma_f32_16x16x32_bf16 v[190:193], a[140:143], a[4:7], v[190:193]
    v_exp_f32 v109, v109
    v_exp_f32 v110, v110
    v_mfma_f32_16x16x32_bf16 v[210:213], a[140:143], a[8:11], v[210:213]
    buffer_load_dwordx4 a[84:87], v5, s[8:11], s44 offen sc1
    v_exp_f32 v111, v111
    v_mfma_f32_16x16x32_bf16 v[210:213], a[160:163], a[24:27], v[210:213]
    v_exp_f32 v112, v112
    v_mfma_f32_16x16x32_bf16 v[230:233], a[160:163], a[28:31], v[230:233]
    v_exp_f32 v113, v113
    v_mfma_f32_16x16x32_bf16 v[230:233], a[140:143], a[12:15], v[230:233]
    buffer_load_dwordx4 a[88:91], v6, s[8:11], s44 offen sc1
    v_exp_f32 v114, v114
    v_exp_f32 v115, v115
    v_mfma_f32_16x16x32_bf16 v[174:177], a[144:147], a[0:3], v[174:177]
    v_exp_f32 v116, v116
    v_mfma_f32_16x16x32_bf16 v[174:177], a[164:167], a[16:19], v[174:177]
    buffer_load_dwordx4 a[92:95], v7, s[8:11], s44 offen sc1
    v_exp_f32 v117, v117
    v_mfma_f32_16x16x32_bf16 v[194:197], a[164:167], a[20:23], v[194:197]
    v_exp_f32 v118, v118
    v_mfma_f32_16x16x32_bf16 v[194:197], a[144:147], a[4:7], v[194:197]
    v_exp_f32 v119, v119
    v_exp_f32 v120, v120
    v_mfma_f32_16x16x32_bf16 v[214:217], a[144:147], a[8:11], v[214:217]
    buffer_load_dwordx4 v[62:65], v17, s[20:23], s45 offen offset:0 sc1
    v_exp_f32 v121, v121
    v_mfma_f32_16x16x32_bf16 v[214:217], a[164:167], a[24:27], v[214:217]
    v_exp_f32 v122, v122
    v_mfma_f32_16x16x32_bf16 v[234:237], a[164:167], a[28:31], v[234:237]
    s_mov_b32 s45, 634880
    buffer_load_dwordx4 v[66:69], v16, s[20:23], s45 offen offset:0 sc1
    v_exp_f32 v123, v123
    v_mfma_f32_16x16x32_bf16 v[234:237], a[144:147], a[12:15], v[234:237]
    v_exp_f32 v124, v124
    v_exp_f32 v125, v125
    v_mfma_f32_16x16x32_bf16 v[178:181], a[148:151], a[0:3], v[178:181]
    v_add_f32 v106, 1.0, v106
    v_mfma_f32_16x16x32_bf16 v[178:181], a[168:171], a[16:19], v[178:181]
    buffer_load_dwordx4 v[70:73], v16, s[20:23], s45 offen offset:1024 sc1
    v_add_f32 v107, 1.0, v107
    v_mfma_f32_16x16x32_bf16 v[198:201], a[168:171], a[20:23], v[198:201]
    v_add_f32 v108, 1.0, v108
    v_mfma_f32_16x16x32_bf16 v[198:201], a[148:151], a[4:7], v[198:201]
    buffer_load_dwordx4 v[74:77], v16, s[20:23], s45 offen offset:2048 sc1
    v_add_f32 v109, 1.0, v109
    v_add_f32 v110, 1.0, v110
    v_mfma_f32_16x16x32_bf16 v[218:221], a[148:151], a[8:11], v[218:221]
    v_add_f32 v111, 1.0, v111
    v_mfma_f32_16x16x32_bf16 v[218:221], a[168:171], a[24:27], v[218:221]
    v_add_f32 v112, 1.0, v112
    v_mfma_f32_16x16x32_bf16 v[238:241], a[168:171], a[28:31], v[238:241]
    v_add_f32 v113, 1.0, v113
    v_mfma_f32_16x16x32_bf16 v[238:241], a[148:151], a[12:15], v[238:241]
    v_add_f32 v114, 1.0, v114
    v_add_f32 v115, 1.0, v115
    v_mfma_f32_16x16x32_bf16 v[182:185], a[152:155], a[0:3], v[182:185]
    v_add_f32 v116, 1.0, v116
    v_mfma_f32_16x16x32_bf16 v[182:185], a[172:175], a[16:19], v[182:185]
    v_add_f32 v117, 1.0, v117
    v_mfma_f32_16x16x32_bf16 v[202:205], a[172:175], a[20:23], v[202:205]
    v_add_f32 v118, 1.0, v118
    v_mfma_f32_16x16x32_bf16 v[202:205], a[152:155], a[4:7], v[202:205]
    v_add_f32 v119, 1.0, v119
    v_add_f32 v120, 1.0, v120
    v_mfma_f32_16x16x32_bf16 v[222:225], a[152:155], a[8:11], v[222:225]
    v_add_f32 v121, 1.0, v121
    v_mfma_f32_16x16x32_bf16 v[222:225], a[172:175], a[24:27], v[222:225]
    v_add_f32 v122, 1.0, v122
    v_mfma_f32_16x16x32_bf16 v[242:245], a[172:175], a[28:31], v[242:245]
    v_add_f32 v123, 1.0, v123
    v_mfma_f32_16x16x32_bf16 v[242:245], a[152:155], a[12:15], v[242:245]
    v_add_f32 v124, 1.0, v124
    v_add_f32 v125, 1.0, v125
    s_waitcnt vmcnt(16)
    v_mfma_f32_16x16x32_bf16 v[166:169], a[176:179], a[32:35], v[166:169]
    s_mov_b32 s44, 491520
    buffer_load_dwordx4 a[0:3], v4, s[8:11], s44 offen sc1
    v_rcp_f32 v106, v106
    v_mfma_f32_16x16x32_bf16 v[166:169], a[196:199], a[48:51], v[166:169]
    v_rcp_f32 v107, v107
    v_mfma_f32_16x16x32_bf16 v[186:189], a[196:199], a[52:55], v[186:189]
    v_rcp_f32 v108, v108
    v_mfma_f32_16x16x32_bf16 v[186:189], a[176:179], a[36:39], v[186:189]
    buffer_load_dwordx4 a[4:7], v5, s[8:11], s44 offen sc1
    v_rcp_f32 v109, v109
    v_rcp_f32 v110, v110
    v_mfma_f32_16x16x32_bf16 v[206:209], a[176:179], a[40:43], v[206:209]
    v_rcp_f32 v111, v111
    v_mfma_f32_16x16x32_bf16 v[206:209], a[196:199], a[56:59], v[206:209]
    v_rcp_f32 v112, v112
    v_mfma_f32_16x16x32_bf16 v[226:229], a[196:199], a[60:63], v[226:229]
    buffer_load_dwordx4 a[8:11], v6, s[8:11], s44 offen sc1
    v_rcp_f32 v113, v113
    v_mfma_f32_16x16x32_bf16 v[226:229], a[176:179], a[44:47], v[226:229]
    v_rcp_f32 v114, v114
    v_rcp_f32 v115, v115
    v_mfma_f32_16x16x32_bf16 v[170:173], a[180:183], a[32:35], v[170:173]
    v_rcp_f32 v116, v116
    v_mfma_f32_16x16x32_bf16 v[170:173], a[200:203], a[48:51], v[170:173]
    buffer_load_dwordx4 a[12:15], v7, s[8:11], s44 offen sc1
    v_rcp_f32 v117, v117
    v_mfma_f32_16x16x32_bf16 v[190:193], a[200:203], a[52:55], v[190:193]
    v_rcp_f32 v118, v118
    v_mfma_f32_16x16x32_bf16 v[190:193], a[180:183], a[36:39], v[190:193]
    v_rcp_f32 v119, v119
    v_rcp_f32 v120, v120
    v_mfma_f32_16x16x32_bf16 v[210:213], a[180:183], a[40:43], v[210:213]
    s_mov_b32 s44, 507904
    buffer_load_dwordx4 a[16:19], v4, s[8:11], s44 offen sc1
    v_rcp_f32 v121, v121
    v_mfma_f32_16x16x32_bf16 v[210:213], a[200:203], a[56:59], v[210:213]
    v_rcp_f32 v122, v122
    v_mfma_f32_16x16x32_bf16 v[230:233], a[200:203], a[60:63], v[230:233]
    v_rcp_f32 v123, v123
    v_mfma_f32_16x16x32_bf16 v[230:233], a[180:183], a[44:47], v[230:233]
    buffer_load_dwordx4 a[20:23], v5, s[8:11], s44 offen sc1
    v_rcp_f32 v124, v124
    v_rcp_f32 v125, v125
    v_mfma_f32_16x16x32_bf16 v[174:177], a[184:187], a[32:35], v[174:177]
    v_mul_f32 v86, v86, v106
    v_mfma_f32_16x16x32_bf16 v[174:177], a[204:207], a[48:51], v[174:177]
    v_mul_f32 v87, v87, v107
    v_mfma_f32_16x16x32_bf16 v[194:197], a[204:207], a[52:55], v[194:197]
    buffer_load_dwordx4 a[24:27], v6, s[8:11], s44 offen sc1
    v_mul_f32 v88, v88, v108
    v_mfma_f32_16x16x32_bf16 v[194:197], a[184:187], a[36:39], v[194:197]
    v_mul_f32 v89, v89, v109
    v_mul_f32 v90, v90, v110
    v_mfma_f32_16x16x32_bf16 v[214:217], a[184:187], a[40:43], v[214:217]
    v_mul_f32 v91, v91, v111
    v_mfma_f32_16x16x32_bf16 v[214:217], a[204:207], a[56:59], v[214:217]
    buffer_load_dwordx4 a[28:31], v7, s[8:11], s44 offen sc1
    v_mul_f32 v92, v92, v112
    v_mfma_f32_16x16x32_bf16 v[234:237], a[204:207], a[60:63], v[234:237]
    v_mul_f32 v93, v93, v113
    v_mfma_f32_16x16x32_bf16 v[234:237], a[184:187], a[44:47], v[234:237]
    v_mul_f32 v94, v94, v114
    v_mul_f32 v95, v95, v115
    v_mfma_f32_16x16x32_bf16 v[178:181], a[188:191], a[32:35], v[178:181]
    buffer_load_dwordx4 v[78:81], v16, s[20:23], s45 offen offset:3072 sc1
    v_mul_f32 v96, v96, v116
    v_mfma_f32_16x16x32_bf16 v[178:181], a[208:211], a[48:51], v[178:181]
    v_mul_f32 v97, v97, v117
    v_mfma_f32_16x16x32_bf16 v[198:201], a[208:211], a[52:55], v[198:201]
    v_mul_f32 v98, v98, v118
    v_mfma_f32_16x16x32_bf16 v[198:201], a[188:191], a[36:39], v[198:201]
    buffer_load_dwordx4 v[82:85], v17, s[20:23], s45 offen offset:0 sc1
    v_mul_f32 v99, v99, v119
    v_mul_f32 v100, v100, v120
    v_mfma_f32_16x16x32_bf16 v[218:221], a[188:191], a[40:43], v[218:221]
    v_mul_f32 v101, v101, v121
    v_mfma_f32_16x16x32_bf16 v[218:221], a[208:211], a[56:59], v[218:221]
    v_mul_f32 v102, v102, v122
    v_mfma_f32_16x16x32_bf16 v[238:241], a[208:211], a[60:63], v[238:241]
    v_mul_f32 v103, v103, v123
    v_mfma_f32_16x16x32_bf16 v[238:241], a[188:191], a[44:47], v[238:241]
    v_mul_f32 v104, v104, v124
    v_mul_f32 v105, v105, v125
    v_mfma_f32_16x16x32_bf16 v[182:185], a[192:195], a[32:35], v[182:185]
    v_cvt_pk_bf16_f32 v36, v86, v87
    v_mfma_f32_16x16x32_bf16 v[182:185], a[212:215], a[48:51], v[182:185]
    v_cvt_pk_bf16_f32 v37, v88, v89
    v_mfma_f32_16x16x32_bf16 v[202:205], a[212:215], a[52:55], v[202:205]
    v_cvt_pk_bf16_f32 v38, v90, v91
    v_mfma_f32_16x16x32_bf16 v[202:205], a[192:195], a[36:39], v[202:205]
    v_cvt_pk_bf16_f32 v39, v92, v93
    v_cvt_pk_bf16_f32 v40, v94, v95
    v_mfma_f32_16x16x32_bf16 v[222:225], a[192:195], a[40:43], v[222:225]
    v_cvt_pk_bf16_f32 v41, v96, v97
    v_mfma_f32_16x16x32_bf16 v[222:225], a[212:215], a[56:59], v[222:225]
    v_cvt_pk_bf16_f32 v42, v98, v99
    v_mfma_f32_16x16x32_bf16 v[242:245], a[212:215], a[60:63], v[242:245]
    v_cvt_pk_bf16_f32 v43, v100, v101
    v_mfma_f32_16x16x32_bf16 v[242:245], a[192:195], a[44:47], v[242:245]
    v_cvt_pk_bf16_f32 v44, v102, v103
    v_cvt_pk_bf16_f32 v45, v104, v105
    s_waitcnt vmcnt(14)
    v_mfma_f32_16x16x32_bf16 v[166:169], a[216:219], a[64:67], v[166:169]
    v_mfma_f32_16x16x32_bf16 v[166:169], a[236:239], a[80:83], v[166:169]
    v_mfma_f32_16x16x32_bf16 v[186:189], a[236:239], a[84:87], v[186:189]
    v_mfma_f32_16x16x32_bf16 v[186:189], a[216:219], a[68:71], v[186:189]
    v_mfma_f32_16x16x32_bf16 v[206:209], a[216:219], a[72:75], v[206:209]
    v_mfma_f32_16x16x32_bf16 v[206:209], a[236:239], a[88:91], v[206:209]
    v_mfma_f32_16x16x32_bf16 v[226:229], a[236:239], a[92:95], v[226:229]
    v_mfma_f32_16x16x32_bf16 v[226:229], a[216:219], a[76:79], v[226:229]
    v_mfma_f32_16x16x32_bf16 v[170:173], a[220:223], a[64:67], v[170:173]
    v_mfma_f32_16x16x32_bf16 v[170:173], a[240:243], a[80:83], v[170:173]
    v_mfma_f32_16x16x32_bf16 v[190:193], a[240:243], a[84:87], v[190:193]
    v_mfma_f32_16x16x32_bf16 v[190:193], a[220:223], a[68:71], v[190:193]
    v_mfma_f32_16x16x32_bf16 v[210:213], a[220:223], a[72:75], v[210:213]
    v_mfma_f32_16x16x32_bf16 v[210:213], a[240:243], a[88:91], v[210:213]
    v_mfma_f32_16x16x32_bf16 v[230:233], a[240:243], a[92:95], v[230:233]
    v_mfma_f32_16x16x32_bf16 v[230:233], a[220:223], a[76:79], v[230:233]
    v_mfma_f32_16x16x32_bf16 v[174:177], a[224:227], a[64:67], v[174:177]
    v_mfma_f32_16x16x32_bf16 v[174:177], a[244:247], a[80:83], v[174:177]
    v_mfma_f32_16x16x32_bf16 v[194:197], a[244:247], a[84:87], v[194:197]
    v_mfma_f32_16x16x32_bf16 v[194:197], a[224:227], a[68:71], v[194:197]
    v_mfma_f32_16x16x32_bf16 v[214:217], a[224:227], a[72:75], v[214:217]
    v_mfma_f32_16x16x32_bf16 v[214:217], a[244:247], a[88:91], v[214:217]
    v_mfma_f32_16x16x32_bf16 v[234:237], a[244:247], a[92:95], v[234:237]
    v_mfma_f32_16x16x32_bf16 v[234:237], a[224:227], a[76:79], v[234:237]
    v_mfma_f32_16x16x32_bf16 v[178:181], a[228:231], a[64:67], v[178:181]
    v_mfma_f32_16x16x32_bf16 v[178:181], a[248:251], a[80:83], v[178:181]
    v_mfma_f32_16x16x32_bf16 v[198:201], a[248:251], a[84:87], v[198:201]
    v_mfma_f32_16x16x32_bf16 v[198:201], a[228:231], a[68:71], v[198:201]
    v_mfma_f32_16x16x32_bf16 v[218:221], a[228:231], a[72:75], v[218:221]
    v_mfma_f32_16x16x32_bf16 v[218:221], a[248:251], a[88:91], v[218:221]
    v_mfma_f32_16x16x32_bf16 v[238:241], a[248:251], a[92:95], v[238:241]
    v_mfma_f32_16x16x32_bf16 v[238:241], a[228:231], a[76:79], v[238:241]
    v_mfma_f32_16x16x32_bf16 v[182:185], a[232:235], a[64:67], v[182:185]
    v_mfma_f32_16x16x32_bf16 v[182:185], a[252:255], a[80:83], v[182:185]
    v_mfma_f32_16x16x32_bf16 v[202:205], a[252:255], a[84:87], v[202:205]
    v_mfma_f32_16x16x32_bf16 v[202:205], a[232:235], a[68:71], v[202:205]
    v_mfma_f32_16x16x32_bf16 v[222:225], a[232:235], a[72:75], v[222:225]
    v_mfma_f32_16x16x32_bf16 v[222:225], a[252:255], a[88:91], v[222:225]
    v_mfma_f32_16x16x32_bf16 v[242:245], a[252:255], a[92:95], v[242:245]
    s_sub_u32 s40, s5, 1
    s_and_b32 s40, s40, 3
    s_mul_i32 s40, s40, 10240
    v_lshl_add_u32 v5, v19, 4, s40
    s_sub_u32 s40, s5, 2
    s_and_b32 s40, s40, 3
    s_mul_i32 s40, s40, 10240
    v_lshl_add_u32 v6, v19, 4, s40
    s_sub_u32 s40, s5, 3
    s_and_b32 s40, s40, 3
    s_mul_i32 s40, s40, 10240
    v_lshl_add_u32 v7, v19, 4, s40
    v_mfma_f32_16x16x32_bf16 v[242:245], a[232:235], a[76:79], v[242:245]
    s_waitcnt vmcnt(0)
    v_mfma_f32_16x16x32_bf16 v[166:169], v[46:49], a[0:3], v[166:169]
    v_mfma_f32_16x16x32_bf16 v[166:169], v[66:69], a[16:19], v[166:169]
    v_mfma_f32_16x16x32_bf16 v[186:189], v[66:69], a[20:23], v[186:189]
    v_mfma_f32_16x16x32_bf16 v[186:189], v[46:49], a[4:7], v[186:189]
    v_mfma_f32_16x16x32_bf16 v[206:209], v[46:49], a[8:11], v[206:209]
    v_mfma_f32_16x16x32_bf16 v[206:209], v[66:69], a[24:27], v[206:209]
    v_mfma_f32_16x16x32_bf16 v[226:229], v[66:69], a[28:31], v[226:229]
    v_mfma_f32_16x16x32_bf16 v[226:229], v[46:49], a[12:15], v[226:229]
    v_mfma_f32_16x16x32_bf16 v[170:173], v[50:53], a[0:3], v[170:173]
    v_mfma_f32_16x16x32_bf16 v[170:173], v[70:73], a[16:19], v[170:173]
    v_mfma_f32_16x16x32_bf16 v[190:193], v[70:73], a[20:23], v[190:193]
    v_mfma_f32_16x16x32_bf16 v[190:193], v[50:53], a[4:7], v[190:193]
    v_mfma_f32_16x16x32_bf16 v[210:213], v[50:53], a[8:11], v[210:213]
    v_mfma_f32_16x16x32_bf16 v[210:213], v[70:73], a[24:27], v[210:213]
    v_mfma_f32_16x16x32_bf16 v[230:233], v[70:73], a[28:31], v[230:233]
    v_mfma_f32_16x16x32_bf16 v[230:233], v[50:53], a[12:15], v[230:233]
    v_mfma_f32_16x16x32_bf16 v[174:177], v[54:57], a[0:3], v[174:177]
    v_mfma_f32_16x16x32_bf16 v[174:177], v[74:77], a[16:19], v[174:177]
    v_mfma_f32_16x16x32_bf16 v[194:197], v[74:77], a[20:23], v[194:197]
    v_mfma_f32_16x16x32_bf16 v[194:197], v[54:57], a[4:7], v[194:197]
    v_mfma_f32_16x16x32_bf16 v[214:217], v[54:57], a[8:11], v[214:217]
    v_mfma_f32_16x16x32_bf16 v[214:217], v[74:77], a[24:27], v[214:217]
    v_mfma_f32_16x16x32_bf16 v[234:237], v[74:77], a[28:31], v[234:237]
    v_mfma_f32_16x16x32_bf16 v[234:237], v[54:57], a[12:15], v[234:237]
    v_mfma_f32_16x16x32_bf16 v[178:181], v[58:61], a[0:3], v[178:181]
    v_mfma_f32_16x16x32_bf16 v[178:181], v[78:81], a[16:19], v[178:181]
    v_mfma_f32_16x16x32_bf16 v[198:201], v[78:81], a[20:23], v[198:201]
    v_mfma_f32_16x16x32_bf16 v[198:201], v[58:61], a[4:7], v[198:201]
    v_mfma_f32_16x16x32_bf16 v[218:221], v[58:61], a[8:11], v[218:221]
    v_mfma_f32_16x16x32_bf16 v[218:221], v[78:81], a[24:27], v[218:221]
    v_mfma_f32_16x16x32_bf16 v[238:241], v[78:81], a[28:31], v[238:241]
    v_mfma_f32_16x16x32_bf16 v[238:241], v[58:61], a[12:15], v[238:241]
    v_mfma_f32_16x16x32_bf16 v[182:185], v[62:65], a[0:3], v[182:185]
    v_mfma_f32_16x16x32_bf16 v[182:185], v[82:85], a[16:19], v[182:185]
    v_mfma_f32_16x16x32_bf16 v[202:205], v[82:85], a[20:23], v[202:205]
    v_mfma_f32_16x16x32_bf16 v[202:205], v[62:65], a[4:7], v[202:205]
    v_mfma_f32_16x16x32_bf16 v[222:225], v[62:65], a[8:11], v[222:225]
    v_mfma_f32_16x16x32_bf16 v[222:225], v[82:85], a[24:27], v[222:225]
    v_mfma_f32_16x16x32_bf16 v[242:245], v[82:85], a[28:31], v[242:245]
    v_mfma_f32_16x16x32_bf16 v[242:245], v[62:65], a[12:15], v[242:245]
    s_nop 3
    ds_write_b128 v9, v[186:189] offset:0
    ds_write_b128 v9, v[190:193] offset:1024
    ds_write_b128 v9, v[194:197] offset:2048
    ds_write_b128 v9, v[198:201] offset:3072
    ds_write_b128 v9, v[202:205] offset:4096
    ds_write_b128 v9, v[206:209] offset:5120
    ds_write_b128 v9, v[210:213] offset:6144
    ds_write_b128 v9, v[214:217] offset:7168
    ds_write_b128 v9, v[218:221] offset:8192
    ds_write_b128 v9, v[222:225] offset:9216
    ds_write_b128 v9, v[226:229] offset:40960
    ds_write_b128 v9, v[230:233] offset:41984
    ds_write_b128 v9, v[234:237] offset:43008
    ds_write_b128 v9, v[238:241] offset:44032
    ds_write_b128 v9, v[242:245] offset:45056
    s_waitcnt lgkmcnt(0)
    s_barrier
    ds_read_b128 v[186:189], v5 offset:0
    ds_read_b128 v[190:193], v5 offset:1024
    ds_read_b128 v[194:197], v5 offset:2048
    ds_read_b128 v[198:201], v5 offset:3072
    ds_read_b128 v[202:205], v5 offset:4096
    ds_read_b128 v[206:209], v6 offset:5120
    ds_read_b128 v[210:213], v6 offset:6144
    ds_read_b128 v[214:217], v6 offset:7168
    ds_read_b128 v[218:221], v6 offset:8192
    ds_read_b128 v[222:225], v6 offset:9216
    ds_read_b128 v[226:229], v7 offset:40960
    ds_read_b128 v[230:233], v7 offset:41984
    ds_read_b128 v[234:237], v7 offset:43008
    ds_read_b128 v[238:241], v7 offset:44032
    ds_read_b128 v[242:245], v7 offset:45056
    v_lshlrev_b32 v66, 16, v36
    v_and_b32 v67, 0xffff0000, v36
    v_lshlrev_b32 v86, 16, v22
    v_and_b32 v87, 0xffff0000, v22
    v_lshlrev_b32 v68, 16, v37
    v_and_b32 v69, 0xffff0000, v37
    v_lshlrev_b32 v88, 16, v23
    v_and_b32 v89, 0xffff0000, v23
    v_lshlrev_b32 v70, 16, v38
    v_and_b32 v71, 0xffff0000, v38
    v_lshlrev_b32 v90, 16, v24
    v_and_b32 v91, 0xffff0000, v24
    v_lshlrev_b32 v72, 16, v39
    v_and_b32 v73, 0xffff0000, v39
    v_lshlrev_b32 v92, 16, v25
    v_and_b32 v93, 0xffff0000, v25
    v_lshlrev_b32 v74, 16, v40
    v_and_b32 v75, 0xffff0000, v40
    v_lshlrev_b32 v94, 16, v26
    v_and_b32 v95, 0xffff0000, v26
    v_lshlrev_b32 v76, 16, v41
    v_and_b32 v77, 0xffff0000, v41
    v_lshlrev_b32 v96, 16, v27
    v_and_b32 v97, 0xffff0000, v27
    v_lshlrev_b32 v78, 16, v42
    v_and_b32 v79, 0xffff0000, v42
    v_lshlrev_b32 v98, 16, v28
    v_and_b32 v99, 0xffff0000, v28
    v_lshlrev_b32 v80, 16, v43
    v_and_b32 v81, 0xffff0000, v43
    v_lshlrev_b32 v100, 16, v29
    v_and_b32 v101, 0xffff0000, v29
    v_lshlrev_b32 v82, 16, v44
    v_and_b32 v83, 0xffff0000, v44
    v_lshlrev_b32 v102, 16, v30
    v_and_b32 v103, 0xffff0000, v30
    v_lshlrev_b32 v84, 16, v45
    v_and_b32 v85, 0xffff0000, v45
    v_lshlrev_b32 v104, 16, v31
    v_and_b32 v105, 0xffff0000, v31
    s_waitcnt lgkmcnt(10)
    v_add_f32 v166, v166, v186
    v_add_f32 v167, v167, v187
    v_add_f32 v168, v168, v188
    v_add_f32 v169, v169, v189
    v_add_f32 v170, v170, v190
    v_add_f32 v171, v171, v191
    v_add_f32 v172, v172, v192
    v_add_f32 v173, v173, v193
    v_add_f32 v174, v174, v194
    v_add_f32 v175, v175, v195
    v_add_f32 v176, v176, v196
    v_add_f32 v177, v177, v197
    v_add_f32 v178, v178, v198
    v_add_f32 v179, v179, v199
    v_add_f32 v180, v180, v200
    v_add_f32 v181, v181, v201
    v_add_f32 v182, v182, v202
    v_add_f32 v183, v183, v203
    v_add_f32 v184, v184, v204
    v_add_f32 v185, v185, v205
    s_waitcnt lgkmcnt(5)
    v_add_f32 v166, v166, v206
    v_add_f32 v167, v167, v207
    v_add_f32 v168, v168, v208
    v_add_f32 v169, v169, v209
    v_add_f32 v170, v170, v210
    v_add_f32 v171, v171, v211
    v_add_f32 v172, v172, v212
    v_add_f32 v173, v173, v213
    v_add_f32 v174, v174, v214
    v_add_f32 v175, v175, v215
    v_add_f32 v176, v176, v216
    v_add_f32 v177, v177, v217
    v_add_f32 v178, v178, v218
    v_add_f32 v179, v179, v219
    v_add_f32 v180, v180, v220
    v_add_f32 v181, v181, v221
    v_add_f32 v182, v182, v222
    v_add_f32 v183, v183, v223
    v_add_f32 v184, v184, v224
    v_add_f32 v185, v185, v225
    s_waitcnt lgkmcnt(0)
    v_add_f32 v166, v166, v226
    v_add_f32 v167, v167, v227
    v_add_f32 v168, v168, v228
    v_add_f32 v169, v169, v229
    v_add_f32 v170, v170, v230
    v_add_f32 v171, v171, v231
    v_add_f32 v172, v172, v232
    v_add_f32 v173, v173, v233
    v_add_f32 v174, v174, v234
    v_add_f32 v175, v175, v235
    v_add_f32 v176, v176, v236
    v_add_f32 v177, v177, v237
    v_add_f32 v178, v178, v238
    v_add_f32 v179, v179, v239
    v_add_f32 v180, v180, v240
    v_add_f32 v181, v181, v241
    v_add_f32 v182, v182, v242
    v_add_f32 v183, v183, v243
    v_add_f32 v184, v184, v244
    v_add_f32 v185, v185, v245
    v_cvt_pk_bf16_f32 v46, v166, v167
    v_cvt_pk_bf16_f32 v47, v168, v169
    v_cvt_pk_bf16_f32 v48, v170, v171
    v_cvt_pk_bf16_f32 v49, v172, v173
    v_cvt_pk_bf16_f32 v50, v174, v175
    v_cvt_pk_bf16_f32 v51, v176, v177
    v_cvt_pk_bf16_f32 v52, v178, v179
    v_cvt_pk_bf16_f32 v53, v180, v181
    v_cvt_pk_bf16_f32 v54, v182, v183
    v_cvt_pk_bf16_f32 v55, v184, v185
    v_lshlrev_b32 v166, 16, v46
    v_and_b32 v167, 0xffff0000, v46
    v_lshlrev_b32 v168, 16, v47
    v_and_b32 v169, 0xffff0000, v47
    v_lshlrev_b32 v170, 16, v48
    v_and_b32 v171, 0xffff0000, v48
    v_lshlrev_b32 v172, 16, v49
    v_and_b32 v173, 0xffff0000, v49
    v_lshlrev_b32 v174, 16, v50
    v_and_b32 v175, 0xffff0000, v50
    v_lshlrev_b32 v176, 16, v51
    v_and_b32 v177, 0xffff0000, v51
    v_lshlrev_b32 v178, 16, v52
    v_and_b32 v179, 0xffff0000, v52
    v_lshlrev_b32 v180, 16, v53
    v_and_b32 v181, 0xffff0000, v53
    v_lshlrev_b32 v182, 16, v54
    v_and_b32 v183, 0xffff0000, v54
    v_lshlrev_b32 v184, 16, v55
    v_and_b32 v185, 0xffff0000, v55
    v_mul_f32 v166, v166, v66
    v_mul_f32 v167, v167, v67
    v_mul_f32 v168, v168, v68
    v_mul_f32 v169, v169, v69
    v_mul_f32 v170, v170, v70
    v_mul_f32 v171, v171, v71
    v_mul_f32 v172, v172, v72
    v_mul_f32 v173, v173, v73
    v_mul_f32 v174, v174, v74
    v_mul_f32 v175, v175, v75
    v_mul_f32 v176, v176, v76
    v_mul_f32 v177, v177, v77
    v_mul_f32 v178, v178, v78
    v_mul_f32 v179, v179, v79
    v_mul_f32 v180, v180, v80
    v_mul_f32 v181, v181, v81
    v_mul_f32 v182, v182, v82
    v_mul_f32 v183, v183, v83
    v_mul_f32 v184, v184, v84
    v_mul_f32 v185, v185, v85
    v_cvt_pk_bf16_f32 v46, v166, v167
    v_cvt_pk_bf16_f32 v47, v168, v169
    v_cvt_pk_bf16_f32 v48, v170, v171
    v_cvt_pk_bf16_f32 v49, v172, v173
    v_cvt_pk_bf16_f32 v50, v174, v175
    v_cvt_pk_bf16_f32 v51, v176, v177
    v_cvt_pk_bf16_f32 v52, v178, v179
    v_cvt_pk_bf16_f32 v53, v180, v181
    v_cvt_pk_bf16_f32 v54, v182, v183
    v_cvt_pk_bf16_f32 v55, v184, v185
    v_lshlrev_b32 v166, 16, v46
    v_and_b32 v167, 0xffff0000, v46
    v_lshlrev_b32 v168, 16, v47
    v_and_b32 v169, 0xffff0000, v47
    v_lshlrev_b32 v170, 16, v48
    v_and_b32 v171, 0xffff0000, v48
    v_lshlrev_b32 v172, 16, v49
    v_and_b32 v173, 0xffff0000, v49
    v_lshlrev_b32 v174, 16, v50
    v_and_b32 v175, 0xffff0000, v50
    v_lshlrev_b32 v176, 16, v51
    v_and_b32 v177, 0xffff0000, v51
    v_lshlrev_b32 v178, 16, v52
    v_and_b32 v179, 0xffff0000, v52
    v_lshlrev_b32 v180, 16, v53
    v_and_b32 v181, 0xffff0000, v53
    v_lshlrev_b32 v182, 16, v54
    v_and_b32 v183, 0xffff0000, v54
    v_lshlrev_b32 v184, 16, v55
    v_and_b32 v185, 0xffff0000, v55
    v_add_f32 v166, v166, v86
    v_add_f32 v167, v167, v87
    v_add_f32 v168, v168, v88
    v_add_f32 v169, v169, v89
    v_add_f32 v170, v170, v90
    v_add_f32 v171, v171, v91
    v_add_f32 v172, v172, v92
    v_add_f32 v173, v173, v93
    v_add_f32 v174, v174, v94
    v_add_f32 v175, v175, v95
    v_add_f32 v176, v176, v96
    v_add_f32 v177, v177, v97
    v_add_f32 v178, v178, v98
    v_add_f32 v179, v179, v99
    v_add_f32 v180, v180, v100
    v_add_f32 v181, v181, v101
    v_add_f32 v182, v182, v102
    v_add_f32 v183, v183, v103
    v_add_f32 v184, v184, v104
    v_add_f32 v185, v185, v105
    v_cvt_pk_bf16_f32 v46, v166, v167
    v_cvt_pk_bf16_f32 v47, v168, v169
    v_cvt_pk_bf16_f32 v48, v170, v171
    v_cvt_pk_bf16_f32 v49, v172, v173
    v_cvt_pk_bf16_f32 v50, v174, v175
    v_cvt_pk_bf16_f32 v51, v176, v177
    v_cvt_pk_bf16_f32 v52, v178, v179
    v_cvt_pk_bf16_f32 v53, v180, v181
    v_cvt_pk_bf16_f32 v54, v182, v183
    v_cvt_pk_bf16_f32 v55, v184, v185
    buffer_store_dwordx2 v[46:47], v34, s[12:15], 0 offen offset:0
    buffer_store_dwordx2 v[48:49], v34, s[12:15], 0 offen offset:32
    buffer_store_dwordx2 v[50:51], v34, s[12:15], 0 offen offset:64
    buffer_store_dwordx2 v[52:53], v34, s[12:15], 0 offen offset:96
    buffer_store_dwordx2 v[54:55], v34, s[12:15], 0 offen offset:128
L_end:
    s_endpgm
L_slow:
    s_lshl_b32 s40, s5, 12
    v_subrev_u32 v13, s40, v13
    v_subrev_u32 v14, s40, v14
    v_subrev_u32 v15, s40, v15
    v_subrev_u32 v16, s40, v16
    v_subrev_u32 v17, s40, v17
    v_subrev_u32 v18, s40, v18
    s_and_b32 s40, s5, 1
    s_lshr_b32 s41, s5, 1
    s_mul_i32 s41, s41, 3
    s_add_u32 s40, s40, s41
    s_add_u32 s40, s40, 1
    s_lshl_b32 s34, s40, 13
    s_sub_u32 s40, s34, 98304
    v_add_u32 v1, s40, v1
    v_add_u32 v2, s40, v2
    v_add_u32 v3, s40, v3
    v_add_u32 v4, s40, v4
    v_add_u32 v5, s34, v5
    v_add_u32 v6, s34, v6
    v_add_u32 v7, s34, v7
    v_add_u32 v8, s34, v8
    v_add_u32 v9, s34, v9
    v_add_u32 v10, s34, v10
    v_add_u32 v11, s34, v11
    v_add_u32 v12, s34, v12
    v_mov_b32 v212, 0xff800000
    v_mov_b32 v216, 0
    v_mov_b32 v213, 0xff800000
    v_mov_b32 v217, 0
    v_mov_b32 v214, 0xff800000
    v_mov_b32 v218, 0
    v_mov_b32 v215, 0xff800000
    v_mov_b32 v219, 0
    v_accvgpr_write_b32 a0, 0
    v_accvgpr_write_b32 a1, 0
    v_accvgpr_write_b32 a2, 0
    v_accvgpr_write_b32 a3, 0
    v_accvgpr_write_b32 a4, 0
    v_accvgpr_write_b32 a5, 0
    v_accvgpr_write_b32 a6, 0
    v_accvgpr_write_b32 a7, 0
    v_accvgpr_write_b32 a8, 0
    v_accvgpr_write_b32 a9, 0
    v_accvgpr_write_b32 a10, 0
    v_accvgpr_write_b32 a11, 0
    v_accvgpr_write_b32 a12, 0
    v_accvgpr_write_b32 a13, 0
    v_accvgpr_write_b32 a14, 0
    v_accvgpr_write_b32 a15, 0
    v_accvgpr_write_b32 a16, 0
    v_accvgpr_write_b32 a17, 0
    v_accvgpr_write_b32 a18, 0
    v_accvgpr_write_b32 a19, 0
    v_accvgpr_write_b32 a20, 0
    v_accvgpr_write_b32 a21, 0
    v_accvgpr_write_b32 a22, 0
    v_accvgpr_write_b32 a23, 0
    v_accvgpr_write_b32 a24, 0
    v_accvgpr_write_b32 a25, 0
    v_accvgpr_write_b32 a26, 0
    v_accvgpr_write_b32 a27, 0
    v_accvgpr_write_b32 a28, 0
    v_accvgpr_write_b32 a29, 0
    v_accvgpr_write_b32 a30, 0
    v_accvgpr_write_b32 a31, 0
    v_accvgpr_write_b32 a32, 0
    v_accvgpr_write_b32 a33, 0
    v_accvgpr_write_b32 a34, 0
    v_accvgpr_write_b32 a35, 0
    v_accvgpr_write_b32 a36, 0
    v_accvgpr_write_b32 a37, 0
    v_accvgpr_write_b32 a38, 0
    v_accvgpr_write_b32 a39, 0
    v_accvgpr_write_b32 a40, 0
    v_accvgpr_write_b32 a41, 0
    v_accvgpr_write_b32 a42, 0
    v_accvgpr_write_b32 a43, 0
    v_accvgpr_write_b32 a44, 0
    v_accvgpr_write_b32 a45, 0
    v_accvgpr_write_b32 a46, 0
    v_accvgpr_write_b32 a47, 0
    v_accvgpr_write_b32 a48, 0
    v_accvgpr_write_b32 a49, 0
    v_accvgpr_write_b32 a50, 0
    v_accvgpr_write_b32 a51, 0
    v_accvgpr_write_b32 a52, 0
    v_accvgpr_write_b32 a53, 0
    v_accvgpr_write_b32 a54, 0
    v_accvgpr_write_b32 a55, 0
    v_accvgpr_write_b32 a56, 0
    v_accvgpr_write_b32 a57, 0
    v_accvgpr_write_b32 a58, 0
    v_accvgpr_write_b32 a59, 0
    v_accvgpr_write_b32 a60, 0
    v_accvgpr_write_b32 a61, 0
    v_accvgpr_write_b32 a62, 0
    v_accvgpr_write_b32 a63, 0
    v_accvgpr_write_b32 a64, 0
    v_accvgpr_write_b32 a65, 0
    v_accvgpr_write_b32 a66, 0
    v_accvgpr_write_b32 a67, 0
    v_accvgpr_write_b32 a68, 0
    v_accvgpr_write_b32 a69, 0
    v_accvgpr_write_b32 a70, 0
    v_accvgpr_write_b32 a71, 0
    v_accvgpr_write_b32 a72, 0
    v_accvgpr_write_b32 a73, 0
    v_accvgpr_write_b32 a74, 0
    v_accvgpr_write_b32 a75, 0
    v_accvgpr_write_b32 a76, 0
    v_accvgpr_write_b32 a77, 0
    v_accvgpr_write_b32 a78, 0
    v_accvgpr_write_b32 a79, 0
    v_accvgpr_write_b32 a80, 0
    v_accvgpr_write_b32 a81, 0
    v_accvgpr_write_b32 a82, 0
    v_accvgpr_write_b32 a83, 0
    v_accvgpr_write_b32 a84, 0
    v_accvgpr_write_b32 a85, 0
    v_accvgpr_write_b32 a86, 0
    v_accvgpr_write_b32 a87, 0
    v_accvgpr_write_b32 a88, 0
    v_accvgpr_write_b32 a89, 0
    v_accvgpr_write_b32 a90, 0
    v_accvgpr_write_b32 a91, 0
    v_accvgpr_write_b32 a92, 0
    v_accvgpr_write_b32 a93, 0
    v_accvgpr_write_b32 a94, 0
    v_accvgpr_write_b32 a95, 0
    v_accvgpr_write_b32 a96, 0
    v_accvgpr_write_b32 a97, 0
    v_accvgpr_write_b32 a98, 0
    v_accvgpr_write_b32 a99, 0
    v_accvgpr_write_b32 a100, 0
    v_accvgpr_write_b32 a101, 0
    v_accvgpr_write_b32 a102, 0
    v_accvgpr_write_b32 a103, 0
    v_accvgpr_write_b32 a104, 0
    v_accvgpr_write_b32 a105, 0
    v_accvgpr_write_b32 a106, 0
    v_accvgpr_write_b32 a107, 0
    v_accvgpr_write_b32 a108, 0
    v_accvgpr_write_b32 a109, 0
    v_accvgpr_write_b32 a110, 0
    v_accvgpr_write_b32 a111, 0
    v_accvgpr_write_b32 a112, 0
    v_accvgpr_write_b32 a113, 0
    v_accvgpr_write_b32 a114, 0
    v_accvgpr_write_b32 a115, 0
    v_accvgpr_write_b32 a116, 0
    v_accvgpr_write_b32 a117, 0
    v_accvgpr_write_b32 a118, 0
    v_accvgpr_write_b32 a119, 0
    v_accvgpr_write_b32 a120, 0
    v_accvgpr_write_b32 a121, 0
    v_accvgpr_write_b32 a122, 0
    v_accvgpr_write_b32 a123, 0
    v_accvgpr_write_b32 a124, 0
    v_accvgpr_write_b32 a125, 0
    v_accvgpr_write_b32 a126, 0
    v_accvgpr_write_b32 a127, 0
    s_mov_b32 s28, 0
L_slow_loop:
    s_add_u32 m0, s34, 0
    s_add_u32 s40, s28, 0
    buffer_load_dwordx4 v13, s[8:11], s40 offen offset:0 lds
    buffer_load_dwordx4 v14, s[8:11], s40 offen offset:1024 lds
    buffer_load_dwordx4 v15, s[8:11], s40 offen offset:2048 lds
    buffer_load_dwordx4 v16, s[8:11], s40 offen offset:3072 lds
    s_add_u32 m0, s34, 4096
    s_add_u32 s40, s28, 4096
    buffer_load_dwordx4 v13, s[8:11], s40 offen offset:0 lds
    buffer_load_dwordx4 v14, s[8:11], s40 offen offset:1024 lds
    buffer_load_dwordx4 v15, s[8:11], s40 offen offset:2048 lds
    buffer_load_dwordx4 v16, s[8:11], s40 offen offset:3072 lds
    s_waitcnt vmcnt(0)
    ds_read_b128 v[148:151], v1 offset:0
    ds_read_b128 v[152:155], v2 offset:0
    ds_read_b128 v[156:159], v3 offset:0
    ds_read_b128 v[160:163], v4 offset:0
    ds_read_b128 v[164:167], v1 offset:4096
    ds_read_b128 v[168:171], v2 offset:4096
    ds_read_b128 v[172:175], v3 offset:4096
    ds_read_b128 v[176:179], v4 offset:4096
    s_waitcnt lgkmcnt(0)
    s_add_u32 m0, s34, 0
    s_add_u32 s40, s28, 0
    buffer_load_dwordx4 v17, s[12:15], s40 offen offset:0 lds
    buffer_load_dwordx4 v18, s[12:15], s40 offen offset:1024 lds
    buffer_load_dwordx4 v17, s[12:15], s40 offen offset:2048 lds
    buffer_load_dwordx4 v18, s[12:15], s40 offen offset:3072 lds
    s_add_u32 m0, s34, 4096
    s_add_u32 s40, s28, 4096
    buffer_load_dwordx4 v17, s[12:15], s40 offen offset:0 lds
    buffer_load_dwordx4 v18, s[12:15], s40 offen offset:1024 lds
    buffer_load_dwordx4 v17, s[12:15], s40 offen offset:2048 lds
    buffer_load_dwordx4 v18, s[12:15], s40 offen offset:3072 lds
    s_waitcnt vmcnt(0)
    ds_read_b64_tr_b16 v[196:197], v5 offset:0
    ds_read_b64_tr_b16 v[198:199], v5 offset:4096
    ds_read_b64_tr_b16 v[200:201], v6 offset:0
    ds_read_b64_tr_b16 v[202:203], v6 offset:4096
    ds_read_b64_tr_b16 v[204:205], v7 offset:0
    ds_read_b64_tr_b16 v[206:207], v7 offset:4096
    ds_read_b64_tr_b16 v[208:209], v8 offset:0
    ds_read_b64_tr_b16 v[210:211], v8 offset:4096
    ds_read_b64_tr_b16 v[228:229], v9 offset:0
    ds_read_b64_tr_b16 v[230:231], v9 offset:4096
    ds_read_b64_tr_b16 v[232:233], v10 offset:0
    ds_read_b64_tr_b16 v[234:235], v10 offset:4096
    ds_read_b64_tr_b16 v[236:237], v11 offset:0
    ds_read_b64_tr_b16 v[238:239], v11 offset:4096
    ds_read_b64_tr_b16 v[240:241], v12 offset:0
    ds_read_b64_tr_b16 v[242:243], v12 offset:4096
    v_mfma_f32_16x16x32_bf16 v[116:119], v[148:151], v[36:39], 0
    v_mfma_f32_16x16x32_bf16 v[116:119], v[152:155], v[40:43], v[116:119]
    v_mfma_f32_16x16x32_bf16 v[116:119], v[156:159], v[44:47], v[116:119]
    v_mfma_f32_16x16x32_bf16 v[116:119], v[160:163], v[48:51], v[116:119]
    v_mfma_f32_16x16x32_bf16 v[132:135], v[164:167], v[36:39], 0
    v_mfma_f32_16x16x32_bf16 v[132:135], v[168:171], v[40:43], v[132:135]
    v_mfma_f32_16x16x32_bf16 v[132:135], v[172:175], v[44:47], v[132:135]
    v_mfma_f32_16x16x32_bf16 v[132:135], v[176:179], v[48:51], v[132:135]
    v_mfma_f32_16x16x32_bf16 v[120:123], v[160:163], v[64:67], 0
    v_mfma_f32_16x16x32_bf16 v[120:123], v[156:159], v[60:63], v[120:123]
    v_mfma_f32_16x16x32_bf16 v[120:123], v[152:155], v[56:59], v[120:123]
    v_mfma_f32_16x16x32_bf16 v[120:123], v[148:151], v[52:55], v[120:123]
    v_mfma_f32_16x16x32_bf16 v[136:139], v[176:179], v[64:67], 0
    v_mfma_f32_16x16x32_bf16 v[136:139], v[172:175], v[60:63], v[136:139]
    v_mfma_f32_16x16x32_bf16 v[136:139], v[168:171], v[56:59], v[136:139]
    v_mfma_f32_16x16x32_bf16 v[136:139], v[164:167], v[52:55], v[136:139]
    v_mfma_f32_16x16x32_bf16 v[124:127], v[148:151], v[68:71], 0
    v_mfma_f32_16x16x32_bf16 v[124:127], v[152:155], v[72:75], v[124:127]
    v_mfma_f32_16x16x32_bf16 v[124:127], v[156:159], v[76:79], v[124:127]
    v_mfma_f32_16x16x32_bf16 v[124:127], v[160:163], v[80:83], v[124:127]
    v_mfma_f32_16x16x32_bf16 v[140:143], v[164:167], v[68:71], 0
    v_mfma_f32_16x16x32_bf16 v[140:143], v[168:171], v[72:75], v[140:143]
    v_mfma_f32_16x16x32_bf16 v[140:143], v[172:175], v[76:79], v[140:143]
    v_mfma_f32_16x16x32_bf16 v[140:143], v[176:179], v[80:83], v[140:143]
    v_mfma_f32_16x16x32_bf16 v[128:131], v[160:163], v[96:99], 0
    v_mfma_f32_16x16x32_bf16 v[128:131], v[156:159], v[92:95], v[128:131]
    v_mfma_f32_16x16x32_bf16 v[128:131], v[152:155], v[88:91], v[128:131]
    v_mfma_f32_16x16x32_bf16 v[128:131], v[148:151], v[84:87], v[128:131]
    v_mfma_f32_16x16x32_bf16 v[144:147], v[176:179], v[96:99], 0
    v_mfma_f32_16x16x32_bf16 v[144:147], v[172:175], v[92:95], v[144:147]
    v_mfma_f32_16x16x32_bf16 v[144:147], v[168:171], v[88:91], v[144:147]
    v_mfma_f32_16x16x32_bf16 v[144:147], v[164:167], v[84:87], v[144:147]
    s_waitcnt lgkmcnt(0)
    s_nop 7
    v_max3_f32 v224, v116, v117, v118
    v_max3_f32 v224, v224, v119, v132
    v_max3_f32 v224, v224, v133, v134
    v_max3_f32 v224, v224, v135, v212
    v_mov_b32 v225, v224
    s_nop 1
    v_permlane32_swap_b32 v224, v225
    v_max_f32 v224, v224, v225
    v_mov_b32 v225, v224
    s_nop 1
    v_permlane16_swap_b32 v224, v225
    v_max_f32 v224, v224, v225
    v_sub_f32 v220, v212, v224
    v_exp_f32 v220, v220
    v_mov_b32 v212, v224
    v_sub_f32 v116, v116, v224
    v_sub_f32 v117, v117, v224
    v_sub_f32 v118, v118, v224
    v_sub_f32 v119, v119, v224
    v_sub_f32 v132, v132, v224
    v_sub_f32 v133, v133, v224
    v_sub_f32 v134, v134, v224
    v_sub_f32 v135, v135, v224
    v_mul_f32 v216, v216, v220
    v_exp_f32 v116, v116
    v_exp_f32 v117, v117
    v_exp_f32 v118, v118
    v_exp_f32 v119, v119
    v_exp_f32 v132, v132
    v_exp_f32 v133, v133
    v_exp_f32 v134, v134
    v_exp_f32 v135, v135
    v_accvgpr_read_b32 v224, a0
    v_accvgpr_read_b32 v225, a1
    v_accvgpr_read_b32 v226, a2
    v_accvgpr_read_b32 v227, a3
    v_mul_f32 v224, v224, v220
    v_mul_f32 v225, v225, v220
    v_mul_f32 v226, v226, v220
    v_mul_f32 v227, v227, v220
    v_accvgpr_write_b32 a0, v224
    v_accvgpr_write_b32 a1, v225
    v_accvgpr_write_b32 a2, v226
    v_accvgpr_write_b32 a3, v227
    v_accvgpr_read_b32 v224, a16
    v_accvgpr_read_b32 v225, a17
    v_accvgpr_read_b32 v226, a18
    v_accvgpr_read_b32 v227, a19
    v_mul_f32 v224, v224, v220
    v_mul_f32 v225, v225, v220
    v_mul_f32 v226, v226, v220
    v_mul_f32 v227, v227, v220
    v_accvgpr_write_b32 a16, v224
    v_accvgpr_write_b32 a17, v225
    v_accvgpr_write_b32 a18, v226
    v_accvgpr_write_b32 a19, v227
    v_accvgpr_read_b32 v224, a32
    v_accvgpr_read_b32 v225, a33
    v_accvgpr_read_b32 v226, a34
    v_accvgpr_read_b32 v227, a35
    v_mul_f32 v224, v224, v220
    v_mul_f32 v225, v225, v220
    v_mul_f32 v226, v226, v220
    v_mul_f32 v227, v227, v220
    v_accvgpr_write_b32 a32, v224
    v_accvgpr_write_b32 a33, v225
    v_accvgpr_write_b32 a34, v226
    v_accvgpr_write_b32 a35, v227
    v_accvgpr_read_b32 v224, a48
    v_accvgpr_read_b32 v225, a49
    v_accvgpr_read_b32 v226, a50
    v_accvgpr_read_b32 v227, a51
    v_mul_f32 v224, v224, v220
    v_mul_f32 v225, v225, v220
    v_mul_f32 v226, v226, v220
    v_mul_f32 v227, v227, v220
    v_accvgpr_write_b32 a48, v224
    v_accvgpr_write_b32 a49, v225
    v_accvgpr_write_b32 a50, v226
    v_accvgpr_write_b32 a51, v227
    v_accvgpr_read_b32 v224, a64
    v_accvgpr_read_b32 v225, a65
    v_accvgpr_read_b32 v226, a66
    v_accvgpr_read_b32 v227, a67
    v_mul_f32 v224, v224, v220
    v_mul_f32 v225, v225, v220
    v_mul_f32 v226, v226, v220
    v_mul_f32 v227, v227, v220
    v_accvgpr_write_b32 a64, v224
    v_accvgpr_write_b32 a65, v225
    v_accvgpr_write_b32 a66, v226
    v_accvgpr_write_b32 a67, v227
    v_accvgpr_read_b32 v224, a80
    v_accvgpr_read_b32 v225, a81
    v_accvgpr_read_b32 v226, a82
    v_accvgpr_read_b32 v227, a83
    v_mul_f32 v224, v224, v220
    v_mul_f32 v225, v225, v220
    v_mul_f32 v226, v226, v220
    v_mul_f32 v227, v227, v220
    v_accvgpr_write_b32 a80, v224
    v_accvgpr_write_b32 a81, v225
    v_accvgpr_write_b32 a82, v226
    v_accvgpr_write_b32 a83, v227
    v_accvgpr_read_b32 v224, a96
    v_accvgpr_read_b32 v225, a97
    v_accvgpr_read_b32 v226, a98
    v_accvgpr_read_b32 v227, a99
    v_mul_f32 v224, v224, v220
    v_mul_f32 v225, v225, v220
    v_mul_f32 v226, v226, v220
    v_mul_f32 v227, v227, v220
    v_accvgpr_write_b32 a96, v224
    v_accvgpr_write_b32 a97, v225
    v_accvgpr_write_b32 a98, v226
    v_accvgpr_write_b32 a99, v227
    v_accvgpr_read_b32 v224, a112
    v_accvgpr_read_b32 v225, a113
    v_accvgpr_read_b32 v226, a114
    v_accvgpr_read_b32 v227, a115
    v_mul_f32 v224, v224, v220
    v_mul_f32 v225, v225, v220
    v_mul_f32 v226, v226, v220
    v_mul_f32 v227, v227, v220
    v_accvgpr_write_b32 a112, v224
    v_accvgpr_write_b32 a113, v225
    v_accvgpr_write_b32 a114, v226
    v_accvgpr_write_b32 a115, v227
    v_add_f32 v216, v216, v116
    v_add_f32 v216, v216, v117
    v_add_f32 v216, v216, v118
    v_add_f32 v216, v216, v119
    v_add_f32 v216, v216, v132
    v_add_f32 v216, v216, v133
    v_add_f32 v216, v216, v134
    v_add_f32 v216, v216, v135
    v_cvt_pk_bf16_f32 v180, v116, v117
    v_cvt_pk_bf16_f32 v181, v118, v119
    v_cvt_pk_bf16_f32 v182, v132, v133
    v_cvt_pk_bf16_f32 v183, v134, v135
    s_nop 1
    v_mfma_f32_16x16x32_bf16 a[0:3], v[196:199], v[180:183], a[0:3]
    v_mfma_f32_16x16x32_bf16 a[16:19], v[200:203], v[180:183], a[16:19]
    v_mfma_f32_16x16x32_bf16 a[32:35], v[204:207], v[180:183], a[32:35]
    v_mfma_f32_16x16x32_bf16 a[48:51], v[208:211], v[180:183], a[48:51]
    v_mfma_f32_16x16x32_bf16 a[64:67], v[228:231], v[180:183], a[64:67]
    v_mfma_f32_16x16x32_bf16 a[80:83], v[232:235], v[180:183], a[80:83]
    v_mfma_f32_16x16x32_bf16 a[96:99], v[236:239], v[180:183], a[96:99]
    v_mfma_f32_16x16x32_bf16 a[112:115], v[240:243], v[180:183], a[112:115]
    v_max3_f32 v224, v120, v121, v122
    v_max3_f32 v224, v224, v123, v136
    v_max3_f32 v224, v224, v137, v138
    v_max3_f32 v224, v224, v139, v213
    v_mov_b32 v225, v224
    s_nop 1
    v_permlane32_swap_b32 v224, v225
    v_max_f32 v224, v224, v225
    v_mov_b32 v225, v224
    s_nop 1
    v_permlane16_swap_b32 v224, v225
    v_max_f32 v224, v224, v225
    v_sub_f32 v220, v213, v224
    v_exp_f32 v220, v220
    v_mov_b32 v213, v224
    v_sub_f32 v120, v120, v224
    v_sub_f32 v121, v121, v224
    v_sub_f32 v122, v122, v224
    v_sub_f32 v123, v123, v224
    v_sub_f32 v136, v136, v224
    v_sub_f32 v137, v137, v224
    v_sub_f32 v138, v138, v224
    v_sub_f32 v139, v139, v224
    v_mul_f32 v217, v217, v220
    v_exp_f32 v120, v120
    v_exp_f32 v121, v121
    v_exp_f32 v122, v122
    v_exp_f32 v123, v123
    v_exp_f32 v136, v136
    v_exp_f32 v137, v137
    v_exp_f32 v138, v138
    v_exp_f32 v139, v139
    v_accvgpr_read_b32 v224, a4
    v_accvgpr_read_b32 v225, a5
    v_accvgpr_read_b32 v226, a6
    v_accvgpr_read_b32 v227, a7
    v_mul_f32 v224, v224, v220
    v_mul_f32 v225, v225, v220
    v_mul_f32 v226, v226, v220
    v_mul_f32 v227, v227, v220
    v_accvgpr_write_b32 a4, v224
    v_accvgpr_write_b32 a5, v225
    v_accvgpr_write_b32 a6, v226
    v_accvgpr_write_b32 a7, v227
    v_accvgpr_read_b32 v224, a20
    v_accvgpr_read_b32 v225, a21
    v_accvgpr_read_b32 v226, a22
    v_accvgpr_read_b32 v227, a23
    v_mul_f32 v224, v224, v220
    v_mul_f32 v225, v225, v220
    v_mul_f32 v226, v226, v220
    v_mul_f32 v227, v227, v220
    v_accvgpr_write_b32 a20, v224
    v_accvgpr_write_b32 a21, v225
    v_accvgpr_write_b32 a22, v226
    v_accvgpr_write_b32 a23, v227
    v_accvgpr_read_b32 v224, a36
    v_accvgpr_read_b32 v225, a37
    v_accvgpr_read_b32 v226, a38
    v_accvgpr_read_b32 v227, a39
    v_mul_f32 v224, v224, v220
    v_mul_f32 v225, v225, v220
    v_mul_f32 v226, v226, v220
    v_mul_f32 v227, v227, v220
    v_accvgpr_write_b32 a36, v224
    v_accvgpr_write_b32 a37, v225
    v_accvgpr_write_b32 a38, v226
    v_accvgpr_write_b32 a39, v227
    v_accvgpr_read_b32 v224, a52
    v_accvgpr_read_b32 v225, a53
    v_accvgpr_read_b32 v226, a54
    v_accvgpr_read_b32 v227, a55
    v_mul_f32 v224, v224, v220
    v_mul_f32 v225, v225, v220
    v_mul_f32 v226, v226, v220
    v_mul_f32 v227, v227, v220
    v_accvgpr_write_b32 a52, v224
    v_accvgpr_write_b32 a53, v225
    v_accvgpr_write_b32 a54, v226
    v_accvgpr_write_b32 a55, v227
    v_accvgpr_read_b32 v224, a68
    v_accvgpr_read_b32 v225, a69
    v_accvgpr_read_b32 v226, a70
    v_accvgpr_read_b32 v227, a71
    v_mul_f32 v224, v224, v220
    v_mul_f32 v225, v225, v220
    v_mul_f32 v226, v226, v220
    v_mul_f32 v227, v227, v220
    v_accvgpr_write_b32 a68, v224
    v_accvgpr_write_b32 a69, v225
    v_accvgpr_write_b32 a70, v226
    v_accvgpr_write_b32 a71, v227
    v_accvgpr_read_b32 v224, a84
    v_accvgpr_read_b32 v225, a85
    v_accvgpr_read_b32 v226, a86
    v_accvgpr_read_b32 v227, a87
    v_mul_f32 v224, v224, v220
    v_mul_f32 v225, v225, v220
    v_mul_f32 v226, v226, v220
    v_mul_f32 v227, v227, v220
    v_accvgpr_write_b32 a84, v224
    v_accvgpr_write_b32 a85, v225
    v_accvgpr_write_b32 a86, v226
    v_accvgpr_write_b32 a87, v227
    v_accvgpr_read_b32 v224, a100
    v_accvgpr_read_b32 v225, a101
    v_accvgpr_read_b32 v226, a102
    v_accvgpr_read_b32 v227, a103
    v_mul_f32 v224, v224, v220
    v_mul_f32 v225, v225, v220
    v_mul_f32 v226, v226, v220
    v_mul_f32 v227, v227, v220
    v_accvgpr_write_b32 a100, v224
    v_accvgpr_write_b32 a101, v225
    v_accvgpr_write_b32 a102, v226
    v_accvgpr_write_b32 a103, v227
    v_accvgpr_read_b32 v224, a116
    v_accvgpr_read_b32 v225, a117
    v_accvgpr_read_b32 v226, a118
    v_accvgpr_read_b32 v227, a119
    v_mul_f32 v224, v224, v220
    v_mul_f32 v225, v225, v220
    v_mul_f32 v226, v226, v220
    v_mul_f32 v227, v227, v220
    v_accvgpr_write_b32 a116, v224
    v_accvgpr_write_b32 a117, v225
    v_accvgpr_write_b32 a118, v226
    v_accvgpr_write_b32 a119, v227
    v_add_f32 v217, v217, v120
    v_add_f32 v217, v217, v121
    v_add_f32 v217, v217, v122
    v_add_f32 v217, v217, v123
    v_add_f32 v217, v217, v136
    v_add_f32 v217, v217, v137
    v_add_f32 v217, v217, v138
    v_add_f32 v217, v217, v139
    v_cvt_pk_bf16_f32 v184, v120, v121
    v_cvt_pk_bf16_f32 v185, v122, v123
    v_cvt_pk_bf16_f32 v186, v136, v137
    v_cvt_pk_bf16_f32 v187, v138, v139
    s_nop 1
    v_mfma_f32_16x16x32_bf16 a[4:7], v[196:199], v[184:187], a[4:7]
    v_mfma_f32_16x16x32_bf16 a[20:23], v[200:203], v[184:187], a[20:23]
    v_mfma_f32_16x16x32_bf16 a[36:39], v[204:207], v[184:187], a[36:39]
    v_mfma_f32_16x16x32_bf16 a[52:55], v[208:211], v[184:187], a[52:55]
    v_mfma_f32_16x16x32_bf16 a[68:71], v[228:231], v[184:187], a[68:71]
    v_mfma_f32_16x16x32_bf16 a[84:87], v[232:235], v[184:187], a[84:87]
    v_mfma_f32_16x16x32_bf16 a[100:103], v[236:239], v[184:187], a[100:103]
    v_mfma_f32_16x16x32_bf16 a[116:119], v[240:243], v[184:187], a[116:119]
    v_max3_f32 v224, v124, v125, v126
    v_max3_f32 v224, v224, v127, v140
    v_max3_f32 v224, v224, v141, v142
    v_max3_f32 v224, v224, v143, v214
    v_mov_b32 v225, v224
    s_nop 1
    v_permlane32_swap_b32 v224, v225
    v_max_f32 v224, v224, v225
    v_mov_b32 v225, v224
    s_nop 1
    v_permlane16_swap_b32 v224, v225
    v_max_f32 v224, v224, v225
    v_sub_f32 v220, v214, v224
    v_exp_f32 v220, v220
    v_mov_b32 v214, v224
    v_sub_f32 v124, v124, v224
    v_sub_f32 v125, v125, v224
    v_sub_f32 v126, v126, v224
    v_sub_f32 v127, v127, v224
    v_sub_f32 v140, v140, v224
    v_sub_f32 v141, v141, v224
    v_sub_f32 v142, v142, v224
    v_sub_f32 v143, v143, v224
    v_mul_f32 v218, v218, v220
    v_exp_f32 v124, v124
    v_exp_f32 v125, v125
    v_exp_f32 v126, v126
    v_exp_f32 v127, v127
    v_exp_f32 v140, v140
    v_exp_f32 v141, v141
    v_exp_f32 v142, v142
    v_exp_f32 v143, v143
    v_accvgpr_read_b32 v224, a8
    v_accvgpr_read_b32 v225, a9
    v_accvgpr_read_b32 v226, a10
    v_accvgpr_read_b32 v227, a11
    v_mul_f32 v224, v224, v220
    v_mul_f32 v225, v225, v220
    v_mul_f32 v226, v226, v220
    v_mul_f32 v227, v227, v220
    v_accvgpr_write_b32 a8, v224
    v_accvgpr_write_b32 a9, v225
    v_accvgpr_write_b32 a10, v226
    v_accvgpr_write_b32 a11, v227
    v_accvgpr_read_b32 v224, a24
    v_accvgpr_read_b32 v225, a25
    v_accvgpr_read_b32 v226, a26
    v_accvgpr_read_b32 v227, a27
    v_mul_f32 v224, v224, v220
    v_mul_f32 v225, v225, v220
    v_mul_f32 v226, v226, v220
    v_mul_f32 v227, v227, v220
    v_accvgpr_write_b32 a24, v224
    v_accvgpr_write_b32 a25, v225
    v_accvgpr_write_b32 a26, v226
    v_accvgpr_write_b32 a27, v227
    v_accvgpr_read_b32 v224, a40
    v_accvgpr_read_b32 v225, a41
    v_accvgpr_read_b32 v226, a42
    v_accvgpr_read_b32 v227, a43
    v_mul_f32 v224, v224, v220
    v_mul_f32 v225, v225, v220
    v_mul_f32 v226, v226, v220
    v_mul_f32 v227, v227, v220
    v_accvgpr_write_b32 a40, v224
    v_accvgpr_write_b32 a41, v225
    v_accvgpr_write_b32 a42, v226
    v_accvgpr_write_b32 a43, v227
    v_accvgpr_read_b32 v224, a56
    v_accvgpr_read_b32 v225, a57
    v_accvgpr_read_b32 v226, a58
    v_accvgpr_read_b32 v227, a59
    v_mul_f32 v224, v224, v220
    v_mul_f32 v225, v225, v220
    v_mul_f32 v226, v226, v220
    v_mul_f32 v227, v227, v220
    v_accvgpr_write_b32 a56, v224
    v_accvgpr_write_b32 a57, v225
    v_accvgpr_write_b32 a58, v226
    v_accvgpr_write_b32 a59, v227
    v_accvgpr_read_b32 v224, a72
    v_accvgpr_read_b32 v225, a73
    v_accvgpr_read_b32 v226, a74
    v_accvgpr_read_b32 v227, a75
    v_mul_f32 v224, v224, v220
    v_mul_f32 v225, v225, v220
    v_mul_f32 v226, v226, v220
    v_mul_f32 v227, v227, v220
    v_accvgpr_write_b32 a72, v224
    v_accvgpr_write_b32 a73, v225
    v_accvgpr_write_b32 a74, v226
    v_accvgpr_write_b32 a75, v227
    v_accvgpr_read_b32 v224, a88
    v_accvgpr_read_b32 v225, a89
    v_accvgpr_read_b32 v226, a90
    v_accvgpr_read_b32 v227, a91
    v_mul_f32 v224, v224, v220
    v_mul_f32 v225, v225, v220
    v_mul_f32 v226, v226, v220
    v_mul_f32 v227, v227, v220
    v_accvgpr_write_b32 a88, v224
    v_accvgpr_write_b32 a89, v225
    v_accvgpr_write_b32 a90, v226
    v_accvgpr_write_b32 a91, v227
    v_accvgpr_read_b32 v224, a104
    v_accvgpr_read_b32 v225, a105
    v_accvgpr_read_b32 v226, a106
    v_accvgpr_read_b32 v227, a107
    v_mul_f32 v224, v224, v220
    v_mul_f32 v225, v225, v220
    v_mul_f32 v226, v226, v220
    v_mul_f32 v227, v227, v220
    v_accvgpr_write_b32 a104, v224
    v_accvgpr_write_b32 a105, v225
    v_accvgpr_write_b32 a106, v226
    v_accvgpr_write_b32 a107, v227
    v_accvgpr_read_b32 v224, a120
    v_accvgpr_read_b32 v225, a121
    v_accvgpr_read_b32 v226, a122
    v_accvgpr_read_b32 v227, a123
    v_mul_f32 v224, v224, v220
    v_mul_f32 v225, v225, v220
    v_mul_f32 v226, v226, v220
    v_mul_f32 v227, v227, v220
    v_accvgpr_write_b32 a120, v224
    v_accvgpr_write_b32 a121, v225
    v_accvgpr_write_b32 a122, v226
    v_accvgpr_write_b32 a123, v227
    v_add_f32 v218, v218, v124
    v_add_f32 v218, v218, v125
    v_add_f32 v218, v218, v126
    v_add_f32 v218, v218, v127
    v_add_f32 v218, v218, v140
    v_add_f32 v218, v218, v141
    v_add_f32 v218, v218, v142
    v_add_f32 v218, v218, v143
    v_cvt_pk_bf16_f32 v188, v124, v125
    v_cvt_pk_bf16_f32 v189, v126, v127
    v_cvt_pk_bf16_f32 v190, v140, v141
    v_cvt_pk_bf16_f32 v191, v142, v143
    s_nop 1
    v_mfma_f32_16x16x32_bf16 a[8:11], v[196:199], v[188:191], a[8:11]
    v_mfma_f32_16x16x32_bf16 a[24:27], v[200:203], v[188:191], a[24:27]
    v_mfma_f32_16x16x32_bf16 a[40:43], v[204:207], v[188:191], a[40:43]
    v_mfma_f32_16x16x32_bf16 a[56:59], v[208:211], v[188:191], a[56:59]
    v_mfma_f32_16x16x32_bf16 a[72:75], v[228:231], v[188:191], a[72:75]
    v_mfma_f32_16x16x32_bf16 a[88:91], v[232:235], v[188:191], a[88:91]
    v_mfma_f32_16x16x32_bf16 a[104:107], v[236:239], v[188:191], a[104:107]
    v_mfma_f32_16x16x32_bf16 a[120:123], v[240:243], v[188:191], a[120:123]
    v_max3_f32 v224, v128, v129, v130
    v_max3_f32 v224, v224, v131, v144
    v_max3_f32 v224, v224, v145, v146
    v_max3_f32 v224, v224, v147, v215
    v_mov_b32 v225, v224
    s_nop 1
    v_permlane32_swap_b32 v224, v225
    v_max_f32 v224, v224, v225
    v_mov_b32 v225, v224
    s_nop 1
    v_permlane16_swap_b32 v224, v225
    v_max_f32 v224, v224, v225
    v_sub_f32 v220, v215, v224
    v_exp_f32 v220, v220
    v_mov_b32 v215, v224
    v_sub_f32 v128, v128, v224
    v_sub_f32 v129, v129, v224
    v_sub_f32 v130, v130, v224
    v_sub_f32 v131, v131, v224
    v_sub_f32 v144, v144, v224
    v_sub_f32 v145, v145, v224
    v_sub_f32 v146, v146, v224
    v_sub_f32 v147, v147, v224
    v_mul_f32 v219, v219, v220
    v_exp_f32 v128, v128
    v_exp_f32 v129, v129
    v_exp_f32 v130, v130
    v_exp_f32 v131, v131
    v_exp_f32 v144, v144
    v_exp_f32 v145, v145
    v_exp_f32 v146, v146
    v_exp_f32 v147, v147
    v_accvgpr_read_b32 v224, a12
    v_accvgpr_read_b32 v225, a13
    v_accvgpr_read_b32 v226, a14
    v_accvgpr_read_b32 v227, a15
    v_mul_f32 v224, v224, v220
    v_mul_f32 v225, v225, v220
    v_mul_f32 v226, v226, v220
    v_mul_f32 v227, v227, v220
    v_accvgpr_write_b32 a12, v224
    v_accvgpr_write_b32 a13, v225
    v_accvgpr_write_b32 a14, v226
    v_accvgpr_write_b32 a15, v227
    v_accvgpr_read_b32 v224, a28
    v_accvgpr_read_b32 v225, a29
    v_accvgpr_read_b32 v226, a30
    v_accvgpr_read_b32 v227, a31
    v_mul_f32 v224, v224, v220
    v_mul_f32 v225, v225, v220
    v_mul_f32 v226, v226, v220
    v_mul_f32 v227, v227, v220
    v_accvgpr_write_b32 a28, v224
    v_accvgpr_write_b32 a29, v225
    v_accvgpr_write_b32 a30, v226
    v_accvgpr_write_b32 a31, v227
    v_accvgpr_read_b32 v224, a44
    v_accvgpr_read_b32 v225, a45
    v_accvgpr_read_b32 v226, a46
    v_accvgpr_read_b32 v227, a47
    v_mul_f32 v224, v224, v220
    v_mul_f32 v225, v225, v220
    v_mul_f32 v226, v226, v220
    v_mul_f32 v227, v227, v220
    v_accvgpr_write_b32 a44, v224
    v_accvgpr_write_b32 a45, v225
    v_accvgpr_write_b32 a46, v226
    v_accvgpr_write_b32 a47, v227
    v_accvgpr_read_b32 v224, a60
    v_accvgpr_read_b32 v225, a61
    v_accvgpr_read_b32 v226, a62
    v_accvgpr_read_b32 v227, a63
    v_mul_f32 v224, v224, v220
    v_mul_f32 v225, v225, v220
    v_mul_f32 v226, v226, v220
    v_mul_f32 v227, v227, v220
    v_accvgpr_write_b32 a60, v224
    v_accvgpr_write_b32 a61, v225
    v_accvgpr_write_b32 a62, v226
    v_accvgpr_write_b32 a63, v227
    v_accvgpr_read_b32 v224, a76
    v_accvgpr_read_b32 v225, a77
    v_accvgpr_read_b32 v226, a78
    v_accvgpr_read_b32 v227, a79
    v_mul_f32 v224, v224, v220
    v_mul_f32 v225, v225, v220
    v_mul_f32 v226, v226, v220
    v_mul_f32 v227, v227, v220
    v_accvgpr_write_b32 a76, v224
    v_accvgpr_write_b32 a77, v225
    v_accvgpr_write_b32 a78, v226
    v_accvgpr_write_b32 a79, v227
    v_accvgpr_read_b32 v224, a92
    v_accvgpr_read_b32 v225, a93
    v_accvgpr_read_b32 v226, a94
    v_accvgpr_read_b32 v227, a95
    v_mul_f32 v224, v224, v220
    v_mul_f32 v225, v225, v220
    v_mul_f32 v226, v226, v220
    v_mul_f32 v227, v227, v220
    v_accvgpr_write_b32 a92, v224
    v_accvgpr_write_b32 a93, v225
    v_accvgpr_write_b32 a94, v226
    v_accvgpr_write_b32 a95, v227
    v_accvgpr_read_b32 v224, a108
    v_accvgpr_read_b32 v225, a109
    v_accvgpr_read_b32 v226, a110
    v_accvgpr_read_b32 v227, a111
    v_mul_f32 v224, v224, v220
    v_mul_f32 v225, v225, v220
    v_mul_f32 v226, v226, v220
    v_mul_f32 v227, v227, v220
    v_accvgpr_write_b32 a108, v224
    v_accvgpr_write_b32 a109, v225
    v_accvgpr_write_b32 a110, v226
    v_accvgpr_write_b32 a111, v227
    v_accvgpr_read_b32 v224, a124
    v_accvgpr_read_b32 v225, a125
    v_accvgpr_read_b32 v226, a126
    v_accvgpr_read_b32 v227, a127
    v_mul_f32 v224, v224, v220
    v_mul_f32 v225, v225, v220
    v_mul_f32 v226, v226, v220
    v_mul_f32 v227, v227, v220
    v_accvgpr_write_b32 a124, v224
    v_accvgpr_write_b32 a125, v225
    v_accvgpr_write_b32 a126, v226
    v_accvgpr_write_b32 a127, v227
    v_add_f32 v219, v219, v128
    v_add_f32 v219, v219, v129
    v_add_f32 v219, v219, v130
    v_add_f32 v219, v219, v131
    v_add_f32 v219, v219, v144
    v_add_f32 v219, v219, v145
    v_add_f32 v219, v219, v146
    v_add_f32 v219, v219, v147
    v_cvt_pk_bf16_f32 v192, v128, v129
    v_cvt_pk_bf16_f32 v193, v130, v131
    v_cvt_pk_bf16_f32 v194, v144, v145
    v_cvt_pk_bf16_f32 v195, v146, v147
    s_nop 1
    v_mfma_f32_16x16x32_bf16 a[12:15], v[196:199], v[192:195], a[12:15]
    v_mfma_f32_16x16x32_bf16 a[28:31], v[200:203], v[192:195], a[28:31]
    v_mfma_f32_16x16x32_bf16 a[44:47], v[204:207], v[192:195], a[44:47]
    v_mfma_f32_16x16x32_bf16 a[60:63], v[208:211], v[192:195], a[60:63]
    v_mfma_f32_16x16x32_bf16 a[76:79], v[228:231], v[192:195], a[76:79]
    v_mfma_f32_16x16x32_bf16 a[92:95], v[232:235], v[192:195], a[92:95]
    v_mfma_f32_16x16x32_bf16 a[108:111], v[236:239], v[192:195], a[108:111]
    v_mfma_f32_16x16x32_bf16 a[124:127], v[240:243], v[192:195], a[124:127]
    s_add_u32 s28, s28, 8192
    s_cmp_lt_u32 s28, 524288
    s_cbranch_scc1 L_slow_loop
    v_mov_b32 v224, v216
    s_nop 1
    v_permlane32_swap_b32 v216, v224
    v_add_f32 v216, v216, v224
    v_mov_b32 v224, v216
    s_nop 1
    v_permlane16_swap_b32 v216, v224
    v_add_f32 v216, v216, v224
    v_rcp_f32 v100, v216
    v_mov_b32 v224, v217
    s_nop 1
    v_permlane32_swap_b32 v217, v224
    v_add_f32 v217, v217, v224
    v_mov_b32 v224, v217
    s_nop 1
    v_permlane16_swap_b32 v217, v224
    v_add_f32 v217, v217, v224
    v_rcp_f32 v101, v217
    v_mov_b32 v224, v218
    s_nop 1
    v_permlane32_swap_b32 v218, v224
    v_add_f32 v218, v218, v224
    v_mov_b32 v224, v218
    s_nop 1
    v_permlane16_swap_b32 v218, v224
    v_add_f32 v218, v218, v224
    v_rcp_f32 v102, v218
    v_mov_b32 v224, v219
    s_nop 1
    v_permlane32_swap_b32 v219, v224
    v_add_f32 v219, v219, v224
    v_mov_b32 v224, v219
    s_nop 1
    v_permlane16_swap_b32 v219, v224
    v_add_f32 v219, v219, v224
    v_rcp_f32 v103, v219
    s_mov_b32 s36, 0
    v_accvgpr_read_b32 v120, a0
    v_accvgpr_read_b32 v121, a1
    v_accvgpr_read_b32 v122, a2
    v_accvgpr_read_b32 v123, a3
    v_accvgpr_read_b32 v124, a16
    v_accvgpr_read_b32 v125, a17
    v_accvgpr_read_b32 v126, a18
    v_accvgpr_read_b32 v127, a19
    v_mul_f32 v120, v120, v100
    v_mul_f32 v121, v121, v100
    v_mul_f32 v122, v122, v100
    v_mul_f32 v123, v123, v100
    v_mul_f32 v124, v124, v100
    v_mul_f32 v125, v125, v100
    v_mul_f32 v126, v126, v100
    v_mul_f32 v127, v127, v100
    v_cvt_pk_bf16_f32 v152, v120, v121
    v_cvt_pk_bf16_f32 v153, v122, v123
    v_cvt_pk_bf16_f32 v154, v124, v125
    v_cvt_pk_bf16_f32 v155, v126, v127
    buffer_store_dwordx4 v[152:155], v110, s[24:27], s36 offen offset:0 sc1
    v_accvgpr_read_b32 v128, a4
    v_accvgpr_read_b32 v129, a5
    v_accvgpr_read_b32 v130, a6
    v_accvgpr_read_b32 v131, a7
    v_accvgpr_read_b32 v132, a20
    v_accvgpr_read_b32 v133, a21
    v_accvgpr_read_b32 v134, a22
    v_accvgpr_read_b32 v135, a23
    v_mul_f32 v128, v128, v101
    v_mul_f32 v129, v129, v101
    v_mul_f32 v130, v130, v101
    v_mul_f32 v131, v131, v101
    v_mul_f32 v132, v132, v101
    v_mul_f32 v133, v133, v101
    v_mul_f32 v134, v134, v101
    v_mul_f32 v135, v135, v101
    v_cvt_pk_bf16_f32 v156, v128, v129
    v_cvt_pk_bf16_f32 v157, v130, v131
    v_cvt_pk_bf16_f32 v158, v132, v133
    v_cvt_pk_bf16_f32 v159, v134, v135
    buffer_store_dwordx4 v[156:159], v110, s[24:27], s36 offen offset:1024 sc1
    v_accvgpr_read_b32 v136, a8
    v_accvgpr_read_b32 v137, a9
    v_accvgpr_read_b32 v138, a10
    v_accvgpr_read_b32 v139, a11
    v_accvgpr_read_b32 v140, a24
    v_accvgpr_read_b32 v141, a25
    v_accvgpr_read_b32 v142, a26
    v_accvgpr_read_b32 v143, a27
    v_mul_f32 v136, v136, v102
    v_mul_f32 v137, v137, v102
    v_mul_f32 v138, v138, v102
    v_mul_f32 v139, v139, v102
    v_mul_f32 v140, v140, v102
    v_mul_f32 v141, v141, v102
    v_mul_f32 v142, v142, v102
    v_mul_f32 v143, v143, v102
    v_cvt_pk_bf16_f32 v160, v136, v137
    v_cvt_pk_bf16_f32 v161, v138, v139
    v_cvt_pk_bf16_f32 v162, v140, v141
    v_cvt_pk_bf16_f32 v163, v142, v143
    buffer_store_dwordx4 v[160:163], v110, s[24:27], s36 offen offset:2048 sc1
    v_accvgpr_read_b32 v144, a12
    v_accvgpr_read_b32 v145, a13
    v_accvgpr_read_b32 v146, a14
    v_accvgpr_read_b32 v147, a15
    v_accvgpr_read_b32 v148, a28
    v_accvgpr_read_b32 v149, a29
    v_accvgpr_read_b32 v150, a30
    v_accvgpr_read_b32 v151, a31
    v_mul_f32 v144, v144, v103
    v_mul_f32 v145, v145, v103
    v_mul_f32 v146, v146, v103
    v_mul_f32 v147, v147, v103
    v_mul_f32 v148, v148, v103
    v_mul_f32 v149, v149, v103
    v_mul_f32 v150, v150, v103
    v_mul_f32 v151, v151, v103
    v_cvt_pk_bf16_f32 v164, v144, v145
    v_cvt_pk_bf16_f32 v165, v146, v147
    v_cvt_pk_bf16_f32 v166, v148, v149
    v_cvt_pk_bf16_f32 v167, v150, v151
    buffer_store_dwordx4 v[164:167], v110, s[24:27], s36 offen offset:3072 sc1
    s_mov_b32 s36, 4096
    v_accvgpr_read_b32 v120, a32
    v_accvgpr_read_b32 v121, a33
    v_accvgpr_read_b32 v122, a34
    v_accvgpr_read_b32 v123, a35
    v_accvgpr_read_b32 v124, a48
    v_accvgpr_read_b32 v125, a49
    v_accvgpr_read_b32 v126, a50
    v_accvgpr_read_b32 v127, a51
    v_mul_f32 v120, v120, v100
    v_mul_f32 v121, v121, v100
    v_mul_f32 v122, v122, v100
    v_mul_f32 v123, v123, v100
    v_mul_f32 v124, v124, v100
    v_mul_f32 v125, v125, v100
    v_mul_f32 v126, v126, v100
    v_mul_f32 v127, v127, v100
    v_cvt_pk_bf16_f32 v152, v120, v121
    v_cvt_pk_bf16_f32 v153, v122, v123
    v_cvt_pk_bf16_f32 v154, v124, v125
    v_cvt_pk_bf16_f32 v155, v126, v127
    buffer_store_dwordx4 v[152:155], v110, s[24:27], s36 offen offset:0 sc1
    v_accvgpr_read_b32 v128, a36
    v_accvgpr_read_b32 v129, a37
    v_accvgpr_read_b32 v130, a38
    v_accvgpr_read_b32 v131, a39
    v_accvgpr_read_b32 v132, a52
    v_accvgpr_read_b32 v133, a53
    v_accvgpr_read_b32 v134, a54
    v_accvgpr_read_b32 v135, a55
    v_mul_f32 v128, v128, v101
    v_mul_f32 v129, v129, v101
    v_mul_f32 v130, v130, v101
    v_mul_f32 v131, v131, v101
    v_mul_f32 v132, v132, v101
    v_mul_f32 v133, v133, v101
    v_mul_f32 v134, v134, v101
    v_mul_f32 v135, v135, v101
    v_cvt_pk_bf16_f32 v156, v128, v129
    v_cvt_pk_bf16_f32 v157, v130, v131
    v_cvt_pk_bf16_f32 v158, v132, v133
    v_cvt_pk_bf16_f32 v159, v134, v135
    buffer_store_dwordx4 v[156:159], v110, s[24:27], s36 offen offset:1024 sc1
    v_accvgpr_read_b32 v136, a40
    v_accvgpr_read_b32 v137, a41
    v_accvgpr_read_b32 v138, a42
    v_accvgpr_read_b32 v139, a43
    v_accvgpr_read_b32 v140, a56
    v_accvgpr_read_b32 v141, a57
    v_accvgpr_read_b32 v142, a58
    v_accvgpr_read_b32 v143, a59
    v_mul_f32 v136, v136, v102
    v_mul_f32 v137, v137, v102
    v_mul_f32 v138, v138, v102
    v_mul_f32 v139, v139, v102
    v_mul_f32 v140, v140, v102
    v_mul_f32 v141, v141, v102
    v_mul_f32 v142, v142, v102
    v_mul_f32 v143, v143, v102
    v_cvt_pk_bf16_f32 v160, v136, v137
    v_cvt_pk_bf16_f32 v161, v138, v139
    v_cvt_pk_bf16_f32 v162, v140, v141
    v_cvt_pk_bf16_f32 v163, v142, v143
    buffer_store_dwordx4 v[160:163], v110, s[24:27], s36 offen offset:2048 sc1
    v_accvgpr_read_b32 v144, a44
    v_accvgpr_read_b32 v145, a45
    v_accvgpr_read_b32 v146, a46
    v_accvgpr_read_b32 v147, a47
    v_accvgpr_read_b32 v148, a60
    v_accvgpr_read_b32 v149, a61
    v_accvgpr_read_b32 v150, a62
    v_accvgpr_read_b32 v151, a63
    v_mul_f32 v144, v144, v103
    v_mul_f32 v145, v145, v103
    v_mul_f32 v146, v146, v103
    v_mul_f32 v147, v147, v103
    v_mul_f32 v148, v148, v103
    v_mul_f32 v149, v149, v103
    v_mul_f32 v150, v150, v103
    v_mul_f32 v151, v151, v103
    v_cvt_pk_bf16_f32 v164, v144, v145
    v_cvt_pk_bf16_f32 v165, v146, v147
    v_cvt_pk_bf16_f32 v166, v148, v149
    v_cvt_pk_bf16_f32 v167, v150, v151
    buffer_store_dwordx4 v[164:167], v110, s[24:27], s36 offen offset:3072 sc1
    s_mov_b32 s36, 8192
    v_accvgpr_read_b32 v120, a64
    v_accvgpr_read_b32 v121, a65
    v_accvgpr_read_b32 v122, a66
    v_accvgpr_read_b32 v123, a67
    v_accvgpr_read_b32 v124, a80
    v_accvgpr_read_b32 v125, a81
    v_accvgpr_read_b32 v126, a82
    v_accvgpr_read_b32 v127, a83
    v_mul_f32 v120, v120, v100
    v_mul_f32 v121, v121, v100
    v_mul_f32 v122, v122, v100
    v_mul_f32 v123, v123, v100
    v_mul_f32 v124, v124, v100
    v_mul_f32 v125, v125, v100
    v_mul_f32 v126, v126, v100
    v_mul_f32 v127, v127, v100
    v_cvt_pk_bf16_f32 v152, v120, v121
    v_cvt_pk_bf16_f32 v153, v122, v123
    v_cvt_pk_bf16_f32 v154, v124, v125
    v_cvt_pk_bf16_f32 v155, v126, v127
    buffer_store_dwordx4 v[152:155], v110, s[24:27], s36 offen offset:0 sc1
    v_accvgpr_read_b32 v128, a68
    v_accvgpr_read_b32 v129, a69
    v_accvgpr_read_b32 v130, a70
    v_accvgpr_read_b32 v131, a71
    v_accvgpr_read_b32 v132, a84
    v_accvgpr_read_b32 v133, a85
    v_accvgpr_read_b32 v134, a86
    v_accvgpr_read_b32 v135, a87
    v_mul_f32 v128, v128, v101
    v_mul_f32 v129, v129, v101
    v_mul_f32 v130, v130, v101
    v_mul_f32 v131, v131, v101
    v_mul_f32 v132, v132, v101
    v_mul_f32 v133, v133, v101
    v_mul_f32 v134, v134, v101
    v_mul_f32 v135, v135, v101
    v_cvt_pk_bf16_f32 v156, v128, v129
    v_cvt_pk_bf16_f32 v157, v130, v131
    v_cvt_pk_bf16_f32 v158, v132, v133
    v_cvt_pk_bf16_f32 v159, v134, v135
    buffer_store_dwordx4 v[156:159], v110, s[24:27], s36 offen offset:1024 sc1
    v_accvgpr_read_b32 v136, a72
    v_accvgpr_read_b32 v137, a73
    v_accvgpr_read_b32 v138, a74
    v_accvgpr_read_b32 v139, a75
    v_accvgpr_read_b32 v140, a88
    v_accvgpr_read_b32 v141, a89
    v_accvgpr_read_b32 v142, a90
    v_accvgpr_read_b32 v143, a91
    v_mul_f32 v136, v136, v102
    v_mul_f32 v137, v137, v102
    v_mul_f32 v138, v138, v102
    v_mul_f32 v139, v139, v102
    v_mul_f32 v140, v140, v102
    v_mul_f32 v141, v141, v102
    v_mul_f32 v142, v142, v102
    v_mul_f32 v143, v143, v102
    v_cvt_pk_bf16_f32 v160, v136, v137
    v_cvt_pk_bf16_f32 v161, v138, v139
    v_cvt_pk_bf16_f32 v162, v140, v141
    v_cvt_pk_bf16_f32 v163, v142, v143
    buffer_store_dwordx4 v[160:163], v110, s[24:27], s36 offen offset:2048 sc1
    v_accvgpr_read_b32 v144, a76
    v_accvgpr_read_b32 v145, a77
    v_accvgpr_read_b32 v146, a78
    v_accvgpr_read_b32 v147, a79
    v_accvgpr_read_b32 v148, a92
    v_accvgpr_read_b32 v149, a93
    v_accvgpr_read_b32 v150, a94
    v_accvgpr_read_b32 v151, a95
    v_mul_f32 v144, v144, v103
    v_mul_f32 v145, v145, v103
    v_mul_f32 v146, v146, v103
    v_mul_f32 v147, v147, v103
    v_mul_f32 v148, v148, v103
    v_mul_f32 v149, v149, v103
    v_mul_f32 v150, v150, v103
    v_mul_f32 v151, v151, v103
    v_cvt_pk_bf16_f32 v164, v144, v145
    v_cvt_pk_bf16_f32 v165, v146, v147
    v_cvt_pk_bf16_f32 v166, v148, v149
    v_cvt_pk_bf16_f32 v167, v150, v151
    buffer_store_dwordx4 v[164:167], v110, s[24:27], s36 offen offset:3072 sc1
    s_mov_b32 s36, 12288
    v_accvgpr_read_b32 v120, a96
    v_accvgpr_read_b32 v121, a97
    v_accvgpr_read_b32 v122, a98
    v_accvgpr_read_b32 v123, a99
    v_accvgpr_read_b32 v124, a112
    v_accvgpr_read_b32 v125, a113
    v_accvgpr_read_b32 v126, a114
    v_accvgpr_read_b32 v127, a115
    v_mul_f32 v120, v120, v100
    v_mul_f32 v121, v121, v100
    v_mul_f32 v122, v122, v100
    v_mul_f32 v123, v123, v100
    v_mul_f32 v124, v124, v100
    v_mul_f32 v125, v125, v100
    v_mul_f32 v126, v126, v100
    v_mul_f32 v127, v127, v100
    v_cvt_pk_bf16_f32 v152, v120, v121
    v_cvt_pk_bf16_f32 v153, v122, v123
    v_cvt_pk_bf16_f32 v154, v124, v125
    v_cvt_pk_bf16_f32 v155, v126, v127
    buffer_store_dwordx4 v[152:155], v110, s[24:27], s36 offen offset:0 sc1
    v_accvgpr_read_b32 v128, a100
    v_accvgpr_read_b32 v129, a101
    v_accvgpr_read_b32 v130, a102
    v_accvgpr_read_b32 v131, a103
    v_accvgpr_read_b32 v132, a116
    v_accvgpr_read_b32 v133, a117
    v_accvgpr_read_b32 v134, a118
    v_accvgpr_read_b32 v135, a119
    v_mul_f32 v128, v128, v101
    v_mul_f32 v129, v129, v101
    v_mul_f32 v130, v130, v101
    v_mul_f32 v131, v131, v101
    v_mul_f32 v132, v132, v101
    v_mul_f32 v133, v133, v101
    v_mul_f32 v134, v134, v101
    v_mul_f32 v135, v135, v101
    v_cvt_pk_bf16_f32 v156, v128, v129
    v_cvt_pk_bf16_f32 v157, v130, v131
    v_cvt_pk_bf16_f32 v158, v132, v133
    v_cvt_pk_bf16_f32 v159, v134, v135
    buffer_store_dwordx4 v[156:159], v110, s[24:27], s36 offen offset:1024 sc1
    v_accvgpr_read_b32 v136, a104
    v_accvgpr_read_b32 v137, a105
    v_accvgpr_read_b32 v138, a106
    v_accvgpr_read_b32 v139, a107
    v_accvgpr_read_b32 v140, a120
    v_accvgpr_read_b32 v141, a121
    v_accvgpr_read_b32 v142, a122
    v_accvgpr_read_b32 v143, a123
    v_mul_f32 v136, v136, v102
    v_mul_f32 v137, v137, v102
    v_mul_f32 v138, v138, v102
    v_mul_f32 v139, v139, v102
    v_mul_f32 v140, v140, v102
    v_mul_f32 v141, v141, v102
    v_mul_f32 v142, v142, v102
    v_mul_f32 v143, v143, v102
    v_cvt_pk_bf16_f32 v160, v136, v137
    v_cvt_pk_bf16_f32 v161, v138, v139
    v_cvt_pk_bf16_f32 v162, v140, v141
    v_cvt_pk_bf16_f32 v163, v142, v143
    buffer_store_dwordx4 v[160:163], v110, s[24:27], s36 offen offset:2048 sc1
    v_accvgpr_read_b32 v144, a108
    v_accvgpr_read_b32 v145, a109
    v_accvgpr_read_b32 v146, a110
    v_accvgpr_read_b32 v147, a111
    v_accvgpr_read_b32 v148, a124
    v_accvgpr_read_b32 v149, a125
    v_accvgpr_read_b32 v150, a126
    v_accvgpr_read_b32 v151, a127
    v_mul_f32 v144, v144, v103
    v_mul_f32 v145, v145, v103
    v_mul_f32 v146, v146, v103
    v_mul_f32 v147, v147, v103
    v_mul_f32 v148, v148, v103
    v_mul_f32 v149, v149, v103
    v_mul_f32 v150, v150, v103
    v_mul_f32 v151, v151, v103
    v_cvt_pk_bf16_f32 v164, v144, v145
    v_cvt_pk_bf16_f32 v165, v146, v147
    v_cvt_pk_bf16_f32 v166, v148, v149
    v_cvt_pk_bf16_f32 v167, v150, v151
    buffer_store_dwordx4 v[164:167], v110, s[24:27], s36 offen offset:3072 sc1
    s_branch L_published
L_spin_rows:
    s_mov_b32 s7, 32768
L_retry_rows:
    s_sleep 2
    buffer_load_dword v252, off, s[92:95], s74 sc1
    s_waitcnt vmcnt(0)
    v_cmp_gt_u32 vcc, 32, v252
    s_and_b64 vcc, vcc, exec
    s_cbranch_scc0 L_back_rows
    s_sub_u32 s7, s7, 1
    s_cbranch_scc0 L_retry_rows
    s_branch L_back_rows
L_spin_all:
    s_mov_b32 s7, 32768
L_retry_all:
    s_sleep 2
    buffer_load_dword v252, v253, s[92:95], 0 offen sc1
    s_waitcnt vmcnt(0)
    v_cmp_gt_u32 vcc, 32, v252
    s_and_b64 vcc, vcc, exec
    s_cbranch_scc0 L_back_all
    s_sub_u32 s7, s7, 1
    s_cbranch_scc0 L_retry_all
    s_branch L_back_all
L_rt_keys:
    s_lshl_b32 s40, s5, 13
    s_add_u32 s40, s40, 0x280008
    v_lshlrev_b32 v253, 4, v19
    buffer_load_dword v28, v253, s[76:79], s40 offen offset:0 sc1
    buffer_load_dword v29, v253, s[76:79], s40 offen offset:1024 sc1
    buffer_load_dword v30, v253, s[76:79], s40 offen offset:2048 sc1
    buffer_load_dword v31, v253, s[76:79], s40 offen offset:3072 sc1
    s_add_u32 s40, s40, 4096
    buffer_load_dword v32, v253, s[76:79], s40 offen offset:0 sc1
    buffer_load_dword v33, v253, s[76:79], s40 offen offset:1024 sc1
    buffer_load_dword v34, v253, s[76:79], s40 offen offset:2048 sc1
    buffer_load_dword v35, v253, s[76:79], s40 offen offset:3072 sc1
    s_branch L_rt_back_keys
L_rt_local:
    s_waitcnt vmcnt(3)
    s_mov_b32 s42, -1
    v_sub_u32 v20, s42, v28
    v_sub_u32 v21, s42, v29
    v_sub_u32 v22, s42, v30
    v_min3_u32 v20, v20, v21, v22
    v_sub_u32 v21, s42, v31
    v_sub_u32 v22, s42, v32
    v_min3_u32 v20, v20, v21, v22
    v_sub_u32 v21, s42, v33
    v_sub_u32 v22, s42, v34
    v_min3_u32 v20, v20, v21, v22
    v_sub_u32 v21, s42, v35
    v_min_u32 v20, v20, v21
    s_nop 1
    v_min_u32_dpp v20, v20, v20 row_shr:1 row_mask:0xf bank_mask:0xf
    s_nop 1
    v_min_u32_dpp v20, v20, v20 row_shr:2 row_mask:0xf bank_mask:0xf
    s_nop 1
    v_min_u32_dpp v20, v20, v20 row_shr:4 row_mask:0xf bank_mask:0xf
    s_nop 1
    v_min_u32_dpp v20, v20, v20 row_shr:8 row_mask:0xf bank_mask:0xf
    s_nop 1
    v_min_u32_dpp v20, v20, v20 row_bcast:15 row_mask:0xa bank_mask:0xf
    s_nop 1
    v_min_u32_dpp v20, v20, v20 row_bcast:31 row_mask:0xc bank_mask:0xf
    s_nop 0
    v_readlane_b32 s50, v20, 63
    s_sub_u32 s50, s42, s50
    s_sub_u32 s42, s50, 1
    v_sub_u32 v20, s42, v28
    v_sub_u32 v21, s42, v29
    v_sub_u32 v22, s42, v30
    v_min3_u32 v20, v20, v21, v22
    v_sub_u32 v21, s42, v31
    v_sub_u32 v22, s42, v32
    v_min3_u32 v20, v20, v21, v22
    v_sub_u32 v21, s42, v33
    v_sub_u32 v22, s42, v34
    v_min3_u32 v20, v20, v21, v22
    v_sub_u32 v21, s42, v35
    v_min_u32 v20, v20, v21
    s_nop 1
    v_min_u32_dpp v20, v20, v20 row_shr:1 row_mask:0xf bank_mask:0xf
    s_nop 1
    v_min_u32_dpp v20, v20, v20 row_shr:2 row_mask:0xf bank_mask:0xf
    s_nop 1
    v_min_u32_dpp v20, v20, v20 row_shr:4 row_mask:0xf bank_mask:0xf
    s_nop 1
    v_min_u32_dpp v20, v20, v20 row_shr:8 row_mask:0xf bank_mask:0xf
    s_nop 1
    v_min_u32_dpp v20, v20, v20 row_bcast:15 row_mask:0xa bank_mask:0xf
    s_nop 1
    v_min_u32_dpp v20, v20, v20 row_bcast:31 row_mask:0xc bank_mask:0xf
    s_nop 0
    v_readlane_b32 s51, v20, 63
    s_sub_u32 s51, s42, s51
    s_sub_u32 s42, s51, 1
    v_sub_u32 v20, s42, v28
    v_sub_u32 v21, s42, v29
    v_sub_u32 v22, s42, v30
    v_min3_u32 v20, v20, v21, v22
    v_sub_u32 v21, s42, v31
    v_sub_u32 v22, s42, v32
    v_min3_u32 v20, v20, v21, v22
    v_sub_u32 v21, s42, v33
    v_sub_u32 v22, s42, v34
    v_min3_u32 v20, v20, v21, v22
    v_sub_u32 v21, s42, v35
    v_min_u32 v20, v20, v21
    s_nop 1
    v_min_u32_dpp v20, v20, v20 row_shr:1 row_mask:0xf bank_mask:0xf
    s_nop 1
    v_min_u32_dpp v20, v20, v20 row_shr:2 row_mask:0xf bank_mask:0xf
    s_nop 1
    v_min_u32_dpp v20, v20, v20 row_shr:4 row_mask:0xf bank_mask:0xf
    s_nop 1
    v_min_u32_dpp v20, v20, v20 row_shr:8 row_mask:0xf bank_mask:0xf
    s_nop 1
    v_min_u32_dpp v20, v20, v20 row_bcast:15 row_mask:0xa bank_mask:0xf
    s_nop 1
    v_min_u32_dpp v20, v20, v20 row_bcast:31 row_mask:0xc bank_mask:0xf
    s_nop 0
    v_readlane_b32 s52, v20, 63
    s_sub_u32 s52, s42, s52
    s_sub_u32 s42, s52, 1
    v_sub_u32 v20, s42, v28
    v_sub_u32 v21, s42, v29
    v_sub_u32 v22, s42, v30
    v_min3_u32 v20, v20, v21, v22
    v_sub_u32 v21, s42, v31
    v_sub_u32 v22, s42, v32
    v_min3_u32 v20, v20, v21, v22
    v_sub_u32 v21, s42, v33
    v_sub_u32 v22, s42, v34
    v_min3_u32 v20, v20, v21, v22
    v_sub_u32 v21, s42, v35
    v_min_u32 v20, v20, v21
    s_nop 1
    v_min_u32_dpp v20, v20, v20 row_shr:1 row_mask:0xf bank_mask:0xf
    s_nop 1
    v_min_u32_dpp v20, v20, v20 row_shr:2 row_mask:0xf bank_mask:0xf
    s_nop 1
    v_min_u32_dpp v20, v20, v20 row_shr:4 row_mask:0xf bank_mask:0xf
    s_nop 1
    v_min_u32_dpp v20, v20, v20 row_shr:8 row_mask:0xf bank_mask:0xf
    s_nop 1
    v_min_u32_dpp v20, v20, v20 row_bcast:15 row_mask:0xa bank_mask:0xf
    s_nop 1
    v_min_u32_dpp v20, v20, v20 row_bcast:31 row_mask:0xc bank_mask:0xf
    s_nop 0
    v_readlane_b32 s53, v20, 63
    s_sub_u32 s53, s42, s53
    s_sub_u32 s42, s53, 1
    v_sub_u32 v20, s42, v28
    v_sub_u32 v21, s42, v29
    v_sub_u32 v22, s42, v30
    v_min3_u32 v20, v20, v21, v22
    v_sub_u32 v21, s42, v31
    v_sub_u32 v22, s42, v32
    v_min3_u32 v20, v20, v21, v22
    v_sub_u32 v21, s42, v33
    v_sub_u32 v22, s42, v34
    v_min3_u32 v20, v20, v21, v22
    v_sub_u32 v21, s42, v35
    v_min_u32 v20, v20, v21
    s_nop 1
    v_min_u32_dpp v20, v20, v20 row_shr:1 row_mask:0xf bank_mask:0xf
    s_nop 1
    v_min_u32_dpp v20, v20, v20 row_shr:2 row_mask:0xf bank_mask:0xf
    s_nop 1
    v_min_u32_dpp v20, v20, v20 row_shr:4 row_mask:0xf bank_mask:0xf
    s_nop 1
    v_min_u32_dpp v20, v20, v20 row_shr:8 row_mask:0xf bank_mask:0xf
    s_nop 1
    v_min_u32_dpp v20, v20, v20 row_bcast:15 row_mask:0xa bank_mask:0xf
    s_nop 1
    v_min_u32_dpp v20, v20, v20 row_bcast:31 row_mask:0xc bank_mask:0xf
    s_nop 0
    v_readlane_b32 s54, v20, 63
    s_sub_u32 s54, s42, s54
    s_sub_u32 s42, s54, 1
    v_sub_u32 v20, s42, v28
    v_sub_u32 v21, s42, v29
    v_sub_u32 v22, s42, v30
    v_min3_u32 v20, v20, v21, v22
    v_sub_u32 v21, s42, v31
    v_sub_u32 v22, s42, v32
    v_min3_u32 v20, v20, v21, v22
    v_sub_u32 v21, s42, v33
    v_sub_u32 v22, s42, v34
    v_min3_u32 v20, v20, v21, v22
    v_sub_u32 v21, s42, v35
    v_min_u32 v20, v20, v21
    s_nop 1
    v_min_u32_dpp v20, v20, v20 row_shr:1 row_mask:0xf bank_mask:0xf
    s_nop 1
    v_min_u32_dpp v20, v20, v20 row_shr:2 row_mask:0xf bank_mask:0xf
    s_nop 1
    v_min_u32_dpp v20, v20, v20 row_shr:4 row_mask:0xf bank_mask:0xf
    s_nop 1
    v_min_u32_dpp v20, v20, v20 row_shr:8 row_mask:0xf bank_mask:0xf
    s_nop 1
    v_min_u32_dpp v20, v20, v20 row_bcast:15 row_mask:0xa bank_mask:0xf
    s_nop 1
    v_min_u32_dpp v20, v20, v20 row_bcast:31 row_mask:0xc bank_mask:0xf
    s_nop 0
    v_readlane_b32 s55, v20, 63
    s_sub_u32 s55, s42, s55
    s_sub_u32 s42, s55, 1
    v_sub_u32 v20, s42, v28
    v_sub_u32 v21, s42, v29
    v_sub_u32 v22, s42, v30
    v_min3_u32 v20, v20, v21, v22
    v_sub_u32 v21, s42, v31
    v_sub_u32 v22, s42, v32
    v_min3_u32 v20, v20, v21, v22
    v_sub_u32 v21, s42, v33
    v_sub_u32 v22, s42, v34
    v_min3_u32 v20, v20, v21, v22
    v_sub_u32 v21, s42, v35
    v_min_u32 v20, v20, v21
    s_nop 1
    v_min_u32_dpp v20, v20, v20 row_shr:1 row_mask:0xf bank_mask:0xf
    s_nop 1
    v_min_u32_dpp v20, v20, v20 row_shr:2 row_mask:0xf bank_mask:0xf
    s_nop 1
    v_min_u32_dpp v20, v20, v20 row_shr:4 row_mask:0xf bank_mask:0xf
    s_nop 1
    v_min_u32_dpp v20, v20, v20 row_shr:8 row_mask:0xf bank_mask:0xf
    s_nop 1
    v_min_u32_dpp v20, v20, v20 row_bcast:15 row_mask:0xa bank_mask:0xf
    s_nop 1
    v_min_u32_dpp v20, v20, v20 row_bcast:31 row_mask:0xc bank_mask:0xf
    s_nop 0
    v_readlane_b32 s56, v20, 63
    s_sub_u32 s56, s42, s56
    s_sub_u32 s42, s56, 1
    v_sub_u32 v20, s42, v28
    v_sub_u32 v21, s42, v29
    v_sub_u32 v22, s42, v30
    v_min3_u32 v20, v20, v21, v22
    v_sub_u32 v21, s42, v31
    v_sub_u32 v22, s42, v32
    v_min3_u32 v20, v20, v21, v22
    v_sub_u32 v21, s42, v33
    v_sub_u32 v22, s42, v34
    v_min3_u32 v20, v20, v21, v22
    v_sub_u32 v21, s42, v35
    v_min_u32 v20, v20, v21
    s_nop 1
    v_min_u32_dpp v20, v20, v20 row_shr:1 row_mask:0xf bank_mask:0xf
    s_nop 1
    v_min_u32_dpp v20, v20, v20 row_shr:2 row_mask:0xf bank_mask:0xf
    s_nop 1
    v_min_u32_dpp v20, v20, v20 row_shr:4 row_mask:0xf bank_mask:0xf
    s_nop 1
    v_min_u32_dpp v20, v20, v20 row_shr:8 row_mask:0xf bank_mask:0xf
    s_nop 1
    v_min_u32_dpp v20, v20, v20 row_bcast:15 row_mask:0xa bank_mask:0xf
    s_nop 1
    v_min_u32_dpp v20, v20, v20 row_bcast:31 row_mask:0xc bank_mask:0xf
    s_nop 0
    v_readlane_b32 s57, v20, 63
    s_sub_u32 s57, s42, s57
    s_sub_u32 s42, s57, 1
    v_mov_b32 v20, s50
    v_writelane_b32 v20, s51, 1
    v_writelane_b32 v20, s52, 2
    v_writelane_b32 v20, s53, 3
    v_writelane_b32 v20, s54, 4
    v_writelane_b32 v20, s55, 5
    v_writelane_b32 v20, s56, 6
    v_writelane_b32 v20, s57, 7
    s_lshl_b32 s42, s5, 8
    s_add_u32 s42, s42, 86016
    v_lshl_add_u32 v21, v19, 2, s42
    ds_write_b32 v21, v20
    s_waitcnt lgkmcnt(0)
    s_branch L_rt_back_local
L_rt_merge:
    v_bfe_u32 v21, v19, 3, 2
    v_lshlrev_b32 v21, 8, v21
    v_and_b32 v20, 7, v19
    v_lshl_add_u32 v21, v20, 2, v21
    v_add_u32 v21, 86016, v21
    ds_read_b32 v20, v21
    s_waitcnt lgkmcnt(0)
    s_mov_b32 s42, -1
    v_sub_u32 v21, s42, v20
    s_nop 1
    v_min_u32_dpp v21, v21, v21 row_shr:1 row_mask:0xf bank_mask:0xf
    s_nop 1
    v_min_u32_dpp v21, v21, v21 row_shr:2 row_mask:0xf bank_mask:0xf
    s_nop 1
    v_min_u32_dpp v21, v21, v21 row_shr:4 row_mask:0xf bank_mask:0xf
    s_nop 1
    v_min_u32_dpp v21, v21, v21 row_shr:8 row_mask:0xf bank_mask:0xf
    s_nop 1
    v_min_u32_dpp v21, v21, v21 row_bcast:15 row_mask:0xa bank_mask:0xf
    s_nop 1
    v_min_u32_dpp v21, v21, v21 row_bcast:31 row_mask:0xc bank_mask:0xf
    s_nop 0
    v_readlane_b32 s50, v21, 63
    s_sub_u32 s50, s42, s50
    s_sub_u32 s42, s50, 1
    v_sub_u32 v21, s42, v20
    s_nop 1
    v_min_u32_dpp v21, v21, v21 row_shr:1 row_mask:0xf bank_mask:0xf
    s_nop 1
    v_min_u32_dpp v21, v21, v21 row_shr:2 row_mask:0xf bank_mask:0xf
    s_nop 1
    v_min_u32_dpp v21, v21, v21 row_shr:4 row_mask:0xf bank_mask:0xf
    s_nop 1
    v_min_u32_dpp v21, v21, v21 row_shr:8 row_mask:0xf bank_mask:0xf
    s_nop 1
    v_min_u32_dpp v21, v21, v21 row_bcast:15 row_mask:0xa bank_mask:0xf
    s_nop 1
    v_min_u32_dpp v21, v21, v21 row_bcast:31 row_mask:0xc bank_mask:0xf
    s_nop 0
    v_readlane_b32 s51, v21, 63
    s_sub_u32 s51, s42, s51
    s_sub_u32 s42, s51, 1
    v_sub_u32 v21, s42, v20
    s_nop 1
    v_min_u32_dpp v21, v21, v21 row_shr:1 row_mask:0xf bank_mask:0xf
    s_nop 1
    v_min_u32_dpp v21, v21, v21 row_shr:2 row_mask:0xf bank_mask:0xf
    s_nop 1
    v_min_u32_dpp v21, v21, v21 row_shr:4 row_mask:0xf bank_mask:0xf
    s_nop 1
    v_min_u32_dpp v21, v21, v21 row_shr:8 row_mask:0xf bank_mask:0xf
    s_nop 1
    v_min_u32_dpp v21, v21, v21 row_bcast:15 row_mask:0xa bank_mask:0xf
    s_nop 1
    v_min_u32_dpp v21, v21, v21 row_bcast:31 row_mask:0xc bank_mask:0xf
    s_nop 0
    v_readlane_b32 s52, v21, 63
    s_sub_u32 s52, s42, s52
    s_sub_u32 s42, s52, 1
    v_sub_u32 v21, s42, v20
    s_nop 1
    v_min_u32_dpp v21, v21, v21 row_shr:1 row_mask:0xf bank_mask:0xf
    s_nop 1
    v_min_u32_dpp v21, v21, v21 row_shr:2 row_mask:0xf bank_mask:0xf
    s_nop 1
    v_min_u32_dpp v21, v21, v21 row_shr:4 row_mask:0xf bank_mask:0xf
    s_nop 1
    v_min_u32_dpp v21, v21, v21 row_shr:8 row_mask:0xf bank_mask:0xf
    s_nop 1
    v_min_u32_dpp v21, v21, v21 row_bcast:15 row_mask:0xa bank_mask:0xf
    s_nop 1
    v_min_u32_dpp v21, v21, v21 row_bcast:31 row_mask:0xc bank_mask:0xf
    s_nop 0
    v_readlane_b32 s53, v21, 63
    s_sub_u32 s53, s42, s53
    s_sub_u32 s42, s53, 1
    v_sub_u32 v21, s42, v20
    s_nop 1
    v_min_u32_dpp v21, v21, v21 row_shr:1 row_mask:0xf bank_mask:0xf
    s_nop 1
    v_min_u32_dpp v21, v21, v21 row_shr:2 row_mask:0xf bank_mask:0xf
    s_nop 1
    v_min_u32_dpp v21, v21, v21 row_shr:4 row_mask:0xf bank_mask:0xf
    s_nop 1
    v_min_u32_dpp v21, v21, v21 row_shr:8 row_mask:0xf bank_mask:0xf
    s_nop 1
    v_min_u32_dpp v21, v21, v21 row_bcast:15 row_mask:0xa bank_mask:0xf
    s_nop 1
    v_min_u32_dpp v21, v21, v21 row_bcast:31 row_mask:0xc bank_mask:0xf
    s_nop 0
    v_readlane_b32 s54, v21, 63
    s_sub_u32 s54, s42, s54
    s_sub_u32 s42, s54, 1
    v_sub_u32 v21, s42, v20
    s_nop 1
    v_min_u32_dpp v21, v21, v21 row_shr:1 row_mask:0xf bank_mask:0xf
    s_nop 1
    v_min_u32_dpp v21, v21, v21 row_shr:2 row_mask:0xf bank_mask:0xf
    s_nop 1
    v_min_u32_dpp v21, v21, v21 row_shr:4 row_mask:0xf bank_mask:0xf
    s_nop 1
    v_min_u32_dpp v21, v21, v21 row_shr:8 row_mask:0xf bank_mask:0xf
    s_nop 1
    v_min_u32_dpp v21, v21, v21 row_bcast:15 row_mask:0xa bank_mask:0xf
    s_nop 1
    v_min_u32_dpp v21, v21, v21 row_bcast:31 row_mask:0xc bank_mask:0xf
    s_nop 0
    v_readlane_b32 s55, v21, 63
    s_sub_u32 s55, s42, s55
    s_sub_u32 s42, s55, 1
    v_sub_u32 v21, s42, v20
    s_nop 1
    v_min_u32_dpp v21, v21, v21 row_shr:1 row_mask:0xf bank_mask:0xf
    s_nop 1
    v_min_u32_dpp v21, v21, v21 row_shr:2 row_mask:0xf bank_mask:0xf
    s_nop 1
    v_min_u32_dpp v21, v21, v21 row_shr:4 row_mask:0xf bank_mask:0xf
    s_nop 1
    v_min_u32_dpp v21, v21, v21 row_shr:8 row_mask:0xf bank_mask:0xf
    s_nop 1
    v_min_u32_dpp v21, v21, v21 row_bcast:15 row_mask:0xa bank_mask:0xf
    s_nop 1
    v_min_u32_dpp v21, v21, v21 row_bcast:31 row_mask:0xc bank_mask:0xf
    s_nop 0
    v_readlane_b32 s56, v21, 63
    s_sub_u32 s56, s42, s56
    s_sub_u32 s42, s56, 1
    v_sub_u32 v21, s42, v20
    s_nop 1
    v_min_u32_dpp v21, v21, v21 row_shr:1 row_mask:0xf bank_mask:0xf
    s_nop 1
    v_min_u32_dpp v21, v21, v21 row_shr:2 row_mask:0xf bank_mask:0xf
    s_nop 1
    v_min_u32_dpp v21, v21, v21 row_shr:4 row_mask:0xf bank_mask:0xf
    s_nop 1
    v_min_u32_dpp v21, v21, v21 row_shr:8 row_mask:0xf bank_mask:0xf
    s_nop 1
    v_min_u32_dpp v21, v21, v21 row_bcast:15 row_mask:0xa bank_mask:0xf
    s_nop 1
    v_min_u32_dpp v21, v21, v21 row_bcast:31 row_mask:0xc bank_mask:0xf
    s_nop 0
    v_readlane_b32 s57, v21, 63
    s_sub_u32 s57, s42, s57
    s_sub_u32 s42, s57, 1
    v_mov_b32 v20, s50
    v_writelane_b32 v20, s51, 1
    v_writelane_b32 v20, s52, 2
    v_writelane_b32 v20, s53, 3
    v_writelane_b32 v20, s54, 4
    v_writelane_b32 v20, s55, 5
    v_writelane_b32 v20, s56, 6
    v_writelane_b32 v20, s57, 7
    v_lshlrev_b32 v21, 2, v19
    s_mov_b32 s42, 0x29b000
    s_mov_b64 exec, 0xff
    buffer_store_dword v20, v21, s[76:79], s42 offen sc1
    s_mov_b64 exec, -1
    s_branch L_rt_back_merge
L_site0:
    s_mov_b32 s43, m0
    s_mov_b32 m0, s38
    s_add_u32 s38, s38, 1024
    buffer_load_dwordx4 v24, s[16:19], s37 offen lds
    s_mov_b32 m0, s43
    s_add_u32 s37, s37, 221184
    s_cmp_eq_u32 s35, 1
    s_cselect_b32 s36, 4, s36
    s_branch L_site_back0
L_site1:
    s_mov_b32 s43, m0
    s_mov_b32 m0, s38
    s_add_u32 s38, s38, 1024
    buffer_load_dwordx4 v24, s[16:19], s37 offen lds
    s_mov_b32 m0, s43
    s_add_u32 s37, s37, 221184
    s_cmp_eq_u32 s35, 1
    s_cselect_b32 s36, 4, s36
    s_branch L_site_back1
L_once_pack:
    s_mov_b64 exec, 1
    buffer_store_dword v27, off, s[76:79], s75 sc1
    s_mov_b64 exec, -1
    s_branch L_once_back_pack
L_site2:
    s_mov_b32 s43, m0
    s_mov_b32 m0, s38
    s_add_u32 s38, s38, 1024
    buffer_load_dwordx4 v24, s[16:19], s37 offen lds
    s_mov_b32 m0, s43
    s_add_u32 s37, s37, 221184
    s_cmp_eq_u32 s35, 1
    s_cselect_b32 s36, 4, s36
    s_branch L_site_back2
L_site3:
    s_mov_b32 s43, m0
    s_mov_b32 m0, s38
    s_add_u32 s38, s38, 1024
    buffer_load_dwordx4 v24, s[16:19], s37 offen lds
    s_mov_b32 m0, s43
    s_add_u32 s37, s37, 221184
    s_cmp_eq_u32 s35, 1
    s_cselect_b32 s36, 4, s36
    s_branch L_site_back3
L_spin_pack:
    s_mov_b32 s7, 32768
L_retry_pack:
    s_sleep 2
    buffer_load_dwordx4 v[28:31], v32, s[76:79], 0 offen sc1
    s_waitcnt vmcnt(0)
    v_min3_u32 v28, v28, v29, v30
    v_min_u32 v28, v28, v31
    v_cmp_gt_u32 vcc, 1, v28
    s_and_b64 vcc, vcc, exec
    s_cbranch_scc0 L_back_pack
    s_sub_u32 s7, s7, 1
    s_cbranch_scc0 L_retry_pack
    s_branch L_back_pack
L_spin_sel:
    s_mov_b32 s7, 32768
L_retry_sel:
    s_sleep 2
    buffer_load_dword v249, v21, s[76:79], 0 offen sc1
    s_waitcnt vmcnt(0)
    v_cmp_eq_u32 vcc, 0, v249
    s_and_b64 vcc, vcc, exec
    s_cbranch_scc0 L_back_sel
    s_sub_u32 s7, s7, 1
    s_cbranch_scc0 L_retry_sel
    s_branch L_back_sel
L_spin_ffn:
    s_mov_b32 s7, 32768
L_retry_ffn:
    s_sleep 2
    buffer_load_dwordx4 v[252:255], v20, s[76:79], 0 offen sc1
    s_waitcnt vmcnt(0)
    v_min3_u32 v252, v252, v253, v254
    v_min_u32 v252, v252, v255
    v_cmp_gt_u32 vcc, 2, v252
    s_and_b64 vcc, vcc, exec
    s_cbranch_scc0 L_back_ffn
    s_sub_u32 s7, s7, 1
    s_cbranch_scc0 L_retry_ffn
    s_branch L_back_ffn
L_spin_o:
    s_mov_b32 s7, 32768
L_retry_o:
    s_sleep 2
    buffer_load_dwordx4 v[252:255], v1, s[76:79], 0 offen sc1
    s_waitcnt vmcnt(0)
    v_min3_u32 v252, v252, v253, v254
    v_min_u32 v252, v252, v255
    v_cmp_gt_u32 vcc, 1, v252
    s_and_b64 vcc, vcc, exec
    s_cbranch_scc0 L_back_o
    s_sub_u32 s7, s7, 1
    s_cbranch_scc0 L_retry_o
    s_branch L_back_o
L_spin_upd:
    s_mov_b32 s7, 32768
L_retry_upd:
    s_sleep 2
    buffer_load_dwordx4 v[252:255], v1, s[76:79], 0 offen sc1
    s_waitcnt vmcnt(0)
    v_min3_u32 v252, v252, v253, v254
    v_min_u32 v252, v252, v255
    v_cmp_gt_u32 vcc, 3, v252
    s_and_b64 vcc, vcc, exec
    s_cbranch_scc0 L_back_upd
    s_sub_u32 s7, s7, 1
    s_cbranch_scc0 L_retry_upd
    s_branch L_back_upd
L_code_end:
    s_endpgm

.section .rodata,"a"
.p2align 6
.amdhsa_kernel recurrent_scan__mha_block_cached__moe_arch_mod__prompt_kernel
  .amdhsa_next_free_vgpr 512
  .amdhsa_next_free_sgpr 102
  .amdhsa_accum_offset 256
  .amdhsa_group_segment_fixed_size 0
  .amdhsa_kernarg_size 104
  .amdhsa_user_sgpr_count 2
  .amdhsa_user_sgpr_kernarg_segment_ptr 1
  .amdhsa_system_sgpr_workgroup_id_x 1
  .amdhsa_float_denorm_mode_32 3
.end_amdhsa_kernel
```

```asm
; @launch grid=(256,1,1) block=(256,1,1) lds=163840
.amdgcn_target "amdgcn-amd-amdhsa--gfx950"
.text
.globl recurrent_scan__mha_block_cached__moe_arch_mod__prompt_kernel
.p2align 8
.type recurrent_scan__mha_block_cached__moe_arch_mod__prompt_kernel,@function
recurrent_scan__mha_block_cached__moe_arch_mod__prompt_kernel:
    s_cmp_ge_u32 s2, 256
    s_cbranch_scc1 L_end
    s_load_dwordx16 s[48:63], s[0:1], 0
    s_load_dwordx8 s[64:71], s[0:1], 64
    s_load_dwordx2 s[72:73], s[0:1], 96
    s_getpc_b64 s[40:41]
L_touch:
    s_bfe_u32 s42, s2, 0x20003
    s_lshl_b32 s42, s42, 8
    v_add_u32 v252, s42, v0
    v_min_u32 v252, (L_code_end - L_touch) / 128, v252
    v_lshlrev_b32 v252, 7, v252
    global_load_dword a120, v252, s[40:41]
    v_lshrrev_b32 v116, 6, v0
    v_and_b32 v19, 63, v0
    s_and_b32 s40, s2, 7
    v_readfirstlane_b32 s5, v116
    s_lshl_b32 s40, s40, 2
    s_bfe_u32 s41, s2, 0x20003
    s_add_u32 s3, s40, s41
    s_lshr_b32 s4, s2, 5
    s_lshl_b32 s74, s4, 5
    s_add_u32 s6, s74, s3
    v_lshrrev_b32 v118, 4, v19
    v_and_b32 v117, 15, v19
    v_lshlrev_b32 v119, 1, v118
    v_xor_b32 v119, v117, v119
    s_lshl_b32 s42, s5, 4
    v_add_u32 v120, s42, v118
    v_lshlrev_b32 v121, 4, v119
    v_xor_b32 v122, 0x80, v121
    v_lshl_add_u32 v123, v120, 13, v121
    v_lshl_add_u32 v116, v120, 13, v122
    v_add_u32 v44, 0, v123
    v_add_u32 v45, 31744, v123
    v_add_u32 v46, 63488, v116
    v_add_u32 v47, 95232, v116
    v_lshl_add_u32 v17, v120, 8, v121
    v_lshl_add_u32 v18, v120, 8, v122
    v_xor_b32 v117, v117, v118
    v_xor_b32 v121, 0, v117
    v_lshlrev_b32 v121, 4, v121
    v_lshl_add_u32 v13, v120, 8, v121
    v_xor_b32 v121, 4, v117
    v_lshlrev_b32 v121, 4, v121
    v_lshl_add_u32 v14, v120, 8, v121
    v_xor_b32 v121, 8, v117
    v_lshlrev_b32 v121, 4, v121
    v_lshl_add_u32 v15, v120, 8, v121
    v_xor_b32 v121, 12, v117
    v_lshlrev_b32 v121, 4, v121
    v_lshl_add_u32 v16, v120, 8, v121
    v_lshrrev_b32 v116, 3, v19
    v_and_b32 v117, 7, v19
    v_xor_b32 v117, v117, v118
    v_mul_u32_u24 v116, 1280, v116
    s_mul_i32 s42, s5, 81920
    v_lshl_add_u32 v119, v117, 4, v116
    v_xor_b32 v117, 4, v117
    v_lshl_add_u32 v120, v117, 4, v116
    v_add_u32 v119, s42, v119
    v_add_u32 v120, s42, v120
    v_add_u32 v36, 0, v119
    v_add_u32 v37, 9216, v120
    v_add_u32 v38, 18432, v119
    v_add_u32 v39, 27648, v120
    v_add_u32 v40, 40960, v119
    v_add_u32 v41, 50176, v120
    v_add_u32 v42, 59392, v119
    v_add_u32 v43, 68608, v120
    s_lshl_b32 s43, s6, 2
    s_add_u32 s43, s43, s5
    s_lshl_b32 s43, s43, 1
    s_mul_i32 s38, s5, 24576
    s_lshl_b32 s40, s5, 12
    s_add_u32 s39, s40, 98304
    s_mov_b32 s34, s39
    s_mov_b32 s28, 0
    s_mov_b32 s29, 0
    s_and_b32 s40, s3, 31
    s_mul_i32 s40, s40, 10
    s_lshr_b32 s40, s40, 5
    s_lshl_b32 s36, s40, 7
    s_waitcnt lgkmcnt(0)
    s_mov_b32 s88, s48
    s_mov_b32 s89, s49
    s_mov_b32 s90, 0x280000
    s_mov_b32 s91, 0x20000
    s_mov_b32 s92, s60
    s_mov_b32 s93, s61
    s_mov_b32 s94, 0x500
    s_mov_b32 s95, 0x20000
    s_lshl_b32 s40, s3, 8
    s_add_u32 s20, s54, s40
    s_addc_u32 s21, s55, 0
    s_mov_b32 s22, 0x4fe100
    s_mov_b32 s23, 0x20000
    s_mul_i32 s40, s4, 327680
    s_add_u32 s16, s48, s40
    s_addc_u32 s17, s49, 0
    s_mov_b32 s18, 0x50000
    s_mov_b32 s19, 0x20000
    s_add_u32 m0, s39, 0
    s_mov_b32 s37, 0
    buffer_load_dwordx4 v44, s[20:23], s37 offen offset:0 lds
    buffer_load_dwordx4 v45, s[20:23], s37 offen offset:1024 lds
    buffer_load_dwordx4 v46, s[20:23], s37 offen offset:2048 lds
    buffer_load_dwordx4 v47, s[20:23], s37 offen offset:3072 lds
    s_add_u32 m0, s38, 0
    s_mov_b32 s36, 0
    buffer_load_dwordx4 v36, s[16:19], s36 offen offset:0 lds
    buffer_load_dwordx4 v37, s[16:19], s36 offen offset:1024 lds
    buffer_load_dwordx4 v38, s[16:19], s36 offen offset:2048 lds
    buffer_load_dwordx4 v39, s[16:19], s36 offen offset:3072 lds
    s_add_u32 m0, s38, 4096
    s_nop 0
    buffer_load_dwordx4 v40, s[16:19], s36 offen offset:0 lds
    buffer_load_dwordx4 v41, s[16:19], s36 offen offset:1024 lds
    buffer_load_dwordx4 v42, s[16:19], s36 offen offset:2048 lds
    buffer_load_dwordx4 v43, s[16:19], s36 offen offset:3072 lds
    v_lshrrev_b32 v108, 5, v19
    v_add_u32 v108, s43, v108
    v_and_b32 v110, 31, v19
    v_lshlrev_b32 v110, 3, v110
    v_mul_u32_u24 v109, 1280, v108
    v_add_u32 v109, v109, v110
    buffer_load_dwordx2 v[60:61], v109, s[88:91], 0 offen offset:0
    buffer_load_dwordx2 v[62:63], v109, s[88:91], 0 offen offset:256
    buffer_load_dwordx2 v[64:65], v109, s[88:91], 0 offen offset:512
    buffer_load_dwordx2 v[66:67], v109, s[88:91], 0 offen offset:768
    buffer_load_dwordx2 v[68:69], v109, s[88:91], 0 offen offset:1024
    buffer_load_dwordx2 v[70:71], v110, s[92:95], 0 offen offset:0
    buffer_load_dwordx2 v[72:73], v110, s[92:95], 0 offen offset:256
    buffer_load_dwordx2 v[74:75], v110, s[92:95], 0 offen offset:512
    buffer_load_dwordx2 v[76:77], v110, s[92:95], 0 offen offset:768
    buffer_load_dwordx2 v[78:79], v110, s[92:95], 0 offen offset:1024
    s_lshl_b32 s40, s3, 19
    s_add_u32 s8, s50, s40
    s_addc_u32 s9, s51, 0
    s_mov_b32 s10, 0x80000
    s_mov_b32 s11, 0x20000
    s_add_u32 s12, s52, s40
    s_addc_u32 s13, s53, 0
    s_mov_b32 s14, 0x80000
    s_mov_b32 s15, 0x20000
    s_and_b32 s40, s5, 1
    s_lshl_b32 s40, s40, 12
    s_cmp_ge_u32 s5, 2
    s_cselect_b32 s30, 32, 8
    s_cselect_b32 s31, 40, 16
    s_cselect_b32 s32, 0, 56
    s_cselect_b32 s33, 48, 24
    s_lshl_b32 s30, s30, 10
    s_add_u32 s30, s30, s40
    s_lshl_b32 s31, s31, 10
    s_add_u32 s31, s31, s40
    s_lshl_b32 s32, s32, 10
    s_add_u32 s32, s32, s40
    s_lshl_b32 s33, s33, 10
    s_add_u32 s33, s33, s40
    s_mov_b32 s44, 0x3e0293ee
    s_mov_b32 s45, 4096
    s_mov_b32 s76, s72
    s_mov_b32 s77, s73
    s_mov_b32 s78, 0x2000000
    s_mov_b32 s79, 0x20000
    s_mov_b32 s92, s70
    s_mov_b32 s93, s71
    s_mov_b32 s94, 0x100
    s_mov_b32 s95, 0x20000
    s_lshl_b32 s41, s4, 2
    s_add_u32 s41, s41, s5
    s_lshl_b32 s40, s41, 5
    s_add_u32 s40, s40, s3
    s_lshl_b32 s40, s40, 14
    s_add_u32 s40, s40, 0x400000
    s_add_u32 s24, s72, s40
    s_addc_u32 s25, s73, 0
    s_mov_b32 s26, 0x4000
    s_mov_b32 s27, 0x20000
    s_and_b32 s42, s3, 3
    s_lshl_b32 s42, s42, 2
    s_lshr_b32 s40, s6, 2
    s_lshl_b32 s40, s40, 7
    s_add_u32 s40, s40, s42
    s_add_u32 s75, s40, 0x290000
    s_lshr_b32 s40, s3, 2
    s_lshl_b32 s40, s40, 7
    s_add_u32 s40, s40, s42
    s_lshl_b32 s42, s41, 10
    s_add_u32 s40, s40, s42
    s_add_u32 s58, s40, 0x292000
    s_cmp_eq_u32 s5, 0
    s_cselect_b32 s59, 5, 8
    s_lshl_b32 s41, s41, 10
    s_add_u32 s46, s41, 0x280000
    v_lshrrev_b32 v116, 4, v19
    v_and_b32 v117, 15, v19
    v_lshlrev_b32 v59, 4, v117
    v_xor_b32 v118, v116, v117
    v_lshlrev_b32 v119, 8, v117
    v_add_u32 v119, 98304, v119
    s_add_u32 s41, s5, 0
    s_and_b32 s41, s41, 3
    s_lshl_b32 s41, s41, 2
    v_xor_b32 v120, s41, v118
    v_lshl_add_u32 v1, v120, 4, v119
    s_add_u32 s41, s5, 1
    s_and_b32 s41, s41, 3
    s_lshl_b32 s41, s41, 2
    v_xor_b32 v120, s41, v118
    v_lshl_add_u32 v2, v120, 4, v119
    s_add_u32 s41, s5, 2
    s_and_b32 s41, s41, 3
    s_lshl_b32 s41, s41, 2
    v_xor_b32 v120, s41, v118
    v_lshl_add_u32 v3, v120, 4, v119
    s_add_u32 s41, s5, 3
    s_and_b32 s41, s41, 3
    s_lshl_b32 s41, s41, 2
    v_xor_b32 v120, s41, v118
    v_lshl_add_u32 v4, v120, 4, v119
    v_lshrrev_b32 v118, 1, v117
    v_xor_b32 v118, v116, v118
    v_lshlrev_b32 v119, 7, v117
    v_add_u32 v119, s38, v119
    v_xor_b32 v120, 0, v118
    v_lshl_add_u32 v48, v120, 4, v119
    v_xor_b32 v120, 4, v118
    v_lshl_add_u32 v49, v120, 4, v119
    v_bfe_u32 v118, v19, 2, 2
    v_bfe_u32 v119, v19, 2, 3
    v_and_b32 v120, 3, v19
    v_lshlrev_b32 v120, 3, v120
    v_lshl_add_u32 v121, v116, 2, v118
    v_lshl_add_u32 v121, v121, 8, v120
    v_lshl_add_u32 v122, v116, 3, v118
    v_lshl_add_u32 v122, v122, 8, v120
    v_add_u32 v122, 98304, v122
    v_xor_b32 v123, 0, v119
    v_lshl_add_u32 v5, v123, 5, v121
    v_xor_b32 v123, 1, v119
    v_lshl_add_u32 v6, v123, 5, v121
    v_xor_b32 v123, 2, v119
    v_lshl_add_u32 v7, v123, 5, v121
    v_xor_b32 v123, 3, v119
    v_lshl_add_u32 v8, v123, 5, v121
    v_xor_b32 v123, 4, v119
    v_lshl_add_u32 v9, v123, 5, v121
    v_xor_b32 v123, 5, v119
    v_lshl_add_u32 v10, v123, 5, v121
    v_xor_b32 v123, 6, v119
    v_lshl_add_u32 v11, v123, 5, v121
    v_xor_b32 v123, 7, v119
    v_lshl_add_u32 v12, v123, 5, v121
    s_lshl_b32 s42, s5, 1
    s_add_u32 s41, s42, 0
    s_and_b32 s41, s41, 7
    v_xor_b32 v123, s41, v119
    v_lshl_add_u32 v50, v123, 5, v122
    s_add_u32 s41, s42, 1
    s_and_b32 s41, s41, 7
    v_xor_b32 v123, s41, v119
    v_lshl_add_u32 v51, v123, 5, v122
    s_add_u32 s41, s42, 2
    s_and_b32 s41, s41, 7
    v_xor_b32 v123, s41, v119
    v_lshl_add_u32 v52, v123, 5, v122
    s_add_u32 s41, s42, 3
    s_and_b32 s41, s41, 7
    v_xor_b32 v123, s41, v119
    v_lshl_add_u32 v53, v123, 5, v122
    s_add_u32 s41, s42, 4
    s_and_b32 s41, s41, 7
    v_xor_b32 v123, s41, v119
    v_lshl_add_u32 v54, v123, 5, v122
    s_add_u32 s41, s42, 5
    s_and_b32 s41, s41, 7
    v_xor_b32 v123, s41, v119
    v_lshl_add_u32 v55, v123, 5, v122
    s_add_u32 s41, s42, 6
    s_and_b32 s41, s41, 7
    v_xor_b32 v123, s41, v119
    v_lshl_add_u32 v56, v123, 5, v122
    s_add_u32 s41, s42, 7
    s_and_b32 s41, s41, 7
    v_xor_b32 v123, s41, v119
    v_lshl_add_u32 v57, v123, 5, v122
    s_lshl_b32 s41, s5, 7
    s_add_u32 s41, s41, 86016
    v_lshl_add_u32 v58, v116, 4, s41
    v_mov_b32 v32, 0x3f803f80
    v_mov_b32 v33, 0x3f803f80
    v_mov_b32 v34, 0x3f803f80
    v_mov_b32 v35, 0x3f803f80
    v_and_b32 v120, 1, v19
    v_cmp_eq_u32 vcc, 0, v120
    v_mov_b32 v121, 0x44444444
    v_mov_b32 v122, 0xeeeeeeee
    v_cndmask_b32 v248, v122, v121, vcc
    v_and_b32 v120, 2, v19
    v_cmp_eq_u32 vcc, 0, v120
    v_mov_b32 v27, 1
    v_mov_b32 v28, 0
    v_cndmask_b32 v244, 0, v32, vcc
    v_cndmask_b32 v245, 0, v32, vcc
    v_cndmask_b32 v246, 0, v32, vcc
    v_cndmask_b32 v247, 0, v32, vcc
    v_accvgpr_write_b32 a224, 0
    v_accvgpr_write_b32 a225, 0
    v_accvgpr_write_b32 a226, 0
    v_accvgpr_write_b32 a227, 0
    v_accvgpr_write_b32 a228, 0
    v_accvgpr_write_b32 a229, 0
    v_accvgpr_write_b32 a230, 0
    v_accvgpr_write_b32 a231, 0
    v_accvgpr_write_b32 a232, 0
    v_accvgpr_write_b32 a233, 0
    v_accvgpr_write_b32 a234, 0
    v_accvgpr_write_b32 a235, 0
    v_accvgpr_write_b32 a236, 0
    v_accvgpr_write_b32 a237, 0
    v_accvgpr_write_b32 a238, 0
    v_accvgpr_write_b32 a239, 0
    s_mul_i32 s47, s5, 5120
    s_mov_b32 s96, s56
    s_mov_b32 s97, s57
    s_mov_b32 s98, 0x500000
    s_mov_b32 s99, 0x20000
    s_lshr_b32 s40, s6, 1
    s_and_b32 s41, s6, 1
    s_lshl_b32 s41, s41, 2
    s_add_u32 s41, s41, s5
    s_add_u32 s47, s47, 65536
    s_mul_i32 s42, s40, 40960
    s_mul_i32 s43, s41, 160
    s_add_u32 s42, s42, s43
    v_add_u32 v25, 0, v19
    v_mul_u32_u24 v26, 6554, v25
    v_lshrrev_b32 v26, 16, v26
    v_mul_u32_u24 v20, 1120, v26
    v_lshl_add_u32 v20, v25, 4, v20
    v_add_u32 v20, s42, v20
    v_add_u32 v25, 64, v19
    v_mul_u32_u24 v26, 6554, v25
    v_lshrrev_b32 v26, 16, v26
    v_mul_u32_u24 v21, 1120, v26
    v_lshl_add_u32 v21, v25, 4, v21
    v_add_u32 v21, s42, v21
    v_add_u32 v25, 128, v19
    v_mul_u32_u24 v26, 6554, v25
    v_lshrrev_b32 v26, 16, v26
    v_mul_u32_u24 v22, 1120, v26
    v_lshl_add_u32 v22, v25, 4, v22
    v_add_u32 v22, s42, v22
    v_add_u32 v25, 192, v19
    v_mul_u32_u24 v26, 6554, v25
    v_lshrrev_b32 v26, 16, v26
    v_mul_u32_u24 v23, 1120, v26
    v_lshl_add_u32 v23, v25, 4, v23
    v_add_u32 v23, s42, v23
    v_add_u32 v25, 256, v19
    v_mul_u32_u24 v26, 6554, v25
    v_lshrrev_b32 v26, 16, v26
    v_mul_u32_u24 v24, 1120, v26
    v_lshl_add_u32 v24, v25, 4, v24
    v_add_u32 v24, s42, v24
    v_lshrrev_b32 v25, 2, v19
    v_mul_u32_u24 v25, 160, v25
    v_and_b32 v26, 3, v19
    v_lshl_add_u32 v25, v26, 3, v25
    v_add_u32 v25, s47, v25
    s_lshl_b32 s42, s41, 7
    s_add_u32 s42, s42, s40
    s_mul_i32 s42, s42, 5120
    s_add_u32 s42, s42, 0x1400000
    v_lshlrev_b32 v26, 4, v19
    v_add_u32 v26, s42, v26
    s_add_u32 m0, s39, 16384
    s_mov_b32 s37, 524288
    buffer_load_dwordx4 v44, s[20:23], s37 offen offset:0 lds
    buffer_load_dwordx4 v45, s[20:23], s37 offen offset:1024 lds
    buffer_load_dwordx4 v46, s[20:23], s37 offen offset:2048 lds
    buffer_load_dwordx4 v47, s[20:23], s37 offen offset:3072 lds
    s_add_u32 m0, s38, 8192
    s_mov_b32 s36, 128
    buffer_load_dwordx4 v36, s[16:19], s36 offen offset:0 lds
    buffer_load_dwordx4 v37, s[16:19], s36 offen offset:1024 lds
    buffer_load_dwordx4 v38, s[16:19], s36 offen offset:2048 lds
    buffer_load_dwordx4 v39, s[16:19], s36 offen offset:3072 lds
    s_add_u32 m0, s38, 12288
    s_nop 0
    buffer_load_dwordx4 v40, s[16:19], s36 offen offset:0 lds
    buffer_load_dwordx4 v41, s[16:19], s36 offen offset:1024 lds
    buffer_load_dwordx4 v42, s[16:19], s36 offen offset:2048 lds
    buffer_load_dwordx4 v43, s[16:19], s36 offen offset:3072 lds
    s_add_u32 m0, s39, 32768
    s_mov_b32 s37, 1048576
    buffer_load_dwordx4 v44, s[20:23], s37 offen offset:0 lds
    buffer_load_dwordx4 v45, s[20:23], s37 offen offset:1024 lds
    buffer_load_dwordx4 v46, s[20:23], s37 offen offset:2048 lds
    buffer_load_dwordx4 v47, s[20:23], s37 offen offset:3072 lds
    s_waitcnt vmcnt(26)
    s_barrier
    ds_read_b64_tr_b16 a[0:1], v50 offset:0
    ds_read_b64_tr_b16 a[2:3], v50 offset:1024
    ds_read_b128 a[32:35], v48 offset:0
    ds_read_b128 a[36:39], v48 offset:2048
    ds_read_b128 a[40:43], v48 offset:4096
    ds_read_b128 a[44:47], v48 offset:6144
    ds_read_b64_tr_b16 a[4:5], v51 offset:0
    ds_read_b64_tr_b16 a[6:7], v51 offset:1024
    ds_read_b64_tr_b16 a[8:9], v52 offset:0
    ds_read_b64_tr_b16 a[10:11], v52 offset:1024
    ds_read_b64_tr_b16 a[12:13], v53 offset:0
    ds_read_b64_tr_b16 a[14:15], v53 offset:1024
    ds_read_b64_tr_b16 a[16:17], v54 offset:0
    ds_read_b64_tr_b16 a[18:19], v54 offset:1024
    ds_read_b64_tr_b16 a[20:21], v55 offset:0
    ds_read_b64_tr_b16 a[22:23], v55 offset:1024
    ds_read_b64_tr_b16 a[24:25], v56 offset:0
    ds_read_b64_tr_b16 a[26:27], v56 offset:1024
    ds_read_b64_tr_b16 a[28:29], v57 offset:0
    ds_read_b64_tr_b16 a[30:31], v57 offset:1024
    s_waitcnt lgkmcnt(0)
    v_mfma_f32_16x16x32_bf16 v[100:103], a[0:3], v[32:35], 0
    s_waitcnt vmcnt(16)
    ds_read_b64_tr_b16 a[48:49], v50 offset:8192
    v_mfma_f32_16x16x32_bf16 v[104:107], a[4:7], v[32:35], 0
    s_add_u32 m0, s38, 16384
    s_mov_b32 s36, 256
    ds_read_b64_tr_b16 a[50:51], v50 offset:9216
    v_mfma_f32_16x16x32_bf16 v[116:119], a[0:3], a[32:35], 0
    s_lshl_b32 s40, s6, 7
    buffer_load_dwordx4 v36, s[16:19], s36 offen offset:0 lds
    v_mfma_f32_16x16x32_bf16 v[148:151], a[0:3], a[36:39], 0
    s_add_u32 s41, s40, 0x292000
    ds_read_b128 a[80:83], v49 offset:0
    v_mfma_f32_16x16x32_bf16 v[180:183], a[0:3], a[40:43], 0
    s_add_u32 s40, s40, 0x290000
    ds_read_b128 a[84:87], v49 offset:2048
    v_mfma_f32_16x16x32_bf16 v[212:215], a[0:3], a[44:47], 0
    s_cmp_lt_u32 s6, 64
    s_cselect_b32 s40, s40, 0x2000000
    buffer_load_dwordx4 v37, s[16:19], s36 offen offset:1024 lds
    v_mfma_f32_16x16x32_bf16 v[216:219], a[4:7], a[44:47], 0
    s_cmp_eq_u32 s5, 1
    s_cselect_b32 s40, s40, 0x2000000
    ds_read_b128 a[88:91], v49 offset:4096
    v_mfma_f32_16x16x32_bf16 v[184:187], a[4:7], a[40:43], 0
    s_cmp_eq_u32 s5, 0
    s_cselect_b32 s40, s41, s40
    ds_read_b128 a[92:95], v49 offset:6144
    v_mfma_f32_16x16x32_bf16 v[152:155], a[4:7], a[36:39], 0
    s_lshl_b32 s41, s6, 2
    ds_read_b64_tr_b16 a[52:53], v51 offset:8192
    v_mfma_f32_16x16x32_bf16 v[120:123], a[4:7], a[32:35], 0
    s_add_u32 s41, s41, s5
    buffer_load_dwordx4 v38, s[16:19], s36 offen offset:2048 lds
    v_mfma_f32_16x16x32_bf16 v[124:127], a[8:11], a[32:35], 0
    s_cmp_eq_u32 s41, 1022
    s_cselect_b32 s40, 0x29b000, s40
    ds_read_b64_tr_b16 a[54:55], v51 offset:9216
    v_lshlrev_b32 v29, 2, v19
    v_mfma_f32_16x16x32_bf16 v[156:159], a[8:11], a[36:39], 0
    ds_read_b64_tr_b16 a[56:57], v52 offset:8192
    s_mov_b32 exec_hi, 0
    buffer_store_dword v28, v29, s[76:79], s40 offen sc1
    s_mov_b32 exec_hi, -1
    v_lshlrev_b32 v80, 16, v60
    v_and_b32 v81, 0xffff0000, v60
    v_mfma_f32_16x16x32_bf16 v[188:191], a[8:11], a[40:43], 0
    ds_read_b64_tr_b16 a[58:59], v52 offset:9216
    v_lshlrev_b32 v82, 16, v61
    v_mfma_f32_16x16x32_bf16 v[220:223], a[8:11], a[44:47], 0
    buffer_load_dwordx4 v39, s[16:19], s36 offen offset:3072 lds
    v_and_b32 v83, 0xffff0000, v61
    v_lshlrev_b32 v84, 16, v62
    v_mfma_f32_16x16x32_bf16 v[224:227], a[12:15], a[44:47], 0
    ds_read_b64_tr_b16 a[60:61], v53 offset:8192
    v_and_b32 v85, 0xffff0000, v62
    v_mfma_f32_16x16x32_bf16 v[192:195], a[12:15], a[40:43], 0
    ds_read_b64_tr_b16 a[62:63], v53 offset:9216
    v_lshlrev_b32 v86, 16, v63
    v_mfma_f32_16x16x32_bf16 v[160:163], a[12:15], a[36:39], 0
    s_add_u32 m0, s38, 20480
    ds_read_b64_tr_b16 a[64:65], v54 offset:8192
    v_and_b32 v87, 0xffff0000, v63
    v_lshlrev_b32 v88, 16, v64
    v_mfma_f32_16x16x32_bf16 v[128:131], a[12:15], a[32:35], 0
    buffer_load_dwordx4 v40, s[16:19], s36 offen offset:0 lds
    v_and_b32 v89, 0xffff0000, v64
    v_mfma_f32_16x16x32_bf16 v[132:135], a[16:19], a[32:35], 0
    ds_read_b64_tr_b16 a[66:67], v54 offset:9216
    v_lshlrev_b32 v90, 16, v65
    v_mfma_f32_16x16x32_bf16 v[164:167], a[16:19], a[36:39], 0
    ds_read_b64_tr_b16 a[68:69], v55 offset:8192
    v_and_b32 v91, 0xffff0000, v65
    v_lshlrev_b32 v92, 16, v66
    v_mfma_f32_16x16x32_bf16 v[196:199], a[16:19], a[40:43], 0
    buffer_load_dwordx4 v41, s[16:19], s36 offen offset:1024 lds
    v_and_b32 v93, 0xffff0000, v66
    v_mfma_f32_16x16x32_bf16 v[228:231], a[16:19], a[44:47], 0
    ds_read_b64_tr_b16 a[70:71], v55 offset:9216
    v_lshlrev_b32 v94, 16, v67
    v_mfma_f32_16x16x32_bf16 v[232:235], a[20:23], a[44:47], 0
    ds_read_b64_tr_b16 a[72:73], v56 offset:8192
    v_and_b32 v95, 0xffff0000, v67
    v_mfma_f32_16x16x32_bf16 v[200:203], a[20:23], a[40:43], 0
    ds_read_b64_tr_b16 a[74:75], v56 offset:9216
    v_lshlrev_b32 v96, 16, v68
    v_and_b32 v97, 0xffff0000, v68
    v_mfma_f32_16x16x32_bf16 v[168:171], a[20:23], a[36:39], 0
    buffer_load_dwordx4 v42, s[16:19], s36 offen offset:2048 lds
    v_lshlrev_b32 v98, 16, v69
    v_mfma_f32_16x16x32_bf16 v[136:139], a[20:23], a[32:35], 0
    ds_read_b64_tr_b16 a[76:77], v57 offset:8192
    v_and_b32 v99, 0xffff0000, v69
    v_mfma_f32_16x16x32_bf16 v[140:143], a[24:27], a[32:35], 0
    ds_read_b64_tr_b16 a[78:79], v57 offset:9216
    v_add_f32 v109, v80, v81
    v_add_f32 v110, v82, v83
    v_mfma_f32_16x16x32_bf16 v[172:175], a[24:27], a[36:39], 0
    v_add_f32 v109, v109, v84
    v_add_f32 v110, v110, v85
    v_mfma_f32_16x16x32_bf16 v[204:207], a[24:27], a[40:43], 0
    buffer_load_dwordx4 v43, s[16:19], s36 offen offset:3072 lds
    v_add_f32 v109, v109, v86
    v_mfma_f32_16x16x32_bf16 v[236:239], a[24:27], a[44:47], 0
    v_add_f32 v110, v110, v87
    v_add_f32 v109, v109, v88
    v_mfma_f32_16x16x32_bf16 v[240:243], a[28:31], a[44:47], 0
    v_add_f32 v110, v110, v89
    v_add_f32 v109, v109, v90
    v_mfma_f32_16x16x32_bf16 v[208:211], a[28:31], a[40:43], 0
    v_add_f32 v110, v110, v91
    v_add_f32 v109, v109, v92
    v_mfma_f32_16x16x32_bf16 v[176:179], a[28:31], a[36:39], 0
    v_add_f32 v110, v110, v93
    v_add_f32 v109, v109, v94
    v_mfma_f32_16x16x32_bf16 v[144:147], a[28:31], a[32:35], 0
    v_add_f32 v110, v110, v95
    v_add_f32 v109, v109, v96
    s_waitcnt vmcnt(13) lgkmcnt(0)
    s_barrier
    v_mfma_f32_16x16x32_bf16 v[100:103], a[48:51], v[32:35], v[100:103]
    ds_read_b64_tr_b16 a[0:1], v50 offset:16384
    v_add_f32 v110, v110, v97
    v_mfma_f32_16x16x32_bf16 v[104:107], a[52:55], v[32:35], v[104:107]
    s_add_u32 m0, s39, 0
    s_mov_b32 s37, 1572864
    ds_read_b64_tr_b16 a[2:3], v50 offset:17408
    v_add_f32 v109, v109, v98
    v_mfma_f32_16x16x32_bf16 v[116:119], a[48:51], a[80:83], v[116:119]
    buffer_load_dwordx4 v44, s[20:23], s37 offen offset:0 lds
    v_mfma_f32_16x16x32_bf16 v[148:151], a[48:51], a[84:87], v[148:151]
    ds_read_b128 a[32:35], v48 offset:8192
    v_add_f32 v110, v110, v99
    v_mfma_f32_16x16x32_bf16 v[180:183], a[48:51], a[88:91], v[180:183]
    ds_read_b128 a[36:39], v48 offset:10240
    v_add_f32 v109, v109, v110
    v_mfma_f32_16x16x32_bf16 v[212:215], a[48:51], a[92:95], v[212:215]
    ds_read_b128 a[40:43], v48 offset:12288
    v_add_f32_dpp v109, v109, v109 quad_perm:[1,0,3,2] row_mask:0xf bank_mask:0xf
    v_mfma_f32_16x16x32_bf16 v[216:219], a[52:55], a[92:95], v[216:219]
    ds_read_b128 a[44:47], v48 offset:14336
    v_add_f32_dpp v109, v109, v109 quad_perm:[2,3,0,1] row_mask:0xf bank_mask:0xf
    v_mfma_f32_16x16x32_bf16 v[184:187], a[52:55], a[88:91], v[184:187]
    buffer_load_dwordx4 v45, s[20:23], s37 offen offset:1024 lds
    v_add_f32_dpp v109, v109, v109 row_half_mirror row_mask:0xf bank_mask:0xf
    v_mfma_f32_16x16x32_bf16 v[152:155], a[52:55], a[84:87], v[152:155]
    ds_read_b64_tr_b16 a[4:5], v51 offset:16384
    v_add_f32_dpp v109, v109, v109 row_mirror row_mask:0xf bank_mask:0xf
    v_mfma_f32_16x16x32_bf16 v[120:123], a[52:55], a[80:83], v[120:123]
    ds_read_b64_tr_b16 a[6:7], v51 offset:17408
    v_mov_b32 v110, v109
    v_mfma_f32_16x16x32_bf16 v[124:127], a[56:59], a[80:83], v[124:127]
    ds_read_b64_tr_b16 a[8:9], v52 offset:16384
    v_permlane16_swap_b32 v109, v110
    v_mfma_f32_16x16x32_bf16 v[156:159], a[56:59], a[84:87], v[156:159]
    ds_read_b64_tr_b16 a[10:11], v52 offset:17408
    v_add_f32 v109, v109, v110
    v_mfma_f32_16x16x32_bf16 v[188:191], a[56:59], a[88:91], v[188:191]
    buffer_load_dwordx4 v46, s[20:23], s37 offen offset:2048 lds
    v_mul_f32 v111, 0x3acccccd, v109
    v_sub_f32 v60, v80, v111
    v_mfma_f32_16x16x32_bf16 v[220:223], a[56:59], a[92:95], v[220:223]
    ds_read_b64_tr_b16 a[12:13], v53 offset:16384
    v_mul_f32 v109, v60, v60
    v_mfma_f32_16x16x32_bf16 v[224:227], a[60:63], a[92:95], v[224:227]
    ds_read_b64_tr_b16 a[14:15], v53 offset:17408
    v_sub_f32 v61, v81, v111
    v_mfma_f32_16x16x32_bf16 v[192:195], a[60:63], a[88:91], v[192:195]
    ds_read_b64_tr_b16 a[16:17], v54 offset:16384
    v_mul_f32 v112, v61, v61
    v_sub_f32 v60, v82, v111
    v_mfma_f32_16x16x32_bf16 v[160:163], a[60:63], a[84:87], v[160:163]
    ds_read_b64_tr_b16 a[18:19], v54 offset:17408
    v_fmac_f32 v109, v60, v60
    v_mfma_f32_16x16x32_bf16 v[128:131], a[60:63], a[80:83], v[128:131]
    buffer_load_dwordx4 v47, s[20:23], s37 offen offset:3072 lds
    v_sub_f32 v61, v83, v111
    v_mfma_f32_16x16x32_bf16 v[132:135], a[64:67], a[80:83], v[132:135]
    ds_read_b64_tr_b16 a[20:21], v55 offset:16384
    v_fmac_f32 v112, v61, v61
    v_mfma_f32_16x16x32_bf16 v[164:167], a[64:67], a[84:87], v[164:167]
    ds_read_b64_tr_b16 a[22:23], v55 offset:17408
    v_sub_f32 v60, v84, v111
    v_fmac_f32 v109, v60, v60
    v_mfma_f32_16x16x32_bf16 v[196:199], a[64:67], a[88:91], v[196:199]
    ds_read_b64_tr_b16 a[24:25], v56 offset:16384
    v_sub_f32 v61, v85, v111
    v_mfma_f32_16x16x32_bf16 v[228:231], a[64:67], a[92:95], v[228:231]
    s_add_u32 m0, s38, 0
    s_mov_b32 s36, 384
    ds_read_b64_tr_b16 a[26:27], v56 offset:17408
    v_fmac_f32 v112, v61, v61
    v_mfma_f32_16x16x32_bf16 v[232:235], a[68:71], a[92:95], v[232:235]
    buffer_load_dwordx4 v36, s[16:19], s36 offen offset:0 lds
    v_sub_f32 v60, v86, v111
    v_fmac_f32 v109, v60, v60
    v_mfma_f32_16x16x32_bf16 v[200:203], a[68:71], a[88:91], v[200:203]
    ds_read_b64_tr_b16 a[28:29], v57 offset:16384
    v_sub_f32 v61, v87, v111
    v_mfma_f32_16x16x32_bf16 v[168:171], a[68:71], a[84:87], v[168:171]
    ds_read_b64_tr_b16 a[30:31], v57 offset:17408
    v_fmac_f32 v112, v61, v61
    v_mfma_f32_16x16x32_bf16 v[136:139], a[68:71], a[80:83], v[136:139]
    v_sub_f32 v60, v88, v111
    v_fmac_f32 v109, v60, v60
    v_mfma_f32_16x16x32_bf16 v[140:143], a[72:75], a[80:83], v[140:143]
    v_sub_f32 v61, v89, v111
    v_fmac_f32 v112, v61, v61
    v_mfma_f32_16x16x32_bf16 v[172:175], a[72:75], a[84:87], v[172:175]
    buffer_load_dwordx4 v37, s[16:19], s36 offen offset:1024 lds
    v_sub_f32 v60, v90, v111
    v_mfma_f32_16x16x32_bf16 v[204:207], a[72:75], a[88:91], v[204:207]
    v_fmac_f32 v109, v60, v60
    v_sub_f32 v61, v91, v111
    v_mfma_f32_16x16x32_bf16 v[236:239], a[72:75], a[92:95], v[236:239]
    v_fmac_f32 v112, v61, v61
    v_sub_f32 v60, v92, v111
    v_mfma_f32_16x16x32_bf16 v[240:243], a[76:79], a[92:95], v[240:243]
    v_fmac_f32 v109, v60, v60
    v_sub_f32 v61, v93, v111
    v_mfma_f32_16x16x32_bf16 v[208:211], a[76:79], a[88:91], v[208:211]
    v_fmac_f32 v112, v61, v61
    v_sub_f32 v60, v94, v111
    v_mfma_f32_16x16x32_bf16 v[176:179], a[76:79], a[84:87], v[176:179]
    v_fmac_f32 v109, v60, v60
    v_sub_f32 v61, v95, v111
    v_mfma_f32_16x16x32_bf16 v[144:147], a[76:79], a[80:83], v[144:147]
    v_fmac_f32 v112, v61, v61
    v_sub_f32 v60, v96, v111
    s_waitcnt lgkmcnt(0)
    v_mfma_f32_16x16x32_bf16 v[100:103], a[0:3], v[32:35], v[100:103]
    ds_read_b64_tr_b16 a[48:49], v50 offset:24576
    v_fmac_f32 v109, v60, v60
    v_mfma_f32_16x16x32_bf16 v[104:107], a[4:7], v[32:35], v[104:107]
    ds_read_b64_tr_b16 a[50:51], v50 offset:25600
    v_sub_f32 v61, v97, v111
    v_mfma_f32_16x16x32_bf16 v[116:119], a[0:3], a[32:35], v[116:119]
    buffer_load_dwordx4 v38, s[16:19], s36 offen offset:2048 lds
    v_mfma_f32_16x16x32_bf16 v[148:151], a[0:3], a[36:39], v[148:151]
    ds_read_b128 a[80:83], v49 offset:8192
    v_fmac_f32 v112, v61, v61
    v_mfma_f32_16x16x32_bf16 v[180:183], a[0:3], a[40:43], v[180:183]
    ds_read_b128 a[84:87], v49 offset:10240
    v_sub_f32 v60, v98, v111
    v_mfma_f32_16x16x32_bf16 v[212:215], a[0:3], a[44:47], v[212:215]
    ds_read_b128 a[88:91], v49 offset:12288
    v_fmac_f32 v109, v60, v60
    v_mfma_f32_16x16x32_bf16 v[216:219], a[4:7], a[44:47], v[216:219]
    ds_read_b128 a[92:95], v49 offset:14336
    v_sub_f32 v61, v99, v111
    v_mfma_f32_16x16x32_bf16 v[184:187], a[4:7], a[40:43], v[184:187]
    buffer_load_dwordx4 v39, s[16:19], s36 offen offset:3072 lds
    v_mfma_f32_16x16x32_bf16 v[152:155], a[4:7], a[36:39], v[152:155]
    ds_read_b64_tr_b16 a[52:53], v51 offset:24576
    v_fmac_f32 v112, v61, v61
    v_mfma_f32_16x16x32_bf16 v[120:123], a[4:7], a[32:35], v[120:123]
    ds_read_b64_tr_b16 a[54:55], v51 offset:25600
    v_add_f32 v109, v109, v112
    v_mfma_f32_16x16x32_bf16 v[124:127], a[8:11], a[32:35], v[124:127]
    ds_read_b64_tr_b16 a[56:57], v52 offset:24576
    v_add_f32_dpp v109, v109, v109 quad_perm:[1,0,3,2] row_mask:0xf bank_mask:0xf
    v_mfma_f32_16x16x32_bf16 v[156:159], a[8:11], a[36:39], v[156:159]
    s_add_u32 m0, s38, 4096
    ds_read_b64_tr_b16 a[58:59], v52 offset:25600
    v_add_f32_dpp v109, v109, v109 quad_perm:[2,3,0,1] row_mask:0xf bank_mask:0xf
    v_mfma_f32_16x16x32_bf16 v[188:191], a[8:11], a[40:43], v[188:191]
    buffer_load_dwordx4 v40, s[16:19], s36 offen offset:0 lds
    v_add_f32_dpp v109, v109, v109 row_half_mirror row_mask:0xf bank_mask:0xf
    v_mfma_f32_16x16x32_bf16 v[220:223], a[8:11], a[44:47], v[220:223]
    ds_read_b64_tr_b16 a[60:61], v53 offset:24576
    v_add_f32_dpp v109, v109, v109 row_mirror row_mask:0xf bank_mask:0xf
    v_mov_b32 v110, v109
    v_mfma_f32_16x16x32_bf16 v[224:227], a[12:15], a[44:47], v[224:227]
    ds_read_b64_tr_b16 a[62:63], v53 offset:25600
    v_permlane16_swap_b32 v109, v110
    v_mfma_f32_16x16x32_bf16 v[192:195], a[12:15], a[40:43], v[192:195]
    ds_read_b64_tr_b16 a[64:65], v54 offset:24576
    v_add_f32 v109, v109, v110
    v_mul_f32 v109, 0x3acccccd, v109
    v_mfma_f32_16x16x32_bf16 v[160:163], a[12:15], a[36:39], v[160:163]
    ds_read_b64_tr_b16 a[66:67], v54 offset:25600
    v_cvt_pk_bf16_f32 v110, v111, v109
    v_mfma_f32_16x16x32_bf16 v[128:131], a[12:15], a[32:35], v[128:131]
    buffer_load_dwordx4 v41, s[16:19], s36 offen offset:1024 lds
    v_lshlrev_b32 v111, 16, v110
    v_mfma_f32_16x16x32_bf16 v[132:135], a[16:19], a[32:35], v[132:135]
    ds_read_b64_tr_b16 a[68:69], v55 offset:24576
    v_and_b32 v109, 0xffff0000, v110
    v_add_f32 v109, 0x3727c5ac, v109
    v_mfma_f32_16x16x32_bf16 v[164:167], a[16:19], a[36:39], v[164:167]
    ds_read_b64_tr_b16 a[70:71], v55 offset:25600
    v_cvt_pk_bf16_f32 v109, v109, v109
    v_mfma_f32_16x16x32_bf16 v[196:199], a[16:19], a[40:43], v[196:199]
    ds_read_b64_tr_b16 a[72:73], v56 offset:24576
    v_lshlrev_b32 v109, 16, v109
    v_mfma_f32_16x16x32_bf16 v[228:231], a[16:19], a[44:47], v[228:231]
    ds_read_b64_tr_b16 a[74:75], v56 offset:25600
    v_sqrt_f32 v109, v109
    v_sub_f32 v80, v80, v111
    v_mfma_f32_16x16x32_bf16 v[232:235], a[20:23], a[44:47], v[232:235]
    buffer_load_dwordx4 v42, s[16:19], s36 offen offset:2048 lds
    v_sub_f32 v81, v81, v111
    v_mfma_f32_16x16x32_bf16 v[200:203], a[20:23], a[40:43], v[200:203]
    ds_read_b64_tr_b16 a[76:77], v57 offset:24576
    v_sub_f32 v82, v82, v111
    v_mfma_f32_16x16x32_bf16 v[168:171], a[20:23], a[36:39], v[168:171]
    ds_read_b64_tr_b16 a[78:79], v57 offset:25600
    v_sub_f32 v83, v83, v111
    v_mfma_f32_16x16x32_bf16 v[136:139], a[20:23], a[32:35], v[136:139]
    v_sub_f32 v84, v84, v111
    v_sub_f32 v85, v85, v111
    v_mfma_f32_16x16x32_bf16 v[140:143], a[24:27], a[32:35], v[140:143]
    v_sub_f32 v86, v86, v111
    v_sub_f32 v87, v87, v111
    v_mfma_f32_16x16x32_bf16 v[172:175], a[24:27], a[36:39], v[172:175]
    buffer_load_dwordx4 v43, s[16:19], s36 offen offset:3072 lds
    v_sub_f32 v88, v88, v111
    v_mfma_f32_16x16x32_bf16 v[204:207], a[24:27], a[40:43], v[204:207]
    v_sub_f32 v89, v89, v111
    v_sub_f32 v90, v90, v111
    v_mfma_f32_16x16x32_bf16 v[236:239], a[24:27], a[44:47], v[236:239]
    v_sub_f32 v91, v91, v111
    v_sub_f32 v92, v92, v111
    v_mfma_f32_16x16x32_bf16 v[240:243], a[28:31], a[44:47], v[240:243]
    v_sub_f32 v93, v93, v111
    v_sub_f32 v94, v94, v111
    v_mfma_f32_16x16x32_bf16 v[208:211], a[28:31], a[40:43], v[208:211]
    v_sub_f32 v95, v95, v111
    v_sub_f32 v96, v96, v111
    v_mfma_f32_16x16x32_bf16 v[176:179], a[28:31], a[36:39], v[176:179]
    v_sub_f32 v97, v97, v111
    v_sub_f32 v98, v98, v111
    v_mfma_f32_16x16x32_bf16 v[144:147], a[28:31], a[32:35], v[144:147]
    v_sub_f32 v99, v99, v111
    v_cvt_pk_bf16_f32 v109, v109, v109
    s_waitcnt vmcnt(12) lgkmcnt(0)
    s_barrier
    v_mfma_f32_16x16x32_bf16 v[100:103], a[48:51], v[32:35], v[100:103]
    ds_read_b64_tr_b16 a[0:1], v50 offset:32768
    v_lshlrev_b32 v109, 16, v109
    v_mfma_f32_16x16x32_bf16 v[104:107], a[52:55], v[32:35], v[104:107]
    s_add_u32 m0, s39, 16384
    s_mov_b32 s37, 2097152
    ds_read_b64_tr_b16 a[2:3], v50 offset:33792
    v_mfma_f32_16x16x32_bf16 v[116:119], a[48:51], a[80:83], v[116:119]
    buffer_load_dwordx4 v44, s[20:23], s37 offen offset:0 lds
    v_mfma_f32_16x16x32_bf16 v[148:151], a[48:51], a[84:87], v[148:151]
    ds_read_b128 a[32:35], v48 offset:16384
    v_mfma_f32_16x16x32_bf16 v[180:183], a[48:51], a[88:91], v[180:183]
    ds_read_b128 a[36:39], v48 offset:18432
    v_rcp_f32 v112, v109
    v_mfma_f32_16x16x32_bf16 v[212:215], a[48:51], a[92:95], v[212:215]
    ds_read_b128 a[40:43], v48 offset:20480
    v_cvt_pk_bf16_f32 v60, v80, v81
    v_mfma_f32_16x16x32_bf16 v[216:219], a[52:55], a[92:95], v[216:219]
    ds_read_b128 a[44:47], v48 offset:22528
    v_cvt_pk_bf16_f32 v61, v82, v83
    v_mfma_f32_16x16x32_bf16 v[184:187], a[52:55], a[88:91], v[184:187]
    buffer_load_dwordx4 v45, s[20:23], s37 offen offset:1024 lds
    v_cvt_pk_bf16_f32 v62, v84, v85
    v_cvt_pk_bf16_f32 v63, v86, v87
    v_mfma_f32_16x16x32_bf16 v[152:155], a[52:55], a[84:87], v[152:155]
    ds_read_b64_tr_b16 a[4:5], v51 offset:32768
    v_cvt_pk_bf16_f32 v64, v88, v89
    v_mfma_f32_16x16x32_bf16 v[120:123], a[52:55], a[80:83], v[120:123]
    ds_read_b64_tr_b16 a[6:7], v51 offset:33792
    v_cvt_pk_bf16_f32 v65, v90, v91
    v_mfma_f32_16x16x32_bf16 v[124:127], a[56:59], a[80:83], v[124:127]
    ds_read_b64_tr_b16 a[8:9], v52 offset:32768
    v_cvt_pk_bf16_f32 v66, v92, v93
    v_mfma_f32_16x16x32_bf16 v[156:159], a[56:59], a[84:87], v[156:159]
    ds_read_b64_tr_b16 a[10:11], v52 offset:33792
    v_cvt_pk_bf16_f32 v67, v94, v95
    v_cvt_pk_bf16_f32 v68, v96, v97
    v_mfma_f32_16x16x32_bf16 v[188:191], a[56:59], a[88:91], v[188:191]
    buffer_load_dwordx4 v46, s[20:23], s37 offen offset:2048 lds
    v_cvt_pk_bf16_f32 v69, v98, v99
    v_mfma_f32_16x16x32_bf16 v[220:223], a[56:59], a[92:95], v[220:223]
    ds_read_b64_tr_b16 a[12:13], v53 offset:32768
    v_lshlrev_b32 v80, 16, v60
    v_mfma_f32_16x16x32_bf16 v[224:227], a[60:63], a[92:95], v[224:227]
    ds_read_b64_tr_b16 a[14:15], v53 offset:33792
    v_and_b32 v81, 0xffff0000, v60
    v_lshlrev_b32 v82, 16, v61
    v_mfma_f32_16x16x32_bf16 v[192:195], a[60:63], a[88:91], v[192:195]
    ds_read_b64_tr_b16 a[16:17], v54 offset:32768
    v_and_b32 v83, 0xffff0000, v61
    v_mfma_f32_16x16x32_bf16 v[160:163], a[60:63], a[84:87], v[160:163]
    ds_read_b64_tr_b16 a[18:19], v54 offset:33792
    v_lshlrev_b32 v84, 16, v62
    v_mfma_f32_16x16x32_bf16 v[128:131], a[60:63], a[80:83], v[128:131]
    buffer_load_dwordx4 v47, s[20:23], s37 offen offset:3072 lds
    v_and_b32 v85, 0xffff0000, v62
    v_lshlrev_b32 v86, 16, v63
    v_mfma_f32_16x16x32_bf16 v[132:135], a[64:67], a[80:83], v[132:135]
    ds_read_b64_tr_b16 a[20:21], v55 offset:32768
    v_and_b32 v87, 0xffff0000, v63
    v_mfma_f32_16x16x32_bf16 v[164:167], a[64:67], a[84:87], v[164:167]
    ds_read_b64_tr_b16 a[22:23], v55 offset:33792
    v_lshlrev_b32 v88, 16, v64
    v_mfma_f32_16x16x32_bf16 v[196:199], a[64:67], a[88:91], v[196:199]
    ds_read_b64_tr_b16 a[24:25], v56 offset:32768
    v_and_b32 v89, 0xffff0000, v64
    v_mfma_f32_16x16x32_bf16 v[228:231], a[64:67], a[92:95], v[228:231]
    s_add_u32 m0, s38, 8192
    s_mov_b32 s36, 512
    ds_read_b64_tr_b16 a[26:27], v56 offset:33792
    v_lshlrev_b32 v90, 16, v65
    v_and_b32 v91, 0xffff0000, v65
    v_mfma_f32_16x16x32_bf16 v[232:235], a[68:71], a[92:95], v[232:235]
    buffer_load_dwordx4 v36, s[16:19], s36 offen offset:0 lds
    v_lshlrev_b32 v92, 16, v66
    v_mfma_f32_16x16x32_bf16 v[200:203], a[68:71], a[88:91], v[200:203]
    ds_read_b64_tr_b16 a[28:29], v57 offset:32768
    v_and_b32 v93, 0xffff0000, v66
    v_mfma_f32_16x16x32_bf16 v[168:171], a[68:71], a[84:87], v[168:171]
    ds_read_b64_tr_b16 a[30:31], v57 offset:33792
    v_lshlrev_b32 v94, 16, v67
    v_and_b32 v95, 0xffff0000, v67
    v_mfma_f32_16x16x32_bf16 v[136:139], a[68:71], a[80:83], v[136:139]
    v_lshlrev_b32 v96, 16, v68
    v_and_b32 v97, 0xffff0000, v68
    v_mfma_f32_16x16x32_bf16 v[140:143], a[72:75], a[80:83], v[140:143]
    v_lshlrev_b32 v98, 16, v69
    v_and_b32 v99, 0xffff0000, v69
    v_mfma_f32_16x16x32_bf16 v[172:175], a[72:75], a[84:87], v[172:175]
    buffer_load_dwordx4 v37, s[16:19], s36 offen offset:1024 lds
    v_mul_f32 v80, v80, v112
    v_mfma_f32_16x16x32_bf16 v[204:207], a[72:75], a[88:91], v[204:207]
    v_mul_f32 v81, v81, v112
    v_mul_f32 v82, v82, v112
    v_mfma_f32_16x16x32_bf16 v[236:239], a[72:75], a[92:95], v[236:239]
    v_mul_f32 v83, v83, v112
    v_mul_f32 v84, v84, v112
    v_mfma_f32_16x16x32_bf16 v[240:243], a[76:79], a[92:95], v[240:243]
    v_mul_f32 v85, v85, v112
    v_mul_f32 v86, v86, v112
    v_mfma_f32_16x16x32_bf16 v[208:211], a[76:79], a[88:91], v[208:211]
    v_mul_f32 v87, v87, v112
    v_mul_f32 v88, v88, v112
    v_mfma_f32_16x16x32_bf16 v[176:179], a[76:79], a[84:87], v[176:179]
    v_mul_f32 v89, v89, v112
    v_mul_f32 v90, v90, v112
    v_mfma_f32_16x16x32_bf16 v[144:147], a[76:79], a[80:83], v[144:147]
    v_mul_f32 v91, v91, v112
    v_mul_f32 v92, v92, v112
    s_waitcnt lgkmcnt(0)
    v_mfma_f32_16x16x32_bf16 v[100:103], a[0:3], v[32:35], v[100:103]
    ds_read_b64_tr_b16 a[48:49], v50 offset:40960
    v_mul_f32 v93, v93, v112
    v_mfma_f32_16x16x32_bf16 v[104:107], a[4:7], v[32:35], v[104:107]
    ds_read_b64_tr_b16 a[50:51], v50 offset:41984
    v_mul_f32 v94, v94, v112
    v_mfma_f32_16x16x32_bf16 v[116:119], a[0:3], a[32:35], v[116:119]
    buffer_load_dwordx4 v38, s[16:19], s36 offen offset:2048 lds
    v_mfma_f32_16x16x32_bf16 v[148:151], a[0:3], a[36:39], v[148:151]
    ds_read_b128 a[80:83], v49 offset:16384
    v_mul_f32 v95, v95, v112
    v_mfma_f32_16x16x32_bf16 v[180:183], a[0:3], a[40:43], v[180:183]
    ds_read_b128 a[84:87], v49 offset:18432
    v_mul_f32 v96, v96, v112
    v_mfma_f32_16x16x32_bf16 v[212:215], a[0:3], a[44:47], v[212:215]
    ds_read_b128 a[88:91], v49 offset:20480
    v_mul_f32 v97, v97, v112
    v_mfma_f32_16x16x32_bf16 v[216:219], a[4:7], a[44:47], v[216:219]
    ds_read_b128 a[92:95], v49 offset:22528
    v_mul_f32 v98, v98, v112
    v_mfma_f32_16x16x32_bf16 v[184:187], a[4:7], a[40:43], v[184:187]
    buffer_load_dwordx4 v39, s[16:19], s36 offen offset:3072 lds
    v_mfma_f32_16x16x32_bf16 v[152:155], a[4:7], a[36:39], v[152:155]
    ds_read_b64_tr_b16 a[52:53], v51 offset:40960
    v_mul_f32 v99, v99, v112
    v_mfma_f32_16x16x32_bf16 v[120:123], a[4:7], a[32:35], v[120:123]
    ds_read_b64_tr_b16 a[54:55], v51 offset:41984
    v_cvt_pk_bf16_f32 v60, v80, v81
    v_mfma_f32_16x16x32_bf16 v[124:127], a[8:11], a[32:35], v[124:127]
    ds_read_b64_tr_b16 a[56:57], v52 offset:40960
    v_cvt_pk_bf16_f32 v61, v82, v83
    v_mfma_f32_16x16x32_bf16 v[156:159], a[8:11], a[36:39], v[156:159]
    s_add_u32 m0, s38, 12288
    ds_read_b64_tr_b16 a[58:59], v52 offset:41984
    v_cvt_pk_bf16_f32 v62, v84, v85
    v_mfma_f32_16x16x32_bf16 v[188:191], a[8:11], a[40:43], v[188:191]
    buffer_load_dwordx4 v40, s[16:19], s36 offen offset:0 lds
    v_cvt_pk_bf16_f32 v63, v86, v87
    v_mfma_f32_16x16x32_bf16 v[220:223], a[8:11], a[44:47], v[220:223]
    ds_read_b64_tr_b16 a[60:61], v53 offset:40960
    v_cvt_pk_bf16_f32 v64, v88, v89
    v_cvt_pk_bf16_f32 v65, v90, v91
    v_mfma_f32_16x16x32_bf16 v[224:227], a[12:15], a[44:47], v[224:227]
    ds_read_b64_tr_b16 a[62:63], v53 offset:41984
    v_cvt_pk_bf16_f32 v66, v92, v93
    v_mfma_f32_16x16x32_bf16 v[192:195], a[12:15], a[40:43], v[192:195]
    ds_read_b64_tr_b16 a[64:65], v54 offset:40960
    v_cvt_pk_bf16_f32 v67, v94, v95
    v_mfma_f32_16x16x32_bf16 v[160:163], a[12:15], a[36:39], v[160:163]
    ds_read_b64_tr_b16 a[66:67], v54 offset:41984
    v_cvt_pk_bf16_f32 v68, v96, v97
    v_mfma_f32_16x16x32_bf16 v[128:131], a[12:15], a[32:35], v[128:131]
    buffer_load_dwordx4 v41, s[16:19], s36 offen offset:1024 lds
    v_cvt_pk_bf16_f32 v69, v98, v99
    v_mov_b32 v109, 0
    v_mfma_f32_16x16x32_bf16 v[132:135], a[16:19], a[32:35], v[132:135]
    ds_read_b64_tr_b16 a[68:69], v55 offset:40960
    v_dot2c_f32_bf16 v109, v60, v70
    v_dot2c_f32_bf16 v109, v61, v71
    v_dot2c_f32_bf16 v109, v62, v72
    v_dot2c_f32_bf16 v109, v63, v73
    v_dot2c_f32_bf16 v109, v64, v74
    v_dot2c_f32_bf16 v109, v65, v75
    v_dot2c_f32_bf16 v109, v66, v76
    v_dot2c_f32_bf16 v109, v67, v77
    v_dot2c_f32_bf16 v109, v68, v78
    v_dot2c_f32_bf16 v109, v69, v79
    s_nop 2
    v_mfma_f32_16x16x32_bf16 v[164:167], a[16:19], a[36:39], v[164:167]
    ds_read_b64_tr_b16 a[70:71], v55 offset:41984
    v_add_f32_dpp v109, v109, v109 quad_perm:[1,0,3,2] row_mask:0xf bank_mask:0xf
    v_mfma_f32_16x16x32_bf16 v[196:199], a[16:19], a[40:43], v[196:199]
    ds_read_b64_tr_b16 a[72:73], v56 offset:40960
    v_add_f32_dpp v109, v109, v109 quad_perm:[2,3,0,1] row_mask:0xf bank_mask:0xf
    v_mfma_f32_16x16x32_bf16 v[228:231], a[16:19], a[44:47], v[228:231]
    ds_read_b64_tr_b16 a[74:75], v56 offset:41984
    v_add_f32_dpp v109, v109, v109 row_half_mirror row_mask:0xf bank_mask:0xf
    v_mfma_f32_16x16x32_bf16 v[232:235], a[20:23], a[44:47], v[232:235]
    buffer_load_dwordx4 v42, s[16:19], s36 offen offset:2048 lds
    v_add_f32_dpp v109, v109, v109 row_mirror row_mask:0xf bank_mask:0xf
    v_mov_b32 v110, v109
    v_mfma_f32_16x16x32_bf16 v[200:203], a[20:23], a[40:43], v[200:203]
    ds_read_b64_tr_b16 a[76:77], v57 offset:40960
    v_permlane16_swap_b32 v109, v110
    v_add_f32 v109, v109, v110
    v_mfma_f32_16x16x32_bf16 v[168:171], a[20:23], a[36:39], v[168:171]
    ds_read_b64_tr_b16 a[78:79], v57 offset:41984
    v_cvt_pk_bf16_f32 v109, v109, v109
    v_mfma_f32_16x16x32_bf16 v[136:139], a[20:23], a[32:35], v[136:139]
    v_lshlrev_b32 v109, 16, v109
    v_ashrrev_i32 v110, 31, v109
    v_mfma_f32_16x16x32_bf16 v[140:143], a[24:27], a[32:35], v[140:143]
    v_or_b32 v110, 0x80000000, v110
    v_xor_b32 v109, v109, v110
    v_mfma_f32_16x16x32_bf16 v[172:175], a[24:27], a[36:39], v[172:175]
    buffer_load_dwordx4 v43, s[16:19], s36 offen offset:3072 lds
    v_and_b32 v109, 0xffff0000, v109
    v_mfma_f32_16x16x32_bf16 v[204:207], a[24:27], a[40:43], v[204:207]
    v_sub_u32 v110, 0xffff, v108
    v_or_b32 v62, v109, v110
    v_mfma_f32_16x16x32_bf16 v[236:239], a[24:27], a[44:47], v[236:239]
    v_mov_b32 v60, v111
    v_mov_b32 v61, v112
    v_mfma_f32_16x16x32_bf16 v[240:243], a[28:31], a[44:47], v[240:243]
    v_mov_b32 v63, 0
    v_lshlrev_b32 v110, 4, v108
    v_mfma_f32_16x16x32_bf16 v[208:211], a[28:31], a[40:43], v[208:211]
    s_mov_b32 s40, 0x280000
    s_mov_b32 exec_lo, 1
    s_mov_b32 exec_hi, 1
    buffer_store_dwordx4 v[60:63], v110, s[76:79], s40 offen sc1
    s_mov_b64 exec, -1
    v_mfma_f32_16x16x32_bf16 v[176:179], a[28:31], a[36:39], v[176:179]
    v_mfma_f32_16x16x32_bf16 v[144:147], a[28:31], a[32:35], v[144:147]
    s_waitcnt vmcnt(13) lgkmcnt(0)
    s_barrier
    v_mfma_f32_16x16x32_bf16 v[100:103], a[48:51], v[32:35], v[100:103]
    ds_read_b64_tr_b16 a[0:1], v50 offset:0
    v_mfma_f32_16x16x32_bf16 v[104:107], a[52:55], v[32:35], v[104:107]
    s_add_u32 m0, s39, 32768
    s_mov_b32 s37, 2621440
    ds_read_b64_tr_b16 a[2:3], v50 offset:1024
    v_mfma_f32_16x16x32_bf16 v[116:119], a[48:51], a[80:83], v[116:119]
    buffer_load_dwordx4 v44, s[20:23], s37 offen offset:0 lds
    v_mfma_f32_16x16x32_bf16 v[148:151], a[48:51], a[84:87], v[148:151]
    ds_read_b128 a[32:35], v48 offset:0
    v_mfma_f32_16x16x32_bf16 v[180:183], a[48:51], a[88:91], v[180:183]
    ds_read_b128 a[36:39], v48 offset:2048
    v_mfma_f32_16x16x32_bf16 v[212:215], a[48:51], a[92:95], v[212:215]
    ds_read_b128 a[40:43], v48 offset:4096
    v_mfma_f32_16x16x32_bf16 v[216:219], a[52:55], a[92:95], v[216:219]
    ds_read_b128 a[44:47], v48 offset:6144
    v_mfma_f32_16x16x32_bf16 v[184:187], a[52:55], a[88:91], v[184:187]
    buffer_load_dwordx4 v45, s[20:23], s37 offen offset:1024 lds
    v_mfma_f32_16x16x32_bf16 v[152:155], a[52:55], a[84:87], v[152:155]
    ds_read_b64_tr_b16 a[4:5], v51 offset:0
    v_mfma_f32_16x16x32_bf16 v[120:123], a[52:55], a[80:83], v[120:123]
    ds_read_b64_tr_b16 a[6:7], v51 offset:1024
    v_mfma_f32_16x16x32_bf16 v[124:127], a[56:59], a[80:83], v[124:127]
    ds_read_b64_tr_b16 a[8:9], v52 offset:0
    v_mfma_f32_16x16x32_bf16 v[156:159], a[56:59], a[84:87], v[156:159]
    ds_read_b64_tr_b16 a[10:11], v52 offset:1024
    v_mfma_f32_16x16x32_bf16 v[188:191], a[56:59], a[88:91], v[188:191]
    buffer_load_dwordx4 v46, s[20:23], s37 offen offset:2048 lds
    v_mfma_f32_16x16x32_bf16 v[220:223], a[56:59], a[92:95], v[220:223]
    ds_read_b64_tr_b16 a[12:13], v53 offset:0
    v_mfma_f32_16x16x32_bf16 v[224:227], a[60:63], a[92:95], v[224:227]
    ds_read_b64_tr_b16 a[14:15], v53 offset:1024
    v_mfma_f32_16x16x32_bf16 v[192:195], a[60:63], a[88:91], v[192:195]
    ds_read_b64_tr_b16 a[16:17], v54 offset:0
    v_mfma_f32_16x16x32_bf16 v[160:163], a[60:63], a[84:87], v[160:163]
    ds_read_b64_tr_b16 a[18:19], v54 offset:1024
    v_mfma_f32_16x16x32_bf16 v[128:131], a[60:63], a[80:83], v[128:131]
    buffer_load_dwordx4 v47, s[20:23], s37 offen offset:3072 lds
    v_mfma_f32_16x16x32_bf16 v[132:135], a[64:67], a[80:83], v[132:135]
    ds_read_b64_tr_b16 a[20:21], v55 offset:0
    v_mfma_f32_16x16x32_bf16 v[164:167], a[64:67], a[84:87], v[164:167]
    ds_read_b64_tr_b16 a[22:23], v55 offset:1024
    v_mfma_f32_16x16x32_bf16 v[196:199], a[64:67], a[88:91], v[196:199]
    ds_read_b64_tr_b16 a[24:25], v56 offset:0
    v_mfma_f32_16x16x32_bf16 v[228:231], a[64:67], a[92:95], v[228:231]
    s_add_u32 m0, s38, 16384
    s_mov_b32 s36, 640
    ds_read_b64_tr_b16 a[26:27], v56 offset:1024
    v_mfma_f32_16x16x32_bf16 v[232:235], a[68:71], a[92:95], v[232:235]
    buffer_load_dwordx4 v36, s[16:19], s36 offen offset:0 lds
    v_mfma_f32_16x16x32_bf16 v[200:203], a[68:71], a[88:91], v[200:203]
    ds_read_b64_tr_b16 a[28:29], v57 offset:0
    v_mfma_f32_16x16x32_bf16 v[168:171], a[68:71], a[84:87], v[168:171]
    ds_read_b64_tr_b16 a[30:31], v57 offset:1024
    v_mfma_f32_16x16x32_bf16 v[136:139], a[68:71], a[80:83], v[136:139]
    v_mfma_f32_16x16x32_bf16 v[140:143], a[72:75], a[80:83], v[140:143]
    v_mfma_f32_16x16x32_bf16 v[172:175], a[72:75], a[84:87], v[172:175]
    buffer_load_dwordx4 v37, s[16:19], s36 offen offset:1024 lds
    v_mfma_f32_16x16x32_bf16 v[204:207], a[72:75], a[88:91], v[204:207]
    v_mfma_f32_16x16x32_bf16 v[236:239], a[72:75], a[92:95], v[236:239]
    v_mfma_f32_16x16x32_bf16 v[240:243], a[76:79], a[92:95], v[240:243]
    v_mfma_f32_16x16x32_bf16 v[208:211], a[76:79], a[88:91], v[208:211]
    v_mfma_f32_16x16x32_bf16 v[176:179], a[76:79], a[84:87], v[176:179]
    v_mfma_f32_16x16x32_bf16 v[144:147], a[76:79], a[80:83], v[144:147]
    s_waitcnt lgkmcnt(0)
    v_mfma_f32_16x16x32_bf16 v[100:103], a[0:3], v[32:35], v[100:103]
    ds_read_b64_tr_b16 a[48:49], v50 offset:8192
    v_mfma_f32_16x16x32_bf16 v[104:107], a[4:7], v[32:35], v[104:107]
    ds_read_b64_tr_b16 a[50:51], v50 offset:9216
    v_mfma_f32_16x16x32_bf16 v[116:119], a[0:3], a[32:35], v[116:119]
    buffer_load_dwordx4 v38, s[16:19], s36 offen offset:2048 lds
    v_mfma_f32_16x16x32_bf16 v[148:151], a[0:3], a[36:39], v[148:151]
    ds_read_b128 a[80:83], v49 offset:0
    v_mfma_f32_16x16x32_bf16 v[180:183], a[0:3], a[40:43], v[180:183]
    ds_read_b128 a[84:87], v49 offset:2048
    v_mfma_f32_16x16x32_bf16 v[212:215], a[0:3], a[44:47], v[212:215]
    ds_read_b128 a[88:91], v49 offset:4096
    v_mfma_f32_16x16x32_bf16 v[216:219], a[4:7], a[44:47], v[216:219]
    ds_read_b128 a[92:95], v49 offset:6144
    v_mfma_f32_16x16x32_bf16 v[184:187], a[4:7], a[40:43], v[184:187]
    buffer_load_dwordx4 v39, s[16:19], s36 offen offset:3072 lds
    v_mfma_f32_16x16x32_bf16 v[152:155], a[4:7], a[36:39], v[152:155]
    ds_read_b64_tr_b16 a[52:53], v51 offset:8192
    v_mfma_f32_16x16x32_bf16 v[120:123], a[4:7], a[32:35], v[120:123]
    ds_read_b64_tr_b16 a[54:55], v51 offset:9216
    v_mfma_f32_16x16x32_bf16 v[124:127], a[8:11], a[32:35], v[124:127]
    ds_read_b64_tr_b16 a[56:57], v52 offset:8192
    v_mfma_f32_16x16x32_bf16 v[156:159], a[8:11], a[36:39], v[156:159]
    s_add_u32 m0, s38, 20480
    ds_read_b64_tr_b16 a[58:59], v52 offset:9216
    v_mfma_f32_16x16x32_bf16 v[188:191], a[8:11], a[40:43], v[188:191]
    buffer_load_dwordx4 v40, s[16:19], s36 offen offset:0 lds
    v_mfma_f32_16x16x32_bf16 v[220:223], a[8:11], a[44:47], v[220:223]
    ds_read_b64_tr_b16 a[60:61], v53 offset:8192
    v_mfma_f32_16x16x32_bf16 v[224:227], a[12:15], a[44:47], v[224:227]
    ds_read_b64_tr_b16 a[62:63], v53 offset:9216
    v_mfma_f32_16x16x32_bf16 v[192:195], a[12:15], a[40:43], v[192:195]
    ds_read_b64_tr_b16 a[64:65], v54 offset:8192
    v_mfma_f32_16x16x32_bf16 v[160:163], a[12:15], a[36:39], v[160:163]
    ds_read_b64_tr_b16 a[66:67], v54 offset:9216
    v_mfma_f32_16x16x32_bf16 v[128:131], a[12:15], a[32:35], v[128:131]
    buffer_load_dwordx4 v41, s[16:19], s36 offen offset:1024 lds
    v_mfma_f32_16x16x32_bf16 v[132:135], a[16:19], a[32:35], v[132:135]
    ds_read_b64_tr_b16 a[68:69], v55 offset:8192
    v_mfma_f32_16x16x32_bf16 v[164:167], a[16:19], a[36:39], v[164:167]
    ds_read_b64_tr_b16 a[70:71], v55 offset:9216
    v_mfma_f32_16x16x32_bf16 v[196:199], a[16:19], a[40:43], v[196:199]
    ds_read_b64_tr_b16 a[72:73], v56 offset:8192
    v_mfma_f32_16x16x32_bf16 v[228:231], a[16:19], a[44:47], v[228:231]
    ds_read_b64_tr_b16 a[74:75], v56 offset:9216
    v_mfma_f32_16x16x32_bf16 v[232:235], a[20:23], a[44:47], v[232:235]
    buffer_load_dwordx4 v42, s[16:19], s36 offen offset:2048 lds
    v_mfma_f32_16x16x32_bf16 v[200:203], a[20:23], a[40:43], v[200:203]
    ds_read_b64_tr_b16 a[76:77], v57 offset:8192
    v_mfma_f32_16x16x32_bf16 v[168:171], a[20:23], a[36:39], v[168:171]
    ds_read_b64_tr_b16 a[78:79], v57 offset:9216
    v_mfma_f32_16x16x32_bf16 v[136:139], a[20:23], a[32:35], v[136:139]
    v_mfma_f32_16x16x32_bf16 v[140:143], a[24:27], a[32:35], v[140:143]
    v_mfma_f32_16x16x32_bf16 v[172:175], a[24:27], a[36:39], v[172:175]
    buffer_load_dwordx4 v43, s[16:19], s36 offen offset:3072 lds
    v_mfma_f32_16x16x32_bf16 v[204:207], a[24:27], a[40:43], v[204:207]
    v_mfma_f32_16x16x32_bf16 v[236:239], a[24:27], a[44:47], v[236:239]
    v_mfma_f32_16x16x32_bf16 v[240:243], a[28:31], a[44:47], v[240:243]
    v_mfma_f32_16x16x32_bf16 v[208:211], a[28:31], a[40:43], v[208:211]
    v_mfma_f32_16x16x32_bf16 v[176:179], a[28:31], a[36:39], v[176:179]
    v_mfma_f32_16x16x32_bf16 v[144:147], a[28:31], a[32:35], v[144:147]
    s_waitcnt vmcnt(13) lgkmcnt(0)
    s_barrier
    v_mfma_f32_16x16x32_bf16 v[100:103], a[48:51], v[32:35], v[100:103]
    ds_read_b64_tr_b16 a[0:1], v50 offset:16384
    v_mfma_f32_16x16x32_bf16 v[104:107], a[52:55], v[32:35], v[104:107]
    s_add_u32 m0, s39, 0
    s_mov_b32 s37, 3145728
    ds_read_b64_tr_b16 a[2:3], v50 offset:17408
    v_mfma_f32_16x16x32_bf16 v[116:119], a[48:51], a[80:83], v[116:119]
    buffer_load_dwordx4 v44, s[20:23], s37 offen offset:0 lds
    v_mfma_f32_16x16x32_bf16 v[148:151], a[48:51], a[84:87], v[148:151]
    ds_read_b128 a[32:35], v48 offset:8192
    v_mfma_f32_16x16x32_bf16 v[180:183], a[48:51], a[88:91], v[180:183]
    ds_read_b128 a[36:39], v48 offset:10240
    v_mfma_f32_16x16x32_bf16 v[212:215], a[48:51], a[92:95], v[212:215]
    ds_read_b128 a[40:43], v48 offset:12288
    v_mfma_f32_16x16x32_bf16 v[216:219], a[52:55], a[92:95], v[216:219]
    ds_read_b128 a[44:47], v48 offset:14336
    v_mfma_f32_16x16x32_bf16 v[184:187], a[52:55], a[88:91], v[184:187]
    buffer_load_dwordx4 v45, s[20:23], s37 offen offset:1024 lds
    v_mfma_f32_16x16x32_bf16 v[152:155], a[52:55], a[84:87], v[152:155]
    ds_read_b64_tr_b16 a[4:5], v51 offset:16384
    v_mfma_f32_16x16x32_bf16 v[120:123], a[52:55], a[80:83], v[120:123]
    ds_read_b64_tr_b16 a[6:7], v51 offset:17408
    v_mfma_f32_16x16x32_bf16 v[124:127], a[56:59], a[80:83], v[124:127]
    ds_read_b64_tr_b16 a[8:9], v52 offset:16384
    v_mfma_f32_16x16x32_bf16 v[156:159], a[56:59], a[84:87], v[156:159]
    ds_read_b64_tr_b16 a[10:11], v52 offset:17408
    v_mfma_f32_16x16x32_bf16 v[188:191], a[56:59], a[88:91], v[188:191]
    buffer_load_dwordx4 v46, s[20:23], s37 offen offset:2048 lds
    v_mfma_f32_16x16x32_bf16 v[220:223], a[56:59], a[92:95], v[220:223]
    ds_read_b64_tr_b16 a[12:13], v53 offset:16384
    v_mfma_f32_16x16x32_bf16 v[224:227], a[60:63], a[92:95], v[224:227]
    ds_read_b64_tr_b16 a[14:15], v53 offset:17408
    v_mfma_f32_16x16x32_bf16 v[192:195], a[60:63], a[88:91], v[192:195]
    ds_read_b64_tr_b16 a[16:17], v54 offset:16384
    v_mfma_f32_16x16x32_bf16 v[160:163], a[60:63], a[84:87], v[160:163]
    ds_read_b64_tr_b16 a[18:19], v54 offset:17408
    v_mfma_f32_16x16x32_bf16 v[128:131], a[60:63], a[80:83], v[128:131]
    buffer_load_dwordx4 v47, s[20:23], s37 offen offset:3072 lds
    v_mfma_f32_16x16x32_bf16 v[132:135], a[64:67], a[80:83], v[132:135]
    ds_read_b64_tr_b16 a[20:21], v55 offset:16384
    v_mfma_f32_16x16x32_bf16 v[164:167], a[64:67], a[84:87], v[164:167]
    ds_read_b64_tr_b16 a[22:23], v55 offset:17408
    v_mfma_f32_16x16x32_bf16 v[196:199], a[64:67], a[88:91], v[196:199]
    ds_read_b64_tr_b16 a[24:25], v56 offset:16384
    v_mfma_f32_16x16x32_bf16 v[228:231], a[64:67], a[92:95], v[228:231]
    s_add_u32 m0, s38, 0
    s_mov_b32 s36, 768
    ds_read_b64_tr_b16 a[26:27], v56 offset:17408
    v_mfma_f32_16x16x32_bf16 v[232:235], a[68:71], a[92:95], v[232:235]
    buffer_load_dwordx4 v36, s[16:19], s36 offen offset:0 lds
    v_mfma_f32_16x16x32_bf16 v[200:203], a[68:71], a[88:91], v[200:203]
    ds_read_b64_tr_b16 a[28:29], v57 offset:16384
    v_mfma_f32_16x16x32_bf16 v[168:171], a[68:71], a[84:87], v[168:171]
    ds_read_b64_tr_b16 a[30:31], v57 offset:17408
    v_mfma_f32_16x16x32_bf16 v[136:139], a[68:71], a[80:83], v[136:139]
    v_mfma_f32_16x16x32_bf16 v[140:143], a[72:75], a[80:83], v[140:143]
    v_mfma_f32_16x16x32_bf16 v[172:175], a[72:75], a[84:87], v[172:175]
    buffer_load_dwordx4 v37, s[16:19], s36 offen offset:1024 lds
    v_mfma_f32_16x16x32_bf16 v[204:207], a[72:75], a[88:91], v[204:207]
    v_mfma_f32_16x16x32_bf16 v[236:239], a[72:75], a[92:95], v[236:239]
    v_mfma_f32_16x16x32_bf16 v[240:243], a[76:79], a[92:95], v[240:243]
    v_mfma_f32_16x16x32_bf16 v[208:211], a[76:79], a[88:91], v[208:211]
    v_mfma_f32_16x16x32_bf16 v[176:179], a[76:79], a[84:87], v[176:179]
    v_mfma_f32_16x16x32_bf16 v[144:147], a[76:79], a[80:83], v[144:147]
    s_waitcnt lgkmcnt(0)
    v_mfma_f32_16x16x32_bf16 v[100:103], a[0:3], v[32:35], v[100:103]
    ds_read_b64_tr_b16 a[48:49], v50 offset:24576
    v_mfma_f32_16x16x32_bf16 v[104:107], a[4:7], v[32:35], v[104:107]
    ds_read_b64_tr_b16 a[50:51], v50 offset:25600
    v_mfma_f32_16x16x32_bf16 v[116:119], a[0:3], a[32:35], v[116:119]
    buffer_load_dwordx4 v38, s[16:19], s36 offen offset:2048 lds
    v_mfma_f32_16x16x32_bf16 v[148:151], a[0:3], a[36:39], v[148:151]
    ds_read_b128 a[80:83], v49 offset:8192
    v_mfma_f32_16x16x32_bf16 v[180:183], a[0:3], a[40:43], v[180:183]
    ds_read_b128 a[84:87], v49 offset:10240
    v_mfma_f32_16x16x32_bf16 v[212:215], a[0:3], a[44:47], v[212:215]
    ds_read_b128 a[88:91], v49 offset:12288
    v_mfma_f32_16x16x32_bf16 v[216:219], a[4:7], a[44:47], v[216:219]
    ds_read_b128 a[92:95], v49 offset:14336
    v_mfma_f32_16x16x32_bf16 v[184:187], a[4:7], a[40:43], v[184:187]
    buffer_load_dwordx4 v39, s[16:19], s36 offen offset:3072 lds
    v_mfma_f32_16x16x32_bf16 v[152:155], a[4:7], a[36:39], v[152:155]
    ds_read_b64_tr_b16 a[52:53], v51 offset:24576
    v_mfma_f32_16x16x32_bf16 v[120:123], a[4:7], a[32:35], v[120:123]
    ds_read_b64_tr_b16 a[54:55], v51 offset:25600
    v_mfma_f32_16x16x32_bf16 v[124:127], a[8:11], a[32:35], v[124:127]
    ds_read_b64_tr_b16 a[56:57], v52 offset:24576
    v_mfma_f32_16x16x32_bf16 v[156:159], a[8:11], a[36:39], v[156:159]
    s_add_u32 m0, s38, 4096
    ds_read_b64_tr_b16 a[58:59], v52 offset:25600
    v_mfma_f32_16x16x32_bf16 v[188:191], a[8:11], a[40:43], v[188:191]
    buffer_load_dwordx4 v40, s[16:19], s36 offen offset:0 lds
    v_mfma_f32_16x16x32_bf16 v[220:223], a[8:11], a[44:47], v[220:223]
    ds_read_b64_tr_b16 a[60:61], v53 offset:24576
    v_mfma_f32_16x16x32_bf16 v[224:227], a[12:15], a[44:47], v[224:227]
    ds_read_b64_tr_b16 a[62:63], v53 offset:25600
    v_mfma_f32_16x16x32_bf16 v[192:195], a[12:15], a[40:43], v[192:195]
    ds_read_b64_tr_b16 a[64:65], v54 offset:24576
    v_mfma_f32_16x16x32_bf16 v[160:163], a[12:15], a[36:39], v[160:163]
    ds_read_b64_tr_b16 a[66:67], v54 offset:25600
    v_mfma_f32_16x16x32_bf16 v[128:131], a[12:15], a[32:35], v[128:131]
    buffer_load_dwordx4 v41, s[16:19], s36 offen offset:1024 lds
    v_mfma_f32_16x16x32_bf16 v[132:135], a[16:19], a[32:35], v[132:135]
    ds_read_b64_tr_b16 a[68:69], v55 offset:24576
    v_mfma_f32_16x16x32_bf16 v[164:167], a[16:19], a[36:39], v[164:167]
    ds_read_b64_tr_b16 a[70:71], v55 offset:25600
    v_mfma_f32_16x16x32_bf16 v[196:199], a[16:19], a[40:43], v[196:199]
    ds_read_b64_tr_b16 a[72:73], v56 offset:24576
    v_mfma_f32_16x16x32_bf16 v[228:231], a[16:19], a[44:47], v[228:231]
    ds_read_b64_tr_b16 a[74:75], v56 offset:25600
    v_mfma_f32_16x16x32_bf16 v[232:235], a[20:23], a[44:47], v[232:235]
    buffer_load_dwordx4 v42, s[16:19], s36 offen offset:2048 lds
    v_mfma_f32_16x16x32_bf16 v[200:203], a[20:23], a[40:43], v[200:203]
    ds_read_b64_tr_b16 a[76:77], v57 offset:24576
    v_mfma_f32_16x16x32_bf16 v[168:171], a[20:23], a[36:39], v[168:171]
    ds_read_b64_tr_b16 a[78:79], v57 offset:25600
    v_mfma_f32_16x16x32_bf16 v[136:139], a[20:23], a[32:35], v[136:139]
    v_mfma_f32_16x16x32_bf16 v[140:143], a[24:27], a[32:35], v[140:143]
    v_mfma_f32_16x16x32_bf16 v[172:175], a[24:27], a[36:39], v[172:175]
    buffer_load_dwordx4 v43, s[16:19], s36 offen offset:3072 lds
    v_mfma_f32_16x16x32_bf16 v[204:207], a[24:27], a[40:43], v[204:207]
    v_mfma_f32_16x16x32_bf16 v[236:239], a[24:27], a[44:47], v[236:239]
    v_mfma_f32_16x16x32_bf16 v[240:243], a[28:31], a[44:47], v[240:243]
    v_mfma_f32_16x16x32_bf16 v[208:211], a[28:31], a[40:43], v[208:211]
    v_mfma_f32_16x16x32_bf16 v[176:179], a[28:31], a[36:39], v[176:179]
    v_mfma_f32_16x16x32_bf16 v[144:147], a[28:31], a[32:35], v[144:147]
    s_waitcnt vmcnt(12) lgkmcnt(0)
    s_barrier
    s_cmp_lg_u32 s5, 0
    s_cbranch_scc1 L_signalled
    s_mov_b64 exec, 1
    buffer_atomic_add v27, off, s[92:95], s74 sc1
    s_mov_b64 exec, -1
L_signalled:
    v_mfma_f32_16x16x32_bf16 v[100:103], a[48:51], v[32:35], v[100:103]
    ds_read_b64_tr_b16 a[0:1], v50 offset:32768
    v_mfma_f32_16x16x32_bf16 v[104:107], a[52:55], v[32:35], v[104:107]
    s_add_u32 m0, s39, 16384
    s_mov_b32 s37, 3670016
    ds_read_b64_tr_b16 a[2:3], v50 offset:33792
    v_mfma_f32_16x16x32_bf16 v[116:119], a[48:51], a[80:83], v[116:119]
    buffer_load_dwordx4 v44, s[20:23], s37 offen offset:0 lds
    v_mfma_f32_16x16x32_bf16 v[148:151], a[48:51], a[84:87], v[148:151]
    ds_read_b128 a[32:35], v48 offset:16384
    v_mfma_f32_16x16x32_bf16 v[180:183], a[48:51], a[88:91], v[180:183]
    ds_read_b128 a[36:39], v48 offset:18432
    v_mfma_f32_16x16x32_bf16 v[212:215], a[48:51], a[92:95], v[212:215]
    buffer_load_dwordx4 v45, s[20:23], s37 offen offset:1024 lds
    v_mfma_f32_16x16x32_bf16 v[216:219], a[52:55], a[92:95], v[216:219]
    ds_read_b128 a[40:43], v48 offset:20480
    v_mfma_f32_16x16x32_bf16 v[184:187], a[52:55], a[88:91], v[184:187]
    ds_read_b128 a[44:47], v48 offset:22528
    v_mfma_f32_16x16x32_bf16 v[152:155], a[52:55], a[84:87], v[152:155]
    ds_read_b64_tr_b16 a[4:5], v51 offset:32768
    v_mfma_f32_16x16x32_bf16 v[120:123], a[52:55], a[80:83], v[120:123]
    buffer_load_dwordx4 v46, s[20:23], s37 offen offset:2048 lds
    v_mfma_f32_16x16x32_bf16 v[124:127], a[56:59], a[80:83], v[124:127]
    ds_read_b64_tr_b16 a[6:7], v51 offset:33792
    v_mfma_f32_16x16x32_bf16 v[156:159], a[56:59], a[84:87], v[156:159]
    ds_read_b64_tr_b16 a[8:9], v52 offset:32768
    v_mfma_f32_16x16x32_bf16 v[188:191], a[56:59], a[88:91], v[188:191]
    ds_read_b64_tr_b16 a[10:11], v52 offset:33792
    v_mfma_f32_16x16x32_bf16 v[220:223], a[56:59], a[92:95], v[220:223]
    buffer_load_dwordx4 v47, s[20:23], s37 offen offset:3072 lds
    v_mfma_f32_16x16x32_bf16 v[224:227], a[60:63], a[92:95], v[224:227]
    ds_read_b64_tr_b16 a[12:13], v53 offset:32768
    v_mfma_f32_16x16x32_bf16 v[192:195], a[60:63], a[88:91], v[192:195]
    ds_read_b64_tr_b16 a[14:15], v53 offset:33792
    v_mfma_f32_16x16x32_bf16 v[160:163], a[60:63], a[84:87], v[160:163]
    s_add_u32 m0, s38, 8192
    s_mov_b32 s36, 896
    ds_read_b64_tr_b16 a[16:17], v54 offset:32768
    v_mfma_f32_16x16x32_bf16 v[128:131], a[60:63], a[80:83], v[128:131]
    buffer_load_dwordx4 v36, s[16:19], s36 offen offset:0 lds
    v_mfma_f32_16x16x32_bf16 v[132:135], a[64:67], a[80:83], v[132:135]
    ds_read_b64_tr_b16 a[18:19], v54 offset:33792
    v_mfma_f32_16x16x32_bf16 v[164:167], a[64:67], a[84:87], v[164:167]
    ds_read_b64_tr_b16 a[20:21], v55 offset:32768
    v_mfma_f32_16x16x32_bf16 v[196:199], a[64:67], a[88:91], v[196:199]
    buffer_load_dwordx4 v37, s[16:19], s36 offen offset:1024 lds
    v_mfma_f32_16x16x32_bf16 v[228:231], a[64:67], a[92:95], v[228:231]
    ds_read_b64_tr_b16 a[22:23], v55 offset:33792
    v_mfma_f32_16x16x32_bf16 v[232:235], a[68:71], a[92:95], v[232:235]
    ds_read_b64_tr_b16 a[24:25], v56 offset:32768
    v_mfma_f32_16x16x32_bf16 v[200:203], a[68:71], a[88:91], v[200:203]
    ds_read_b64_tr_b16 a[26:27], v56 offset:33792
    v_mfma_f32_16x16x32_bf16 v[168:171], a[68:71], a[84:87], v[168:171]
    buffer_load_dwordx4 v38, s[16:19], s36 offen offset:2048 lds
    v_mfma_f32_16x16x32_bf16 v[136:139], a[68:71], a[80:83], v[136:139]
    ds_read_b64_tr_b16 a[28:29], v57 offset:32768
    v_mfma_f32_16x16x32_bf16 v[140:143], a[72:75], a[80:83], v[140:143]
    ds_read_b64_tr_b16 a[30:31], v57 offset:33792
    v_mfma_f32_16x16x32_bf16 v[172:175], a[72:75], a[84:87], v[172:175]
    v_mfma_f32_16x16x32_bf16 v[204:207], a[72:75], a[88:91], v[204:207]
    buffer_load_dwordx4 v39, s[16:19], s36 offen offset:3072 lds
    v_mfma_f32_16x16x32_bf16 v[236:239], a[72:75], a[92:95], v[236:239]
    v_mfma_f32_16x16x32_bf16 v[240:243], a[76:79], a[92:95], v[240:243]
    v_mfma_f32_16x16x32_bf16 v[208:211], a[76:79], a[88:91], v[208:211]
    v_mfma_f32_16x16x32_bf16 v[176:179], a[76:79], a[84:87], v[176:179]
    v_mfma_f32_16x16x32_bf16 v[144:147], a[76:79], a[80:83], v[144:147]
    s_waitcnt lgkmcnt(0)
    v_mfma_f32_16x16x32_bf16 v[100:103], a[0:3], v[32:35], v[100:103]
    ds_read_b64_tr_b16 a[48:49], v50 offset:40960
    v_mfma_f32_16x16x32_bf16 v[104:107], a[4:7], v[32:35], v[104:107]
    s_add_u32 m0, s38, 12288
    ds_read_b64_tr_b16 a[50:51], v50 offset:41984
    v_mfma_f32_16x16x32_bf16 v[116:119], a[0:3], a[32:35], v[116:119]
    buffer_load_dwordx4 v40, s[16:19], s36 offen offset:0 lds
    v_mfma_f32_16x16x32_bf16 v[148:151], a[0:3], a[36:39], v[148:151]
    ds_read_b128 a[80:83], v49 offset:16384
    v_mfma_f32_16x16x32_bf16 v[180:183], a[0:3], a[40:43], v[180:183]
    ds_read_b128 a[84:87], v49 offset:18432
    v_mfma_f32_16x16x32_bf16 v[212:215], a[0:3], a[44:47], v[212:215]
    buffer_load_dwordx4 v41, s[16:19], s36 offen offset:1024 lds
    v_mfma_f32_16x16x32_bf16 v[216:219], a[4:7], a[44:47], v[216:219]
    ds_read_b128 a[88:91], v49 offset:20480
    v_mfma_f32_16x16x32_bf16 v[184:187], a[4:7], a[40:43], v[184:187]
    ds_read_b128 a[92:95], v49 offset:22528
    v_mfma_f32_16x16x32_bf16 v[152:155], a[4:7], a[36:39], v[152:155]
    ds_read_b64_tr_b16 a[52:53], v51 offset:40960
    v_mfma_f32_16x16x32_bf16 v[120:123], a[4:7], a[32:35], v[120:123]
    buffer_load_dwordx4 v42, s[16:19], s36 offen offset:2048 lds
    v_mfma_f32_16x16x32_bf16 v[124:127], a[8:11], a[32:35], v[124:127]
    ds_read_b64_tr_b16 a[54:55], v51 offset:41984
    v_mfma_f32_16x16x32_bf16 v[156:159], a[8:11], a[36:39], v[156:159]
    ds_read_b64_tr_b16 a[56:57], v52 offset:40960
    v_mfma_f32_16x16x32_bf16 v[188:191], a[8:11], a[40:43], v[188:191]
    ds_read_b64_tr_b16 a[58:59], v52 offset:41984
    v_mfma_f32_16x16x32_bf16 v[220:223], a[8:11], a[44:47], v[220:223]
    buffer_load_dwordx4 v43, s[16:19], s36 offen offset:3072 lds
    v_mfma_f32_16x16x32_bf16 v[224:227], a[12:15], a[44:47], v[224:227]
    ds_read_b64_tr_b16 a[60:61], v53 offset:40960
    v_mfma_f32_16x16x32_bf16 v[192:195], a[12:15], a[40:43], v[192:195]
    ds_read_b64_tr_b16 a[62:63], v53 offset:41984
    v_mfma_f32_16x16x32_bf16 v[160:163], a[12:15], a[36:39], v[160:163]
    s_add_u32 m0, s34, 49152
    ds_read_b64_tr_b16 a[64:65], v54 offset:40960
    v_mfma_f32_16x16x32_bf16 v[128:131], a[12:15], a[32:35], v[128:131]
    buffer_load_dwordx4 v13, s[8:11], s28 offen offset:0 lds
    v_mfma_f32_16x16x32_bf16 v[132:135], a[16:19], a[32:35], v[132:135]
    ds_read_b64_tr_b16 a[66:67], v54 offset:41984
    v_mfma_f32_16x16x32_bf16 v[164:167], a[16:19], a[36:39], v[164:167]
    ds_read_b64_tr_b16 a[68:69], v55 offset:40960
    v_mfma_f32_16x16x32_bf16 v[196:199], a[16:19], a[40:43], v[196:199]
    buffer_load_dwordx4 v14, s[8:11], s28 offen offset:1024 lds
    v_mfma_f32_16x16x32_bf16 v[228:231], a[16:19], a[44:47], v[228:231]
    ds_read_b64_tr_b16 a[70:71], v55 offset:41984
    v_mfma_f32_16x16x32_bf16 v[232:235], a[20:23], a[44:47], v[232:235]
    ds_read_b64_tr_b16 a[72:73], v56 offset:40960
    v_mfma_f32_16x16x32_bf16 v[200:203], a[20:23], a[40:43], v[200:203]
    ds_read_b64_tr_b16 a[74:75], v56 offset:41984
    v_mfma_f32_16x16x32_bf16 v[168:171], a[20:23], a[36:39], v[168:171]
    buffer_load_dwordx4 v15, s[8:11], s28 offen offset:2048 lds
    v_mfma_f32_16x16x32_bf16 v[136:139], a[20:23], a[32:35], v[136:139]
    ds_read_b64_tr_b16 a[76:77], v57 offset:40960
    v_mfma_f32_16x16x32_bf16 v[140:143], a[24:27], a[32:35], v[140:143]
    ds_read_b64_tr_b16 a[78:79], v57 offset:41984
    v_mfma_f32_16x16x32_bf16 v[172:175], a[24:27], a[36:39], v[172:175]
    v_mfma_f32_16x16x32_bf16 v[204:207], a[24:27], a[40:43], v[204:207]
    buffer_load_dwordx4 v16, s[8:11], s28 offen offset:3072 lds
    v_mfma_f32_16x16x32_bf16 v[236:239], a[24:27], a[44:47], v[236:239]
    v_mfma_f32_16x16x32_bf16 v[240:243], a[28:31], a[44:47], v[240:243]
    v_mfma_f32_16x16x32_bf16 v[208:211], a[28:31], a[40:43], v[208:211]
    v_mfma_f32_16x16x32_bf16 v[176:179], a[28:31], a[36:39], v[176:179]
    v_mfma_f32_16x16x32_bf16 v[144:147], a[28:31], a[32:35], v[144:147]
    s_add_u32 s28, s28, 16384
    s_waitcnt vmcnt(16) lgkmcnt(0)
    s_barrier
    v_mfma_f32_16x16x32_bf16 v[100:103], a[48:51], v[32:35], v[100:103]
    ds_read_b64_tr_b16 a[0:1], v50 offset:0
    v_mfma_f32_16x16x32_bf16 v[104:107], a[52:55], v[32:35], v[104:107]
    s_add_u32 m0, s39, 32768
    s_mov_b32 s37, 4194304
    ds_read_b64_tr_b16 a[2:3], v50 offset:1024
    v_mfma_f32_16x16x32_bf16 v[116:119], a[48:51], a[80:83], v[116:119]
    buffer_load_dwordx4 v44, s[20:23], s37 offen offset:0 lds
    v_mfma_f32_16x16x32_bf16 v[148:151], a[48:51], a[84:87], v[148:151]
    ds_read_b128 a[32:35], v48 offset:0
    v_mfma_f32_16x16x32_bf16 v[180:183], a[48:51], a[88:91], v[180:183]
    ds_read_b128 a[36:39], v48 offset:2048
    v_mfma_f32_16x16x32_bf16 v[212:215], a[48:51], a[92:95], v[212:215]
    ds_read_b128 a[40:43], v48 offset:4096
    v_mfma_f32_16x16x32_bf16 v[216:219], a[52:55], a[92:95], v[216:219]
    ds_read_b128 a[44:47], v48 offset:6144
    v_mfma_f32_16x16x32_bf16 v[184:187], a[52:55], a[88:91], v[184:187]
    buffer_load_dwordx4 v45, s[20:23], s37 offen offset:1024 lds
    v_mfma_f32_16x16x32_bf16 v[152:155], a[52:55], a[84:87], v[152:155]
    ds_read_b64_tr_b16 a[4:5], v51 offset:0
    v_mfma_f32_16x16x32_bf16 v[120:123], a[52:55], a[80:83], v[120:123]
    ds_read_b64_tr_b16 a[6:7], v51 offset:1024
    v_mfma_f32_16x16x32_bf16 v[124:127], a[56:59], a[80:83], v[124:127]
    ds_read_b64_tr_b16 a[8:9], v52 offset:0
    v_mfma_f32_16x16x32_bf16 v[156:159], a[56:59], a[84:87], v[156:159]
    ds_read_b64_tr_b16 a[10:11], v52 offset:1024
    v_mfma_f32_16x16x32_bf16 v[188:191], a[56:59], a[88:91], v[188:191]
    buffer_load_dwordx4 v46, s[20:23], s37 offen offset:2048 lds
    v_mfma_f32_16x16x32_bf16 v[220:223], a[56:59], a[92:95], v[220:223]
    ds_read_b64_tr_b16 a[12:13], v53 offset:0
    v_mfma_f32_16x16x32_bf16 v[224:227], a[60:63], a[92:95], v[224:227]
    ds_read_b64_tr_b16 a[14:15], v53 offset:1024
    v_mfma_f32_16x16x32_bf16 v[192:195], a[60:63], a[88:91], v[192:195]
    ds_read_b64_tr_b16 a[16:17], v54 offset:0
    v_mfma_f32_16x16x32_bf16 v[160:163], a[60:63], a[84:87], v[160:163]
    ds_read_b64_tr_b16 a[18:19], v54 offset:1024
    v_mfma_f32_16x16x32_bf16 v[128:131], a[60:63], a[80:83], v[128:131]
    buffer_load_dwordx4 v47, s[20:23], s37 offen offset:3072 lds
    v_mfma_f32_16x16x32_bf16 v[132:135], a[64:67], a[80:83], v[132:135]
    ds_read_b64_tr_b16 a[20:21], v55 offset:0
    v_mfma_f32_16x16x32_bf16 v[164:167], a[64:67], a[84:87], v[164:167]
    ds_read_b64_tr_b16 a[22:23], v55 offset:1024
    v_mfma_f32_16x16x32_bf16 v[196:199], a[64:67], a[88:91], v[196:199]
    ds_read_b64_tr_b16 a[24:25], v56 offset:0
    v_mfma_f32_16x16x32_bf16 v[228:231], a[64:67], a[92:95], v[228:231]
    s_add_u32 m0, s38, 16384
    s_mov_b32 s36, 1024
    ds_read_b64_tr_b16 a[26:27], v56 offset:1024
    v_mfma_f32_16x16x32_bf16 v[232:235], a[68:71], a[92:95], v[232:235]
    buffer_load_dwordx4 v36, s[16:19], s36 offen offset:0 lds
    v_mfma_f32_16x16x32_bf16 v[200:203], a[68:71], a[88:91], v[200:203]
    ds_read_b64_tr_b16 a[28:29], v57 offset:0
    v_mfma_f32_16x16x32_bf16 v[168:171], a[68:71], a[84:87], v[168:171]
    ds_read_b64_tr_b16 a[30:31], v57 offset:1024
    v_mfma_f32_16x16x32_bf16 v[136:139], a[68:71], a[80:83], v[136:139]
    v_mfma_f32_16x16x32_bf16 v[140:143], a[72:75], a[80:83], v[140:143]
    v_mfma_f32_16x16x32_bf16 v[172:175], a[72:75], a[84:87], v[172:175]
    buffer_load_dwordx4 v37, s[16:19], s36 offen offset:1024 lds
    v_mfma_f32_16x16x32_bf16 v[204:207], a[72:75], a[88:91], v[204:207]
    v_mfma_f32_16x16x32_bf16 v[236:239], a[72:75], a[92:95], v[236:239]
    v_mfma_f32_16x16x32_bf16 v[240:243], a[76:79], a[92:95], v[240:243]
    v_mfma_f32_16x16x32_bf16 v[208:211], a[76:79], a[88:91], v[208:211]
    v_mfma_f32_16x16x32_bf16 v[176:179], a[76:79], a[84:87], v[176:179]
    v_mfma_f32_16x16x32_bf16 v[144:147], a[76:79], a[80:83], v[144:147]
    s_waitcnt lgkmcnt(0)
    v_mfma_f32_16x16x32_bf16 v[100:103], a[0:3], v[32:35], v[100:103]
    ds_read_b64_tr_b16 a[48:49], v50 offset:8192
    v_mfma_f32_16x16x32_bf16 v[104:107], a[4:7], v[32:35], v[104:107]
    ds_read_b64_tr_b16 a[50:51], v50 offset:9216
    v_mfma_f32_16x16x32_bf16 v[116:119], a[0:3], a[32:35], v[116:119]
    buffer_load_dwordx4 v38, s[16:19], s36 offen offset:2048 lds
    v_mfma_f32_16x16x32_bf16 v[148:151], a[0:3], a[36:39], v[148:151]
    ds_read_b128 a[80:83], v49 offset:0
    v_mfma_f32_16x16x32_bf16 v[180:183], a[0:3], a[40:43], v[180:183]
    ds_read_b128 a[84:87], v49 offset:2048
    v_mfma_f32_16x16x32_bf16 v[212:215], a[0:3], a[44:47], v[212:215]
    ds_read_b128 a[88:91], v49 offset:4096
    v_mfma_f32_16x16x32_bf16 v[216:219], a[4:7], a[44:47], v[216:219]
    ds_read_b128 a[92:95], v49 offset:6144
    v_mfma_f32_16x16x32_bf16 v[184:187], a[4:7], a[40:43], v[184:187]
    buffer_load_dwordx4 v39, s[16:19], s36 offen offset:3072 lds
    v_mfma_f32_16x16x32_bf16 v[152:155], a[4:7], a[36:39], v[152:155]
    ds_read_b64_tr_b16 a[52:53], v51 offset:8192
    v_mfma_f32_16x16x32_bf16 v[120:123], a[4:7], a[32:35], v[120:123]
    ds_read_b64_tr_b16 a[54:55], v51 offset:9216
    v_mfma_f32_16x16x32_bf16 v[124:127], a[8:11], a[32:35], v[124:127]
    ds_read_b64_tr_b16 a[56:57], v52 offset:8192
    v_mfma_f32_16x16x32_bf16 v[156:159], a[8:11], a[36:39], v[156:159]
    s_add_u32 m0, s38, 20480
    ds_read_b64_tr_b16 a[58:59], v52 offset:9216
    v_mfma_f32_16x16x32_bf16 v[188:191], a[8:11], a[40:43], v[188:191]
    buffer_load_dwordx4 v40, s[16:19], s36 offen offset:0 lds
    v_mfma_f32_16x16x32_bf16 v[220:223], a[8:11], a[44:47], v[220:223]
    ds_read_b64_tr_b16 a[60:61], v53 offset:8192
    v_mfma_f32_16x16x32_bf16 v[224:227], a[12:15], a[44:47], v[224:227]
    ds_read_b64_tr_b16 a[62:63], v53 offset:9216
    v_mfma_f32_16x16x32_bf16 v[192:195], a[12:15], a[40:43], v[192:195]
    ds_read_b64_tr_b16 a[64:65], v54 offset:8192
    v_mfma_f32_16x16x32_bf16 v[160:163], a[12:15], a[36:39], v[160:163]
    ds_read_b64_tr_b16 a[66:67], v54 offset:9216
    v_mfma_f32_16x16x32_bf16 v[128:131], a[12:15], a[32:35], v[128:131]
    buffer_load_dwordx4 v41, s[16:19], s36 offen offset:1024 lds
    v_mfma_f32_16x16x32_bf16 v[132:135], a[16:19], a[32:35], v[132:135]
    ds_read_b64_tr_b16 a[68:69], v55 offset:8192
    v_mfma_f32_16x16x32_bf16 v[164:167], a[16:19], a[36:39], v[164:167]
    ds_read_b64_tr_b16 a[70:71], v55 offset:9216
    v_mfma_f32_16x16x32_bf16 v[196:199], a[16:19], a[40:43], v[196:199]
    ds_read_b64_tr_b16 a[72:73], v56 offset:8192
    v_mfma_f32_16x16x32_bf16 v[228:231], a[16:19], a[44:47], v[228:231]
    ds_read_b64_tr_b16 a[74:75], v56 offset:9216
    v_mfma_f32_16x16x32_bf16 v[232:235], a[20:23], a[44:47], v[232:235]
    buffer_load_dwordx4 v42, s[16:19], s36 offen offset:2048 lds
    v_mfma_f32_16x16x32_bf16 v[200:203], a[20:23], a[40:43], v[200:203]
    ds_read_b64_tr_b16 a[76:77], v57 offset:8192
    v_mfma_f32_16x16x32_bf16 v[168:171], a[20:23], a[36:39], v[168:171]
    ds_read_b64_tr_b16 a[78:79], v57 offset:9216
    v_mfma_f32_16x16x32_bf16 v[136:139], a[20:23], a[32:35], v[136:139]
    v_mfma_f32_16x16x32_bf16 v[140:143], a[24:27], a[32:35], v[140:143]
    v_mfma_f32_16x16x32_bf16 v[172:175], a[24:27], a[36:39], v[172:175]
    buffer_load_dwordx4 v43, s[16:19], s36 offen offset:3072 lds
    v_mfma_f32_16x16x32_bf16 v[204:207], a[24:27], a[40:43], v[204:207]
    v_mfma_f32_16x16x32_bf16 v[236:239], a[24:27], a[44:47], v[236:239]
    v_mfma_f32_16x16x32_bf16 v[240:243], a[28:31], a[44:47], v[240:243]
    v_mfma_f32_16x16x32_bf16 v[208:211], a[28:31], a[40:43], v[208:211]
    v_mfma_f32_16x16x32_bf16 v[176:179], a[28:31], a[36:39], v[176:179]
    v_mfma_f32_16x16x32_bf16 v[144:147], a[28:31], a[32:35], v[144:147]
    s_waitcnt vmcnt(16) lgkmcnt(0)
    s_barrier
    v_mfma_f32_16x16x32_bf16 v[100:103], a[48:51], v[32:35], v[100:103]
    ds_read_b64_tr_b16 a[0:1], v50 offset:16384
    v_mfma_f32_16x16x32_bf16 v[104:107], a[52:55], v[32:35], v[104:107]
    s_add_u32 m0, s39, 0
    s_mov_b32 s37, 4718592
    ds_read_b64_tr_b16 a[2:3], v50 offset:17408
    v_mfma_f32_16x16x32_bf16 v[116:119], a[48:51], a[80:83], v[116:119]
    buffer_load_dwordx4 v44, s[20:23], s37 offen offset:0 lds
    v_mfma_f32_16x16x32_bf16 v[148:151], a[48:51], a[84:87], v[148:151]
    ds_read_b128 a[32:35], v48 offset:8192
    v_mfma_f32_16x16x32_bf16 v[180:183], a[48:51], a[88:91], v[180:183]
    ds_read_b128 a[36:39], v48 offset:10240
    v_mfma_f32_16x16x32_bf16 v[212:215], a[48:51], a[92:95], v[212:215]
    ds_read_b128 a[40:43], v48 offset:12288
    v_mfma_f32_16x16x32_bf16 v[216:219], a[52:55], a[92:95], v[216:219]
    ds_read_b128 a[44:47], v48 offset:14336
    v_mfma_f32_16x16x32_bf16 v[184:187], a[52:55], a[88:91], v[184:187]
    buffer_load_dwordx4 v45, s[20:23], s37 offen offset:1024 lds
    v_mfma_f32_16x16x32_bf16 v[152:155], a[52:55], a[84:87], v[152:155]
    ds_read_b64_tr_b16 a[4:5], v51 offset:16384
    v_mfma_f32_16x16x32_bf16 v[120:123], a[52:55], a[80:83], v[120:123]
    ds_read_b64_tr_b16 a[6:7], v51 offset:17408
    v_mfma_f32_16x16x32_bf16 v[124:127], a[56:59], a[80:83], v[124:127]
    ds_read_b64_tr_b16 a[8:9], v52 offset:16384
    v_mfma_f32_16x16x32_bf16 v[156:159], a[56:59], a[84:87], v[156:159]
    ds_read_b64_tr_b16 a[10:11], v52 offset:17408
    v_mfma_f32_16x16x32_bf16 v[188:191], a[56:59], a[88:91], v[188:191]
    buffer_load_dwordx4 v46, s[20:23], s37 offen offset:2048 lds
    v_mfma_f32_16x16x32_bf16 v[220:223], a[56:59], a[92:95], v[220:223]
    ds_read_b64_tr_b16 a[12:13], v53 offset:16384
    v_mfma_f32_16x16x32_bf16 v[224:227], a[60:63], a[92:95], v[224:227]
    ds_read_b64_tr_b16 a[14:15], v53 offset:17408
    v_mfma_f32_16x16x32_bf16 v[192:195], a[60:63], a[88:91], v[192:195]
    ds_read_b64_tr_b16 a[16:17], v54 offset:16384
    v_mfma_f32_16x16x32_bf16 v[160:163], a[60:63], a[84:87], v[160:163]
    ds_read_b64_tr_b16 a[18:19], v54 offset:17408
    v_mfma_f32_16x16x32_bf16 v[128:131], a[60:63], a[80:83], v[128:131]
    buffer_load_dwordx4 v47, s[20:23], s37 offen offset:3072 lds
    v_mfma_f32_16x16x32_bf16 v[132:135], a[64:67], a[80:83], v[132:135]
    ds_read_b64_tr_b16 a[20:21], v55 offset:16384
    v_mfma_f32_16x16x32_bf16 v[164:167], a[64:67], a[84:87], v[164:167]
    ds_read_b64_tr_b16 a[22:23], v55 offset:17408
    v_mfma_f32_16x16x32_bf16 v[196:199], a[64:67], a[88:91], v[196:199]
    ds_read_b64_tr_b16 a[24:25], v56 offset:16384
    v_mfma_f32_16x16x32_bf16 v[228:231], a[64:67], a[92:95], v[228:231]
    s_add_u32 m0, s38, 0
    s_mov_b32 s36, 1152
    ds_read_b64_tr_b16 a[26:27], v56 offset:17408
    v_mfma_f32_16x16x32_bf16 v[232:235], a[68:71], a[92:95], v[232:235]
    buffer_load_dword v252, off, s[92:95], s74 sc1
    buffer_load_dwordx4 v36, s[16:19], s36 offen offset:0 lds
    v_mfma_f32_16x16x32_bf16 v[200:203], a[68:71], a[88:91], v[200:203]
    ds_read_b64_tr_b16 a[28:29], v57 offset:16384
    v_mfma_f32_16x16x32_bf16 v[168:171], a[68:71], a[84:87], v[168:171]
    ds_read_b64_tr_b16 a[30:31], v57 offset:17408
    v_mfma_f32_16x16x32_bf16 v[136:139], a[68:71], a[80:83], v[136:139]
    v_mfma_f32_16x16x32_bf16 v[140:143], a[72:75], a[80:83], v[140:143]
    v_mfma_f32_16x16x32_bf16 v[172:175], a[72:75], a[84:87], v[172:175]
    buffer_load_dwordx4 v37, s[16:19], s36 offen offset:1024 lds
    v_mfma_f32_16x16x32_bf16 v[204:207], a[72:75], a[88:91], v[204:207]
    v_mfma_f32_16x16x32_bf16 v[236:239], a[72:75], a[92:95], v[236:239]
    v_mfma_f32_16x16x32_bf16 v[240:243], a[76:79], a[92:95], v[240:243]
    v_mfma_f32_16x16x32_bf16 v[208:211], a[76:79], a[88:91], v[208:211]
    v_mfma_f32_16x16x32_bf16 v[176:179], a[76:79], a[84:87], v[176:179]
    v_mfma_f32_16x16x32_bf16 v[144:147], a[76:79], a[80:83], v[144:147]
    s_waitcnt lgkmcnt(0)
    v_mfma_f32_16x16x32_bf16 v[100:103], a[0:3], v[32:35], v[100:103]
    ds_read_b64_tr_b16 a[48:49], v50 offset:24576
    v_mfma_f32_16x16x32_bf16 v[104:107], a[4:7], v[32:35], v[104:107]
    ds_read_b64_tr_b16 a[50:51], v50 offset:25600
    v_mfma_f32_16x16x32_bf16 v[116:119], a[0:3], a[32:35], v[116:119]
    buffer_load_dwordx4 v38, s[16:19], s36 offen offset:2048 lds
    v_mfma_f32_16x16x32_bf16 v[148:151], a[0:3], a[36:39], v[148:151]
    ds_read_b128 a[80:83], v49 offset:8192
    v_mfma_f32_16x16x32_bf16 v[180:183], a[0:3], a[40:43], v[180:183]
    ds_read_b128 a[84:87], v49 offset:10240
    v_mfma_f32_16x16x32_bf16 v[212:215], a[0:3], a[44:47], v[212:215]
    ds_read_b128 a[88:91], v49 offset:12288
    v_mfma_f32_16x16x32_bf16 v[216:219], a[4:7], a[44:47], v[216:219]
    ds_read_b128 a[92:95], v49 offset:14336
    v_mfma_f32_16x16x32_bf16 v[184:187], a[4:7], a[40:43], v[184:187]
    buffer_load_dwordx4 v39, s[16:19], s36 offen offset:3072 lds
    v_mfma_f32_16x16x32_bf16 v[152:155], a[4:7], a[36:39], v[152:155]
    ds_read_b64_tr_b16 a[52:53], v51 offset:24576
    v_mfma_f32_16x16x32_bf16 v[120:123], a[4:7], a[32:35], v[120:123]
    ds_read_b64_tr_b16 a[54:55], v51 offset:25600
    v_mfma_f32_16x16x32_bf16 v[124:127], a[8:11], a[32:35], v[124:127]
    ds_read_b64_tr_b16 a[56:57], v52 offset:24576
    v_mfma_f32_16x16x32_bf16 v[156:159], a[8:11], a[36:39], v[156:159]
    s_add_u32 m0, s38, 4096
    ds_read_b64_tr_b16 a[58:59], v52 offset:25600
    v_mfma_f32_16x16x32_bf16 v[188:191], a[8:11], a[40:43], v[188:191]
    buffer_load_dwordx4 v40, s[16:19], s36 offen offset:0 lds
    v_mfma_f32_16x16x32_bf16 v[220:223], a[8:11], a[44:47], v[220:223]
    ds_read_b64_tr_b16 a[60:61], v53 offset:24576
    v_mfma_f32_16x16x32_bf16 v[224:227], a[12:15], a[44:47], v[224:227]
    ds_read_b64_tr_b16 a[62:63], v53 offset:25600
    v_mfma_f32_16x16x32_bf16 v[192:195], a[12:15], a[40:43], v[192:195]
    ds_read_b64_tr_b16 a[64:65], v54 offset:24576
    v_mfma_f32_16x16x32_bf16 v[160:163], a[12:15], a[36:39], v[160:163]
    ds_read_b64_tr_b16 a[66:67], v54 offset:25600
    v_mfma_f32_16x16x32_bf16 v[128:131], a[12:15], a[32:35], v[128:131]
    buffer_load_dwordx4 v41, s[16:19], s36 offen offset:1024 lds
    v_mfma_f32_16x16x32_bf16 v[132:135], a[16:19], a[32:35], v[132:135]
    ds_read_b64_tr_b16 a[68:69], v55 offset:24576
    v_mfma_f32_16x16x32_bf16 v[164:167], a[16:19], a[36:39], v[164:167]
    ds_read_b64_tr_b16 a[70:71], v55 offset:25600
    v_mfma_f32_16x16x32_bf16 v[196:199], a[16:19], a[40:43], v[196:199]
    ds_read_b64_tr_b16 a[72:73], v56 offset:24576
    v_mfma_f32_16x16x32_bf16 v[228:231], a[16:19], a[44:47], v[228:231]
    ds_read_b64_tr_b16 a[74:75], v56 offset:25600
    v_mfma_f32_16x16x32_bf16 v[232:235], a[20:23], a[44:47], v[232:235]
    buffer_load_dwordx4 v42, s[16:19], s36 offen offset:2048 lds
    v_mfma_f32_16x16x32_bf16 v[200:203], a[20:23], a[40:43], v[200:203]
    ds_read_b64_tr_b16 a[76:77], v57 offset:24576
    v_mfma_f32_16x16x32_bf16 v[168:171], a[20:23], a[36:39], v[168:171]
    ds_read_b64_tr_b16 a[78:79], v57 offset:25600
    v_mfma_f32_16x16x32_bf16 v[136:139], a[20:23], a[32:35], v[136:139]
    v_mfma_f32_16x16x32_bf16 v[140:143], a[24:27], a[32:35], v[140:143]
    v_mfma_f32_16x16x32_bf16 v[172:175], a[24:27], a[36:39], v[172:175]
    buffer_load_dwordx4 v43, s[16:19], s36 offen offset:3072 lds
    v_mfma_f32_16x16x32_bf16 v[204:207], a[24:27], a[40:43], v[204:207]
    v_mfma_f32_16x16x32_bf16 v[236:239], a[24:27], a[44:47], v[236:239]
    v_mfma_f32_16x16x32_bf16 v[240:243], a[28:31], a[44:47], v[240:243]
    v_mfma_f32_16x16x32_bf16 v[208:211], a[28:31], a[40:43], v[208:211]
    v_mfma_f32_16x16x32_bf16 v[176:179], a[28:31], a[36:39], v[176:179]
    v_mfma_f32_16x16x32_bf16 v[144:147], a[28:31], a[32:35], v[144:147]
    s_waitcnt vmcnt(13) lgkmcnt(0)
    s_barrier
    v_mfma_f32_16x16x32_bf16 v[100:103], a[48:51], v[32:35], v[100:103]
    ds_read_b64_tr_b16 a[0:1], v50 offset:32768
    v_mfma_f32_16x16x32_bf16 v[104:107], a[52:55], v[32:35], v[104:107]
    s_add_u32 m0, s34, 16384
    ds_read_b64_tr_b16 a[2:3], v50 offset:33792
    v_mfma_f32_16x16x32_bf16 v[116:119], a[48:51], a[80:83], v[116:119]
    buffer_load_dwordx4 v13, s[8:11], s28 offen offset:0 lds
    v_mfma_f32_16x16x32_bf16 v[148:151], a[48:51], a[84:87], v[148:151]
    ds_read_b128 a[32:35], v48 offset:16384
    v_mfma_f32_16x16x32_bf16 v[180:183], a[48:51], a[88:91], v[180:183]
    ds_read_b128 a[36:39], v48 offset:18432
    v_mfma_f32_16x16x32_bf16 v[212:215], a[48:51], a[92:95], v[212:215]
    ds_read_b128 a[40:43], v48 offset:20480
    v_mfma_f32_16x16x32_bf16 v[216:219], a[52:55], a[92:95], v[216:219]
    ds_read_b128 a[44:47], v48 offset:22528
    v_mfma_f32_16x16x32_bf16 v[184:187], a[52:55], a[88:91], v[184:187]
    ds_read_b64_tr_b16 a[4:5], v51 offset:32768
    v_mfma_f32_16x16x32_bf16 v[152:155], a[52:55], a[84:87], v[152:155]
    ds_read_b64_tr_b16 a[6:7], v51 offset:33792
    v_mfma_f32_16x16x32_bf16 v[120:123], a[52:55], a[80:83], v[120:123]
    ds_read_b64_tr_b16 a[8:9], v52 offset:32768
    v_mfma_f32_16x16x32_bf16 v[124:127], a[56:59], a[80:83], v[124:127]
    ds_read_b64_tr_b16 a[10:11], v52 offset:33792
    v_mfma_f32_16x16x32_bf16 v[156:159], a[56:59], a[84:87], v[156:159]
    ds_read_b64_tr_b16 a[12:13], v53 offset:32768
    v_mfma_f32_16x16x32_bf16 v[188:191], a[56:59], a[88:91], v[188:191]
    ds_read_b64_tr_b16 a[14:15], v53 offset:33792
    v_mfma_f32_16x16x32_bf16 v[220:223], a[56:59], a[92:95], v[220:223]
    ds_read_b64_tr_b16 a[16:17], v54 offset:32768
    v_mfma_f32_16x16x32_bf16 v[224:227], a[60:63], a[92:95], v[224:227]
    ds_read_b64_tr_b16 a[18:19], v54 offset:33792
    v_mfma_f32_16x16x32_bf16 v[192:195], a[60:63], a[88:91], v[192:195]
    ds_read_b64_tr_b16 a[20:21], v55 offset:32768
    v_mfma_f32_16x16x32_bf16 v[160:163], a[60:63], a[84:87], v[160:163]
    ds_read_b64_tr_b16 a[22:23], v55 offset:33792
    v_mfma_f32_16x16x32_bf16 v[128:131], a[60:63], a[80:83], v[128:131]
    buffer_load_dwordx4 v14, s[8:11], s28 offen offset:1024 lds
    v_mfma_f32_16x16x32_bf16 v[132:135], a[64:67], a[80:83], v[132:135]
    ds_read_b64_tr_b16 a[24:25], v56 offset:32768
    v_mfma_f32_16x16x32_bf16 v[164:167], a[64:67], a[84:87], v[164:167]
    ds_read_b64_tr_b16 a[26:27], v56 offset:33792
    v_mfma_f32_16x16x32_bf16 v[196:199], a[64:67], a[88:91], v[196:199]
    ds_read_b64_tr_b16 a[28:29], v57 offset:32768
    v_mfma_f32_16x16x32_bf16 v[228:231], a[64:67], a[92:95], v[228:231]
    s_waitcnt vmcnt(10)
    v_cmp_gt_u32 vcc, 32, v252
    s_and_b64 vcc, vcc, exec
    s_cbranch_scc1 L_spin_rows
L_back_rows:
    buffer_load_dwordx2 v[108:109], v59, s[76:79], s46 offen offset:0 sc1
    buffer_load_dwordx2 v[110:111], v59, s[76:79], s46 offen offset:256 sc1
    buffer_load_dwordx2 v[112:113], v59, s[76:79], s46 offen offset:512 sc1
    buffer_load_dwordx2 v[114:115], v59, s[76:79], s46 offen offset:768 sc1
    ds_read_b64_tr_b16 a[30:31], v57 offset:33792
    v_mfma_f32_16x16x32_bf16 v[232:235], a[68:71], a[92:95], v[232:235]
    v_mfma_f32_16x16x32_bf16 v[200:203], a[68:71], a[88:91], v[200:203]
    v_mfma_f32_16x16x32_bf16 v[168:171], a[68:71], a[84:87], v[168:171]
    v_mfma_f32_16x16x32_bf16 v[136:139], a[68:71], a[80:83], v[136:139]
    v_mfma_f32_16x16x32_bf16 v[140:143], a[72:75], a[80:83], v[140:143]
    v_mfma_f32_16x16x32_bf16 v[172:175], a[72:75], a[84:87], v[172:175]
    v_mfma_f32_16x16x32_bf16 v[204:207], a[72:75], a[88:91], v[204:207]
    v_mfma_f32_16x16x32_bf16 v[236:239], a[72:75], a[92:95], v[236:239]
    v_mfma_f32_16x16x32_bf16 v[240:243], a[76:79], a[92:95], v[240:243]
    v_mfma_f32_16x16x32_bf16 v[208:211], a[76:79], a[88:91], v[208:211]
    v_mfma_f32_16x16x32_bf16 v[176:179], a[76:79], a[84:87], v[176:179]
    v_mfma_f32_16x16x32_bf16 v[144:147], a[76:79], a[80:83], v[144:147]
    s_waitcnt lgkmcnt(0)
    v_mfma_f32_16x16x32_bf16 v[100:103], a[0:3], v[32:35], v[100:103]
    ds_read_b64_tr_b16 a[48:49], v50 offset:40960
    v_mfma_f32_16x16x32_bf16 v[104:107], a[4:7], v[32:35], v[104:107]
    ds_read_b64_tr_b16 a[50:51], v50 offset:41984
    v_mfma_f32_16x16x32_bf16 v[116:119], a[0:3], a[32:35], v[116:119]
    buffer_load_dwordx4 v15, s[8:11], s28 offen offset:2048 lds
    v_mfma_f32_16x16x32_bf16 v[148:151], a[0:3], a[36:39], v[148:151]
    ds_read_b128 a[80:83], v49 offset:16384
    v_mfma_f32_16x16x32_bf16 v[180:183], a[0:3], a[40:43], v[180:183]
    ds_read_b128 a[84:87], v49 offset:18432
    v_mfma_f32_16x16x32_bf16 v[212:215], a[0:3], a[44:47], v[212:215]
    ds_read_b128 a[88:91], v49 offset:20480
    v_mfma_f32_16x16x32_bf16 v[216:219], a[4:7], a[44:47], v[216:219]
    ds_read_b128 a[92:95], v49 offset:22528
    v_mfma_f32_16x16x32_bf16 v[184:187], a[4:7], a[40:43], v[184:187]
    ds_read_b64_tr_b16 a[52:53], v51 offset:40960
    v_mfma_f32_16x16x32_bf16 v[152:155], a[4:7], a[36:39], v[152:155]
    ds_read_b64_tr_b16 a[54:55], v51 offset:41984
    v_mfma_f32_16x16x32_bf16 v[120:123], a[4:7], a[32:35], v[120:123]
    ds_read_b64_tr_b16 a[56:57], v52 offset:40960
    v_mfma_f32_16x16x32_bf16 v[124:127], a[8:11], a[32:35], v[124:127]
    ds_read_b64_tr_b16 a[58:59], v52 offset:41984
    v_mfma_f32_16x16x32_bf16 v[156:159], a[8:11], a[36:39], v[156:159]
    ds_read_b64_tr_b16 a[60:61], v53 offset:40960
    v_mfma_f32_16x16x32_bf16 v[188:191], a[8:11], a[40:43], v[188:191]
    ds_read_b64_tr_b16 a[62:63], v53 offset:41984
    v_mfma_f32_16x16x32_bf16 v[220:223], a[8:11], a[44:47], v[220:223]
    ds_read_b64_tr_b16 a[64:65], v54 offset:40960
    v_mfma_f32_16x16x32_bf16 v[224:227], a[12:15], a[44:47], v[224:227]
    ds_read_b64_tr_b16 a[66:67], v54 offset:41984
    v_mfma_f32_16x16x32_bf16 v[192:195], a[12:15], a[40:43], v[192:195]
    ds_read_b64_tr_b16 a[68:69], v55 offset:40960
    v_mfma_f32_16x16x32_bf16 v[160:163], a[12:15], a[36:39], v[160:163]
    ds_read_b64_tr_b16 a[70:71], v55 offset:41984
    v_mfma_f32_16x16x32_bf16 v[128:131], a[12:15], a[32:35], v[128:131]
    buffer_load_dwordx4 v16, s[8:11], s28 offen offset:3072 lds
    v_mfma_f32_16x16x32_bf16 v[132:135], a[16:19], a[32:35], v[132:135]
    ds_read_b64_tr_b16 a[72:73], v56 offset:40960
    v_mfma_f32_16x16x32_bf16 v[164:167], a[16:19], a[36:39], v[164:167]
    ds_read_b64_tr_b16 a[74:75], v56 offset:41984
    v_mfma_f32_16x16x32_bf16 v[196:199], a[16:19], a[40:43], v[196:199]
    ds_read_b64_tr_b16 a[76:77], v57 offset:40960
    v_mfma_f32_16x16x32_bf16 v[228:231], a[16:19], a[44:47], v[228:231]
    ds_read_b64_tr_b16 a[78:79], v57 offset:41984
    v_mfma_f32_16x16x32_bf16 v[232:235], a[20:23], a[44:47], v[232:235]
    v_mfma_f32_16x16x32_bf16 v[200:203], a[20:23], a[40:43], v[200:203]
    v_mfma_f32_16x16x32_bf16 v[168:171], a[20:23], a[36:39], v[168:171]
    v_mfma_f32_16x16x32_bf16 v[136:139], a[20:23], a[32:35], v[136:139]
    v_mfma_f32_16x16x32_bf16 v[140:143], a[24:27], a[32:35], v[140:143]
    v_mfma_f32_16x16x32_bf16 v[172:175], a[24:27], a[36:39], v[172:175]
    v_mfma_f32_16x16x32_bf16 v[204:207], a[24:27], a[40:43], v[204:207]
    v_mfma_f32_16x16x32_bf16 v[236:239], a[24:27], a[44:47], v[236:239]
    v_mfma_f32_16x16x32_bf16 v[240:243], a[28:31], a[44:47], v[240:243]
    v_mfma_f32_16x16x32_bf16 v[208:211], a[28:31], a[40:43], v[208:211]
    v_mfma_f32_16x16x32_bf16 v[176:179], a[28:31], a[36:39], v[176:179]
    v_mfma_f32_16x16x32_bf16 v[144:147], a[28:31], a[32:35], v[144:147]
    s_add_u32 s28, s28, 16384
    s_waitcnt vmcnt(8) lgkmcnt(0)
    s_barrier
    v_mfma_f32_16x16x32_bf16 v[100:103], a[48:51], v[32:35], v[100:103]
    ds_read_b64_tr_b16 a[0:1], v50 offset:0
    v_mfma_f32_16x16x32_bf16 v[104:107], a[52:55], v[32:35], v[104:107]
    s_add_u32 m0, s34, 32768
    ds_read_b64_tr_b16 a[2:3], v50 offset:1024
    v_mfma_f32_16x16x32_bf16 v[116:119], a[48:51], a[80:83], v[116:119]
    buffer_load_dwordx4 v13, s[8:11], s28 offen offset:0 lds
    v_mfma_f32_16x16x32_bf16 v[148:151], a[48:51], a[84:87], v[148:151]
    ds_read_b128 a[32:35], v48 offset:0
    v_mfma_f32_16x16x32_bf16 v[180:183], a[48:51], a[88:91], v[180:183]
    ds_read_b128 a[36:39], v48 offset:2048
    v_mfma_f32_16x16x32_bf16 v[212:215], a[48:51], a[92:95], v[212:215]
    ds_read_b128 a[40:43], v48 offset:4096
    v_mfma_f32_16x16x32_bf16 v[216:219], a[52:55], a[92:95], v[216:219]
    ds_read_b128 a[44:47], v48 offset:6144
    v_mfma_f32_16x16x32_bf16 v[184:187], a[52:55], a[88:91], v[184:187]
    ds_read_b64_tr_b16 a[4:5], v51 offset:0
    v_mfma_f32_16x16x32_bf16 v[152:155], a[52:55], a[84:87], v[152:155]
    ds_read_b64_tr_b16 a[6:7], v51 offset:1024
    v_mfma_f32_16x16x32_bf16 v[120:123], a[52:55], a[80:83], v[120:123]
    buffer_load_dwordx4 v14, s[8:11], s28 offen offset:1024 lds
    v_mfma_f32_16x16x32_bf16 v[124:127], a[56:59], a[80:83], v[124:127]
    ds_read_b64_tr_b16 a[8:9], v52 offset:0
    v_mfma_f32_16x16x32_bf16 v[156:159], a[56:59], a[84:87], v[156:159]
    ds_read_b64_tr_b16 a[10:11], v52 offset:1024
    v_mfma_f32_16x16x32_bf16 v[188:191], a[56:59], a[88:91], v[188:191]
    ds_read_b64_tr_b16 a[12:13], v53 offset:0
    v_mfma_f32_16x16x32_bf16 v[220:223], a[56:59], a[92:95], v[220:223]
    ds_read_b64_tr_b16 a[14:15], v53 offset:1024
    v_mfma_f32_16x16x32_bf16 v[224:227], a[60:63], a[92:95], v[224:227]
    ds_read_b64_tr_b16 a[16:17], v54 offset:0
    v_mfma_f32_16x16x32_bf16 v[192:195], a[60:63], a[88:91], v[192:195]
    ds_read_b64_tr_b16 a[18:19], v54 offset:1024
    v_mfma_f32_16x16x32_bf16 v[160:163], a[60:63], a[84:87], v[160:163]
    ds_read_b64_tr_b16 a[20:21], v55 offset:0
    v_mfma_f32_16x16x32_bf16 v[128:131], a[60:63], a[80:83], v[128:131]
    buffer_load_dwordx4 v15, s[8:11], s28 offen offset:2048 lds
    v_mfma_f32_16x16x32_bf16 v[132:135], a[64:67], a[80:83], v[132:135]
    ds_read_b64_tr_b16 a[22:23], v55 offset:1024
    v_mfma_f32_16x16x32_bf16 v[164:167], a[64:67], a[84:87], v[164:167]
    ds_read_b64_tr_b16 a[24:25], v56 offset:0
    v_mfma_f32_16x16x32_bf16 v[196:199], a[64:67], a[88:91], v[196:199]
    ds_read_b64_tr_b16 a[26:27], v56 offset:1024
    v_mfma_f32_16x16x32_bf16 v[228:231], a[64:67], a[92:95], v[228:231]
    ds_read_b64_tr_b16 a[28:29], v57 offset:0
    v_mfma_f32_16x16x32_bf16 v[232:235], a[68:71], a[92:95], v[232:235]
    ds_read_b64_tr_b16 a[30:31], v57 offset:1024
    v_mfma_f32_16x16x32_bf16 v[200:203], a[68:71], a[88:91], v[200:203]
    v_mfma_f32_16x16x32_bf16 v[168:171], a[68:71], a[84:87], v[168:171]
    buffer_load_dwordx4 v16, s[8:11], s28 offen offset:3072 lds
    v_mfma_f32_16x16x32_bf16 v[136:139], a[68:71], a[80:83], v[136:139]
    v_mfma_f32_16x16x32_bf16 v[140:143], a[72:75], a[80:83], v[140:143]
    v_mfma_f32_16x16x32_bf16 v[172:175], a[72:75], a[84:87], v[172:175]
    v_mfma_f32_16x16x32_bf16 v[204:207], a[72:75], a[88:91], v[204:207]
    v_mfma_f32_16x16x32_bf16 v[236:239], a[72:75], a[92:95], v[236:239]
    v_mfma_f32_16x16x32_bf16 v[240:243], a[76:79], a[92:95], v[240:243]
    v_mfma_f32_16x16x32_bf16 v[208:211], a[76:79], a[88:91], v[208:211]
    v_mfma_f32_16x16x32_bf16 v[176:179], a[76:79], a[84:87], v[176:179]
    v_mfma_f32_16x16x32_bf16 v[144:147], a[76:79], a[80:83], v[144:147]
    s_waitcnt lgkmcnt(0)
    v_mfma_f32_16x16x32_bf16 v[100:103], a[0:3], v[32:35], v[100:103]
    ds_read_b64_tr_b16 a[48:49], v50 offset:8192
    v_mfma_f32_16x16x32_bf16 v[104:107], a[4:7], v[32:35], v[104:107]
    s_add_u32 s28, s28, 16384
    s_mov_b32 m0, s30
    ds_read_b64_tr_b16 a[50:51], v50 offset:9216
    v_mfma_f32_16x16x32_bf16 v[116:119], a[0:3], a[32:35], v[116:119]
    buffer_load_dwordx4 v17, s[12:15], s29 offen offset:0 lds
    v_mfma_f32_16x16x32_bf16 v[148:151], a[0:3], a[36:39], v[148:151]
    ds_read_b64_tr_b16 a[52:53], v51 offset:8192
    v_mfma_f32_16x16x32_bf16 v[180:183], a[0:3], a[40:43], v[180:183]
    ds_read_b64_tr_b16 a[54:55], v51 offset:9216
    v_mfma_f32_16x16x32_bf16 v[212:215], a[0:3], a[44:47], v[212:215]
    ds_read_b128 a[80:83], v49 offset:0
    v_mfma_f32_16x16x32_bf16 v[216:219], a[4:7], a[44:47], v[216:219]
    ds_read_b128 a[84:87], v49 offset:2048
    v_mfma_f32_16x16x32_bf16 v[184:187], a[4:7], a[40:43], v[184:187]
    ds_read_b128 a[88:91], v49 offset:4096
    v_mfma_f32_16x16x32_bf16 v[152:155], a[4:7], a[36:39], v[152:155]
    ds_read_b128 a[92:95], v49 offset:6144
    v_mfma_f32_16x16x32_bf16 v[120:123], a[4:7], a[32:35], v[120:123]
    buffer_load_dwordx4 v18, s[12:15], s29 offen offset:1024 lds
    v_mfma_f32_16x16x32_bf16 v[124:127], a[8:11], a[32:35], v[124:127]
    ds_read_b64_tr_b16 a[56:57], v52 offset:8192
    v_mfma_f32_16x16x32_bf16 v[156:159], a[8:11], a[36:39], v[156:159]
    ds_read_b64_tr_b16 a[58:59], v52 offset:9216
    v_mfma_f32_16x16x32_bf16 v[188:191], a[8:11], a[40:43], v[188:191]
    ds_read_b64_tr_b16 a[60:61], v53 offset:8192
    v_mfma_f32_16x16x32_bf16 v[220:223], a[8:11], a[44:47], v[220:223]
    ds_read_b64_tr_b16 a[62:63], v53 offset:9216
    v_mfma_f32_16x16x32_bf16 v[224:227], a[12:15], a[44:47], v[224:227]
    ds_read_b64_tr_b16 a[64:65], v54 offset:8192
    v_mfma_f32_16x16x32_bf16 v[192:195], a[12:15], a[40:43], v[192:195]
    s_waitcnt lgkmcnt(9)
    ds_read_b64_tr_b16 a[66:67], v54 offset:9216
    v_mfma_f32_16x16x32_bf16 v[100:103], a[48:51], v[32:35], v[100:103]
    ds_read_b64_tr_b16 a[68:69], v55 offset:8192
    v_mfma_f32_16x16x32_bf16 v[104:107], a[52:55], v[32:35], v[104:107]
    buffer_load_dwordx4 v17, s[12:15], s29 offen offset:2048 lds
    v_mfma_f32_16x16x32_bf16 v[160:163], a[12:15], a[36:39], v[160:163]
    ds_read_b64_tr_b16 a[70:71], v55 offset:9216
    v_mfma_f32_16x16x32_bf16 v[128:131], a[12:15], a[32:35], v[128:131]
    ds_read_b64_tr_b16 a[72:73], v56 offset:8192
    v_mfma_f32_16x16x32_bf16 v[132:135], a[16:19], a[32:35], v[132:135]
    ds_read_b64_tr_b16 a[74:75], v56 offset:9216
    v_mfma_f32_16x16x32_bf16 v[164:167], a[16:19], a[36:39], v[164:167]
    ds_read_b64_tr_b16 a[76:77], v57 offset:8192
    v_mfma_f32_16x16x32_bf16 v[196:199], a[16:19], a[40:43], v[196:199]
    ds_read_b64_tr_b16 a[78:79], v57 offset:9216
    v_mfma_f32_16x16x32_bf16 v[228:231], a[16:19], a[44:47], v[228:231]
    ds_write_b128 v58, v[100:103] offset:0
    v_mfma_f32_16x16x32_bf16 v[232:235], a[20:23], a[44:47], v[232:235]
    buffer_load_dwordx4 v18, s[12:15], s29 offen offset:3072 lds
    v_mfma_f32_16x16x32_bf16 v[200:203], a[20:23], a[40:43], v[200:203]
    ds_write_b128 v58, v[104:107] offset:64
    v_mfma_f32_16x16x32_bf16 v[168:171], a[20:23], a[36:39], v[168:171]
    ds_write_b128 v58, v[100:103] offset:512
    v_mfma_f32_16x16x32_bf16 v[136:139], a[20:23], a[32:35], v[136:139]
    ds_write_b128 v58, v[104:107] offset:576
    v_mfma_f32_16x16x32_bf16 v[140:143], a[24:27], a[32:35], v[140:143]
    v_mfma_f32_16x16x32_bf16 v[172:175], a[24:27], a[36:39], v[172:175]
    v_mfma_f32_16x16x32_bf16 v[204:207], a[24:27], a[40:43], v[204:207]
    v_mfma_f32_16x16x32_bf16 v[236:239], a[24:27], a[44:47], v[236:239]
    v_mfma_f32_16x16x32_bf16 v[240:243], a[28:31], a[44:47], v[240:243]
    v_mfma_f32_16x16x32_bf16 v[208:211], a[28:31], a[40:43], v[208:211]
    v_mfma_f32_16x16x32_bf16 v[176:179], a[28:31], a[36:39], v[176:179]
    v_mfma_f32_16x16x32_bf16 v[144:147], a[28:31], a[32:35], v[144:147]
    s_add_u32 s29, s29, 16384
    s_waitcnt vmcnt(10) lgkmcnt(0)
    s_barrier
    v_mfma_f32_16x16x32_bf16 v[116:119], a[48:51], a[80:83], v[116:119]
    ds_read_b128 v[68:71], v58 offset:0
    v_mfma_f32_16x16x32_bf16 v[120:123], a[52:55], a[80:83], v[120:123]
    ds_read_b128 v[72:75], v58 offset:64
    v_mul_f32 v109, s44, v109
    v_mfma_f32_16x16x32_bf16 v[124:127], a[56:59], a[80:83], v[124:127]
    ds_read_b128 v[76:79], v58 offset:128
    v_mul_f32 v111, s44, v111
    v_mfma_f32_16x16x32_bf16 v[128:131], a[60:63], a[80:83], v[128:131]
    ds_read_b128 v[80:83], v58 offset:192
    v_mul_f32 v113, s44, v113
    v_mfma_f32_16x16x32_bf16 v[132:135], a[64:67], a[80:83], v[132:135]
    ds_read_b128 v[84:87], v58 offset:256
    v_mfma_f32_16x16x32_bf16 v[136:139], a[68:71], a[80:83], v[136:139]
    ds_read_b128 v[88:91], v58 offset:320
    v_mul_f32 v115, s44, v115
    v_mfma_f32_16x16x32_bf16 v[140:143], a[72:75], a[80:83], v[140:143]
    ds_read_b128 v[92:95], v58 offset:384
    v_and_b32 v253, 7, v19
    v_mfma_f32_16x16x32_bf16 v[144:147], a[76:79], a[80:83], v[144:147]
    ds_read_b128 v[96:99], v58 offset:448
    v_lshlrev_b32 v253, 5, v253
    v_mfma_f32_16x16x32_bf16 v[148:151], a[48:51], a[84:87], v[148:151]
    ds_read_b128 a[128:131], v1 offset:49152
    v_mfma_f32_16x16x32_bf16 v[152:155], a[52:55], a[84:87], v[152:155]
    ds_read_b128 a[132:135], v2 offset:49152
    v_mfma_f32_16x16x32_bf16 v[156:159], a[56:59], a[84:87], v[156:159]
    ds_read_b128 a[136:139], v3 offset:49152
    v_mfma_f32_16x16x32_bf16 v[160:163], a[60:63], a[84:87], v[160:163]
    ds_read_b128 a[140:143], v4 offset:49152
    v_mfma_f32_16x16x32_bf16 v[164:167], a[64:67], a[84:87], v[164:167]
    ds_read_b128 a[144:147], v1 offset:53248
    v_mfma_f32_16x16x32_bf16 v[168:171], a[68:71], a[84:87], v[168:171]
    ds_read_b128 a[148:151], v2 offset:53248
    v_mfma_f32_16x16x32_bf16 v[172:175], a[72:75], a[84:87], v[172:175]
    ds_read_b128 a[152:155], v3 offset:53248
    v_mfma_f32_16x16x32_bf16 v[176:179], a[76:79], a[84:87], v[176:179]
    ds_read_b128 a[156:159], v4 offset:53248
    buffer_load_dword v252, v253, s[92:95], 0 offen sc1
    s_waitcnt lgkmcnt(8)
    v_pk_fma_f32 v[116:117], v[108:109], v[68:69], v[116:117] op_sel_hi:[0,1,1] neg_lo:[1,0,0] neg_hi:[1,0,0]
    v_pk_fma_f32 v[118:119], v[108:109], v[70:71], v[118:119] op_sel_hi:[0,1,1] neg_lo:[1,0,0] neg_hi:[1,0,0]
    v_pk_fma_f32 v[120:121], v[108:109], v[72:73], v[120:121] op_sel_hi:[0,1,1] neg_lo:[1,0,0] neg_hi:[1,0,0]
    v_pk_fma_f32 v[122:123], v[108:109], v[74:75], v[122:123] op_sel_hi:[0,1,1] neg_lo:[1,0,0] neg_hi:[1,0,0]
    v_pk_fma_f32 v[124:125], v[108:109], v[76:77], v[124:125] op_sel_hi:[0,1,1] neg_lo:[1,0,0] neg_hi:[1,0,0]
    v_pk_fma_f32 v[126:127], v[108:109], v[78:79], v[126:127] op_sel_hi:[0,1,1] neg_lo:[1,0,0] neg_hi:[1,0,0]
    v_pk_fma_f32 v[128:129], v[108:109], v[80:81], v[128:129] op_sel_hi:[0,1,1] neg_lo:[1,0,0] neg_hi:[1,0,0]
    v_pk_fma_f32 v[130:131], v[108:109], v[82:83], v[130:131] op_sel_hi:[0,1,1] neg_lo:[1,0,0] neg_hi:[1,0,0]
    v_pk_fma_f32 v[132:133], v[108:109], v[84:85], v[132:133] op_sel_hi:[0,1,1] neg_lo:[1,0,0] neg_hi:[1,0,0]
    v_pk_fma_f32 v[134:135], v[108:109], v[86:87], v[134:135] op_sel_hi:[0,1,1] neg_lo:[1,0,0] neg_hi:[1,0,0]
    v_pk_fma_f32 v[136:137], v[108:109], v[88:89], v[136:137] op_sel_hi:[0,1,1] neg_lo:[1,0,0] neg_hi:[1,0,0]
    v_pk_fma_f32 v[138:139], v[108:109], v[90:91], v[138:139] op_sel_hi:[0,1,1] neg_lo:[1,0,0] neg_hi:[1,0,0]
    v_pk_fma_f32 v[140:141], v[108:109], v[92:93], v[140:141] op_sel_hi:[0,1,1] neg_lo:[1,0,0] neg_hi:[1,0,0]
    v_pk_fma_f32 v[142:143], v[108:109], v[94:95], v[142:143] op_sel_hi:[0,1,1] neg_lo:[1,0,0] neg_hi:[1,0,0]
    v_pk_fma_f32 v[144:145], v[108:109], v[96:97], v[144:145] op_sel_hi:[0,1,1] neg_lo:[1,0,0] neg_hi:[1,0,0]
    v_pk_fma_f32 v[146:147], v[108:109], v[98:99], v[146:147] op_sel_hi:[0,1,1] neg_lo:[1,0,0] neg_hi:[1,0,0]
    v_pk_mul_f32 v[116:117], v[116:117], v[108:109] op_sel:[0,1] op_sel_hi:[1,1]
    v_pk_mul_f32 v[118:119], v[118:119], v[108:109] op_sel:[0,1] op_sel_hi:[1,1]
    v_pk_mul_f32 v[120:121], v[120:121], v[108:109] op_sel:[0,1] op_sel_hi:[1,1]
    v_pk_mul_f32 v[122:123], v[122:123], v[108:109] op_sel:[0,1] op_sel_hi:[1,1]
    v_pk_mul_f32 v[124:125], v[124:125], v[108:109] op_sel:[0,1] op_sel_hi:[1,1]
    v_pk_mul_f32 v[126:127], v[126:127], v[108:109] op_sel:[0,1] op_sel_hi:[1,1]
    v_pk_mul_f32 v[128:129], v[128:129], v[108:109] op_sel:[0,1] op_sel_hi:[1,1]
    v_pk_mul_f32 v[130:131], v[130:131], v[108:109] op_sel:[0,1] op_sel_hi:[1,1]
    v_pk_mul_f32 v[132:133], v[132:133], v[108:109] op_sel:[0,1] op_sel_hi:[1,1]
    v_pk_mul_f32 v[134:135], v[134:135], v[108:109] op_sel:[0,1] op_sel_hi:[1,1]
    v_pk_mul_f32 v[136:137], v[136:137], v[108:109] op_sel:[0,1] op_sel_hi:[1,1]
    v_pk_mul_f32 v[138:139], v[138:139], v[108:109] op_sel:[0,1] op_sel_hi:[1,1]
    v_pk_mul_f32 v[140:141], v[140:141], v[108:109] op_sel:[0,1] op_sel_hi:[1,1]
    v_pk_mul_f32 v[142:143], v[142:143], v[108:109] op_sel:[0,1] op_sel_hi:[1,1]
    v_pk_mul_f32 v[144:145], v[144:145], v[108:109] op_sel:[0,1] op_sel_hi:[1,1]
    v_pk_mul_f32 v[146:147], v[146:147], v[108:109] op_sel:[0,1] op_sel_hi:[1,1]
    v_mfma_f32_16x16x32_bf16 v[180:183], a[48:51], a[88:91], v[180:183]
    ds_read_b128 a[160:163], v1 offset:57344
    v_cvt_pk_bf16_f32 v36, v116, v117
    v_cvt_pk_bf16_f32 v37, v118, v119
    v_cvt_pk_bf16_f32 v38, v120, v121
    v_cvt_pk_bf16_f32 v39, v122, v123
    v_mfma_f32_16x16x32_bf16 v[184:187], a[52:55], a[88:91], v[184:187]
    ds_read_b128 a[164:167], v2 offset:57344
    v_cvt_pk_bf16_f32 v40, v124, v125
    v_cvt_pk_bf16_f32 v41, v126, v127
    v_cvt_pk_bf16_f32 v42, v128, v129
    v_cvt_pk_bf16_f32 v43, v130, v131
    v_mfma_f32_16x16x32_bf16 v[188:191], a[56:59], a[88:91], v[188:191]
    ds_read_b128 a[168:171], v3 offset:57344
    v_cvt_pk_bf16_f32 v44, v132, v133
    v_cvt_pk_bf16_f32 v45, v134, v135
    v_cvt_pk_bf16_f32 v46, v136, v137
    v_cvt_pk_bf16_f32 v47, v138, v139
    v_mfma_f32_16x16x32_bf16 v[192:195], a[60:63], a[88:91], v[192:195]
    ds_read_b128 a[172:175], v4 offset:57344
    v_cvt_pk_bf16_f32 v48, v140, v141
    v_cvt_pk_bf16_f32 v49, v142, v143
    v_cvt_pk_bf16_f32 v50, v144, v145
    v_cvt_pk_bf16_f32 v51, v146, v147
    v_mfma_f32_16x16x32_bf16 v[196:199], a[64:67], a[88:91], v[196:199]
    ds_read_b128 a[176:179], v1 offset:61440
    v_permlane32_swap_b32 v36, v38
    v_permlane32_swap_b32 v37, v39
    v_permlane32_swap_b32 v40, v42
    v_permlane32_swap_b32 v41, v43
    v_mfma_f32_16x16x32_bf16 v[200:203], a[68:71], a[88:91], v[200:203]
    ds_read_b128 a[180:183], v2 offset:61440
    v_permlane32_swap_b32 v44, v46
    v_permlane32_swap_b32 v45, v47
    v_permlane32_swap_b32 v48, v50
    v_permlane32_swap_b32 v49, v51
    v_mfma_f32_16x16x32_bf16 v[204:207], a[72:75], a[88:91], v[204:207]
    ds_read_b128 a[184:187], v3 offset:61440
    v_permlane16_swap_b32 v36, v38
    v_permlane16_swap_b32 v37, v39
    v_permlane16_swap_b32 v40, v42
    v_permlane16_swap_b32 v41, v43
    v_mfma_f32_16x16x32_bf16 v[208:211], a[76:79], a[88:91], v[208:211]
    ds_read_b128 a[188:191], v4 offset:61440
    v_permlane16_swap_b32 v44, v46
    v_permlane16_swap_b32 v45, v47
    v_permlane16_swap_b32 v48, v50
    v_permlane16_swap_b32 v49, v51
    v_pk_fma_f32 v[148:149], v[110:111], v[68:69], v[148:149] op_sel_hi:[0,1,1] neg_lo:[1,0,0] neg_hi:[1,0,0]
    v_pk_fma_f32 v[150:151], v[110:111], v[70:71], v[150:151] op_sel_hi:[0,1,1] neg_lo:[1,0,0] neg_hi:[1,0,0]
    v_pk_fma_f32 v[152:153], v[110:111], v[72:73], v[152:153] op_sel_hi:[0,1,1] neg_lo:[1,0,0] neg_hi:[1,0,0]
    v_pk_fma_f32 v[154:155], v[110:111], v[74:75], v[154:155] op_sel_hi:[0,1,1] neg_lo:[1,0,0] neg_hi:[1,0,0]
    v_pk_fma_f32 v[156:157], v[110:111], v[76:77], v[156:157] op_sel_hi:[0,1,1] neg_lo:[1,0,0] neg_hi:[1,0,0]
    v_pk_fma_f32 v[158:159], v[110:111], v[78:79], v[158:159] op_sel_hi:[0,1,1] neg_lo:[1,0,0] neg_hi:[1,0,0]
    v_pk_fma_f32 v[160:161], v[110:111], v[80:81], v[160:161] op_sel_hi:[0,1,1] neg_lo:[1,0,0] neg_hi:[1,0,0]
    v_pk_fma_f32 v[162:163], v[110:111], v[82:83], v[162:163] op_sel_hi:[0,1,1] neg_lo:[1,0,0] neg_hi:[1,0,0]
    v_pk_fma_f32 v[164:165], v[110:111], v[84:85], v[164:165] op_sel_hi:[0,1,1] neg_lo:[1,0,0] neg_hi:[1,0,0]
    v_pk_fma_f32 v[166:167], v[110:111], v[86:87], v[166:167] op_sel_hi:[0,1,1] neg_lo:[1,0,0] neg_hi:[1,0,0]
    v_pk_fma_f32 v[168:169], v[110:111], v[88:89], v[168:169] op_sel_hi:[0,1,1] neg_lo:[1,0,0] neg_hi:[1,0,0]
    v_pk_fma_f32 v[170:171], v[110:111], v[90:91], v[170:171] op_sel_hi:[0,1,1] neg_lo:[1,0,0] neg_hi:[1,0,0]
    v_pk_fma_f32 v[172:173], v[110:111], v[92:93], v[172:173] op_sel_hi:[0,1,1] neg_lo:[1,0,0] neg_hi:[1,0,0]
    v_pk_fma_f32 v[174:175], v[110:111], v[94:95], v[174:175] op_sel_hi:[0,1,1] neg_lo:[1,0,0] neg_hi:[1,0,0]
    v_pk_fma_f32 v[176:177], v[110:111], v[96:97], v[176:177] op_sel_hi:[0,1,1] neg_lo:[1,0,0] neg_hi:[1,0,0]
    v_pk_fma_f32 v[178:179], v[110:111], v[98:99], v[178:179] op_sel_hi:[0,1,1] neg_lo:[1,0,0] neg_hi:[1,0,0]
    v_pk_mul_f32 v[148:149], v[148:149], v[110:111] op_sel:[0,1] op_sel_hi:[1,1]
    v_pk_mul_f32 v[150:151], v[150:151], v[110:111] op_sel:[0,1] op_sel_hi:[1,1]
    v_pk_mul_f32 v[152:153], v[152:153], v[110:111] op_sel:[0,1] op_sel_hi:[1,1]
    v_pk_mul_f32 v[154:155], v[154:155], v[110:111] op_sel:[0,1] op_sel_hi:[1,1]
    v_pk_mul_f32 v[156:157], v[156:157], v[110:111] op_sel:[0,1] op_sel_hi:[1,1]
    v_pk_mul_f32 v[158:159], v[158:159], v[110:111] op_sel:[0,1] op_sel_hi:[1,1]
    v_pk_mul_f32 v[160:161], v[160:161], v[110:111] op_sel:[0,1] op_sel_hi:[1,1]
    v_pk_mul_f32 v[162:163], v[162:163], v[110:111] op_sel:[0,1] op_sel_hi:[1,1]
    v_pk_mul_f32 v[164:165], v[164:165], v[110:111] op_sel:[0,1] op_sel_hi:[1,1]
    v_pk_mul_f32 v[166:167], v[166:167], v[110:111] op_sel:[0,1] op_sel_hi:[1,1]
    v_pk_mul_f32 v[168:169], v[168:169], v[110:111] op_sel:[0,1] op_sel_hi:[1,1]
    v_pk_mul_f32 v[170:171], v[170:171], v[110:111] op_sel:[0,1] op_sel_hi:[1,1]
    v_pk_mul_f32 v[172:173], v[172:173], v[110:111] op_sel:[0,1] op_sel_hi:[1,1]
    v_pk_mul_f32 v[174:175], v[174:175], v[110:111] op_sel:[0,1] op_sel_hi:[1,1]
    v_pk_mul_f32 v[176:177], v[176:177], v[110:111] op_sel:[0,1] op_sel_hi:[1,1]
    v_pk_mul_f32 v[178:179], v[178:179], v[110:111] op_sel:[0,1] op_sel_hi:[1,1]
    v_mfma_f32_16x16x32_bf16 v[212:215], a[48:51], a[92:95], v[212:215]
    s_add_u32 m0, s47, 0
    s_nop 0
    buffer_load_dwordx4 v20, s[96:99], 0 offen lds
    v_cvt_pk_bf16_f32 v52, v148, v149
    v_cvt_pk_bf16_f32 v53, v150, v151
    v_cvt_pk_bf16_f32 v54, v152, v153
    v_cvt_pk_bf16_f32 v55, v154, v155
    v_mfma_f32_16x16x32_bf16 v[216:219], a[52:55], a[92:95], v[216:219]
    s_add_u32 m0, s47, 1024
    s_nop 0
    buffer_load_dwordx4 v21, s[96:99], 0 offen lds
    v_cvt_pk_bf16_f32 v56, v156, v157
    v_cvt_pk_bf16_f32 v57, v158, v159
    v_cvt_pk_bf16_f32 v58, v160, v161
    v_cvt_pk_bf16_f32 v59, v162, v163
    v_mfma_f32_16x16x32_bf16 v[220:223], a[56:59], a[92:95], v[220:223]
    s_add_u32 m0, s47, 2048
    s_nop 0
    buffer_load_dwordx4 v22, s[96:99], 0 offen lds
    v_cvt_pk_bf16_f32 v60, v164, v165
    v_cvt_pk_bf16_f32 v61, v166, v167
    v_cvt_pk_bf16_f32 v62, v168, v169
    v_cvt_pk_bf16_f32 v63, v170, v171
    v_mfma_f32_16x16x32_bf16 v[224:227], a[60:63], a[92:95], v[224:227]
    s_add_u32 m0, s47, 3072
    s_nop 0
    buffer_load_dwordx4 v23, s[96:99], 0 offen lds
    v_cvt_pk_bf16_f32 v64, v172, v173
    v_cvt_pk_bf16_f32 v65, v174, v175
    v_cvt_pk_bf16_f32 v66, v176, v177
    v_cvt_pk_bf16_f32 v67, v178, v179
    v_mfma_f32_16x16x32_bf16 v[228:231], a[64:67], a[92:95], v[228:231]
    s_add_u32 m0, s47, 4096
    s_nop 0
    buffer_load_dwordx4 v24, s[96:99], 0 offen lds
    v_permlane32_swap_b32 v52, v54
    v_permlane32_swap_b32 v53, v55
    v_permlane32_swap_b32 v56, v58
    v_permlane32_swap_b32 v57, v59
    v_mfma_f32_16x16x32_bf16 v[232:235], a[68:71], a[92:95], v[232:235]
    v_permlane32_swap_b32 v60, v62
    v_permlane32_swap_b32 v61, v63
    v_permlane32_swap_b32 v64, v66
    v_permlane32_swap_b32 v65, v67
    v_mfma_f32_16x16x32_bf16 v[236:239], a[72:75], a[92:95], v[236:239]
    v_permlane16_swap_b32 v52, v54
    v_permlane16_swap_b32 v53, v55
    v_permlane16_swap_b32 v56, v58
    v_permlane16_swap_b32 v57, v59
    v_mfma_f32_16x16x32_bf16 v[240:243], a[76:79], a[92:95], v[240:243]
    v_permlane16_swap_b32 v60, v62
    v_permlane16_swap_b32 v61, v63
    v_permlane16_swap_b32 v64, v66
    v_permlane16_swap_b32 v65, v67
    v_pk_fma_f32 v[180:181], v[112:113], v[68:69], v[180:181] op_sel_hi:[0,1,1] neg_lo:[1,0,0] neg_hi:[1,0,0]
    v_pk_fma_f32 v[182:183], v[112:113], v[70:71], v[182:183] op_sel_hi:[0,1,1] neg_lo:[1,0,0] neg_hi:[1,0,0]
    v_pk_fma_f32 v[184:185], v[112:113], v[72:73], v[184:185] op_sel_hi:[0,1,1] neg_lo:[1,0,0] neg_hi:[1,0,0]
    v_pk_fma_f32 v[186:187], v[112:113], v[74:75], v[186:187] op_sel_hi:[0,1,1] neg_lo:[1,0,0] neg_hi:[1,0,0]
    v_pk_fma_f32 v[188:189], v[112:113], v[76:77], v[188:189] op_sel_hi:[0,1,1] neg_lo:[1,0,0] neg_hi:[1,0,0]
    v_pk_fma_f32 v[190:191], v[112:113], v[78:79], v[190:191] op_sel_hi:[0,1,1] neg_lo:[1,0,0] neg_hi:[1,0,0]
    v_pk_fma_f32 v[192:193], v[112:113], v[80:81], v[192:193] op_sel_hi:[0,1,1] neg_lo:[1,0,0] neg_hi:[1,0,0]
    v_pk_fma_f32 v[194:195], v[112:113], v[82:83], v[194:195] op_sel_hi:[0,1,1] neg_lo:[1,0,0] neg_hi:[1,0,0]
    v_pk_fma_f32 v[196:197], v[112:113], v[84:85], v[196:197] op_sel_hi:[0,1,1] neg_lo:[1,0,0] neg_hi:[1,0,0]
    v_pk_fma_f32 v[198:199], v[112:113], v[86:87], v[198:199] op_sel_hi:[0,1,1] neg_lo:[1,0,0] neg_hi:[1,0,0]
    v_pk_fma_f32 v[200:201], v[112:113], v[88:89], v[200:201] op_sel_hi:[0,1,1] neg_lo:[1,0,0] neg_hi:[1,0,0]
    v_pk_fma_f32 v[202:203], v[112:113], v[90:91], v[202:203] op_sel_hi:[0,1,1] neg_lo:[1,0,0] neg_hi:[1,0,0]
    v_pk_fma_f32 v[204:205], v[112:113], v[92:93], v[204:205] op_sel_hi:[0,1,1] neg_lo:[1,0,0] neg_hi:[1,0,0]
    v_pk_fma_f32 v[206:207], v[112:113], v[94:95], v[206:207] op_sel_hi:[0,1,1] neg_lo:[1,0,0] neg_hi:[1,0,0]
    v_pk_fma_f32 v[208:209], v[112:113], v[96:97], v[208:209] op_sel_hi:[0,1,1] neg_lo:[1,0,0] neg_hi:[1,0,0]
    v_pk_fma_f32 v[210:211], v[112:113], v[98:99], v[210:211] op_sel_hi:[0,1,1] neg_lo:[1,0,0] neg_hi:[1,0,0]
    v_pk_mul_f32 v[180:181], v[180:181], v[112:113] op_sel:[0,1] op_sel_hi:[1,1]
    v_pk_mul_f32 v[182:183], v[182:183], v[112:113] op_sel:[0,1] op_sel_hi:[1,1]
    v_pk_mul_f32 v[184:185], v[184:185], v[112:113] op_sel:[0,1] op_sel_hi:[1,1]
    v_pk_mul_f32 v[186:187], v[186:187], v[112:113] op_sel:[0,1] op_sel_hi:[1,1]
    v_pk_mul_f32 v[188:189], v[188:189], v[112:113] op_sel:[0,1] op_sel_hi:[1,1]
    v_pk_mul_f32 v[190:191], v[190:191], v[112:113] op_sel:[0,1] op_sel_hi:[1,1]
    v_pk_mul_f32 v[192:193], v[192:193], v[112:113] op_sel:[0,1] op_sel_hi:[1,1]
    v_pk_mul_f32 v[194:195], v[194:195], v[112:113] op_sel:[0,1] op_sel_hi:[1,1]
    v_pk_mul_f32 v[196:197], v[196:197], v[112:113] op_sel:[0,1] op_sel_hi:[1,1]
    v_pk_mul_f32 v[198:199], v[198:199], v[112:113] op_sel:[0,1] op_sel_hi:[1,1]
    v_pk_mul_f32 v[200:201], v[200:201], v[112:113] op_sel:[0,1] op_sel_hi:[1,1]
    v_pk_mul_f32 v[202:203], v[202:203], v[112:113] op_sel:[0,1] op_sel_hi:[1,1]
    v_pk_mul_f32 v[204:205], v[204:205], v[112:113] op_sel:[0,1] op_sel_hi:[1,1]
    v_pk_mul_f32 v[206:207], v[206:207], v[112:113] op_sel:[0,1] op_sel_hi:[1,1]
    v_pk_mul_f32 v[208:209], v[208:209], v[112:113] op_sel:[0,1] op_sel_hi:[1,1]
    v_pk_mul_f32 v[210:211], v[210:211], v[112:113] op_sel:[0,1] op_sel_hi:[1,1]
    v_pk_fma_f32 v[212:213], v[114:115], v[68:69], v[212:213] op_sel_hi:[0,1,1] neg_lo:[1,0,0] neg_hi:[1,0,0]
    v_pk_fma_f32 v[214:215], v[114:115], v[70:71], v[214:215] op_sel_hi:[0,1,1] neg_lo:[1,0,0] neg_hi:[1,0,0]
    v_pk_fma_f32 v[216:217], v[114:115], v[72:73], v[216:217] op_sel_hi:[0,1,1] neg_lo:[1,0,0] neg_hi:[1,0,0]
    v_pk_fma_f32 v[218:219], v[114:115], v[74:75], v[218:219] op_sel_hi:[0,1,1] neg_lo:[1,0,0] neg_hi:[1,0,0]
    v_pk_fma_f32 v[220:221], v[114:115], v[76:77], v[220:221] op_sel_hi:[0,1,1] neg_lo:[1,0,0] neg_hi:[1,0,0]
    v_pk_fma_f32 v[222:223], v[114:115], v[78:79], v[222:223] op_sel_hi:[0,1,1] neg_lo:[1,0,0] neg_hi:[1,0,0]
    v_pk_fma_f32 v[224:225], v[114:115], v[80:81], v[224:225] op_sel_hi:[0,1,1] neg_lo:[1,0,0] neg_hi:[1,0,0]
    v_pk_fma_f32 v[226:227], v[114:115], v[82:83], v[226:227] op_sel_hi:[0,1,1] neg_lo:[1,0,0] neg_hi:[1,0,0]
    v_pk_fma_f32 v[228:229], v[114:115], v[84:85], v[228:229] op_sel_hi:[0,1,1] neg_lo:[1,0,0] neg_hi:[1,0,0]
    v_pk_fma_f32 v[230:231], v[114:115], v[86:87], v[230:231] op_sel_hi:[0,1,1] neg_lo:[1,0,0] neg_hi:[1,0,0]
    v_pk_fma_f32 v[232:233], v[114:115], v[88:89], v[232:233] op_sel_hi:[0,1,1] neg_lo:[1,0,0] neg_hi:[1,0,0]
    v_pk_fma_f32 v[234:235], v[114:115], v[90:91], v[234:235] op_sel_hi:[0,1,1] neg_lo:[1,0,0] neg_hi:[1,0,0]
    v_pk_fma_f32 v[236:237], v[114:115], v[92:93], v[236:237] op_sel_hi:[0,1,1] neg_lo:[1,0,0] neg_hi:[1,0,0]
    v_pk_fma_f32 v[238:239], v[114:115], v[94:95], v[238:239] op_sel_hi:[0,1,1] neg_lo:[1,0,0] neg_hi:[1,0,0]
    v_pk_fma_f32 v[240:241], v[114:115], v[96:97], v[240:241] op_sel_hi:[0,1,1] neg_lo:[1,0,0] neg_hi:[1,0,0]
    v_pk_fma_f32 v[242:243], v[114:115], v[98:99], v[242:243] op_sel_hi:[0,1,1] neg_lo:[1,0,0] neg_hi:[1,0,0]
    s_waitcnt lgkmcnt(0)
    v_mfma_f32_16x16x32_bf16 v[116:119], a[128:131], v[36:39], 0
    v_cvt_pk_bf16_f32 v68, v180, v181
    v_cvt_pk_bf16_f32 v69, v182, v183
    v_cvt_pk_bf16_f32 v70, v184, v185
    v_cvt_pk_bf16_f32 v71, v186, v187
    v_mfma_f32_16x16x32_bf16 v[116:119], a[132:135], v[40:43], v[116:119]
    v_cvt_pk_bf16_f32 v72, v188, v189
    v_cvt_pk_bf16_f32 v73, v190, v191
    v_cvt_pk_bf16_f32 v74, v192, v193
    v_cvt_pk_bf16_f32 v75, v194, v195
    v_mfma_f32_16x16x32_bf16 v[116:119], a[136:139], v[44:47], v[116:119]
    v_cvt_pk_bf16_f32 v76, v196, v197
    v_cvt_pk_bf16_f32 v77, v198, v199
    v_cvt_pk_bf16_f32 v78, v200, v201
    v_cvt_pk_bf16_f32 v79, v202, v203
    v_mfma_f32_16x16x32_bf16 v[116:119], a[140:143], v[48:51], v[116:119]
    v_cvt_pk_bf16_f32 v80, v204, v205
    v_cvt_pk_bf16_f32 v81, v206, v207
    v_cvt_pk_bf16_f32 v82, v208, v209
    v_cvt_pk_bf16_f32 v83, v210, v211
    v_mfma_f32_16x16x32_bf16 v[132:135], a[144:147], v[36:39], 0
    v_permlane32_swap_b32 v68, v70
    v_permlane32_swap_b32 v69, v71
    v_permlane32_swap_b32 v72, v74
    v_permlane32_swap_b32 v73, v75
    v_mfma_f32_16x16x32_bf16 v[132:135], a[148:151], v[40:43], v[132:135]
    v_permlane32_swap_b32 v76, v78
    v_permlane32_swap_b32 v77, v79
    v_permlane32_swap_b32 v80, v82
    v_permlane32_swap_b32 v81, v83
    v_mfma_f32_16x16x32_bf16 v[132:135], a[152:155], v[44:47], v[132:135]
    v_permlane16_swap_b32 v68, v70
    v_permlane16_swap_b32 v69, v71
    v_permlane16_swap_b32 v72, v74
    v_permlane16_swap_b32 v73, v75
    v_mfma_f32_16x16x32_bf16 v[132:135], a[156:159], v[48:51], v[132:135]
    v_permlane16_swap_b32 v76, v78
    v_permlane16_swap_b32 v77, v79
    v_permlane16_swap_b32 v80, v82
    v_permlane16_swap_b32 v81, v83
    v_pk_mul_f32 v[212:213], v[212:213], v[114:115] op_sel:[0,1] op_sel_hi:[1,1]
    v_pk_mul_f32 v[214:215], v[214:215], v[114:115] op_sel:[0,1] op_sel_hi:[1,1]
    v_pk_mul_f32 v[216:217], v[216:217], v[114:115] op_sel:[0,1] op_sel_hi:[1,1]
    v_pk_mul_f32 v[218:219], v[218:219], v[114:115] op_sel:[0,1] op_sel_hi:[1,1]
    v_pk_mul_f32 v[220:221], v[220:221], v[114:115] op_sel:[0,1] op_sel_hi:[1,1]
    v_pk_mul_f32 v[222:223], v[222:223], v[114:115] op_sel:[0,1] op_sel_hi:[1,1]
    v_pk_mul_f32 v[224:225], v[224:225], v[114:115] op_sel:[0,1] op_sel_hi:[1,1]
    v_pk_mul_f32 v[226:227], v[226:227], v[114:115] op_sel:[0,1] op_sel_hi:[1,1]
    v_pk_mul_f32 v[228:229], v[228:229], v[114:115] op_sel:[0,1] op_sel_hi:[1,1]
    v_pk_mul_f32 v[230:231], v[230:231], v[114:115] op_sel:[0,1] op_sel_hi:[1,1]
    v_pk_mul_f32 v[232:233], v[232:233], v[114:115] op_sel:[0,1] op_sel_hi:[1,1]
    v_pk_mul_f32 v[234:235], v[234:235], v[114:115] op_sel:[0,1] op_sel_hi:[1,1]
    v_pk_mul_f32 v[236:237], v[236:237], v[114:115] op_sel:[0,1] op_sel_hi:[1,1]
    v_pk_mul_f32 v[238:239], v[238:239], v[114:115] op_sel:[0,1] op_sel_hi:[1,1]
    v_pk_mul_f32 v[240:241], v[240:241], v[114:115] op_sel:[0,1] op_sel_hi:[1,1]
    v_pk_mul_f32 v[242:243], v[242:243], v[114:115] op_sel:[0,1] op_sel_hi:[1,1]
    v_mfma_f32_16x16x32_bf16 v[120:123], a[140:143], v[64:67], 0
    v_cvt_pk_bf16_f32 v84, v212, v213
    v_cvt_pk_bf16_f32 v85, v214, v215
    v_cvt_pk_bf16_f32 v86, v216, v217
    v_cvt_pk_bf16_f32 v87, v218, v219
    v_mfma_f32_16x16x32_bf16 v[120:123], a[136:139], v[60:63], v[120:123]
    v_cvt_pk_bf16_f32 v88, v220, v221
    v_cvt_pk_bf16_f32 v89, v222, v223
    v_cvt_pk_bf16_f32 v90, v224, v225
    v_cvt_pk_bf16_f32 v91, v226, v227
    v_mfma_f32_16x16x32_bf16 v[120:123], a[132:135], v[56:59], v[120:123]
    v_cvt_pk_bf16_f32 v92, v228, v229
    v_cvt_pk_bf16_f32 v93, v230, v231
    v_cvt_pk_bf16_f32 v94, v232, v233
    v_cvt_pk_bf16_f32 v95, v234, v235
    v_mfma_f32_16x16x32_bf16 v[120:123], a[128:131], v[52:55], v[120:123]
    v_cvt_pk_bf16_f32 v96, v236, v237
    v_cvt_pk_bf16_f32 v97, v238, v239
    v_cvt_pk_bf16_f32 v98, v240, v241
    v_cvt_pk_bf16_f32 v99, v242, v243
    v_mfma_f32_16x16x32_bf16 v[136:139], a[156:159], v[64:67], 0
    v_permlane32_swap_b32 v84, v86
    v_permlane32_swap_b32 v85, v87
    v_permlane32_swap_b32 v88, v90
    v_permlane32_swap_b32 v89, v91
    v_mfma_f32_16x16x32_bf16 v[136:139], a[152:155], v[60:63], v[136:139]
    v_permlane32_swap_b32 v92, v94
    v_permlane32_swap_b32 v93, v95
    v_permlane32_swap_b32 v96, v98
    v_permlane32_swap_b32 v97, v99
    v_mfma_f32_16x16x32_bf16 v[136:139], a[148:151], v[56:59], v[136:139]
    v_permlane16_swap_b32 v84, v86
    v_permlane16_swap_b32 v85, v87
    v_permlane16_swap_b32 v88, v90
    v_permlane16_swap_b32 v89, v91
    v_mfma_f32_16x16x32_bf16 v[136:139], a[144:147], v[52:55], v[136:139]
    v_permlane16_swap_b32 v92, v94
    v_permlane16_swap_b32 v93, v95
    v_permlane16_swap_b32 v96, v98
    v_permlane16_swap_b32 v97, v99
    v_mfma_f32_16x16x32_bf16 v[124:127], a[128:131], v[68:71], 0
    v_max3_f32 v28, v116, v117, v118
    v_max3_f32 v30, v120, v121, v122
    v_mfma_f32_16x16x32_bf16 v[124:127], a[132:135], v[72:75], v[124:127]
    v_max3_f32 v29, v119, v132, v133
    v_max3_f32 v31, v123, v136, v137
    v_max3_f32 v28, v28, v134, v135
    v_mfma_f32_16x16x32_bf16 v[124:127], a[136:139], v[76:79], v[124:127]
    v_max3_f32 v30, v30, v138, v139
    v_max_f32 v28, v28, v29
    v_max_f32 v30, v30, v31
    v_mfma_f32_16x16x32_bf16 v[124:127], a[140:143], v[80:83], v[124:127]
    v_mov_b32 v29, v28
    v_mov_b32 v31, v30
    s_nop 0
    v_permlane32_swap_b32 v28, v29
    v_mfma_f32_16x16x32_bf16 v[140:143], a[144:147], v[68:71], 0
    v_permlane32_swap_b32 v30, v31
    v_max_f32 v28, v28, v29
    v_mfma_f32_16x16x32_bf16 v[140:143], a[148:151], v[72:75], v[140:143]
    v_max_f32 v30, v30, v31
    v_mov_b32 v29, v28
    v_mov_b32 v31, v30
    v_mfma_f32_16x16x32_bf16 v[140:143], a[152:155], v[76:79], v[140:143]
    v_permlane16_swap_b32 v28, v29
    v_permlane16_swap_b32 v30, v31
    v_max_f32 v28, v28, v29
    v_mfma_f32_16x16x32_bf16 v[140:143], a[156:159], v[80:83], v[140:143]
    v_max_f32 v30, v30, v31
    v_sub_f32 v100, 0, v28
    v_sub_f32 v104, 0, v30
    v_mfma_f32_16x16x32_bf16 v[128:131], a[140:143], v[96:99], 0
    v_sub_f32 v101, 0, v28
    v_sub_f32 v105, 0, v30
    v_mfma_f32_16x16x32_bf16 v[128:131], a[136:139], v[92:95], v[128:131]
    v_sub_f32 v102, 0, v28
    v_sub_f32 v106, 0, v30
    v_sub_f32 v103, 0, v28
    v_mfma_f32_16x16x32_bf16 v[128:131], a[132:135], v[88:91], v[128:131]
    v_sub_f32 v107, 0, v30
    v_sub_f32 v116, v116, v28
    v_sub_f32 v120, v120, v30
    v_mfma_f32_16x16x32_bf16 v[128:131], a[128:131], v[84:87], v[128:131]
    v_sub_f32 v117, v117, v28
    v_sub_f32 v121, v121, v30
    v_sub_f32 v118, v118, v28
    v_mfma_f32_16x16x32_bf16 v[144:147], a[156:159], v[96:99], 0
    v_sub_f32 v122, v122, v30
    v_sub_f32 v119, v119, v28
    v_mfma_f32_16x16x32_bf16 v[144:147], a[152:155], v[92:95], v[144:147]
    v_sub_f32 v123, v123, v30
    v_sub_f32 v132, v132, v28
    v_sub_f32 v136, v136, v30
    v_mfma_f32_16x16x32_bf16 v[144:147], a[148:151], v[88:91], v[144:147]
    v_sub_f32 v133, v133, v28
    v_sub_f32 v137, v137, v30
    v_sub_f32 v134, v134, v28
    v_mfma_f32_16x16x32_bf16 v[144:147], a[144:147], v[84:87], v[144:147]
    v_sub_f32 v138, v138, v30
    v_sub_f32 v135, v135, v28
    v_sub_f32 v139, v139, v30
    s_waitcnt vmcnt(14)
    s_barrier
    v_mfma_f32_16x16x32_bf16 v[148:151], a[160:163], v[36:39], v[100:103]
    s_add_u32 m0, s34, 0
    s_nop 0
    s_nop 0
    s_nop 0
    v_mfma_f32_16x16x32_bf16 v[148:151], a[164:167], v[40:43], v[148:151]
    ds_read_b128 a[128:131], v1 offset:16384
    s_nop 0
    v_max3_f32 v32, v124, v125, v126
    v_max3_f32 v34, v128, v129, v130
    v_mfma_f32_16x16x32_bf16 v[148:151], a[168:171], v[44:47], v[148:151]
    ds_read_b128 a[132:135], v2 offset:16384
    v_max3_f32 v33, v127, v140, v141
    v_max3_f32 v35, v131, v144, v145
    v_max3_f32 v32, v32, v142, v143
    v_mfma_f32_16x16x32_bf16 v[148:151], a[172:175], v[48:51], v[148:151]
    buffer_load_dwordx4 v13, s[8:11], s28 offen offset:0 lds
    v_max3_f32 v34, v34, v146, v147
    v_max_f32 v32, v32, v33
    v_max_f32 v34, v34, v35
    v_mfma_f32_16x16x32_bf16 v[152:155], a[172:175], v[64:67], v[104:107]
    v_mov_b32 v33, v32
    v_mov_b32 v35, v34
    s_nop 0
    v_permlane32_swap_b32 v32, v33
    v_mfma_f32_16x16x32_bf16 v[152:155], a[168:171], v[60:63], v[152:155]
    v_permlane32_swap_b32 v34, v35
    v_max_f32 v32, v32, v33
    v_max_f32 v34, v34, v35
    v_mfma_f32_16x16x32_bf16 v[152:155], a[164:167], v[56:59], v[152:155]
    v_mov_b32 v33, v32
    v_mov_b32 v35, v34
    s_nop 0
    v_permlane16_swap_b32 v32, v33
    v_mfma_f32_16x16x32_bf16 v[152:155], a[160:163], v[52:55], v[152:155]
    v_permlane16_swap_b32 v34, v35
    v_max_f32 v32, v32, v33
    v_max_f32 v34, v34, v35
    v_mfma_f32_16x16x32_bf16 v[164:167], a[176:179], v[36:39], v[100:103]
    v_sub_f32 v108, 0, v32
    v_sub_f32 v112, 0, v34
    v_sub_f32 v109, 0, v32
    v_mfma_f32_16x16x32_bf16 v[164:167], a[180:183], v[40:43], v[164:167]
    v_sub_f32 v113, 0, v34
    v_sub_f32 v110, 0, v32
    v_sub_f32 v114, 0, v34
    v_mfma_f32_16x16x32_bf16 v[164:167], a[184:187], v[44:47], v[164:167]
    v_sub_f32 v111, 0, v32
    v_sub_f32 v115, 0, v34
    v_sub_f32 v124, v124, v32
    v_mfma_f32_16x16x32_bf16 v[164:167], a[188:191], v[48:51], v[164:167]
    v_sub_f32 v128, v128, v34
    v_sub_f32 v125, v125, v32
    v_sub_f32 v129, v129, v34
    v_mfma_f32_16x16x32_bf16 v[168:171], a[188:191], v[64:67], v[104:107]
    v_sub_f32 v126, v126, v32
    v_sub_f32 v130, v130, v34
    v_sub_f32 v127, v127, v32
    v_mfma_f32_16x16x32_bf16 v[168:171], a[184:187], v[60:63], v[168:171]
    v_sub_f32 v131, v131, v34
    v_sub_f32 v140, v140, v32
    v_sub_f32 v144, v144, v34
    v_mfma_f32_16x16x32_bf16 v[168:171], a[180:183], v[56:59], v[168:171]
    v_sub_f32 v141, v141, v32
    v_sub_f32 v145, v145, v34
    v_sub_f32 v142, v142, v32
    v_mfma_f32_16x16x32_bf16 v[168:171], a[176:179], v[52:55], v[168:171]
    v_sub_f32 v146, v146, v34
    v_sub_f32 v143, v143, v32
    v_sub_f32 v147, v147, v34
    s_nop 0
    v_mfma_f32_16x16x32_bf16 v[156:159], a[160:163], v[68:71], v[108:111]
    ds_read_b128 a[136:139], v3 offset:16384
    v_mfma_f32_16x16x32_bf16 v[156:159], a[164:167], v[72:75], v[156:159]
    ds_read_b128 a[140:143], v4 offset:16384
    v_mfma_f32_16x16x32_bf16 v[156:159], a[168:171], v[76:79], v[156:159]
    buffer_load_dwordx4 v14, s[8:11], s28 offen offset:1024 lds
    v_mfma_f32_16x16x32_bf16 v[156:159], a[172:175], v[80:83], v[156:159]
    v_mfma_f32_16x16x32_bf16 v[160:163], a[172:175], v[96:99], v[112:115]
    v_mfma_f32_16x16x32_bf16 v[160:163], a[168:171], v[92:95], v[160:163]
    v_mfma_f32_16x16x32_bf16 v[160:163], a[164:167], v[88:91], v[160:163]
    v_mfma_f32_16x16x32_bf16 v[160:163], a[160:163], v[84:87], v[160:163]
    s_waitcnt lgkmcnt(2)
    v_mfma_f32_16x16x32_bf16 v[172:175], a[176:179], v[68:71], v[108:111]
    s_waitcnt vmcnt(7)
    ds_read_b128 a[144:147], v1 offset:20480
    v_exp_f32 v116, v116
    v_mfma_f32_16x16x32_bf16 v[172:175], a[180:183], v[72:75], v[172:175]
    ds_read_b128 a[148:151], v2 offset:20480
    v_exp_f32 v117, v117
    v_mfma_f32_16x16x32_bf16 v[172:175], a[184:187], v[76:79], v[172:175]
    v_cvt_pk_bf16_f32 v180, v116, v117
    v_exp_f32 v118, v118
    v_mfma_f32_16x16x32_bf16 v[172:175], a[188:191], v[80:83], v[172:175]
    v_exp_f32 v119, v119
    v_mfma_f32_16x16x32_bf16 v[176:179], a[188:191], v[96:99], v[112:115]
    v_cvt_pk_bf16_f32 v181, v118, v119
    v_exp_f32 v120, v120
    v_mfma_f32_16x16x32_bf16 v[176:179], a[184:187], v[92:95], v[176:179]
    v_exp_f32 v121, v121
    v_mfma_f32_16x16x32_bf16 v[176:179], a[180:183], v[88:91], v[176:179]
    buffer_load_dwordx4 v15, s[8:11], s28 offen offset:2048 lds
    v_cvt_pk_bf16_f32 v188, v120, v121
    v_exp_f32 v122, v122
    v_mfma_f32_16x16x32_bf16 v[176:179], a[176:179], v[84:87], v[176:179]
    s_waitcnt lgkmcnt(2)
    v_exp_f32 v123, v123
    v_mfma_f32_16x16x32_bf16 v[116:119], a[128:131], v[36:39], v[100:103]
    ds_read_b128 a[152:155], v3 offset:20480
    v_cvt_pk_bf16_f32 v189, v122, v123
    v_exp_f32 v124, v124
    v_mfma_f32_16x16x32_bf16 v[116:119], a[132:135], v[40:43], v[116:119]
    ds_read_b128 a[156:159], v4 offset:20480
    v_exp_f32 v125, v125
    v_mfma_f32_16x16x32_bf16 v[116:119], a[136:139], v[44:47], v[116:119]
    v_cvt_pk_bf16_f32 v196, v124, v125
    v_exp_f32 v126, v126
    v_cmp_gt_u32 vcc, 32, v252
    s_and_b64 vcc, vcc, exec
    s_cbranch_scc1 L_spin_all
L_back_all:
    v_mfma_f32_16x16x32_bf16 v[116:119], a[140:143], v[48:51], v[116:119]
    s_cmp_eq_u32 s6, 255
    s_cbranch_scc1 L_rt_keys
L_rt_back_keys:
    v_exp_f32 v127, v127
    v_mfma_f32_16x16x32_bf16 v[120:123], a[140:143], v[64:67], v[104:107]
    v_cvt_pk_bf16_f32 v197, v126, v127
    v_exp_f32 v128, v128
    v_mfma_f32_16x16x32_bf16 v[120:123], a[136:139], v[60:63], v[120:123]
    v_exp_f32 v129, v129
    v_mfma_f32_16x16x32_bf16 v[120:123], a[132:135], v[56:59], v[120:123]
    buffer_load_dwordx4 v16, s[8:11], s28 offen offset:3072 lds
    v_cvt_pk_bf16_f32 v204, v128, v129
    v_exp_f32 v130, v130
    v_mfma_f32_16x16x32_bf16 v[120:123], a[128:131], v[52:55], v[120:123]
    s_waitcnt lgkmcnt(2)
    v_exp_f32 v131, v131
    v_mfma_f32_16x16x32_bf16 v[124:127], a[128:131], v[68:71], v[108:111]
    ds_read_b128 a[160:163], v1 offset:24576
    v_cvt_pk_bf16_f32 v205, v130, v131
    v_exp_f32 v132, v132
    v_mfma_f32_16x16x32_bf16 v[124:127], a[132:135], v[72:75], v[124:127]
    ds_read_b128 a[164:167], v2 offset:24576
    v_exp_f32 v133, v133
    v_mfma_f32_16x16x32_bf16 v[124:127], a[136:139], v[76:79], v[124:127]
    v_cvt_pk_bf16_f32 v182, v132, v133
    v_exp_f32 v134, v134
    v_mfma_f32_16x16x32_bf16 v[124:127], a[140:143], v[80:83], v[124:127]
    v_exp_f32 v135, v135
    v_mfma_f32_16x16x32_bf16 v[128:131], a[140:143], v[96:99], v[112:115]
    v_cvt_pk_bf16_f32 v183, v134, v135
    v_exp_f32 v136, v136
    v_mfma_f32_16x16x32_bf16 v[128:131], a[136:139], v[92:95], v[128:131]
    s_add_u32 s28, s28, 16384
    s_mov_b32 m0, s31
    v_exp_f32 v137, v137
    v_mfma_f32_16x16x32_bf16 v[128:131], a[132:135], v[88:91], v[128:131]
    buffer_load_dwordx4 v17, s[12:15], s29 offen offset:0 lds
    v_cvt_pk_bf16_f32 v190, v136, v137
    v_exp_f32 v138, v138
    v_mfma_f32_16x16x32_bf16 v[128:131], a[128:131], v[84:87], v[128:131]
    s_waitcnt lgkmcnt(2)
    v_exp_f32 v139, v139
    v_mfma_f32_16x16x32_bf16 v[132:135], a[144:147], v[36:39], v[100:103]
    ds_read_b128 a[168:171], v3 offset:24576
    v_cvt_pk_bf16_f32 v191, v138, v139
    v_exp_f32 v140, v140
    v_mfma_f32_16x16x32_bf16 v[132:135], a[148:151], v[40:43], v[132:135]
    ds_read_b128 a[172:175], v4 offset:24576
    v_exp_f32 v141, v141
    v_mfma_f32_16x16x32_bf16 v[132:135], a[152:155], v[44:47], v[132:135]
    v_cvt_pk_bf16_f32 v198, v140, v141
    v_exp_f32 v142, v142
    v_mfma_f32_16x16x32_bf16 v[132:135], a[156:159], v[48:51], v[132:135]
    v_exp_f32 v143, v143
    v_mfma_f32_16x16x32_bf16 v[136:139], a[156:159], v[64:67], v[104:107]
    v_cvt_pk_bf16_f32 v199, v142, v143
    v_exp_f32 v144, v144
    v_mfma_f32_16x16x32_bf16 v[136:139], a[152:155], v[60:63], v[136:139]
    v_exp_f32 v145, v145
    v_mfma_f32_16x16x32_bf16 v[136:139], a[148:151], v[56:59], v[136:139]
    buffer_load_dwordx4 v18, s[12:15], s29 offen offset:1024 lds
    v_cvt_pk_bf16_f32 v206, v144, v145
    v_exp_f32 v146, v146
    v_mfma_f32_16x16x32_bf16 v[136:139], a[144:147], v[52:55], v[136:139]
    s_waitcnt lgkmcnt(2)
    v_exp_f32 v147, v147
    v_mfma_f32_16x16x32_bf16 v[140:143], a[144:147], v[68:71], v[108:111]
    ds_read_b128 a[176:179], v1 offset:28672
    v_cvt_pk_bf16_f32 v207, v146, v147
    v_exp_f32 v148, v148
    v_mfma_f32_16x16x32_bf16 v[140:143], a[148:151], v[72:75], v[140:143]
    ds_read_b128 a[180:183], v2 offset:28672
    v_exp_f32 v149, v149
    v_mfma_f32_16x16x32_bf16 v[140:143], a[152:155], v[76:79], v[140:143]
    v_cvt_pk_bf16_f32 v184, v148, v149
    v_exp_f32 v150, v150
    v_mfma_f32_16x16x32_bf16 v[140:143], a[156:159], v[80:83], v[140:143]
    v_exp_f32 v151, v151
    v_mfma_f32_16x16x32_bf16 v[144:147], a[156:159], v[96:99], v[112:115]
    v_cvt_pk_bf16_f32 v185, v150, v151
    v_exp_f32 v152, v152
    v_mfma_f32_16x16x32_bf16 v[144:147], a[152:155], v[92:95], v[144:147]
    v_exp_f32 v153, v153
    v_mfma_f32_16x16x32_bf16 v[144:147], a[148:151], v[88:91], v[144:147]
    buffer_load_dwordx4 v17, s[12:15], s29 offen offset:2048 lds
    v_cvt_pk_bf16_f32 v192, v152, v153
    v_exp_f32 v154, v154
    v_mfma_f32_16x16x32_bf16 v[144:147], a[144:147], v[84:87], v[144:147]
    s_waitcnt lgkmcnt(2)
    v_exp_f32 v155, v155
    v_mfma_f32_16x16x32_bf16 v[148:151], a[160:163], v[36:39], v[100:103]
    ds_read_b128 a[184:187], v3 offset:28672
    v_cvt_pk_bf16_f32 v193, v154, v155
    v_exp_f32 v156, v156
    v_mfma_f32_16x16x32_bf16 v[148:151], a[164:167], v[40:43], v[148:151]
    ds_read_b128 a[188:191], v4 offset:28672
    v_exp_f32 v157, v157
    v_mfma_f32_16x16x32_bf16 v[148:151], a[168:171], v[44:47], v[148:151]
    v_cvt_pk_bf16_f32 v200, v156, v157
    v_exp_f32 v158, v158
    v_mfma_f32_16x16x32_bf16 v[148:151], a[172:175], v[48:51], v[148:151]
    v_exp_f32 v159, v159
    v_mfma_f32_16x16x32_bf16 v[152:155], a[172:175], v[64:67], v[104:107]
    v_cvt_pk_bf16_f32 v201, v158, v159
    v_exp_f32 v160, v160
    v_mfma_f32_16x16x32_bf16 v[152:155], a[168:171], v[60:63], v[152:155]
    v_exp_f32 v161, v161
    v_mfma_f32_16x16x32_bf16 v[152:155], a[164:167], v[56:59], v[152:155]
    buffer_load_dwordx4 v18, s[12:15], s29 offen offset:3072 lds
    v_cvt_pk_bf16_f32 v208, v160, v161
    v_exp_f32 v162, v162
    v_mfma_f32_16x16x32_bf16 v[152:155], a[160:163], v[52:55], v[152:155]
    s_waitcnt vmcnt(14) lgkmcnt(2)
    s_barrier
    s_add_u32 s29, s29, 16384
    v_exp_f32 v163, v163
    v_mfma_f32_16x16x32_bf16 v[156:159], a[160:163], v[68:71], v[108:111]
    s_waitcnt vmcnt(8)
    ds_read_b64_tr_b16 a[192:193], v5 offset:8192
    v_cvt_pk_bf16_f32 v209, v162, v163
    v_exp_f32 v164, v164
    v_mfma_f32_16x16x32_bf16 v[156:159], a[164:167], v[72:75], v[156:159]
    ds_read_b64_tr_b16 a[194:195], v5 offset:12288
    v_exp_f32 v165, v165
    v_mfma_f32_16x16x32_bf16 v[156:159], a[168:171], v[76:79], v[156:159]
    ds_read_b128 a[128:131], v1 offset:32768
    ds_read_b64_tr_b16 a[240:241], v25 offset:0
    v_cvt_pk_bf16_f32 v186, v164, v165
    v_exp_f32 v166, v166
    v_mfma_f32_16x16x32_bf16 v[156:159], a[172:175], v[80:83], v[156:159]
    ds_read_b64_tr_b16 a[196:197], v5 offset:32768
    v_exp_f32 v167, v167
    v_mfma_f32_16x16x32_bf16 v[160:163], a[172:175], v[96:99], v[112:115]
    ds_read_b64_tr_b16 a[198:199], v5 offset:36864
    ds_read_b64_tr_b16 a[242:243], v25 offset:2560
    v_cvt_pk_bf16_f32 v187, v166, v167
    v_exp_f32 v168, v168
    v_mfma_f32_16x16x32_bf16 v[160:163], a[168:171], v[92:95], v[160:163]
    s_add_u32 m0, s34, 49152
    ds_read_b128 a[132:135], v2 offset:32768
    ds_read_b64_tr_b16 a[244:245], v25 offset:32
    v_exp_f32 v169, v169
    v_mfma_f32_16x16x32_bf16 v[160:163], a[164:167], v[88:91], v[160:163]
    buffer_load_dwordx4 v13, s[8:11], s28 offen offset:0 lds
    v_cvt_pk_bf16_f32 v194, v168, v169
    v_exp_f32 v170, v170
    v_mfma_f32_16x16x32_bf16 v[160:163], a[160:163], v[84:87], v[160:163]
    s_waitcnt lgkmcnt(6)
    ds_read_b64_tr_b16 a[246:247], v25 offset:2592
    v_exp_f32 v171, v171
    v_mfma_f32_16x16x32_bf16 v[164:167], a[176:179], v[36:39], v[100:103]
    ds_read_b64_tr_b16 a[200:201], v6 offset:8192
    ds_read_b64_tr_b16 a[248:249], v25 offset:64
    v_cvt_pk_bf16_f32 v195, v170, v171
    v_exp_f32 v172, v172
    v_mfma_f32_16x16x32_bf16 v[164:167], a[180:183], v[40:43], v[164:167]
    ds_read_b64_tr_b16 a[202:203], v6 offset:12288
    v_exp_f32 v173, v173
    v_mfma_f32_16x16x32_bf16 v[164:167], a[184:187], v[44:47], v[164:167]
    ds_read_b128 a[136:139], v3 offset:32768
    ds_read_b64_tr_b16 a[250:251], v25 offset:2624
    v_cvt_pk_bf16_f32 v202, v172, v173
    v_exp_f32 v174, v174
    v_mfma_f32_16x16x32_bf16 v[164:167], a[188:191], v[48:51], v[164:167]
    ds_read_b64_tr_b16 a[204:205], v6 offset:32768
    ds_read_b64_tr_b16 a[252:253], v25 offset:96
    v_exp_f32 v175, v175
    v_mfma_f32_16x16x32_bf16 v[168:171], a[188:191], v[64:67], v[104:107]
    ds_read_b64_tr_b16 a[206:207], v6 offset:36864
    v_cvt_pk_bf16_f32 v203, v174, v175
    v_exp_f32 v176, v176
    v_mfma_f32_16x16x32_bf16 v[168:171], a[184:187], v[60:63], v[168:171]
    ds_read_b128 a[140:143], v4 offset:32768
    ds_read_b64_tr_b16 a[254:255], v25 offset:2656
    v_exp_f32 v177, v177
    v_mfma_f32_16x16x32_bf16 v[168:171], a[180:183], v[56:59], v[168:171]
    buffer_load_dwordx4 v14, s[8:11], s28 offen offset:1024 lds
    ds_read_b64_tr_b16 v[252:253], v25 offset:128
    v_cvt_pk_bf16_f32 v210, v176, v177
    v_exp_f32 v178, v178
    v_mfma_f32_16x16x32_bf16 v[168:171], a[176:179], v[52:55], v[168:171]
    s_waitcnt lgkmcnt(6)
    ds_read_b64_tr_b16 v[254:255], v25 offset:2688
    v_exp_f32 v179, v179
    v_mfma_f32_16x16x32_bf16 v[172:175], a[176:179], v[68:71], v[108:111]
    s_mov_b32 s16, s62
    v_exp_f32 v116, v116
    v_mfma_f32_16x16x32_bf16 v[172:175], a[180:183], v[72:75], v[172:175]
    s_mov_b32 s17, s63
    ds_read_b64_tr_b16 a[208:209], v7 offset:8192
    v_cvt_pk_bf16_f32 v211, v178, v179
    v_mfma_f32_16x16x32_bf16 v[172:175], a[184:187], v[76:79], v[172:175]
    s_mov_b32 s18, 0x21c000
    v_exp_f32 v117, v117
    v_mfma_f32_16x16x32_bf16 v[172:175], a[188:191], v[80:83], v[172:175]
    s_mov_b32 s19, 0x20000
    ds_read_b64_tr_b16 a[210:211], v7 offset:12288
    v_mfma_f32_16x16x32_bf16 v[176:179], a[188:191], v[96:99], v[112:115]
    s_mov_b32 s20, s64
    v_exp_f32 v118, v118
    v_mfma_f32_16x16x32_bf16 v[176:179], a[184:187], v[92:95], v[176:179]
    s_mov_b32 s21, s65
    ds_read_b128 a[144:147], v1 offset:36864
    v_cvt_pk_bf16_f32 v212, v116, v117
    v_mfma_f32_16x16x32_bf16 v[176:179], a[180:183], v[88:91], v[176:179]
    s_mov_b32 s22, 0x21c000
    v_exp_f32 v119, v119
    v_mfma_f32_16x16x32_bf16 v[176:179], a[176:179], v[84:87], v[176:179]
    s_mov_b32 s23, 0x20000
    ds_read_b64_tr_b16 a[212:213], v7 offset:32768
    v_mfma_f32_16x16x32_bf16 a[0:3], a[192:195], v[180:183], 0
    s_mov_b32 s96, s66
    v_exp_f32 v120, v120
    v_mfma_f32_16x16x32_bf16 a[0:3], a[196:199], v[184:187], a[0:3]
    s_mov_b32 s97, s67
    ds_read_b64_tr_b16 a[214:215], v7 offset:36864
    v_cvt_pk_bf16_f32 v213, v118, v119
    v_mfma_f32_16x16x32_bf16 a[4:7], a[196:199], v[192:195], 0
    s_mov_b32 s98, 0x21c000
    v_exp_f32 v121, v121
    v_mfma_f32_16x16x32_bf16 a[4:7], a[192:195], v[188:191], a[4:7]
    s_mov_b32 s99, 0x20000
    ds_read_b128 a[148:151], v2 offset:36864
    v_cvt_pk_bf16_f32 v220, v120, v121
    v_mfma_f32_16x16x32_bf16 a[8:11], a[192:195], v[196:199], 0
    v_exp_f32 v122, v122
    v_mfma_f32_16x16x32_bf16 a[8:11], a[196:199], v[200:203], a[8:11]
    buffer_load_dwordx4 v15, s[8:11], s28 offen offset:2048 lds
    v_mfma_f32_16x16x32_bf16 a[12:15], a[196:199], v[208:211], 0
    v_exp_f32 v123, v123
    v_mfma_f32_16x16x32_bf16 a[12:15], a[192:195], v[204:207], a[12:15]
    s_waitcnt lgkmcnt(6)
    v_mul_u32_u24 v24, 3456, v19
    v_mfma_f32_16x16x32_bf16 v[116:119], a[128:131], v[36:39], v[100:103]
    s_lshl_b32 s40, s6, 4
    v_exp_f32 v124, v124
    v_mfma_f32_16x16x32_bf16 v[116:119], a[132:135], v[40:43], v[116:119]
    ds_read_b64_tr_b16 a[216:217], v8 offset:8192
    v_cvt_pk_bf16_f32 v221, v122, v123
    v_mfma_f32_16x16x32_bf16 v[116:119], a[136:139], v[44:47], v[116:119]
    v_exp_f32 v125, v125
    v_mfma_f32_16x16x32_bf16 v[116:119], a[140:143], v[48:51], v[116:119]
    ds_read_b64_tr_b16 a[218:219], v8 offset:12288
    v_add_u32 v24, s40, v24
    v_mfma_f32_16x16x32_bf16 v[120:123], a[140:143], v[64:67], v[104:107]
    s_cmp_ge_u32 s5, 2
    s_cselect_b32 s16, s20, s16
    s_cselect_b32 s17, s21, s17
    v_exp_f32 v126, v126
    v_mfma_f32_16x16x32_bf16 v[120:123], a[136:139], v[60:63], v[120:123]
    s_cmp_ge_u32 s6, 216
    s_cselect_b32 s18, 0, s18
    ds_read_b128 a[152:155], v3 offset:36864
    v_cvt_pk_bf16_f32 v228, v124, v125
    v_mfma_f32_16x16x32_bf16 v[120:123], a[132:135], v[56:59], v[120:123]
    s_and_b32 s40, s5, 1
    v_exp_f32 v127, v127
    v_mfma_f32_16x16x32_bf16 v[120:123], a[128:131], v[52:55], v[120:123]
    s_mul_i32 s37, s40, 1105920
    ds_read_b64_tr_b16 a[220:221], v8 offset:32768
    v_mfma_f32_16x16x32_bf16 a[16:19], a[200:203], v[180:183], 0
    s_mul_i32 s38, s5, 5120
    v_exp_f32 v128, v128
    v_mfma_f32_16x16x32_bf16 a[16:19], a[204:207], v[184:187], a[16:19]
    s_add_u32 s38, s38, 65536
    ds_read_b64_tr_b16 a[222:223], v8 offset:36864
    v_cvt_pk_bf16_f32 v229, v126, v127
    v_mfma_f32_16x16x32_bf16 a[20:23], a[204:207], v[192:195], 0
    s_mov_b32 s36, 4
    buffer_store_dwordx4 a[240:243], v26, s[76:79], 0 offen offset:0 sc1
    v_exp_f32 v129, v129
    v_mfma_f32_16x16x32_bf16 a[20:23], a[200:203], v[188:191], a[20:23]
    ds_read_b128 a[156:159], v4 offset:36864
    v_mfma_f32_16x16x32_bf16 a[24:27], a[200:203], v[196:199], 0
    v_exp_f32 v130, v130
    v_mfma_f32_16x16x32_bf16 a[24:27], a[204:207], v[200:203], a[24:27]
    v_cvt_pk_bf16_f32 v236, v128, v129
    v_mfma_f32_16x16x32_bf16 a[28:31], a[204:207], v[208:211], 0
    v_exp_f32 v131, v131
    v_mfma_f32_16x16x32_bf16 a[28:31], a[200:203], v[204:207], a[28:31]
    buffer_load_dwordx4 v16, s[8:11], s28 offen offset:3072 lds
    v_smfmac_f32_16x16x64_bf16 a[224:227], v[244:247], v[180:187], v248
    s_waitcnt lgkmcnt(6)
    buffer_store_dwordx4 a[244:247], v26, s[76:79], 0 offen offset:1024 sc1
    v_mfma_f32_16x16x32_bf16 v[124:127], a[128:131], v[68:71], v[108:111]
    v_exp_f32 v132, v132
    v_mfma_f32_16x16x32_bf16 v[124:127], a[132:135], v[72:75], v[124:127]
    ds_read_b64_tr_b16 a[192:193], v9 offset:8192
    v_cvt_pk_bf16_f32 v237, v130, v131
    v_mfma_f32_16x16x32_bf16 v[124:127], a[136:139], v[76:79], v[124:127]
    v_exp_f32 v133, v133
    v_mfma_f32_16x16x32_bf16 v[124:127], a[140:143], v[80:83], v[124:127]
    ds_read_b64_tr_b16 a[194:195], v9 offset:12288
    v_mfma_f32_16x16x32_bf16 v[128:131], a[140:143], v[96:99], v[112:115]
    v_exp_f32 v134, v134
    v_mfma_f32_16x16x32_bf16 v[128:131], a[136:139], v[92:95], v[128:131]
    ds_read_b128 a[160:163], v1 offset:40960
    v_cvt_pk_bf16_f32 v214, v132, v133
    v_mfma_f32_16x16x32_bf16 v[128:131], a[132:135], v[88:91], v[128:131]
    v_exp_f32 v135, v135
    v_mfma_f32_16x16x32_bf16 v[128:131], a[128:131], v[84:87], v[128:131]
    ds_read_b64_tr_b16 a[196:197], v9 offset:32768
    v_mfma_f32_16x16x32_bf16 a[32:35], a[208:211], v[180:183], 0
    v_exp_f32 v136, v136
    v_mfma_f32_16x16x32_bf16 a[32:35], a[212:215], v[184:187], a[32:35]
    ds_read_b64_tr_b16 a[198:199], v9 offset:36864
    v_cvt_pk_bf16_f32 v215, v134, v135
    v_mfma_f32_16x16x32_bf16 a[36:39], a[212:215], v[192:195], 0
    v_exp_f32 v137, v137
    v_mfma_f32_16x16x32_bf16 a[36:39], a[208:211], v[188:191], a[36:39]
    ds_read_b128 a[164:167], v2 offset:40960
    v_cvt_pk_bf16_f32 v222, v136, v137
    v_mfma_f32_16x16x32_bf16 a[40:43], a[208:211], v[196:199], 0
    s_add_u32 s28, s28, 16384
    s_mov_b32 m0, s32
    buffer_store_dwordx4 a[248:251], v26, s[76:79], 0 offen offset:2048 sc1
    v_exp_f32 v138, v138
    v_mfma_f32_16x16x32_bf16 a[40:43], a[212:215], v[200:203], a[40:43]
    buffer_load_dwordx4 v17, s[12:15], s29 offen offset:0 lds
    v_mfma_f32_16x16x32_bf16 a[44:47], a[212:215], v[208:211], 0
    v_exp_f32 v139, v139
    v_mfma_f32_16x16x32_bf16 a[44:47], a[208:211], v[204:207], a[44:47]
    s_waitcnt lgkmcnt(6)
    buffer_store_dwordx4 a[252:255], v26, s[76:79], 0 offen offset:3072 sc1
    v_mfma_f32_16x16x32_bf16 v[132:135], a[144:147], v[36:39], v[100:103]
    v_exp_f32 v140, v140
    v_mfma_f32_16x16x32_bf16 v[132:135], a[148:151], v[40:43], v[132:135]
    ds_read_b64_tr_b16 a[200:201], v10 offset:8192
    v_cvt_pk_bf16_f32 v223, v138, v139
    v_mfma_f32_16x16x32_bf16 v[132:135], a[152:155], v[44:47], v[132:135]
    v_exp_f32 v141, v141
    v_mfma_f32_16x16x32_bf16 v[132:135], a[156:159], v[48:51], v[132:135]
    ds_read_b64_tr_b16 a[202:203], v10 offset:12288
    v_mfma_f32_16x16x32_bf16 v[136:139], a[156:159], v[64:67], v[104:107]
    v_exp_f32 v142, v142
    v_mfma_f32_16x16x32_bf16 v[136:139], a[152:155], v[60:63], v[136:139]
    ds_read_b128 a[168:171], v3 offset:40960
    v_cvt_pk_bf16_f32 v230, v140, v141
    v_mfma_f32_16x16x32_bf16 v[136:139], a[148:151], v[56:59], v[136:139]
    v_exp_f32 v143, v143
    v_mfma_f32_16x16x32_bf16 v[136:139], a[144:147], v[52:55], v[136:139]
    ds_read_b64_tr_b16 a[204:205], v10 offset:32768
    v_mfma_f32_16x16x32_bf16 a[48:51], a[216:219], v[180:183], 0
    v_exp_f32 v144, v144
    v_mfma_f32_16x16x32_bf16 a[48:51], a[220:223], v[184:187], a[48:51]
    ds_read_b64_tr_b16 a[206:207], v10 offset:36864
    v_cvt_pk_bf16_f32 v231, v142, v143
    v_mfma_f32_16x16x32_bf16 a[52:55], a[220:223], v[192:195], 0
    v_exp_f32 v145, v145
    v_mfma_f32_16x16x32_bf16 a[52:55], a[216:219], v[188:191], a[52:55]
    ds_read_b128 a[172:175], v4 offset:40960
    v_mfma_f32_16x16x32_bf16 a[56:59], a[216:219], v[196:199], 0
    v_exp_f32 v146, v146
    v_mfma_f32_16x16x32_bf16 a[56:59], a[220:223], v[200:203], a[56:59]
    v_cvt_pk_bf16_f32 v238, v144, v145
    v_mfma_f32_16x16x32_bf16 a[60:63], a[220:223], v[208:211], 0
    v_exp_f32 v147, v147
    v_mfma_f32_16x16x32_bf16 a[60:63], a[216:219], v[204:207], a[60:63]
    buffer_load_dwordx4 v18, s[12:15], s29 offen offset:1024 lds
    v_smfmac_f32_16x16x64_bf16 a[228:231], v[244:247], v[188:195], v248
    s_waitcnt lgkmcnt(6)
    buffer_store_dwordx4 v[252:255], v26, s[76:79], s45 offen offset:0 sc1
    v_mfma_f32_16x16x32_bf16 v[140:143], a[144:147], v[68:71], v[108:111]
    s_cmp_eq_u32 s6, 255
    s_cbranch_scc1 L_rt_local
L_rt_back_local:
    v_exp_f32 v148, v148
    v_mfma_f32_16x16x32_bf16 v[140:143], a[148:151], v[72:75], v[140:143]
    ds_read_b64_tr_b16 a[208:209], v11 offset:8192
    v_cvt_pk_bf16_f32 v239, v146, v147
    v_mfma_f32_16x16x32_bf16 v[140:143], a[152:155], v[76:79], v[140:143]
    v_exp_f32 v149, v149
    v_mfma_f32_16x16x32_bf16 v[140:143], a[156:159], v[80:83], v[140:143]
    ds_read_b64_tr_b16 a[210:211], v11 offset:12288
    v_mfma_f32_16x16x32_bf16 v[144:147], a[156:159], v[96:99], v[112:115]
    v_exp_f32 v150, v150
    v_mfma_f32_16x16x32_bf16 v[144:147], a[152:155], v[92:95], v[144:147]
    ds_read_b128 a[176:179], v1 offset:45056
    v_cvt_pk_bf16_f32 v216, v148, v149
    v_mfma_f32_16x16x32_bf16 v[144:147], a[148:151], v[88:91], v[144:147]
    v_exp_f32 v151, v151
    v_mfma_f32_16x16x32_bf16 v[144:147], a[144:147], v[84:87], v[144:147]
    ds_read_b64_tr_b16 a[212:213], v11 offset:32768
    v_mfma_f32_16x16x32_bf16 a[64:67], a[192:195], v[180:183], 0
    v_exp_f32 v152, v152
    v_mfma_f32_16x16x32_bf16 a[64:67], a[196:199], v[184:187], a[64:67]
    ds_read_b64_tr_b16 a[214:215], v11 offset:36864
    v_cvt_pk_bf16_f32 v217, v150, v151
    v_mfma_f32_16x16x32_bf16 a[68:71], a[196:199], v[192:195], 0
    v_exp_f32 v153, v153
    v_mfma_f32_16x16x32_bf16 a[68:71], a[192:195], v[188:191], a[68:71]
    ds_read_b128 a[180:183], v2 offset:45056
    v_cvt_pk_bf16_f32 v224, v152, v153
    v_mfma_f32_16x16x32_bf16 a[72:75], a[192:195], v[196:199], 0
    v_exp_f32 v154, v154
    v_mfma_f32_16x16x32_bf16 a[72:75], a[196:199], v[200:203], a[72:75]
    buffer_load_dwordx4 v17, s[12:15], s29 offen offset:2048 lds
    v_mfma_f32_16x16x32_bf16 a[76:79], a[196:199], v[208:211], 0
    v_exp_f32 v155, v155
    v_mfma_f32_16x16x32_bf16 a[76:79], a[192:195], v[204:207], a[76:79]
    s_waitcnt lgkmcnt(6)
    v_mfma_f32_16x16x32_bf16 v[148:151], a[160:163], v[36:39], v[100:103]
    v_exp_f32 v156, v156
    v_mfma_f32_16x16x32_bf16 v[148:151], a[164:167], v[40:43], v[148:151]
    ds_read_b64_tr_b16 a[216:217], v12 offset:8192
    v_cvt_pk_bf16_f32 v225, v154, v155
    v_mfma_f32_16x16x32_bf16 v[148:151], a[168:171], v[44:47], v[148:151]
    v_exp_f32 v157, v157
    v_mfma_f32_16x16x32_bf16 v[148:151], a[172:175], v[48:51], v[148:151]
    ds_read_b64_tr_b16 a[218:219], v12 offset:12288
    v_mfma_f32_16x16x32_bf16 v[152:155], a[172:175], v[64:67], v[104:107]
    v_exp_f32 v158, v158
    v_mfma_f32_16x16x32_bf16 v[152:155], a[168:171], v[60:63], v[152:155]
    ds_read_b128 a[184:187], v3 offset:45056
    v_cvt_pk_bf16_f32 v232, v156, v157
    v_mfma_f32_16x16x32_bf16 v[152:155], a[164:167], v[56:59], v[152:155]
    v_exp_f32 v159, v159
    v_mfma_f32_16x16x32_bf16 v[152:155], a[160:163], v[52:55], v[152:155]
    ds_read_b64_tr_b16 a[220:221], v12 offset:32768
    v_mfma_f32_16x16x32_bf16 a[80:83], a[200:203], v[180:183], 0
    v_exp_f32 v160, v160
    v_mfma_f32_16x16x32_bf16 a[80:83], a[204:207], v[184:187], a[80:83]
    ds_read_b64_tr_b16 a[222:223], v12 offset:36864
    v_cvt_pk_bf16_f32 v233, v158, v159
    v_mfma_f32_16x16x32_bf16 a[84:87], a[204:207], v[192:195], 0
    v_exp_f32 v161, v161
    v_mfma_f32_16x16x32_bf16 a[84:87], a[200:203], v[188:191], a[84:87]
    ds_read_b128 a[188:191], v4 offset:45056
    v_mfma_f32_16x16x32_bf16 a[88:91], a[200:203], v[196:199], 0
    v_exp_f32 v162, v162
    v_mfma_f32_16x16x32_bf16 a[88:91], a[204:207], v[200:203], a[88:91]
    v_cvt_pk_bf16_f32 v240, v160, v161
    v_mfma_f32_16x16x32_bf16 a[92:95], a[204:207], v[208:211], 0
    v_exp_f32 v163, v163
    v_mfma_f32_16x16x32_bf16 a[92:95], a[200:203], v[204:207], a[92:95]
    buffer_load_dwordx4 v18, s[12:15], s29 offen offset:3072 lds
    v_smfmac_f32_16x16x64_bf16 a[232:235], v[244:247], v[196:203], v248
    s_waitcnt vmcnt(13) lgkmcnt(6)
    s_barrier
    s_add_u32 s29, s29, 16384
    v_mfma_f32_16x16x32_bf16 v[156:159], a[160:163], v[68:71], v[108:111]
    v_exp_f32 v164, v164
    v_mfma_f32_16x16x32_bf16 v[156:159], a[164:167], v[72:75], v[156:159]
    ds_read_b64_tr_b16 a[192:193], v5 offset:16384
    v_cvt_pk_bf16_f32 v241, v162, v163
    v_mfma_f32_16x16x32_bf16 v[156:159], a[168:171], v[76:79], v[156:159]
    v_exp_f32 v165, v165
    v_mfma_f32_16x16x32_bf16 v[156:159], a[172:175], v[80:83], v[156:159]
    ds_read_b64_tr_b16 a[194:195], v5 offset:20480
    v_mfma_f32_16x16x32_bf16 v[160:163], a[172:175], v[96:99], v[112:115]
    v_exp_f32 v166, v166
    v_mfma_f32_16x16x32_bf16 v[160:163], a[168:171], v[92:95], v[160:163]
    ds_read_b128 a[128:131], v1 offset:0
    v_cvt_pk_bf16_f32 v218, v164, v165
    v_mfma_f32_16x16x32_bf16 v[160:163], a[164:167], v[88:91], v[160:163]
    v_exp_f32 v167, v167
    v_mfma_f32_16x16x32_bf16 v[160:163], a[160:163], v[84:87], v[160:163]
    ds_read_b64_tr_b16 a[196:197], v5 offset:40960
    v_mfma_f32_16x16x32_bf16 a[96:99], a[208:211], v[180:183], 0
    v_exp_f32 v168, v168
    v_mfma_f32_16x16x32_bf16 a[96:99], a[212:215], v[184:187], a[96:99]
    ds_read_b64_tr_b16 a[198:199], v5 offset:45056
    v_cvt_pk_bf16_f32 v219, v166, v167
    v_mfma_f32_16x16x32_bf16 a[100:103], a[212:215], v[192:195], 0
    v_exp_f32 v169, v169
    v_mfma_f32_16x16x32_bf16 a[100:103], a[208:211], v[188:191], a[100:103]
    ds_read_b128 a[132:135], v2 offset:0
    v_cvt_pk_bf16_f32 v226, v168, v169
    v_mfma_f32_16x16x32_bf16 a[104:107], a[208:211], v[196:199], 0
    s_add_u32 m0, s34, 16384
    v_exp_f32 v170, v170
    v_mfma_f32_16x16x32_bf16 a[104:107], a[212:215], v[200:203], a[104:107]
    buffer_load_dwordx4 v13, s[8:11], s28 offen offset:0 lds
    v_mfma_f32_16x16x32_bf16 a[108:111], a[212:215], v[208:211], 0
    v_exp_f32 v171, v171
    v_mfma_f32_16x16x32_bf16 a[108:111], a[208:211], v[204:207], a[108:111]
    s_waitcnt lgkmcnt(6)
    v_mfma_f32_16x16x32_bf16 v[164:167], a[176:179], v[36:39], v[100:103]
    s_cmp_eq_u32 s6, 255
    s_cbranch_scc1 L_rt_merge
L_rt_back_merge:
    v_exp_f32 v172, v172
    v_mfma_f32_16x16x32_bf16 v[164:167], a[180:183], v[40:43], v[164:167]
    ds_read_b64_tr_b16 a[200:201], v6 offset:16384
    v_cvt_pk_bf16_f32 v227, v170, v171
    v_mfma_f32_16x16x32_bf16 v[164:167], a[184:187], v[44:47], v[164:167]
    v_exp_f32 v173, v173
    v_mfma_f32_16x16x32_bf16 v[164:167], a[188:191], v[48:51], v[164:167]
    ds_read_b64_tr_b16 a[202:203], v6 offset:20480
    v_mfma_f32_16x16x32_bf16 v[168:171], a[188:191], v[64:67], v[104:107]
    v_exp_f32 v174, v174
    v_mfma_f32_16x16x32_bf16 v[168:171], a[184:187], v[60:63], v[168:171]
    ds_read_b128 a[136:139], v3 offset:0
    v_cvt_pk_bf16_f32 v234, v172, v173
    v_mfma_f32_16x16x32_bf16 v[168:171], a[180:183], v[56:59], v[168:171]
    v_exp_f32 v175, v175
    v_mfma_f32_16x16x32_bf16 v[168:171], a[176:179], v[52:55], v[168:171]
    ds_read_b64_tr_b16 a[204:205], v6 offset:40960
    v_mfma_f32_16x16x32_bf16 a[112:115], a[216:219], v[180:183], 0
    v_exp_f32 v176, v176
    v_mfma_f32_16x16x32_bf16 a[112:115], a[220:223], v[184:187], a[112:115]
    ds_read_b64_tr_b16 a[206:207], v6 offset:45056
    v_cvt_pk_bf16_f32 v235, v174, v175
    v_mfma_f32_16x16x32_bf16 a[116:119], a[220:223], v[192:195], 0
    v_exp_f32 v177, v177
    v_mfma_f32_16x16x32_bf16 a[116:119], a[216:219], v[188:191], a[116:119]
    ds_read_b128 a[140:143], v4 offset:0
    v_mfma_f32_16x16x32_bf16 a[120:123], a[216:219], v[196:199], 0
    v_exp_f32 v178, v178
    v_mfma_f32_16x16x32_bf16 a[120:123], a[220:223], v[200:203], a[120:123]
    v_cvt_pk_bf16_f32 v242, v176, v177
    v_mfma_f32_16x16x32_bf16 a[124:127], a[220:223], v[208:211], 0
    v_exp_f32 v179, v179
    v_mfma_f32_16x16x32_bf16 a[124:127], a[216:219], v[204:207], a[124:127]
    buffer_load_dwordx4 v14, s[8:11], s28 offen offset:1024 lds
    v_smfmac_f32_16x16x64_bf16 a[236:239], v[244:247], v[204:211], v248
    s_waitcnt lgkmcnt(6)
    s_mov_b32 s35, 5
.p2align 6
L_attn_loop:
    v_mfma_f32_16x16x32_bf16 v[172:175], a[176:179], v[68:71], v[108:111]
    v_exp_f32 v116, v116
    v_mfma_f32_16x16x32_bf16 v[172:175], a[180:183], v[72:75], v[172:175]
    ds_read_b64_tr_b16 a[208:209], v7 offset:16384
    v_cvt_pk_bf16_f32 v243, v178, v179
    v_mfma_f32_16x16x32_bf16 v[172:175], a[184:187], v[76:79], v[172:175]
    v_exp_f32 v117, v117
    v_mfma_f32_16x16x32_bf16 v[172:175], a[188:191], v[80:83], v[172:175]
    ds_read_b64_tr_b16 a[210:211], v7 offset:20480
    v_mfma_f32_16x16x32_bf16 v[176:179], a[188:191], v[96:99], v[112:115]
    v_exp_f32 v118, v118
    v_mfma_f32_16x16x32_bf16 v[176:179], a[184:187], v[92:95], v[176:179]
    ds_read_b128 a[144:147], v1 offset:4096
    v_cvt_pk_bf16_f32 v180, v116, v117
    v_mfma_f32_16x16x32_bf16 v[176:179], a[180:183], v[88:91], v[176:179]
    v_exp_f32 v119, v119
    v_mfma_f32_16x16x32_bf16 v[176:179], a[176:179], v[84:87], v[176:179]
    ds_read_b64_tr_b16 a[212:213], v7 offset:40960
    v_mfma_f32_16x16x32_bf16 a[0:3], a[192:195], v[212:215], a[0:3]
    v_exp_f32 v120, v120
    v_mfma_f32_16x16x32_bf16 a[0:3], a[196:199], v[216:219], a[0:3]
    ds_read_b64_tr_b16 a[214:215], v7 offset:45056
    v_cvt_pk_bf16_f32 v181, v118, v119
    v_mfma_f32_16x16x32_bf16 a[4:7], a[196:199], v[224:227], a[4:7]
    v_exp_f32 v121, v121
    v_mfma_f32_16x16x32_bf16 a[4:7], a[192:195], v[220:223], a[4:7]
    ds_read_b128 a[148:151], v2 offset:4096
    v_cvt_pk_bf16_f32 v188, v120, v121
    v_mfma_f32_16x16x32_bf16 a[8:11], a[192:195], v[228:231], a[8:11]
    v_exp_f32 v122, v122
    v_mfma_f32_16x16x32_bf16 a[8:11], a[196:199], v[232:235], a[8:11]
    buffer_load_dwordx4 v15, s[8:11], s28 offen offset:2048 lds
    v_mfma_f32_16x16x32_bf16 a[12:15], a[196:199], v[240:243], a[12:15]
    v_exp_f32 v123, v123
    v_mfma_f32_16x16x32_bf16 a[12:15], a[192:195], v[236:239], a[12:15]
    s_waitcnt lgkmcnt(6)
    v_mfma_f32_16x16x32_bf16 v[116:119], a[128:131], v[36:39], v[100:103]
    v_exp_f32 v124, v124
    v_mfma_f32_16x16x32_bf16 v[116:119], a[132:135], v[40:43], v[116:119]
    ds_read_b64_tr_b16 a[216:217], v8 offset:16384
    v_cvt_pk_bf16_f32 v189, v122, v123
    v_mfma_f32_16x16x32_bf16 v[116:119], a[136:139], v[44:47], v[116:119]
    v_exp_f32 v125, v125
    v_mfma_f32_16x16x32_bf16 v[116:119], a[140:143], v[48:51], v[116:119]
    ds_read_b64_tr_b16 a[218:219], v8 offset:20480
    v_mfma_f32_16x16x32_bf16 v[120:123], a[140:143], v[64:67], v[104:107]
    v_exp_f32 v126, v126
    v_mfma_f32_16x16x32_bf16 v[120:123], a[136:139], v[60:63], v[120:123]
    ds_read_b128 a[152:155], v3 offset:4096
    v_cvt_pk_bf16_f32 v196, v124, v125
    v_mfma_f32_16x16x32_bf16 v[120:123], a[132:135], v[56:59], v[120:123]
    v_exp_f32 v127, v127
    v_mfma_f32_16x16x32_bf16 v[120:123], a[128:131], v[52:55], v[120:123]
    ds_read_b64_tr_b16 a[220:221], v8 offset:40960
    v_mfma_f32_16x16x32_bf16 a[16:19], a[200:203], v[212:215], a[16:19]
    v_exp_f32 v128, v128
    v_mfma_f32_16x16x32_bf16 a[16:19], a[204:207], v[216:219], a[16:19]
    ds_read_b64_tr_b16 a[222:223], v8 offset:45056
    v_cvt_pk_bf16_f32 v197, v126, v127
    v_mfma_f32_16x16x32_bf16 a[20:23], a[204:207], v[224:227], a[20:23]
    v_exp_f32 v129, v129
    v_mfma_f32_16x16x32_bf16 a[20:23], a[200:203], v[220:223], a[20:23]
    ds_read_b128 a[156:159], v4 offset:4096
    v_mfma_f32_16x16x32_bf16 a[24:27], a[200:203], v[228:231], a[24:27]
    v_exp_f32 v130, v130
    v_mfma_f32_16x16x32_bf16 a[24:27], a[204:207], v[232:235], a[24:27]
    v_cvt_pk_bf16_f32 v204, v128, v129
    v_mfma_f32_16x16x32_bf16 a[28:31], a[204:207], v[240:243], a[28:31]
    v_exp_f32 v131, v131
    v_mfma_f32_16x16x32_bf16 a[28:31], a[200:203], v[236:239], a[28:31]
    buffer_load_dwordx4 v16, s[8:11], s28 offen offset:3072 lds
    v_smfmac_f32_16x16x64_bf16 a[224:227], v[244:247], v[212:219], v248
    s_waitcnt lgkmcnt(6)
    v_mfma_f32_16x16x32_bf16 v[124:127], a[128:131], v[68:71], v[108:111]
    s_cmp_eq_u32 s36, 0
    s_cbranch_scc1 L_site0
L_site_back0:
    v_exp_f32 v132, v132
    v_mfma_f32_16x16x32_bf16 v[124:127], a[132:135], v[72:75], v[124:127]
    ds_read_b64_tr_b16 a[192:193], v9 offset:16384
    v_cvt_pk_bf16_f32 v205, v130, v131
    v_mfma_f32_16x16x32_bf16 v[124:127], a[136:139], v[76:79], v[124:127]
    v_exp_f32 v133, v133
    v_mfma_f32_16x16x32_bf16 v[124:127], a[140:143], v[80:83], v[124:127]
    ds_read_b64_tr_b16 a[194:195], v9 offset:20480
    v_mfma_f32_16x16x32_bf16 v[128:131], a[140:143], v[96:99], v[112:115]
    v_exp_f32 v134, v134
    v_mfma_f32_16x16x32_bf16 v[128:131], a[136:139], v[92:95], v[128:131]
    ds_read_b128 a[160:163], v1 offset:8192
    v_cvt_pk_bf16_f32 v182, v132, v133
    v_mfma_f32_16x16x32_bf16 v[128:131], a[132:135], v[88:91], v[128:131]
    v_exp_f32 v135, v135
    v_mfma_f32_16x16x32_bf16 v[128:131], a[128:131], v[84:87], v[128:131]
    ds_read_b64_tr_b16 a[196:197], v9 offset:40960
    v_mfma_f32_16x16x32_bf16 a[32:35], a[208:211], v[212:215], a[32:35]
    v_exp_f32 v136, v136
    v_mfma_f32_16x16x32_bf16 a[32:35], a[212:215], v[216:219], a[32:35]
    ds_read_b64_tr_b16 a[198:199], v9 offset:45056
    v_cvt_pk_bf16_f32 v183, v134, v135
    v_mfma_f32_16x16x32_bf16 a[36:39], a[212:215], v[224:227], a[36:39]
    v_exp_f32 v137, v137
    v_mfma_f32_16x16x32_bf16 a[36:39], a[208:211], v[220:223], a[36:39]
    ds_read_b128 a[164:167], v2 offset:8192
    v_cvt_pk_bf16_f32 v190, v136, v137
    v_mfma_f32_16x16x32_bf16 a[40:43], a[208:211], v[228:231], a[40:43]
    s_add_u32 s28, s28, 16384
    s_mov_b32 m0, s33
    v_exp_f32 v138, v138
    v_mfma_f32_16x16x32_bf16 a[40:43], a[212:215], v[232:235], a[40:43]
    buffer_load_dwordx4 v17, s[12:15], s29 offen offset:0 lds
    v_mfma_f32_16x16x32_bf16 a[44:47], a[212:215], v[240:243], a[44:47]
    v_exp_f32 v139, v139
    v_mfma_f32_16x16x32_bf16 a[44:47], a[208:211], v[236:239], a[44:47]
    s_waitcnt lgkmcnt(6)
    v_mfma_f32_16x16x32_bf16 v[132:135], a[144:147], v[36:39], v[100:103]
    v_exp_f32 v140, v140
    v_mfma_f32_16x16x32_bf16 v[132:135], a[148:151], v[40:43], v[132:135]
    ds_read_b64_tr_b16 a[200:201], v10 offset:16384
    v_cvt_pk_bf16_f32 v191, v138, v139
    v_mfma_f32_16x16x32_bf16 v[132:135], a[152:155], v[44:47], v[132:135]
    v_exp_f32 v141, v141
    v_mfma_f32_16x16x32_bf16 v[132:135], a[156:159], v[48:51], v[132:135]
    ds_read_b64_tr_b16 a[202:203], v10 offset:20480
    v_mfma_f32_16x16x32_bf16 v[136:139], a[156:159], v[64:67], v[104:107]
    v_exp_f32 v142, v142
    v_mfma_f32_16x16x32_bf16 v[136:139], a[152:155], v[60:63], v[136:139]
    ds_read_b128 a[168:171], v3 offset:8192
    v_cvt_pk_bf16_f32 v198, v140, v141
    v_mfma_f32_16x16x32_bf16 v[136:139], a[148:151], v[56:59], v[136:139]
    v_exp_f32 v143, v143
    v_mfma_f32_16x16x32_bf16 v[136:139], a[144:147], v[52:55], v[136:139]
    ds_read_b64_tr_b16 a[204:205], v10 offset:40960
    v_mfma_f32_16x16x32_bf16 a[48:51], a[216:219], v[212:215], a[48:51]
    v_exp_f32 v144, v144
    v_mfma_f32_16x16x32_bf16 a[48:51], a[220:223], v[216:219], a[48:51]
    ds_read_b64_tr_b16 a[206:207], v10 offset:45056
    v_cvt_pk_bf16_f32 v199, v142, v143
    v_mfma_f32_16x16x32_bf16 a[52:55], a[220:223], v[224:227], a[52:55]
    v_exp_f32 v145, v145
    v_mfma_f32_16x16x32_bf16 a[52:55], a[216:219], v[220:223], a[52:55]
    ds_read_b128 a[172:175], v4 offset:8192
    v_mfma_f32_16x16x32_bf16 a[56:59], a[216:219], v[228:231], a[56:59]
    v_exp_f32 v146, v146
    v_mfma_f32_16x16x32_bf16 a[56:59], a[220:223], v[232:235], a[56:59]
    v_cvt_pk_bf16_f32 v206, v144, v145
    v_mfma_f32_16x16x32_bf16 a[60:63], a[220:223], v[240:243], a[60:63]
    v_exp_f32 v147, v147
    v_mfma_f32_16x16x32_bf16 a[60:63], a[216:219], v[236:239], a[60:63]
    buffer_load_dwordx4 v18, s[12:15], s29 offen offset:1024 lds
    v_smfmac_f32_16x16x64_bf16 a[228:231], v[244:247], v[220:227], v248
    s_waitcnt lgkmcnt(6)
    v_mfma_f32_16x16x32_bf16 v[140:143], a[144:147], v[68:71], v[108:111]
    v_exp_f32 v148, v148
    v_mfma_f32_16x16x32_bf16 v[140:143], a[148:151], v[72:75], v[140:143]
    ds_read_b64_tr_b16 a[208:209], v11 offset:16384
    v_cvt_pk_bf16_f32 v207, v146, v147
    v_mfma_f32_16x16x32_bf16 v[140:143], a[152:155], v[76:79], v[140:143]
    v_exp_f32 v149, v149
    v_mfma_f32_16x16x32_bf16 v[140:143], a[156:159], v[80:83], v[140:143]
    ds_read_b64_tr_b16 a[210:211], v11 offset:20480
    v_mfma_f32_16x16x32_bf16 v[144:147], a[156:159], v[96:99], v[112:115]
    v_exp_f32 v150, v150
    v_mfma_f32_16x16x32_bf16 v[144:147], a[152:155], v[92:95], v[144:147]
    ds_read_b128 a[176:179], v1 offset:12288
    v_cvt_pk_bf16_f32 v184, v148, v149
    v_mfma_f32_16x16x32_bf16 v[144:147], a[148:151], v[88:91], v[144:147]
    v_exp_f32 v151, v151
    v_mfma_f32_16x16x32_bf16 v[144:147], a[144:147], v[84:87], v[144:147]
    ds_read_b64_tr_b16 a[212:213], v11 offset:40960
    v_mfma_f32_16x16x32_bf16 a[64:67], a[192:195], v[212:215], a[64:67]
    v_exp_f32 v152, v152
    v_mfma_f32_16x16x32_bf16 a[64:67], a[196:199], v[216:219], a[64:67]
    ds_read_b64_tr_b16 a[214:215], v11 offset:45056
    v_cvt_pk_bf16_f32 v185, v150, v151
    v_mfma_f32_16x16x32_bf16 a[68:71], a[196:199], v[224:227], a[68:71]
    v_exp_f32 v153, v153
    v_mfma_f32_16x16x32_bf16 a[68:71], a[192:195], v[220:223], a[68:71]
    ds_read_b128 a[180:183], v2 offset:12288
    v_cvt_pk_bf16_f32 v192, v152, v153
    v_mfma_f32_16x16x32_bf16 a[72:75], a[192:195], v[228:231], a[72:75]
    v_exp_f32 v154, v154
    v_mfma_f32_16x16x32_bf16 a[72:75], a[196:199], v[232:235], a[72:75]
    buffer_load_dwordx4 v17, s[12:15], s29 offen offset:2048 lds
    v_mfma_f32_16x16x32_bf16 a[76:79], a[196:199], v[240:243], a[76:79]
    v_exp_f32 v155, v155
    v_mfma_f32_16x16x32_bf16 a[76:79], a[192:195], v[236:239], a[76:79]
    s_waitcnt lgkmcnt(6)
    v_mfma_f32_16x16x32_bf16 v[148:151], a[160:163], v[36:39], v[100:103]
    v_exp_f32 v156, v156
    v_mfma_f32_16x16x32_bf16 v[148:151], a[164:167], v[40:43], v[148:151]
    ds_read_b64_tr_b16 a[216:217], v12 offset:16384
    v_cvt_pk_bf16_f32 v193, v154, v155
    v_mfma_f32_16x16x32_bf16 v[148:151], a[168:171], v[44:47], v[148:151]
    v_exp_f32 v157, v157
    v_mfma_f32_16x16x32_bf16 v[148:151], a[172:175], v[48:51], v[148:151]
    ds_read_b64_tr_b16 a[218:219], v12 offset:20480
    v_mfma_f32_16x16x32_bf16 v[152:155], a[172:175], v[64:67], v[104:107]
    v_exp_f32 v158, v158
    v_mfma_f32_16x16x32_bf16 v[152:155], a[168:171], v[60:63], v[152:155]
    ds_read_b128 a[184:187], v3 offset:12288
    v_cvt_pk_bf16_f32 v200, v156, v157
    v_mfma_f32_16x16x32_bf16 v[152:155], a[164:167], v[56:59], v[152:155]
    v_exp_f32 v159, v159
    v_mfma_f32_16x16x32_bf16 v[152:155], a[160:163], v[52:55], v[152:155]
    ds_read_b64_tr_b16 a[220:221], v12 offset:40960
    v_mfma_f32_16x16x32_bf16 a[80:83], a[200:203], v[212:215], a[80:83]
    v_exp_f32 v160, v160
    v_mfma_f32_16x16x32_bf16 a[80:83], a[204:207], v[216:219], a[80:83]
    ds_read_b64_tr_b16 a[222:223], v12 offset:45056
    v_cvt_pk_bf16_f32 v201, v158, v159
    v_mfma_f32_16x16x32_bf16 a[84:87], a[204:207], v[224:227], a[84:87]
    v_exp_f32 v161, v161
    v_mfma_f32_16x16x32_bf16 a[84:87], a[200:203], v[220:223], a[84:87]
    ds_read_b128 a[188:191], v4 offset:12288
    v_mfma_f32_16x16x32_bf16 a[88:91], a[200:203], v[228:231], a[88:91]
    v_exp_f32 v162, v162
    v_mfma_f32_16x16x32_bf16 a[88:91], a[204:207], v[232:235], a[88:91]
    v_cvt_pk_bf16_f32 v208, v160, v161
    v_mfma_f32_16x16x32_bf16 a[92:95], a[204:207], v[240:243], a[92:95]
    v_exp_f32 v163, v163
    v_mfma_f32_16x16x32_bf16 a[92:95], a[200:203], v[236:239], a[92:95]
    buffer_load_dwordx4 v18, s[12:15], s29 offen offset:3072 lds
    v_smfmac_f32_16x16x64_bf16 a[232:235], v[244:247], v[228:235], v248
    s_waitcnt vmcnt(8) lgkmcnt(6)
    s_barrier
    s_add_u32 s29, s29, 16384
    v_mfma_f32_16x16x32_bf16 v[156:159], a[160:163], v[68:71], v[108:111]
    v_exp_f32 v164, v164
    v_mfma_f32_16x16x32_bf16 v[156:159], a[164:167], v[72:75], v[156:159]
    ds_read_b64_tr_b16 a[192:193], v5 offset:57344
    v_cvt_pk_bf16_f32 v209, v162, v163
    v_mfma_f32_16x16x32_bf16 v[156:159], a[168:171], v[76:79], v[156:159]
    v_exp_f32 v165, v165
    v_mfma_f32_16x16x32_bf16 v[156:159], a[172:175], v[80:83], v[156:159]
    ds_read_b64_tr_b16 a[194:195], v5 offset:61440
    v_mfma_f32_16x16x32_bf16 v[160:163], a[172:175], v[96:99], v[112:115]
    v_exp_f32 v166, v166
    v_mfma_f32_16x16x32_bf16 v[160:163], a[168:171], v[92:95], v[160:163]
    ds_read_b128 a[128:131], v1 offset:49152
    v_cvt_pk_bf16_f32 v186, v164, v165
    v_mfma_f32_16x16x32_bf16 v[160:163], a[164:167], v[88:91], v[160:163]
    v_exp_f32 v167, v167
    v_mfma_f32_16x16x32_bf16 v[160:163], a[160:163], v[84:87], v[160:163]
    ds_read_b64_tr_b16 a[196:197], v5 offset:0
    v_mfma_f32_16x16x32_bf16 a[96:99], a[208:211], v[212:215], a[96:99]
    v_exp_f32 v168, v168
    v_mfma_f32_16x16x32_bf16 a[96:99], a[212:215], v[216:219], a[96:99]
    ds_read_b64_tr_b16 a[198:199], v5 offset:4096
    v_cvt_pk_bf16_f32 v187, v166, v167
    v_mfma_f32_16x16x32_bf16 a[100:103], a[212:215], v[224:227], a[100:103]
    v_exp_f32 v169, v169
    v_mfma_f32_16x16x32_bf16 a[100:103], a[208:211], v[220:223], a[100:103]
    ds_read_b128 a[132:135], v2 offset:49152
    v_cvt_pk_bf16_f32 v194, v168, v169
    v_mfma_f32_16x16x32_bf16 a[104:107], a[208:211], v[228:231], a[104:107]
    s_add_u32 m0, s34, 32768
    v_exp_f32 v170, v170
    v_mfma_f32_16x16x32_bf16 a[104:107], a[212:215], v[232:235], a[104:107]
    buffer_load_dwordx4 v13, s[8:11], s28 offen offset:0 lds
    v_mfma_f32_16x16x32_bf16 a[108:111], a[212:215], v[240:243], a[108:111]
    v_exp_f32 v171, v171
    v_mfma_f32_16x16x32_bf16 a[108:111], a[208:211], v[236:239], a[108:111]
    s_waitcnt lgkmcnt(6)
    v_mfma_f32_16x16x32_bf16 v[164:167], a[176:179], v[36:39], v[100:103]
    v_exp_f32 v172, v172
    v_mfma_f32_16x16x32_bf16 v[164:167], a[180:183], v[40:43], v[164:167]
    ds_read_b64_tr_b16 a[200:201], v6 offset:57344
    v_cvt_pk_bf16_f32 v195, v170, v171
    v_mfma_f32_16x16x32_bf16 v[164:167], a[184:187], v[44:47], v[164:167]
    v_exp_f32 v173, v173
    v_mfma_f32_16x16x32_bf16 v[164:167], a[188:191], v[48:51], v[164:167]
    ds_read_b64_tr_b16 a[202:203], v6 offset:61440
    v_mfma_f32_16x16x32_bf16 v[168:171], a[188:191], v[64:67], v[104:107]
    v_exp_f32 v174, v174
    v_mfma_f32_16x16x32_bf16 v[168:171], a[184:187], v[60:63], v[168:171]
    ds_read_b128 a[136:139], v3 offset:49152
    v_cvt_pk_bf16_f32 v202, v172, v173
    v_mfma_f32_16x16x32_bf16 v[168:171], a[180:183], v[56:59], v[168:171]
    v_exp_f32 v175, v175
    v_mfma_f32_16x16x32_bf16 v[168:171], a[176:179], v[52:55], v[168:171]
    ds_read_b64_tr_b16 a[204:205], v6 offset:0
    v_mfma_f32_16x16x32_bf16 a[112:115], a[216:219], v[212:215], a[112:115]
    v_exp_f32 v176, v176
    v_mfma_f32_16x16x32_bf16 a[112:115], a[220:223], v[216:219], a[112:115]
    ds_read_b64_tr_b16 a[206:207], v6 offset:4096
    v_cvt_pk_bf16_f32 v203, v174, v175
    v_mfma_f32_16x16x32_bf16 a[116:119], a[220:223], v[224:227], a[116:119]
    v_exp_f32 v177, v177
    v_mfma_f32_16x16x32_bf16 a[116:119], a[216:219], v[220:223], a[116:119]
    ds_read_b128 a[140:143], v4 offset:49152
    v_mfma_f32_16x16x32_bf16 a[120:123], a[216:219], v[228:231], a[120:123]
    v_exp_f32 v178, v178
    v_mfma_f32_16x16x32_bf16 a[120:123], a[220:223], v[232:235], a[120:123]
    v_cvt_pk_bf16_f32 v210, v176, v177
    v_mfma_f32_16x16x32_bf16 a[124:127], a[220:223], v[240:243], a[124:127]
    v_exp_f32 v179, v179
    v_mfma_f32_16x16x32_bf16 a[124:127], a[216:219], v[236:239], a[124:127]
    buffer_load_dwordx4 v14, s[8:11], s28 offen offset:1024 lds
    v_smfmac_f32_16x16x64_bf16 a[236:239], v[244:247], v[236:243], v248
    s_waitcnt lgkmcnt(6)
    v_mfma_f32_16x16x32_bf16 v[172:175], a[176:179], v[68:71], v[108:111]
    v_exp_f32 v116, v116
    v_mfma_f32_16x16x32_bf16 v[172:175], a[180:183], v[72:75], v[172:175]
    ds_read_b64_tr_b16 a[208:209], v7 offset:57344
    v_cvt_pk_bf16_f32 v211, v178, v179
    v_mfma_f32_16x16x32_bf16 v[172:175], a[184:187], v[76:79], v[172:175]
    v_exp_f32 v117, v117
    v_mfma_f32_16x16x32_bf16 v[172:175], a[188:191], v[80:83], v[172:175]
    ds_read_b64_tr_b16 a[210:211], v7 offset:61440
    v_mfma_f32_16x16x32_bf16 v[176:179], a[188:191], v[96:99], v[112:115]
    v_exp_f32 v118, v118
    v_mfma_f32_16x16x32_bf16 v[176:179], a[184:187], v[92:95], v[176:179]
    ds_read_b128 a[144:147], v1 offset:53248
    v_cvt_pk_bf16_f32 v212, v116, v117
    v_mfma_f32_16x16x32_bf16 v[176:179], a[180:183], v[88:91], v[176:179]
    v_exp_f32 v119, v119
    v_mfma_f32_16x16x32_bf16 v[176:179], a[176:179], v[84:87], v[176:179]
    ds_read_b64_tr_b16 a[212:213], v7 offset:0
    v_mfma_f32_16x16x32_bf16 a[0:3], a[192:195], v[180:183], a[0:3]
    v_exp_f32 v120, v120
    v_mfma_f32_16x16x32_bf16 a[0:3], a[196:199], v[184:187], a[0:3]
    ds_read_b64_tr_b16 a[214:215], v7 offset:4096
    v_cvt_pk_bf16_f32 v213, v118, v119
    v_mfma_f32_16x16x32_bf16 a[4:7], a[196:199], v[192:195], a[4:7]
    v_exp_f32 v121, v121
    v_mfma_f32_16x16x32_bf16 a[4:7], a[192:195], v[188:191], a[4:7]
    ds_read_b128 a[148:151], v2 offset:53248
    v_cvt_pk_bf16_f32 v220, v120, v121
    v_mfma_f32_16x16x32_bf16 a[8:11], a[192:195], v[196:199], a[8:11]
    v_exp_f32 v122, v122
    v_mfma_f32_16x16x32_bf16 a[8:11], a[196:199], v[200:203], a[8:11]
    buffer_load_dwordx4 v15, s[8:11], s28 offen offset:2048 lds
    v_mfma_f32_16x16x32_bf16 a[12:15], a[196:199], v[208:211], a[12:15]
    v_exp_f32 v123, v123
    v_mfma_f32_16x16x32_bf16 a[12:15], a[192:195], v[204:207], a[12:15]
    s_waitcnt lgkmcnt(6)
    v_mfma_f32_16x16x32_bf16 v[116:119], a[128:131], v[36:39], v[100:103]
    v_exp_f32 v124, v124
    v_mfma_f32_16x16x32_bf16 v[116:119], a[132:135], v[40:43], v[116:119]
    ds_read_b64_tr_b16 a[216:217], v8 offset:57344
    v_cvt_pk_bf16_f32 v221, v122, v123
    v_mfma_f32_16x16x32_bf16 v[116:119], a[136:139], v[44:47], v[116:119]
    v_exp_f32 v125, v125
    v_mfma_f32_16x16x32_bf16 v[116:119], a[140:143], v[48:51], v[116:119]
    ds_read_b64_tr_b16 a[218:219], v8 offset:61440
    v_mfma_f32_16x16x32_bf16 v[120:123], a[140:143], v[64:67], v[104:107]
    v_exp_f32 v126, v126
    v_mfma_f32_16x16x32_bf16 v[120:123], a[136:139], v[60:63], v[120:123]
    ds_read_b128 a[152:155], v3 offset:53248
    v_cvt_pk_bf16_f32 v228, v124, v125
    v_mfma_f32_16x16x32_bf16 v[120:123], a[132:135], v[56:59], v[120:123]
    v_exp_f32 v127, v127
    v_mfma_f32_16x16x32_bf16 v[120:123], a[128:131], v[52:55], v[120:123]
    ds_read_b64_tr_b16 a[220:221], v8 offset:0
    v_mfma_f32_16x16x32_bf16 a[16:19], a[200:203], v[180:183], a[16:19]
    v_exp_f32 v128, v128
    v_mfma_f32_16x16x32_bf16 a[16:19], a[204:207], v[184:187], a[16:19]
    ds_read_b64_tr_b16 a[222:223], v8 offset:4096
    v_cvt_pk_bf16_f32 v229, v126, v127
    v_mfma_f32_16x16x32_bf16 a[20:23], a[204:207], v[192:195], a[20:23]
    v_exp_f32 v129, v129
    v_mfma_f32_16x16x32_bf16 a[20:23], a[200:203], v[188:191], a[20:23]
    ds_read_b128 a[156:159], v4 offset:53248
    v_mfma_f32_16x16x32_bf16 a[24:27], a[200:203], v[196:199], a[24:27]
    v_exp_f32 v130, v130
    v_mfma_f32_16x16x32_bf16 a[24:27], a[204:207], v[200:203], a[24:27]
    v_cvt_pk_bf16_f32 v236, v128, v129
    v_mfma_f32_16x16x32_bf16 a[28:31], a[204:207], v[208:211], a[28:31]
    v_exp_f32 v131, v131
    v_mfma_f32_16x16x32_bf16 a[28:31], a[200:203], v[204:207], a[28:31]
    buffer_load_dwordx4 v16, s[8:11], s28 offen offset:3072 lds
    v_smfmac_f32_16x16x64_bf16 a[224:227], v[244:247], v[180:187], v248
    s_waitcnt lgkmcnt(6)
    v_mfma_f32_16x16x32_bf16 v[124:127], a[128:131], v[68:71], v[108:111]
    s_cmp_eq_u32 s36, 1
    s_cbranch_scc1 L_site1
L_site_back1:
    v_exp_f32 v132, v132
    v_mfma_f32_16x16x32_bf16 v[124:127], a[132:135], v[72:75], v[124:127]
    ds_read_b64_tr_b16 a[192:193], v9 offset:57344
    v_cvt_pk_bf16_f32 v237, v130, v131
    v_mfma_f32_16x16x32_bf16 v[124:127], a[136:139], v[76:79], v[124:127]
    v_exp_f32 v133, v133
    v_mfma_f32_16x16x32_bf16 v[124:127], a[140:143], v[80:83], v[124:127]
    ds_read_b64_tr_b16 a[194:195], v9 offset:61440
    v_mfma_f32_16x16x32_bf16 v[128:131], a[140:143], v[96:99], v[112:115]
    v_exp_f32 v134, v134
    v_mfma_f32_16x16x32_bf16 v[128:131], a[136:139], v[92:95], v[128:131]
    ds_read_b128 a[160:163], v1 offset:57344
    v_cvt_pk_bf16_f32 v214, v132, v133
    v_mfma_f32_16x16x32_bf16 v[128:131], a[132:135], v[88:91], v[128:131]
    v_exp_f32 v135, v135
    v_mfma_f32_16x16x32_bf16 v[128:131], a[128:131], v[84:87], v[128:131]
    ds_read_b64_tr_b16 a[196:197], v9 offset:0
    v_mfma_f32_16x16x32_bf16 a[32:35], a[208:211], v[180:183], a[32:35]
    v_exp_f32 v136, v136
    v_mfma_f32_16x16x32_bf16 a[32:35], a[212:215], v[184:187], a[32:35]
    ds_read_b64_tr_b16 a[198:199], v9 offset:4096
    v_cvt_pk_bf16_f32 v215, v134, v135
    v_mfma_f32_16x16x32_bf16 a[36:39], a[212:215], v[192:195], a[36:39]
    v_exp_f32 v137, v137
    v_mfma_f32_16x16x32_bf16 a[36:39], a[208:211], v[188:191], a[36:39]
    ds_read_b128 a[164:167], v2 offset:57344
    v_cvt_pk_bf16_f32 v222, v136, v137
    v_mfma_f32_16x16x32_bf16 a[40:43], a[208:211], v[196:199], a[40:43]
    s_add_u32 s28, s28, 16384
    s_mov_b32 m0, s30
    v_exp_f32 v138, v138
    v_mfma_f32_16x16x32_bf16 a[40:43], a[212:215], v[200:203], a[40:43]
    buffer_load_dwordx4 v17, s[12:15], s29 offen offset:0 lds
    v_mfma_f32_16x16x32_bf16 a[44:47], a[212:215], v[208:211], a[44:47]
    v_exp_f32 v139, v139
    v_mfma_f32_16x16x32_bf16 a[44:47], a[208:211], v[204:207], a[44:47]
    s_waitcnt lgkmcnt(6)
    v_mfma_f32_16x16x32_bf16 v[132:135], a[144:147], v[36:39], v[100:103]
    v_exp_f32 v140, v140
    v_mfma_f32_16x16x32_bf16 v[132:135], a[148:151], v[40:43], v[132:135]
    ds_read_b64_tr_b16 a[200:201], v10 offset:57344
    v_cvt_pk_bf16_f32 v223, v138, v139
    v_mfma_f32_16x16x32_bf16 v[132:135], a[152:155], v[44:47], v[132:135]
    v_exp_f32 v141, v141
    v_mfma_f32_16x16x32_bf16 v[132:135], a[156:159], v[48:51], v[132:135]
    ds_read_b64_tr_b16 a[202:203], v10 offset:61440
    v_mfma_f32_16x16x32_bf16 v[136:139], a[156:159], v[64:67], v[104:107]
    v_exp_f32 v142, v142
    v_mfma_f32_16x16x32_bf16 v[136:139], a[152:155], v[60:63], v[136:139]
    ds_read_b128 a[168:171], v3 offset:57344
    v_cvt_pk_bf16_f32 v230, v140, v141
    v_mfma_f32_16x16x32_bf16 v[136:139], a[148:151], v[56:59], v[136:139]
    v_exp_f32 v143, v143
    v_mfma_f32_16x16x32_bf16 v[136:139], a[144:147], v[52:55], v[136:139]
    ds_read_b64_tr_b16 a[204:205], v10 offset:0
    v_mfma_f32_16x16x32_bf16 a[48:51], a[216:219], v[180:183], a[48:51]
    v_exp_f32 v144, v144
    v_mfma_f32_16x16x32_bf16 a[48:51], a[220:223], v[184:187], a[48:51]
    ds_read_b64_tr_b16 a[206:207], v10 offset:4096
    v_cvt_pk_bf16_f32 v231, v142, v143
    v_mfma_f32_16x16x32_bf16 a[52:55], a[220:223], v[192:195], a[52:55]
    v_exp_f32 v145, v145
    v_mfma_f32_16x16x32_bf16 a[52:55], a[216:219], v[188:191], a[52:55]
    ds_read_b128 a[172:175], v4 offset:57344
    v_mfma_f32_16x16x32_bf16 a[56:59], a[216:219], v[196:199], a[56:59]
    v_exp_f32 v146, v146
    v_mfma_f32_16x16x32_bf16 a[56:59], a[220:223], v[200:203], a[56:59]
    v_cvt_pk_bf16_f32 v238, v144, v145
    v_mfma_f32_16x16x32_bf16 a[60:63], a[220:223], v[208:211], a[60:63]
    v_exp_f32 v147, v147
    v_mfma_f32_16x16x32_bf16 a[60:63], a[216:219], v[204:207], a[60:63]
    buffer_load_dwordx4 v18, s[12:15], s29 offen offset:1024 lds
    v_smfmac_f32_16x16x64_bf16 a[228:231], v[244:247], v[188:195], v248
    s_waitcnt lgkmcnt(6)
    v_mfma_f32_16x16x32_bf16 v[140:143], a[144:147], v[68:71], v[108:111]
    v_exp_f32 v148, v148
    v_mfma_f32_16x16x32_bf16 v[140:143], a[148:151], v[72:75], v[140:143]
    ds_read_b64_tr_b16 a[208:209], v11 offset:57344
    v_cvt_pk_bf16_f32 v239, v146, v147
    v_mfma_f32_16x16x32_bf16 v[140:143], a[152:155], v[76:79], v[140:143]
    v_exp_f32 v149, v149
    v_mfma_f32_16x16x32_bf16 v[140:143], a[156:159], v[80:83], v[140:143]
    ds_read_b64_tr_b16 a[210:211], v11 offset:61440
    v_mfma_f32_16x16x32_bf16 v[144:147], a[156:159], v[96:99], v[112:115]
    v_exp_f32 v150, v150
    v_mfma_f32_16x16x32_bf16 v[144:147], a[152:155], v[92:95], v[144:147]
    ds_read_b128 a[176:179], v1 offset:61440
    v_cvt_pk_bf16_f32 v216, v148, v149
    v_mfma_f32_16x16x32_bf16 v[144:147], a[148:151], v[88:91], v[144:147]
    v_exp_f32 v151, v151
    v_mfma_f32_16x16x32_bf16 v[144:147], a[144:147], v[84:87], v[144:147]
    ds_read_b64_tr_b16 a[212:213], v11 offset:0
    v_mfma_f32_16x16x32_bf16 a[64:67], a[192:195], v[180:183], a[64:67]
    v_exp_f32 v152, v152
    v_mfma_f32_16x16x32_bf16 a[64:67], a[196:199], v[184:187], a[64:67]
    ds_read_b64_tr_b16 a[214:215], v11 offset:4096
    v_cvt_pk_bf16_f32 v217, v150, v151
    v_mfma_f32_16x16x32_bf16 a[68:71], a[196:199], v[192:195], a[68:71]
    v_exp_f32 v153, v153
    v_mfma_f32_16x16x32_bf16 a[68:71], a[192:195], v[188:191], a[68:71]
    ds_read_b128 a[180:183], v2 offset:61440
    v_cvt_pk_bf16_f32 v224, v152, v153
    v_mfma_f32_16x16x32_bf16 a[72:75], a[192:195], v[196:199], a[72:75]
    v_exp_f32 v154, v154
    v_mfma_f32_16x16x32_bf16 a[72:75], a[196:199], v[200:203], a[72:75]
    buffer_load_dwordx4 v17, s[12:15], s29 offen offset:2048 lds
    v_mfma_f32_16x16x32_bf16 a[76:79], a[196:199], v[208:211], a[76:79]
    v_exp_f32 v155, v155
    v_mfma_f32_16x16x32_bf16 a[76:79], a[192:195], v[204:207], a[76:79]
    s_waitcnt lgkmcnt(6)
    v_mfma_f32_16x16x32_bf16 v[148:151], a[160:163], v[36:39], v[100:103]
    v_exp_f32 v156, v156
    v_mfma_f32_16x16x32_bf16 v[148:151], a[164:167], v[40:43], v[148:151]
    ds_read_b64_tr_b16 a[216:217], v12 offset:57344
    v_cvt_pk_bf16_f32 v225, v154, v155
    v_mfma_f32_16x16x32_bf16 v[148:151], a[168:171], v[44:47], v[148:151]
    v_exp_f32 v157, v157
    v_mfma_f32_16x16x32_bf16 v[148:151], a[172:175], v[48:51], v[148:151]
    ds_read_b64_tr_b16 a[218:219], v12 offset:61440
    v_mfma_f32_16x16x32_bf16 v[152:155], a[172:175], v[64:67], v[104:107]
    v_exp_f32 v158, v158
    v_mfma_f32_16x16x32_bf16 v[152:155], a[168:171], v[60:63], v[152:155]
    ds_read_b128 a[184:187], v3 offset:61440
    v_cvt_pk_bf16_f32 v232, v156, v157
    v_mfma_f32_16x16x32_bf16 v[152:155], a[164:167], v[56:59], v[152:155]
    v_exp_f32 v159, v159
    v_mfma_f32_16x16x32_bf16 v[152:155], a[160:163], v[52:55], v[152:155]
    ds_read_b64_tr_b16 a[220:221], v12 offset:0
    v_mfma_f32_16x16x32_bf16 a[80:83], a[200:203], v[180:183], a[80:83]
    v_exp_f32 v160, v160
    v_mfma_f32_16x16x32_bf16 a[80:83], a[204:207], v[184:187], a[80:83]
    ds_read_b64_tr_b16 a[222:223], v12 offset:4096
    v_cvt_pk_bf16_f32 v233, v158, v159
    v_mfma_f32_16x16x32_bf16 a[84:87], a[204:207], v[192:195], a[84:87]
    v_exp_f32 v161, v161
    v_mfma_f32_16x16x32_bf16 a[84:87], a[200:203], v[188:191], a[84:87]
    ds_read_b128 a[188:191], v4 offset:61440
    v_mfma_f32_16x16x32_bf16 a[88:91], a[200:203], v[196:199], a[88:91]
    v_exp_f32 v162, v162
    v_mfma_f32_16x16x32_bf16 a[88:91], a[204:207], v[200:203], a[88:91]
    v_cvt_pk_bf16_f32 v240, v160, v161
    v_mfma_f32_16x16x32_bf16 a[92:95], a[204:207], v[208:211], a[92:95]
    v_exp_f32 v163, v163
    v_mfma_f32_16x16x32_bf16 a[92:95], a[200:203], v[204:207], a[92:95]
    buffer_load_dwordx4 v18, s[12:15], s29 offen offset:3072 lds
    v_smfmac_f32_16x16x64_bf16 a[232:235], v[244:247], v[196:203], v248
    s_waitcnt vmcnt(8) lgkmcnt(6)
    s_barrier
    s_add_u32 s29, s29, 16384
    v_mfma_f32_16x16x32_bf16 v[156:159], a[160:163], v[68:71], v[108:111]
    v_exp_f32 v164, v164
    v_mfma_f32_16x16x32_bf16 v[156:159], a[164:167], v[72:75], v[156:159]
    ds_read_b64_tr_b16 a[192:193], v5 offset:24576
    v_cvt_pk_bf16_f32 v241, v162, v163
    v_mfma_f32_16x16x32_bf16 v[156:159], a[168:171], v[76:79], v[156:159]
    v_exp_f32 v165, v165
    v_mfma_f32_16x16x32_bf16 v[156:159], a[172:175], v[80:83], v[156:159]
    ds_read_b64_tr_b16 a[194:195], v5 offset:28672
    v_mfma_f32_16x16x32_bf16 v[160:163], a[172:175], v[96:99], v[112:115]
    v_exp_f32 v166, v166
    v_mfma_f32_16x16x32_bf16 v[160:163], a[168:171], v[92:95], v[160:163]
    ds_read_b128 a[128:131], v1 offset:16384
    v_cvt_pk_bf16_f32 v218, v164, v165
    v_mfma_f32_16x16x32_bf16 v[160:163], a[164:167], v[88:91], v[160:163]
    v_exp_f32 v167, v167
    v_mfma_f32_16x16x32_bf16 v[160:163], a[160:163], v[84:87], v[160:163]
    ds_read_b64_tr_b16 a[196:197], v5 offset:49152
    v_mfma_f32_16x16x32_bf16 a[96:99], a[208:211], v[180:183], a[96:99]
    v_exp_f32 v168, v168
    v_mfma_f32_16x16x32_bf16 a[96:99], a[212:215], v[184:187], a[96:99]
    ds_read_b64_tr_b16 a[198:199], v5 offset:53248
    v_cvt_pk_bf16_f32 v219, v166, v167
    v_mfma_f32_16x16x32_bf16 a[100:103], a[212:215], v[192:195], a[100:103]
    v_exp_f32 v169, v169
    v_mfma_f32_16x16x32_bf16 a[100:103], a[208:211], v[188:191], a[100:103]
    ds_read_b128 a[132:135], v2 offset:16384
    v_cvt_pk_bf16_f32 v226, v168, v169
    v_mfma_f32_16x16x32_bf16 a[104:107], a[208:211], v[196:199], a[104:107]
    s_add_u32 m0, s34, 0
    v_exp_f32 v170, v170
    v_mfma_f32_16x16x32_bf16 a[104:107], a[212:215], v[200:203], a[104:107]
    buffer_load_dwordx4 v13, s[8:11], s28 offen offset:0 lds
    v_mfma_f32_16x16x32_bf16 a[108:111], a[212:215], v[208:211], a[108:111]
    v_exp_f32 v171, v171
    v_mfma_f32_16x16x32_bf16 a[108:111], a[208:211], v[204:207], a[108:111]
    s_waitcnt lgkmcnt(6)
    v_mfma_f32_16x16x32_bf16 v[164:167], a[176:179], v[36:39], v[100:103]
    s_cmp_eq_u32 s59, s35
    s_cbranch_scc1 L_once_pack
L_once_back_pack:
    v_exp_f32 v172, v172
    v_mfma_f32_16x16x32_bf16 v[164:167], a[180:183], v[40:43], v[164:167]
    ds_read_b64_tr_b16 a[200:201], v6 offset:24576
    v_cvt_pk_bf16_f32 v227, v170, v171
    v_mfma_f32_16x16x32_bf16 v[164:167], a[184:187], v[44:47], v[164:167]
    v_exp_f32 v173, v173
    v_mfma_f32_16x16x32_bf16 v[164:167], a[188:191], v[48:51], v[164:167]
    ds_read_b64_tr_b16 a[202:203], v6 offset:28672
    v_mfma_f32_16x16x32_bf16 v[168:171], a[188:191], v[64:67], v[104:107]
    v_exp_f32 v174, v174
    v_mfma_f32_16x16x32_bf16 v[168:171], a[184:187], v[60:63], v[168:171]
    ds_read_b128 a[136:139], v3 offset:16384
    v_cvt_pk_bf16_f32 v234, v172, v173
    v_mfma_f32_16x16x32_bf16 v[168:171], a[180:183], v[56:59], v[168:171]
    v_exp_f32 v175, v175
    v_mfma_f32_16x16x32_bf16 v[168:171], a[176:179], v[52:55], v[168:171]
    ds_read_b64_tr_b16 a[204:205], v6 offset:49152
    v_mfma_f32_16x16x32_bf16 a[112:115], a[216:219], v[180:183], a[112:115]
    v_exp_f32 v176, v176
    v_mfma_f32_16x16x32_bf16 a[112:115], a[220:223], v[184:187], a[112:115]
    ds_read_b64_tr_b16 a[206:207], v6 offset:53248
    v_cvt_pk_bf16_f32 v235, v174, v175
    v_mfma_f32_16x16x32_bf16 a[116:119], a[220:223], v[192:195], a[116:119]
    v_exp_f32 v177, v177
    v_mfma_f32_16x16x32_bf16 a[116:119], a[216:219], v[188:191], a[116:119]
    ds_read_b128 a[140:143], v4 offset:16384
    v_mfma_f32_16x16x32_bf16 a[120:123], a[216:219], v[196:199], a[120:123]
    v_exp_f32 v178, v178
    v_mfma_f32_16x16x32_bf16 a[120:123], a[220:223], v[200:203], a[120:123]
    v_cvt_pk_bf16_f32 v242, v176, v177
    v_mfma_f32_16x16x32_bf16 a[124:127], a[220:223], v[208:211], a[124:127]
    v_exp_f32 v179, v179
    v_mfma_f32_16x16x32_bf16 a[124:127], a[216:219], v[204:207], a[124:127]
    buffer_load_dwordx4 v14, s[8:11], s28 offen offset:1024 lds
    v_smfmac_f32_16x16x64_bf16 a[236:239], v[244:247], v[204:211], v248
    s_waitcnt lgkmcnt(6)
    v_mfma_f32_16x16x32_bf16 v[172:175], a[176:179], v[68:71], v[108:111]
    v_exp_f32 v116, v116
    v_mfma_f32_16x16x32_bf16 v[172:175], a[180:183], v[72:75], v[172:175]
    ds_read_b64_tr_b16 a[208:209], v7 offset:24576
    v_cvt_pk_bf16_f32 v243, v178, v179
    v_mfma_f32_16x16x32_bf16 v[172:175], a[184:187], v[76:79], v[172:175]
    v_exp_f32 v117, v117
    v_mfma_f32_16x16x32_bf16 v[172:175], a[188:191], v[80:83], v[172:175]
    ds_read_b64_tr_b16 a[210:211], v7 offset:28672
    v_mfma_f32_16x16x32_bf16 v[176:179], a[188:191], v[96:99], v[112:115]
    v_exp_f32 v118, v118
    v_mfma_f32_16x16x32_bf16 v[176:179], a[184:187], v[92:95], v[176:179]
    ds_read_b128 a[144:147], v1 offset:20480
    v_cvt_pk_bf16_f32 v180, v116, v117
    v_mfma_f32_16x16x32_bf16 v[176:179], a[180:183], v[88:91], v[176:179]
    v_exp_f32 v119, v119
    v_mfma_f32_16x16x32_bf16 v[176:179], a[176:179], v[84:87], v[176:179]
    ds_read_b64_tr_b16 a[212:213], v7 offset:49152
    v_mfma_f32_16x16x32_bf16 a[0:3], a[192:195], v[212:215], a[0:3]
    v_exp_f32 v120, v120
    v_mfma_f32_16x16x32_bf16 a[0:3], a[196:199], v[216:219], a[0:3]
    ds_read_b64_tr_b16 a[214:215], v7 offset:53248
    v_cvt_pk_bf16_f32 v181, v118, v119
    v_mfma_f32_16x16x32_bf16 a[4:7], a[196:199], v[224:227], a[4:7]
    v_exp_f32 v121, v121
    v_mfma_f32_16x16x32_bf16 a[4:7], a[192:195], v[220:223], a[4:7]
    ds_read_b128 a[148:151], v2 offset:20480
    v_cvt_pk_bf16_f32 v188, v120, v121
    v_mfma_f32_16x16x32_bf16 a[8:11], a[192:195], v[228:231], a[8:11]
    v_exp_f32 v122, v122
    v_mfma_f32_16x16x32_bf16 a[8:11], a[196:199], v[232:235], a[8:11]
    buffer_load_dwordx4 v15, s[8:11], s28 offen offset:2048 lds
    v_mfma_f32_16x16x32_bf16 a[12:15], a[196:199], v[240:243], a[12:15]
    v_exp_f32 v123, v123
    v_mfma_f32_16x16x32_bf16 a[12:15], a[192:195], v[236:239], a[12:15]
    s_waitcnt lgkmcnt(6)
    v_mfma_f32_16x16x32_bf16 v[116:119], a[128:131], v[36:39], v[100:103]
    v_exp_f32 v124, v124
    v_mfma_f32_16x16x32_bf16 v[116:119], a[132:135], v[40:43], v[116:119]
    ds_read_b64_tr_b16 a[216:217], v8 offset:24576
    v_cvt_pk_bf16_f32 v189, v122, v123
    v_mfma_f32_16x16x32_bf16 v[116:119], a[136:139], v[44:47], v[116:119]
    v_exp_f32 v125, v125
    v_mfma_f32_16x16x32_bf16 v[116:119], a[140:143], v[48:51], v[116:119]
    ds_read_b64_tr_b16 a[218:219], v8 offset:28672
    v_mfma_f32_16x16x32_bf16 v[120:123], a[140:143], v[64:67], v[104:107]
    v_exp_f32 v126, v126
    v_mfma_f32_16x16x32_bf16 v[120:123], a[136:139], v[60:63], v[120:123]
    ds_read_b128 a[152:155], v3 offset:20480
    v_cvt_pk_bf16_f32 v196, v124, v125
    v_mfma_f32_16x16x32_bf16 v[120:123], a[132:135], v[56:59], v[120:123]
    v_exp_f32 v127, v127
    v_mfma_f32_16x16x32_bf16 v[120:123], a[128:131], v[52:55], v[120:123]
    ds_read_b64_tr_b16 a[220:221], v8 offset:49152
    v_mfma_f32_16x16x32_bf16 a[16:19], a[200:203], v[212:215], a[16:19]
    v_exp_f32 v128, v128
    v_mfma_f32_16x16x32_bf16 a[16:19], a[204:207], v[216:219], a[16:19]
    ds_read_b64_tr_b16 a[222:223], v8 offset:53248
    v_cvt_pk_bf16_f32 v197, v126, v127
    v_mfma_f32_16x16x32_bf16 a[20:23], a[204:207], v[224:227], a[20:23]
    v_exp_f32 v129, v129
    v_mfma_f32_16x16x32_bf16 a[20:23], a[200:203], v[220:223], a[20:23]
    ds_read_b128 a[156:159], v4 offset:20480
    v_mfma_f32_16x16x32_bf16 a[24:27], a[200:203], v[228:231], a[24:27]
    v_exp_f32 v130, v130
    v_mfma_f32_16x16x32_bf16 a[24:27], a[204:207], v[232:235], a[24:27]
    v_cvt_pk_bf16_f32 v204, v128, v129
    v_mfma_f32_16x16x32_bf16 a[28:31], a[204:207], v[240:243], a[28:31]
    v_exp_f32 v131, v131
    v_mfma_f32_16x16x32_bf16 a[28:31], a[200:203], v[236:239], a[28:31]
    buffer_load_dwordx4 v16, s[8:11], s28 offen offset:3072 lds
    v_smfmac_f32_16x16x64_bf16 a[224:227], v[244:247], v[212:219], v248
    s_waitcnt lgkmcnt(6)
    v_mfma_f32_16x16x32_bf16 v[124:127], a[128:131], v[68:71], v[108:111]
    s_cmp_eq_u32 s36, 2
    s_cbranch_scc1 L_site2
L_site_back2:
    v_exp_f32 v132, v132
    v_mfma_f32_16x16x32_bf16 v[124:127], a[132:135], v[72:75], v[124:127]
    ds_read_b64_tr_b16 a[192:193], v9 offset:24576
    v_cvt_pk_bf16_f32 v205, v130, v131
    v_mfma_f32_16x16x32_bf16 v[124:127], a[136:139], v[76:79], v[124:127]
    v_exp_f32 v133, v133
    v_mfma_f32_16x16x32_bf16 v[124:127], a[140:143], v[80:83], v[124:127]
    ds_read_b64_tr_b16 a[194:195], v9 offset:28672
    v_mfma_f32_16x16x32_bf16 v[128:131], a[140:143], v[96:99], v[112:115]
    v_exp_f32 v134, v134
    v_mfma_f32_16x16x32_bf16 v[128:131], a[136:139], v[92:95], v[128:131]
    ds_read_b128 a[160:163], v1 offset:24576
    v_cvt_pk_bf16_f32 v182, v132, v133
    v_mfma_f32_16x16x32_bf16 v[128:131], a[132:135], v[88:91], v[128:131]
    v_exp_f32 v135, v135
    v_mfma_f32_16x16x32_bf16 v[128:131], a[128:131], v[84:87], v[128:131]
    ds_read_b64_tr_b16 a[196:197], v9 offset:49152
    v_mfma_f32_16x16x32_bf16 a[32:35], a[208:211], v[212:215], a[32:35]
    v_exp_f32 v136, v136
    v_mfma_f32_16x16x32_bf16 a[32:35], a[212:215], v[216:219], a[32:35]
    ds_read_b64_tr_b16 a[198:199], v9 offset:53248
    v_cvt_pk_bf16_f32 v183, v134, v135
    v_mfma_f32_16x16x32_bf16 a[36:39], a[212:215], v[224:227], a[36:39]
    v_exp_f32 v137, v137
    v_mfma_f32_16x16x32_bf16 a[36:39], a[208:211], v[220:223], a[36:39]
    ds_read_b128 a[164:167], v2 offset:24576
    v_cvt_pk_bf16_f32 v190, v136, v137
    v_mfma_f32_16x16x32_bf16 a[40:43], a[208:211], v[228:231], a[40:43]
    s_add_u32 s28, s28, 16384
    s_mov_b32 m0, s31
    v_exp_f32 v138, v138
    v_mfma_f32_16x16x32_bf16 a[40:43], a[212:215], v[232:235], a[40:43]
    buffer_load_dwordx4 v17, s[12:15], s29 offen offset:0 lds
    v_mfma_f32_16x16x32_bf16 a[44:47], a[212:215], v[240:243], a[44:47]
    v_exp_f32 v139, v139
    v_mfma_f32_16x16x32_bf16 a[44:47], a[208:211], v[236:239], a[44:47]
    s_waitcnt lgkmcnt(6)
    v_mfma_f32_16x16x32_bf16 v[132:135], a[144:147], v[36:39], v[100:103]
    v_exp_f32 v140, v140
    v_mfma_f32_16x16x32_bf16 v[132:135], a[148:151], v[40:43], v[132:135]
    ds_read_b64_tr_b16 a[200:201], v10 offset:24576
    v_cvt_pk_bf16_f32 v191, v138, v139
    v_mfma_f32_16x16x32_bf16 v[132:135], a[152:155], v[44:47], v[132:135]
    v_exp_f32 v141, v141
    v_mfma_f32_16x16x32_bf16 v[132:135], a[156:159], v[48:51], v[132:135]
    ds_read_b64_tr_b16 a[202:203], v10 offset:28672
    v_mfma_f32_16x16x32_bf16 v[136:139], a[156:159], v[64:67], v[104:107]
    v_exp_f32 v142, v142
    v_mfma_f32_16x16x32_bf16 v[136:139], a[152:155], v[60:63], v[136:139]
    ds_read_b128 a[168:171], v3 offset:24576
    v_cvt_pk_bf16_f32 v198, v140, v141
    v_mfma_f32_16x16x32_bf16 v[136:139], a[148:151], v[56:59], v[136:139]
    v_exp_f32 v143, v143
    v_mfma_f32_16x16x32_bf16 v[136:139], a[144:147], v[52:55], v[136:139]
    ds_read_b64_tr_b16 a[204:205], v10 offset:49152
    v_mfma_f32_16x16x32_bf16 a[48:51], a[216:219], v[212:215], a[48:51]
    v_exp_f32 v144, v144
    v_mfma_f32_16x16x32_bf16 a[48:51], a[220:223], v[216:219], a[48:51]
    ds_read_b64_tr_b16 a[206:207], v10 offset:53248
    v_cvt_pk_bf16_f32 v199, v142, v143
    v_mfma_f32_16x16x32_bf16 a[52:55], a[220:223], v[224:227], a[52:55]
    v_exp_f32 v145, v145
    v_mfma_f32_16x16x32_bf16 a[52:55], a[216:219], v[220:223], a[52:55]
    ds_read_b128 a[172:175], v4 offset:24576
    v_mfma_f32_16x16x32_bf16 a[56:59], a[216:219], v[228:231], a[56:59]
    v_exp_f32 v146, v146
    v_mfma_f32_16x16x32_bf16 a[56:59], a[220:223], v[232:235], a[56:59]
    v_cvt_pk_bf16_f32 v206, v144, v145
    v_mfma_f32_16x16x32_bf16 a[60:63], a[220:223], v[240:243], a[60:63]
    v_exp_f32 v147, v147
    v_mfma_f32_16x16x32_bf16 a[60:63], a[216:219], v[236:239], a[60:63]
    buffer_load_dwordx4 v18, s[12:15], s29 offen offset:1024 lds
    v_smfmac_f32_16x16x64_bf16 a[228:231], v[244:247], v[220:227], v248
    s_waitcnt lgkmcnt(6)
    v_mfma_f32_16x16x32_bf16 v[140:143], a[144:147], v[68:71], v[108:111]
    v_exp_f32 v148, v148
    v_mfma_f32_16x16x32_bf16 v[140:143], a[148:151], v[72:75], v[140:143]
    ds_read_b64_tr_b16 a[208:209], v11 offset:24576
    v_cvt_pk_bf16_f32 v207, v146, v147
    v_mfma_f32_16x16x32_bf16 v[140:143], a[152:155], v[76:79], v[140:143]
    v_exp_f32 v149, v149
    v_mfma_f32_16x16x32_bf16 v[140:143], a[156:159], v[80:83], v[140:143]
    ds_read_b64_tr_b16 a[210:211], v11 offset:28672
    v_mfma_f32_16x16x32_bf16 v[144:147], a[156:159], v[96:99], v[112:115]
    v_exp_f32 v150, v150
    v_mfma_f32_16x16x32_bf16 v[144:147], a[152:155], v[92:95], v[144:147]
    ds_read_b128 a[176:179], v1 offset:28672
    v_cvt_pk_bf16_f32 v184, v148, v149
    v_mfma_f32_16x16x32_bf16 v[144:147], a[148:151], v[88:91], v[144:147]
    v_exp_f32 v151, v151
    v_mfma_f32_16x16x32_bf16 v[144:147], a[144:147], v[84:87], v[144:147]
    ds_read_b64_tr_b16 a[212:213], v11 offset:49152
    v_mfma_f32_16x16x32_bf16 a[64:67], a[192:195], v[212:215], a[64:67]
    v_exp_f32 v152, v152
    v_mfma_f32_16x16x32_bf16 a[64:67], a[196:199], v[216:219], a[64:67]
    ds_read_b64_tr_b16 a[214:215], v11 offset:53248
    v_cvt_pk_bf16_f32 v185, v150, v151
    v_mfma_f32_16x16x32_bf16 a[68:71], a[196:199], v[224:227], a[68:71]
    v_exp_f32 v153, v153
    v_mfma_f32_16x16x32_bf16 a[68:71], a[192:195], v[220:223], a[68:71]
    ds_read_b128 a[180:183], v2 offset:28672
    v_cvt_pk_bf16_f32 v192, v152, v153
    v_mfma_f32_16x16x32_bf16 a[72:75], a[192:195], v[228:231], a[72:75]
    v_exp_f32 v154, v154
    v_mfma_f32_16x16x32_bf16 a[72:75], a[196:199], v[232:235], a[72:75]
    buffer_load_dwordx4 v17, s[12:15], s29 offen offset:2048 lds
    v_mfma_f32_16x16x32_bf16 a[76:79], a[196:199], v[240:243], a[76:79]
    v_exp_f32 v155, v155
    v_mfma_f32_16x16x32_bf16 a[76:79], a[192:195], v[236:239], a[76:79]
    s_waitcnt lgkmcnt(6)
    v_mfma_f32_16x16x32_bf16 v[148:151], a[160:163], v[36:39], v[100:103]
    v_exp_f32 v156, v156
    v_mfma_f32_16x16x32_bf16 v[148:151], a[164:167], v[40:43], v[148:151]
    ds_read_b64_tr_b16 a[216:217], v12 offset:24576
    v_cvt_pk_bf16_f32 v193, v154, v155
    v_mfma_f32_16x16x32_bf16 v[148:151], a[168:171], v[44:47], v[148:151]
    v_exp_f32 v157, v157
    v_mfma_f32_16x16x32_bf16 v[148:151], a[172:175], v[48:51], v[148:151]
    ds_read_b64_tr_b16 a[218:219], v12 offset:28672
    v_mfma_f32_16x16x32_bf16 v[152:155], a[172:175], v[64:67], v[104:107]
    v_exp_f32 v158, v158
    v_mfma_f32_16x16x32_bf16 v[152:155], a[168:171], v[60:63], v[152:155]
    ds_read_b128 a[184:187], v3 offset:28672
    v_cvt_pk_bf16_f32 v200, v156, v157
    v_mfma_f32_16x16x32_bf16 v[152:155], a[164:167], v[56:59], v[152:155]
    v_exp_f32 v159, v159
    v_mfma_f32_16x16x32_bf16 v[152:155], a[160:163], v[52:55], v[152:155]
    ds_read_b64_tr_b16 a[220:221], v12 offset:49152
    v_mfma_f32_16x16x32_bf16 a[80:83], a[200:203], v[212:215], a[80:83]
    v_exp_f32 v160, v160
    v_mfma_f32_16x16x32_bf16 a[80:83], a[204:207], v[216:219], a[80:83]
    ds_read_b64_tr_b16 a[222:223], v12 offset:53248
    v_cvt_pk_bf16_f32 v201, v158, v159
    v_mfma_f32_16x16x32_bf16 a[84:87], a[204:207], v[224:227], a[84:87]
    v_exp_f32 v161, v161
    v_mfma_f32_16x16x32_bf16 a[84:87], a[200:203], v[220:223], a[84:87]
    ds_read_b128 a[188:191], v4 offset:28672
    v_mfma_f32_16x16x32_bf16 a[88:91], a[200:203], v[228:231], a[88:91]
    v_exp_f32 v162, v162
    v_mfma_f32_16x16x32_bf16 a[88:91], a[204:207], v[232:235], a[88:91]
    v_cvt_pk_bf16_f32 v208, v160, v161
    v_mfma_f32_16x16x32_bf16 a[92:95], a[204:207], v[240:243], a[92:95]
    v_exp_f32 v163, v163
    v_mfma_f32_16x16x32_bf16 a[92:95], a[200:203], v[236:239], a[92:95]
    buffer_load_dwordx4 v18, s[12:15], s29 offen offset:3072 lds
    v_smfmac_f32_16x16x64_bf16 a[232:235], v[244:247], v[228:235], v248
    s_waitcnt vmcnt(8) lgkmcnt(6)
    s_barrier
    s_add_u32 s29, s29, 16384
    v_mfma_f32_16x16x32_bf16 v[156:159], a[160:163], v[68:71], v[108:111]
    v_exp_f32 v164, v164
    v_mfma_f32_16x16x32_bf16 v[156:159], a[164:167], v[72:75], v[156:159]
    ds_read_b64_tr_b16 a[192:193], v5 offset:8192
    v_cvt_pk_bf16_f32 v209, v162, v163
    v_mfma_f32_16x16x32_bf16 v[156:159], a[168:171], v[76:79], v[156:159]
    v_exp_f32 v165, v165
    v_mfma_f32_16x16x32_bf16 v[156:159], a[172:175], v[80:83], v[156:159]
    ds_read_b64_tr_b16 a[194:195], v5 offset:12288
    v_mfma_f32_16x16x32_bf16 v[160:163], a[172:175], v[96:99], v[112:115]
    v_exp_f32 v166, v166
    v_mfma_f32_16x16x32_bf16 v[160:163], a[168:171], v[92:95], v[160:163]
    ds_read_b128 a[128:131], v1 offset:32768
    v_cvt_pk_bf16_f32 v186, v164, v165
    v_mfma_f32_16x16x32_bf16 v[160:163], a[164:167], v[88:91], v[160:163]
    v_exp_f32 v167, v167
    v_mfma_f32_16x16x32_bf16 v[160:163], a[160:163], v[84:87], v[160:163]
    ds_read_b64_tr_b16 a[196:197], v5 offset:32768
    v_mfma_f32_16x16x32_bf16 a[96:99], a[208:211], v[212:215], a[96:99]
    v_exp_f32 v168, v168
    v_mfma_f32_16x16x32_bf16 a[96:99], a[212:215], v[216:219], a[96:99]
    ds_read_b64_tr_b16 a[198:199], v5 offset:36864
    v_cvt_pk_bf16_f32 v187, v166, v167
    v_mfma_f32_16x16x32_bf16 a[100:103], a[212:215], v[224:227], a[100:103]
    v_exp_f32 v169, v169
    v_mfma_f32_16x16x32_bf16 a[100:103], a[208:211], v[220:223], a[100:103]
    ds_read_b128 a[132:135], v2 offset:32768
    v_cvt_pk_bf16_f32 v194, v168, v169
    v_mfma_f32_16x16x32_bf16 a[104:107], a[208:211], v[228:231], a[104:107]
    s_add_u32 m0, s34, 49152
    v_exp_f32 v170, v170
    v_mfma_f32_16x16x32_bf16 a[104:107], a[212:215], v[232:235], a[104:107]
    buffer_load_dwordx4 v13, s[8:11], s28 offen offset:0 lds
    v_mfma_f32_16x16x32_bf16 a[108:111], a[212:215], v[240:243], a[108:111]
    v_exp_f32 v171, v171
    v_mfma_f32_16x16x32_bf16 a[108:111], a[208:211], v[236:239], a[108:111]
    s_waitcnt lgkmcnt(6)
    v_mfma_f32_16x16x32_bf16 v[164:167], a[176:179], v[36:39], v[100:103]
    v_exp_f32 v172, v172
    v_mfma_f32_16x16x32_bf16 v[164:167], a[180:183], v[40:43], v[164:167]
    ds_read_b64_tr_b16 a[200:201], v6 offset:8192
    v_cvt_pk_bf16_f32 v195, v170, v171
    v_mfma_f32_16x16x32_bf16 v[164:167], a[184:187], v[44:47], v[164:167]
    v_exp_f32 v173, v173
    v_mfma_f32_16x16x32_bf16 v[164:167], a[188:191], v[48:51], v[164:167]
    ds_read_b64_tr_b16 a[202:203], v6 offset:12288
    v_mfma_f32_16x16x32_bf16 v[168:171], a[188:191], v[64:67], v[104:107]
    v_exp_f32 v174, v174
    v_mfma_f32_16x16x32_bf16 v[168:171], a[184:187], v[60:63], v[168:171]
    ds_read_b128 a[136:139], v3 offset:32768
    v_cvt_pk_bf16_f32 v202, v172, v173
    v_mfma_f32_16x16x32_bf16 v[168:171], a[180:183], v[56:59], v[168:171]
    v_exp_f32 v175, v175
    v_mfma_f32_16x16x32_bf16 v[168:171], a[176:179], v[52:55], v[168:171]
    ds_read_b64_tr_b16 a[204:205], v6 offset:32768
    v_mfma_f32_16x16x32_bf16 a[112:115], a[216:219], v[212:215], a[112:115]
    v_exp_f32 v176, v176
    v_mfma_f32_16x16x32_bf16 a[112:115], a[220:223], v[216:219], a[112:115]
    ds_read_b64_tr_b16 a[206:207], v6 offset:36864
    v_cvt_pk_bf16_f32 v203, v174, v175
    v_mfma_f32_16x16x32_bf16 a[116:119], a[220:223], v[224:227], a[116:119]
    v_exp_f32 v177, v177
    v_mfma_f32_16x16x32_bf16 a[116:119], a[216:219], v[220:223], a[116:119]
    ds_read_b128 a[140:143], v4 offset:32768
    v_mfma_f32_16x16x32_bf16 a[120:123], a[216:219], v[228:231], a[120:123]
    v_exp_f32 v178, v178
    v_mfma_f32_16x16x32_bf16 a[120:123], a[220:223], v[232:235], a[120:123]
    v_cvt_pk_bf16_f32 v210, v176, v177
    v_mfma_f32_16x16x32_bf16 a[124:127], a[220:223], v[240:243], a[124:127]
    v_exp_f32 v179, v179
    v_mfma_f32_16x16x32_bf16 a[124:127], a[216:219], v[236:239], a[124:127]
    buffer_load_dwordx4 v14, s[8:11], s28 offen offset:1024 lds
    v_smfmac_f32_16x16x64_bf16 a[236:239], v[244:247], v[236:243], v248
    s_waitcnt lgkmcnt(6)
    v_mfma_f32_16x16x32_bf16 v[172:175], a[176:179], v[68:71], v[108:111]
    v_exp_f32 v116, v116
    v_mfma_f32_16x16x32_bf16 v[172:175], a[180:183], v[72:75], v[172:175]
    ds_read_b64_tr_b16 a[208:209], v7 offset:8192
    v_cvt_pk_bf16_f32 v211, v178, v179
    v_mfma_f32_16x16x32_bf16 v[172:175], a[184:187], v[76:79], v[172:175]
    v_exp_f32 v117, v117
    v_mfma_f32_16x16x32_bf16 v[172:175], a[188:191], v[80:83], v[172:175]
    ds_read_b64_tr_b16 a[210:211], v7 offset:12288
    v_mfma_f32_16x16x32_bf16 v[176:179], a[188:191], v[96:99], v[112:115]
    v_exp_f32 v118, v118
    v_mfma_f32_16x16x32_bf16 v[176:179], a[184:187], v[92:95], v[176:179]
    ds_read_b128 a[144:147], v1 offset:36864
    v_cvt_pk_bf16_f32 v212, v116, v117
    v_mfma_f32_16x16x32_bf16 v[176:179], a[180:183], v[88:91], v[176:179]
    v_exp_f32 v119, v119
    v_mfma_f32_16x16x32_bf16 v[176:179], a[176:179], v[84:87], v[176:179]
    ds_read_b64_tr_b16 a[212:213], v7 offset:32768
    v_mfma_f32_16x16x32_bf16 a[0:3], a[192:195], v[180:183], a[0:3]
    v_exp_f32 v120, v120
    v_mfma_f32_16x16x32_bf16 a[0:3], a[196:199], v[184:187], a[0:3]
    ds_read_b64_tr_b16 a[214:215], v7 offset:36864
    v_cvt_pk_bf16_f32 v213, v118, v119
    v_mfma_f32_16x16x32_bf16 a[4:7], a[196:199], v[192:195], a[4:7]
    v_exp_f32 v121, v121
    v_mfma_f32_16x16x32_bf16 a[4:7], a[192:195], v[188:191], a[4:7]
    ds_read_b128 a[148:151], v2 offset:36864
    v_cvt_pk_bf16_f32 v220, v120, v121
    v_mfma_f32_16x16x32_bf16 a[8:11], a[192:195], v[196:199], a[8:11]
    v_exp_f32 v122, v122
    v_mfma_f32_16x16x32_bf16 a[8:11], a[196:199], v[200:203], a[8:11]
    buffer_load_dwordx4 v15, s[8:11], s28 offen offset:2048 lds
    v_mfma_f32_16x16x32_bf16 a[12:15], a[196:199], v[208:211], a[12:15]
    v_exp_f32 v123, v123
    v_mfma_f32_16x16x32_bf16 a[12:15], a[192:195], v[204:207], a[12:15]
    s_waitcnt lgkmcnt(6)
    v_mfma_f32_16x16x32_bf16 v[116:119], a[128:131], v[36:39], v[100:103]
    v_exp_f32 v124, v124
    v_mfma_f32_16x16x32_bf16 v[116:119], a[132:135], v[40:43], v[116:119]
    ds_read_b64_tr_b16 a[216:217], v8 offset:8192
    v_cvt_pk_bf16_f32 v221, v122, v123
    v_mfma_f32_16x16x32_bf16 v[116:119], a[136:139], v[44:47], v[116:119]
    v_exp_f32 v125, v125
    v_mfma_f32_16x16x32_bf16 v[116:119], a[140:143], v[48:51], v[116:119]
    ds_read_b64_tr_b16 a[218:219], v8 offset:12288
    v_mfma_f32_16x16x32_bf16 v[120:123], a[140:143], v[64:67], v[104:107]
    v_exp_f32 v126, v126
    v_mfma_f32_16x16x32_bf16 v[120:123], a[136:139], v[60:63], v[120:123]
    ds_read_b128 a[152:155], v3 offset:36864
    v_cvt_pk_bf16_f32 v228, v124, v125
    v_mfma_f32_16x16x32_bf16 v[120:123], a[132:135], v[56:59], v[120:123]
    v_exp_f32 v127, v127
    v_mfma_f32_16x16x32_bf16 v[120:123], a[128:131], v[52:55], v[120:123]
    ds_read_b64_tr_b16 a[220:221], v8 offset:32768
    v_mfma_f32_16x16x32_bf16 a[16:19], a[200:203], v[180:183], a[16:19]
    v_exp_f32 v128, v128
    v_mfma_f32_16x16x32_bf16 a[16:19], a[204:207], v[184:187], a[16:19]
    ds_read_b64_tr_b16 a[222:223], v8 offset:36864
    v_cvt_pk_bf16_f32 v229, v126, v127
    v_mfma_f32_16x16x32_bf16 a[20:23], a[204:207], v[192:195], a[20:23]
    v_exp_f32 v129, v129
    v_mfma_f32_16x16x32_bf16 a[20:23], a[200:203], v[188:191], a[20:23]
    ds_read_b128 a[156:159], v4 offset:36864
    v_mfma_f32_16x16x32_bf16 a[24:27], a[200:203], v[196:199], a[24:27]
    v_exp_f32 v130, v130
    v_mfma_f32_16x16x32_bf16 a[24:27], a[204:207], v[200:203], a[24:27]
    v_cvt_pk_bf16_f32 v236, v128, v129
    v_mfma_f32_16x16x32_bf16 a[28:31], a[204:207], v[208:211], a[28:31]
    v_exp_f32 v131, v131
    v_mfma_f32_16x16x32_bf16 a[28:31], a[200:203], v[204:207], a[28:31]
    buffer_load_dwordx4 v16, s[8:11], s28 offen offset:3072 lds
    v_smfmac_f32_16x16x64_bf16 a[224:227], v[244:247], v[180:187], v248
    s_waitcnt lgkmcnt(6)
    v_mfma_f32_16x16x32_bf16 v[124:127], a[128:131], v[68:71], v[108:111]
    s_cmp_eq_u32 s36, 3
    s_cbranch_scc1 L_site3
L_site_back3:
    v_exp_f32 v132, v132
    v_mfma_f32_16x16x32_bf16 v[124:127], a[132:135], v[72:75], v[124:127]
    ds_read_b64_tr_b16 a[192:193], v9 offset:8192
    v_cvt_pk_bf16_f32 v237, v130, v131
    v_mfma_f32_16x16x32_bf16 v[124:127], a[136:139], v[76:79], v[124:127]
    v_exp_f32 v133, v133
    v_mfma_f32_16x16x32_bf16 v[124:127], a[140:143], v[80:83], v[124:127]
    ds_read_b64_tr_b16 a[194:195], v9 offset:12288
    v_mfma_f32_16x16x32_bf16 v[128:131], a[140:143], v[96:99], v[112:115]
    v_exp_f32 v134, v134
    v_mfma_f32_16x16x32_bf16 v[128:131], a[136:139], v[92:95], v[128:131]
    ds_read_b128 a[160:163], v1 offset:40960
    v_cvt_pk_bf16_f32 v214, v132, v133
    v_mfma_f32_16x16x32_bf16 v[128:131], a[132:135], v[88:91], v[128:131]
    v_exp_f32 v135, v135
    v_mfma_f32_16x16x32_bf16 v[128:131], a[128:131], v[84:87], v[128:131]
    ds_read_b64_tr_b16 a[196:197], v9 offset:32768
    v_mfma_f32_16x16x32_bf16 a[32:35], a[208:211], v[180:183], a[32:35]
    v_exp_f32 v136, v136
    v_mfma_f32_16x16x32_bf16 a[32:35], a[212:215], v[184:187], a[32:35]
    ds_read_b64_tr_b16 a[198:199], v9 offset:36864
    v_cvt_pk_bf16_f32 v215, v134, v135
    v_mfma_f32_16x16x32_bf16 a[36:39], a[212:215], v[192:195], a[36:39]
    v_exp_f32 v137, v137
    v_mfma_f32_16x16x32_bf16 a[36:39], a[208:211], v[188:191], a[36:39]
    ds_read_b128 a[164:167], v2 offset:40960
    v_cvt_pk_bf16_f32 v222, v136, v137
    v_mfma_f32_16x16x32_bf16 a[40:43], a[208:211], v[196:199], a[40:43]
    s_add_u32 s28, s28, 16384
    s_mov_b32 m0, s32
    v_exp_f32 v138, v138
    v_mfma_f32_16x16x32_bf16 a[40:43], a[212:215], v[200:203], a[40:43]
    buffer_load_dwordx4 v17, s[12:15], s29 offen offset:0 lds
    v_mfma_f32_16x16x32_bf16 a[44:47], a[212:215], v[208:211], a[44:47]
    v_exp_f32 v139, v139
    v_mfma_f32_16x16x32_bf16 a[44:47], a[208:211], v[204:207], a[44:47]
    s_waitcnt lgkmcnt(6)
    v_mfma_f32_16x16x32_bf16 v[132:135], a[144:147], v[36:39], v[100:103]
    v_exp_f32 v140, v140
    v_mfma_f32_16x16x32_bf16 v[132:135], a[148:151], v[40:43], v[132:135]
    ds_read_b64_tr_b16 a[200:201], v10 offset:8192
    v_cvt_pk_bf16_f32 v223, v138, v139
    v_mfma_f32_16x16x32_bf16 v[132:135], a[152:155], v[44:47], v[132:135]
    v_exp_f32 v141, v141
    v_mfma_f32_16x16x32_bf16 v[132:135], a[156:159], v[48:51], v[132:135]
    ds_read_b64_tr_b16 a[202:203], v10 offset:12288
    v_mfma_f32_16x16x32_bf16 v[136:139], a[156:159], v[64:67], v[104:107]
    v_exp_f32 v142, v142
    v_mfma_f32_16x16x32_bf16 v[136:139], a[152:155], v[60:63], v[136:139]
    ds_read_b128 a[168:171], v3 offset:40960
    v_cvt_pk_bf16_f32 v230, v140, v141
    v_mfma_f32_16x16x32_bf16 v[136:139], a[148:151], v[56:59], v[136:139]
    v_exp_f32 v143, v143
    v_mfma_f32_16x16x32_bf16 v[136:139], a[144:147], v[52:55], v[136:139]
    ds_read_b64_tr_b16 a[204:205], v10 offset:32768
    v_mfma_f32_16x16x32_bf16 a[48:51], a[216:219], v[180:183], a[48:51]
    v_exp_f32 v144, v144
    v_mfma_f32_16x16x32_bf16 a[48:51], a[220:223], v[184:187], a[48:51]
    ds_read_b64_tr_b16 a[206:207], v10 offset:36864
    v_cvt_pk_bf16_f32 v231, v142, v143
    v_mfma_f32_16x16x32_bf16 a[52:55], a[220:223], v[192:195], a[52:55]
    v_exp_f32 v145, v145
    v_mfma_f32_16x16x32_bf16 a[52:55], a[216:219], v[188:191], a[52:55]
    ds_read_b128 a[172:175], v4 offset:40960
    v_mfma_f32_16x16x32_bf16 a[56:59], a[216:219], v[196:199], a[56:59]
    v_exp_f32 v146, v146
    v_mfma_f32_16x16x32_bf16 a[56:59], a[220:223], v[200:203], a[56:59]
    v_cvt_pk_bf16_f32 v238, v144, v145
    v_mfma_f32_16x16x32_bf16 a[60:63], a[220:223], v[208:211], a[60:63]
    v_exp_f32 v147, v147
    v_mfma_f32_16x16x32_bf16 a[60:63], a[216:219], v[204:207], a[60:63]
    buffer_load_dwordx4 v18, s[12:15], s29 offen offset:1024 lds
    v_smfmac_f32_16x16x64_bf16 a[228:231], v[244:247], v[188:195], v248
    s_waitcnt lgkmcnt(6)
    v_mfma_f32_16x16x32_bf16 v[140:143], a[144:147], v[68:71], v[108:111]
    v_exp_f32 v148, v148
    v_mfma_f32_16x16x32_bf16 v[140:143], a[148:151], v[72:75], v[140:143]
    ds_read_b64_tr_b16 a[208:209], v11 offset:8192
    v_cvt_pk_bf16_f32 v239, v146, v147
    v_mfma_f32_16x16x32_bf16 v[140:143], a[152:155], v[76:79], v[140:143]
    v_exp_f32 v149, v149
    v_mfma_f32_16x16x32_bf16 v[140:143], a[156:159], v[80:83], v[140:143]
    ds_read_b64_tr_b16 a[210:211], v11 offset:12288
    v_mfma_f32_16x16x32_bf16 v[144:147], a[156:159], v[96:99], v[112:115]
    v_exp_f32 v150, v150
    v_mfma_f32_16x16x32_bf16 v[144:147], a[152:155], v[92:95], v[144:147]
    ds_read_b128 a[176:179], v1 offset:45056
    v_cvt_pk_bf16_f32 v216, v148, v149
    v_mfma_f32_16x16x32_bf16 v[144:147], a[148:151], v[88:91], v[144:147]
    v_exp_f32 v151, v151
    v_mfma_f32_16x16x32_bf16 v[144:147], a[144:147], v[84:87], v[144:147]
    ds_read_b64_tr_b16 a[212:213], v11 offset:32768
    v_mfma_f32_16x16x32_bf16 a[64:67], a[192:195], v[180:183], a[64:67]
    v_exp_f32 v152, v152
    v_mfma_f32_16x16x32_bf16 a[64:67], a[196:199], v[184:187], a[64:67]
    ds_read_b64_tr_b16 a[214:215], v11 offset:36864
    v_cvt_pk_bf16_f32 v217, v150, v151
    v_mfma_f32_16x16x32_bf16 a[68:71], a[196:199], v[192:195], a[68:71]
    v_exp_f32 v153, v153
    v_mfma_f32_16x16x32_bf16 a[68:71], a[192:195], v[188:191], a[68:71]
    ds_read_b128 a[180:183], v2 offset:45056
    v_cvt_pk_bf16_f32 v224, v152, v153
    v_mfma_f32_16x16x32_bf16 a[72:75], a[192:195], v[196:199], a[72:75]
    v_exp_f32 v154, v154
    v_mfma_f32_16x16x32_bf16 a[72:75], a[196:199], v[200:203], a[72:75]
    buffer_load_dwordx4 v17, s[12:15], s29 offen offset:2048 lds
    v_mfma_f32_16x16x32_bf16 a[76:79], a[196:199], v[208:211], a[76:79]
    v_exp_f32 v155, v155
    v_mfma_f32_16x16x32_bf16 a[76:79], a[192:195], v[204:207], a[76:79]
    s_waitcnt lgkmcnt(6)
    v_mfma_f32_16x16x32_bf16 v[148:151], a[160:163], v[36:39], v[100:103]
    v_exp_f32 v156, v156
    v_mfma_f32_16x16x32_bf16 v[148:151], a[164:167], v[40:43], v[148:151]
    ds_read_b64_tr_b16 a[216:217], v12 offset:8192
    v_cvt_pk_bf16_f32 v225, v154, v155
    v_mfma_f32_16x16x32_bf16 v[148:151], a[168:171], v[44:47], v[148:151]
    v_exp_f32 v157, v157
    v_mfma_f32_16x16x32_bf16 v[148:151], a[172:175], v[48:51], v[148:151]
    ds_read_b64_tr_b16 a[218:219], v12 offset:12288
    v_mfma_f32_16x16x32_bf16 v[152:155], a[172:175], v[64:67], v[104:107]
    v_exp_f32 v158, v158
    v_mfma_f32_16x16x32_bf16 v[152:155], a[168:171], v[60:63], v[152:155]
    ds_read_b128 a[184:187], v3 offset:45056
    v_cvt_pk_bf16_f32 v232, v156, v157
    v_mfma_f32_16x16x32_bf16 v[152:155], a[164:167], v[56:59], v[152:155]
    v_exp_f32 v159, v159
    v_mfma_f32_16x16x32_bf16 v[152:155], a[160:163], v[52:55], v[152:155]
    ds_read_b64_tr_b16 a[220:221], v12 offset:32768
    v_mfma_f32_16x16x32_bf16 a[80:83], a[200:203], v[180:183], a[80:83]
    v_exp_f32 v160, v160
    v_mfma_f32_16x16x32_bf16 a[80:83], a[204:207], v[184:187], a[80:83]
    ds_read_b64_tr_b16 a[222:223], v12 offset:36864
    v_cvt_pk_bf16_f32 v233, v158, v159
    v_mfma_f32_16x16x32_bf16 a[84:87], a[204:207], v[192:195], a[84:87]
    v_exp_f32 v161, v161
    v_mfma_f32_16x16x32_bf16 a[84:87], a[200:203], v[188:191], a[84:87]
    ds_read_b128 a[188:191], v4 offset:45056
    v_mfma_f32_16x16x32_bf16 a[88:91], a[200:203], v[196:199], a[88:91]
    v_exp_f32 v162, v162
    v_mfma_f32_16x16x32_bf16 a[88:91], a[204:207], v[200:203], a[88:91]
    v_cvt_pk_bf16_f32 v240, v160, v161
    v_mfma_f32_16x16x32_bf16 a[92:95], a[204:207], v[208:211], a[92:95]
    v_exp_f32 v163, v163
    v_mfma_f32_16x16x32_bf16 a[92:95], a[200:203], v[204:207], a[92:95]
    buffer_load_dwordx4 v18, s[12:15], s29 offen offset:3072 lds
    v_smfmac_f32_16x16x64_bf16 a[232:235], v[244:247], v[196:203], v248
    s_waitcnt vmcnt(8) lgkmcnt(6)
    s_barrier
    s_add_u32 s29, s29, 16384
    v_mfma_f32_16x16x32_bf16 v[156:159], a[160:163], v[68:71], v[108:111]
    v_exp_f32 v164, v164
    v_mfma_f32_16x16x32_bf16 v[156:159], a[164:167], v[72:75], v[156:159]
    ds_read_b64_tr_b16 a[192:193], v5 offset:16384
    v_cvt_pk_bf16_f32 v241, v162, v163
    v_mfma_f32_16x16x32_bf16 v[156:159], a[168:171], v[76:79], v[156:159]
    v_exp_f32 v165, v165
    v_mfma_f32_16x16x32_bf16 v[156:159], a[172:175], v[80:83], v[156:159]
    ds_read_b64_tr_b16 a[194:195], v5 offset:20480
    v_mfma_f32_16x16x32_bf16 v[160:163], a[172:175], v[96:99], v[112:115]
    v_exp_f32 v166, v166
    v_mfma_f32_16x16x32_bf16 v[160:163], a[168:171], v[92:95], v[160:163]
    ds_read_b128 a[128:131], v1 offset:0
    v_cvt_pk_bf16_f32 v218, v164, v165
    v_mfma_f32_16x16x32_bf16 v[160:163], a[164:167], v[88:91], v[160:163]
    v_exp_f32 v167, v167
    v_mfma_f32_16x16x32_bf16 v[160:163], a[160:163], v[84:87], v[160:163]
    ds_read_b64_tr_b16 a[196:197], v5 offset:40960
    v_mfma_f32_16x16x32_bf16 a[96:99], a[208:211], v[180:183], a[96:99]
    v_exp_f32 v168, v168
    v_mfma_f32_16x16x32_bf16 a[96:99], a[212:215], v[184:187], a[96:99]
    ds_read_b64_tr_b16 a[198:199], v5 offset:45056
    v_cvt_pk_bf16_f32 v219, v166, v167
    v_mfma_f32_16x16x32_bf16 a[100:103], a[212:215], v[192:195], a[100:103]
    v_exp_f32 v169, v169
    v_mfma_f32_16x16x32_bf16 a[100:103], a[208:211], v[188:191], a[100:103]
    ds_read_b128 a[132:135], v2 offset:0
    v_cvt_pk_bf16_f32 v226, v168, v169
    v_mfma_f32_16x16x32_bf16 a[104:107], a[208:211], v[196:199], a[104:107]
    s_add_u32 m0, s34, 16384
    v_exp_f32 v170, v170
    v_mfma_f32_16x16x32_bf16 a[104:107], a[212:215], v[200:203], a[104:107]
    buffer_load_dwordx4 v13, s[8:11], s28 offen offset:0 lds
    v_mfma_f32_16x16x32_bf16 a[108:111], a[212:215], v[208:211], a[108:111]
    v_exp_f32 v171, v171
    v_mfma_f32_16x16x32_bf16 a[108:111], a[208:211], v[204:207], a[108:111]
    s_waitcnt lgkmcnt(6)
    v_mfma_f32_16x16x32_bf16 v[164:167], a[176:179], v[36:39], v[100:103]
    s_mov_b32 s36, s5
    v_exp_f32 v172, v172
    v_mfma_f32_16x16x32_bf16 v[164:167], a[180:183], v[40:43], v[164:167]
    ds_read_b64_tr_b16 a[200:201], v6 offset:16384
    v_cvt_pk_bf16_f32 v227, v170, v171
    v_mfma_f32_16x16x32_bf16 v[164:167], a[184:187], v[44:47], v[164:167]
    v_exp_f32 v173, v173
    v_mfma_f32_16x16x32_bf16 v[164:167], a[188:191], v[48:51], v[164:167]
    ds_read_b64_tr_b16 a[202:203], v6 offset:20480
    v_mfma_f32_16x16x32_bf16 v[168:171], a[188:191], v[64:67], v[104:107]
    v_exp_f32 v174, v174
    v_mfma_f32_16x16x32_bf16 v[168:171], a[184:187], v[60:63], v[168:171]
    ds_read_b128 a[136:139], v3 offset:0
    v_cvt_pk_bf16_f32 v234, v172, v173
    v_mfma_f32_16x16x32_bf16 v[168:171], a[180:183], v[56:59], v[168:171]
    v_exp_f32 v175, v175
    v_mfma_f32_16x16x32_bf16 v[168:171], a[176:179], v[52:55], v[168:171]
    ds_read_b64_tr_b16 a[204:205], v6 offset:40960
    v_mfma_f32_16x16x32_bf16 a[112:115], a[216:219], v[180:183], a[112:115]
    v_exp_f32 v176, v176
    v_mfma_f32_16x16x32_bf16 a[112:115], a[220:223], v[184:187], a[112:115]
    ds_read_b64_tr_b16 a[206:207], v6 offset:45056
    v_cvt_pk_bf16_f32 v235, v174, v175
    v_mfma_f32_16x16x32_bf16 a[116:119], a[220:223], v[192:195], a[116:119]
    v_exp_f32 v177, v177
    v_mfma_f32_16x16x32_bf16 a[116:119], a[216:219], v[188:191], a[116:119]
    ds_read_b128 a[140:143], v4 offset:0
    v_mfma_f32_16x16x32_bf16 a[120:123], a[216:219], v[196:199], a[120:123]
    v_exp_f32 v178, v178
    v_mfma_f32_16x16x32_bf16 a[120:123], a[220:223], v[200:203], a[120:123]
    v_cvt_pk_bf16_f32 v242, v176, v177
    v_mfma_f32_16x16x32_bf16 a[124:127], a[220:223], v[208:211], a[124:127]
    v_exp_f32 v179, v179
    v_mfma_f32_16x16x32_bf16 a[124:127], a[216:219], v[204:207], a[124:127]
    buffer_load_dwordx4 v14, s[8:11], s28 offen offset:1024 lds
    v_smfmac_f32_16x16x64_bf16 a[236:239], v[244:247], v[204:211], v248
    s_waitcnt lgkmcnt(6)
    s_sub_u32 s35, s35, 1
    s_cbranch_scc0 L_attn_loop
    v_mfma_f32_16x16x32_bf16 v[172:175], a[176:179], v[68:71], v[108:111]
    s_bfe_u32 s40, s2, 0x20001
    v_exp_f32 v116, v116
    v_mfma_f32_16x16x32_bf16 v[172:175], a[180:183], v[72:75], v[172:175]
    s_lshl_b32 s40, s40, 3
    ds_read_b64_tr_b16 a[208:209], v7 offset:16384
    v_cvt_pk_bf16_f32 v243, v178, v179
    v_mfma_f32_16x16x32_bf16 v[172:175], a[184:187], v[76:79], v[172:175]
    s_bfe_u32 s41, s2, 0x30003
    v_exp_f32 v117, v117
    v_mfma_f32_16x16x32_bf16 v[172:175], a[188:191], v[80:83], v[172:175]
    s_add_u32 s87, s40, s41
    ds_read_b64_tr_b16 a[210:211], v7 offset:20480
    v_and_b32 v21, 7, v19
    v_mfma_f32_16x16x32_bf16 v[176:179], a[188:191], v[96:99], v[112:115]
    s_and_b32 s40, s2, 1
    v_exp_f32 v118, v118
    v_mfma_f32_16x16x32_bf16 v[176:179], a[184:187], v[92:95], v[176:179]
    s_lshl_b32 s40, s40, 2
    ds_read_b128 a[144:147], v1 offset:4096
    v_cvt_pk_bf16_f32 v180, v116, v117
    v_mfma_f32_16x16x32_bf16 v[176:179], a[180:183], v[88:91], v[176:179]
    s_lshr_b32 s41, s2, 6
    v_exp_f32 v119, v119
    v_mfma_f32_16x16x32_bf16 v[176:179], a[176:179], v[84:87], v[176:179]
    s_add_u32 s100, s40, s41
    ds_read_b64_tr_b16 a[212:213], v7 offset:40960
    v_lshlrev_b32 v21, 2, v21
    v_mfma_f32_16x16x32_bf16 a[0:3], a[192:195], v[212:215], a[0:3]
    s_add_u32 s16, s72, 0x1a00000
    s_addc_u32 s17, s73, 0
    v_exp_f32 v120, v120
    v_mfma_f32_16x16x32_bf16 a[0:3], a[196:199], v[216:219], a[0:3]
    s_mov_b32 s18, 0x438000
    ds_read_b64_tr_b16 a[214:215], v7 offset:45056
    v_cvt_pk_bf16_f32 v181, v118, v119
    v_mfma_f32_16x16x32_bf16 a[4:7], a[196:199], v[224:227], a[4:7]
    s_mov_b32 s19, 0x20000
    v_exp_f32 v121, v121
    v_mfma_f32_16x16x32_bf16 a[4:7], a[192:195], v[220:223], a[4:7]
    ds_read_b128 a[148:151], v2 offset:4096
    v_cvt_pk_bf16_f32 v188, v120, v121
    v_mfma_f32_16x16x32_bf16 a[8:11], a[192:195], v[228:231], a[8:11]
    v_exp_f32 v122, v122
    v_mfma_f32_16x16x32_bf16 a[8:11], a[196:199], v[232:235], a[8:11]
    buffer_load_dwordx4 v15, s[8:11], s28 offen offset:2048 lds
    v_add_u32 v21, 0x29b000, v21
    v_mfma_f32_16x16x32_bf16 a[12:15], a[196:199], v[240:243], a[12:15]
    v_exp_f32 v123, v123
    v_mfma_f32_16x16x32_bf16 a[12:15], a[192:195], v[236:239], a[12:15]
    s_waitcnt lgkmcnt(6)
    buffer_load_dword v249, v21, s[76:79], 0 offen sc1
    v_mfma_f32_16x16x32_bf16 v[116:119], a[128:131], v[36:39], v[100:103]
    v_exp_f32 v124, v124
    v_mfma_f32_16x16x32_bf16 v[116:119], a[132:135], v[40:43], v[116:119]
    ds_read_b64_tr_b16 a[216:217], v8 offset:16384
    v_cvt_pk_bf16_f32 v189, v122, v123
    v_mfma_f32_16x16x32_bf16 v[116:119], a[136:139], v[44:47], v[116:119]
    v_exp_f32 v125, v125
    v_mfma_f32_16x16x32_bf16 v[116:119], a[140:143], v[48:51], v[116:119]
    ds_read_b64_tr_b16 a[218:219], v8 offset:20480
    v_lshlrev_b32 v32, 7, v19
    v_mfma_f32_16x16x32_bf16 v[120:123], a[140:143], v[64:67], v[104:107]
    v_exp_f32 v126, v126
    v_mfma_f32_16x16x32_bf16 v[120:123], a[136:139], v[60:63], v[120:123]
    ds_read_b128 a[152:155], v3 offset:4096
    v_cvt_pk_bf16_f32 v196, v124, v125
    v_mfma_f32_16x16x32_bf16 v[120:123], a[132:135], v[56:59], v[120:123]
    v_exp_f32 v127, v127
    v_mfma_f32_16x16x32_bf16 v[120:123], a[128:131], v[52:55], v[120:123]
    ds_read_b64_tr_b16 a[220:221], v8 offset:40960
    v_add_u32 v32, 0x290000, v32
    v_mfma_f32_16x16x32_bf16 a[16:19], a[200:203], v[212:215], a[16:19]
    v_exp_f32 v128, v128
    v_mfma_f32_16x16x32_bf16 a[16:19], a[204:207], v[216:219], a[16:19]
    ds_read_b64_tr_b16 a[222:223], v8 offset:45056
    v_cvt_pk_bf16_f32 v197, v126, v127
    v_mfma_f32_16x16x32_bf16 a[20:23], a[204:207], v[224:227], a[20:23]
    v_exp_f32 v129, v129
    v_mfma_f32_16x16x32_bf16 a[20:23], a[200:203], v[220:223], a[20:23]
    ds_read_b128 a[156:159], v4 offset:4096
    v_mfma_f32_16x16x32_bf16 a[24:27], a[200:203], v[228:231], a[24:27]
    v_exp_f32 v130, v130
    v_mfma_f32_16x16x32_bf16 a[24:27], a[204:207], v[232:235], a[24:27]
    v_cvt_pk_bf16_f32 v204, v128, v129
    v_mfma_f32_16x16x32_bf16 a[28:31], a[204:207], v[240:243], a[28:31]
    v_exp_f32 v131, v131
    v_mfma_f32_16x16x32_bf16 a[28:31], a[200:203], v[236:239], a[28:31]
    buffer_load_dwordx4 v16, s[8:11], s28 offen offset:3072 lds
    v_smfmac_f32_16x16x64_bf16 a[224:227], v[244:247], v[212:219], v248
    s_waitcnt lgkmcnt(6)
    buffer_load_dwordx4 v[28:31], v32, s[76:79], 0 offen sc1
    v_mfma_f32_16x16x32_bf16 v[124:127], a[128:131], v[68:71], v[108:111]
    v_exp_f32 v132, v132
    v_mfma_f32_16x16x32_bf16 v[124:127], a[132:135], v[72:75], v[124:127]
    ds_read_b64_tr_b16 a[192:193], v9 offset:16384
    v_cvt_pk_bf16_f32 v205, v130, v131
    v_mfma_f32_16x16x32_bf16 v[124:127], a[136:139], v[76:79], v[124:127]
    v_exp_f32 v133, v133
    v_mfma_f32_16x16x32_bf16 v[124:127], a[140:143], v[80:83], v[124:127]
    ds_read_b64_tr_b16 a[194:195], v9 offset:20480
    v_mov_b32 v24, 0x3f803f80
    v_mfma_f32_16x16x32_bf16 v[128:131], a[140:143], v[96:99], v[112:115]
    v_exp_f32 v134, v134
    v_mfma_f32_16x16x32_bf16 v[128:131], a[136:139], v[92:95], v[128:131]
    ds_read_b128 a[160:163], v1 offset:8192
    v_cvt_pk_bf16_f32 v182, v132, v133
    v_mfma_f32_16x16x32_bf16 v[128:131], a[132:135], v[88:91], v[128:131]
    v_exp_f32 v135, v135
    v_accvgpr_write_b32 a240, v24
    v_mfma_f32_16x16x32_bf16 v[128:131], a[128:131], v[84:87], v[128:131]
    ds_read_b64_tr_b16 a[196:197], v9 offset:40960
    v_accvgpr_write_b32 a241, v24
    v_mfma_f32_16x16x32_bf16 a[32:35], a[208:211], v[212:215], a[32:35]
    v_exp_f32 v136, v136
    v_mfma_f32_16x16x32_bf16 a[32:35], a[212:215], v[216:219], a[32:35]
    ds_read_b64_tr_b16 a[198:199], v9 offset:45056
    v_cvt_pk_bf16_f32 v183, v134, v135
    v_lshlrev_b32 v25, 4, v19
    v_mfma_f32_16x16x32_bf16 a[36:39], a[212:215], v[224:227], a[36:39]
    s_mul_i32 s40, s5, 3072
    v_exp_f32 v137, v137
    v_mfma_f32_16x16x32_bf16 a[36:39], a[208:211], v[220:223], a[36:39]
    s_mul_i32 s41, s6, 10240
    ds_read_b128 a[164:167], v2 offset:8192
    v_cvt_pk_bf16_f32 v190, v136, v137
    v_mfma_f32_16x16x32_bf16 a[40:43], a[208:211], v[228:231], a[40:43]
    s_add_u32 s28, s28, 16384
    s_mov_b32 m0, s33
    v_exp_f32 v138, v138
    v_accvgpr_write_b32 a242, v24
    v_mfma_f32_16x16x32_bf16 a[40:43], a[212:215], v[232:235], a[40:43]
    s_add_u32 s41, s41, s40
    buffer_load_dwordx4 v17, s[12:15], s29 offen offset:0 lds
    v_mfma_f32_16x16x32_bf16 a[44:47], a[212:215], v[240:243], a[44:47]
    v_exp_f32 v139, v139
    v_mfma_f32_16x16x32_bf16 a[44:47], a[208:211], v[236:239], a[44:47]
    s_waitcnt lgkmcnt(6)
    v_accvgpr_write_b32 a243, v24
    v_accvgpr_write_b32 a244, v24
    v_mfma_f32_16x16x32_bf16 v[132:135], a[144:147], v[36:39], v[100:103]
    v_exp_f32 v140, v140
    v_mfma_f32_16x16x32_bf16 v[132:135], a[148:151], v[40:43], v[132:135]
    ds_read_b64_tr_b16 a[200:201], v10 offset:16384
    v_cvt_pk_bf16_f32 v191, v138, v139
    v_mfma_f32_16x16x32_bf16 v[132:135], a[152:155], v[44:47], v[132:135]
    v_exp_f32 v141, v141
    v_mfma_f32_16x16x32_bf16 v[132:135], a[156:159], v[48:51], v[132:135]
    ds_read_b64_tr_b16 a[202:203], v10 offset:20480
    v_accvgpr_write_b32 a245, v24
    v_mfma_f32_16x16x32_bf16 v[136:139], a[156:159], v[64:67], v[104:107]
    v_exp_f32 v142, v142
    v_mfma_f32_16x16x32_bf16 v[136:139], a[152:155], v[60:63], v[136:139]
    ds_read_b128 a[168:171], v3 offset:8192
    v_cvt_pk_bf16_f32 v198, v140, v141
    v_mfma_f32_16x16x32_bf16 v[136:139], a[148:151], v[56:59], v[136:139]
    v_exp_f32 v143, v143
    v_mfma_f32_16x16x32_bf16 v[136:139], a[144:147], v[52:55], v[136:139]
    ds_read_b64_tr_b16 a[204:205], v10 offset:40960
    v_accvgpr_write_b32 a246, v24
    v_mfma_f32_16x16x32_bf16 a[48:51], a[216:219], v[212:215], a[48:51]
    v_exp_f32 v144, v144
    v_mfma_f32_16x16x32_bf16 a[48:51], a[220:223], v[216:219], a[48:51]
    ds_read_b64_tr_b16 a[206:207], v10 offset:45056
    v_cvt_pk_bf16_f32 v199, v142, v143
    v_mfma_f32_16x16x32_bf16 a[52:55], a[220:223], v[224:227], a[52:55]
    v_exp_f32 v145, v145
    v_mfma_f32_16x16x32_bf16 a[52:55], a[216:219], v[220:223], a[52:55]
    ds_read_b128 a[172:175], v4 offset:8192
    v_accvgpr_write_b32 a247, v24
    v_mfma_f32_16x16x32_bf16 a[56:59], a[216:219], v[228:231], a[56:59]
    v_exp_f32 v146, v146
    v_mfma_f32_16x16x32_bf16 a[56:59], a[220:223], v[232:235], a[56:59]
    v_cvt_pk_bf16_f32 v206, v144, v145
    v_accvgpr_write_b32 a248, v24
    v_mfma_f32_16x16x32_bf16 a[60:63], a[220:223], v[240:243], a[60:63]
    v_exp_f32 v147, v147
    v_mfma_f32_16x16x32_bf16 a[60:63], a[216:219], v[236:239], a[60:63]
    buffer_load_dwordx4 v18, s[12:15], s29 offen offset:1024 lds
    v_smfmac_f32_16x16x64_bf16 a[228:231], v[244:247], v[220:227], v248
    s_waitcnt lgkmcnt(6)
    v_accvgpr_write_b32 a249, v24
    v_accvgpr_write_b32 a250, v24
    v_mfma_f32_16x16x32_bf16 v[140:143], a[144:147], v[68:71], v[108:111]
    v_exp_f32 v148, v148
    v_mfma_f32_16x16x32_bf16 v[140:143], a[148:151], v[72:75], v[140:143]
    ds_read_b64_tr_b16 a[208:209], v11 offset:16384
    v_cvt_pk_bf16_f32 v207, v146, v147
    v_mfma_f32_16x16x32_bf16 v[140:143], a[152:155], v[76:79], v[140:143]
    v_exp_f32 v149, v149
    v_mfma_f32_16x16x32_bf16 v[140:143], a[156:159], v[80:83], v[140:143]
    ds_read_b64_tr_b16 a[210:211], v11 offset:20480
    v_accvgpr_write_b32 a251, v24
    v_mfma_f32_16x16x32_bf16 v[144:147], a[156:159], v[96:99], v[112:115]
    v_exp_f32 v150, v150
    v_mfma_f32_16x16x32_bf16 v[144:147], a[152:155], v[92:95], v[144:147]
    ds_read_b128 a[176:179], v1 offset:12288
    v_cvt_pk_bf16_f32 v184, v148, v149
    v_mfma_f32_16x16x32_bf16 v[144:147], a[148:151], v[88:91], v[144:147]
    v_exp_f32 v151, v151
    v_mfma_f32_16x16x32_bf16 v[144:147], a[144:147], v[84:87], v[144:147]
    ds_read_b64_tr_b16 a[212:213], v11 offset:40960
    v_accvgpr_write_b32 a252, v24
    v_mfma_f32_16x16x32_bf16 a[64:67], a[192:195], v[212:215], a[64:67]
    v_exp_f32 v152, v152
    v_mfma_f32_16x16x32_bf16 a[64:67], a[196:199], v[216:219], a[64:67]
    ds_read_b64_tr_b16 a[214:215], v11 offset:45056
    v_cvt_pk_bf16_f32 v185, v150, v151
    v_mfma_f32_16x16x32_bf16 a[68:71], a[196:199], v[224:227], a[68:71]
    v_exp_f32 v153, v153
    v_mfma_f32_16x16x32_bf16 a[68:71], a[192:195], v[220:223], a[68:71]
    ds_read_b128 a[180:183], v2 offset:12288
    v_cvt_pk_bf16_f32 v192, v152, v153
    v_mfma_f32_16x16x32_bf16 a[72:75], a[192:195], v[228:231], a[72:75]
    v_exp_f32 v154, v154
    v_mfma_f32_16x16x32_bf16 a[72:75], a[196:199], v[232:235], a[72:75]
    buffer_load_dwordx4 v17, s[12:15], s29 offen offset:2048 lds
    s_mov_b32 s43, m0
    s_add_u32 m0, s40, 86016
    s_nop 0
    buffer_load_dwordx4 v25, s[96:99], s41 offen offset:0 lds
    s_mov_b32 m0, s43
    v_accvgpr_write_b32 a253, v24
    v_mfma_f32_16x16x32_bf16 a[76:79], a[196:199], v[240:243], a[76:79]
    v_exp_f32 v155, v155
    v_mfma_f32_16x16x32_bf16 a[76:79], a[192:195], v[236:239], a[76:79]
    s_waitcnt lgkmcnt(6)
    v_accvgpr_write_b32 a254, v24
    v_accvgpr_write_b32 a255, v24
    v_mfma_f32_16x16x32_bf16 v[148:151], a[160:163], v[36:39], v[100:103]
    v_exp_f32 v156, v156
    v_mfma_f32_16x16x32_bf16 v[148:151], a[164:167], v[40:43], v[148:151]
    ds_read_b64_tr_b16 a[216:217], v12 offset:16384
    v_cvt_pk_bf16_f32 v193, v154, v155
    v_mfma_f32_16x16x32_bf16 v[148:151], a[168:171], v[44:47], v[148:151]
    v_exp_f32 v157, v157
    v_mfma_f32_16x16x32_bf16 v[148:151], a[172:175], v[48:51], v[148:151]
    ds_read_b64_tr_b16 a[218:219], v12 offset:20480
    v_mov_b32 v252, v24
    v_mfma_f32_16x16x32_bf16 v[152:155], a[172:175], v[64:67], v[104:107]
    v_exp_f32 v158, v158
    v_mfma_f32_16x16x32_bf16 v[152:155], a[168:171], v[60:63], v[152:155]
    ds_read_b128 a[184:187], v3 offset:12288
    v_cvt_pk_bf16_f32 v200, v156, v157
    v_mfma_f32_16x16x32_bf16 v[152:155], a[164:167], v[56:59], v[152:155]
    v_exp_f32 v159, v159
    v_mfma_f32_16x16x32_bf16 v[152:155], a[160:163], v[52:55], v[152:155]
    ds_read_b64_tr_b16 a[220:221], v12 offset:40960
    s_mov_b32 s43, m0
    s_add_u32 m0, s40, 86016
    s_nop 0
    buffer_load_dwordx4 v25, s[96:99], s41 offen offset:1024 lds
    s_mov_b32 m0, s43
    v_mov_b32 v253, v24
    v_mfma_f32_16x16x32_bf16 a[80:83], a[200:203], v[212:215], a[80:83]
    v_exp_f32 v160, v160
    v_mfma_f32_16x16x32_bf16 a[80:83], a[204:207], v[216:219], a[80:83]
    ds_read_b64_tr_b16 a[222:223], v12 offset:45056
    v_cvt_pk_bf16_f32 v201, v158, v159
    v_mfma_f32_16x16x32_bf16 a[84:87], a[204:207], v[224:227], a[84:87]
    v_exp_f32 v161, v161
    v_mfma_f32_16x16x32_bf16 a[84:87], a[200:203], v[220:223], a[84:87]
    ds_read_b128 a[188:191], v4 offset:12288
    v_mov_b32 v254, v24
    v_mfma_f32_16x16x32_bf16 a[88:91], a[200:203], v[228:231], a[88:91]
    v_exp_f32 v162, v162
    v_mfma_f32_16x16x32_bf16 a[88:91], a[204:207], v[232:235], a[88:91]
    v_cvt_pk_bf16_f32 v208, v160, v161
    v_mov_b32 v255, v24
    v_mfma_f32_16x16x32_bf16 a[92:95], a[204:207], v[240:243], a[92:95]
    v_exp_f32 v163, v163
    v_mfma_f32_16x16x32_bf16 a[92:95], a[200:203], v[236:239], a[92:95]
    buffer_load_dwordx4 v18, s[12:15], s29 offen offset:3072 lds
    v_smfmac_f32_16x16x64_bf16 a[232:235], v[244:247], v[228:235], v248
    s_waitcnt vmcnt(12) lgkmcnt(6)
    s_barrier
    s_add_u32 s29, s29, 16384
    s_mov_b32 s43, m0
    s_add_u32 m0, s40, 86016
    s_nop 0
    buffer_load_dwordx4 v25, s[96:99], s41 offen offset:2048 lds
    s_mov_b32 m0, s43
    v_mfma_f32_16x16x32_bf16 v[156:159], a[160:163], v[68:71], v[108:111]
    s_waitcnt vmcnt(7)
    v_exp_f32 v164, v164
    v_mfma_f32_16x16x32_bf16 v[156:159], a[164:167], v[72:75], v[156:159]
    ds_read_b64_tr_b16 a[192:193], v5 offset:57344
    v_cvt_pk_bf16_f32 v209, v162, v163
    v_mfma_f32_16x16x32_bf16 v[156:159], a[168:171], v[76:79], v[156:159]
    v_exp_f32 v165, v165
    v_mfma_f32_16x16x32_bf16 v[156:159], a[172:175], v[80:83], v[156:159]
    ds_read_b64_tr_b16 a[194:195], v5 offset:61440
    v_cmp_eq_u32 vcc, 0, v249
    s_and_b64 vcc, vcc, exec
    s_cbranch_scc1 L_spin_sel
L_back_sel:
    v_mfma_f32_16x16x32_bf16 v[160:163], a[172:175], v[96:99], v[112:115]
    v_exp_f32 v166, v166
    v_mfma_f32_16x16x32_bf16 v[160:163], a[168:171], v[92:95], v[160:163]
    ds_read_b128 a[128:131], v1 offset:49152
    v_cvt_pk_bf16_f32 v186, v164, v165
    v_mfma_f32_16x16x32_bf16 v[160:163], a[164:167], v[88:91], v[160:163]
    v_exp_f32 v167, v167
    v_mfma_f32_16x16x32_bf16 v[160:163], a[160:163], v[84:87], v[160:163]
    ds_read_b64_tr_b16 a[196:197], v5 offset:0
    v_min3_u32 v28, v28, v29, v30
    v_mfma_f32_16x16x32_bf16 a[96:99], a[208:211], v[212:215], a[96:99]
    v_exp_f32 v168, v168
    v_mfma_f32_16x16x32_bf16 a[96:99], a[212:215], v[216:219], a[96:99]
    ds_read_b64_tr_b16 a[198:199], v5 offset:4096
    v_cvt_pk_bf16_f32 v187, v166, v167
    v_mfma_f32_16x16x32_bf16 a[100:103], a[212:215], v[224:227], a[100:103]
    v_exp_f32 v169, v169
    v_mfma_f32_16x16x32_bf16 a[100:103], a[208:211], v[220:223], a[100:103]
    ds_read_b128 a[132:135], v2 offset:49152
    v_cvt_pk_bf16_f32 v194, v168, v169
    v_mfma_f32_16x16x32_bf16 a[104:107], a[208:211], v[228:231], a[104:107]
    s_add_u32 m0, s34, 32768
    v_exp_f32 v170, v170
    v_mfma_f32_16x16x32_bf16 a[104:107], a[212:215], v[232:235], a[104:107]
    buffer_load_dwordx4 v13, s[8:11], s28 offen offset:0 lds
    v_mfma_f32_16x16x32_bf16 a[108:111], a[212:215], v[240:243], a[108:111]
    v_exp_f32 v171, v171
    v_mfma_f32_16x16x32_bf16 a[108:111], a[208:211], v[236:239], a[108:111]
    s_waitcnt lgkmcnt(6)
    v_min_u32 v28, v28, v31
    v_cmp_gt_u32 vcc, 1, v28
    s_and_b64 vcc, vcc, exec
    s_cbranch_scc1 L_spin_pack
L_back_pack:
    v_mfma_f32_16x16x32_bf16 v[164:167], a[176:179], v[36:39], v[100:103]
    v_exp_f32 v172, v172
    v_mfma_f32_16x16x32_bf16 v[164:167], a[180:183], v[40:43], v[164:167]
    ds_read_b64_tr_b16 a[200:201], v6 offset:57344
    v_cvt_pk_bf16_f32 v195, v170, v171
    v_mfma_f32_16x16x32_bf16 v[164:167], a[184:187], v[44:47], v[164:167]
    v_exp_f32 v173, v173
    v_mfma_f32_16x16x32_bf16 v[164:167], a[188:191], v[48:51], v[164:167]
    ds_read_b64_tr_b16 a[202:203], v6 offset:61440
    v_mfma_f32_16x16x32_bf16 v[168:171], a[188:191], v[64:67], v[104:107]
    v_exp_f32 v174, v174
    v_mfma_f32_16x16x32_bf16 v[168:171], a[184:187], v[60:63], v[168:171]
    ds_read_b128 a[136:139], v3 offset:49152
    v_cvt_pk_bf16_f32 v202, v172, v173
    v_mfma_f32_16x16x32_bf16 v[168:171], a[180:183], v[56:59], v[168:171]
    v_exp_f32 v175, v175
    v_mfma_f32_16x16x32_bf16 v[168:171], a[176:179], v[52:55], v[168:171]
    ds_read_b64_tr_b16 a[204:205], v6 offset:0
    v_mfma_f32_16x16x32_bf16 a[112:115], a[216:219], v[212:215], a[112:115]
    v_exp_f32 v176, v176
    v_mfma_f32_16x16x32_bf16 a[112:115], a[220:223], v[216:219], a[112:115]
    ds_read_b64_tr_b16 a[206:207], v6 offset:4096
    v_cvt_pk_bf16_f32 v203, v174, v175
    v_mfma_f32_16x16x32_bf16 a[116:119], a[220:223], v[224:227], a[116:119]
    v_exp_f32 v177, v177
    v_mfma_f32_16x16x32_bf16 a[116:119], a[216:219], v[220:223], a[116:119]
    ds_read_b128 a[140:143], v4 offset:49152
    v_mfma_f32_16x16x32_bf16 a[120:123], a[216:219], v[228:231], a[120:123]
    v_exp_f32 v178, v178
    v_mfma_f32_16x16x32_bf16 a[120:123], a[220:223], v[232:235], a[120:123]
    v_cvt_pk_bf16_f32 v210, v176, v177
    v_mfma_f32_16x16x32_bf16 a[124:127], a[220:223], v[240:243], a[124:127]
    v_exp_f32 v179, v179
    v_mfma_f32_16x16x32_bf16 a[124:127], a[216:219], v[236:239], a[124:127]
    buffer_load_dwordx4 v14, s[8:11], s28 offen offset:1024 lds
    v_smfmac_f32_16x16x64_bf16 a[236:239], v[244:247], v[236:243], v248
    s_waitcnt lgkmcnt(6)
    v_mfma_f32_16x16x32_bf16 v[172:175], a[176:179], v[68:71], v[108:111]
    v_exp_f32 v116, v116
    v_mfma_f32_16x16x32_bf16 v[172:175], a[180:183], v[72:75], v[172:175]
    ds_read_b64_tr_b16 a[208:209], v7 offset:57344
    v_cvt_pk_bf16_f32 v211, v178, v179
    v_mfma_f32_16x16x32_bf16 v[172:175], a[184:187], v[76:79], v[172:175]
    v_exp_f32 v117, v117
    v_mfma_f32_16x16x32_bf16 v[172:175], a[188:191], v[80:83], v[172:175]
    ds_read_b64_tr_b16 a[210:211], v7 offset:61440
    v_mov_b32 v22, v249
    v_mfma_f32_16x16x32_bf16 v[176:179], a[188:191], v[96:99], v[112:115]
    v_exp_f32 v118, v118
    v_mfma_f32_16x16x32_bf16 v[176:179], a[184:187], v[92:95], v[176:179]
    ds_read_b128 a[144:147], v1 offset:53248
    v_cvt_pk_bf16_f32 v212, v116, v117
    v_mfma_f32_16x16x32_bf16 v[176:179], a[180:183], v[88:91], v[176:179]
    v_exp_f32 v119, v119
    v_mfma_f32_16x16x32_bf16 v[176:179], a[176:179], v[84:87], v[176:179]
    ds_read_b64_tr_b16 a[212:213], v7 offset:0
    v_not_b32 v22, v22
    v_mfma_f32_16x16x32_bf16 a[0:3], a[192:195], v[180:183], a[0:3]
    v_exp_f32 v120, v120
    v_mfma_f32_16x16x32_bf16 a[0:3], a[196:199], v[184:187], a[0:3]
    ds_read_b64_tr_b16 a[214:215], v7 offset:4096
    v_cvt_pk_bf16_f32 v213, v118, v119
    v_mfma_f32_16x16x32_bf16 a[4:7], a[196:199], v[192:195], a[4:7]
    v_exp_f32 v121, v121
    v_mfma_f32_16x16x32_bf16 a[4:7], a[192:195], v[188:191], a[4:7]
    ds_read_b128 a[148:151], v2 offset:53248
    v_cvt_pk_bf16_f32 v220, v120, v121
    v_mfma_f32_16x16x32_bf16 a[8:11], a[192:195], v[196:199], a[8:11]
    v_exp_f32 v122, v122
    v_and_b32 v22, 0x7ff, v22
    v_mfma_f32_16x16x32_bf16 a[8:11], a[196:199], v[200:203], a[8:11]
    buffer_load_dwordx4 v15, s[8:11], s28 offen offset:2048 lds
    v_mfma_f32_16x16x32_bf16 a[12:15], a[196:199], v[208:211], a[12:15]
    v_exp_f32 v123, v123
    v_mfma_f32_16x16x32_bf16 a[12:15], a[192:195], v[204:207], a[12:15]
    s_waitcnt lgkmcnt(6)
    v_lshrrev_b32 v24, 4, v19
    v_lshlrev_b32 v23, 4, v22
    v_mfma_f32_16x16x32_bf16 v[116:119], a[128:131], v[36:39], v[100:103]
    v_exp_f32 v124, v124
    v_mfma_f32_16x16x32_bf16 v[116:119], a[132:135], v[40:43], v[116:119]
    ds_read_b64_tr_b16 a[216:217], v8 offset:57344
    v_cvt_pk_bf16_f32 v221, v122, v123
    v_mfma_f32_16x16x32_bf16 v[116:119], a[136:139], v[44:47], v[116:119]
    v_exp_f32 v125, v125
    v_mfma_f32_16x16x32_bf16 v[116:119], a[140:143], v[48:51], v[116:119]
    ds_read_b64_tr_b16 a[218:219], v8 offset:61440
    v_mul_u32_u24 v22, 1280, v22
    v_mfma_f32_16x16x32_bf16 v[120:123], a[140:143], v[64:67], v[104:107]
    v_exp_f32 v126, v126
    v_mfma_f32_16x16x32_bf16 v[120:123], a[136:139], v[60:63], v[120:123]
    ds_read_b128 a[152:155], v3 offset:53248
    v_cvt_pk_bf16_f32 v228, v124, v125
    v_mfma_f32_16x16x32_bf16 v[120:123], a[132:135], v[56:59], v[120:123]
    v_exp_f32 v127, v127
    v_mfma_f32_16x16x32_bf16 v[120:123], a[128:131], v[52:55], v[120:123]
    ds_read_b64_tr_b16 a[220:221], v8 offset:0
    v_lshl_add_u32 v22, v24, 4, v22
    v_mfma_f32_16x16x32_bf16 a[16:19], a[200:203], v[180:183], a[16:19]
    s_mul_i32 s40, s5, 320
    v_exp_f32 v128, v128
    v_mfma_f32_16x16x32_bf16 a[16:19], a[204:207], v[184:187], a[16:19]
    s_mov_b32 s41, 0x280000
    ds_read_b64_tr_b16 a[222:223], v8 offset:4096
    v_cvt_pk_bf16_f32 v229, v126, v127
    v_mfma_f32_16x16x32_bf16 a[20:23], a[204:207], v[192:195], a[20:23]
    v_exp_f32 v129, v129
    v_mfma_f32_16x16x32_bf16 a[20:23], a[200:203], v[188:191], a[20:23]
    ds_read_b128 a[156:159], v4 offset:53248
    v_mfma_f32_16x16x32_bf16 a[24:27], a[200:203], v[196:199], a[24:27]
    v_exp_f32 v130, v130
    v_mfma_f32_16x16x32_bf16 a[24:27], a[204:207], v[200:203], a[24:27]
    v_cvt_pk_bf16_f32 v236, v128, v129
    v_mfma_f32_16x16x32_bf16 a[28:31], a[204:207], v[208:211], a[28:31]
    v_exp_f32 v131, v131
    v_mfma_f32_16x16x32_bf16 a[28:31], a[200:203], v[204:207], a[28:31]
    buffer_load_dwordx4 v16, s[8:11], s28 offen offset:3072 lds
    v_smfmac_f32_16x16x64_bf16 a[224:227], v[244:247], v[180:187], v248
    s_waitcnt lgkmcnt(6)
    buffer_load_dwordx2 v[20:21], v23, s[76:79], s41 offen sc1
    v_mfma_f32_16x16x32_bf16 v[124:127], a[128:131], v[68:71], v[108:111]
    v_exp_f32 v132, v132
    v_mfma_f32_16x16x32_bf16 v[124:127], a[132:135], v[72:75], v[124:127]
    ds_read_b64_tr_b16 a[192:193], v9 offset:57344
    v_cvt_pk_bf16_f32 v237, v130, v131
    v_mfma_f32_16x16x32_bf16 v[124:127], a[136:139], v[76:79], v[124:127]
    v_exp_f32 v133, v133
    v_mfma_f32_16x16x32_bf16 v[124:127], a[140:143], v[80:83], v[124:127]
    ds_read_b64_tr_b16 a[194:195], v9 offset:61440
    v_mfma_f32_16x16x32_bf16 v[128:131], a[140:143], v[96:99], v[112:115]
    v_exp_f32 v134, v134
    v_mfma_f32_16x16x32_bf16 v[128:131], a[136:139], v[92:95], v[128:131]
    ds_read_b128 a[160:163], v1 offset:57344
    v_cvt_pk_bf16_f32 v214, v132, v133
    v_mfma_f32_16x16x32_bf16 v[128:131], a[132:135], v[88:91], v[128:131]
    v_exp_f32 v135, v135
    v_mfma_f32_16x16x32_bf16 v[128:131], a[128:131], v[84:87], v[128:131]
    ds_read_b64_tr_b16 a[196:197], v9 offset:0
    v_mfma_f32_16x16x32_bf16 a[32:35], a[208:211], v[180:183], a[32:35]
    v_exp_f32 v136, v136
    v_mfma_f32_16x16x32_bf16 a[32:35], a[212:215], v[184:187], a[32:35]
    ds_read_b64_tr_b16 a[198:199], v9 offset:4096
    v_cvt_pk_bf16_f32 v215, v134, v135
    v_mfma_f32_16x16x32_bf16 a[36:39], a[212:215], v[192:195], a[36:39]
    v_exp_f32 v137, v137
    v_mfma_f32_16x16x32_bf16 a[36:39], a[208:211], v[188:191], a[36:39]
    ds_read_b128 a[164:167], v2 offset:57344
    v_cvt_pk_bf16_f32 v222, v136, v137
    v_mfma_f32_16x16x32_bf16 a[40:43], a[208:211], v[196:199], a[40:43]
    s_add_u32 s28, s28, 16384
    s_mov_b32 m0, s30
    v_exp_f32 v138, v138
    v_mfma_f32_16x16x32_bf16 a[40:43], a[212:215], v[200:203], a[40:43]
    buffer_load_dwordx4 v17, s[12:15], s29 offen offset:0 lds
    v_mfma_f32_16x16x32_bf16 a[44:47], a[212:215], v[208:211], a[44:47]
    s_mov_b32 exec_lo, 0x00ff00ff
    s_mov_b32 exec_hi, 0x00ff00ff
    buffer_load_dwordx4 a[240:243], v22, s[88:91], s40 offen offset:0
    s_mov_b64 exec, -1
    v_exp_f32 v139, v139
    v_mfma_f32_16x16x32_bf16 a[44:47], a[208:211], v[204:207], a[44:47]
    s_waitcnt lgkmcnt(6)
    s_mov_b32 exec_lo, 0x00ff00ff
    s_mov_b32 exec_hi, 0x00ff00ff
    buffer_load_dwordx4 a[244:247], v22, s[88:91], s40 offen offset:64
    s_mov_b64 exec, -1
    v_mfma_f32_16x16x32_bf16 v[132:135], a[144:147], v[36:39], v[100:103]
    v_exp_f32 v140, v140
    v_mfma_f32_16x16x32_bf16 v[132:135], a[148:151], v[40:43], v[132:135]
    ds_read_b64_tr_b16 a[200:201], v10 offset:57344
    v_cvt_pk_bf16_f32 v223, v138, v139
    v_mfma_f32_16x16x32_bf16 v[132:135], a[152:155], v[44:47], v[132:135]
    v_exp_f32 v141, v141
    v_mfma_f32_16x16x32_bf16 v[132:135], a[156:159], v[48:51], v[132:135]
    ds_read_b64_tr_b16 a[202:203], v10 offset:61440
    v_mfma_f32_16x16x32_bf16 v[136:139], a[156:159], v[64:67], v[104:107]
    v_exp_f32 v142, v142
    v_mfma_f32_16x16x32_bf16 v[136:139], a[152:155], v[60:63], v[136:139]
    ds_read_b128 a[168:171], v3 offset:57344
    v_cvt_pk_bf16_f32 v230, v140, v141
    v_mfma_f32_16x16x32_bf16 v[136:139], a[148:151], v[56:59], v[136:139]
    v_exp_f32 v143, v143
    v_mfma_f32_16x16x32_bf16 v[136:139], a[144:147], v[52:55], v[136:139]
    ds_read_b64_tr_b16 a[204:205], v10 offset:0
    s_mov_b32 exec_lo, 0x00ff00ff
    s_mov_b32 exec_hi, 0x00ff00ff
    buffer_load_dwordx4 a[248:251], v22, s[88:91], s40 offen offset:128
    s_mov_b64 exec, -1
    v_mfma_f32_16x16x32_bf16 a[48:51], a[216:219], v[180:183], a[48:51]
    v_exp_f32 v144, v144
    v_mfma_f32_16x16x32_bf16 a[48:51], a[220:223], v[184:187], a[48:51]
    ds_read_b64_tr_b16 a[206:207], v10 offset:4096
    v_cvt_pk_bf16_f32 v231, v142, v143
    v_mfma_f32_16x16x32_bf16 a[52:55], a[220:223], v[192:195], a[52:55]
    v_exp_f32 v145, v145
    v_mfma_f32_16x16x32_bf16 a[52:55], a[216:219], v[188:191], a[52:55]
    ds_read_b128 a[172:175], v4 offset:57344
    v_mfma_f32_16x16x32_bf16 a[56:59], a[216:219], v[196:199], a[56:59]
    s_mov_b32 exec_lo, 0x00ff00ff
    s_mov_b32 exec_hi, 0x00ff00ff
    buffer_load_dwordx4 a[252:255], v22, s[88:91], s40 offen offset:192
    s_mov_b64 exec, -1
    v_exp_f32 v146, v146
    v_mfma_f32_16x16x32_bf16 a[56:59], a[220:223], v[200:203], a[56:59]
    v_cvt_pk_bf16_f32 v238, v144, v145
    v_mfma_f32_16x16x32_bf16 a[60:63], a[220:223], v[208:211], a[60:63]
    v_exp_f32 v147, v147
    v_mfma_f32_16x16x32_bf16 a[60:63], a[216:219], v[204:207], a[60:63]
    buffer_load_dwordx4 v18, s[12:15], s29 offen offset:1024 lds
    v_smfmac_f32_16x16x64_bf16 a[228:231], v[244:247], v[188:195], v248
    s_waitcnt lgkmcnt(6)
    s_mov_b32 exec_lo, 0x00ff00ff
    s_mov_b32 exec_hi, 0x00ff00ff
    buffer_load_dwordx4 v[252:255], v22, s[88:91], s40 offen offset:256
    s_mov_b64 exec, -1
    v_mfma_f32_16x16x32_bf16 v[140:143], a[144:147], v[68:71], v[108:111]
    v_exp_f32 v148, v148
    v_mfma_f32_16x16x32_bf16 v[140:143], a[148:151], v[72:75], v[140:143]
    ds_read_b64_tr_b16 a[208:209], v11 offset:57344
    v_cvt_pk_bf16_f32 v239, v146, v147
    v_mfma_f32_16x16x32_bf16 v[140:143], a[152:155], v[76:79], v[140:143]
    v_exp_f32 v149, v149
    v_lshrrev_b32 v22, 4, v19
    v_mfma_f32_16x16x32_bf16 v[140:143], a[156:159], v[80:83], v[140:143]
    ds_read_b64_tr_b16 a[210:211], v11 offset:61440
    v_bfe_u32 v24, v19, 2, 2
    v_mfma_f32_16x16x32_bf16 v[144:147], a[156:159], v[96:99], v[112:115]
    v_exp_f32 v150, v150
    v_mfma_f32_16x16x32_bf16 v[144:147], a[152:155], v[92:95], v[144:147]
    ds_read_b128 a[176:179], v1 offset:61440
    v_cvt_pk_bf16_f32 v216, v148, v149
    v_mfma_f32_16x16x32_bf16 v[144:147], a[148:151], v[88:91], v[144:147]
    v_exp_f32 v151, v151
    v_lshl_add_u32 v22, v22, 3, v24
    v_mfma_f32_16x16x32_bf16 v[144:147], a[144:147], v[84:87], v[144:147]
    ds_read_b64_tr_b16 a[212:213], v11 offset:0
    v_and_b32 v24, 1, v19
    v_mfma_f32_16x16x32_bf16 a[64:67], a[192:195], v[180:183], a[64:67]
    v_exp_f32 v152, v152
    v_mfma_f32_16x16x32_bf16 a[64:67], a[196:199], v[184:187], a[64:67]
    ds_read_b64_tr_b16 a[214:215], v11 offset:4096
    v_cvt_pk_bf16_f32 v217, v150, v151
    v_mfma_f32_16x16x32_bf16 a[68:71], a[196:199], v[192:195], a[68:71]
    v_exp_f32 v153, v153
    v_mfma_f32_16x16x32_bf16 a[68:71], a[192:195], v[188:191], a[68:71]
    ds_read_b128 a[180:183], v2 offset:61440
    v_cvt_pk_bf16_f32 v224, v152, v153
    v_lshl_add_u32 v22, v22, 1, v24
    v_mfma_f32_16x16x32_bf16 a[72:75], a[192:195], v[196:199], a[72:75]
    v_exp_f32 v154, v154
    v_mfma_f32_16x16x32_bf16 a[72:75], a[196:199], v[200:203], a[72:75]
    buffer_load_dwordx4 v17, s[12:15], s29 offen offset:2048 lds
    v_bfe_u32 v24, v19, 1, 1
    v_mfma_f32_16x16x32_bf16 a[76:79], a[196:199], v[208:211], a[76:79]
    v_exp_f32 v155, v155
    v_mfma_f32_16x16x32_bf16 a[76:79], a[192:195], v[204:207], a[76:79]
    s_waitcnt lgkmcnt(6)
    v_mul_u32_u24 v24, 10240, v24
    v_lshl_add_u32 v22, v22, 3, v24
    v_mfma_f32_16x16x32_bf16 v[148:151], a[160:163], v[36:39], v[100:103]
    s_mul_i32 s42, s5, 2560
    v_exp_f32 v156, v156
    v_mfma_f32_16x16x32_bf16 v[148:151], a[164:167], v[40:43], v[148:151]
    s_add_u32 s42, s42, 65536
    ds_read_b64_tr_b16 a[216:217], v12 offset:57344
    v_cvt_pk_bf16_f32 v225, v154, v155
    v_mfma_f32_16x16x32_bf16 v[148:151], a[168:171], v[44:47], v[148:151]
    v_exp_f32 v157, v157
    v_mfma_f32_16x16x32_bf16 v[148:151], a[172:175], v[48:51], v[148:151]
    ds_read_b64_tr_b16 a[218:219], v12 offset:61440
    v_add_u32 v22, s42, v22
    v_mfma_f32_16x16x32_bf16 v[152:155], a[172:175], v[64:67], v[104:107]
    s_mov_b32 s42, 65536
    v_exp_f32 v158, v158
    v_mfma_f32_16x16x32_bf16 v[152:155], a[168:171], v[60:63], v[152:155]
    ds_read_b128 a[184:187], v3 offset:61440
    v_cvt_pk_bf16_f32 v232, v156, v157
    v_mfma_f32_16x16x32_bf16 v[152:155], a[164:167], v[56:59], v[152:155]
    v_exp_f32 v159, v159
    v_mfma_f32_16x16x32_bf16 v[152:155], a[160:163], v[52:55], v[152:155]
    ds_read_b64_tr_b16 a[220:221], v12 offset:0
    v_lshl_add_u32 v23, v19, 4, s42
    v_mfma_f32_16x16x32_bf16 a[80:83], a[200:203], v[180:183], a[80:83]
    v_exp_f32 v160, v160
    v_mfma_f32_16x16x32_bf16 a[80:83], a[204:207], v[184:187], a[80:83]
    ds_read_b64_tr_b16 a[222:223], v12 offset:4096
    v_cvt_pk_bf16_f32 v233, v158, v159
    v_mfma_f32_16x16x32_bf16 a[84:87], a[204:207], v[192:195], a[84:87]
    v_exp_f32 v161, v161
    v_mfma_f32_16x16x32_bf16 a[84:87], a[200:203], v[188:191], a[84:87]
    ds_read_b128 a[188:191], v4 offset:61440
    v_readlane_b32 s50, v249, 0
    v_mfma_f32_16x16x32_bf16 a[88:91], a[200:203], v[196:199], a[88:91]
    v_exp_f32 v162, v162
    v_mfma_f32_16x16x32_bf16 a[88:91], a[204:207], v[200:203], a[88:91]
    v_cvt_pk_bf16_f32 v240, v160, v161
    v_readlane_b32 s51, v249, 1
    v_mfma_f32_16x16x32_bf16 a[92:95], a[204:207], v[208:211], a[92:95]
    v_exp_f32 v163, v163
    v_mfma_f32_16x16x32_bf16 a[92:95], a[200:203], v[204:207], a[92:95]
    buffer_load_dwordx4 v18, s[12:15], s29 offen offset:3072 lds
    v_smfmac_f32_16x16x64_bf16 a[232:235], v[244:247], v[196:203], v248
    s_waitcnt vmcnt(15) lgkmcnt(6)
    s_barrier
    s_add_u32 s29, s29, 16384
    v_readlane_b32 s52, v249, 2
    v_mfma_f32_16x16x32_bf16 v[156:159], a[160:163], v[68:71], v[108:111]
    v_exp_f32 v164, v164
    v_mfma_f32_16x16x32_bf16 v[156:159], a[164:167], v[72:75], v[156:159]
    ds_read_b64_tr_b16 a[192:193], v5 offset:24576
    v_cvt_pk_bf16_f32 v241, v162, v163
    v_mfma_f32_16x16x32_bf16 v[156:159], a[168:171], v[76:79], v[156:159]
    v_exp_f32 v165, v165
    v_mfma_f32_16x16x32_bf16 v[156:159], a[172:175], v[80:83], v[156:159]
    ds_read_b64_tr_b16 a[194:195], v5 offset:28672
    v_readlane_b32 s53, v249, 3
    v_mfma_f32_16x16x32_bf16 v[160:163], a[172:175], v[96:99], v[112:115]
    v_exp_f32 v166, v166
    v_mfma_f32_16x16x32_bf16 v[160:163], a[168:171], v[92:95], v[160:163]
    ds_read_b128 a[128:131], v1 offset:16384
    v_cvt_pk_bf16_f32 v218, v164, v165
    v_mfma_f32_16x16x32_bf16 v[160:163], a[164:167], v[88:91], v[160:163]
    v_exp_f32 v167, v167
    v_mfma_f32_16x16x32_bf16 v[160:163], a[160:163], v[84:87], v[160:163]
    ds_read_b64_tr_b16 a[196:197], v5 offset:49152
    v_readlane_b32 s54, v249, 4
    v_mfma_f32_16x16x32_bf16 a[96:99], a[208:211], v[180:183], a[96:99]
    v_exp_f32 v168, v168
    v_mfma_f32_16x16x32_bf16 a[96:99], a[212:215], v[184:187], a[96:99]
    ds_read_b64_tr_b16 a[198:199], v5 offset:53248
    v_cvt_pk_bf16_f32 v219, v166, v167
    v_mfma_f32_16x16x32_bf16 a[100:103], a[212:215], v[192:195], a[100:103]
    v_exp_f32 v169, v169
    v_mfma_f32_16x16x32_bf16 a[100:103], a[208:211], v[188:191], a[100:103]
    ds_read_b128 a[132:135], v2 offset:16384
    v_cvt_pk_bf16_f32 v226, v168, v169
    v_readlane_b32 s55, v249, 5
    v_mfma_f32_16x16x32_bf16 a[104:107], a[208:211], v[196:199], a[104:107]
    s_add_u32 m0, s34, 0
    v_exp_f32 v170, v170
    v_mfma_f32_16x16x32_bf16 a[104:107], a[212:215], v[200:203], a[104:107]
    buffer_load_dwordx4 v13, s[8:11], s28 offen offset:0 lds
    v_readlane_b32 s56, v249, 6
    v_mfma_f32_16x16x32_bf16 a[108:111], a[212:215], v[208:211], a[108:111]
    v_exp_f32 v171, v171
    v_mfma_f32_16x16x32_bf16 a[108:111], a[208:211], v[204:207], a[108:111]
    s_waitcnt lgkmcnt(6)
    v_readlane_b32 s57, v249, 7
    v_mfma_f32_16x16x32_bf16 v[164:167], a[176:179], v[36:39], v[100:103]
    v_exp_f32 v172, v172
    v_mfma_f32_16x16x32_bf16 v[164:167], a[180:183], v[40:43], v[164:167]
    ds_read_b64_tr_b16 a[200:201], v6 offset:24576
    v_cvt_pk_bf16_f32 v227, v170, v171
    v_mfma_f32_16x16x32_bf16 v[164:167], a[184:187], v[44:47], v[164:167]
    v_exp_f32 v173, v173
    v_mfma_f32_16x16x32_bf16 v[164:167], a[188:191], v[48:51], v[164:167]
    ds_read_b64_tr_b16 a[202:203], v6 offset:28672
    v_mfma_f32_16x16x32_bf16 v[168:171], a[188:191], v[64:67], v[104:107]
    v_exp_f32 v174, v174
    v_mfma_f32_16x16x32_bf16 v[168:171], a[184:187], v[60:63], v[168:171]
    ds_read_b128 a[136:139], v3 offset:16384
    v_cvt_pk_bf16_f32 v234, v172, v173
    v_mfma_f32_16x16x32_bf16 v[168:171], a[180:183], v[56:59], v[168:171]
    v_exp_f32 v175, v175
    v_mfma_f32_16x16x32_bf16 v[168:171], a[176:179], v[52:55], v[168:171]
    ds_read_b64_tr_b16 a[204:205], v6 offset:49152
    ds_read_b64_tr_b16 v[24:25], v22 offset:0
    v_mfma_f32_16x16x32_bf16 a[112:115], a[216:219], v[180:183], a[112:115]
    v_exp_f32 v176, v176
    v_mfma_f32_16x16x32_bf16 a[112:115], a[220:223], v[184:187], a[112:115]
    ds_read_b64_tr_b16 a[206:207], v6 offset:53248
    v_cvt_pk_bf16_f32 v235, v174, v175
    v_mfma_f32_16x16x32_bf16 a[116:119], a[220:223], v[192:195], a[116:119]
    v_exp_f32 v177, v177
    v_mfma_f32_16x16x32_bf16 a[116:119], a[216:219], v[188:191], a[116:119]
    ds_read_b128 a[140:143], v4 offset:16384
    ds_read_b64_tr_b16 v[26:27], v22 offset:64
    v_mfma_f32_16x16x32_bf16 a[120:123], a[216:219], v[196:199], a[120:123]
    v_exp_f32 v178, v178
    v_mfma_f32_16x16x32_bf16 a[120:123], a[220:223], v[200:203], a[120:123]
    ds_read_b64_tr_b16 v[28:29], v22 offset:512
    v_cvt_pk_bf16_f32 v242, v176, v177
    v_mfma_f32_16x16x32_bf16 a[124:127], a[220:223], v[208:211], a[124:127]
    v_exp_f32 v179, v179
    v_mfma_f32_16x16x32_bf16 a[124:127], a[216:219], v[204:207], a[124:127]
    buffer_load_dwordx4 v14, s[8:11], s28 offen offset:1024 lds
    v_smfmac_f32_16x16x64_bf16 a[236:239], v[244:247], v[204:211], v248
    s_waitcnt lgkmcnt(6)
    ds_read_b64_tr_b16 v[30:31], v22 offset:576
    v_mfma_f32_16x16x32_bf16 v[172:175], a[176:179], v[68:71], v[108:111]
    v_exp_f32 v116, v116
    v_mfma_f32_16x16x32_bf16 v[172:175], a[180:183], v[72:75], v[172:175]
    ds_read_b64_tr_b16 a[208:209], v7 offset:24576
    v_cvt_pk_bf16_f32 v243, v178, v179
    v_mfma_f32_16x16x32_bf16 v[172:175], a[184:187], v[76:79], v[172:175]
    v_exp_f32 v117, v117
    v_mfma_f32_16x16x32_bf16 v[172:175], a[188:191], v[80:83], v[172:175]
    ds_read_b64_tr_b16 a[210:211], v7 offset:28672
    v_mfma_f32_16x16x32_bf16 v[176:179], a[188:191], v[96:99], v[112:115]
    v_exp_f32 v118, v118
    v_mfma_f32_16x16x32_bf16 v[176:179], a[184:187], v[92:95], v[176:179]
    ds_read_b128 a[144:147], v1 offset:20480
    v_cvt_pk_bf16_f32 v180, v116, v117
    v_mfma_f32_16x16x32_bf16 v[176:179], a[180:183], v[88:91], v[176:179]
    v_exp_f32 v119, v119
    v_mfma_f32_16x16x32_bf16 v[176:179], a[176:179], v[84:87], v[176:179]
    ds_read_b64_tr_b16 a[212:213], v7 offset:49152
    v_mfma_f32_16x16x32_bf16 a[0:3], a[192:195], v[212:215], a[0:3]
    v_exp_f32 v120, v120
    v_mfma_f32_16x16x32_bf16 a[0:3], a[196:199], v[216:219], a[0:3]
    ds_read_b64_tr_b16 a[214:215], v7 offset:53248
    v_cvt_pk_bf16_f32 v181, v118, v119
    v_mfma_f32_16x16x32_bf16 a[4:7], a[196:199], v[224:227], a[4:7]
    v_exp_f32 v121, v121
    v_mfma_f32_16x16x32_bf16 a[4:7], a[192:195], v[220:223], a[4:7]
    ds_read_b128 a[148:151], v2 offset:20480
    v_cvt_pk_bf16_f32 v188, v120, v121
    v_mfma_f32_16x16x32_bf16 a[8:11], a[192:195], v[228:231], a[8:11]
    v_exp_f32 v122, v122
    v_mfma_f32_16x16x32_bf16 a[8:11], a[196:199], v[232:235], a[8:11]
    buffer_load_dwordx4 v15, s[8:11], s28 offen offset:2048 lds
    v_mfma_f32_16x16x32_bf16 a[12:15], a[196:199], v[240:243], a[12:15]
    v_exp_f32 v123, v123
    v_mfma_f32_16x16x32_bf16 a[12:15], a[192:195], v[236:239], a[12:15]
    s_waitcnt lgkmcnt(6)
    v_mfma_f32_16x16x32_bf16 v[116:119], a[128:131], v[36:39], v[100:103]
    s_waitcnt vmcnt(5)
    v_exp_f32 v124, v124
    v_mfma_f32_16x16x32_bf16 v[32:35], v[24:27], a[240:243], 0
    v_mfma_f32_16x16x32_bf16 v[32:35], v[28:31], a[244:247], v[32:35]
    ds_read_b64_tr_b16 v[24:25], v22 offset:1024
    v_mfma_f32_16x16x32_bf16 v[116:119], a[132:135], v[40:43], v[116:119]
    ds_read_b64_tr_b16 a[216:217], v8 offset:24576
    v_cvt_pk_bf16_f32 v189, v122, v123
    v_mfma_f32_16x16x32_bf16 v[116:119], a[136:139], v[44:47], v[116:119]
    v_exp_f32 v125, v125
    v_mfma_f32_16x16x32_bf16 v[116:119], a[140:143], v[48:51], v[116:119]
    ds_read_b64_tr_b16 a[218:219], v8 offset:28672
    v_mfma_f32_16x16x32_bf16 v[120:123], a[140:143], v[64:67], v[104:107]
    v_exp_f32 v126, v126
    v_mfma_f32_16x16x32_bf16 v[120:123], a[136:139], v[60:63], v[120:123]
    ds_read_b128 a[152:155], v3 offset:20480
    v_cvt_pk_bf16_f32 v196, v124, v125
    v_mfma_f32_16x16x32_bf16 v[120:123], a[132:135], v[56:59], v[120:123]
    v_exp_f32 v127, v127
    v_mfma_f32_16x16x32_bf16 v[120:123], a[128:131], v[52:55], v[120:123]
    ds_read_b64_tr_b16 a[220:221], v8 offset:49152
    v_mfma_f32_16x16x32_bf16 a[16:19], a[200:203], v[212:215], a[16:19]
    v_exp_f32 v128, v128
    v_mfma_f32_16x16x32_bf16 a[16:19], a[204:207], v[216:219], a[16:19]
    ds_read_b64_tr_b16 a[222:223], v8 offset:53248
    v_cvt_pk_bf16_f32 v197, v126, v127
    v_mfma_f32_16x16x32_bf16 a[20:23], a[204:207], v[224:227], a[20:23]
    v_exp_f32 v129, v129
    v_mfma_f32_16x16x32_bf16 a[20:23], a[200:203], v[220:223], a[20:23]
    ds_read_b128 a[156:159], v4 offset:20480
    v_mfma_f32_16x16x32_bf16 a[24:27], a[200:203], v[228:231], a[24:27]
    v_exp_f32 v130, v130
    v_mfma_f32_16x16x32_bf16 a[24:27], a[204:207], v[232:235], a[24:27]
    ds_read_b64_tr_b16 v[26:27], v22 offset:1088
    v_cvt_pk_bf16_f32 v204, v128, v129
    v_mfma_f32_16x16x32_bf16 a[28:31], a[204:207], v[240:243], a[28:31]
    v_exp_f32 v131, v131
    v_mfma_f32_16x16x32_bf16 a[28:31], a[200:203], v[236:239], a[28:31]
    buffer_load_dwordx4 v16, s[8:11], s28 offen offset:3072 lds
    v_smfmac_f32_16x16x64_bf16 a[224:227], v[244:247], v[212:219], v248
    s_waitcnt lgkmcnt(6)
    ds_read_b64_tr_b16 v[28:29], v22 offset:1536
    ds_read_b64_tr_b16 v[30:31], v22 offset:1600
    v_mfma_f32_16x16x32_bf16 v[124:127], a[128:131], v[68:71], v[108:111]
    s_mul_i32 s40, s5, 2560
    v_exp_f32 v132, v132
    v_mfma_f32_16x16x32_bf16 v[124:127], a[132:135], v[72:75], v[124:127]
    ds_read_b64_tr_b16 a[192:193], v9 offset:24576
    v_cvt_pk_bf16_f32 v205, v130, v131
    v_mfma_f32_16x16x32_bf16 v[124:127], a[136:139], v[76:79], v[124:127]
    v_exp_f32 v133, v133
    v_add_u32 v0, s40, v23
    v_mfma_f32_16x16x32_bf16 v[124:127], a[140:143], v[80:83], v[124:127]
    s_nop 0
    ds_read_b64_tr_b16 a[194:195], v9 offset:28672
    v_mfma_f32_16x16x32_bf16 v[128:131], a[140:143], v[96:99], v[112:115]
    s_nop 0
    v_exp_f32 v134, v134
    v_mfma_f32_16x16x32_bf16 v[128:131], a[136:139], v[92:95], v[128:131]
    s_nop 0
    ds_read_b128 a[160:163], v1 offset:24576
    v_cvt_pk_bf16_f32 v182, v132, v133
    v_mfma_f32_16x16x32_bf16 v[128:131], a[132:135], v[88:91], v[128:131]
    s_nop 0
    v_exp_f32 v135, v135
    v_mfma_f32_16x16x32_bf16 v[128:131], a[128:131], v[84:87], v[128:131]
    s_nop 0
    ds_read_b64_tr_b16 a[196:197], v9 offset:49152
    v_mfma_f32_16x16x32_bf16 a[32:35], a[208:211], v[212:215], a[32:35]
    s_nop 0
    v_exp_f32 v136, v136
    v_mfma_f32_16x16x32_bf16 a[32:35], a[212:215], v[216:219], a[32:35]
    s_waitcnt lgkmcnt(4)
    ds_read_b64_tr_b16 a[198:199], v9 offset:53248
    v_cvt_pk_bf16_f32 v183, v134, v135
    v_mfma_f32_16x16x32_bf16 v[32:35], v[24:27], a[248:251], v[32:35]
    v_mfma_f32_16x16x32_bf16 v[32:35], v[28:31], a[252:255], v[32:35]
    ds_read_b64_tr_b16 v[24:25], v22 offset:2048
    v_mfma_f32_16x16x32_bf16 a[36:39], a[212:215], v[224:227], a[36:39]
    v_exp_f32 v137, v137
    v_mfma_f32_16x16x32_bf16 a[36:39], a[208:211], v[220:223], a[36:39]
    ds_read_b128 a[164:167], v2 offset:24576
    v_cvt_pk_bf16_f32 v190, v136, v137
    v_mfma_f32_16x16x32_bf16 a[40:43], a[208:211], v[228:231], a[40:43]
    s_add_u32 s28, s28, 16384
    s_mov_b32 m0, s31
    v_exp_f32 v138, v138
    v_mfma_f32_16x16x32_bf16 a[40:43], a[212:215], v[232:235], a[40:43]
    buffer_load_dwordx4 v17, s[12:15], s29 offen offset:0 lds
    v_mfma_f32_16x16x32_bf16 a[44:47], a[212:215], v[240:243], a[44:47]
    v_exp_f32 v139, v139
    v_mfma_f32_16x16x32_bf16 a[44:47], a[208:211], v[236:239], a[44:47]
    s_waitcnt lgkmcnt(6)
    ds_read_b64_tr_b16 v[26:27], v22 offset:2112
    v_mfma_f32_16x16x32_bf16 v[132:135], a[144:147], v[36:39], v[100:103]
    s_nop 0
    v_exp_f32 v140, v140
    v_mfma_f32_16x16x32_bf16 v[132:135], a[148:151], v[40:43], v[132:135]
    s_nop 0
    ds_read_b64_tr_b16 a[200:201], v10 offset:24576
    v_cvt_pk_bf16_f32 v191, v138, v139
    v_mfma_f32_16x16x32_bf16 v[132:135], a[152:155], v[44:47], v[132:135]
    s_nop 0
    v_exp_f32 v141, v141
    v_mfma_f32_16x16x32_bf16 v[132:135], a[156:159], v[48:51], v[132:135]
    s_nop 0
    ds_read_b64_tr_b16 a[202:203], v10 offset:28672
    v_mfma_f32_16x16x32_bf16 v[136:139], a[156:159], v[64:67], v[104:107]
    s_nop 0
    v_exp_f32 v142, v142
    v_mfma_f32_16x16x32_bf16 v[136:139], a[152:155], v[60:63], v[136:139]
    s_nop 0
    ds_read_b128 a[168:171], v3 offset:24576
    v_cvt_pk_bf16_f32 v198, v140, v141
    v_mfma_f32_16x16x32_bf16 v[136:139], a[148:151], v[56:59], v[136:139]
    s_nop 0
    v_exp_f32 v143, v143
    v_mfma_f32_16x16x32_bf16 v[136:139], a[144:147], v[52:55], v[136:139]
    s_nop 0
    ds_read_b64_tr_b16 a[204:205], v10 offset:49152
    v_mfma_f32_16x16x32_bf16 a[48:51], a[216:219], v[212:215], a[48:51]
    s_waitcnt lgkmcnt(4)
    v_exp_f32 v144, v144
    v_mfma_f32_16x16x32_bf16 v[32:35], v[24:27], v[252:255], v[32:35]
    v_mfma_f32_16x16x32_bf16 a[48:51], a[220:223], v[216:219], a[48:51]
    ds_read_b64_tr_b16 a[206:207], v10 offset:53248
    v_cvt_pk_bf16_f32 v199, v142, v143
    v_mfma_f32_16x16x32_bf16 a[52:55], a[220:223], v[224:227], a[52:55]
    v_exp_f32 v145, v145
    v_mfma_f32_16x16x32_bf16 a[52:55], a[216:219], v[220:223], a[52:55]
    ds_read_b128 a[172:175], v4 offset:24576
    v_mfma_f32_16x16x32_bf16 a[56:59], a[216:219], v[228:231], a[56:59]
    v_exp_f32 v146, v146
    v_mfma_f32_16x16x32_bf16 a[56:59], a[220:223], v[232:235], a[56:59]
    v_cvt_pk_bf16_f32 v206, v144, v145
    v_mfma_f32_16x16x32_bf16 a[60:63], a[220:223], v[240:243], a[60:63]
    v_exp_f32 v147, v147
    v_mfma_f32_16x16x32_bf16 a[60:63], a[216:219], v[236:239], a[60:63]
    buffer_load_dwordx4 v18, s[12:15], s29 offen offset:1024 lds
    v_smfmac_f32_16x16x64_bf16 a[228:231], v[244:247], v[220:227], v248
    s_waitcnt lgkmcnt(6)
    v_mfma_f32_16x16x32_bf16 v[140:143], a[144:147], v[68:71], v[108:111]
    s_nop 0
    v_exp_f32 v148, v148
    v_mfma_f32_16x16x32_bf16 v[140:143], a[148:151], v[72:75], v[140:143]
    s_nop 0
    ds_read_b64_tr_b16 a[208:209], v11 offset:24576
    v_cvt_pk_bf16_f32 v207, v146, v147
    v_mfma_f32_16x16x32_bf16 v[140:143], a[152:155], v[76:79], v[140:143]
    s_nop 0
    v_exp_f32 v149, v149
    v_mfma_f32_16x16x32_bf16 v[140:143], a[156:159], v[80:83], v[140:143]
    ds_read_b64_tr_b16 a[210:211], v11 offset:28672
    v_mfma_f32_16x16x32_bf16 v[144:147], a[156:159], v[96:99], v[112:115]
    v_exp_f32 v150, v150
    v_mfma_f32_16x16x32_bf16 v[144:147], a[152:155], v[92:95], v[144:147]
    ds_read_b128 a[176:179], v1 offset:28672
    v_cvt_pk_bf16_f32 v184, v148, v149
    v_mfma_f32_16x16x32_bf16 v[144:147], a[148:151], v[88:91], v[144:147]
    v_exp_f32 v151, v151
    v_mfma_f32_16x16x32_bf16 v[144:147], a[144:147], v[84:87], v[144:147]
    ds_read_b64_tr_b16 a[212:213], v11 offset:49152
    ds_write_b128 v0, v[32:35]
    v_bfe_u32 v22, v19, 2, 3
    v_mfma_f32_16x16x32_bf16 a[64:67], a[192:195], v[212:215], a[64:67]
    v_exp_f32 v152, v152
    v_mul_u32_u24 v22, 160, v22
    v_mfma_f32_16x16x32_bf16 a[64:67], a[196:199], v[216:219], a[64:67]
    ds_read_b64_tr_b16 a[214:215], v11 offset:53248
    v_cvt_pk_bf16_f32 v185, v150, v151
    v_mfma_f32_16x16x32_bf16 a[68:71], a[196:199], v[224:227], a[68:71]
    v_exp_f32 v153, v153
    v_and_b32 v28, 3, v19
    v_mfma_f32_16x16x32_bf16 a[68:71], a[192:195], v[220:223], a[68:71]
    ds_read_b128 a[180:183], v2 offset:28672
    v_cvt_pk_bf16_f32 v192, v152, v153
    v_add_u32 v22, v22, v28
    v_mfma_f32_16x16x32_bf16 a[72:75], a[192:195], v[228:231], a[72:75]
    s_mul_i32 s42, s5, 320
    v_exp_f32 v154, v154
    v_mfma_f32_16x16x32_bf16 a[72:75], a[196:199], v[232:235], a[72:75]
    s_add_u32 s42, s42, 86016
    buffer_load_dwordx4 v17, s[12:15], s29 offen offset:2048 lds
    v_mfma_f32_16x16x32_bf16 a[76:79], a[196:199], v[240:243], a[76:79]
    v_exp_f32 v155, v155
    v_mfma_f32_16x16x32_bf16 a[76:79], a[192:195], v[236:239], a[76:79]
    s_waitcnt lgkmcnt(6)
    v_lshl_add_u32 v22, v22, 3, s42
    v_mfma_f32_16x16x32_bf16 v[148:151], a[160:163], v[36:39], v[100:103]
    v_exp_f32 v156, v156
    v_mfma_f32_16x16x32_bf16 v[148:151], a[164:167], v[40:43], v[148:151]
    ds_read_b64_tr_b16 a[216:217], v12 offset:24576
    v_cvt_pk_bf16_f32 v193, v154, v155
    v_mfma_f32_16x16x32_bf16 v[148:151], a[168:171], v[44:47], v[148:151]
    v_exp_f32 v157, v157
    v_mfma_f32_16x16x32_bf16 v[148:151], a[172:175], v[48:51], v[148:151]
    ds_read_b64_tr_b16 a[218:219], v12 offset:28672
    v_mfma_f32_16x16x32_bf16 v[152:155], a[172:175], v[64:67], v[104:107]
    v_exp_f32 v158, v158
    v_mfma_f32_16x16x32_bf16 v[152:155], a[168:171], v[60:63], v[152:155]
    ds_read_b128 a[184:187], v3 offset:28672
    v_cvt_pk_bf16_f32 v200, v156, v157
    v_mfma_f32_16x16x32_bf16 v[152:155], a[164:167], v[56:59], v[152:155]
    v_exp_f32 v159, v159
    v_mfma_f32_16x16x32_bf16 v[152:155], a[160:163], v[52:55], v[152:155]
    ds_read_b64_tr_b16 a[220:221], v12 offset:49152
    v_mfma_f32_16x16x32_bf16 a[80:83], a[200:203], v[212:215], a[80:83]
    v_exp_f32 v160, v160
    v_mfma_f32_16x16x32_bf16 a[80:83], a[204:207], v[216:219], a[80:83]
    ds_read_b64_tr_b16 a[222:223], v12 offset:53248
    v_cvt_pk_bf16_f32 v201, v158, v159
    v_mfma_f32_16x16x32_bf16 a[84:87], a[204:207], v[224:227], a[84:87]
    v_exp_f32 v161, v161
    v_mfma_f32_16x16x32_bf16 a[84:87], a[200:203], v[220:223], a[84:87]
    ds_read_b128 a[188:191], v4 offset:28672
    v_mfma_f32_16x16x32_bf16 a[88:91], a[200:203], v[228:231], a[88:91]
    v_exp_f32 v162, v162
    v_mfma_f32_16x16x32_bf16 a[88:91], a[204:207], v[232:235], a[88:91]
    v_cvt_pk_bf16_f32 v208, v160, v161
    v_mfma_f32_16x16x32_bf16 a[92:95], a[204:207], v[240:243], a[92:95]
    v_exp_f32 v163, v163
    v_mfma_f32_16x16x32_bf16 a[92:95], a[200:203], v[236:239], a[92:95]
    buffer_load_dwordx4 v18, s[12:15], s29 offen offset:3072 lds
    v_smfmac_f32_16x16x64_bf16 a[232:235], v[244:247], v[228:235], v248
    s_waitcnt vmcnt(8) lgkmcnt(6)
    s_barrier
    s_add_u32 s29, s29, 16384
    v_mfma_f32_16x16x32_bf16 v[156:159], a[160:163], v[68:71], v[108:111]
    v_exp_f32 v164, v164
    v_mfma_f32_16x16x32_bf16 v[156:159], a[164:167], v[72:75], v[156:159]
    ds_read_b64_tr_b16 a[192:193], v5 offset:8192
    v_cvt_pk_bf16_f32 v209, v162, v163
    v_mfma_f32_16x16x32_bf16 v[156:159], a[168:171], v[76:79], v[156:159]
    v_exp_f32 v165, v165
    v_mfma_f32_16x16x32_bf16 v[156:159], a[172:175], v[80:83], v[156:159]
    ds_read_b64_tr_b16 a[194:195], v5 offset:12288
    ds_read_b128 v[24:27], v23 offset:0
    v_mfma_f32_16x16x32_bf16 v[160:163], a[172:175], v[96:99], v[112:115]
    v_exp_f32 v166, v166
    v_mfma_f32_16x16x32_bf16 v[160:163], a[168:171], v[92:95], v[160:163]
    ds_read_b128 a[128:131], v1 offset:32768
    v_cvt_pk_bf16_f32 v186, v164, v165
    v_mfma_f32_16x16x32_bf16 v[160:163], a[164:167], v[88:91], v[160:163]
    v_exp_f32 v167, v167
    v_mfma_f32_16x16x32_bf16 v[160:163], a[160:163], v[84:87], v[160:163]
    ds_read_b64_tr_b16 a[196:197], v5 offset:32768
    ds_read_b128 v[28:31], v23 offset:2560
    v_mfma_f32_16x16x32_bf16 a[96:99], a[208:211], v[212:215], a[96:99]
    v_exp_f32 v168, v168
    v_mfma_f32_16x16x32_bf16 a[96:99], a[212:215], v[216:219], a[96:99]
    ds_read_b64_tr_b16 a[198:199], v5 offset:36864
    v_cvt_pk_bf16_f32 v187, v166, v167
    v_mfma_f32_16x16x32_bf16 a[100:103], a[212:215], v[224:227], a[100:103]
    v_exp_f32 v169, v169
    v_mfma_f32_16x16x32_bf16 a[100:103], a[208:211], v[220:223], a[100:103]
    ds_read_b128 a[132:135], v2 offset:32768
    v_cvt_pk_bf16_f32 v194, v168, v169
    v_mfma_f32_16x16x32_bf16 a[104:107], a[208:211], v[228:231], a[104:107]
    s_mov_b32 m0, s32
    v_exp_f32 v170, v170
    v_mfma_f32_16x16x32_bf16 a[104:107], a[212:215], v[232:235], a[104:107]
    buffer_load_dwordx4 v17, s[12:15], s29 offen offset:0 lds
    v_mfma_f32_16x16x32_bf16 a[108:111], a[212:215], v[240:243], a[108:111]
    v_exp_f32 v171, v171
    v_mfma_f32_16x16x32_bf16 a[108:111], a[208:211], v[236:239], a[108:111]
    s_waitcnt lgkmcnt(6)
    ds_read_b128 v[32:35], v23 offset:5120
    ds_read_b128 v[252:255], v23 offset:7680
    v_mfma_f32_16x16x32_bf16 v[164:167], a[176:179], v[36:39], v[100:103]
    v_exp_f32 v172, v172
    v_mfma_f32_16x16x32_bf16 v[164:167], a[180:183], v[40:43], v[164:167]
    ds_read_b64_tr_b16 a[200:201], v6 offset:8192
    v_cvt_pk_bf16_f32 v195, v170, v171
    v_mfma_f32_16x16x32_bf16 v[164:167], a[184:187], v[44:47], v[164:167]
    v_exp_f32 v173, v173
    v_mfma_f32_16x16x32_bf16 v[164:167], a[188:191], v[48:51], v[164:167]
    ds_read_b64_tr_b16 a[202:203], v6 offset:12288
    v_mfma_f32_16x16x32_bf16 v[168:171], a[188:191], v[64:67], v[104:107]
    v_exp_f32 v174, v174
    v_mfma_f32_16x16x32_bf16 v[168:171], a[184:187], v[60:63], v[168:171]
    ds_read_b128 a[136:139], v3 offset:32768
    v_cvt_pk_bf16_f32 v202, v172, v173
    v_mfma_f32_16x16x32_bf16 v[168:171], a[180:183], v[56:59], v[168:171]
    v_exp_f32 v175, v175
    v_mfma_f32_16x16x32_bf16 v[168:171], a[176:179], v[52:55], v[168:171]
    ds_read_b64_tr_b16 a[204:205], v6 offset:32768
    ds_read_b64_tr_b16 a[240:241], v22 offset:0
    v_mfma_f32_16x16x32_bf16 a[112:115], a[216:219], v[212:215], a[112:115]
    v_exp_f32 v176, v176
    v_mfma_f32_16x16x32_bf16 a[112:115], a[220:223], v[216:219], a[112:115]
    ds_read_b64_tr_b16 a[206:207], v6 offset:36864
    v_cvt_pk_bf16_f32 v203, v174, v175
    v_mfma_f32_16x16x32_bf16 a[116:119], a[220:223], v[224:227], a[116:119]
    v_exp_f32 v177, v177
    v_mfma_f32_16x16x32_bf16 a[116:119], a[216:219], v[220:223], a[116:119]
    ds_read_b128 a[140:143], v4 offset:32768
    ds_read_b64_tr_b16 a[242:243], v22 offset:32
    v_mfma_f32_16x16x32_bf16 a[120:123], a[216:219], v[228:231], a[120:123]
    v_exp_f32 v178, v178
    v_mfma_f32_16x16x32_bf16 a[120:123], a[220:223], v[232:235], a[120:123]
    ds_read_b64_tr_b16 a[244:245], v22 offset:64
    v_cvt_pk_bf16_f32 v210, v176, v177
    v_mfma_f32_16x16x32_bf16 a[124:127], a[220:223], v[240:243], a[124:127]
    v_exp_f32 v179, v179
    v_mfma_f32_16x16x32_bf16 a[124:127], a[216:219], v[236:239], a[124:127]
    buffer_load_dwordx4 v18, s[12:15], s29 offen offset:1024 lds
    v_smfmac_f32_16x16x64_bf16 a[236:239], v[244:247], v[236:243], v248
    s_waitcnt lgkmcnt(6)
    ds_read_b64_tr_b16 a[246:247], v22 offset:96
    v_mfma_f32_16x16x32_bf16 v[172:175], a[176:179], v[68:71], v[108:111]
    v_exp_f32 v116, v116
    v_mfma_f32_16x16x32_bf16 v[172:175], a[180:183], v[72:75], v[172:175]
    ds_read_b64_tr_b16 a[208:209], v7 offset:8192
    v_cvt_pk_bf16_f32 v211, v178, v179
    v_add_f32 v24, v24, v28
    v_mfma_f32_16x16x32_bf16 v[172:175], a[184:187], v[76:79], v[172:175]
    v_exp_f32 v117, v117
    v_add_f32 v25, v25, v29
    v_mfma_f32_16x16x32_bf16 v[172:175], a[188:191], v[80:83], v[172:175]
    ds_read_b64_tr_b16 a[210:211], v7 offset:12288
    v_add_f32 v26, v26, v30
    v_mfma_f32_16x16x32_bf16 v[176:179], a[188:191], v[96:99], v[112:115]
    v_exp_f32 v118, v118
    v_mfma_f32_16x16x32_bf16 v[176:179], a[184:187], v[92:95], v[176:179]
    ds_read_b128 a[144:147], v1 offset:36864
    v_cvt_pk_bf16_f32 v212, v116, v117
    v_add_f32 v27, v27, v31
    v_mfma_f32_16x16x32_bf16 v[176:179], a[180:183], v[88:91], v[176:179]
    v_exp_f32 v119, v119
    v_add_f32 v24, v24, v32
    v_mfma_f32_16x16x32_bf16 v[176:179], a[176:179], v[84:87], v[176:179]
    ds_read_b64_tr_b16 a[212:213], v7 offset:32768
    v_add_f32 v25, v25, v33
    v_mfma_f32_16x16x32_bf16 a[0:3], a[192:195], v[180:183], a[0:3]
    v_exp_f32 v120, v120
    v_mfma_f32_16x16x32_bf16 a[0:3], a[196:199], v[184:187], a[0:3]
    ds_read_b64_tr_b16 a[214:215], v7 offset:36864
    v_cvt_pk_bf16_f32 v213, v118, v119
    v_add_f32 v26, v26, v34
    v_mfma_f32_16x16x32_bf16 a[4:7], a[196:199], v[192:195], a[4:7]
    v_exp_f32 v121, v121
    v_add_f32 v27, v27, v35
    v_mfma_f32_16x16x32_bf16 a[4:7], a[192:195], v[188:191], a[4:7]
    ds_read_b128 a[148:151], v2 offset:36864
    v_cvt_pk_bf16_f32 v220, v120, v121
    v_add_f32 v24, v24, v252
    v_mfma_f32_16x16x32_bf16 a[8:11], a[192:195], v[196:199], a[8:11]
    v_exp_f32 v122, v122
    v_mfma_f32_16x16x32_bf16 a[8:11], a[196:199], v[200:203], a[8:11]
    buffer_load_dwordx4 v17, s[12:15], s29 offen offset:2048 lds
    v_add_f32 v25, v25, v253
    v_mfma_f32_16x16x32_bf16 a[12:15], a[196:199], v[208:211], a[12:15]
    v_exp_f32 v123, v123
    v_add_f32 v26, v26, v254
    v_mfma_f32_16x16x32_bf16 a[12:15], a[192:195], v[204:207], a[12:15]
    s_waitcnt lgkmcnt(6)
    ds_read_b64_tr_b16 a[248:249], v22 offset:128
    v_add_f32 v27, v27, v255
    v_mfma_f32_16x16x32_bf16 v[116:119], a[128:131], v[36:39], v[100:103]
    v_exp_f32 v124, v124
    v_mfma_f32_16x16x32_bf16 v[116:119], a[132:135], v[40:43], v[116:119]
    ds_read_b64_tr_b16 a[216:217], v8 offset:8192
    v_cvt_pk_bf16_f32 v221, v122, v123
    v_mov_b32_dpp v28, v24 row_newbcast:8 row_mask:0xf bank_mask:0xf
    v_mfma_f32_16x16x32_bf16 v[116:119], a[136:139], v[44:47], v[116:119]
    v_exp_f32 v125, v125
    v_mov_b32_dpp v29, v25 row_newbcast:8 row_mask:0xf bank_mask:0xf
    v_mfma_f32_16x16x32_bf16 v[116:119], a[140:143], v[48:51], v[116:119]
    ds_read_b64_tr_b16 a[218:219], v8 offset:12288
    v_mov_b32_dpp v30, v26 row_newbcast:8 row_mask:0xf bank_mask:0xf
    v_mfma_f32_16x16x32_bf16 v[120:123], a[140:143], v[64:67], v[104:107]
    v_exp_f32 v126, v126
    v_mfma_f32_16x16x32_bf16 v[120:123], a[136:139], v[60:63], v[120:123]
    ds_read_b128 a[152:155], v3 offset:36864
    v_cvt_pk_bf16_f32 v228, v124, v125
    v_mov_b32_dpp v31, v27 row_newbcast:8 row_mask:0xf bank_mask:0xf
    v_mfma_f32_16x16x32_bf16 v[120:123], a[132:135], v[56:59], v[120:123]
    v_exp_f32 v127, v127
    v_mfma_f32_16x16x32_bf16 v[120:123], a[128:131], v[52:55], v[120:123]
    ds_read_b64_tr_b16 a[220:221], v8 offset:32768
    v_fma_f32 v24, -v20, v28, v24
    v_mfma_f32_16x16x32_bf16 a[16:19], a[200:203], v[180:183], a[16:19]
    v_exp_f32 v128, v128
    v_fma_f32 v25, -v20, v29, v25
    v_mfma_f32_16x16x32_bf16 a[16:19], a[204:207], v[184:187], a[16:19]
    ds_read_b64_tr_b16 a[222:223], v8 offset:36864
    v_cvt_pk_bf16_f32 v229, v126, v127
    v_fma_f32 v26, -v20, v30, v26
    v_mfma_f32_16x16x32_bf16 a[20:23], a[204:207], v[192:195], a[20:23]
    v_exp_f32 v129, v129
    v_mfma_f32_16x16x32_bf16 a[20:23], a[200:203], v[188:191], a[20:23]
    ds_read_b128 a[156:159], v4 offset:36864
    v_fma_f32 v27, -v20, v31, v27
    v_mfma_f32_16x16x32_bf16 a[24:27], a[200:203], v[196:199], a[24:27]
    v_exp_f32 v130, v130
    v_mul_f32 v24, v24, v21
    v_mfma_f32_16x16x32_bf16 a[24:27], a[204:207], v[200:203], a[24:27]
    v_cvt_pk_bf16_f32 v236, v128, v129
    v_mul_f32 v25, v25, v21
    v_mfma_f32_16x16x32_bf16 a[28:31], a[204:207], v[208:211], a[28:31]
    v_exp_f32 v131, v131
    v_mfma_f32_16x16x32_bf16 a[28:31], a[200:203], v[204:207], a[28:31]
    buffer_load_dwordx4 v18, s[12:15], s29 offen offset:3072 lds
    v_mul_f32 v26, v26, v21
    v_smfmac_f32_16x16x64_bf16 a[224:227], v[244:247], v[180:187], v248
    s_waitcnt lgkmcnt(6)
    s_add_u32 s29, s29, 16384
    ds_read_b64_tr_b16 a[250:251], v22 offset:160
    ds_read_b64_tr_b16 a[252:253], v22 offset:192
    ds_read_b64_tr_b16 a[254:255], v22 offset:224
    v_mul_f32 v27, v27, v21
    v_cvt_pk_bf16_f32 v28, v24, v25
    v_mfma_f32_16x16x32_bf16 v[124:127], a[128:131], v[68:71], v[108:111]
    v_exp_f32 v132, v132
    v_mfma_f32_16x16x32_bf16 v[124:127], a[132:135], v[72:75], v[124:127]
    ds_read_b64_tr_b16 a[192:193], v9 offset:8192
    v_cvt_pk_bf16_f32 v237, v130, v131
    v_mfma_f32_16x16x32_bf16 v[124:127], a[136:139], v[76:79], v[124:127]
    v_exp_f32 v133, v133
    v_cvt_pk_bf16_f32 v29, v26, v27
    v_mfma_f32_16x16x32_bf16 v[124:127], a[140:143], v[80:83], v[124:127]
    ds_read_b64_tr_b16 a[194:195], v9 offset:12288
    v_lshlrev_b32 v24, 16, v28
    v_mfma_f32_16x16x32_bf16 v[128:131], a[140:143], v[96:99], v[112:115]
    v_exp_f32 v134, v134
    v_mfma_f32_16x16x32_bf16 v[128:131], a[136:139], v[92:95], v[128:131]
    ds_read_b128 a[160:163], v1 offset:40960
    v_cvt_pk_bf16_f32 v214, v132, v133
    v_and_b32 v25, 0xffff0000, v28
    v_mfma_f32_16x16x32_bf16 v[128:131], a[132:135], v[88:91], v[128:131]
    v_exp_f32 v135, v135
    v_lshlrev_b32 v26, 16, v29
    v_mfma_f32_16x16x32_bf16 v[128:131], a[128:131], v[84:87], v[128:131]
    ds_read_b64_tr_b16 a[196:197], v9 offset:32768
    v_and_b32 v27, 0xffff0000, v29
    v_mfma_f32_16x16x32_bf16 a[32:35], a[208:211], v[180:183], a[32:35]
    v_exp_f32 v136, v136
    v_mfma_f32_16x16x32_bf16 a[32:35], a[212:215], v[184:187], a[32:35]
    ds_read_b64_tr_b16 a[198:199], v9 offset:36864
    v_cvt_pk_bf16_f32 v215, v134, v135
    v_mov_b32 v32, v24
    v_mfma_f32_16x16x32_bf16 a[36:39], a[212:215], v[192:195], a[36:39]
    v_exp_f32 v137, v137
    v_mov_b32 v33, v25
    v_mfma_f32_16x16x32_bf16 a[36:39], a[208:211], v[188:191], a[36:39]
    ds_read_b128 a[164:167], v2 offset:40960
    v_mov_b32 v34, v26
    v_mfma_f32_16x16x32_bf16 a[40:43], a[208:211], v[196:199], a[40:43]
    v_exp_f32 v138, v138
    v_mfma_f32_16x16x32_bf16 a[40:43], a[212:215], v[200:203], a[40:43]
    v_cvt_pk_bf16_f32 v222, v136, v137
    v_mov_b32 v35, v27
    v_mfma_f32_16x16x32_bf16 a[44:47], a[212:215], v[208:211], a[44:47]
    v_exp_f32 v139, v139
    v_permlane32_swap_b32 v24, v32
    v_mfma_f32_16x16x32_bf16 a[44:47], a[208:211], v[204:207], a[44:47]
    s_waitcnt lgkmcnt(6)
    v_permlane32_swap_b32 v25, v33
    v_mfma_f32_16x16x32_bf16 v[132:135], a[144:147], v[36:39], v[100:103]
    v_exp_f32 v140, v140
    v_mfma_f32_16x16x32_bf16 v[132:135], a[148:151], v[40:43], v[132:135]
    ds_read_b64_tr_b16 a[200:201], v10 offset:8192
    v_cvt_pk_bf16_f32 v223, v138, v139
    v_permlane32_swap_b32 v26, v34
    v_mfma_f32_16x16x32_bf16 v[132:135], a[152:155], v[44:47], v[132:135]
    v_exp_f32 v141, v141
    v_permlane32_swap_b32 v27, v35
    v_mfma_f32_16x16x32_bf16 v[132:135], a[156:159], v[48:51], v[132:135]
    ds_read_b64_tr_b16 a[202:203], v10 offset:12288
    v_mul_f32 v28, 0xbfb8aa3b, v24
    v_mfma_f32_16x16x32_bf16 v[136:139], a[156:159], v[64:67], v[104:107]
    v_exp_f32 v142, v142
    v_mfma_f32_16x16x32_bf16 v[136:139], a[152:155], v[60:63], v[136:139]
    ds_read_b128 a[168:171], v3 offset:40960
    v_cvt_pk_bf16_f32 v230, v140, v141
    v_mul_f32 v29, 0xbfb8aa3b, v25
    v_mfma_f32_16x16x32_bf16 v[136:139], a[148:151], v[56:59], v[136:139]
    v_exp_f32 v143, v143
    v_mfma_f32_16x16x32_bf16 v[136:139], a[144:147], v[52:55], v[136:139]
    ds_read_b64_tr_b16 a[204:205], v10 offset:32768
    v_mul_f32 v30, 0xbfb8aa3b, v26
    v_mfma_f32_16x16x32_bf16 a[48:51], a[216:219], v[180:183], a[48:51]
    v_exp_f32 v144, v144
    v_mul_f32 v31, 0xbfb8aa3b, v27
    v_mfma_f32_16x16x32_bf16 a[48:51], a[220:223], v[184:187], a[48:51]
    ds_read_b64_tr_b16 a[206:207], v10 offset:36864
    v_cvt_pk_bf16_f32 v231, v142, v143
    v_exp_f32 v28, v28
    v_mfma_f32_16x16x32_bf16 a[52:55], a[220:223], v[192:195], a[52:55]
    v_exp_f32 v145, v145
    v_mfma_f32_16x16x32_bf16 a[52:55], a[216:219], v[188:191], a[52:55]
    ds_read_b128 a[172:175], v4 offset:40960
    v_exp_f32 v29, v29
    v_mfma_f32_16x16x32_bf16 a[56:59], a[216:219], v[196:199], a[56:59]
    v_exp_f32 v146, v146
    v_exp_f32 v30, v30
    v_mfma_f32_16x16x32_bf16 a[56:59], a[220:223], v[200:203], a[56:59]
    v_cvt_pk_bf16_f32 v238, v144, v145
    v_mfma_f32_16x16x32_bf16 a[60:63], a[220:223], v[208:211], a[60:63]
    v_exp_f32 v147, v147
    v_exp_f32 v31, v31
    v_mfma_f32_16x16x32_bf16 a[60:63], a[216:219], v[204:207], a[60:63]
    v_add_f32 v28, 1.0, v28
    v_add_f32 v29, 1.0, v29
    v_smfmac_f32_16x16x64_bf16 a[228:231], v[244:247], v[188:195], v248
    s_waitcnt lgkmcnt(6)
    v_add_f32 v30, 1.0, v30
    v_add_f32 v31, 1.0, v31
    v_mfma_f32_16x16x32_bf16 v[140:143], a[144:147], v[68:71], v[108:111]
    v_exp_f32 v148, v148
    v_mfma_f32_16x16x32_bf16 v[140:143], a[148:151], v[72:75], v[140:143]
    ds_read_b64_tr_b16 a[208:209], v11 offset:8192
    v_cvt_pk_bf16_f32 v239, v146, v147
    v_mfma_f32_16x16x32_bf16 v[140:143], a[152:155], v[76:79], v[140:143]
    v_exp_f32 v149, v149
    v_mfma_f32_16x16x32_bf16 v[140:143], a[156:159], v[80:83], v[140:143]
    ds_read_b64_tr_b16 a[210:211], v11 offset:12288
    v_rcp_f32 v28, v28
    v_mfma_f32_16x16x32_bf16 v[144:147], a[156:159], v[96:99], v[112:115]
    v_exp_f32 v150, v150
    v_mfma_f32_16x16x32_bf16 v[144:147], a[152:155], v[92:95], v[144:147]
    ds_read_b128 a[176:179], v1 offset:45056
    v_cvt_pk_bf16_f32 v216, v148, v149
    v_rcp_f32 v29, v29
    v_mfma_f32_16x16x32_bf16 v[144:147], a[148:151], v[88:91], v[144:147]
    v_exp_f32 v151, v151
    v_rcp_f32 v30, v30
    v_mfma_f32_16x16x32_bf16 v[144:147], a[144:147], v[84:87], v[144:147]
    ds_read_b64_tr_b16 a[212:213], v11 offset:32768
    v_rcp_f32 v31, v31
    v_mfma_f32_16x16x32_bf16 a[64:67], a[192:195], v[180:183], a[64:67]
    v_exp_f32 v152, v152
    v_mfma_f32_16x16x32_bf16 a[64:67], a[196:199], v[184:187], a[64:67]
    ds_read_b64_tr_b16 a[214:215], v11 offset:36864
    v_cvt_pk_bf16_f32 v217, v150, v151
    v_mul_f32 v24, v24, v28
    v_mfma_f32_16x16x32_bf16 a[68:71], a[196:199], v[192:195], a[68:71]
    v_exp_f32 v153, v153
    v_mul_f32 v25, v25, v29
    v_mfma_f32_16x16x32_bf16 a[68:71], a[192:195], v[188:191], a[68:71]
    ds_read_b128 a[180:183], v2 offset:45056
    v_mul_f32 v26, v26, v30
    v_mfma_f32_16x16x32_bf16 a[72:75], a[192:195], v[196:199], a[72:75]
    v_exp_f32 v154, v154
    v_mfma_f32_16x16x32_bf16 a[72:75], a[196:199], v[200:203], a[72:75]
    v_cvt_pk_bf16_f32 v224, v152, v153
    v_mul_f32 v27, v27, v31
    v_mfma_f32_16x16x32_bf16 a[76:79], a[196:199], v[208:211], a[76:79]
    v_exp_f32 v155, v155
    v_cvt_pk_bf16_f32 v28, v24, v25
    v_mfma_f32_16x16x32_bf16 a[76:79], a[192:195], v[204:207], a[76:79]
    s_waitcnt lgkmcnt(6)
    v_cvt_pk_bf16_f32 v29, v26, v27
    v_lshlrev_b32 v24, 16, v28
    v_mfma_f32_16x16x32_bf16 v[148:151], a[160:163], v[36:39], v[100:103]
    v_exp_f32 v156, v156
    v_mfma_f32_16x16x32_bf16 v[148:151], a[164:167], v[40:43], v[148:151]
    ds_read_b64_tr_b16 a[216:217], v12 offset:8192
    v_cvt_pk_bf16_f32 v225, v154, v155
    v_mfma_f32_16x16x32_bf16 v[148:151], a[168:171], v[44:47], v[148:151]
    v_exp_f32 v157, v157
    v_and_b32 v25, 0xffff0000, v28
    v_mfma_f32_16x16x32_bf16 v[148:151], a[172:175], v[48:51], v[148:151]
    ds_read_b64_tr_b16 a[218:219], v12 offset:12288
    v_lshlrev_b32 v26, 16, v29
    v_mfma_f32_16x16x32_bf16 v[152:155], a[172:175], v[64:67], v[104:107]
    v_exp_f32 v158, v158
    v_mfma_f32_16x16x32_bf16 v[152:155], a[168:171], v[60:63], v[152:155]
    ds_read_b128 a[184:187], v3 offset:45056
    v_cvt_pk_bf16_f32 v232, v156, v157
    v_and_b32 v27, 0xffff0000, v29
    v_mfma_f32_16x16x32_bf16 v[152:155], a[164:167], v[56:59], v[152:155]
    v_exp_f32 v159, v159
    v_mfma_f32_16x16x32_bf16 v[152:155], a[160:163], v[52:55], v[152:155]
    ds_read_b64_tr_b16 a[220:221], v12 offset:32768
    v_mul_f32 v24, v24, v32
    v_mfma_f32_16x16x32_bf16 a[80:83], a[200:203], v[180:183], a[80:83]
    v_exp_f32 v160, v160
    v_mul_f32 v25, v25, v33
    v_mfma_f32_16x16x32_bf16 a[80:83], a[204:207], v[184:187], a[80:83]
    ds_read_b64_tr_b16 a[222:223], v12 offset:36864
    v_cvt_pk_bf16_f32 v233, v158, v159
    v_mul_f32 v26, v26, v34
    v_mfma_f32_16x16x32_bf16 a[84:87], a[204:207], v[192:195], a[84:87]
    v_exp_f32 v161, v161
    v_mfma_f32_16x16x32_bf16 a[84:87], a[200:203], v[188:191], a[84:87]
    ds_read_b128 a[188:191], v4 offset:45056
    v_mul_f32 v27, v27, v35
    v_mfma_f32_16x16x32_bf16 a[88:91], a[200:203], v[196:199], a[88:91]
    v_exp_f32 v162, v162
    v_cmp_gt_u32 vcc, 32, v19
    v_mfma_f32_16x16x32_bf16 a[88:91], a[204:207], v[200:203], a[88:91]
    v_cvt_pk_bf16_f32 v240, v160, v161
    v_cvt_pk_bf16_f32 v252, v24, v25
    v_mfma_f32_16x16x32_bf16 a[92:95], a[204:207], v[208:211], a[92:95]
    v_exp_f32 v163, v163
    v_mfma_f32_16x16x32_bf16 a[92:95], a[200:203], v[204:207], a[92:95]
    v_cvt_pk_bf16_f32 v253, v26, v27
    v_cndmask_b32 v252, 0, v252, vcc
    v_smfmac_f32_16x16x64_bf16 a[232:235], v[244:247], v[196:203], v248
    s_waitcnt vmcnt(4) lgkmcnt(0)
    s_barrier
    v_cndmask_b32 v253, 0, v253, vcc
    v_and_b32 v23, 7, v19
    v_mfma_f32_16x16x32_bf16 v[156:159], a[160:163], v[68:71], v[108:111]
    v_exp_f32 v164, v164
    v_mfma_f32_16x16x32_bf16 v[156:159], a[164:167], v[72:75], v[156:159]
    ds_read_b64_tr_b16 a[192:193], v5 offset:16384
    v_cvt_pk_bf16_f32 v241, v162, v163
    v_mfma_f32_16x16x32_bf16 v[156:159], a[168:171], v[76:79], v[156:159]
    v_exp_f32 v165, v165
    v_mfma_f32_16x16x32_bf16 v[156:159], a[172:175], v[80:83], v[156:159]
    ds_read_b64_tr_b16 a[194:195], v5 offset:20480
    v_mul_u32_u24 v23, 34560, v23
    v_mfma_f32_16x16x32_bf16 v[160:163], a[172:175], v[96:99], v[112:115]
    v_exp_f32 v166, v166
    v_mfma_f32_16x16x32_bf16 v[160:163], a[168:171], v[92:95], v[160:163]
    ds_read_b128 a[128:131], v1 offset:0
    v_cvt_pk_bf16_f32 v218, v164, v165
    v_lshrrev_b32 v0, 4, v19
    v_mfma_f32_16x16x32_bf16 v[160:163], a[164:167], v[88:91], v[160:163]
    v_exp_f32 v167, v167
    v_add_u32 v23, v23, v0
    v_mfma_f32_16x16x32_bf16 v[160:163], a[160:163], v[84:87], v[160:163]
    ds_read_b64_tr_b16 a[196:197], v5 offset:40960
    v_and_b32 v0, 8, v19
    v_mfma_f32_16x16x32_bf16 a[96:99], a[208:211], v[180:183], a[96:99]
    v_exp_f32 v168, v168
    v_mfma_f32_16x16x32_bf16 a[96:99], a[212:215], v[184:187], a[96:99]
    ds_read_b64_tr_b16 a[198:199], v5 offset:45056
    v_cvt_pk_bf16_f32 v219, v166, v167
    v_lshrrev_b32 v0, 1, v0
    v_mfma_f32_16x16x32_bf16 a[100:103], a[212:215], v[192:195], a[100:103]
    v_exp_f32 v169, v169
    v_add_lshl_u32 v23, v23, v0, 4
    v_mfma_f32_16x16x32_bf16 a[100:103], a[208:211], v[188:191], a[100:103]
    s_mul_i32 s42, s5, 1080
    ds_read_b128 a[132:135], v2 offset:0
    v_cvt_pk_bf16_f32 v226, v168, v169
    v_mfma_f32_16x16x32_bf16 a[104:107], a[208:211], v[196:199], a[104:107]
    s_mov_b32 m0, s33
    v_exp_f32 v170, v170
    v_mfma_f32_16x16x32_bf16 a[104:107], a[212:215], v[200:203], a[104:107]
    s_add_u32 s42, s42, s6
    buffer_load_dwordx4 v17, s[12:15], s29 offen offset:0 lds
    v_mfma_f32_16x16x32_bf16 a[108:111], a[212:215], v[208:211], a[108:111]
    s_lshl_b32 s42, s42, 7
    v_exp_f32 v171, v171
    v_mfma_f32_16x16x32_bf16 a[108:111], a[208:211], v[204:207], a[108:111]
    s_waitcnt lgkmcnt(6)
    s_cmp_lt_u32 s6, 216
    s_cselect_b32 s42, s42, 0x438000
    v_mfma_f32_16x16x32_bf16 v[164:167], a[176:179], v[36:39], v[100:103]
    v_exp_f32 v172, v172
    v_mfma_f32_16x16x16_bf16 v[24:27], a[240:241], v[252:253], 0
    v_mfma_f32_16x16x16_bf16 v[28:31], a[242:243], v[252:253], 0
    s_nop 0
    v_mfma_f32_16x16x32_bf16 v[164:167], a[180:183], v[40:43], v[164:167]
    s_nop 0
    ds_read_b64_tr_b16 a[200:201], v6 offset:16384
    v_cvt_pk_bf16_f32 v227, v170, v171
    v_mfma_f32_16x16x32_bf16 v[164:167], a[184:187], v[44:47], v[164:167]
    s_nop 0
    v_exp_f32 v173, v173
    v_mfma_f32_16x16x32_bf16 v[164:167], a[188:191], v[48:51], v[164:167]
    s_nop 0
    ds_read_b64_tr_b16 a[202:203], v6 offset:20480
    v_mov_b32_dpp v24, v28 row_shr:8 row_mask:0xf bank_mask:0xc
    v_mfma_f32_16x16x32_bf16 v[168:171], a[188:191], v[64:67], v[104:107]
    v_exp_f32 v174, v174
    v_mfma_f32_16x16x32_bf16 v[168:171], a[184:187], v[60:63], v[168:171]
    ds_read_b128 a[136:139], v3 offset:0
    v_cvt_pk_bf16_f32 v234, v172, v173
    v_mfma_f32_16x16x32_bf16 v[168:171], a[180:183], v[56:59], v[168:171]
    v_exp_f32 v175, v175
    v_mfma_f32_16x16x32_bf16 v[168:171], a[176:179], v[52:55], v[168:171]
    ds_read_b64_tr_b16 a[204:205], v6 offset:40960
    v_mov_b32_dpp v25, v29 row_shr:8 row_mask:0xf bank_mask:0xc
    v_mfma_f32_16x16x32_bf16 a[112:115], a[216:219], v[180:183], a[112:115]
    v_exp_f32 v176, v176
    v_mfma_f32_16x16x32_bf16 a[112:115], a[220:223], v[184:187], a[112:115]
    ds_read_b64_tr_b16 a[206:207], v6 offset:45056
    v_cvt_pk_bf16_f32 v235, v174, v175
    v_mfma_f32_16x16x32_bf16 a[116:119], a[220:223], v[192:195], a[116:119]
    v_exp_f32 v177, v177
    v_mov_b32_dpp v26, v30 row_shr:8 row_mask:0xf bank_mask:0xc
    v_mfma_f32_16x16x32_bf16 a[116:119], a[216:219], v[188:191], a[116:119]
    ds_read_b128 a[140:143], v4 offset:0
    v_mov_b32_dpp v27, v31 row_shr:8 row_mask:0xf bank_mask:0xc
    v_mfma_f32_16x16x32_bf16 a[120:123], a[216:219], v[196:199], a[120:123]
    v_exp_f32 v178, v178
    v_mfma_f32_16x16x32_bf16 a[120:123], a[220:223], v[200:203], a[120:123]
    buffer_store_dwordx4 v[24:27], v23, s[16:19], s42 offen sc1
    v_cvt_pk_bf16_f32 v242, v176, v177
    v_mfma_f32_16x16x32_bf16 a[124:127], a[220:223], v[208:211], a[124:127]
    s_add_u32 s42, s42, 27648
    v_exp_f32 v179, v179
    v_mfma_f32_16x16x32_bf16 a[124:127], a[216:219], v[204:207], a[124:127]
    buffer_load_dwordx4 v18, s[12:15], s29 offen offset:1024 lds
    v_smfmac_f32_16x16x64_bf16 a[236:239], v[244:247], v[204:211], v248
    s_waitcnt lgkmcnt(6)
    ds_read_b64_tr_b16 a[240:241], v22 offset:256
    ds_read_b64_tr_b16 a[242:243], v22 offset:288
    v_mfma_f32_16x16x32_bf16 v[172:175], a[176:179], v[68:71], v[108:111]
    v_exp_f32 v116, v116
    v_mfma_f32_16x16x16_bf16 v[32:35], a[244:245], v[252:253], 0
    v_mfma_f32_16x16x16_bf16 v[28:31], a[246:247], v[252:253], 0
    s_nop 0
    v_mfma_f32_16x16x32_bf16 v[172:175], a[180:183], v[72:75], v[172:175]
    s_nop 0
    ds_read_b64_tr_b16 a[208:209], v7 offset:16384
    v_cvt_pk_bf16_f32 v243, v178, v179
    v_mfma_f32_16x16x32_bf16 v[172:175], a[184:187], v[76:79], v[172:175]
    s_nop 0
    v_exp_f32 v117, v117
    v_mfma_f32_16x16x32_bf16 v[172:175], a[188:191], v[80:83], v[172:175]
    s_nop 0
    ds_read_b64_tr_b16 a[210:211], v7 offset:20480
    v_mov_b32_dpp v32, v28 row_shr:8 row_mask:0xf bank_mask:0xc
    v_mfma_f32_16x16x32_bf16 v[176:179], a[188:191], v[96:99], v[112:115]
    s_mul_i32 s46, s5, 10240
    v_exp_f32 v118, v118
    v_mfma_f32_16x16x32_bf16 v[176:179], a[184:187], v[92:95], v[176:179]
    s_mul_i32 s40, s100, 655360
    ds_read_b128 a[144:147], v1 offset:4096
    v_cvt_pk_bf16_f32 v180, v116, v117
    v_mfma_f32_16x16x32_bf16 v[176:179], a[180:183], v[88:91], v[176:179]
    s_add_u32 s40, s40, 0x1400000
    v_exp_f32 v119, v119
    v_mfma_f32_16x16x32_bf16 v[176:179], a[176:179], v[84:87], v[176:179]
    s_add_u32 s20, s72, s40
    s_addc_u32 s21, s73, 0
    ds_read_b64_tr_b16 a[212:213], v7 offset:40960
    v_mov_b32_dpp v33, v29 row_shr:8 row_mask:0xf bank_mask:0xc
    v_mfma_f32_16x16x32_bf16 a[0:3], a[192:195], v[212:215], a[0:3]
    s_mov_b32 s22, 0xa0000
    v_exp_f32 v120, v120
    v_mfma_f32_16x16x32_bf16 a[0:3], a[196:199], v[216:219], a[0:3]
    s_mov_b32 s23, 0x20000
    ds_read_b64_tr_b16 a[214:215], v7 offset:45056
    v_cvt_pk_bf16_f32 v181, v118, v119
    v_mfma_f32_16x16x32_bf16 a[4:7], a[196:199], v[224:227], a[4:7]
    s_mul_i32 s40, s5, 5120
    v_exp_f32 v121, v121
    v_mfma_f32_16x16x32_bf16 a[4:7], a[192:195], v[220:223], a[4:7]
    ds_read_b128 a[148:151], v2 offset:4096
    v_cvt_pk_bf16_f32 v188, v120, v121
    v_mov_b32_dpp v34, v30 row_shr:8 row_mask:0xf bank_mask:0xc
    v_mfma_f32_16x16x32_bf16 a[8:11], a[192:195], v[228:231], a[8:11]
    v_exp_f32 v122, v122
    v_mfma_f32_16x16x32_bf16 a[8:11], a[196:199], v[232:235], a[8:11]
    buffer_load_dwordx4 v17, s[12:15], s29 offen offset:2048 lds
    v_mov_b32_dpp v35, v31 row_shr:8 row_mask:0xf bank_mask:0xc
    v_mfma_f32_16x16x32_bf16 a[12:15], a[196:199], v[240:243], a[12:15]
    buffer_store_dwordx4 v[32:35], v23, s[16:19], s42 offen sc1
    v_exp_f32 v123, v123
    v_mfma_f32_16x16x32_bf16 a[12:15], a[192:195], v[236:239], a[12:15]
    s_waitcnt lgkmcnt(6)
    s_add_u32 s42, s42, 27648
    v_lshl_add_u32 v20, v19, 4, s40
    v_add_u32 v21, 4096, v20
    v_mfma_f32_16x16x32_bf16 v[116:119], a[128:131], v[36:39], v[100:103]
    v_exp_f32 v124, v124
    v_mfma_f32_16x16x16_bf16 v[24:27], a[248:249], v[252:253], 0
    v_mfma_f32_16x16x16_bf16 v[28:31], a[250:251], v[252:253], 0
    s_nop 0
    v_mfma_f32_16x16x32_bf16 v[116:119], a[132:135], v[40:43], v[116:119]
    s_nop 0
    ds_read_b64_tr_b16 a[216:217], v8 offset:16384
    v_cvt_pk_bf16_f32 v189, v122, v123
    v_mfma_f32_16x16x32_bf16 v[116:119], a[136:139], v[44:47], v[116:119]
    s_nop 0
    v_exp_f32 v125, v125
    v_mfma_f32_16x16x32_bf16 v[116:119], a[140:143], v[48:51], v[116:119]
    s_nop 0
    ds_read_b64_tr_b16 a[218:219], v8 offset:20480
    v_mov_b32_dpp v24, v28 row_shr:8 row_mask:0xf bank_mask:0xc
    v_mfma_f32_16x16x32_bf16 v[120:123], a[140:143], v[64:67], v[104:107]
    v_exp_f32 v126, v126
    v_mfma_f32_16x16x32_bf16 v[120:123], a[136:139], v[60:63], v[120:123]
    ds_read_b128 a[152:155], v3 offset:4096
    v_cvt_pk_bf16_f32 v196, v124, v125
    v_mfma_f32_16x16x32_bf16 v[120:123], a[132:135], v[56:59], v[120:123]
    v_exp_f32 v127, v127
    v_mfma_f32_16x16x32_bf16 v[120:123], a[128:131], v[52:55], v[120:123]
    ds_read_b64_tr_b16 a[220:221], v8 offset:40960
    v_mov_b32_dpp v25, v29 row_shr:8 row_mask:0xf bank_mask:0xc
    v_mfma_f32_16x16x32_bf16 a[16:19], a[200:203], v[212:215], a[16:19]
    v_exp_f32 v128, v128
    v_mfma_f32_16x16x32_bf16 a[16:19], a[204:207], v[216:219], a[16:19]
    ds_read_b64_tr_b16 a[222:223], v8 offset:45056
    v_cvt_pk_bf16_f32 v197, v126, v127
    v_mfma_f32_16x16x32_bf16 a[20:23], a[204:207], v[224:227], a[20:23]
    v_exp_f32 v129, v129
    v_mfma_f32_16x16x32_bf16 a[20:23], a[200:203], v[220:223], a[20:23]
    ds_read_b128 a[156:159], v4 offset:4096
    v_mov_b32_dpp v26, v30 row_shr:8 row_mask:0xf bank_mask:0xc
    v_mfma_f32_16x16x32_bf16 a[24:27], a[200:203], v[228:231], a[24:27]
    v_exp_f32 v130, v130
    v_mfma_f32_16x16x32_bf16 a[24:27], a[204:207], v[232:235], a[24:27]
    v_cvt_pk_bf16_f32 v204, v128, v129
    v_mov_b32_dpp v27, v31 row_shr:8 row_mask:0xf bank_mask:0xc
    v_mfma_f32_16x16x32_bf16 a[28:31], a[204:207], v[240:243], a[28:31]
    v_exp_f32 v131, v131
    v_mfma_f32_16x16x32_bf16 a[28:31], a[200:203], v[236:239], a[28:31]
    buffer_load_dwordx4 v18, s[12:15], s29 offen offset:3072 lds
    buffer_store_dwordx4 v[24:27], v23, s[16:19], s42 offen sc1
    v_smfmac_f32_16x16x64_bf16 a[224:227], v[244:247], v[212:219], v248
    s_waitcnt lgkmcnt(6)
    s_add_u32 s29, s29, 16384
    s_add_u32 s42, s42, 27648
    v_mfma_f32_16x16x32_bf16 v[124:127], a[128:131], v[68:71], v[108:111]
    v_exp_f32 v132, v132
    v_mfma_f32_16x16x16_bf16 v[32:35], a[252:253], v[252:253], 0
    v_mfma_f32_16x16x16_bf16 v[28:31], a[254:255], v[252:253], 0
    s_nop 0
    v_mfma_f32_16x16x32_bf16 v[124:127], a[132:135], v[72:75], v[124:127]
    s_nop 0
    ds_read_b64_tr_b16 a[192:193], v9 offset:16384
    v_cvt_pk_bf16_f32 v205, v130, v131
    v_mfma_f32_16x16x32_bf16 v[124:127], a[136:139], v[76:79], v[124:127]
    s_nop 0
    v_exp_f32 v133, v133
    v_mfma_f32_16x16x32_bf16 v[124:127], a[140:143], v[80:83], v[124:127]
    s_nop 0
    ds_read_b64_tr_b16 a[194:195], v9 offset:20480
    v_mov_b32_dpp v32, v28 row_shr:8 row_mask:0xf bank_mask:0xc
    v_mfma_f32_16x16x32_bf16 v[128:131], a[140:143], v[96:99], v[112:115]
    s_add_u32 m0, s46, 122880
    v_exp_f32 v134, v134
    v_mfma_f32_16x16x32_bf16 v[128:131], a[136:139], v[92:95], v[128:131]
    s_mov_b32 s45, 286720
    ds_read_b128 a[160:163], v1 offset:8192
    v_cvt_pk_bf16_f32 v182, v132, v133
    v_mfma_f32_16x16x32_bf16 v[128:131], a[132:135], v[88:91], v[128:131]
    v_exp_f32 v135, v135
    v_mfma_f32_16x16x32_bf16 v[128:131], a[128:131], v[84:87], v[128:131]
    ds_read_b64_tr_b16 a[196:197], v9 offset:40960
    v_mov_b32_dpp v33, v29 row_shr:8 row_mask:0xf bank_mask:0xc
    v_mfma_f32_16x16x32_bf16 a[32:35], a[208:211], v[212:215], a[32:35]
    v_exp_f32 v136, v136
    v_mfma_f32_16x16x32_bf16 a[32:35], a[212:215], v[216:219], a[32:35]
    ds_read_b64_tr_b16 a[198:199], v9 offset:45056
    v_cvt_pk_bf16_f32 v183, v134, v135
    v_mfma_f32_16x16x32_bf16 a[36:39], a[212:215], v[224:227], a[36:39]
    v_exp_f32 v137, v137
    v_mfma_f32_16x16x32_bf16 a[36:39], a[208:211], v[220:223], a[36:39]
    ds_read_b128 a[164:167], v2 offset:8192
    v_mov_b32_dpp v34, v30 row_shr:8 row_mask:0xf bank_mask:0xc
    v_mfma_f32_16x16x32_bf16 a[40:43], a[208:211], v[228:231], a[40:43]
    v_exp_f32 v138, v138
    v_mfma_f32_16x16x32_bf16 a[40:43], a[212:215], v[232:235], a[40:43]
    v_cvt_pk_bf16_f32 v190, v136, v137
    v_mov_b32_dpp v35, v31 row_shr:8 row_mask:0xf bank_mask:0xc
    v_mfma_f32_16x16x32_bf16 a[44:47], a[212:215], v[240:243], a[44:47]
    buffer_store_dwordx4 v[32:35], v23, s[16:19], s42 offen sc1
    v_exp_f32 v139, v139
    v_mfma_f32_16x16x32_bf16 a[44:47], a[208:211], v[236:239], a[44:47]
    s_waitcnt lgkmcnt(6)
    s_add_u32 s42, s42, 27648
    buffer_load_dwordx4 v20, s[20:23], s45 offen offset:0 sc1 lds
    v_mfma_f32_16x16x32_bf16 v[132:135], a[144:147], v[36:39], v[100:103]
    v_exp_f32 v140, v140
    v_mfma_f32_16x16x16_bf16 v[24:27], a[240:241], v[252:253], 0
    v_mfma_f32_16x16x16_bf16 v[28:31], a[242:243], v[252:253], 0
    s_nop 0
    buffer_load_dwordx4 v20, s[20:23], s45 offen offset:1024 sc1 lds
    v_mfma_f32_16x16x32_bf16 v[132:135], a[148:151], v[40:43], v[132:135]
    s_nop 0
    ds_read_b64_tr_b16 a[200:201], v10 offset:16384
    v_cvt_pk_bf16_f32 v191, v138, v139
    v_mfma_f32_16x16x32_bf16 v[132:135], a[152:155], v[44:47], v[132:135]
    s_nop 0
    v_exp_f32 v141, v141
    v_mfma_f32_16x16x32_bf16 v[132:135], a[156:159], v[48:51], v[132:135]
    s_nop 0
    ds_read_b64_tr_b16 a[202:203], v10 offset:20480
    v_mov_b32_dpp v24, v28 row_shr:8 row_mask:0xf bank_mask:0xc
    v_mfma_f32_16x16x32_bf16 v[136:139], a[156:159], v[64:67], v[104:107]
    v_exp_f32 v142, v142
    v_mfma_f32_16x16x32_bf16 v[136:139], a[152:155], v[60:63], v[136:139]
    ds_read_b128 a[168:171], v3 offset:8192
    v_cvt_pk_bf16_f32 v198, v140, v141
    v_mfma_f32_16x16x32_bf16 v[136:139], a[148:151], v[56:59], v[136:139]
    v_exp_f32 v143, v143
    v_mfma_f32_16x16x32_bf16 v[136:139], a[144:147], v[52:55], v[136:139]
    ds_read_b64_tr_b16 a[204:205], v10 offset:40960
    v_mov_b32_dpp v25, v29 row_shr:8 row_mask:0xf bank_mask:0xc
    v_mfma_f32_16x16x32_bf16 a[48:51], a[216:219], v[212:215], a[48:51]
    v_exp_f32 v144, v144
    v_mfma_f32_16x16x32_bf16 a[48:51], a[220:223], v[216:219], a[48:51]
    ds_read_b64_tr_b16 a[206:207], v10 offset:45056
    v_cvt_pk_bf16_f32 v199, v142, v143
    v_mfma_f32_16x16x32_bf16 a[52:55], a[220:223], v[224:227], a[52:55]
    v_exp_f32 v145, v145
    v_mfma_f32_16x16x32_bf16 a[52:55], a[216:219], v[220:223], a[52:55]
    ds_read_b128 a[172:175], v4 offset:8192
    v_mov_b32_dpp v26, v30 row_shr:8 row_mask:0xf bank_mask:0xc
    v_mfma_f32_16x16x32_bf16 a[56:59], a[216:219], v[228:231], a[56:59]
    v_exp_f32 v146, v146
    v_mfma_f32_16x16x32_bf16 a[56:59], a[220:223], v[232:235], a[56:59]
    v_cvt_pk_bf16_f32 v206, v144, v145
    v_mov_b32_dpp v27, v31 row_shr:8 row_mask:0xf bank_mask:0xc
    v_mfma_f32_16x16x32_bf16 a[60:63], a[220:223], v[240:243], a[60:63]
    buffer_load_dwordx4 v20, s[20:23], s45 offen offset:2048 sc1 lds
    v_exp_f32 v147, v147
    v_mfma_f32_16x16x32_bf16 a[60:63], a[216:219], v[236:239], a[60:63]
    buffer_store_dwordx4 v[24:27], v23, s[16:19], s42 offen sc1
    v_smfmac_f32_16x16x64_bf16 a[228:231], v[244:247], v[220:227], v248
    s_waitcnt lgkmcnt(6)
    s_add_u32 s42, s42, 27648
    buffer_load_dwordx4 v20, s[20:23], s45 offen offset:3072 sc1 lds
    v_mfma_f32_16x16x32_bf16 v[140:143], a[144:147], v[68:71], v[108:111]
    s_mov_b32 s101, 0
    v_exp_f32 v148, v148
    v_mfma_f32_16x16x32_bf16 v[140:143], a[148:151], v[72:75], v[140:143]
    s_not_b32 s40, s50
    ds_read_b64_tr_b16 a[208:209], v11 offset:16384
    v_cvt_pk_bf16_f32 v207, v146, v147
    v_mfma_f32_16x16x32_bf16 v[140:143], a[152:155], v[76:79], v[140:143]
    s_bfe_u32 s40, s40, 0x50006
    v_exp_f32 v149, v149
    v_mfma_f32_16x16x32_bf16 v[140:143], a[156:159], v[80:83], v[140:143]
    s_cmp_eq_u32 s40, s87
    s_cselect_b32 s40, 1, 0
    ds_read_b64_tr_b16 a[210:211], v11 offset:20480
    v_mfma_f32_16x16x32_bf16 v[144:147], a[156:159], v[96:99], v[112:115]
    s_lshl_b32 s40, s40, 0
    v_exp_f32 v150, v150
    v_mfma_f32_16x16x32_bf16 v[144:147], a[152:155], v[92:95], v[144:147]
    s_or_b32 s101, s101, s40
    ds_read_b128 a[176:179], v1 offset:12288
    v_cvt_pk_bf16_f32 v184, v148, v149
    v_mfma_f32_16x16x32_bf16 v[144:147], a[148:151], v[88:91], v[144:147]
    s_not_b32 s40, s51
    v_exp_f32 v151, v151
    v_mfma_f32_16x16x32_bf16 v[144:147], a[144:147], v[84:87], v[144:147]
    s_bfe_u32 s40, s40, 0x50006
    ds_read_b64_tr_b16 a[212:213], v11 offset:40960
    v_mfma_f32_16x16x32_bf16 a[64:67], a[192:195], v[212:215], a[64:67]
    s_cmp_eq_u32 s40, s87
    s_cselect_b32 s40, 1, 0
    v_exp_f32 v152, v152
    v_mfma_f32_16x16x32_bf16 a[64:67], a[196:199], v[216:219], a[64:67]
    s_lshl_b32 s40, s40, 1
    ds_read_b64_tr_b16 a[214:215], v11 offset:45056
    v_cvt_pk_bf16_f32 v185, v150, v151
    v_mfma_f32_16x16x32_bf16 a[68:71], a[196:199], v[224:227], a[68:71]
    s_or_b32 s101, s101, s40
    v_exp_f32 v153, v153
    v_mfma_f32_16x16x32_bf16 a[68:71], a[192:195], v[220:223], a[68:71]
    s_not_b32 s40, s52
    ds_read_b128 a[180:183], v2 offset:12288
    v_mfma_f32_16x16x32_bf16 a[72:75], a[192:195], v[228:231], a[72:75]
    s_bfe_u32 s40, s40, 0x50006
    v_exp_f32 v154, v154
    v_mfma_f32_16x16x32_bf16 a[72:75], a[196:199], v[232:235], a[72:75]
    s_cmp_eq_u32 s40, s87
    s_cselect_b32 s40, 1, 0
    v_cvt_pk_bf16_f32 v192, v152, v153
    v_mfma_f32_16x16x32_bf16 a[76:79], a[196:199], v[240:243], a[76:79]
    s_lshl_b32 s40, s40, 2
    v_exp_f32 v155, v155
    v_mfma_f32_16x16x32_bf16 a[76:79], a[192:195], v[236:239], a[76:79]
    s_waitcnt lgkmcnt(6)
    v_mfma_f32_16x16x32_bf16 v[148:151], a[160:163], v[36:39], v[100:103]
    s_or_b32 s101, s101, s40
    v_exp_f32 v156, v156
    v_mfma_f32_16x16x32_bf16 v[148:151], a[164:167], v[40:43], v[148:151]
    s_not_b32 s40, s53
    ds_read_b64_tr_b16 a[216:217], v12 offset:16384
    v_cvt_pk_bf16_f32 v193, v154, v155
    v_mfma_f32_16x16x32_bf16 v[148:151], a[168:171], v[44:47], v[148:151]
    s_bfe_u32 s40, s40, 0x50006
    v_exp_f32 v157, v157
    v_mfma_f32_16x16x32_bf16 v[148:151], a[172:175], v[48:51], v[148:151]
    s_cmp_eq_u32 s40, s87
    s_cselect_b32 s40, 1, 0
    ds_read_b64_tr_b16 a[218:219], v12 offset:20480
    v_mfma_f32_16x16x32_bf16 v[152:155], a[172:175], v[64:67], v[104:107]
    s_lshl_b32 s40, s40, 3
    v_exp_f32 v158, v158
    v_mfma_f32_16x16x32_bf16 v[152:155], a[168:171], v[60:63], v[152:155]
    s_or_b32 s101, s101, s40
    ds_read_b128 a[184:187], v3 offset:12288
    v_cvt_pk_bf16_f32 v200, v156, v157
    v_mfma_f32_16x16x32_bf16 v[152:155], a[164:167], v[56:59], v[152:155]
    s_not_b32 s40, s54
    v_exp_f32 v159, v159
    v_mfma_f32_16x16x32_bf16 v[152:155], a[160:163], v[52:55], v[152:155]
    s_bfe_u32 s40, s40, 0x50006
    ds_read_b64_tr_b16 a[220:221], v12 offset:40960
    v_mfma_f32_16x16x32_bf16 a[80:83], a[200:203], v[212:215], a[80:83]
    s_cmp_eq_u32 s40, s87
    s_cselect_b32 s40, 1, 0
    v_exp_f32 v160, v160
    v_mfma_f32_16x16x32_bf16 a[80:83], a[204:207], v[216:219], a[80:83]
    s_lshl_b32 s40, s40, 4
    ds_read_b64_tr_b16 a[222:223], v12 offset:45056
    v_cvt_pk_bf16_f32 v201, v158, v159
    v_mfma_f32_16x16x32_bf16 a[84:87], a[204:207], v[224:227], a[84:87]
    s_or_b32 s101, s101, s40
    v_exp_f32 v161, v161
    v_mfma_f32_16x16x32_bf16 a[84:87], a[200:203], v[220:223], a[84:87]
    s_not_b32 s40, s55
    ds_read_b128 a[188:191], v4 offset:12288
    v_mfma_f32_16x16x32_bf16 a[88:91], a[200:203], v[228:231], a[88:91]
    s_bfe_u32 s40, s40, 0x50006
    v_exp_f32 v162, v162
    v_mfma_f32_16x16x32_bf16 a[88:91], a[204:207], v[232:235], a[88:91]
    s_cmp_eq_u32 s40, s87
    s_cselect_b32 s40, 1, 0
    v_cvt_pk_bf16_f32 v208, v160, v161
    v_mfma_f32_16x16x32_bf16 a[92:95], a[204:207], v[240:243], a[92:95]
    s_lshl_b32 s40, s40, 5
    v_exp_f32 v163, v163
    v_mfma_f32_16x16x32_bf16 a[92:95], a[200:203], v[236:239], a[92:95]
    s_or_b32 s101, s101, s40
    v_smfmac_f32_16x16x64_bf16 a[232:235], v[244:247], v[228:235], v248
    s_waitcnt vmcnt(13) lgkmcnt(6)
    s_barrier
    v_mfma_f32_16x16x32_bf16 v[156:159], a[160:163], v[68:71], v[108:111]
    s_not_b32 s40, s56
    v_exp_f32 v164, v164
    v_mfma_f32_16x16x32_bf16 v[156:159], a[164:167], v[72:75], v[156:159]
    s_bfe_u32 s40, s40, 0x50006
    ds_read_b64_tr_b16 a[192:193], v5 offset:57344
    v_cvt_pk_bf16_f32 v209, v162, v163
    v_mfma_f32_16x16x32_bf16 v[156:159], a[168:171], v[76:79], v[156:159]
    s_cmp_eq_u32 s40, s87
    s_cselect_b32 s40, 1, 0
    v_exp_f32 v165, v165
    v_mfma_f32_16x16x32_bf16 v[156:159], a[172:175], v[80:83], v[156:159]
    s_lshl_b32 s40, s40, 6
    ds_read_b64_tr_b16 a[194:195], v5 offset:61440
    v_mfma_f32_16x16x32_bf16 v[160:163], a[172:175], v[96:99], v[112:115]
    s_or_b32 s101, s101, s40
    v_exp_f32 v166, v166
    v_mfma_f32_16x16x32_bf16 v[160:163], a[168:171], v[92:95], v[160:163]
    s_not_b32 s40, s57
    ds_read_b64_tr_b16 a[196:197], v5 offset:0
    v_cvt_pk_bf16_f32 v186, v164, v165
    v_mfma_f32_16x16x32_bf16 v[160:163], a[164:167], v[88:91], v[160:163]
    s_bfe_u32 s40, s40, 0x50006
    v_exp_f32 v167, v167
    v_mfma_f32_16x16x32_bf16 v[160:163], a[160:163], v[84:87], v[160:163]
    s_cmp_eq_u32 s40, s87
    s_cselect_b32 s40, 1, 0
    ds_read_b64_tr_b16 a[198:199], v5 offset:4096
    v_mfma_f32_16x16x32_bf16 a[96:99], a[208:211], v[212:215], a[96:99]
    s_lshl_b32 s40, s40, 7
    v_exp_f32 v168, v168
    v_mfma_f32_16x16x32_bf16 a[96:99], a[212:215], v[216:219], a[96:99]
    s_or_b32 s101, s101, s40
    v_cvt_pk_bf16_f32 v187, v166, v167
    v_mfma_f32_16x16x32_bf16 a[100:103], a[212:215], v[224:227], a[100:103]
    s_add_u32 m0, s46, 126976
    s_nop 0
    buffer_load_dwordx4 v21, s[20:23], s45 offen offset:0 sc1 lds
    v_exp_f32 v169, v169
    v_mfma_f32_16x16x32_bf16 a[100:103], a[208:211], v[220:223], a[100:103]
    s_add_u32 m0, s46, 128000
    v_mfma_f32_16x16x32_bf16 a[104:107], a[208:211], v[228:231], a[104:107]
    s_mov_b32 s45, 307200
    buffer_load_dwordx4 v20, s[20:23], s45 offen offset:0 sc1 lds
    buffer_load_dwordx4 v20, s[20:23], s45 offen offset:1024 sc1 lds
    v_exp_f32 v170, v170
    v_mfma_f32_16x16x32_bf16 a[104:107], a[212:215], v[232:235], a[104:107]
    buffer_load_dwordx4 v20, s[20:23], s45 offen offset:2048 sc1 lds
    v_cvt_pk_bf16_f32 v194, v168, v169
    v_mfma_f32_16x16x32_bf16 a[108:111], a[212:215], v[240:243], a[108:111]
    v_exp_f32 v171, v171
    v_mfma_f32_16x16x32_bf16 a[108:111], a[208:211], v[236:239], a[108:111]
    s_waitcnt lgkmcnt(4)
    buffer_load_dwordx4 v20, s[20:23], s45 offen offset:3072 sc1 lds
    v_mfma_f32_16x16x32_bf16 v[164:167], a[176:179], v[36:39], v[100:103]
    s_add_u32 m0, s46, 132096
    v_exp_f32 v172, v172
    v_mfma_f32_16x16x32_bf16 v[164:167], a[180:183], v[40:43], v[164:167]
    ds_read_b64_tr_b16 a[200:201], v6 offset:57344
    v_cvt_pk_bf16_f32 v195, v170, v171
    v_mfma_f32_16x16x32_bf16 v[164:167], a[184:187], v[44:47], v[164:167]
    v_exp_f32 v173, v173
    v_mfma_f32_16x16x32_bf16 v[164:167], a[188:191], v[48:51], v[164:167]
    ds_read_b64_tr_b16 a[202:203], v6 offset:61440
    v_mfma_f32_16x16x32_bf16 v[168:171], a[188:191], v[64:67], v[104:107]
    v_exp_f32 v174, v174
    v_mfma_f32_16x16x32_bf16 v[168:171], a[184:187], v[60:63], v[168:171]
    ds_read_b64_tr_b16 a[204:205], v6 offset:0
    v_cvt_pk_bf16_f32 v202, v172, v173
    v_mfma_f32_16x16x32_bf16 v[168:171], a[180:183], v[56:59], v[168:171]
    v_exp_f32 v175, v175
    v_mfma_f32_16x16x32_bf16 v[168:171], a[176:179], v[52:55], v[168:171]
    ds_read_b64_tr_b16 a[206:207], v6 offset:4096
    v_mfma_f32_16x16x32_bf16 a[112:115], a[216:219], v[212:215], a[112:115]
    v_exp_f32 v176, v176
    v_mfma_f32_16x16x32_bf16 a[112:115], a[220:223], v[216:219], a[112:115]
    v_cvt_pk_bf16_f32 v203, v174, v175
    v_mfma_f32_16x16x32_bf16 a[116:119], a[220:223], v[224:227], a[116:119]
    v_exp_f32 v177, v177
    v_mfma_f32_16x16x32_bf16 a[116:119], a[216:219], v[220:223], a[116:119]
    buffer_load_dwordx4 v21, s[20:23], s45 offen offset:0 sc1 lds
    v_mfma_f32_16x16x32_bf16 a[120:123], a[216:219], v[228:231], a[120:123]
    v_exp_f32 v178, v178
    v_mfma_f32_16x16x32_bf16 a[120:123], a[220:223], v[232:235], a[120:123]
    v_cvt_pk_bf16_f32 v210, v176, v177
    v_mfma_f32_16x16x32_bf16 a[124:127], a[220:223], v[240:243], a[124:127]
    v_exp_f32 v179, v179
    v_mfma_f32_16x16x32_bf16 a[124:127], a[216:219], v[236:239], a[124:127]
    v_smfmac_f32_16x16x64_bf16 a[236:239], v[244:247], v[236:243], v248
    s_waitcnt lgkmcnt(4)
    v_mfma_f32_16x16x32_bf16 v[172:175], a[176:179], v[68:71], v[108:111]
    v_exp_f32 v116, v116
    v_mfma_f32_16x16x32_bf16 v[172:175], a[180:183], v[72:75], v[172:175]
    ds_read_b64_tr_b16 a[208:209], v7 offset:57344
    v_cvt_pk_bf16_f32 v211, v178, v179
    v_mfma_f32_16x16x32_bf16 v[172:175], a[184:187], v[76:79], v[172:175]
    v_exp_f32 v117, v117
    v_mfma_f32_16x16x32_bf16 v[172:175], a[188:191], v[80:83], v[172:175]
    ds_read_b64_tr_b16 a[210:211], v7 offset:61440
    v_mfma_f32_16x16x32_bf16 v[176:179], a[188:191], v[96:99], v[112:115]
    v_exp_f32 v118, v118
    v_mfma_f32_16x16x32_bf16 v[176:179], a[184:187], v[92:95], v[176:179]
    ds_read_b64_tr_b16 a[212:213], v7 offset:0
    v_cvt_pk_bf16_f32 v212, v116, v117
    v_mfma_f32_16x16x32_bf16 v[176:179], a[180:183], v[88:91], v[176:179]
    v_exp_f32 v119, v119
    v_mfma_f32_16x16x32_bf16 v[176:179], a[176:179], v[84:87], v[176:179]
    ds_read_b64_tr_b16 a[214:215], v7 offset:4096
    v_mfma_f32_16x16x32_bf16 a[0:3], a[192:195], v[180:183], a[0:3]
    v_exp_f32 v120, v120
    v_mfma_f32_16x16x32_bf16 a[0:3], a[196:199], v[184:187], a[0:3]
    v_cvt_pk_bf16_f32 v213, v118, v119
    v_mfma_f32_16x16x32_bf16 a[4:7], a[196:199], v[192:195], a[4:7]
    v_exp_f32 v121, v121
    v_mfma_f32_16x16x32_bf16 a[4:7], a[192:195], v[188:191], a[4:7]
    v_mfma_f32_16x16x32_bf16 a[8:11], a[192:195], v[196:199], a[8:11]
    v_exp_f32 v122, v122
    v_mfma_f32_16x16x32_bf16 a[8:11], a[196:199], v[200:203], a[8:11]
    v_cvt_pk_bf16_f32 v220, v120, v121
    v_mfma_f32_16x16x32_bf16 a[12:15], a[196:199], v[208:211], a[12:15]
    v_exp_f32 v123, v123
    v_mfma_f32_16x16x32_bf16 a[12:15], a[192:195], v[204:207], a[12:15]
    s_waitcnt lgkmcnt(4)
    v_mfma_f32_16x16x32_bf16 a[16:19], a[200:203], v[180:183], a[16:19]
    ds_read_b64_tr_b16 a[216:217], v8 offset:57344
    v_cvt_pk_bf16_f32 v221, v122, v123
    v_exp_f32 v124, v124
    v_mfma_f32_16x16x32_bf16 a[16:19], a[204:207], v[184:187], a[16:19]
    ds_read_b64_tr_b16 a[218:219], v8 offset:61440
    v_exp_f32 v125, v125
    v_mfma_f32_16x16x32_bf16 a[20:23], a[204:207], v[192:195], a[20:23]
    ds_read_b64_tr_b16 a[220:221], v8 offset:0
    v_cvt_pk_bf16_f32 v228, v124, v125
    v_exp_f32 v126, v126
    v_mov_b32 v114, v20
    v_mfma_f32_16x16x32_bf16 a[20:23], a[200:203], v[188:191], a[20:23]
    ds_read_b64_tr_b16 a[222:223], v8 offset:4096
    v_exp_f32 v127, v127
    v_mfma_f32_16x16x32_bf16 a[24:27], a[200:203], v[196:199], a[24:27]
    v_cvt_pk_bf16_f32 v229, v126, v127
    v_exp_f32 v128, v128
    v_mfma_f32_16x16x32_bf16 a[24:27], a[204:207], v[200:203], a[24:27]
    v_exp_f32 v129, v129
    v_mov_b32 v115, v21
    v_mfma_f32_16x16x32_bf16 a[28:31], a[204:207], v[208:211], a[28:31]
    v_cvt_pk_bf16_f32 v236, v128, v129
    v_exp_f32 v130, v130
    v_mfma_f32_16x16x32_bf16 a[28:31], a[200:203], v[204:207], a[28:31]
    v_exp_f32 v131, v131
    v_smfmac_f32_16x16x64_bf16 a[224:227], v[244:247], v[180:187], v248
    s_waitcnt lgkmcnt(4)
    v_mov_b32 v0, 2
    v_mfma_f32_16x16x32_bf16 a[32:35], a[208:211], v[180:183], a[32:35]
    s_mov_b32 s45, 0
    ds_read_b64_tr_b16 a[192:193], v9 offset:57344
    v_cvt_pk_bf16_f32 v237, v130, v131
    v_exp_f32 v132, v132
    v_mfma_f32_16x16x32_bf16 a[32:35], a[212:215], v[184:187], a[32:35]
    ds_read_b64_tr_b16 a[194:195], v9 offset:61440
    v_exp_f32 v133, v133
    v_mfma_f32_16x16x32_bf16 a[36:39], a[212:215], v[192:195], a[36:39]
    ds_read_b64_tr_b16 a[196:197], v9 offset:0
    buffer_load_dwordx4 a[128:131], v114, s[20:23], s45 offen offset:0 sc1
    v_cvt_pk_bf16_f32 v214, v132, v133
    v_exp_f32 v134, v134
    v_mfma_f32_16x16x32_bf16 a[36:39], a[208:211], v[188:191], a[36:39]
    s_mov_b32 s45, 0
    ds_read_b64_tr_b16 a[198:199], v9 offset:4096
    v_exp_f32 v135, v135
    v_mfma_f32_16x16x32_bf16 a[40:43], a[208:211], v[196:199], a[40:43]
    v_cvt_pk_bf16_f32 v215, v134, v135
    v_exp_f32 v136, v136
    v_mfma_f32_16x16x32_bf16 a[40:43], a[212:215], v[200:203], a[40:43]
    buffer_load_dwordx4 a[132:135], v114, s[20:23], s45 offen offset:1024 sc1
    v_exp_f32 v137, v137
    v_mfma_f32_16x16x32_bf16 a[44:47], a[212:215], v[208:211], a[44:47]
    s_mov_b32 s45, 0
    v_cvt_pk_bf16_f32 v222, v136, v137
    v_exp_f32 v138, v138
    v_mfma_f32_16x16x32_bf16 a[44:47], a[208:211], v[204:207], a[44:47]
    s_waitcnt lgkmcnt(4)
    v_exp_f32 v139, v139
    v_mfma_f32_16x16x32_bf16 a[48:51], a[216:219], v[180:183], a[48:51]
    ds_read_b64_tr_b16 a[200:201], v10 offset:57344
    v_cvt_pk_bf16_f32 v223, v138, v139
    v_exp_f32 v140, v140
    v_mfma_f32_16x16x32_bf16 a[48:51], a[220:223], v[184:187], a[48:51]
    ds_read_b64_tr_b16 a[202:203], v10 offset:61440
    buffer_load_dwordx4 a[136:139], v114, s[20:23], s45 offen offset:2048 sc1
    v_exp_f32 v141, v141
    v_mfma_f32_16x16x32_bf16 a[52:55], a[220:223], v[192:195], a[52:55]
    s_mov_b32 s45, 0
    ds_read_b64_tr_b16 a[204:205], v10 offset:0
    v_cvt_pk_bf16_f32 v230, v140, v141
    v_exp_f32 v142, v142
    v_mfma_f32_16x16x32_bf16 a[52:55], a[216:219], v[188:191], a[52:55]
    ds_read_b64_tr_b16 a[206:207], v10 offset:4096
    v_exp_f32 v143, v143
    v_mfma_f32_16x16x32_bf16 a[56:59], a[216:219], v[196:199], a[56:59]
    buffer_load_dwordx4 a[140:143], v114, s[20:23], s45 offen offset:3072 sc1
    v_cvt_pk_bf16_f32 v231, v142, v143
    v_exp_f32 v144, v144
    v_mfma_f32_16x16x32_bf16 a[56:59], a[220:223], v[200:203], a[56:59]
    s_mov_b32 s45, 0
    v_exp_f32 v145, v145
    v_mfma_f32_16x16x32_bf16 a[60:63], a[220:223], v[208:211], a[60:63]
    v_cvt_pk_bf16_f32 v238, v144, v145
    v_exp_f32 v146, v146
    v_mfma_f32_16x16x32_bf16 a[60:63], a[216:219], v[204:207], a[60:63]
    buffer_load_dwordx4 a[144:147], v115, s[20:23], s45 offen offset:0 sc1
    v_exp_f32 v147, v147
    v_smfmac_f32_16x16x64_bf16 a[228:231], v[244:247], v[188:195], v248
    s_waitcnt lgkmcnt(4)
    v_mfma_f32_16x16x32_bf16 a[64:67], a[192:195], v[180:183], a[64:67]
    s_mov_b32 s45, 20480
    ds_read_b64_tr_b16 a[208:209], v11 offset:57344
    v_cvt_pk_bf16_f32 v239, v146, v147
    v_exp_f32 v148, v148
    v_mfma_f32_16x16x32_bf16 a[64:67], a[196:199], v[184:187], a[64:67]
    ds_read_b64_tr_b16 a[210:211], v11 offset:61440
    buffer_load_dwordx4 a[148:151], v114, s[20:23], s45 offen offset:0 sc1
    v_exp_f32 v149, v149
    v_mfma_f32_16x16x32_bf16 a[68:71], a[196:199], v[192:195], a[68:71]
    s_mov_b32 s45, 20480
    ds_read_b64_tr_b16 a[212:213], v11 offset:0
    v_cvt_pk_bf16_f32 v216, v148, v149
    v_exp_f32 v150, v150
    v_mfma_f32_16x16x32_bf16 a[68:71], a[192:195], v[188:191], a[68:71]
    ds_read_b64_tr_b16 a[214:215], v11 offset:4096
    v_exp_f32 v151, v151
    v_mfma_f32_16x16x32_bf16 a[72:75], a[192:195], v[196:199], a[72:75]
    buffer_load_dwordx4 a[152:155], v114, s[20:23], s45 offen offset:1024 sc1
    v_cvt_pk_bf16_f32 v217, v150, v151
    v_exp_f32 v152, v152
    v_mfma_f32_16x16x32_bf16 a[72:75], a[196:199], v[200:203], a[72:75]
    s_mov_b32 s45, 20480
    v_exp_f32 v153, v153
    v_mfma_f32_16x16x32_bf16 a[76:79], a[196:199], v[208:211], a[76:79]
    v_cvt_pk_bf16_f32 v224, v152, v153
    v_exp_f32 v154, v154
    v_mfma_f32_16x16x32_bf16 a[76:79], a[192:195], v[204:207], a[76:79]
    s_waitcnt lgkmcnt(4)
    buffer_load_dwordx4 a[156:159], v114, s[20:23], s45 offen offset:2048 sc1
    v_exp_f32 v155, v155
    v_mfma_f32_16x16x32_bf16 a[80:83], a[200:203], v[180:183], a[80:83]
    s_mov_b32 s45, 20480
    ds_read_b64_tr_b16 a[216:217], v12 offset:57344
    v_cvt_pk_bf16_f32 v225, v154, v155
    v_exp_f32 v156, v156
    v_mfma_f32_16x16x32_bf16 a[80:83], a[204:207], v[184:187], a[80:83]
    ds_read_b64_tr_b16 a[218:219], v12 offset:61440
    v_exp_f32 v157, v157
    v_mfma_f32_16x16x32_bf16 a[84:87], a[204:207], v[192:195], a[84:87]
    ds_read_b64_tr_b16 a[220:221], v12 offset:0
    v_cvt_pk_bf16_f32 v232, v156, v157
    v_exp_f32 v158, v158
    v_mfma_f32_16x16x32_bf16 a[84:87], a[200:203], v[188:191], a[84:87]
    ds_read_b64_tr_b16 a[222:223], v12 offset:4096
    buffer_load_dwordx4 a[160:163], v114, s[20:23], s45 offen offset:3072 sc1
    v_exp_f32 v159, v159
    v_mfma_f32_16x16x32_bf16 a[88:91], a[200:203], v[196:199], a[88:91]
    s_mov_b32 s45, 20480
    v_cvt_pk_bf16_f32 v233, v158, v159
    v_exp_f32 v160, v160
    v_mfma_f32_16x16x32_bf16 a[88:91], a[204:207], v[200:203], a[88:91]
    v_exp_f32 v161, v161
    v_mfma_f32_16x16x32_bf16 a[92:95], a[204:207], v[208:211], a[92:95]
    buffer_load_dwordx4 a[164:167], v115, s[20:23], s45 offen offset:0 sc1
    v_cvt_pk_bf16_f32 v240, v160, v161
    v_exp_f32 v162, v162
    v_mfma_f32_16x16x32_bf16 a[92:95], a[200:203], v[204:207], a[92:95]
    s_mov_b32 s45, 40960
    v_exp_f32 v163, v163
    v_smfmac_f32_16x16x64_bf16 a[232:235], v[244:247], v[196:203], v248
    s_waitcnt vmcnt(17) lgkmcnt(4)
    s_barrier
    buffer_load_dwordx4 a[168:171], v114, s[20:23], s45 offen offset:0 sc1
    v_mfma_f32_16x16x32_bf16 a[96:99], a[208:211], v[180:183], a[96:99]
    s_mov_b32 s45, 40960
    ds_read_b64_tr_b16 a[192:193], v5 offset:24576
    v_cvt_pk_bf16_f32 v241, v162, v163
    v_exp_f32 v164, v164
    v_mfma_f32_16x16x32_bf16 a[96:99], a[212:215], v[184:187], a[96:99]
    ds_read_b64_tr_b16 a[194:195], v5 offset:28672
    v_exp_f32 v165, v165
    v_mfma_f32_16x16x32_bf16 a[100:103], a[212:215], v[192:195], a[100:103]
    ds_read_b64_tr_b16 a[196:197], v5 offset:49152
    v_cvt_pk_bf16_f32 v218, v164, v165
    v_exp_f32 v166, v166
    v_mfma_f32_16x16x32_bf16 a[100:103], a[208:211], v[188:191], a[100:103]
    ds_read_b64_tr_b16 a[198:199], v5 offset:53248
    buffer_load_dwordx4 a[172:175], v114, s[20:23], s45 offen offset:1024 sc1
    v_exp_f32 v167, v167
    v_mfma_f32_16x16x32_bf16 a[104:107], a[208:211], v[196:199], a[104:107]
    s_mov_b32 s45, 40960
    v_cvt_pk_bf16_f32 v219, v166, v167
    v_exp_f32 v168, v168
    v_mfma_f32_16x16x32_bf16 a[104:107], a[212:215], v[200:203], a[104:107]
    v_exp_f32 v169, v169
    v_mfma_f32_16x16x32_bf16 a[108:111], a[212:215], v[208:211], a[108:111]
    buffer_load_dwordx4 a[176:179], v114, s[20:23], s45 offen offset:2048 sc1
    v_cvt_pk_bf16_f32 v226, v168, v169
    v_exp_f32 v170, v170
    v_mfma_f32_16x16x32_bf16 a[108:111], a[208:211], v[204:207], a[108:111]
    s_waitcnt lgkmcnt(4)
    s_cmp_lg_u32 s5, 0
    s_cbranch_scc1 L_ffn_flagged
    s_mov_b64 exec, 1
    buffer_store_dword v0, off, s[76:79], s75 sc1
    s_mov_b64 exec, -1
L_ffn_flagged:
    v_exp_f32 v171, v171
    v_mfma_f32_16x16x32_bf16 a[112:115], a[216:219], v[180:183], a[112:115]
    s_mov_b32 s45, 40960
    ds_read_b64_tr_b16 a[200:201], v6 offset:24576
    v_cvt_pk_bf16_f32 v227, v170, v171
    v_exp_f32 v172, v172
    v_mfma_f32_16x16x32_bf16 a[112:115], a[220:223], v[184:187], a[112:115]
    ds_read_b64_tr_b16 a[202:203], v6 offset:28672
    v_exp_f32 v173, v173
    v_mfma_f32_16x16x32_bf16 a[116:119], a[220:223], v[192:195], a[116:119]
    ds_read_b64_tr_b16 a[204:205], v6 offset:49152
    buffer_load_dwordx4 a[180:183], v114, s[20:23], s45 offen offset:3072 sc1
    v_cvt_pk_bf16_f32 v234, v172, v173
    v_exp_f32 v174, v174
    v_mfma_f32_16x16x32_bf16 a[116:119], a[216:219], v[188:191], a[116:119]
    s_mov_b32 s45, 40960
    ds_read_b64_tr_b16 a[206:207], v6 offset:53248
    v_exp_f32 v175, v175
    v_mfma_f32_16x16x32_bf16 a[120:123], a[216:219], v[196:199], a[120:123]
    v_cvt_pk_bf16_f32 v235, v174, v175
    v_exp_f32 v176, v176
    v_mfma_f32_16x16x32_bf16 a[120:123], a[220:223], v[200:203], a[120:123]
    buffer_load_dwordx4 a[184:187], v115, s[20:23], s45 offen offset:0 sc1
    v_exp_f32 v177, v177
    v_mfma_f32_16x16x32_bf16 a[124:127], a[220:223], v[208:211], a[124:127]
    s_mov_b32 s45, 61440
    v_cvt_pk_bf16_f32 v242, v176, v177
    v_exp_f32 v178, v178
    v_mfma_f32_16x16x32_bf16 a[124:127], a[216:219], v[204:207], a[124:127]
    v_exp_f32 v179, v179
    v_smfmac_f32_16x16x64_bf16 a[236:239], v[244:247], v[204:211], v248
    s_waitcnt lgkmcnt(4)
    buffer_load_dwordx4 a[188:191], v114, s[20:23], s45 offen offset:0 sc1
    v_mfma_f32_16x16x32_bf16 a[0:3], a[192:195], v[212:215], a[0:3]
    s_lshl_b32 s40, s87, 2
    ds_read_b64_tr_b16 a[208:209], v7 offset:24576
    v_cvt_pk_bf16_f32 v243, v178, v179
    v_mfma_f32_16x16x32_bf16 a[0:3], a[196:199], v[216:219], a[0:3]
    s_add_u32 s40, s40, s5
    ds_read_b64_tr_b16 a[210:211], v7 offset:28672
    v_smfmac_f32_16x16x64_bf16 a[224:227], v[244:247], v[212:219], v248
    s_lshl_b32 s40, s40, 4
    ds_read_b64_tr_b16 a[212:213], v7 offset:49152
    v_and_b32 v35, 15, v19
    v_smfmac_f32_16x16x64_bf16 a[228:231], v[244:247], v[220:227], v248
    ds_read_b64_tr_b16 a[214:215], v7 offset:53248
    v_add_u32 v35, s40, v35
    v_smfmac_f32_16x16x64_bf16 a[232:235], v[244:247], v[228:235], v248
    v_mul_u32_u24 v34, 1280, v35
    v_lshrrev_b32 v116, 4, v19
    v_smfmac_f32_16x16x64_bf16 a[236:239], v[244:247], v[236:243], v248
    v_lshl_add_u32 v34, v116, 3, v34
    v_mfma_f32_16x16x32_bf16 a[4:7], a[196:199], v[224:227], a[4:7]
    s_mul_i32 s40, s100, 160
    v_add_u32 v34, s40, v34
    v_lshlrev_b32 v116, 4, v35
    v_mfma_f32_16x16x32_bf16 a[4:7], a[192:195], v[220:223], a[4:7]
    s_mov_b32 s40, 0x280000
    buffer_load_dwordx2 v[32:33], v116, s[76:79], s40 offen sc1
    v_mfma_f32_16x16x32_bf16 a[8:11], a[192:195], v[228:231], a[8:11]
    buffer_load_dwordx2 v[22:23], v34, s[88:91], 0 offen offset:0
    v_mfma_f32_16x16x32_bf16 a[8:11], a[196:199], v[232:235], a[8:11]
    buffer_load_dwordx2 v[24:25], v34, s[88:91], 0 offen offset:32
    v_mfma_f32_16x16x32_bf16 a[12:15], a[196:199], v[240:243], a[12:15]
    buffer_load_dwordx2 v[26:27], v34, s[88:91], 0 offen offset:64
    v_mfma_f32_16x16x32_bf16 a[12:15], a[192:195], v[236:239], a[12:15]
    s_waitcnt lgkmcnt(4)
    buffer_load_dwordx2 v[28:29], v34, s[88:91], 0 offen offset:96
    v_mfma_f32_16x16x32_bf16 a[16:19], a[200:203], v[212:215], a[16:19]
    ds_read_b64_tr_b16 a[216:217], v8 offset:24576
    v_accvgpr_read_b32 v100, a224
    v_mfma_f32_16x16x32_bf16 a[16:19], a[204:207], v[216:219], a[16:19]
    ds_read_b64_tr_b16 a[218:219], v8 offset:28672
    v_accvgpr_read_b32 v104, a225
    v_accvgpr_read_b32 v101, a228
    v_accvgpr_read_b32 v105, a229
    v_mfma_f32_16x16x32_bf16 a[20:23], a[204:207], v[224:227], a[20:23]
    ds_read_b64_tr_b16 a[220:221], v8 offset:49152
    v_accvgpr_read_b32 v102, a232
    v_accvgpr_read_b32 v106, a233
    v_mfma_f32_16x16x32_bf16 a[20:23], a[200:203], v[220:223], a[20:23]
    ds_read_b64_tr_b16 a[222:223], v8 offset:53248
    v_accvgpr_read_b32 v103, a236
    v_accvgpr_read_b32 v107, a237
    v_add_f32 v100, v100, v104
    v_mfma_f32_16x16x32_bf16 a[24:27], a[200:203], v[228:231], a[24:27]
    buffer_load_dwordx2 v[30:31], v34, s[88:91], 0 offen offset:128
    v_add_f32 v101, v101, v105
    v_add_f32 v102, v102, v106
    v_add_f32 v103, v103, v107
    v_mfma_f32_16x16x32_bf16 a[24:27], a[204:207], v[232:235], a[24:27]
    v_lshlrev_b32 v20, 7, v19
    v_add_u32 v20, 0x290000, v20
    v_maximum3_f32 v108, v100, v101, v102
    v_maximum3_f32 v108, v108, v103, v103
    v_mfma_f32_16x16x32_bf16 a[28:31], a[204:207], v[240:243], a[28:31]
    buffer_load_dwordx4 v[252:255], v20, s[76:79], 0 offen sc1
    v_mul_f32 v108, 0x4d800000, v108
    v_mov_b32 v109, 0
    v_lshlrev_b32 v110, 4, v19
    v_mfma_f32_16x16x32_bf16 a[28:31], a[200:203], v[236:239], a[28:31]
    s_waitcnt lgkmcnt(4)
    v_rcp_f32 v100, v100
    v_rcp_f32 v101, v101
    v_rcp_f32 v102, v102
    v_rcp_f32 v103, v103
    v_mfma_f32_16x16x32_bf16 a[32:35], a[208:211], v[212:215], a[32:35]
    s_mov_b32 s36, 0
    ds_read_b64_tr_b16 a[192:193], v9 offset:24576
    v_accvgpr_read_b32 v120, a0
    v_accvgpr_read_b32 v121, a1
    v_accvgpr_read_b32 v122, a2
    v_accvgpr_read_b32 v123, a3
    v_mfma_f32_16x16x32_bf16 a[32:35], a[212:215], v[216:219], a[32:35]
    ds_read_b64_tr_b16 a[194:195], v9 offset:28672
    v_accvgpr_read_b32 v124, a16
    v_accvgpr_read_b32 v125, a17
    v_accvgpr_read_b32 v126, a18
    v_accvgpr_read_b32 v127, a19
    v_maximum3_f32 v108, v108, |v120|, |v121|
    v_maximum3_f32 v109, v109, |v122|, |v123|
    v_mfma_f32_16x16x32_bf16 a[36:39], a[212:215], v[224:227], a[36:39]
    ds_read_b64_tr_b16 a[196:197], v9 offset:49152
    v_maximum3_f32 v108, v108, |v124|, |v125|
    v_maximum3_f32 v109, v109, |v126|, |v127|
    v_mul_f32 v120, v120, v100
    v_mul_f32 v121, v121, v100
    v_mul_f32 v122, v122, v100
    v_mul_f32 v123, v123, v100
    v_mfma_f32_16x16x32_bf16 a[36:39], a[208:211], v[220:223], a[36:39]
    ds_read_b64_tr_b16 a[198:199], v9 offset:53248
    v_mul_f32 v124, v124, v100
    v_mul_f32 v125, v125, v100
    v_mul_f32 v126, v126, v100
    v_mul_f32 v127, v127, v100
    v_cvt_pk_bf16_f32 v152, v120, v121
    v_cvt_pk_bf16_f32 v153, v122, v123
    v_cvt_pk_bf16_f32 v154, v124, v125
    v_mfma_f32_16x16x32_bf16 a[40:43], a[208:211], v[228:231], a[40:43]
    v_cvt_pk_bf16_f32 v155, v126, v127
    v_mfma_f32_16x16x32_bf16 a[40:43], a[212:215], v[232:235], a[40:43]
    buffer_store_dwordx4 v[152:155], v110, s[24:27], s36 offen offset:0 sc1
    v_accvgpr_read_b32 v128, a4
    v_accvgpr_read_b32 v129, a5
    v_accvgpr_read_b32 v130, a6
    v_accvgpr_read_b32 v131, a7
    v_accvgpr_read_b32 v132, a20
    v_accvgpr_read_b32 v133, a21
    v_accvgpr_read_b32 v134, a22
    v_accvgpr_read_b32 v135, a23
    v_maximum3_f32 v108, v108, |v128|, |v129|
    v_maximum3_f32 v109, v109, |v130|, |v131|
    v_mfma_f32_16x16x32_bf16 a[44:47], a[212:215], v[240:243], a[44:47]
    v_maximum3_f32 v108, v108, |v132|, |v133|
    v_maximum3_f32 v109, v109, |v134|, |v135|
    v_mul_f32 v128, v128, v101
    v_mul_f32 v129, v129, v101
    v_mul_f32 v130, v130, v101
    v_mul_f32 v131, v131, v101
    v_mul_f32 v132, v132, v101
    v_mfma_f32_16x16x32_bf16 a[44:47], a[208:211], v[236:239], a[44:47]
    s_waitcnt lgkmcnt(4)
    v_mul_f32 v133, v133, v101
    v_mul_f32 v134, v134, v101
    v_mul_f32 v135, v135, v101
    v_cvt_pk_bf16_f32 v156, v128, v129
    v_cvt_pk_bf16_f32 v157, v130, v131
    v_cvt_pk_bf16_f32 v158, v132, v133
    v_mfma_f32_16x16x32_bf16 a[48:51], a[216:219], v[212:215], a[48:51]
    ds_read_b64_tr_b16 a[200:201], v10 offset:24576
    v_cvt_pk_bf16_f32 v159, v134, v135
    v_mfma_f32_16x16x32_bf16 a[48:51], a[220:223], v[216:219], a[48:51]
    ds_read_b64_tr_b16 a[202:203], v10 offset:28672
    buffer_store_dwordx4 v[156:159], v110, s[24:27], s36 offen offset:1024 sc1
    v_accvgpr_read_b32 v136, a8
    v_accvgpr_read_b32 v137, a9
    v_accvgpr_read_b32 v138, a10
    v_accvgpr_read_b32 v139, a11
    v_accvgpr_read_b32 v140, a24
    v_accvgpr_read_b32 v141, a25
    v_accvgpr_read_b32 v142, a26
    v_accvgpr_read_b32 v143, a27
    v_maximum3_f32 v108, v108, |v136|, |v137|
    v_maximum3_f32 v109, v109, |v138|, |v139|
    v_maximum3_f32 v108, v108, |v140|, |v141|
    v_mfma_f32_16x16x32_bf16 a[52:55], a[220:223], v[224:227], a[52:55]
    ds_read_b64_tr_b16 a[204:205], v10 offset:49152
    v_maximum3_f32 v109, v109, |v142|, |v143|
    v_mul_f32 v136, v136, v102
    v_mul_f32 v137, v137, v102
    v_mul_f32 v138, v138, v102
    v_mul_f32 v139, v139, v102
    v_mul_f32 v140, v140, v102
    v_mfma_f32_16x16x32_bf16 a[52:55], a[216:219], v[220:223], a[52:55]
    ds_read_b64_tr_b16 a[206:207], v10 offset:53248
    v_mul_f32 v141, v141, v102
    v_mul_f32 v142, v142, v102
    v_mul_f32 v143, v143, v102
    v_cvt_pk_bf16_f32 v160, v136, v137
    v_cvt_pk_bf16_f32 v161, v138, v139
    v_cvt_pk_bf16_f32 v162, v140, v141
    v_mfma_f32_16x16x32_bf16 a[56:59], a[216:219], v[228:231], a[56:59]
    v_cvt_pk_bf16_f32 v163, v142, v143
    v_mfma_f32_16x16x32_bf16 a[56:59], a[220:223], v[232:235], a[56:59]
    buffer_store_dwordx4 v[160:163], v110, s[24:27], s36 offen offset:2048 sc1
    v_accvgpr_read_b32 v144, a12
    v_accvgpr_read_b32 v145, a13
    v_accvgpr_read_b32 v146, a14
    v_accvgpr_read_b32 v147, a15
    v_accvgpr_read_b32 v148, a28
    v_accvgpr_read_b32 v149, a29
    v_accvgpr_read_b32 v150, a30
    v_accvgpr_read_b32 v151, a31
    v_maximum3_f32 v108, v108, |v144|, |v145|
    v_maximum3_f32 v109, v109, |v146|, |v147|
    v_maximum3_f32 v108, v108, |v148|, |v149|
    v_mfma_f32_16x16x32_bf16 a[60:63], a[220:223], v[240:243], a[60:63]
    v_maximum3_f32 v109, v109, |v150|, |v151|
    v_mul_f32 v144, v144, v103
    v_mul_f32 v145, v145, v103
    v_mul_f32 v146, v146, v103
    v_mul_f32 v147, v147, v103
    v_mul_f32 v148, v148, v103
    v_mfma_f32_16x16x32_bf16 a[60:63], a[216:219], v[236:239], a[60:63]
    s_waitcnt lgkmcnt(4)
    v_mul_f32 v149, v149, v103
    v_mul_f32 v150, v150, v103
    v_mul_f32 v151, v151, v103
    v_cvt_pk_bf16_f32 v164, v144, v145
    v_cvt_pk_bf16_f32 v165, v146, v147
    v_cvt_pk_bf16_f32 v166, v148, v149
    v_cvt_pk_bf16_f32 v167, v150, v151
    buffer_store_dwordx4 v[164:167], v110, s[24:27], s36 offen offset:3072 sc1
    v_mfma_f32_16x16x32_bf16 a[64:67], a[192:195], v[212:215], a[64:67]
    s_mov_b32 s36, 4096
    ds_read_b64_tr_b16 a[208:209], v11 offset:24576
    v_accvgpr_read_b32 v120, a32
    v_accvgpr_read_b32 v121, a33
    v_accvgpr_read_b32 v122, a34
    v_accvgpr_read_b32 v123, a35
    v_accvgpr_read_b32 v124, a48
    v_mfma_f32_16x16x32_bf16 a[64:67], a[196:199], v[216:219], a[64:67]
    ds_read_b64_tr_b16 a[210:211], v11 offset:28672
    v_accvgpr_read_b32 v125, a49
    v_accvgpr_read_b32 v126, a50
    v_accvgpr_read_b32 v127, a51
    v_maximum3_f32 v108, v108, |v120|, |v121|
    v_maximum3_f32 v109, v109, |v122|, |v123|
    v_maximum3_f32 v108, v108, |v124|, |v125|
    v_maximum3_f32 v109, v109, |v126|, |v127|
    v_mfma_f32_16x16x32_bf16 a[68:71], a[196:199], v[224:227], a[68:71]
    ds_read_b64_tr_b16 a[212:213], v11 offset:49152
    v_mul_f32 v120, v120, v100
    v_mul_f32 v121, v121, v100
    v_mul_f32 v122, v122, v100
    v_mul_f32 v123, v123, v100
    v_mul_f32 v124, v124, v100
    v_mul_f32 v125, v125, v100
    v_mul_f32 v126, v126, v100
    v_mfma_f32_16x16x32_bf16 a[68:71], a[192:195], v[220:223], a[68:71]
    ds_read_b64_tr_b16 a[214:215], v11 offset:53248
    v_mul_f32 v127, v127, v100
    v_cvt_pk_bf16_f32 v152, v120, v121
    v_cvt_pk_bf16_f32 v153, v122, v123
    v_cvt_pk_bf16_f32 v154, v124, v125
    v_cvt_pk_bf16_f32 v155, v126, v127
    v_mfma_f32_16x16x32_bf16 a[72:75], a[192:195], v[228:231], a[72:75]
    buffer_store_dwordx4 v[152:155], v110, s[24:27], s36 offen offset:0 sc1
    v_mfma_f32_16x16x32_bf16 a[72:75], a[196:199], v[232:235], a[72:75]
    s_mov_b32 s45, 61440
    buffer_load_dwordx4 a[0:3], v114, s[20:23], s45 offen offset:1024 sc1
    v_mfma_f32_16x16x32_bf16 a[76:79], a[196:199], v[240:243], a[76:79]
    s_mov_b32 s45, 61440
    buffer_load_dwordx4 a[4:7], v114, s[20:23], s45 offen offset:2048 sc1
    v_accvgpr_read_b32 v128, a36
    v_accvgpr_read_b32 v129, a37
    v_accvgpr_read_b32 v130, a38
    v_accvgpr_read_b32 v131, a39
    v_accvgpr_read_b32 v132, a52
    v_accvgpr_read_b32 v133, a53
    v_accvgpr_read_b32 v134, a54
    v_accvgpr_read_b32 v135, a55
    v_maximum3_f32 v108, v108, |v128|, |v129|
    v_maximum3_f32 v109, v109, |v130|, |v131|
    v_maximum3_f32 v108, v108, |v132|, |v133|
    v_maximum3_f32 v109, v109, |v134|, |v135|
    v_mul_f32 v128, v128, v101
    v_mul_f32 v129, v129, v101
    v_mul_f32 v130, v130, v101
    v_mul_f32 v131, v131, v101
    v_mul_f32 v132, v132, v101
    v_mul_f32 v133, v133, v101
    v_mul_f32 v134, v134, v101
    v_mul_f32 v135, v135, v101
    v_mfma_f32_16x16x32_bf16 a[76:79], a[192:195], v[236:239], a[76:79]
    s_waitcnt lgkmcnt(4)
    v_cvt_pk_bf16_f32 v156, v128, v129
    v_cvt_pk_bf16_f32 v157, v130, v131
    v_cvt_pk_bf16_f32 v158, v132, v133
    v_cvt_pk_bf16_f32 v159, v134, v135
    v_mfma_f32_16x16x32_bf16 a[80:83], a[200:203], v[212:215], a[80:83]
    ds_read_b64_tr_b16 a[216:217], v12 offset:24576
    buffer_store_dwordx4 v[156:159], v110, s[24:27], s36 offen offset:1024 sc1
    v_mfma_f32_16x16x32_bf16 a[80:83], a[204:207], v[216:219], a[80:83]
    s_mov_b32 s45, 61440
    ds_read_b64_tr_b16 a[218:219], v12 offset:28672
    buffer_load_dwordx4 a[8:11], v114, s[20:23], s45 offen offset:3072 sc1
    v_mfma_f32_16x16x32_bf16 a[84:87], a[204:207], v[224:227], a[84:87]
    s_mov_b32 s45, 61440
    ds_read_b64_tr_b16 a[220:221], v12 offset:49152
    buffer_load_dwordx4 a[12:15], v115, s[20:23], s45 offen offset:0 sc1
    v_accvgpr_read_b32 v136, a40
    v_accvgpr_read_b32 v137, a41
    v_accvgpr_read_b32 v138, a42
    v_accvgpr_read_b32 v139, a43
    v_accvgpr_read_b32 v140, a56
    v_accvgpr_read_b32 v141, a57
    v_accvgpr_read_b32 v142, a58
    v_accvgpr_read_b32 v143, a59
    v_maximum3_f32 v108, v108, |v136|, |v137|
    v_maximum3_f32 v109, v109, |v138|, |v139|
    v_maximum3_f32 v108, v108, |v140|, |v141|
    v_maximum3_f32 v109, v109, |v142|, |v143|
    v_mul_f32 v136, v136, v102
    v_mul_f32 v137, v137, v102
    v_mul_f32 v138, v138, v102
    v_mul_f32 v139, v139, v102
    v_mul_f32 v140, v140, v102
    v_mul_f32 v141, v141, v102
    v_mul_f32 v142, v142, v102
    v_mul_f32 v143, v143, v102
    v_mfma_f32_16x16x32_bf16 a[84:87], a[200:203], v[220:223], a[84:87]
    ds_read_b64_tr_b16 a[222:223], v12 offset:53248
    v_cvt_pk_bf16_f32 v160, v136, v137
    v_cvt_pk_bf16_f32 v161, v138, v139
    v_cvt_pk_bf16_f32 v162, v140, v141
    v_cvt_pk_bf16_f32 v163, v142, v143
    v_mfma_f32_16x16x32_bf16 a[88:91], a[200:203], v[228:231], a[88:91]
    buffer_store_dwordx4 v[160:163], v110, s[24:27], s36 offen offset:2048 sc1
    v_mfma_f32_16x16x32_bf16 a[88:91], a[204:207], v[232:235], a[88:91]
    s_mov_b32 s45, 81920
    buffer_load_dwordx4 a[16:19], v114, s[20:23], s45 offen offset:0 sc1
    v_mfma_f32_16x16x32_bf16 a[92:95], a[204:207], v[240:243], a[92:95]
    s_mov_b32 s45, 81920
    buffer_load_dwordx4 a[20:23], v114, s[20:23], s45 offen offset:1024 sc1
    v_accvgpr_read_b32 v144, a44
    v_accvgpr_read_b32 v145, a45
    v_accvgpr_read_b32 v146, a46
    v_accvgpr_read_b32 v147, a47
    v_accvgpr_read_b32 v148, a60
    v_accvgpr_read_b32 v149, a61
    v_accvgpr_read_b32 v150, a62
    v_accvgpr_read_b32 v151, a63
    v_maximum3_f32 v108, v108, |v144|, |v145|
    v_maximum3_f32 v109, v109, |v146|, |v147|
    v_maximum3_f32 v108, v108, |v148|, |v149|
    v_maximum3_f32 v109, v109, |v150|, |v151|
    v_mul_f32 v144, v144, v103
    v_mul_f32 v145, v145, v103
    v_mul_f32 v146, v146, v103
    v_mul_f32 v147, v147, v103
    v_mul_f32 v148, v148, v103
    v_mul_f32 v149, v149, v103
    v_mul_f32 v150, v150, v103
    v_mul_f32 v151, v151, v103
    v_mfma_f32_16x16x32_bf16 a[92:95], a[200:203], v[236:239], a[92:95]
    s_waitcnt lgkmcnt(4)
    v_cvt_pk_bf16_f32 v164, v144, v145
    v_cvt_pk_bf16_f32 v165, v146, v147
    v_cvt_pk_bf16_f32 v166, v148, v149
    v_cvt_pk_bf16_f32 v167, v150, v151
    buffer_store_dwordx4 v[164:167], v110, s[24:27], s36 offen offset:3072 sc1
    s_mov_b32 s45, 81920
    buffer_load_dwordx4 a[24:27], v114, s[20:23], s45 offen offset:2048 sc1
    s_mov_b32 s45, 81920
    buffer_load_dwordx4 a[28:31], v114, s[20:23], s45 offen offset:3072 sc1
    v_mfma_f32_16x16x32_bf16 a[96:99], a[208:211], v[212:215], a[96:99]
    s_mov_b32 s36, 8192
    v_accvgpr_read_b32 v120, a64
    v_accvgpr_read_b32 v121, a65
    v_accvgpr_read_b32 v122, a66
    v_accvgpr_read_b32 v123, a67
    v_accvgpr_read_b32 v124, a80
    v_mfma_f32_16x16x32_bf16 a[96:99], a[212:215], v[216:219], a[96:99]
    v_accvgpr_read_b32 v125, a81
    v_accvgpr_read_b32 v126, a82
    v_accvgpr_read_b32 v127, a83
    v_maximum3_f32 v108, v108, |v120|, |v121|
    v_maximum3_f32 v109, v109, |v122|, |v123|
    v_maximum3_f32 v108, v108, |v124|, |v125|
    v_maximum3_f32 v109, v109, |v126|, |v127|
    v_mfma_f32_16x16x32_bf16 a[100:103], a[212:215], v[224:227], a[100:103]
    v_mul_f32 v120, v120, v100
    v_mul_f32 v121, v121, v100
    v_mul_f32 v122, v122, v100
    v_mul_f32 v123, v123, v100
    v_mul_f32 v124, v124, v100
    v_mul_f32 v125, v125, v100
    v_mul_f32 v126, v126, v100
    v_mfma_f32_16x16x32_bf16 a[100:103], a[208:211], v[220:223], a[100:103]
    v_mul_f32 v127, v127, v100
    v_cvt_pk_bf16_f32 v152, v120, v121
    v_cvt_pk_bf16_f32 v153, v122, v123
    v_cvt_pk_bf16_f32 v154, v124, v125
    v_cvt_pk_bf16_f32 v155, v126, v127
    v_mfma_f32_16x16x32_bf16 a[104:107], a[208:211], v[228:231], a[104:107]
    buffer_store_dwordx4 v[152:155], v110, s[24:27], s36 offen offset:0 sc1
    v_mfma_f32_16x16x32_bf16 a[104:107], a[212:215], v[232:235], a[104:107]
    s_mov_b32 s45, 81920
    buffer_load_dwordx4 a[32:35], v115, s[20:23], s45 offen offset:0 sc1
    v_mfma_f32_16x16x32_bf16 a[108:111], a[212:215], v[240:243], a[108:111]
    s_mov_b32 s45, 102400
    buffer_load_dwordx4 a[36:39], v114, s[20:23], s45 offen offset:0 sc1
    v_accvgpr_read_b32 v128, a68
    v_accvgpr_read_b32 v129, a69
    v_accvgpr_read_b32 v130, a70
    v_accvgpr_read_b32 v131, a71
    v_accvgpr_read_b32 v132, a84
    v_accvgpr_read_b32 v133, a85
    v_accvgpr_read_b32 v134, a86
    v_accvgpr_read_b32 v135, a87
    v_maximum3_f32 v108, v108, |v128|, |v129|
    v_maximum3_f32 v109, v109, |v130|, |v131|
    v_maximum3_f32 v108, v108, |v132|, |v133|
    v_maximum3_f32 v109, v109, |v134|, |v135|
    v_mul_f32 v128, v128, v101
    v_mul_f32 v129, v129, v101
    v_mul_f32 v130, v130, v101
    v_mul_f32 v131, v131, v101
    v_mul_f32 v132, v132, v101
    v_mul_f32 v133, v133, v101
    v_mul_f32 v134, v134, v101
    v_mul_f32 v135, v135, v101
    v_mfma_f32_16x16x32_bf16 a[108:111], a[208:211], v[236:239], a[108:111]
    s_waitcnt lgkmcnt(0)
    v_cvt_pk_bf16_f32 v156, v128, v129
    v_cvt_pk_bf16_f32 v157, v130, v131
    v_cvt_pk_bf16_f32 v158, v132, v133
    v_cvt_pk_bf16_f32 v159, v134, v135
    v_mfma_f32_16x16x32_bf16 a[112:115], a[216:219], v[212:215], a[112:115]
    buffer_store_dwordx4 v[156:159], v110, s[24:27], s36 offen offset:1024 sc1
    v_mfma_f32_16x16x32_bf16 a[112:115], a[220:223], v[216:219], a[112:115]
    s_mov_b32 s45, 102400
    buffer_load_dwordx4 a[40:43], v114, s[20:23], s45 offen offset:1024 sc1
    v_mfma_f32_16x16x32_bf16 a[116:119], a[220:223], v[224:227], a[116:119]
    s_mov_b32 s45, 102400
    buffer_load_dwordx4 a[44:47], v114, s[20:23], s45 offen offset:2048 sc1
    v_accvgpr_read_b32 v136, a72
    v_accvgpr_read_b32 v137, a73
    v_accvgpr_read_b32 v138, a74
    v_accvgpr_read_b32 v139, a75
    v_accvgpr_read_b32 v140, a88
    v_accvgpr_read_b32 v141, a89
    v_accvgpr_read_b32 v142, a90
    v_accvgpr_read_b32 v143, a91
    v_maximum3_f32 v108, v108, |v136|, |v137|
    v_maximum3_f32 v109, v109, |v138|, |v139|
    v_maximum3_f32 v108, v108, |v140|, |v141|
    v_maximum3_f32 v109, v109, |v142|, |v143|
    v_mul_f32 v136, v136, v102
    v_mul_f32 v137, v137, v102
    v_mul_f32 v138, v138, v102
    v_mul_f32 v139, v139, v102
    v_mul_f32 v140, v140, v102
    v_mul_f32 v141, v141, v102
    v_mul_f32 v142, v142, v102
    v_mul_f32 v143, v143, v102
    v_mfma_f32_16x16x32_bf16 a[116:119], a[216:219], v[220:223], a[116:119]
    v_cvt_pk_bf16_f32 v160, v136, v137
    v_cvt_pk_bf16_f32 v161, v138, v139
    v_cvt_pk_bf16_f32 v162, v140, v141
    v_cvt_pk_bf16_f32 v163, v142, v143
    v_mfma_f32_16x16x32_bf16 a[120:123], a[216:219], v[228:231], a[120:123]
    buffer_store_dwordx4 v[160:163], v110, s[24:27], s36 offen offset:2048 sc1
    v_mfma_f32_16x16x32_bf16 a[120:123], a[220:223], v[232:235], a[120:123]
    s_mov_b32 s45, 102400
    buffer_load_dwordx4 a[48:51], v114, s[20:23], s45 offen offset:3072 sc1
    v_mfma_f32_16x16x32_bf16 a[124:127], a[220:223], v[240:243], a[124:127]
    s_mov_b32 s45, 102400
    buffer_load_dwordx4 a[52:55], v115, s[20:23], s45 offen offset:0 sc1
    v_accvgpr_read_b32 v144, a76
    v_accvgpr_read_b32 v145, a77
    v_accvgpr_read_b32 v146, a78
    v_accvgpr_read_b32 v147, a79
    v_accvgpr_read_b32 v148, a92
    v_accvgpr_read_b32 v149, a93
    v_accvgpr_read_b32 v150, a94
    v_accvgpr_read_b32 v151, a95
    v_maximum3_f32 v108, v108, |v144|, |v145|
    v_maximum3_f32 v109, v109, |v146|, |v147|
    v_maximum3_f32 v108, v108, |v148|, |v149|
    v_maximum3_f32 v109, v109, |v150|, |v151|
    v_mul_f32 v144, v144, v103
    v_mul_f32 v145, v145, v103
    v_mul_f32 v146, v146, v103
    v_mul_f32 v147, v147, v103
    v_mul_f32 v148, v148, v103
    v_mul_f32 v149, v149, v103
    v_mul_f32 v150, v150, v103
    v_mul_f32 v151, v151, v103
    v_mfma_f32_16x16x32_bf16 a[124:127], a[216:219], v[236:239], a[124:127]
    v_cvt_pk_bf16_f32 v164, v144, v145
    v_cvt_pk_bf16_f32 v165, v146, v147
    v_cvt_pk_bf16_f32 v166, v148, v149
    v_cvt_pk_bf16_f32 v167, v150, v151
    buffer_store_dwordx4 v[164:167], v110, s[24:27], s36 offen offset:3072 sc1
    s_mov_b32 s45, 122880
    buffer_load_dwordx4 a[56:59], v114, s[20:23], s45 offen offset:0 sc1
    s_mov_b32 s45, 122880
    buffer_load_dwordx4 a[60:63], v114, s[20:23], s45 offen offset:1024 sc1
    s_mov_b32 s36, 12288
    v_accvgpr_read_b32 v120, a96
    v_accvgpr_read_b32 v121, a97
    v_accvgpr_read_b32 v122, a98
    v_accvgpr_read_b32 v123, a99
    v_accvgpr_read_b32 v124, a112
    v_accvgpr_read_b32 v125, a113
    v_accvgpr_read_b32 v126, a114
    v_accvgpr_read_b32 v127, a115
    v_maximum3_f32 v108, v108, |v120|, |v121|
    v_maximum3_f32 v109, v109, |v122|, |v123|
    v_maximum3_f32 v108, v108, |v124|, |v125|
    v_maximum3_f32 v109, v109, |v126|, |v127|
    v_mul_f32 v120, v120, v100
    v_mul_f32 v121, v121, v100
    v_mul_f32 v122, v122, v100
    v_mul_f32 v123, v123, v100
    v_mul_f32 v124, v124, v100
    v_mul_f32 v125, v125, v100
    v_mul_f32 v126, v126, v100
    v_mul_f32 v127, v127, v100
    v_cvt_pk_bf16_f32 v152, v120, v121
    v_cvt_pk_bf16_f32 v153, v122, v123
    v_cvt_pk_bf16_f32 v154, v124, v125
    v_cvt_pk_bf16_f32 v155, v126, v127
    buffer_store_dwordx4 v[152:155], v110, s[24:27], s36 offen offset:0 sc1
    s_mov_b32 s45, 122880
    buffer_load_dwordx4 a[64:67], v114, s[20:23], s45 offen offset:2048 sc1
    s_mov_b32 s45, 122880
    buffer_load_dwordx4 a[68:71], v114, s[20:23], s45 offen offset:3072 sc1
    v_accvgpr_read_b32 v128, a100
    v_accvgpr_read_b32 v129, a101
    v_accvgpr_read_b32 v130, a102
    v_accvgpr_read_b32 v131, a103
    v_accvgpr_read_b32 v132, a116
    v_accvgpr_read_b32 v133, a117
    v_accvgpr_read_b32 v134, a118
    v_accvgpr_read_b32 v135, a119
    v_maximum3_f32 v108, v108, |v128|, |v129|
    v_maximum3_f32 v109, v109, |v130|, |v131|
    v_maximum3_f32 v108, v108, |v132|, |v133|
    v_maximum3_f32 v109, v109, |v134|, |v135|
    v_mul_f32 v128, v128, v101
    v_mul_f32 v129, v129, v101
    v_mul_f32 v130, v130, v101
    v_mul_f32 v131, v131, v101
    v_mul_f32 v132, v132, v101
    v_mul_f32 v133, v133, v101
    v_mul_f32 v134, v134, v101
    v_mul_f32 v135, v135, v101
    v_cvt_pk_bf16_f32 v156, v128, v129
    v_cvt_pk_bf16_f32 v157, v130, v131
    v_cvt_pk_bf16_f32 v158, v132, v133
    v_cvt_pk_bf16_f32 v159, v134, v135
    buffer_store_dwordx4 v[156:159], v110, s[24:27], s36 offen offset:1024 sc1
    s_mov_b32 s45, 122880
    buffer_load_dwordx4 a[72:75], v115, s[20:23], s45 offen offset:0 sc1
    s_mov_b32 s45, 143360
    buffer_load_dwordx4 a[76:79], v114, s[20:23], s45 offen offset:0 sc1
    v_accvgpr_read_b32 v136, a104
    v_accvgpr_read_b32 v137, a105
    v_accvgpr_read_b32 v138, a106
    v_accvgpr_read_b32 v139, a107
    v_accvgpr_read_b32 v140, a120
    v_accvgpr_read_b32 v141, a121
    v_accvgpr_read_b32 v142, a122
    v_accvgpr_read_b32 v143, a123
    v_maximum3_f32 v108, v108, |v136|, |v137|
    v_maximum3_f32 v109, v109, |v138|, |v139|
    v_maximum3_f32 v108, v108, |v140|, |v141|
    v_maximum3_f32 v109, v109, |v142|, |v143|
    v_mul_f32 v136, v136, v102
    v_mul_f32 v137, v137, v102
    v_mul_f32 v138, v138, v102
    v_mul_f32 v139, v139, v102
    v_mul_f32 v140, v140, v102
    v_mul_f32 v141, v141, v102
    v_mul_f32 v142, v142, v102
    v_mul_f32 v143, v143, v102
    v_cvt_pk_bf16_f32 v160, v136, v137
    v_cvt_pk_bf16_f32 v161, v138, v139
    v_cvt_pk_bf16_f32 v162, v140, v141
    v_cvt_pk_bf16_f32 v163, v142, v143
    buffer_store_dwordx4 v[160:163], v110, s[24:27], s36 offen offset:2048 sc1
    s_mov_b32 s45, 143360
    buffer_load_dwordx4 a[80:83], v114, s[20:23], s45 offen offset:1024 sc1
    s_mov_b32 s45, 143360
    buffer_load_dwordx4 a[84:87], v114, s[20:23], s45 offen offset:2048 sc1
    v_accvgpr_read_b32 v144, a108
    v_accvgpr_read_b32 v145, a109
    v_accvgpr_read_b32 v146, a110
    v_accvgpr_read_b32 v147, a111
    v_accvgpr_read_b32 v148, a124
    v_accvgpr_read_b32 v149, a125
    v_accvgpr_read_b32 v150, a126
    v_accvgpr_read_b32 v151, a127
    v_maximum3_f32 v108, v108, |v144|, |v145|
    v_maximum3_f32 v109, v109, |v146|, |v147|
    v_maximum3_f32 v108, v108, |v148|, |v149|
    v_maximum3_f32 v109, v109, |v150|, |v151|
    v_mul_f32 v144, v144, v103
    v_mul_f32 v145, v145, v103
    v_mul_f32 v146, v146, v103
    v_mul_f32 v147, v147, v103
    v_mul_f32 v148, v148, v103
    v_mul_f32 v149, v149, v103
    v_mul_f32 v150, v150, v103
    v_mul_f32 v151, v151, v103
    v_cvt_pk_bf16_f32 v164, v144, v145
    v_cvt_pk_bf16_f32 v165, v146, v147
    v_cvt_pk_bf16_f32 v166, v148, v149
    v_cvt_pk_bf16_f32 v167, v150, v151
    buffer_store_dwordx4 v[164:167], v110, s[24:27], s36 offen offset:3072 sc1
    s_mov_b32 s45, 143360
    buffer_load_dwordx4 a[88:91], v114, s[20:23], s45 offen offset:3072 sc1
    s_mov_b32 s45, 143360
    buffer_load_dwordx4 a[92:95], v115, s[20:23], s45 offen offset:0 sc1
    v_maximum3_f32 v108, v108, v109, v109
    v_cmp_ngt_f32 vcc, 0x7f800000, v108
    s_and_b64 vcc, vcc, exec
    s_cbranch_scc1 L_slow
L_published:
    v_mov_b32 v16, v114
    v_mov_b32 v17, v115
    v_mov_b32 v3, v249
    v_mov_b32 v2, 1
    s_waitcnt vmcnt(40)
    v_lshlrev_b32 v166, 16, v22
    v_and_b32 v167, 0xffff0000, v22
    v_lshlrev_b32 v168, 16, v23
    v_and_b32 v169, 0xffff0000, v23
    v_lshlrev_b32 v170, 16, v24
    v_and_b32 v171, 0xffff0000, v24
    v_lshlrev_b32 v172, 16, v25
    v_and_b32 v173, 0xffff0000, v25
    v_lshlrev_b32 v174, 16, v26
    v_and_b32 v175, 0xffff0000, v26
    v_lshlrev_b32 v176, 16, v27
    v_and_b32 v177, 0xffff0000, v27
    v_lshlrev_b32 v178, 16, v28
    v_and_b32 v179, 0xffff0000, v28
    v_lshlrev_b32 v180, 16, v29
    v_and_b32 v181, 0xffff0000, v29
    v_lshlrev_b32 v182, 16, v30
    v_and_b32 v183, 0xffff0000, v30
    v_lshlrev_b32 v184, 16, v31
    v_and_b32 v185, 0xffff0000, v31
    s_mov_b32 s45, 163840
    buffer_load_dwordx4 v[46:49], v16, s[20:23], s45 offen offset:0 sc1
    v_pk_add_f32 v[166:167], v[166:167], v[32:33] op_sel_hi:[1,0] neg_lo:[0,1] neg_hi:[0,1]
    v_pk_add_f32 v[168:169], v[168:169], v[32:33] op_sel_hi:[1,0] neg_lo:[0,1] neg_hi:[0,1]
    v_pk_add_f32 v[170:171], v[170:171], v[32:33] op_sel_hi:[1,0] neg_lo:[0,1] neg_hi:[0,1]
    v_pk_add_f32 v[172:173], v[172:173], v[32:33] op_sel_hi:[1,0] neg_lo:[0,1] neg_hi:[0,1]
    v_pk_add_f32 v[174:175], v[174:175], v[32:33] op_sel_hi:[1,0] neg_lo:[0,1] neg_hi:[0,1]
    v_pk_add_f32 v[176:177], v[176:177], v[32:33] op_sel_hi:[1,0] neg_lo:[0,1] neg_hi:[0,1]
    v_pk_add_f32 v[178:179], v[178:179], v[32:33] op_sel_hi:[1,0] neg_lo:[0,1] neg_hi:[0,1]
    v_pk_add_f32 v[180:181], v[180:181], v[32:33] op_sel_hi:[1,0] neg_lo:[0,1] neg_hi:[0,1]
    v_pk_add_f32 v[182:183], v[182:183], v[32:33] op_sel_hi:[1,0] neg_lo:[0,1] neg_hi:[0,1]
    v_pk_add_f32 v[184:185], v[184:185], v[32:33] op_sel_hi:[1,0] neg_lo:[0,1] neg_hi:[0,1]
    v_cvt_pk_bf16_f32 v36, v166, v167
    v_cvt_pk_bf16_f32 v37, v168, v169
    v_cvt_pk_bf16_f32 v38, v170, v171
    v_cvt_pk_bf16_f32 v39, v172, v173
    v_cvt_pk_bf16_f32 v40, v174, v175
    v_cvt_pk_bf16_f32 v41, v176, v177
    v_cvt_pk_bf16_f32 v42, v178, v179
    v_cvt_pk_bf16_f32 v43, v180, v181
    v_cvt_pk_bf16_f32 v44, v182, v183
    v_cvt_pk_bf16_f32 v45, v184, v185
    buffer_load_dwordx4 v[50:53], v16, s[20:23], s45 offen offset:1024 sc1
    v_lshlrev_b32 v166, 16, v36
    v_and_b32 v167, 0xffff0000, v36
    v_lshlrev_b32 v168, 16, v37
    v_and_b32 v169, 0xffff0000, v37
    v_lshlrev_b32 v170, 16, v38
    v_and_b32 v171, 0xffff0000, v38
    v_lshlrev_b32 v172, 16, v39
    v_and_b32 v173, 0xffff0000, v39
    v_lshlrev_b32 v174, 16, v40
    v_and_b32 v175, 0xffff0000, v40
    v_lshlrev_b32 v176, 16, v41
    v_and_b32 v177, 0xffff0000, v41
    v_lshlrev_b32 v178, 16, v42
    v_and_b32 v179, 0xffff0000, v42
    v_lshlrev_b32 v180, 16, v43
    v_and_b32 v181, 0xffff0000, v43
    v_lshlrev_b32 v182, 16, v44
    v_and_b32 v183, 0xffff0000, v44
    v_lshlrev_b32 v184, 16, v45
    v_and_b32 v185, 0xffff0000, v45
    buffer_load_dwordx4 v[54:57], v16, s[20:23], s45 offen offset:2048 sc1
    v_pk_mul_f32 v[166:167], v[166:167], v[32:33] op_sel:[0,1] op_sel_hi:[1,1]
    v_pk_mul_f32 v[168:169], v[168:169], v[32:33] op_sel:[0,1] op_sel_hi:[1,1]
    v_pk_mul_f32 v[170:171], v[170:171], v[32:33] op_sel:[0,1] op_sel_hi:[1,1]
    v_pk_mul_f32 v[172:173], v[172:173], v[32:33] op_sel:[0,1] op_sel_hi:[1,1]
    v_pk_mul_f32 v[174:175], v[174:175], v[32:33] op_sel:[0,1] op_sel_hi:[1,1]
    v_pk_mul_f32 v[176:177], v[176:177], v[32:33] op_sel:[0,1] op_sel_hi:[1,1]
    v_pk_mul_f32 v[178:179], v[178:179], v[32:33] op_sel:[0,1] op_sel_hi:[1,1]
    v_pk_mul_f32 v[180:181], v[180:181], v[32:33] op_sel:[0,1] op_sel_hi:[1,1]
    v_pk_mul_f32 v[182:183], v[182:183], v[32:33] op_sel:[0,1] op_sel_hi:[1,1]
    v_pk_mul_f32 v[184:185], v[184:185], v[32:33] op_sel:[0,1] op_sel_hi:[1,1]
    v_cvt_pk_bf16_f32 v36, v166, v167
    v_cvt_pk_bf16_f32 v37, v168, v169
    v_cvt_pk_bf16_f32 v38, v170, v171
    v_cvt_pk_bf16_f32 v39, v172, v173
    v_cvt_pk_bf16_f32 v40, v174, v175
    v_cvt_pk_bf16_f32 v41, v176, v177
    v_cvt_pk_bf16_f32 v42, v178, v179
    v_cvt_pk_bf16_f32 v43, v180, v181
    v_cvt_pk_bf16_f32 v44, v182, v183
    v_cvt_pk_bf16_f32 v45, v184, v185
    buffer_load_dwordx4 v[58:61], v16, s[20:23], s45 offen offset:3072 sc1
    s_lshl_b32 s40, s87, 19
    s_add_u32 s40, s40, 0x400000
    s_add_u32 s8, s72, s40
    s_addc_u32 s9, s73, 0
    s_mov_b32 s10, 0x80000
    s_mov_b32 s11, 0x20000
    s_mov_b32 s12, s68
    s_mov_b32 s13, s69
    s_mov_b32 s14, 0x280000
    s_mov_b32 s15, 0x20000
    s_add_u32 s40, s5, 0
    s_and_b32 s40, s40, 3
    s_lshl_b32 s41, s5, 2
    s_add_u32 s41, s41, s40
    s_lshl_b32 s41, s41, 10
    v_lshl_add_u32 v4, v19, 4, s41
    s_add_u32 s40, s5, 1
    s_and_b32 s40, s40, 3
    s_lshl_b32 s41, s5, 2
    s_add_u32 s41, s41, s40
    buffer_load_dwordx4 v[62:65], v17, s[20:23], s45 offen offset:0 sc1
    s_lshl_b32 s41, s41, 10
    v_lshl_add_u32 v5, v19, 4, s41
    s_add_u32 s40, s5, 2
    s_and_b32 s40, s40, 3
    s_lshl_b32 s41, s5, 2
    s_add_u32 s41, s41, s40
    s_lshl_b32 s41, s41, 10
    v_lshl_add_u32 v6, v19, 4, s41
    s_add_u32 s40, s5, 3
    s_and_b32 s40, s40, 3
    s_lshl_b32 s41, s5, 2
    s_add_u32 s41, s41, s40
    s_lshl_b32 s41, s41, 10
    v_lshl_add_u32 v7, v19, 4, s41
    v_lshl_add_u32 v9, v19, 4, s46
    v_add_u32 v10, 81920, v9
    s_waitcnt vmcnt(7)
    s_mov_b64 exec, 1
    buffer_store_dword v2, off, s[76:79], s58 sc1
    s_mov_b64 exec, -1
    s_mov_b32 s45, 184320
    buffer_load_dwordx4 v[66:69], v16, s[20:23], s45 offen offset:0 sc1
    buffer_load_dwordx4 v[70:73], v16, s[20:23], s45 offen offset:1024 sc1
    buffer_load_dwordx4 v[74:77], v16, s[20:23], s45 offen offset:2048 sc1
    buffer_load_dwordx4 v[78:81], v16, s[20:23], s45 offen offset:3072 sc1
    buffer_load_dwordx4 v[82:85], v17, s[20:23], s45 offen offset:0 sc1
    v_min3_u32 v252, v252, v253, v254
    v_min_u32 v252, v252, v255
    v_cmp_gt_u32 vcc, 2, v252
    s_and_b64 vcc, vcc, exec
    s_cbranch_scc1 L_spin_ffn
L_back_ffn:
    s_mul_i32 s40, s6, 27648
    s_lshl_b32 s41, s5, 10
    s_add_u32 s40, s40, s41
    v_lshlrev_b32 v194, 4, v19
    buffer_load_dwordx4 v[166:169], v194, s[16:19], s40 offen sc1
    s_add_u32 s40, s40, 4096
    buffer_load_dwordx4 v[170:173], v194, s[16:19], s40 offen sc1
    s_add_u32 s40, s40, 4096
    buffer_load_dwordx4 v[174:177], v194, s[16:19], s40 offen sc1
    s_add_u32 s40, s40, 4096
    buffer_load_dwordx4 v[178:181], v194, s[16:19], s40 offen sc1
    s_add_u32 s40, s40, 4096
    buffer_load_dwordx4 v[182:185], v194, s[16:19], s40 offen sc1
    s_add_u32 s40, s40, 4096
    buffer_load_dwordx4 v[186:189], v194, s[16:19], s40 offen sc1
    s_add_u32 s40, s40, 4096
    s_cmp_eq_u32 s5, 3
    s_cselect_b32 s40, 0x438000, s40
    buffer_load_dwordx4 v[190:193], v194, s[16:19], s40 offen sc1
    v_mov_b32 v11, 0x2000000
    s_not_b32 s40, s50
    s_and_b32 s40, s40, 0x7ff
    v_cmp_eq_u32 vcc, s40, v35
    s_mov_b32 s45, 204800
    buffer_load_dwordx4 v[86:89], v16, s[20:23], s45 offen offset:0 sc1
    v_mov_b32 v12, 0x29c000
    s_nop 0
    v_cndmask_b32 v11, v11, v12, vcc
    s_not_b32 s40, s51
    buffer_load_dwordx4 v[90:93], v16, s[20:23], s45 offen offset:1024 sc1
    s_and_b32 s40, s40, 0x7ff
    v_cmp_eq_u32 vcc, s40, v35
    v_mov_b32 v12, 0x29c500
    s_nop 0
    buffer_load_dwordx4 v[94:97], v16, s[20:23], s45 offen offset:2048 sc1
    v_cndmask_b32 v11, v11, v12, vcc
    s_not_b32 s40, s52
    s_and_b32 s40, s40, 0x7ff
    v_cmp_eq_u32 vcc, s40, v35
    buffer_load_dwordx4 v[98:101], v16, s[20:23], s45 offen offset:3072 sc1
    v_mov_b32 v12, 0x29ca00
    s_nop 0
    v_cndmask_b32 v11, v11, v12, vcc
    s_not_b32 s40, s53
    buffer_load_dwordx4 v[102:105], v17, s[20:23], s45 offen offset:0 sc1
    s_and_b32 s40, s40, 0x7ff
    v_cmp_eq_u32 vcc, s40, v35
    v_mov_b32 v12, 0x29cf00
    s_nop 0
    s_mov_b32 s45, 225280
    buffer_load_dwordx4 v[106:109], v16, s[20:23], s45 offen offset:0 sc1
    v_cndmask_b32 v11, v11, v12, vcc
    s_not_b32 s40, s54
    s_and_b32 s40, s40, 0x7ff
    v_cmp_eq_u32 vcc, s40, v35
    buffer_load_dwordx4 v[110:113], v16, s[20:23], s45 offen offset:1024 sc1
    v_mov_b32 v12, 0x29d400
    s_nop 0
    v_cndmask_b32 v11, v11, v12, vcc
    s_not_b32 s40, s55
    buffer_load_dwordx4 v[114:117], v16, s[20:23], s45 offen offset:2048 sc1
    s_and_b32 s40, s40, 0x7ff
    v_cmp_eq_u32 vcc, s40, v35
    v_mov_b32 v12, 0x29d900
    s_nop 0
    buffer_load_dwordx4 v[118:121], v16, s[20:23], s45 offen offset:3072 sc1
    v_cndmask_b32 v11, v11, v12, vcc
    s_not_b32 s40, s56
    s_and_b32 s40, s40, 0x7ff
    v_cmp_eq_u32 vcc, s40, v35
    buffer_load_dwordx4 v[122:125], v17, s[20:23], s45 offen offset:0 sc1
    v_mov_b32 v12, 0x29de00
    s_nop 0
    v_cndmask_b32 v11, v11, v12, vcc
    s_not_b32 s40, s57
    s_mov_b32 s45, 245760
    buffer_load_dwordx4 v[126:129], v16, s[20:23], s45 offen offset:0 sc1
    s_and_b32 s40, s40, 0x7ff
    v_cmp_eq_u32 vcc, s40, v35
    v_mov_b32 v12, 0x29e300
    s_nop 0
    buffer_load_dwordx4 v[130:133], v16, s[20:23], s45 offen offset:1024 sc1
    v_cndmask_b32 v11, v11, v12, vcc
    v_mul_u32_u24 v12, 1280, v35
    v_sub_u32 v12, v34, v12
    v_add_u32 v11, v11, v12
    buffer_load_dwordx4 v[134:137], v16, s[20:23], s45 offen offset:2048 sc1
    buffer_load_dwordx4 v[138:141], v16, s[20:23], s45 offen offset:3072 sc1
    buffer_load_dwordx4 v[142:145], v17, s[20:23], s45 offen offset:0 sc1
    s_waitcnt vmcnt(15)
    v_add_f32 v166, v166, v170
    v_add_f32 v167, v167, v171
    v_add_f32 v168, v168, v172
    v_add_f32 v169, v169, v173
    v_add_f32 v166, v166, v174
    s_mov_b32 s45, 266240
    buffer_load_dwordx4 v[146:149], v16, s[20:23], s45 offen offset:0 sc1
    v_add_f32 v167, v167, v175
    v_add_f32 v168, v168, v176
    v_add_f32 v169, v169, v177
    v_add_f32 v166, v166, v178
    v_add_f32 v167, v167, v179
    buffer_load_dwordx4 v[150:153], v16, s[20:23], s45 offen offset:1024 sc1
    v_add_f32 v168, v168, v180
    v_add_f32 v169, v169, v181
    v_add_f32 v166, v166, v182
    v_add_f32 v167, v167, v183
    v_add_f32 v168, v168, v184
    buffer_load_dwordx4 v[154:157], v16, s[20:23], s45 offen offset:2048 sc1
    v_add_f32 v169, v169, v185
    v_add_f32 v166, v166, v186
    v_add_f32 v167, v167, v187
    v_add_f32 v168, v168, v188
    v_add_f32 v169, v169, v189
    buffer_load_dwordx4 v[158:161], v16, s[20:23], s45 offen offset:3072 sc1
    v_add_f32 v166, v166, v190
    v_add_f32 v167, v167, v191
    v_add_f32 v168, v168, v192
    v_add_f32 v169, v169, v193
    v_add_f32_dpp v166, v166, v166 row_ror:8 row_mask:0xf bank_mask:0xf
    buffer_load_dwordx4 v[162:165], v17, s[20:23], s45 offen offset:0 sc1
    v_add_f32_dpp v167, v167, v167 row_ror:8 row_mask:0xf bank_mask:0xf
    v_add_f32_dpp v168, v168, v168 row_ror:8 row_mask:0xf bank_mask:0xf
    v_add_f32_dpp v169, v169, v169 row_ror:8 row_mask:0xf bank_mask:0xf
    v_mov_b32 v170, v166
    v_mov_b32 v171, v167
    v_mov_b32 v172, v168
    v_mov_b32 v173, v169
    v_permlane16_swap_b32 v166, v170
    v_permlane16_swap_b32 v167, v171
    v_permlane16_swap_b32 v168, v172
    v_permlane16_swap_b32 v169, v173
    v_add_f32 v166, v166, v170
    v_add_f32 v167, v167, v171
    v_add_f32 v168, v168, v172
    v_add_f32 v169, v169, v173
    v_mov_b32 v170, v166
    v_mov_b32 v171, v167
    v_mov_b32 v172, v168
    v_mov_b32 v173, v169
    v_permlane32_swap_b32 v166, v170
    v_permlane32_swap_b32 v167, v171
    v_permlane32_swap_b32 v168, v172
    v_permlane32_swap_b32 v169, v173
    v_add_f32 v166, v166, v170
    v_add_f32 v167, v167, v171
    v_add_f32 v168, v168, v172
    v_add_f32 v169, v169, v173
    v_and_b32 v194, 7, v19
    v_lshlrev_b32 v194, 4, v194
    v_add_u32 v194, 81920, v194
    s_lshl_b32 s40, s5, 7
    v_add_u32 v195, s40, v194
    ds_write_b128 v195, v[166:169]
    s_waitcnt lgkmcnt(0)
    s_barrier
    s_add_u32 m0, s46, 0
    s_mov_b32 s45, 327680
    buffer_load_dwordx4 v16, s[20:23], s45 offen offset:0 sc1 lds
    buffer_load_dwordx4 v16, s[20:23], s45 offen offset:1024 sc1 lds
    buffer_load_dwordx4 v16, s[20:23], s45 offen offset:2048 sc1 lds
    buffer_load_dwordx4 v16, s[20:23], s45 offen offset:3072 sc1 lds
    s_add_u32 m0, s46, 4096
    s_nop 0
    buffer_load_dwordx4 v17, s[20:23], s45 offen offset:0 sc1 lds
    s_add_u32 m0, s46, 5120
    s_mov_b32 s45, 348160
    buffer_load_dwordx4 v16, s[20:23], s45 offen offset:0 sc1 lds
    buffer_load_dwordx4 v16, s[20:23], s45 offen offset:1024 sc1 lds
    buffer_load_dwordx4 v16, s[20:23], s45 offen offset:2048 sc1 lds
    buffer_load_dwordx4 v16, s[20:23], s45 offen offset:3072 sc1 lds
    s_add_u32 m0, s46, 9216
    s_nop 0
    buffer_load_dwordx4 v17, s[20:23], s45 offen offset:0 sc1 lds
    s_cmp_lg_u32 s5, 0
    s_cbranch_scc1 L_summed
    ds_read_b128 v[166:169], v194 offset:0
    ds_read_b128 v[170:173], v194 offset:128
    ds_read_b128 v[174:177], v194 offset:256
    ds_read_b128 v[178:181], v194 offset:384
    s_mul_i32 s42, s6, 3277
    s_lshr_b32 s42, s42, 16
    s_min_u32 s42, s42, 7
    v_readlane_b32 s40, v3, s42
    s_and_b32 s40, s40, 0xffff0000
    s_ashr_i32 s41, s40, 31
    s_andn2_b32 s41, 0x7fff0000, s41
    s_or_b32 s41, s41, 0x80000000
    s_xor_b32 s40, s40, s41
    v_mov_b32 v182, 0xbfb8aa3b
    v_mul_f32 v182, s40, v182
    v_exp_f32 v182, v182
    s_nop 0
    v_add_f32 v182, 1.0, v182
    v_rcp_f32 v182, v182
    s_nop 0
    v_cvt_pk_bf16_f32 v182, v182, v182
    v_lshlrev_b32 v182, 16, v182
    s_lshl_b32 s40, s6, 6
    s_add_u32 s40, s40, 0x29c000
    s_cmp_lt_u32 s6, 160
    s_cselect_b32 s40, s40, 0x2000000
    v_lshlrev_b32 v183, 3, v19
    s_waitcnt lgkmcnt(0)
    v_add_f32 v166, v166, v170
    v_add_f32 v167, v167, v171
    v_add_f32 v168, v168, v172
    v_add_f32 v169, v169, v173
    v_add_f32 v166, v166, v174
    v_add_f32 v167, v167, v175
    v_add_f32 v168, v168, v176
    v_add_f32 v169, v169, v177
    v_add_f32 v166, v166, v178
    v_add_f32 v167, v167, v179
    v_add_f32 v168, v168, v180
    v_add_f32 v169, v169, v181
    v_cvt_pk_bf16_f32 v170, v166, v167
    v_cvt_pk_bf16_f32 v171, v168, v169
    v_lshlrev_b32 v166, 16, v170
    v_and_b32 v167, 0xffff0000, v170
    v_lshlrev_b32 v168, 16, v171
    v_and_b32 v169, 0xffff0000, v171
    v_mul_f32 v166, v166, v182
    v_mul_f32 v167, v167, v182
    v_mul_f32 v168, v168, v182
    v_mul_f32 v169, v169, v182
    v_cvt_pk_bf16_f32 v170, v166, v167
    v_cvt_pk_bf16_f32 v171, v168, v169
    s_mov_b64 exec, 0xff
    buffer_store_dwordx2 v[170:171], v183, s[76:79], s40 offen sc1
    s_mov_b64 exec, -1
L_summed:
    s_lshl_b32 s40, s87, 10
    s_add_u32 s40, s40, 0x292000
    v_and_b32 v1, 7, v19
    v_lshl_add_u32 v1, v1, 7, s40
    buffer_load_dwordx4 v[252:255], v1, s[76:79], 0 offen sc1
    s_add_u32 m0, s46, 40960
    s_mov_b32 s45, 368640
    buffer_load_dwordx4 v16, s[20:23], s45 offen offset:0 sc1 lds
    buffer_load_dwordx4 v16, s[20:23], s45 offen offset:1024 sc1 lds
    buffer_load_dwordx4 v16, s[20:23], s45 offen offset:2048 sc1 lds
    buffer_load_dwordx4 v16, s[20:23], s45 offen offset:3072 sc1 lds
    s_add_u32 m0, s46, 45056
    s_nop 0
    buffer_load_dwordx4 v17, s[20:23], s45 offen offset:0 sc1 lds
    s_add_u32 m0, s46, 46080
    s_mov_b32 s45, 389120
    buffer_load_dwordx4 v16, s[20:23], s45 offen offset:0 sc1 lds
    buffer_load_dwordx4 v16, s[20:23], s45 offen offset:1024 sc1 lds
    buffer_load_dwordx4 v16, s[20:23], s45 offen offset:2048 sc1 lds
    buffer_load_dwordx4 v16, s[20:23], s45 offen offset:3072 sc1 lds
    s_add_u32 m0, s46, 50176
    s_nop 0
    buffer_load_dwordx4 v17, s[20:23], s45 offen offset:0 sc1 lds
    s_add_u32 m0, s46, 81920
    s_mov_b32 s45, 409600
    buffer_load_dwordx4 v16, s[20:23], s45 offen offset:0 sc1 lds
    buffer_load_dwordx4 v16, s[20:23], s45 offen offset:1024 sc1 lds
    buffer_load_dwordx4 v16, s[20:23], s45 offen offset:2048 sc1 lds
    buffer_load_dwordx4 v16, s[20:23], s45 offen offset:3072 sc1 lds
    s_add_u32 m0, s46, 86016
    s_nop 0
    buffer_load_dwordx4 v17, s[20:23], s45 offen offset:0 sc1 lds
    s_add_u32 m0, s46, 87040
    s_mov_b32 s45, 430080
    buffer_load_dwordx4 v16, s[20:23], s45 offen offset:0 sc1 lds
    buffer_load_dwordx4 v16, s[20:23], s45 offen offset:1024 sc1 lds
    buffer_load_dwordx4 v16, s[20:23], s45 offen offset:2048 sc1 lds
    buffer_load_dwordx4 v16, s[20:23], s45 offen offset:3072 sc1 lds
    s_add_u32 m0, s46, 91136
    s_nop 0
    buffer_load_dwordx4 v17, s[20:23], s45 offen offset:0 sc1 lds
    v_mov_b32 v2, 3
    s_cmp_lg_u32 s5, 0
    s_cbranch_scc1 L_back_o
    s_waitcnt vmcnt(20)
    s_mov_b64 exec, 1
    buffer_store_dword v2, off, s[76:79], s75 sc1
    s_mov_b64 exec, -1
    v_min3_u32 v252, v252, v253, v254
    v_min_u32 v252, v252, v255
    v_cmp_gt_u32 vcc, 1, v252
    s_and_b64 vcc, vcc, exec
    s_cbranch_scc1 L_spin_o
L_back_o:
    s_barrier
    s_mov_b32 s44, 0
    buffer_load_dwordx4 a[96:99], v4, s[8:11], s44 offen sc1
    buffer_load_dwordx4 a[100:103], v5, s[8:11], s44 offen sc1
    buffer_load_dwordx4 a[104:107], v6, s[8:11], s44 offen sc1
    buffer_load_dwordx4 a[108:111], v7, s[8:11], s44 offen sc1
    s_mov_b32 s44, 16384
    buffer_load_dwordx4 a[112:115], v4, s[8:11], s44 offen sc1
    buffer_load_dwordx4 a[116:119], v5, s[8:11], s44 offen sc1
    buffer_load_dwordx4 a[120:123], v6, s[8:11], s44 offen sc1
    buffer_load_dwordx4 a[124:127], v7, s[8:11], s44 offen sc1
    s_mov_b32 s44, 32768
    buffer_load_dwordx4 a[192:195], v4, s[8:11], s44 offen sc1
    buffer_load_dwordx4 a[196:199], v5, s[8:11], s44 offen sc1
    buffer_load_dwordx4 a[200:203], v6, s[8:11], s44 offen sc1
    buffer_load_dwordx4 a[204:207], v7, s[8:11], s44 offen sc1
    s_mov_b32 s44, 49152
    buffer_load_dwordx4 a[208:211], v4, s[8:11], s44 offen sc1
    buffer_load_dwordx4 a[212:215], v5, s[8:11], s44 offen sc1
    buffer_load_dwordx4 a[216:219], v6, s[8:11], s44 offen sc1
    buffer_load_dwordx4 a[220:223], v7, s[8:11], s44 offen sc1
    s_waitcnt vmcnt(8)
    v_mfma_f32_16x16x32_bf16 v[166:169], a[128:131], a[96:99], 0
    s_mov_b32 s44, 65536
    buffer_load_dwordx4 a[224:227], v4, s[8:11], s44 offen sc1
    v_mfma_f32_16x16x32_bf16 v[166:169], a[148:151], a[112:115], v[166:169]
    v_mfma_f32_16x16x32_bf16 v[186:189], a[148:151], a[116:119], 0
    v_mfma_f32_16x16x32_bf16 v[186:189], a[128:131], a[100:103], v[186:189]
    buffer_load_dwordx4 a[228:231], v5, s[8:11], s44 offen sc1
    v_mfma_f32_16x16x32_bf16 v[206:209], a[128:131], a[104:107], 0
    v_mfma_f32_16x16x32_bf16 v[206:209], a[148:151], a[120:123], v[206:209]
    v_mfma_f32_16x16x32_bf16 v[226:229], a[148:151], a[124:127], 0
    v_mfma_f32_16x16x32_bf16 v[226:229], a[128:131], a[108:111], v[226:229]
    buffer_load_dwordx4 a[232:235], v6, s[8:11], s44 offen sc1
    v_mfma_f32_16x16x32_bf16 v[170:173], a[132:135], a[96:99], 0
    v_mfma_f32_16x16x32_bf16 v[170:173], a[152:155], a[112:115], v[170:173]
    v_mfma_f32_16x16x32_bf16 v[190:193], a[152:155], a[116:119], 0
    v_mfma_f32_16x16x32_bf16 v[190:193], a[132:135], a[100:103], v[190:193]
    buffer_load_dwordx4 a[236:239], v7, s[8:11], s44 offen sc1
    v_mfma_f32_16x16x32_bf16 v[210:213], a[132:135], a[104:107], 0
    v_mfma_f32_16x16x32_bf16 v[210:213], a[152:155], a[120:123], v[210:213]
    v_mfma_f32_16x16x32_bf16 v[230:233], a[152:155], a[124:127], 0
    v_mfma_f32_16x16x32_bf16 v[230:233], a[132:135], a[108:111], v[230:233]
    s_mov_b32 s44, 81920
    buffer_load_dwordx4 a[240:243], v4, s[8:11], s44 offen sc1
    v_mfma_f32_16x16x32_bf16 v[174:177], a[136:139], a[96:99], 0
    v_mfma_f32_16x16x32_bf16 v[174:177], a[156:159], a[112:115], v[174:177]
    v_mfma_f32_16x16x32_bf16 v[194:197], a[156:159], a[116:119], 0
    buffer_load_dwordx4 a[244:247], v5, s[8:11], s44 offen sc1
    v_mfma_f32_16x16x32_bf16 v[194:197], a[136:139], a[100:103], v[194:197]
    v_mfma_f32_16x16x32_bf16 v[214:217], a[136:139], a[104:107], 0
    v_mfma_f32_16x16x32_bf16 v[214:217], a[156:159], a[120:123], v[214:217]
    v_mfma_f32_16x16x32_bf16 v[234:237], a[156:159], a[124:127], 0
    buffer_load_dwordx4 a[248:251], v6, s[8:11], s44 offen sc1
    v_mfma_f32_16x16x32_bf16 v[234:237], a[136:139], a[108:111], v[234:237]
    v_mfma_f32_16x16x32_bf16 v[178:181], a[140:143], a[96:99], 0
    v_mfma_f32_16x16x32_bf16 v[178:181], a[160:163], a[112:115], v[178:181]
    v_mfma_f32_16x16x32_bf16 v[198:201], a[160:163], a[116:119], 0
    buffer_load_dwordx4 a[252:255], v7, s[8:11], s44 offen sc1
    v_mfma_f32_16x16x32_bf16 v[198:201], a[140:143], a[100:103], v[198:201]
    v_mfma_f32_16x16x32_bf16 v[218:221], a[140:143], a[104:107], 0
    v_mfma_f32_16x16x32_bf16 v[218:221], a[160:163], a[120:123], v[218:221]
    v_mfma_f32_16x16x32_bf16 v[238:241], a[160:163], a[124:127], 0
    v_mfma_f32_16x16x32_bf16 v[238:241], a[140:143], a[108:111], v[238:241]
    v_mfma_f32_16x16x32_bf16 v[182:185], a[144:147], a[96:99], 0
    v_mfma_f32_16x16x32_bf16 v[182:185], a[164:167], a[112:115], v[182:185]
    v_mfma_f32_16x16x32_bf16 v[202:205], a[164:167], a[116:119], 0
    v_mfma_f32_16x16x32_bf16 v[202:205], a[144:147], a[100:103], v[202:205]
    v_mfma_f32_16x16x32_bf16 v[222:225], a[144:147], a[104:107], 0
    v_mfma_f32_16x16x32_bf16 v[222:225], a[164:167], a[120:123], v[222:225]
    v_mfma_f32_16x16x32_bf16 v[242:245], a[164:167], a[124:127], 0
    v_mfma_f32_16x16x32_bf16 v[242:245], a[144:147], a[108:111], v[242:245]
    s_waitcnt vmcnt(8)
    v_mfma_f32_16x16x32_bf16 v[166:169], a[168:171], a[192:195], v[166:169]
    s_mov_b32 s44, 98304
    buffer_load_dwordx4 a[96:99], v4, s[8:11], s44 offen sc1
    v_mfma_f32_16x16x32_bf16 v[166:169], a[188:191], a[208:211], v[166:169]
    v_mfma_f32_16x16x32_bf16 v[186:189], a[188:191], a[212:215], v[186:189]
    buffer_load_dwordx4 a[100:103], v5, s[8:11], s44 offen sc1
    v_mfma_f32_16x16x32_bf16 v[186:189], a[168:171], a[196:199], v[186:189]
    v_mfma_f32_16x16x32_bf16 v[206:209], a[168:171], a[200:203], v[206:209]
    v_mfma_f32_16x16x32_bf16 v[206:209], a[188:191], a[216:219], v[206:209]
    buffer_load_dwordx4 a[104:107], v6, s[8:11], s44 offen sc1
    v_mfma_f32_16x16x32_bf16 v[226:229], a[188:191], a[220:223], v[226:229]
    v_mfma_f32_16x16x32_bf16 v[226:229], a[168:171], a[204:207], v[226:229]
    buffer_load_dwordx4 a[108:111], v7, s[8:11], s44 offen sc1
    v_mfma_f32_16x16x32_bf16 v[170:173], a[172:175], a[192:195], v[170:173]
    v_mfma_f32_16x16x32_bf16 v[170:173], a[0:3], a[208:211], v[170:173]
    v_mfma_f32_16x16x32_bf16 v[190:193], a[0:3], a[212:215], v[190:193]
    s_mov_b32 s44, 114688
    buffer_load_dwordx4 a[112:115], v4, s[8:11], s44 offen sc1
    v_mfma_f32_16x16x32_bf16 v[190:193], a[172:175], a[196:199], v[190:193]
    v_mfma_f32_16x16x32_bf16 v[210:213], a[172:175], a[200:203], v[210:213]
    buffer_load_dwordx4 a[116:119], v5, s[8:11], s44 offen sc1
    v_mfma_f32_16x16x32_bf16 v[210:213], a[0:3], a[216:219], v[210:213]
    v_mfma_f32_16x16x32_bf16 v[230:233], a[0:3], a[220:223], v[230:233]
    v_mfma_f32_16x16x32_bf16 v[230:233], a[172:175], a[204:207], v[230:233]
    buffer_load_dwordx4 a[120:123], v6, s[8:11], s44 offen sc1
    v_mfma_f32_16x16x32_bf16 v[174:177], a[176:179], a[192:195], v[174:177]
    v_mfma_f32_16x16x32_bf16 v[174:177], a[4:7], a[208:211], v[174:177]
    buffer_load_dwordx4 a[124:127], v7, s[8:11], s44 offen sc1
    v_mfma_f32_16x16x32_bf16 v[194:197], a[4:7], a[212:215], v[194:197]
    v_mfma_f32_16x16x32_bf16 v[194:197], a[176:179], a[196:199], v[194:197]
    v_mfma_f32_16x16x32_bf16 v[214:217], a[176:179], a[200:203], v[214:217]
    s_mov_b32 s45, 450560
    buffer_load_dwordx4 a[128:131], v16, s[20:23], s45 offen offset:0 sc1
    v_mfma_f32_16x16x32_bf16 v[214:217], a[4:7], a[216:219], v[214:217]
    v_mfma_f32_16x16x32_bf16 v[234:237], a[4:7], a[220:223], v[234:237]
    buffer_load_dwordx4 a[132:135], v16, s[20:23], s45 offen offset:1024 sc1
    v_mfma_f32_16x16x32_bf16 v[234:237], a[176:179], a[204:207], v[234:237]
    v_mfma_f32_16x16x32_bf16 v[178:181], a[180:183], a[192:195], v[178:181]
    v_mfma_f32_16x16x32_bf16 v[178:181], a[8:11], a[208:211], v[178:181]
    buffer_load_dwordx4 a[136:139], v16, s[20:23], s45 offen offset:2048 sc1
    v_mfma_f32_16x16x32_bf16 v[198:201], a[8:11], a[212:215], v[198:201]
    v_mfma_f32_16x16x32_bf16 v[198:201], a[180:183], a[196:199], v[198:201]
    buffer_load_dwordx4 a[140:143], v16, s[20:23], s45 offen offset:3072 sc1
    v_mfma_f32_16x16x32_bf16 v[218:221], a[180:183], a[200:203], v[218:221]
    v_mfma_f32_16x16x32_bf16 v[218:221], a[8:11], a[216:219], v[218:221]
    v_mfma_f32_16x16x32_bf16 v[238:241], a[8:11], a[220:223], v[238:241]
    v_mfma_f32_16x16x32_bf16 v[238:241], a[180:183], a[204:207], v[238:241]
    v_mfma_f32_16x16x32_bf16 v[182:185], a[184:187], a[192:195], v[182:185]
    v_mfma_f32_16x16x32_bf16 v[182:185], a[12:15], a[208:211], v[182:185]
    v_mfma_f32_16x16x32_bf16 v[202:205], a[12:15], a[212:215], v[202:205]
    v_mfma_f32_16x16x32_bf16 v[202:205], a[184:187], a[196:199], v[202:205]
    v_mfma_f32_16x16x32_bf16 v[222:225], a[184:187], a[200:203], v[222:225]
    v_mfma_f32_16x16x32_bf16 v[222:225], a[12:15], a[216:219], v[222:225]
    v_mfma_f32_16x16x32_bf16 v[242:245], a[12:15], a[220:223], v[242:245]
    v_mfma_f32_16x16x32_bf16 v[242:245], a[184:187], a[204:207], v[242:245]
    s_waitcnt vmcnt(12)
    v_mfma_f32_16x16x32_bf16 v[166:169], a[16:19], a[224:227], v[166:169]
    s_mov_b32 s44, 131072
    buffer_load_dwordx4 a[192:195], v4, s[8:11], s44 offen sc1
    v_mfma_f32_16x16x32_bf16 v[166:169], a[36:39], a[240:243], v[166:169]
    v_mfma_f32_16x16x32_bf16 v[186:189], a[36:39], a[244:247], v[186:189]
    buffer_load_dwordx4 a[196:199], v5, s[8:11], s44 offen sc1
    v_mfma_f32_16x16x32_bf16 v[186:189], a[16:19], a[228:231], v[186:189]
    v_mfma_f32_16x16x32_bf16 v[206:209], a[16:19], a[232:235], v[206:209]
    v_mfma_f32_16x16x32_bf16 v[206:209], a[36:39], a[248:251], v[206:209]
    buffer_load_dwordx4 a[200:203], v6, s[8:11], s44 offen sc1
    v_mfma_f32_16x16x32_bf16 v[226:229], a[36:39], a[252:255], v[226:229]
    v_mfma_f32_16x16x32_bf16 v[226:229], a[16:19], a[236:239], v[226:229]
    buffer_load_dwordx4 a[204:207], v7, s[8:11], s44 offen sc1
    v_mfma_f32_16x16x32_bf16 v[170:173], a[20:23], a[224:227], v[170:173]
    v_mfma_f32_16x16x32_bf16 v[170:173], a[40:43], a[240:243], v[170:173]
    v_mfma_f32_16x16x32_bf16 v[190:193], a[40:43], a[244:247], v[190:193]
    s_mov_b32 s44, 147456
    buffer_load_dwordx4 a[208:211], v4, s[8:11], s44 offen sc1
    v_mfma_f32_16x16x32_bf16 v[190:193], a[20:23], a[228:231], v[190:193]
    v_mfma_f32_16x16x32_bf16 v[210:213], a[20:23], a[232:235], v[210:213]
    buffer_load_dwordx4 a[212:215], v5, s[8:11], s44 offen sc1
    v_mfma_f32_16x16x32_bf16 v[210:213], a[40:43], a[248:251], v[210:213]
    v_mfma_f32_16x16x32_bf16 v[230:233], a[40:43], a[252:255], v[230:233]
    v_mfma_f32_16x16x32_bf16 v[230:233], a[20:23], a[236:239], v[230:233]
    buffer_load_dwordx4 a[216:219], v6, s[8:11], s44 offen sc1
    v_mfma_f32_16x16x32_bf16 v[174:177], a[24:27], a[224:227], v[174:177]
    v_mfma_f32_16x16x32_bf16 v[174:177], a[44:47], a[240:243], v[174:177]
    buffer_load_dwordx4 a[220:223], v7, s[8:11], s44 offen sc1
    v_mfma_f32_16x16x32_bf16 v[194:197], a[44:47], a[244:247], v[194:197]
    v_mfma_f32_16x16x32_bf16 v[194:197], a[24:27], a[228:231], v[194:197]
    v_mfma_f32_16x16x32_bf16 v[214:217], a[24:27], a[232:235], v[214:217]
    buffer_load_dwordx4 a[144:147], v17, s[20:23], s45 offen offset:0 sc1
    v_mfma_f32_16x16x32_bf16 v[214:217], a[44:47], a[248:251], v[214:217]
    v_mfma_f32_16x16x32_bf16 v[234:237], a[44:47], a[252:255], v[234:237]
    s_mov_b32 s45, 471040
    buffer_load_dwordx4 a[148:151], v16, s[20:23], s45 offen offset:0 sc1
    v_mfma_f32_16x16x32_bf16 v[234:237], a[24:27], a[236:239], v[234:237]
    v_mfma_f32_16x16x32_bf16 v[178:181], a[28:31], a[224:227], v[178:181]
    v_mfma_f32_16x16x32_bf16 v[178:181], a[48:51], a[240:243], v[178:181]
    buffer_load_dwordx4 a[152:155], v16, s[20:23], s45 offen offset:1024 sc1
    v_mfma_f32_16x16x32_bf16 v[198:201], a[48:51], a[244:247], v[198:201]
    v_mfma_f32_16x16x32_bf16 v[198:201], a[28:31], a[228:231], v[198:201]
    buffer_load_dwordx4 a[156:159], v16, s[20:23], s45 offen offset:2048 sc1
    v_mfma_f32_16x16x32_bf16 v[218:221], a[28:31], a[232:235], v[218:221]
    v_mfma_f32_16x16x32_bf16 v[218:221], a[48:51], a[248:251], v[218:221]
    v_mfma_f32_16x16x32_bf16 v[238:241], a[48:51], a[252:255], v[238:241]
    v_mfma_f32_16x16x32_bf16 v[238:241], a[28:31], a[236:239], v[238:241]
    v_mfma_f32_16x16x32_bf16 v[182:185], a[32:35], a[224:227], v[182:185]
    v_mfma_f32_16x16x32_bf16 v[182:185], a[52:55], a[240:243], v[182:185]
    v_mfma_f32_16x16x32_bf16 v[202:205], a[52:55], a[244:247], v[202:205]
    v_mfma_f32_16x16x32_bf16 v[202:205], a[32:35], a[228:231], v[202:205]
    v_mfma_f32_16x16x32_bf16 v[222:225], a[32:35], a[232:235], v[222:225]
    v_mfma_f32_16x16x32_bf16 v[222:225], a[52:55], a[248:251], v[222:225]
    v_mfma_f32_16x16x32_bf16 v[242:245], a[52:55], a[252:255], v[242:245]
    v_mfma_f32_16x16x32_bf16 v[242:245], a[32:35], a[236:239], v[242:245]
    s_waitcnt vmcnt(16)
    v_mfma_f32_16x16x32_bf16 v[166:169], a[56:59], a[96:99], v[166:169]
    s_mov_b32 s44, 163840
    buffer_load_dwordx4 a[224:227], v4, s[8:11], s44 offen sc1
    v_mfma_f32_16x16x32_bf16 v[166:169], a[76:79], a[112:115], v[166:169]
    v_mfma_f32_16x16x32_bf16 v[186:189], a[76:79], a[116:119], v[186:189]
    buffer_load_dwordx4 a[228:231], v5, s[8:11], s44 offen sc1
    v_mfma_f32_16x16x32_bf16 v[186:189], a[56:59], a[100:103], v[186:189]
    v_mfma_f32_16x16x32_bf16 v[206:209], a[56:59], a[104:107], v[206:209]
    v_mfma_f32_16x16x32_bf16 v[206:209], a[76:79], a[120:123], v[206:209]
    buffer_load_dwordx4 a[232:235], v6, s[8:11], s44 offen sc1
    v_mfma_f32_16x16x32_bf16 v[226:229], a[76:79], a[124:127], v[226:229]
    v_mfma_f32_16x16x32_bf16 v[226:229], a[56:59], a[108:111], v[226:229]
    buffer_load_dwordx4 a[236:239], v7, s[8:11], s44 offen sc1
    v_mfma_f32_16x16x32_bf16 v[170:173], a[60:63], a[96:99], v[170:173]
    v_mfma_f32_16x16x32_bf16 v[170:173], a[80:83], a[112:115], v[170:173]
    v_mfma_f32_16x16x32_bf16 v[190:193], a[80:83], a[116:119], v[190:193]
    s_mov_b32 s44, 180224
    buffer_load_dwordx4 a[240:243], v4, s[8:11], s44 offen sc1
    v_mfma_f32_16x16x32_bf16 v[190:193], a[60:63], a[100:103], v[190:193]
    v_mfma_f32_16x16x32_bf16 v[210:213], a[60:63], a[104:107], v[210:213]
    buffer_load_dwordx4 a[244:247], v5, s[8:11], s44 offen sc1
    v_mfma_f32_16x16x32_bf16 v[210:213], a[80:83], a[120:123], v[210:213]
    v_mfma_f32_16x16x32_bf16 v[230:233], a[80:83], a[124:127], v[230:233]
    v_mfma_f32_16x16x32_bf16 v[230:233], a[60:63], a[108:111], v[230:233]
    buffer_load_dwordx4 a[248:251], v6, s[8:11], s44 offen sc1
    v_mfma_f32_16x16x32_bf16 v[174:177], a[64:67], a[96:99], v[174:177]
    v_mfma_f32_16x16x32_bf16 v[174:177], a[84:87], a[112:115], v[174:177]
    buffer_load_dwordx4 a[252:255], v7, s[8:11], s44 offen sc1
    v_mfma_f32_16x16x32_bf16 v[194:197], a[84:87], a[116:119], v[194:197]
    v_mfma_f32_16x16x32_bf16 v[194:197], a[64:67], a[100:103], v[194:197]
    v_mfma_f32_16x16x32_bf16 v[214:217], a[64:67], a[104:107], v[214:217]
    buffer_load_dwordx4 a[160:163], v16, s[20:23], s45 offen offset:3072 sc1
    v_mfma_f32_16x16x32_bf16 v[214:217], a[84:87], a[120:123], v[214:217]
    v_mfma_f32_16x16x32_bf16 v[234:237], a[84:87], a[124:127], v[234:237]
    buffer_load_dwordx4 a[164:167], v17, s[20:23], s45 offen offset:0 sc1
    v_mfma_f32_16x16x32_bf16 v[234:237], a[64:67], a[108:111], v[234:237]
    v_mfma_f32_16x16x32_bf16 v[178:181], a[68:71], a[96:99], v[178:181]
    v_mfma_f32_16x16x32_bf16 v[178:181], a[88:91], a[112:115], v[178:181]
    s_mov_b32 s45, 491520
    buffer_load_dwordx4 a[168:171], v16, s[20:23], s45 offen offset:0 sc1
    v_mfma_f32_16x16x32_bf16 v[198:201], a[88:91], a[116:119], v[198:201]
    v_mfma_f32_16x16x32_bf16 v[198:201], a[68:71], a[100:103], v[198:201]
    buffer_load_dwordx4 a[172:175], v16, s[20:23], s45 offen offset:1024 sc1
    v_mfma_f32_16x16x32_bf16 v[218:221], a[68:71], a[104:107], v[218:221]
    v_mfma_f32_16x16x32_bf16 v[218:221], a[88:91], a[120:123], v[218:221]
    v_mfma_f32_16x16x32_bf16 v[238:241], a[88:91], a[124:127], v[238:241]
    v_mfma_f32_16x16x32_bf16 v[238:241], a[68:71], a[108:111], v[238:241]
    v_mfma_f32_16x16x32_bf16 v[182:185], a[72:75], a[96:99], v[182:185]
    v_mfma_f32_16x16x32_bf16 v[182:185], a[92:95], a[112:115], v[182:185]
    v_mfma_f32_16x16x32_bf16 v[202:205], a[92:95], a[116:119], v[202:205]
    v_mfma_f32_16x16x32_bf16 v[202:205], a[72:75], a[100:103], v[202:205]
    v_mfma_f32_16x16x32_bf16 v[222:225], a[72:75], a[104:107], v[222:225]
    v_mfma_f32_16x16x32_bf16 v[222:225], a[92:95], a[120:123], v[222:225]
    v_mfma_f32_16x16x32_bf16 v[242:245], a[92:95], a[124:127], v[242:245]
    v_mfma_f32_16x16x32_bf16 v[242:245], a[72:75], a[108:111], v[242:245]
    s_waitcnt vmcnt(16)
    v_mfma_f32_16x16x32_bf16 v[166:169], v[46:49], a[192:195], v[166:169]
    s_mov_b32 s44, 196608
    buffer_load_dwordx4 a[96:99], v4, s[8:11], s44 offen sc1
    v_mfma_f32_16x16x32_bf16 v[166:169], v[66:69], a[208:211], v[166:169]
    v_mfma_f32_16x16x32_bf16 v[186:189], v[66:69], a[212:215], v[186:189]
    buffer_load_dwordx4 a[100:103], v5, s[8:11], s44 offen sc1
    v_mfma_f32_16x16x32_bf16 v[186:189], v[46:49], a[196:199], v[186:189]
    v_mfma_f32_16x16x32_bf16 v[206:209], v[46:49], a[200:203], v[206:209]
    v_mfma_f32_16x16x32_bf16 v[206:209], v[66:69], a[216:219], v[206:209]
    buffer_load_dwordx4 a[104:107], v6, s[8:11], s44 offen sc1
    v_mfma_f32_16x16x32_bf16 v[226:229], v[66:69], a[220:223], v[226:229]
    v_mfma_f32_16x16x32_bf16 v[226:229], v[46:49], a[204:207], v[226:229]
    buffer_load_dwordx4 a[108:111], v7, s[8:11], s44 offen sc1
    v_mfma_f32_16x16x32_bf16 v[170:173], v[50:53], a[192:195], v[170:173]
    v_mfma_f32_16x16x32_bf16 v[170:173], v[70:73], a[208:211], v[170:173]
    v_mfma_f32_16x16x32_bf16 v[190:193], v[70:73], a[212:215], v[190:193]
    s_mov_b32 s44, 212992
    buffer_load_dwordx4 a[112:115], v4, s[8:11], s44 offen sc1
    v_mfma_f32_16x16x32_bf16 v[190:193], v[50:53], a[196:199], v[190:193]
    v_mfma_f32_16x16x32_bf16 v[210:213], v[50:53], a[200:203], v[210:213]
    buffer_load_dwordx4 a[116:119], v5, s[8:11], s44 offen sc1
    v_mfma_f32_16x16x32_bf16 v[210:213], v[70:73], a[216:219], v[210:213]
    v_mfma_f32_16x16x32_bf16 v[230:233], v[70:73], a[220:223], v[230:233]
    v_mfma_f32_16x16x32_bf16 v[230:233], v[50:53], a[204:207], v[230:233]
    buffer_load_dwordx4 a[120:123], v6, s[8:11], s44 offen sc1
    v_mfma_f32_16x16x32_bf16 v[174:177], v[54:57], a[192:195], v[174:177]
    v_mfma_f32_16x16x32_bf16 v[174:177], v[74:77], a[208:211], v[174:177]
    buffer_load_dwordx4 a[124:127], v7, s[8:11], s44 offen sc1
    v_mfma_f32_16x16x32_bf16 v[194:197], v[74:77], a[212:215], v[194:197]
    v_mfma_f32_16x16x32_bf16 v[194:197], v[54:57], a[196:199], v[194:197]
    v_mfma_f32_16x16x32_bf16 v[214:217], v[54:57], a[200:203], v[214:217]
    buffer_load_dwordx4 a[176:179], v16, s[20:23], s45 offen offset:2048 sc1
    v_mfma_f32_16x16x32_bf16 v[214:217], v[74:77], a[216:219], v[214:217]
    v_mfma_f32_16x16x32_bf16 v[234:237], v[74:77], a[220:223], v[234:237]
    buffer_load_dwordx4 a[180:183], v16, s[20:23], s45 offen offset:3072 sc1
    v_mfma_f32_16x16x32_bf16 v[234:237], v[54:57], a[204:207], v[234:237]
    v_mfma_f32_16x16x32_bf16 v[178:181], v[58:61], a[192:195], v[178:181]
    v_mfma_f32_16x16x32_bf16 v[178:181], v[78:81], a[208:211], v[178:181]
    buffer_load_dwordx4 a[184:187], v17, s[20:23], s45 offen offset:0 sc1
    v_mfma_f32_16x16x32_bf16 v[198:201], v[78:81], a[212:215], v[198:201]
    v_mfma_f32_16x16x32_bf16 v[198:201], v[58:61], a[196:199], v[198:201]
    s_mov_b32 s45, 512000
    buffer_load_dwordx4 a[188:191], v16, s[20:23], s45 offen offset:0 sc1
    v_mfma_f32_16x16x32_bf16 v[218:221], v[58:61], a[200:203], v[218:221]
    v_mfma_f32_16x16x32_bf16 v[218:221], v[78:81], a[216:219], v[218:221]
    v_mfma_f32_16x16x32_bf16 v[238:241], v[78:81], a[220:223], v[238:241]
    v_mfma_f32_16x16x32_bf16 v[238:241], v[58:61], a[204:207], v[238:241]
    v_mfma_f32_16x16x32_bf16 v[182:185], v[62:65], a[192:195], v[182:185]
    v_mfma_f32_16x16x32_bf16 v[182:185], v[82:85], a[208:211], v[182:185]
    v_mfma_f32_16x16x32_bf16 v[202:205], v[82:85], a[212:215], v[202:205]
    v_mfma_f32_16x16x32_bf16 v[202:205], v[62:65], a[196:199], v[202:205]
    v_mfma_f32_16x16x32_bf16 v[222:225], v[62:65], a[200:203], v[222:225]
    v_mfma_f32_16x16x32_bf16 v[222:225], v[82:85], a[216:219], v[222:225]
    v_mfma_f32_16x16x32_bf16 v[242:245], v[82:85], a[220:223], v[242:245]
    v_mfma_f32_16x16x32_bf16 v[242:245], v[62:65], a[204:207], v[242:245]
    s_waitcnt vmcnt(16)
    v_mfma_f32_16x16x32_bf16 v[166:169], v[86:89], a[224:227], v[166:169]
    s_mov_b32 s44, 229376
    buffer_load_dwordx4 a[192:195], v4, s[8:11], s44 offen sc1
    v_mfma_f32_16x16x32_bf16 v[166:169], v[106:109], a[240:243], v[166:169]
    v_mfma_f32_16x16x32_bf16 v[186:189], v[106:109], a[244:247], v[186:189]
    buffer_load_dwordx4 a[196:199], v5, s[8:11], s44 offen sc1
    v_mfma_f32_16x16x32_bf16 v[186:189], v[86:89], a[228:231], v[186:189]
    v_mfma_f32_16x16x32_bf16 v[206:209], v[86:89], a[232:235], v[206:209]
    v_mfma_f32_16x16x32_bf16 v[206:209], v[106:109], a[248:251], v[206:209]
    buffer_load_dwordx4 a[200:203], v6, s[8:11], s44 offen sc1
    v_mfma_f32_16x16x32_bf16 v[226:229], v[106:109], a[252:255], v[226:229]
    v_mfma_f32_16x16x32_bf16 v[226:229], v[86:89], a[236:239], v[226:229]
    buffer_load_dwordx4 a[204:207], v7, s[8:11], s44 offen sc1
    v_mfma_f32_16x16x32_bf16 v[170:173], v[90:93], a[224:227], v[170:173]
    v_mfma_f32_16x16x32_bf16 v[170:173], v[110:113], a[240:243], v[170:173]
    v_mfma_f32_16x16x32_bf16 v[190:193], v[110:113], a[244:247], v[190:193]
    s_mov_b32 s44, 245760
    buffer_load_dwordx4 a[208:211], v4, s[8:11], s44 offen sc1
    v_mfma_f32_16x16x32_bf16 v[190:193], v[90:93], a[228:231], v[190:193]
    v_mfma_f32_16x16x32_bf16 v[210:213], v[90:93], a[232:235], v[210:213]
    buffer_load_dwordx4 a[212:215], v5, s[8:11], s44 offen sc1
    v_mfma_f32_16x16x32_bf16 v[210:213], v[110:113], a[248:251], v[210:213]
    v_mfma_f32_16x16x32_bf16 v[230:233], v[110:113], a[252:255], v[230:233]
    v_mfma_f32_16x16x32_bf16 v[230:233], v[90:93], a[236:239], v[230:233]
    buffer_load_dwordx4 a[216:219], v6, s[8:11], s44 offen sc1
    v_mfma_f32_16x16x32_bf16 v[174:177], v[94:97], a[224:227], v[174:177]
    v_mfma_f32_16x16x32_bf16 v[174:177], v[114:117], a[240:243], v[174:177]
    buffer_load_dwordx4 a[220:223], v7, s[8:11], s44 offen sc1
    v_mfma_f32_16x16x32_bf16 v[194:197], v[114:117], a[244:247], v[194:197]
    v_mfma_f32_16x16x32_bf16 v[194:197], v[94:97], a[228:231], v[194:197]
    v_mfma_f32_16x16x32_bf16 v[214:217], v[94:97], a[232:235], v[214:217]
    buffer_load_dwordx4 a[0:3], v16, s[20:23], s45 offen offset:1024 sc1
    v_mfma_f32_16x16x32_bf16 v[214:217], v[114:117], a[248:251], v[214:217]
    v_mfma_f32_16x16x32_bf16 v[234:237], v[114:117], a[252:255], v[234:237]
    buffer_load_dwordx4 a[4:7], v16, s[20:23], s45 offen offset:2048 sc1
    v_mfma_f32_16x16x32_bf16 v[234:237], v[94:97], a[236:239], v[234:237]
    v_mfma_f32_16x16x32_bf16 v[178:181], v[98:101], a[224:227], v[178:181]
    v_mfma_f32_16x16x32_bf16 v[178:181], v[118:121], a[240:243], v[178:181]
    buffer_load_dwordx4 a[8:11], v16, s[20:23], s45 offen offset:3072 sc1
    v_mfma_f32_16x16x32_bf16 v[198:201], v[118:121], a[244:247], v[198:201]
    v_mfma_f32_16x16x32_bf16 v[198:201], v[98:101], a[228:231], v[198:201]
    buffer_load_dwordx4 a[12:15], v17, s[20:23], s45 offen offset:0 sc1
    v_mfma_f32_16x16x32_bf16 v[218:221], v[98:101], a[232:235], v[218:221]
    v_mfma_f32_16x16x32_bf16 v[218:221], v[118:121], a[248:251], v[218:221]
    v_mfma_f32_16x16x32_bf16 v[238:241], v[118:121], a[252:255], v[238:241]
    v_mfma_f32_16x16x32_bf16 v[238:241], v[98:101], a[236:239], v[238:241]
    v_mfma_f32_16x16x32_bf16 v[182:185], v[102:105], a[224:227], v[182:185]
    v_mfma_f32_16x16x32_bf16 v[182:185], v[122:125], a[240:243], v[182:185]
    v_mfma_f32_16x16x32_bf16 v[202:205], v[122:125], a[244:247], v[202:205]
    v_mfma_f32_16x16x32_bf16 v[202:205], v[102:105], a[228:231], v[202:205]
    v_mfma_f32_16x16x32_bf16 v[222:225], v[102:105], a[232:235], v[222:225]
    v_mfma_f32_16x16x32_bf16 v[222:225], v[122:125], a[248:251], v[222:225]
    v_mfma_f32_16x16x32_bf16 v[242:245], v[122:125], a[252:255], v[242:245]
    s_cmp_eq_u32 s101, 0
    s_cbranch_scc1 L_no_fl
    v_lshlrev_b32 v1, 7, v19
    v_add_u32 v1, 0x290000, v1
    buffer_load_dwordx4 v[252:255], v1, s[76:79], 0 offen sc1
L_no_fl:
    v_mfma_f32_16x16x32_bf16 v[242:245], v[102:105], a[236:239], v[242:245]
    s_waitcnt vmcnt(16)
    v_mfma_f32_16x16x32_bf16 v[166:169], v[126:129], a[96:99], v[166:169]
    s_mov_b32 s44, 262144
    buffer_load_dwordx4 a[224:227], v4, s[8:11], s44 offen sc1
    v_mfma_f32_16x16x32_bf16 v[166:169], v[146:149], a[112:115], v[166:169]
    ds_read_b128 v[86:89], v10 offset:40960
    v_mfma_f32_16x16x32_bf16 v[186:189], v[146:149], a[116:119], v[186:189]
    buffer_load_dwordx4 a[228:231], v5, s[8:11], s44 offen sc1
    v_mfma_f32_16x16x32_bf16 v[186:189], v[126:129], a[100:103], v[186:189]
    v_mfma_f32_16x16x32_bf16 v[206:209], v[126:129], a[104:107], v[206:209]
    ds_read_b128 v[90:93], v10 offset:41984
    v_mfma_f32_16x16x32_bf16 v[206:209], v[146:149], a[120:123], v[206:209]
    buffer_load_dwordx4 a[232:235], v6, s[8:11], s44 offen sc1
    v_mfma_f32_16x16x32_bf16 v[226:229], v[146:149], a[124:127], v[226:229]
    v_mfma_f32_16x16x32_bf16 v[226:229], v[126:129], a[108:111], v[226:229]
    buffer_load_dwordx4 a[236:239], v7, s[8:11], s44 offen sc1
    v_mfma_f32_16x16x32_bf16 v[170:173], v[130:133], a[96:99], v[170:173]
    ds_read_b128 v[94:97], v10 offset:43008
    v_mfma_f32_16x16x32_bf16 v[170:173], v[150:153], a[112:115], v[170:173]
    v_mfma_f32_16x16x32_bf16 v[190:193], v[150:153], a[116:119], v[190:193]
    s_mov_b32 s44, 278528
    buffer_load_dwordx4 a[240:243], v4, s[8:11], s44 offen sc1
    v_mfma_f32_16x16x32_bf16 v[190:193], v[130:133], a[100:103], v[190:193]
    ds_read_b128 v[98:101], v10 offset:44032
    v_mfma_f32_16x16x32_bf16 v[210:213], v[130:133], a[104:107], v[210:213]
    buffer_load_dwordx4 a[244:247], v5, s[8:11], s44 offen sc1
    v_mfma_f32_16x16x32_bf16 v[210:213], v[150:153], a[120:123], v[210:213]
    v_mfma_f32_16x16x32_bf16 v[230:233], v[150:153], a[124:127], v[230:233]
    ds_read_b128 v[102:105], v10 offset:45056
    v_mfma_f32_16x16x32_bf16 v[230:233], v[130:133], a[108:111], v[230:233]
    buffer_load_dwordx4 a[248:251], v6, s[8:11], s44 offen sc1
    v_mfma_f32_16x16x32_bf16 v[174:177], v[134:137], a[96:99], v[174:177]
    v_mfma_f32_16x16x32_bf16 v[174:177], v[154:157], a[112:115], v[174:177]
    buffer_load_dwordx4 a[252:255], v7, s[8:11], s44 offen sc1
    v_mfma_f32_16x16x32_bf16 v[194:197], v[154:157], a[116:119], v[194:197]
    ds_read_b128 v[106:109], v10 offset:46080
    v_mfma_f32_16x16x32_bf16 v[194:197], v[134:137], a[100:103], v[194:197]
    v_mfma_f32_16x16x32_bf16 v[214:217], v[134:137], a[104:107], v[214:217]
    s_mov_b32 s45, 532480
    buffer_load_dwordx4 a[16:19], v16, s[20:23], s45 offen offset:0 sc1
    v_mfma_f32_16x16x32_bf16 v[214:217], v[154:157], a[120:123], v[214:217]
    ds_read_b128 v[110:113], v10 offset:47104
    v_mfma_f32_16x16x32_bf16 v[234:237], v[154:157], a[124:127], v[234:237]
    buffer_load_dwordx4 a[20:23], v16, s[20:23], s45 offen offset:1024 sc1
    v_mfma_f32_16x16x32_bf16 v[234:237], v[134:137], a[108:111], v[234:237]
    v_mfma_f32_16x16x32_bf16 v[178:181], v[138:141], a[96:99], v[178:181]
    ds_read_b128 v[114:117], v10 offset:48128
    v_mfma_f32_16x16x32_bf16 v[178:181], v[158:161], a[112:115], v[178:181]
    buffer_load_dwordx4 a[24:27], v16, s[20:23], s45 offen offset:2048 sc1
    v_mfma_f32_16x16x32_bf16 v[198:201], v[158:161], a[116:119], v[198:201]
    v_mfma_f32_16x16x32_bf16 v[198:201], v[138:141], a[100:103], v[198:201]
    buffer_load_dwordx4 a[28:31], v16, s[20:23], s45 offen offset:3072 sc1
    v_mfma_f32_16x16x32_bf16 v[218:221], v[138:141], a[104:107], v[218:221]
    ds_read_b128 v[118:121], v10 offset:49152
    v_mfma_f32_16x16x32_bf16 v[218:221], v[158:161], a[120:123], v[218:221]
    v_mfma_f32_16x16x32_bf16 v[238:241], v[158:161], a[124:127], v[238:241]
    ds_read_b128 v[122:125], v10 offset:50176
    v_mfma_f32_16x16x32_bf16 v[238:241], v[138:141], a[108:111], v[238:241]
    v_mfma_f32_16x16x32_bf16 v[182:185], v[142:145], a[96:99], v[182:185]
    v_mfma_f32_16x16x32_bf16 v[182:185], v[162:165], a[112:115], v[182:185]
    v_mfma_f32_16x16x32_bf16 v[202:205], v[162:165], a[116:119], v[202:205]
    v_mfma_f32_16x16x32_bf16 v[202:205], v[142:145], a[100:103], v[202:205]
    v_mfma_f32_16x16x32_bf16 v[222:225], v[142:145], a[104:107], v[222:225]
    v_mfma_f32_16x16x32_bf16 v[222:225], v[162:165], a[120:123], v[222:225]
    v_mfma_f32_16x16x32_bf16 v[242:245], v[162:165], a[124:127], v[242:245]
    v_mfma_f32_16x16x32_bf16 v[242:245], v[142:145], a[108:111], v[242:245]
    s_waitcnt vmcnt(16) lgkmcnt(0)
    v_mfma_f32_16x16x32_bf16 v[166:169], v[86:89], a[192:195], v[166:169]
    s_mov_b32 s44, 294912
    buffer_load_dwordx4 a[96:99], v4, s[8:11], s44 offen sc1
    v_mfma_f32_16x16x32_bf16 v[166:169], v[106:109], a[208:211], v[166:169]
    ds_read_b128 v[126:129], v9 offset:0
    v_mfma_f32_16x16x32_bf16 v[186:189], v[106:109], a[212:215], v[186:189]
    buffer_load_dwordx4 a[100:103], v5, s[8:11], s44 offen sc1
    v_mfma_f32_16x16x32_bf16 v[186:189], v[86:89], a[196:199], v[186:189]
    v_mfma_f32_16x16x32_bf16 v[206:209], v[86:89], a[200:203], v[206:209]
    ds_read_b128 v[130:133], v9 offset:1024
    v_mfma_f32_16x16x32_bf16 v[206:209], v[106:109], a[216:219], v[206:209]
    buffer_load_dwordx4 a[104:107], v6, s[8:11], s44 offen sc1
    v_mfma_f32_16x16x32_bf16 v[226:229], v[106:109], a[220:223], v[226:229]
    v_mfma_f32_16x16x32_bf16 v[226:229], v[86:89], a[204:207], v[226:229]
    buffer_load_dwordx4 a[108:111], v7, s[8:11], s44 offen sc1
    v_mfma_f32_16x16x32_bf16 v[170:173], v[90:93], a[192:195], v[170:173]
    ds_read_b128 v[134:137], v9 offset:2048
    v_mfma_f32_16x16x32_bf16 v[170:173], v[110:113], a[208:211], v[170:173]
    v_mfma_f32_16x16x32_bf16 v[190:193], v[110:113], a[212:215], v[190:193]
    s_mov_b32 s44, 311296
    buffer_load_dwordx4 a[112:115], v4, s[8:11], s44 offen sc1
    v_mfma_f32_16x16x32_bf16 v[190:193], v[90:93], a[196:199], v[190:193]
    ds_read_b128 v[138:141], v9 offset:3072
    v_mfma_f32_16x16x32_bf16 v[210:213], v[90:93], a[200:203], v[210:213]
    buffer_load_dwordx4 a[116:119], v5, s[8:11], s44 offen sc1
    v_mfma_f32_16x16x32_bf16 v[210:213], v[110:113], a[216:219], v[210:213]
    v_mfma_f32_16x16x32_bf16 v[230:233], v[110:113], a[220:223], v[230:233]
    ds_read_b128 v[142:145], v9 offset:4096
    v_mfma_f32_16x16x32_bf16 v[230:233], v[90:93], a[204:207], v[230:233]
    buffer_load_dwordx4 a[120:123], v6, s[8:11], s44 offen sc1
    v_mfma_f32_16x16x32_bf16 v[174:177], v[94:97], a[192:195], v[174:177]
    v_mfma_f32_16x16x32_bf16 v[174:177], v[114:117], a[208:211], v[174:177]
    buffer_load_dwordx4 a[124:127], v7, s[8:11], s44 offen sc1
    v_mfma_f32_16x16x32_bf16 v[194:197], v[114:117], a[212:215], v[194:197]
    ds_read_b128 v[146:149], v9 offset:5120
    v_mfma_f32_16x16x32_bf16 v[194:197], v[94:97], a[196:199], v[194:197]
    v_mfma_f32_16x16x32_bf16 v[214:217], v[94:97], a[200:203], v[214:217]
    buffer_load_dwordx4 a[32:35], v17, s[20:23], s45 offen offset:0 sc1
    v_mfma_f32_16x16x32_bf16 v[214:217], v[114:117], a[216:219], v[214:217]
    ds_read_b128 v[150:153], v9 offset:6144
    v_mfma_f32_16x16x32_bf16 v[234:237], v[114:117], a[220:223], v[234:237]
    s_mov_b32 s45, 552960
    buffer_load_dwordx4 a[36:39], v16, s[20:23], s45 offen offset:0 sc1
    v_mfma_f32_16x16x32_bf16 v[234:237], v[94:97], a[204:207], v[234:237]
    v_mfma_f32_16x16x32_bf16 v[178:181], v[98:101], a[192:195], v[178:181]
    ds_read_b128 v[154:157], v9 offset:7168
    v_mfma_f32_16x16x32_bf16 v[178:181], v[118:121], a[208:211], v[178:181]
    buffer_load_dwordx4 a[40:43], v16, s[20:23], s45 offen offset:1024 sc1
    v_mfma_f32_16x16x32_bf16 v[198:201], v[118:121], a[212:215], v[198:201]
    v_mfma_f32_16x16x32_bf16 v[198:201], v[98:101], a[196:199], v[198:201]
    buffer_load_dwordx4 a[44:47], v16, s[20:23], s45 offen offset:2048 sc1
    v_mfma_f32_16x16x32_bf16 v[218:221], v[98:101], a[200:203], v[218:221]
    ds_read_b128 v[158:161], v9 offset:8192
    v_mfma_f32_16x16x32_bf16 v[218:221], v[118:121], a[216:219], v[218:221]
    v_mfma_f32_16x16x32_bf16 v[238:241], v[118:121], a[220:223], v[238:241]
    ds_read_b128 v[162:165], v9 offset:9216
    v_mfma_f32_16x16x32_bf16 v[238:241], v[98:101], a[204:207], v[238:241]
    v_mfma_f32_16x16x32_bf16 v[182:185], v[102:105], a[192:195], v[182:185]
    v_mfma_f32_16x16x32_bf16 v[182:185], v[122:125], a[208:211], v[182:185]
    v_mfma_f32_16x16x32_bf16 v[202:205], v[122:125], a[212:215], v[202:205]
    v_mfma_f32_16x16x32_bf16 v[202:205], v[102:105], a[196:199], v[202:205]
    v_mfma_f32_16x16x32_bf16 v[222:225], v[102:105], a[200:203], v[222:225]
    v_mfma_f32_16x16x32_bf16 v[222:225], v[122:125], a[216:219], v[222:225]
    v_mfma_f32_16x16x32_bf16 v[242:245], v[122:125], a[220:223], v[242:245]
    s_cmp_eq_u32 s101, 0
    s_cbranch_scc1 L_back_upd
    s_waitcnt vmcnt(24)
    v_min3_u32 v252, v252, v253, v254
    v_min_u32 v252, v252, v255
    v_cmp_gt_u32 vcc, 3, v252
    s_and_b64 vcc, vcc, exec
    s_cbranch_scc1 L_spin_upd
L_back_upd:
    buffer_load_dwordx2 v[20:21], v11, s[76:79], 0 offen offset:0 sc1
    buffer_load_dwordx2 v[246:247], v11, s[76:79], 0 offen offset:32 sc1
    buffer_load_dwordx2 v[248:249], v11, s[76:79], 0 offen offset:64 sc1
    buffer_load_dwordx2 v[252:253], v11, s[76:79], 0 offen offset:96 sc1
    buffer_load_dwordx2 v[254:255], v11, s[76:79], 0 offen offset:128 sc1
    v_mfma_f32_16x16x32_bf16 v[242:245], v[102:105], a[204:207], v[242:245]
    s_waitcnt vmcnt(21) lgkmcnt(0)
    v_mfma_f32_16x16x32_bf16 v[166:169], v[126:129], a[224:227], v[166:169]
    s_mov_b32 s44, 327680
    buffer_load_dwordx4 a[192:195], v4, s[8:11], s44 offen sc1
    v_mfma_f32_16x16x32_bf16 v[166:169], v[146:149], a[240:243], v[166:169]
    ds_read_b128 v[86:89], v9 offset:40960
    v_mfma_f32_16x16x32_bf16 v[186:189], v[146:149], a[244:247], v[186:189]
    buffer_load_dwordx4 a[196:199], v5, s[8:11], s44 offen sc1
    v_mfma_f32_16x16x32_bf16 v[186:189], v[126:129], a[228:231], v[186:189]
    v_mfma_f32_16x16x32_bf16 v[206:209], v[126:129], a[232:235], v[206:209]
    ds_read_b128 v[90:93], v9 offset:41984
    v_mfma_f32_16x16x32_bf16 v[206:209], v[146:149], a[248:251], v[206:209]
    buffer_load_dwordx4 a[200:203], v6, s[8:11], s44 offen sc1
    v_mfma_f32_16x16x32_bf16 v[226:229], v[146:149], a[252:255], v[226:229]
    v_mfma_f32_16x16x32_bf16 v[226:229], v[126:129], a[236:239], v[226:229]
    buffer_load_dwordx4 a[204:207], v7, s[8:11], s44 offen sc1
    v_mfma_f32_16x16x32_bf16 v[170:173], v[130:133], a[224:227], v[170:173]
    ds_read_b128 v[94:97], v9 offset:43008
    v_mfma_f32_16x16x32_bf16 v[170:173], v[150:153], a[240:243], v[170:173]
    v_mfma_f32_16x16x32_bf16 v[190:193], v[150:153], a[244:247], v[190:193]
    s_mov_b32 s44, 344064
    buffer_load_dwordx4 a[208:211], v4, s[8:11], s44 offen sc1
    v_mfma_f32_16x16x32_bf16 v[190:193], v[130:133], a[228:231], v[190:193]
    ds_read_b128 v[98:101], v9 offset:44032
    v_mfma_f32_16x16x32_bf16 v[210:213], v[130:133], a[232:235], v[210:213]
    buffer_load_dwordx4 a[212:215], v5, s[8:11], s44 offen sc1
    v_mfma_f32_16x16x32_bf16 v[210:213], v[150:153], a[248:251], v[210:213]
    v_mfma_f32_16x16x32_bf16 v[230:233], v[150:153], a[252:255], v[230:233]
    ds_read_b128 v[102:105], v9 offset:45056
    v_mfma_f32_16x16x32_bf16 v[230:233], v[130:133], a[236:239], v[230:233]
    buffer_load_dwordx4 a[216:219], v6, s[8:11], s44 offen sc1
    v_mfma_f32_16x16x32_bf16 v[174:177], v[134:137], a[224:227], v[174:177]
    v_mfma_f32_16x16x32_bf16 v[174:177], v[154:157], a[240:243], v[174:177]
    buffer_load_dwordx4 a[220:223], v7, s[8:11], s44 offen sc1
    v_mfma_f32_16x16x32_bf16 v[194:197], v[154:157], a[244:247], v[194:197]
    ds_read_b128 v[106:109], v9 offset:46080
    v_mfma_f32_16x16x32_bf16 v[194:197], v[134:137], a[228:231], v[194:197]
    v_mfma_f32_16x16x32_bf16 v[214:217], v[134:137], a[232:235], v[214:217]
    buffer_load_dwordx4 a[48:51], v16, s[20:23], s45 offen offset:3072 sc1
    v_mfma_f32_16x16x32_bf16 v[214:217], v[154:157], a[248:251], v[214:217]
    ds_read_b128 v[110:113], v9 offset:47104
    v_mfma_f32_16x16x32_bf16 v[234:237], v[154:157], a[252:255], v[234:237]
    buffer_load_dwordx4 a[52:55], v17, s[20:23], s45 offen offset:0 sc1
    v_mfma_f32_16x16x32_bf16 v[234:237], v[134:137], a[236:239], v[234:237]
    v_mfma_f32_16x16x32_bf16 v[178:181], v[138:141], a[224:227], v[178:181]
    ds_read_b128 v[114:117], v9 offset:48128
    v_mfma_f32_16x16x32_bf16 v[178:181], v[158:161], a[240:243], v[178:181]
    s_mov_b32 s45, 573440
    buffer_load_dwordx4 a[56:59], v16, s[20:23], s45 offen offset:0 sc1
    v_mfma_f32_16x16x32_bf16 v[198:201], v[158:161], a[244:247], v[198:201]
    v_mfma_f32_16x16x32_bf16 v[198:201], v[138:141], a[228:231], v[198:201]
    buffer_load_dwordx4 a[60:63], v16, s[20:23], s45 offen offset:1024 sc1
    v_mfma_f32_16x16x32_bf16 v[218:221], v[138:141], a[232:235], v[218:221]
    ds_read_b128 v[118:121], v9 offset:49152
    v_mfma_f32_16x16x32_bf16 v[218:221], v[158:161], a[248:251], v[218:221]
    v_mfma_f32_16x16x32_bf16 v[238:241], v[158:161], a[252:255], v[238:241]
    ds_read_b128 v[122:125], v9 offset:50176
    v_mfma_f32_16x16x32_bf16 v[238:241], v[138:141], a[236:239], v[238:241]
    v_mfma_f32_16x16x32_bf16 v[182:185], v[142:145], a[224:227], v[182:185]
    v_mfma_f32_16x16x32_bf16 v[182:185], v[162:165], a[240:243], v[182:185]
    v_mfma_f32_16x16x32_bf16 v[202:205], v[162:165], a[244:247], v[202:205]
    v_mfma_f32_16x16x32_bf16 v[202:205], v[142:145], a[228:231], v[202:205]
    v_mfma_f32_16x16x32_bf16 v[222:225], v[142:145], a[232:235], v[222:225]
    v_mfma_f32_16x16x32_bf16 v[222:225], v[162:165], a[248:251], v[222:225]
    v_mfma_f32_16x16x32_bf16 v[242:245], v[162:165], a[252:255], v[242:245]
    v_mfma_f32_16x16x32_bf16 v[242:245], v[142:145], a[236:239], v[242:245]
    s_waitcnt vmcnt(21) lgkmcnt(0)
    v_mfma_f32_16x16x32_bf16 v[166:169], v[86:89], a[96:99], v[166:169]
    s_mov_b32 s44, 360448
    buffer_load_dwordx4 a[224:227], v4, s[8:11], s44 offen sc1
    v_mfma_f32_16x16x32_bf16 v[166:169], v[106:109], a[112:115], v[166:169]
    ds_read_b128 v[126:129], v10 offset:0
    v_mfma_f32_16x16x32_bf16 v[186:189], v[106:109], a[116:119], v[186:189]
    buffer_load_dwordx4 a[228:231], v5, s[8:11], s44 offen sc1
    v_mfma_f32_16x16x32_bf16 v[186:189], v[86:89], a[100:103], v[186:189]
    v_mfma_f32_16x16x32_bf16 v[206:209], v[86:89], a[104:107], v[206:209]
    ds_read_b128 v[130:133], v10 offset:1024
    v_mfma_f32_16x16x32_bf16 v[206:209], v[106:109], a[120:123], v[206:209]
    buffer_load_dwordx4 a[232:235], v6, s[8:11], s44 offen sc1
    v_mfma_f32_16x16x32_bf16 v[226:229], v[106:109], a[124:127], v[226:229]
    v_mfma_f32_16x16x32_bf16 v[226:229], v[86:89], a[108:111], v[226:229]
    buffer_load_dwordx4 a[236:239], v7, s[8:11], s44 offen sc1
    v_mfma_f32_16x16x32_bf16 v[170:173], v[90:93], a[96:99], v[170:173]
    ds_read_b128 v[134:137], v10 offset:2048
    v_mfma_f32_16x16x32_bf16 v[170:173], v[110:113], a[112:115], v[170:173]
    v_mfma_f32_16x16x32_bf16 v[190:193], v[110:113], a[116:119], v[190:193]
    s_mov_b32 s44, 376832
    buffer_load_dwordx4 a[240:243], v4, s[8:11], s44 offen sc1
    v_mfma_f32_16x16x32_bf16 v[190:193], v[90:93], a[100:103], v[190:193]
    ds_read_b128 v[138:141], v10 offset:3072
    v_mfma_f32_16x16x32_bf16 v[210:213], v[90:93], a[104:107], v[210:213]
    buffer_load_dwordx4 a[244:247], v5, s[8:11], s44 offen sc1
    v_mfma_f32_16x16x32_bf16 v[210:213], v[110:113], a[120:123], v[210:213]
    v_mfma_f32_16x16x32_bf16 v[230:233], v[110:113], a[124:127], v[230:233]
    ds_read_b128 v[142:145], v10 offset:4096
    v_mfma_f32_16x16x32_bf16 v[230:233], v[90:93], a[108:111], v[230:233]
    buffer_load_dwordx4 a[248:251], v6, s[8:11], s44 offen sc1
    v_mfma_f32_16x16x32_bf16 v[174:177], v[94:97], a[96:99], v[174:177]
    v_mfma_f32_16x16x32_bf16 v[174:177], v[114:117], a[112:115], v[174:177]
    buffer_load_dwordx4 a[252:255], v7, s[8:11], s44 offen sc1
    v_mfma_f32_16x16x32_bf16 v[194:197], v[114:117], a[116:119], v[194:197]
    ds_read_b128 v[146:149], v10 offset:5120
    v_mfma_f32_16x16x32_bf16 v[194:197], v[94:97], a[100:103], v[194:197]
    v_mfma_f32_16x16x32_bf16 v[214:217], v[94:97], a[104:107], v[214:217]
    buffer_load_dwordx4 a[64:67], v16, s[20:23], s45 offen offset:2048 sc1
    v_mfma_f32_16x16x32_bf16 v[214:217], v[114:117], a[120:123], v[214:217]
    ds_read_b128 v[150:153], v10 offset:6144
    v_mfma_f32_16x16x32_bf16 v[234:237], v[114:117], a[124:127], v[234:237]
    buffer_load_dwordx4 a[68:71], v16, s[20:23], s45 offen offset:3072 sc1
    v_mfma_f32_16x16x32_bf16 v[234:237], v[94:97], a[108:111], v[234:237]
    v_mfma_f32_16x16x32_bf16 v[178:181], v[98:101], a[96:99], v[178:181]
    ds_read_b128 v[154:157], v10 offset:7168
    v_mfma_f32_16x16x32_bf16 v[178:181], v[118:121], a[112:115], v[178:181]
    buffer_load_dwordx4 a[72:75], v17, s[20:23], s45 offen offset:0 sc1
    v_mfma_f32_16x16x32_bf16 v[198:201], v[118:121], a[116:119], v[198:201]
    v_mfma_f32_16x16x32_bf16 v[198:201], v[98:101], a[100:103], v[198:201]
    s_mov_b32 s45, 593920
    buffer_load_dwordx4 a[76:79], v16, s[20:23], s45 offen offset:0 sc1
    v_mfma_f32_16x16x32_bf16 v[218:221], v[98:101], a[104:107], v[218:221]
    ds_read_b128 v[158:161], v10 offset:8192
    v_mfma_f32_16x16x32_bf16 v[218:221], v[118:121], a[120:123], v[218:221]
    v_mfma_f32_16x16x32_bf16 v[238:241], v[118:121], a[124:127], v[238:241]
    ds_read_b128 v[162:165], v10 offset:9216
    v_mfma_f32_16x16x32_bf16 v[238:241], v[98:101], a[108:111], v[238:241]
    v_mfma_f32_16x16x32_bf16 v[182:185], v[102:105], a[96:99], v[182:185]
    v_mfma_f32_16x16x32_bf16 v[182:185], v[122:125], a[112:115], v[182:185]
    v_mfma_f32_16x16x32_bf16 v[202:205], v[122:125], a[116:119], v[202:205]
    v_mfma_f32_16x16x32_bf16 v[202:205], v[102:105], a[100:103], v[202:205]
    v_mfma_f32_16x16x32_bf16 v[222:225], v[102:105], a[104:107], v[222:225]
    v_mfma_f32_16x16x32_bf16 v[222:225], v[122:125], a[120:123], v[222:225]
    v_mfma_f32_16x16x32_bf16 v[242:245], v[122:125], a[124:127], v[242:245]
    v_mfma_f32_16x16x32_bf16 v[242:245], v[102:105], a[108:111], v[242:245]
    s_waitcnt vmcnt(16) lgkmcnt(0)
    v_mfma_f32_16x16x32_bf16 v[166:169], v[126:129], a[192:195], v[166:169]
    s_mov_b32 s44, 393216
    buffer_load_dwordx4 a[96:99], v4, s[8:11], s44 offen sc1
    v_lshlrev_b32 v86, 16, v36
    v_mfma_f32_16x16x32_bf16 v[166:169], v[146:149], a[208:211], v[166:169]
    v_and_b32 v87, 0xffff0000, v36
    v_mfma_f32_16x16x32_bf16 v[186:189], v[146:149], a[212:215], v[186:189]
    buffer_load_dwordx4 a[100:103], v5, s[8:11], s44 offen sc1
    v_lshlrev_b32 v106, 16, v20
    v_mfma_f32_16x16x32_bf16 v[186:189], v[126:129], a[196:199], v[186:189]
    v_and_b32 v107, 0xffff0000, v20
    v_lshlrev_b32 v88, 16, v37
    v_mfma_f32_16x16x32_bf16 v[206:209], v[126:129], a[200:203], v[206:209]
    v_and_b32 v89, 0xffff0000, v37
    v_mfma_f32_16x16x32_bf16 v[206:209], v[146:149], a[216:219], v[206:209]
    buffer_load_dwordx4 a[104:107], v6, s[8:11], s44 offen sc1
    v_lshlrev_b32 v108, 16, v21
    v_mfma_f32_16x16x32_bf16 v[226:229], v[146:149], a[220:223], v[226:229]
    v_and_b32 v109, 0xffff0000, v21
    v_mfma_f32_16x16x32_bf16 v[226:229], v[126:129], a[204:207], v[226:229]
    buffer_load_dwordx4 a[108:111], v7, s[8:11], s44 offen sc1
    v_lshlrev_b32 v90, 16, v38
    v_and_b32 v91, 0xffff0000, v38
    v_mfma_f32_16x16x32_bf16 v[170:173], v[130:133], a[192:195], v[170:173]
    v_lshlrev_b32 v110, 16, v246
    v_mfma_f32_16x16x32_bf16 v[170:173], v[150:153], a[208:211], v[170:173]
    v_and_b32 v111, 0xffff0000, v246
    v_mfma_f32_16x16x32_bf16 v[190:193], v[150:153], a[212:215], v[190:193]
    s_mov_b32 s44, 409600
    buffer_load_dwordx4 a[112:115], v4, s[8:11], s44 offen sc1
    v_lshlrev_b32 v92, 16, v39
    v_mfma_f32_16x16x32_bf16 v[190:193], v[130:133], a[196:199], v[190:193]
    v_and_b32 v93, 0xffff0000, v39
    v_lshlrev_b32 v112, 16, v247
    v_mfma_f32_16x16x32_bf16 v[210:213], v[130:133], a[200:203], v[210:213]
    buffer_load_dwordx4 a[116:119], v5, s[8:11], s44 offen sc1
    v_and_b32 v113, 0xffff0000, v247
    v_mfma_f32_16x16x32_bf16 v[210:213], v[150:153], a[216:219], v[210:213]
    v_lshlrev_b32 v94, 16, v40
    v_mfma_f32_16x16x32_bf16 v[230:233], v[150:153], a[220:223], v[230:233]
    v_and_b32 v95, 0xffff0000, v40
    v_mfma_f32_16x16x32_bf16 v[230:233], v[130:133], a[204:207], v[230:233]
    buffer_load_dwordx4 a[120:123], v6, s[8:11], s44 offen sc1
    v_lshlrev_b32 v114, 16, v248
    v_and_b32 v115, 0xffff0000, v248
    v_mfma_f32_16x16x32_bf16 v[174:177], v[134:137], a[192:195], v[174:177]
    v_lshlrev_b32 v96, 16, v41
    v_mfma_f32_16x16x32_bf16 v[174:177], v[154:157], a[208:211], v[174:177]
    buffer_load_dwordx4 a[124:127], v7, s[8:11], s44 offen sc1
    v_and_b32 v97, 0xffff0000, v41
    v_mfma_f32_16x16x32_bf16 v[194:197], v[154:157], a[212:215], v[194:197]
    v_lshlrev_b32 v116, 16, v249
    v_mfma_f32_16x16x32_bf16 v[194:197], v[134:137], a[196:199], v[194:197]
    v_and_b32 v117, 0xffff0000, v249
    v_lshlrev_b32 v98, 16, v42
    v_mfma_f32_16x16x32_bf16 v[214:217], v[134:137], a[200:203], v[214:217]
    buffer_load_dwordx4 a[80:83], v16, s[20:23], s45 offen offset:1024 sc1
    v_and_b32 v99, 0xffff0000, v42
    v_mfma_f32_16x16x32_bf16 v[214:217], v[154:157], a[216:219], v[214:217]
    v_lshlrev_b32 v118, 16, v252
    v_mfma_f32_16x16x32_bf16 v[234:237], v[154:157], a[220:223], v[234:237]
    buffer_load_dwordx4 a[84:87], v16, s[20:23], s45 offen offset:2048 sc1
    v_and_b32 v119, 0xffff0000, v252
    v_mfma_f32_16x16x32_bf16 v[234:237], v[134:137], a[204:207], v[234:237]
    v_lshlrev_b32 v100, 16, v43
    v_and_b32 v101, 0xffff0000, v43
    v_mfma_f32_16x16x32_bf16 v[178:181], v[138:141], a[192:195], v[178:181]
    v_lshlrev_b32 v120, 16, v253
    v_mfma_f32_16x16x32_bf16 v[178:181], v[158:161], a[208:211], v[178:181]
    buffer_load_dwordx4 a[88:91], v16, s[20:23], s45 offen offset:3072 sc1
    v_and_b32 v121, 0xffff0000, v253
    v_mfma_f32_16x16x32_bf16 v[198:201], v[158:161], a[212:215], v[198:201]
    v_lshlrev_b32 v102, 16, v44
    v_mfma_f32_16x16x32_bf16 v[198:201], v[138:141], a[196:199], v[198:201]
    buffer_load_dwordx4 a[92:95], v17, s[20:23], s45 offen offset:0 sc1
    v_and_b32 v103, 0xffff0000, v44
    v_lshlrev_b32 v122, 16, v254
    v_mfma_f32_16x16x32_bf16 v[218:221], v[138:141], a[200:203], v[218:221]
    v_and_b32 v123, 0xffff0000, v254
    v_mfma_f32_16x16x32_bf16 v[218:221], v[158:161], a[216:219], v[218:221]
    v_lshlrev_b32 v104, 16, v45
    v_mfma_f32_16x16x32_bf16 v[238:241], v[158:161], a[220:223], v[238:241]
    v_and_b32 v105, 0xffff0000, v45
    v_mfma_f32_16x16x32_bf16 v[238:241], v[138:141], a[204:207], v[238:241]
    v_lshlrev_b32 v124, 16, v255
    v_and_b32 v125, 0xffff0000, v255
    v_mfma_f32_16x16x32_bf16 v[182:185], v[142:145], a[192:195], v[182:185]
    v_add_f32 v86, v86, v106
    v_mfma_f32_16x16x32_bf16 v[182:185], v[162:165], a[208:211], v[182:185]
    v_add_f32 v87, v87, v107
    v_mfma_f32_16x16x32_bf16 v[202:205], v[162:165], a[212:215], v[202:205]
    v_add_f32 v88, v88, v108
    v_mfma_f32_16x16x32_bf16 v[202:205], v[142:145], a[196:199], v[202:205]
    v_add_f32 v89, v89, v109
    v_add_f32 v90, v90, v110
    v_mfma_f32_16x16x32_bf16 v[222:225], v[142:145], a[200:203], v[222:225]
    v_add_f32 v91, v91, v111
    v_mfma_f32_16x16x32_bf16 v[222:225], v[162:165], a[216:219], v[222:225]
    v_add_f32 v92, v92, v112
    v_mfma_f32_16x16x32_bf16 v[242:245], v[162:165], a[220:223], v[242:245]
    v_add_f32 v93, v93, v113
    v_mfma_f32_16x16x32_bf16 v[242:245], v[142:145], a[204:207], v[242:245]
    v_add_f32 v94, v94, v114
    v_add_f32 v95, v95, v115
    s_waitcnt vmcnt(16)
    v_mfma_f32_16x16x32_bf16 v[166:169], a[128:131], a[224:227], v[166:169]
    s_mov_b32 s44, 425984
    buffer_load_dwordx4 a[192:195], v4, s[8:11], s44 offen sc1
    v_add_f32 v96, v96, v116
    v_mfma_f32_16x16x32_bf16 v[166:169], a[148:151], a[240:243], v[166:169]
    v_add_f32 v97, v97, v117
    v_mfma_f32_16x16x32_bf16 v[186:189], a[148:151], a[244:247], v[186:189]
    buffer_load_dwordx4 a[196:199], v5, s[8:11], s44 offen sc1
    v_add_f32 v98, v98, v118
    v_mfma_f32_16x16x32_bf16 v[186:189], a[128:131], a[228:231], v[186:189]
    v_add_f32 v99, v99, v119
    v_add_f32 v100, v100, v120
    v_mfma_f32_16x16x32_bf16 v[206:209], a[128:131], a[232:235], v[206:209]
    v_add_f32 v101, v101, v121
    v_mfma_f32_16x16x32_bf16 v[206:209], a[148:151], a[248:251], v[206:209]
    buffer_load_dwordx4 a[200:203], v6, s[8:11], s44 offen sc1
    v_add_f32 v102, v102, v122
    v_mfma_f32_16x16x32_bf16 v[226:229], a[148:151], a[252:255], v[226:229]
    v_add_f32 v103, v103, v123
    v_mfma_f32_16x16x32_bf16 v[226:229], a[128:131], a[236:239], v[226:229]
    buffer_load_dwordx4 a[204:207], v7, s[8:11], s44 offen sc1
    v_add_f32 v104, v104, v124
    v_add_f32 v105, v105, v125
    v_mfma_f32_16x16x32_bf16 v[170:173], a[132:135], a[224:227], v[170:173]
    v_cvt_pk_bf16_f32 v106, v86, v87
    v_mfma_f32_16x16x32_bf16 v[170:173], a[152:155], a[240:243], v[170:173]
    v_cvt_pk_bf16_f32 v107, v88, v89
    v_mfma_f32_16x16x32_bf16 v[190:193], a[152:155], a[244:247], v[190:193]
    s_mov_b32 s44, 442368
    buffer_load_dwordx4 a[208:211], v4, s[8:11], s44 offen sc1
    v_cvt_pk_bf16_f32 v108, v90, v91
    v_mfma_f32_16x16x32_bf16 v[190:193], a[132:135], a[228:231], v[190:193]
    v_cvt_pk_bf16_f32 v109, v92, v93
    v_cvt_pk_bf16_f32 v110, v94, v95
    v_mfma_f32_16x16x32_bf16 v[210:213], a[132:135], a[232:235], v[210:213]
    buffer_load_dwordx4 a[212:215], v5, s[8:11], s44 offen sc1
    v_cvt_pk_bf16_f32 v111, v96, v97
    v_mfma_f32_16x16x32_bf16 v[210:213], a[152:155], a[248:251], v[210:213]
    v_cvt_pk_bf16_f32 v112, v98, v99
    v_mfma_f32_16x16x32_bf16 v[230:233], a[152:155], a[252:255], v[230:233]
    v_cvt_pk_bf16_f32 v113, v100, v101
    v_mfma_f32_16x16x32_bf16 v[230:233], a[132:135], a[236:239], v[230:233]
    buffer_load_dwordx4 a[216:219], v6, s[8:11], s44 offen sc1
    v_cvt_pk_bf16_f32 v114, v102, v103
    v_cvt_pk_bf16_f32 v115, v104, v105
    v_mfma_f32_16x16x32_bf16 v[174:177], a[136:139], a[224:227], v[174:177]
    v_lshlrev_b32 v86, 16, v106
    v_mfma_f32_16x16x32_bf16 v[174:177], a[156:159], a[240:243], v[174:177]
    buffer_load_dwordx4 a[220:223], v7, s[8:11], s44 offen sc1
    v_and_b32 v87, 0xffff0000, v106
    v_mfma_f32_16x16x32_bf16 v[194:197], a[156:159], a[244:247], v[194:197]
    v_lshlrev_b32 v88, 16, v107
    v_mfma_f32_16x16x32_bf16 v[194:197], a[136:139], a[228:231], v[194:197]
    v_and_b32 v89, 0xffff0000, v107
    v_lshlrev_b32 v90, 16, v108
    v_mfma_f32_16x16x32_bf16 v[214:217], a[136:139], a[232:235], v[214:217]
    s_mov_b32 s45, 614400
    buffer_load_dwordx4 v[46:49], v16, s[20:23], s45 offen offset:0 sc1
    v_and_b32 v91, 0xffff0000, v108
    v_mfma_f32_16x16x32_bf16 v[214:217], a[156:159], a[248:251], v[214:217]
    v_lshlrev_b32 v92, 16, v109
    v_mfma_f32_16x16x32_bf16 v[234:237], a[156:159], a[252:255], v[234:237]
    buffer_load_dwordx4 v[50:53], v16, s[20:23], s45 offen offset:1024 sc1
    v_and_b32 v93, 0xffff0000, v109
    v_mfma_f32_16x16x32_bf16 v[234:237], a[136:139], a[236:239], v[234:237]
    v_lshlrev_b32 v94, 16, v110
    v_and_b32 v95, 0xffff0000, v110
    v_mfma_f32_16x16x32_bf16 v[178:181], a[140:143], a[224:227], v[178:181]
    v_lshlrev_b32 v96, 16, v111
    v_mfma_f32_16x16x32_bf16 v[178:181], a[160:163], a[240:243], v[178:181]
    buffer_load_dwordx4 v[54:57], v16, s[20:23], s45 offen offset:2048 sc1
    v_and_b32 v97, 0xffff0000, v111
    v_mfma_f32_16x16x32_bf16 v[198:201], a[160:163], a[244:247], v[198:201]
    v_lshlrev_b32 v98, 16, v112
    v_mfma_f32_16x16x32_bf16 v[198:201], a[140:143], a[228:231], v[198:201]
    buffer_load_dwordx4 v[58:61], v16, s[20:23], s45 offen offset:3072 sc1
    v_and_b32 v99, 0xffff0000, v112
    v_lshlrev_b32 v100, 16, v113
    v_mfma_f32_16x16x32_bf16 v[218:221], a[140:143], a[232:235], v[218:221]
    v_and_b32 v101, 0xffff0000, v113
    v_mfma_f32_16x16x32_bf16 v[218:221], a[160:163], a[248:251], v[218:221]
    v_lshlrev_b32 v102, 16, v114
    v_mfma_f32_16x16x32_bf16 v[238:241], a[160:163], a[252:255], v[238:241]
    v_and_b32 v103, 0xffff0000, v114
    v_mfma_f32_16x16x32_bf16 v[238:241], a[140:143], a[236:239], v[238:241]
    v_lshlrev_b32 v104, 16, v115
    v_and_b32 v105, 0xffff0000, v115
    v_mfma_f32_16x16x32_bf16 v[182:185], a[144:147], a[224:227], v[182:185]
    v_mul_f32 v106, 0xbfb8aa3b, v86
    v_mfma_f32_16x16x32_bf16 v[182:185], a[164:167], a[240:243], v[182:185]
    v_mul_f32 v107, 0xbfb8aa3b, v87
    v_mfma_f32_16x16x32_bf16 v[202:205], a[164:167], a[244:247], v[202:205]
    v_mul_f32 v108, 0xbfb8aa3b, v88
    v_mfma_f32_16x16x32_bf16 v[202:205], a[144:147], a[228:231], v[202:205]
    v_mul_f32 v109, 0xbfb8aa3b, v89
    v_mul_f32 v110, 0xbfb8aa3b, v90
    v_mfma_f32_16x16x32_bf16 v[222:225], a[144:147], a[232:235], v[222:225]
    v_mul_f32 v111, 0xbfb8aa3b, v91
    v_mfma_f32_16x16x32_bf16 v[222:225], a[164:167], a[248:251], v[222:225]
    v_mul_f32 v112, 0xbfb8aa3b, v92
    v_mfma_f32_16x16x32_bf16 v[242:245], a[164:167], a[252:255], v[242:245]
    v_mul_f32 v113, 0xbfb8aa3b, v93
    v_mfma_f32_16x16x32_bf16 v[242:245], a[144:147], a[236:239], v[242:245]
    v_mul_f32 v114, 0xbfb8aa3b, v94
    v_mul_f32 v115, 0xbfb8aa3b, v95
    s_waitcnt vmcnt(16)
    v_mfma_f32_16x16x32_bf16 v[166:169], a[168:171], a[96:99], v[166:169]
    s_mov_b32 s44, 458752
    buffer_load_dwordx4 a[224:227], v4, s[8:11], s44 offen sc1
    v_mul_f32 v116, 0xbfb8aa3b, v96
    v_mfma_f32_16x16x32_bf16 v[166:169], a[188:191], a[112:115], v[166:169]
    v_mul_f32 v117, 0xbfb8aa3b, v97
    v_mfma_f32_16x16x32_bf16 v[186:189], a[188:191], a[116:119], v[186:189]
    buffer_load_dwordx4 a[228:231], v5, s[8:11], s44 offen sc1
    v_mul_f32 v118, 0xbfb8aa3b, v98
    v_mfma_f32_16x16x32_bf16 v[186:189], a[168:171], a[100:103], v[186:189]
    v_mul_f32 v119, 0xbfb8aa3b, v99
    v_mul_f32 v120, 0xbfb8aa3b, v100
    v_mfma_f32_16x16x32_bf16 v[206:209], a[168:171], a[104:107], v[206:209]
    v_mul_f32 v121, 0xbfb8aa3b, v101
    v_mfma_f32_16x16x32_bf16 v[206:209], a[188:191], a[120:123], v[206:209]
    buffer_load_dwordx4 a[232:235], v6, s[8:11], s44 offen sc1
    v_mul_f32 v122, 0xbfb8aa3b, v102
    v_mfma_f32_16x16x32_bf16 v[226:229], a[188:191], a[124:127], v[226:229]
    v_mul_f32 v123, 0xbfb8aa3b, v103
    v_mfma_f32_16x16x32_bf16 v[226:229], a[168:171], a[108:111], v[226:229]
    buffer_load_dwordx4 a[236:239], v7, s[8:11], s44 offen sc1
    v_mul_f32 v124, 0xbfb8aa3b, v104
    v_mul_f32 v125, 0xbfb8aa3b, v105
    v_mfma_f32_16x16x32_bf16 v[170:173], a[172:175], a[96:99], v[170:173]
    v_exp_f32 v106, v106
    v_mfma_f32_16x16x32_bf16 v[170:173], a[0:3], a[112:115], v[170:173]
    v_exp_f32 v107, v107
    v_mfma_f32_16x16x32_bf16 v[190:193], a[0:3], a[116:119], v[190:193]
    s_mov_b32 s44, 475136
    buffer_load_dwordx4 a[240:243], v4, s[8:11], s44 offen sc1
    v_exp_f32 v108, v108
    v_mfma_f32_16x16x32_bf16 v[190:193], a[172:175], a[100:103], v[190:193]
    v_exp_f32 v109, v109
    v_exp_f32 v110, v110
    v_mfma_f32_16x16x32_bf16 v[210:213], a[172:175], a[104:107], v[210:213]
    buffer_load_dwordx4 a[244:247], v5, s[8:11], s44 offen sc1
    v_exp_f32 v111, v111
    v_mfma_f32_16x16x32_bf16 v[210:213], a[0:3], a[120:123], v[210:213]
    v_exp_f32 v112, v112
    v_mfma_f32_16x16x32_bf16 v[230:233], a[0:3], a[124:127], v[230:233]
    v_exp_f32 v113, v113
    v_mfma_f32_16x16x32_bf16 v[230:233], a[172:175], a[108:111], v[230:233]
    buffer_load_dwordx4 a[248:251], v6, s[8:11], s44 offen sc1
    v_exp_f32 v114, v114
    v_exp_f32 v115, v115
    v_mfma_f32_16x16x32_bf16 v[174:177], a[176:179], a[96:99], v[174:177]
    v_exp_f32 v116, v116
    v_mfma_f32_16x16x32_bf16 v[174:177], a[4:7], a[112:115], v[174:177]
    buffer_load_dwordx4 a[252:255], v7, s[8:11], s44 offen sc1
    v_exp_f32 v117, v117
    v_mfma_f32_16x16x32_bf16 v[194:197], a[4:7], a[116:119], v[194:197]
    v_exp_f32 v118, v118
    v_mfma_f32_16x16x32_bf16 v[194:197], a[176:179], a[100:103], v[194:197]
    v_exp_f32 v119, v119
    v_exp_f32 v120, v120
    v_mfma_f32_16x16x32_bf16 v[214:217], a[176:179], a[104:107], v[214:217]
    buffer_load_dwordx4 v[62:65], v17, s[20:23], s45 offen offset:0 sc1
    v_exp_f32 v121, v121
    v_mfma_f32_16x16x32_bf16 v[214:217], a[4:7], a[120:123], v[214:217]
    v_exp_f32 v122, v122
    v_mfma_f32_16x16x32_bf16 v[234:237], a[4:7], a[124:127], v[234:237]
    s_mov_b32 s45, 634880
    buffer_load_dwordx4 v[66:69], v16, s[20:23], s45 offen offset:0 sc1
    v_exp_f32 v123, v123
    v_mfma_f32_16x16x32_bf16 v[234:237], a[176:179], a[108:111], v[234:237]
    v_exp_f32 v124, v124
    v_exp_f32 v125, v125
    v_mfma_f32_16x16x32_bf16 v[178:181], a[180:183], a[96:99], v[178:181]
    v_add_f32 v106, 1.0, v106
    v_mfma_f32_16x16x32_bf16 v[178:181], a[8:11], a[112:115], v[178:181]
    buffer_load_dwordx4 v[70:73], v16, s[20:23], s45 offen offset:1024 sc1
    v_add_f32 v107, 1.0, v107
    v_mfma_f32_16x16x32_bf16 v[198:201], a[8:11], a[116:119], v[198:201]
    v_add_f32 v108, 1.0, v108
    v_mfma_f32_16x16x32_bf16 v[198:201], a[180:183], a[100:103], v[198:201]
    buffer_load_dwordx4 v[74:77], v16, s[20:23], s45 offen offset:2048 sc1
    v_add_f32 v109, 1.0, v109
    v_add_f32 v110, 1.0, v110
    v_mfma_f32_16x16x32_bf16 v[218:221], a[180:183], a[104:107], v[218:221]
    v_add_f32 v111, 1.0, v111
    v_mfma_f32_16x16x32_bf16 v[218:221], a[8:11], a[120:123], v[218:221]
    v_add_f32 v112, 1.0, v112
    v_mfma_f32_16x16x32_bf16 v[238:241], a[8:11], a[124:127], v[238:241]
    v_add_f32 v113, 1.0, v113
    v_mfma_f32_16x16x32_bf16 v[238:241], a[180:183], a[108:111], v[238:241]
    v_add_f32 v114, 1.0, v114
    v_add_f32 v115, 1.0, v115
    v_mfma_f32_16x16x32_bf16 v[182:185], a[184:187], a[96:99], v[182:185]
    v_add_f32 v116, 1.0, v116
    v_mfma_f32_16x16x32_bf16 v[182:185], a[12:15], a[112:115], v[182:185]
    v_add_f32 v117, 1.0, v117
    v_mfma_f32_16x16x32_bf16 v[202:205], a[12:15], a[116:119], v[202:205]
    v_add_f32 v118, 1.0, v118
    v_mfma_f32_16x16x32_bf16 v[202:205], a[184:187], a[100:103], v[202:205]
    v_add_f32 v119, 1.0, v119
    v_add_f32 v120, 1.0, v120
    v_mfma_f32_16x16x32_bf16 v[222:225], a[184:187], a[104:107], v[222:225]
    v_add_f32 v121, 1.0, v121
    v_mfma_f32_16x16x32_bf16 v[222:225], a[12:15], a[120:123], v[222:225]
    v_add_f32 v122, 1.0, v122
    v_mfma_f32_16x16x32_bf16 v[242:245], a[12:15], a[124:127], v[242:245]
    v_add_f32 v123, 1.0, v123
    v_mfma_f32_16x16x32_bf16 v[242:245], a[184:187], a[108:111], v[242:245]
    v_add_f32 v124, 1.0, v124
    v_add_f32 v125, 1.0, v125
    s_waitcnt vmcnt(16)
    v_mfma_f32_16x16x32_bf16 v[166:169], a[16:19], a[192:195], v[166:169]
    s_mov_b32 s44, 491520
    buffer_load_dwordx4 a[96:99], v4, s[8:11], s44 offen sc1
    v_rcp_f32 v106, v106
    v_mfma_f32_16x16x32_bf16 v[166:169], a[36:39], a[208:211], v[166:169]
    v_rcp_f32 v107, v107
    v_mfma_f32_16x16x32_bf16 v[186:189], a[36:39], a[212:215], v[186:189]
    v_rcp_f32 v108, v108
    v_mfma_f32_16x16x32_bf16 v[186:189], a[16:19], a[196:199], v[186:189]
    buffer_load_dwordx4 a[100:103], v5, s[8:11], s44 offen sc1
    v_rcp_f32 v109, v109
    v_rcp_f32 v110, v110
    v_mfma_f32_16x16x32_bf16 v[206:209], a[16:19], a[200:203], v[206:209]
    v_rcp_f32 v111, v111
    v_mfma_f32_16x16x32_bf16 v[206:209], a[36:39], a[216:219], v[206:209]
    v_rcp_f32 v112, v112
    v_mfma_f32_16x16x32_bf16 v[226:229], a[36:39], a[220:223], v[226:229]
    buffer_load_dwordx4 a[104:107], v6, s[8:11], s44 offen sc1
    v_rcp_f32 v113, v113
    v_mfma_f32_16x16x32_bf16 v[226:229], a[16:19], a[204:207], v[226:229]
    v_rcp_f32 v114, v114
    v_rcp_f32 v115, v115
    v_mfma_f32_16x16x32_bf16 v[170:173], a[20:23], a[192:195], v[170:173]
    v_rcp_f32 v116, v116
    v_mfma_f32_16x16x32_bf16 v[170:173], a[40:43], a[208:211], v[170:173]
    buffer_load_dwordx4 a[108:111], v7, s[8:11], s44 offen sc1
    v_rcp_f32 v117, v117
    v_mfma_f32_16x16x32_bf16 v[190:193], a[40:43], a[212:215], v[190:193]
    v_rcp_f32 v118, v118
    v_mfma_f32_16x16x32_bf16 v[190:193], a[20:23], a[196:199], v[190:193]
    v_rcp_f32 v119, v119
    v_rcp_f32 v120, v120
    v_mfma_f32_16x16x32_bf16 v[210:213], a[20:23], a[200:203], v[210:213]
    s_mov_b32 s44, 507904
    buffer_load_dwordx4 a[112:115], v4, s[8:11], s44 offen sc1
    v_rcp_f32 v121, v121
    v_mfma_f32_16x16x32_bf16 v[210:213], a[40:43], a[216:219], v[210:213]
    v_rcp_f32 v122, v122
    v_mfma_f32_16x16x32_bf16 v[230:233], a[40:43], a[220:223], v[230:233]
    v_rcp_f32 v123, v123
    v_mfma_f32_16x16x32_bf16 v[230:233], a[20:23], a[204:207], v[230:233]
    buffer_load_dwordx4 a[116:119], v5, s[8:11], s44 offen sc1
    v_rcp_f32 v124, v124
    v_rcp_f32 v125, v125
    v_mfma_f32_16x16x32_bf16 v[174:177], a[24:27], a[192:195], v[174:177]
    v_mul_f32 v86, v86, v106
    v_mfma_f32_16x16x32_bf16 v[174:177], a[44:47], a[208:211], v[174:177]
    v_mul_f32 v87, v87, v107
    v_mfma_f32_16x16x32_bf16 v[194:197], a[44:47], a[212:215], v[194:197]
    buffer_load_dwordx4 a[120:123], v6, s[8:11], s44 offen sc1
    v_mul_f32 v88, v88, v108
    v_mfma_f32_16x16x32_bf16 v[194:197], a[24:27], a[196:199], v[194:197]
    v_mul_f32 v89, v89, v109
    v_mul_f32 v90, v90, v110
    v_mfma_f32_16x16x32_bf16 v[214:217], a[24:27], a[200:203], v[214:217]
    v_mul_f32 v91, v91, v111
    v_mfma_f32_16x16x32_bf16 v[214:217], a[44:47], a[216:219], v[214:217]
    buffer_load_dwordx4 a[124:127], v7, s[8:11], s44 offen sc1
    v_mul_f32 v92, v92, v112
    v_mfma_f32_16x16x32_bf16 v[234:237], a[44:47], a[220:223], v[234:237]
    v_mul_f32 v93, v93, v113
    v_mfma_f32_16x16x32_bf16 v[234:237], a[24:27], a[204:207], v[234:237]
    v_mul_f32 v94, v94, v114
    v_mul_f32 v95, v95, v115
    v_mfma_f32_16x16x32_bf16 v[178:181], a[28:31], a[192:195], v[178:181]
    buffer_load_dwordx4 v[78:81], v16, s[20:23], s45 offen offset:3072 sc1
    v_mul_f32 v96, v96, v116
    v_mfma_f32_16x16x32_bf16 v[178:181], a[48:51], a[208:211], v[178:181]
    v_mul_f32 v97, v97, v117
    v_mfma_f32_16x16x32_bf16 v[198:201], a[48:51], a[212:215], v[198:201]
    v_mul_f32 v98, v98, v118
    v_mfma_f32_16x16x32_bf16 v[198:201], a[28:31], a[196:199], v[198:201]
    buffer_load_dwordx4 v[82:85], v17, s[20:23], s45 offen offset:0 sc1
    v_mul_f32 v99, v99, v119
    v_mul_f32 v100, v100, v120
    v_mfma_f32_16x16x32_bf16 v[218:221], a[28:31], a[200:203], v[218:221]
    v_mul_f32 v101, v101, v121
    v_mfma_f32_16x16x32_bf16 v[218:221], a[48:51], a[216:219], v[218:221]
    v_mul_f32 v102, v102, v122
    v_mfma_f32_16x16x32_bf16 v[238:241], a[48:51], a[220:223], v[238:241]
    v_mul_f32 v103, v103, v123
    v_mfma_f32_16x16x32_bf16 v[238:241], a[28:31], a[204:207], v[238:241]
    v_mul_f32 v104, v104, v124
    v_mul_f32 v105, v105, v125
    v_mfma_f32_16x16x32_bf16 v[182:185], a[32:35], a[192:195], v[182:185]
    v_cvt_pk_bf16_f32 v36, v86, v87
    v_mfma_f32_16x16x32_bf16 v[182:185], a[52:55], a[208:211], v[182:185]
    v_cvt_pk_bf16_f32 v37, v88, v89
    v_mfma_f32_16x16x32_bf16 v[202:205], a[52:55], a[212:215], v[202:205]
    v_cvt_pk_bf16_f32 v38, v90, v91
    v_mfma_f32_16x16x32_bf16 v[202:205], a[32:35], a[196:199], v[202:205]
    v_cvt_pk_bf16_f32 v39, v92, v93
    v_cvt_pk_bf16_f32 v40, v94, v95
    v_mfma_f32_16x16x32_bf16 v[222:225], a[32:35], a[200:203], v[222:225]
    v_cvt_pk_bf16_f32 v41, v96, v97
    v_mfma_f32_16x16x32_bf16 v[222:225], a[52:55], a[216:219], v[222:225]
    v_cvt_pk_bf16_f32 v42, v98, v99
    v_mfma_f32_16x16x32_bf16 v[242:245], a[52:55], a[220:223], v[242:245]
    v_cvt_pk_bf16_f32 v43, v100, v101
    v_mfma_f32_16x16x32_bf16 v[242:245], a[32:35], a[204:207], v[242:245]
    v_cvt_pk_bf16_f32 v44, v102, v103
    v_cvt_pk_bf16_f32 v45, v104, v105
    s_waitcnt vmcnt(14)
    v_mfma_f32_16x16x32_bf16 v[166:169], a[56:59], a[224:227], v[166:169]
    v_lshlrev_b32 v86, 16, v36
    v_mfma_f32_16x16x32_bf16 v[166:169], a[76:79], a[240:243], v[166:169]
    v_and_b32 v87, 0xffff0000, v36
    v_mfma_f32_16x16x32_bf16 v[186:189], a[76:79], a[244:247], v[186:189]
    v_lshlrev_b32 v106, 16, v22
    v_mfma_f32_16x16x32_bf16 v[186:189], a[56:59], a[228:231], v[186:189]
    v_and_b32 v107, 0xffff0000, v22
    v_mfma_f32_16x16x32_bf16 v[206:209], a[56:59], a[232:235], v[206:209]
    v_lshlrev_b32 v88, 16, v37
    v_mfma_f32_16x16x32_bf16 v[206:209], a[76:79], a[248:251], v[206:209]
    v_and_b32 v89, 0xffff0000, v37
    v_mfma_f32_16x16x32_bf16 v[226:229], a[76:79], a[252:255], v[226:229]
    v_lshlrev_b32 v108, 16, v23
    v_mfma_f32_16x16x32_bf16 v[226:229], a[56:59], a[236:239], v[226:229]
    v_and_b32 v109, 0xffff0000, v23
    v_mfma_f32_16x16x32_bf16 v[170:173], a[60:63], a[224:227], v[170:173]
    v_lshlrev_b32 v90, 16, v38
    v_mfma_f32_16x16x32_bf16 v[170:173], a[80:83], a[240:243], v[170:173]
    v_and_b32 v91, 0xffff0000, v38
    v_mfma_f32_16x16x32_bf16 v[190:193], a[80:83], a[244:247], v[190:193]
    v_lshlrev_b32 v110, 16, v24
    v_mfma_f32_16x16x32_bf16 v[190:193], a[60:63], a[228:231], v[190:193]
    v_and_b32 v111, 0xffff0000, v24
    v_mfma_f32_16x16x32_bf16 v[210:213], a[60:63], a[232:235], v[210:213]
    v_lshlrev_b32 v92, 16, v39
    v_mfma_f32_16x16x32_bf16 v[210:213], a[80:83], a[248:251], v[210:213]
    v_and_b32 v93, 0xffff0000, v39
    v_mfma_f32_16x16x32_bf16 v[230:233], a[80:83], a[252:255], v[230:233]
    v_lshlrev_b32 v112, 16, v25
    v_mfma_f32_16x16x32_bf16 v[230:233], a[60:63], a[236:239], v[230:233]
    v_and_b32 v113, 0xffff0000, v25
    v_mfma_f32_16x16x32_bf16 v[174:177], a[64:67], a[224:227], v[174:177]
    v_lshlrev_b32 v94, 16, v40
    v_mfma_f32_16x16x32_bf16 v[174:177], a[84:87], a[240:243], v[174:177]
    v_and_b32 v95, 0xffff0000, v40
    v_mfma_f32_16x16x32_bf16 v[194:197], a[84:87], a[244:247], v[194:197]
    v_lshlrev_b32 v114, 16, v26
    v_mfma_f32_16x16x32_bf16 v[194:197], a[64:67], a[228:231], v[194:197]
    v_and_b32 v115, 0xffff0000, v26
    v_mfma_f32_16x16x32_bf16 v[214:217], a[64:67], a[232:235], v[214:217]
    v_lshlrev_b32 v96, 16, v41
    v_mfma_f32_16x16x32_bf16 v[214:217], a[84:87], a[248:251], v[214:217]
    v_and_b32 v97, 0xffff0000, v41
    v_mfma_f32_16x16x32_bf16 v[234:237], a[84:87], a[252:255], v[234:237]
    v_lshlrev_b32 v116, 16, v27
    v_mfma_f32_16x16x32_bf16 v[234:237], a[64:67], a[236:239], v[234:237]
    v_and_b32 v117, 0xffff0000, v27
    v_mfma_f32_16x16x32_bf16 v[178:181], a[68:71], a[224:227], v[178:181]
    v_lshlrev_b32 v98, 16, v42
    v_mfma_f32_16x16x32_bf16 v[178:181], a[88:91], a[240:243], v[178:181]
    v_and_b32 v99, 0xffff0000, v42
    v_mfma_f32_16x16x32_bf16 v[198:201], a[88:91], a[244:247], v[198:201]
    v_lshlrev_b32 v118, 16, v28
    v_mfma_f32_16x16x32_bf16 v[198:201], a[68:71], a[228:231], v[198:201]
    v_and_b32 v119, 0xffff0000, v28
    v_mfma_f32_16x16x32_bf16 v[218:221], a[68:71], a[232:235], v[218:221]
    v_lshlrev_b32 v100, 16, v43
    v_mfma_f32_16x16x32_bf16 v[218:221], a[88:91], a[248:251], v[218:221]
    v_and_b32 v101, 0xffff0000, v43
    v_mfma_f32_16x16x32_bf16 v[238:241], a[88:91], a[252:255], v[238:241]
    v_lshlrev_b32 v120, 16, v29
    v_mfma_f32_16x16x32_bf16 v[238:241], a[68:71], a[236:239], v[238:241]
    v_and_b32 v121, 0xffff0000, v29
    v_mfma_f32_16x16x32_bf16 v[182:185], a[72:75], a[224:227], v[182:185]
    v_lshlrev_b32 v102, 16, v44
    v_mfma_f32_16x16x32_bf16 v[182:185], a[92:95], a[240:243], v[182:185]
    v_and_b32 v103, 0xffff0000, v44
    v_mfma_f32_16x16x32_bf16 v[202:205], a[92:95], a[244:247], v[202:205]
    v_lshlrev_b32 v122, 16, v30
    v_mfma_f32_16x16x32_bf16 v[202:205], a[72:75], a[228:231], v[202:205]
    v_and_b32 v123, 0xffff0000, v30
    v_mfma_f32_16x16x32_bf16 v[222:225], a[72:75], a[232:235], v[222:225]
    v_lshlrev_b32 v104, 16, v45
    v_mfma_f32_16x16x32_bf16 v[222:225], a[92:95], a[248:251], v[222:225]
    v_and_b32 v105, 0xffff0000, v45
    v_mfma_f32_16x16x32_bf16 v[242:245], a[92:95], a[252:255], v[242:245]
    v_lshlrev_b32 v124, 16, v31
    s_sub_u32 s40, s5, 1
    s_and_b32 s40, s40, 3
    s_mul_i32 s40, s40, 10240
    v_lshl_add_u32 v5, v19, 4, s40
    s_sub_u32 s40, s5, 2
    s_and_b32 s40, s40, 3
    s_mul_i32 s40, s40, 10240
    v_lshl_add_u32 v6, v19, 4, s40
    s_sub_u32 s40, s5, 3
    s_and_b32 s40, s40, 3
    s_mul_i32 s40, s40, 10240
    v_lshl_add_u32 v7, v19, 4, s40
    v_mfma_f32_16x16x32_bf16 v[242:245], a[72:75], a[236:239], v[242:245]
    v_and_b32 v125, 0xffff0000, v31
    s_waitcnt vmcnt(0)
    v_mfma_f32_16x16x32_bf16 v[186:189], v[46:49], a[100:103], v[186:189]
    v_mfma_f32_16x16x32_bf16 v[186:189], v[66:69], a[116:119], v[186:189]
    v_mfma_f32_16x16x32_bf16 v[190:193], v[70:73], a[116:119], v[190:193]
    v_mfma_f32_16x16x32_bf16 v[190:193], v[50:53], a[100:103], v[190:193]
    v_mfma_f32_16x16x32_bf16 v[194:197], v[54:57], a[100:103], v[194:197]
    v_mfma_f32_16x16x32_bf16 v[194:197], v[74:77], a[116:119], v[194:197]
    v_mfma_f32_16x16x32_bf16 v[198:201], v[78:81], a[116:119], v[198:201]
    v_mfma_f32_16x16x32_bf16 v[198:201], v[58:61], a[100:103], v[198:201]
    v_mfma_f32_16x16x32_bf16 v[202:205], v[62:65], a[100:103], v[202:205]
    v_mfma_f32_16x16x32_bf16 v[202:205], v[82:85], a[116:119], v[202:205]
    ds_write_b128 v9, v[186:189] offset:0
    v_mfma_f32_16x16x32_bf16 v[206:209], v[66:69], a[120:123], v[206:209]
    v_mfma_f32_16x16x32_bf16 v[206:209], v[46:49], a[104:107], v[206:209]
    ds_write_b128 v9, v[190:193] offset:1024
    v_mfma_f32_16x16x32_bf16 v[210:213], v[50:53], a[104:107], v[210:213]
    v_mfma_f32_16x16x32_bf16 v[210:213], v[70:73], a[120:123], v[210:213]
    ds_write_b128 v9, v[194:197] offset:2048
    v_mfma_f32_16x16x32_bf16 v[214:217], v[74:77], a[120:123], v[214:217]
    v_mfma_f32_16x16x32_bf16 v[214:217], v[54:57], a[104:107], v[214:217]
    ds_write_b128 v9, v[198:201] offset:3072
    v_mfma_f32_16x16x32_bf16 v[218:221], v[58:61], a[104:107], v[218:221]
    v_mfma_f32_16x16x32_bf16 v[218:221], v[78:81], a[120:123], v[218:221]
    ds_write_b128 v9, v[202:205] offset:4096
    v_mfma_f32_16x16x32_bf16 v[222:225], v[82:85], a[120:123], v[222:225]
    v_mfma_f32_16x16x32_bf16 v[222:225], v[62:65], a[104:107], v[222:225]
    ds_write_b128 v9, v[206:209] offset:5120
    v_mfma_f32_16x16x32_bf16 v[226:229], v[46:49], a[108:111], v[226:229]
    v_mfma_f32_16x16x32_bf16 v[226:229], v[66:69], a[124:127], v[226:229]
    ds_write_b128 v9, v[210:213] offset:6144
    v_mfma_f32_16x16x32_bf16 v[230:233], v[70:73], a[124:127], v[230:233]
    v_mfma_f32_16x16x32_bf16 v[230:233], v[50:53], a[108:111], v[230:233]
    ds_write_b128 v9, v[214:217] offset:7168
    v_mfma_f32_16x16x32_bf16 v[234:237], v[54:57], a[108:111], v[234:237]
    v_mfma_f32_16x16x32_bf16 v[234:237], v[74:77], a[124:127], v[234:237]
    ds_write_b128 v9, v[218:221] offset:8192
    v_mfma_f32_16x16x32_bf16 v[238:241], v[78:81], a[124:127], v[238:241]
    v_mfma_f32_16x16x32_bf16 v[238:241], v[58:61], a[108:111], v[238:241]
    ds_write_b128 v9, v[222:225] offset:9216
    v_mfma_f32_16x16x32_bf16 v[242:245], v[62:65], a[108:111], v[242:245]
    v_mfma_f32_16x16x32_bf16 v[242:245], v[82:85], a[124:127], v[242:245]
    ds_write_b128 v9, v[226:229] offset:40960
    v_mfma_f32_16x16x32_bf16 v[166:169], v[66:69], a[112:115], v[166:169]
    v_mfma_f32_16x16x32_bf16 v[166:169], v[46:49], a[96:99], v[166:169]
    ds_write_b128 v9, v[230:233] offset:41984
    v_mfma_f32_16x16x32_bf16 v[170:173], v[50:53], a[96:99], v[170:173]
    v_mfma_f32_16x16x32_bf16 v[170:173], v[70:73], a[112:115], v[170:173]
    ds_write_b128 v9, v[234:237] offset:43008
    v_mfma_f32_16x16x32_bf16 v[174:177], v[74:77], a[112:115], v[174:177]
    v_mfma_f32_16x16x32_bf16 v[174:177], v[54:57], a[96:99], v[174:177]
    ds_write_b128 v9, v[238:241] offset:44032
    v_mfma_f32_16x16x32_bf16 v[178:181], v[58:61], a[96:99], v[178:181]
    v_mfma_f32_16x16x32_bf16 v[178:181], v[78:81], a[112:115], v[178:181]
    ds_write_b128 v9, v[242:245] offset:45056
    v_mfma_f32_16x16x32_bf16 v[182:185], v[82:85], a[112:115], v[182:185]
    v_mfma_f32_16x16x32_bf16 v[182:185], v[62:65], a[96:99], v[182:185]
    s_waitcnt lgkmcnt(0)
    s_barrier
    ds_read_b128 v[186:189], v5 offset:0
    ds_read_b128 v[190:193], v5 offset:1024
    ds_read_b128 v[194:197], v5 offset:2048
    ds_read_b128 v[198:201], v5 offset:3072
    ds_read_b128 v[202:205], v5 offset:4096
    ds_read_b128 v[206:209], v6 offset:5120
    ds_read_b128 v[210:213], v6 offset:6144
    ds_read_b128 v[214:217], v6 offset:7168
    ds_read_b128 v[218:221], v6 offset:8192
    ds_read_b128 v[222:225], v6 offset:9216
    ds_read_b128 v[226:229], v7 offset:40960
    ds_read_b128 v[230:233], v7 offset:41984
    ds_read_b128 v[234:237], v7 offset:43008
    ds_read_b128 v[238:241], v7 offset:44032
    ds_read_b128 v[242:245], v7 offset:45056
    s_waitcnt lgkmcnt(10)
    v_pk_add_f32 v[166:167], v[166:167], v[186:187]
    v_pk_add_f32 v[168:169], v[168:169], v[188:189]
    v_pk_add_f32 v[170:171], v[170:171], v[190:191]
    v_pk_add_f32 v[172:173], v[172:173], v[192:193]
    v_pk_add_f32 v[174:175], v[174:175], v[194:195]
    v_pk_add_f32 v[176:177], v[176:177], v[196:197]
    v_pk_add_f32 v[178:179], v[178:179], v[198:199]
    v_pk_add_f32 v[180:181], v[180:181], v[200:201]
    v_pk_add_f32 v[182:183], v[182:183], v[202:203]
    v_pk_add_f32 v[184:185], v[184:185], v[204:205]
    s_waitcnt lgkmcnt(5)
    v_pk_add_f32 v[166:167], v[166:167], v[206:207]
    v_pk_add_f32 v[168:169], v[168:169], v[208:209]
    v_pk_add_f32 v[170:171], v[170:171], v[210:211]
    v_pk_add_f32 v[172:173], v[172:173], v[212:213]
    v_pk_add_f32 v[174:175], v[174:175], v[214:215]
    v_pk_add_f32 v[176:177], v[176:177], v[216:217]
    v_pk_add_f32 v[178:179], v[178:179], v[218:219]
    v_pk_add_f32 v[180:181], v[180:181], v[220:221]
    v_pk_add_f32 v[182:183], v[182:183], v[222:223]
    v_pk_add_f32 v[184:185], v[184:185], v[224:225]
    s_waitcnt lgkmcnt(0)
    v_pk_add_f32 v[166:167], v[166:167], v[226:227]
    v_pk_add_f32 v[168:169], v[168:169], v[228:229]
    v_pk_add_f32 v[170:171], v[170:171], v[230:231]
    v_pk_add_f32 v[172:173], v[172:173], v[232:233]
    v_pk_add_f32 v[174:175], v[174:175], v[234:235]
    v_pk_add_f32 v[176:177], v[176:177], v[236:237]
    v_pk_add_f32 v[178:179], v[178:179], v[238:239]
    v_pk_add_f32 v[180:181], v[180:181], v[240:241]
    v_pk_add_f32 v[182:183], v[182:183], v[242:243]
    v_pk_add_f32 v[184:185], v[184:185], v[244:245]
    v_cvt_pk_bf16_f32 v46, v166, v167
    v_cvt_pk_bf16_f32 v47, v168, v169
    v_cvt_pk_bf16_f32 v48, v170, v171
    v_cvt_pk_bf16_f32 v49, v172, v173
    v_cvt_pk_bf16_f32 v50, v174, v175
    v_cvt_pk_bf16_f32 v51, v176, v177
    v_cvt_pk_bf16_f32 v52, v178, v179
    v_cvt_pk_bf16_f32 v53, v180, v181
    v_cvt_pk_bf16_f32 v54, v182, v183
    v_cvt_pk_bf16_f32 v55, v184, v185
    v_lshlrev_b32 v166, 16, v46
    v_and_b32 v167, 0xffff0000, v46
    v_lshlrev_b32 v168, 16, v47
    v_and_b32 v169, 0xffff0000, v47
    v_lshlrev_b32 v170, 16, v48
    v_and_b32 v171, 0xffff0000, v48
    v_lshlrev_b32 v172, 16, v49
    v_and_b32 v173, 0xffff0000, v49
    v_lshlrev_b32 v174, 16, v50
    v_and_b32 v175, 0xffff0000, v50
    v_lshlrev_b32 v176, 16, v51
    v_and_b32 v177, 0xffff0000, v51
    v_lshlrev_b32 v178, 16, v52
    v_and_b32 v179, 0xffff0000, v52
    v_lshlrev_b32 v180, 16, v53
    v_and_b32 v181, 0xffff0000, v53
    v_lshlrev_b32 v182, 16, v54
    v_and_b32 v183, 0xffff0000, v54
    v_lshlrev_b32 v184, 16, v55
    v_and_b32 v185, 0xffff0000, v55
    v_pk_mul_f32 v[166:167], v[166:167], v[86:87]
    v_pk_mul_f32 v[168:169], v[168:169], v[88:89]
    v_pk_mul_f32 v[170:171], v[170:171], v[90:91]
    v_pk_mul_f32 v[172:173], v[172:173], v[92:93]
    v_pk_mul_f32 v[174:175], v[174:175], v[94:95]
    v_pk_mul_f32 v[176:177], v[176:177], v[96:97]
    v_pk_mul_f32 v[178:179], v[178:179], v[98:99]
    v_pk_mul_f32 v[180:181], v[180:181], v[100:101]
    v_pk_mul_f32 v[182:183], v[182:183], v[102:103]
    v_pk_mul_f32 v[184:185], v[184:185], v[104:105]
    v_cvt_pk_bf16_f32 v46, v166, v167
    v_cvt_pk_bf16_f32 v47, v168, v169
    v_cvt_pk_bf16_f32 v48, v170, v171
    v_cvt_pk_bf16_f32 v49, v172, v173
    v_cvt_pk_bf16_f32 v50, v174, v175
    v_cvt_pk_bf16_f32 v51, v176, v177
    v_cvt_pk_bf16_f32 v52, v178, v179
    v_cvt_pk_bf16_f32 v53, v180, v181
    v_cvt_pk_bf16_f32 v54, v182, v183
    v_cvt_pk_bf16_f32 v55, v184, v185
    v_lshlrev_b32 v166, 16, v46
    v_and_b32 v167, 0xffff0000, v46
    v_lshlrev_b32 v168, 16, v47
    v_and_b32 v169, 0xffff0000, v47
    v_lshlrev_b32 v170, 16, v48
    v_and_b32 v171, 0xffff0000, v48
    v_lshlrev_b32 v172, 16, v49
    v_and_b32 v173, 0xffff0000, v49
    v_lshlrev_b32 v174, 16, v50
    v_and_b32 v175, 0xffff0000, v50
    v_lshlrev_b32 v176, 16, v51
    v_and_b32 v177, 0xffff0000, v51
    v_lshlrev_b32 v178, 16, v52
    v_and_b32 v179, 0xffff0000, v52
    v_lshlrev_b32 v180, 16, v53
    v_and_b32 v181, 0xffff0000, v53
    v_lshlrev_b32 v182, 16, v54
    v_and_b32 v183, 0xffff0000, v54
    v_lshlrev_b32 v184, 16, v55
    v_and_b32 v185, 0xffff0000, v55
    v_pk_add_f32 v[166:167], v[166:167], v[106:107]
    v_pk_add_f32 v[168:169], v[168:169], v[108:109]
    v_pk_add_f32 v[170:171], v[170:171], v[110:111]
    v_pk_add_f32 v[172:173], v[172:173], v[112:113]
    v_pk_add_f32 v[174:175], v[174:175], v[114:115]
    v_pk_add_f32 v[176:177], v[176:177], v[116:117]
    v_pk_add_f32 v[178:179], v[178:179], v[118:119]
    v_pk_add_f32 v[180:181], v[180:181], v[120:121]
    v_pk_add_f32 v[182:183], v[182:183], v[122:123]
    v_pk_add_f32 v[184:185], v[184:185], v[124:125]
    v_cvt_pk_bf16_f32 v46, v166, v167
    v_cvt_pk_bf16_f32 v47, v168, v169
    buffer_store_dwordx2 v[46:47], v34, s[12:15], 0 offen offset:0
    v_cvt_pk_bf16_f32 v48, v170, v171
    v_cvt_pk_bf16_f32 v49, v172, v173
    buffer_store_dwordx2 v[48:49], v34, s[12:15], 0 offen offset:32
    v_cvt_pk_bf16_f32 v50, v174, v175
    v_cvt_pk_bf16_f32 v51, v176, v177
    buffer_store_dwordx2 v[50:51], v34, s[12:15], 0 offen offset:64
    v_cvt_pk_bf16_f32 v52, v178, v179
    v_cvt_pk_bf16_f32 v53, v180, v181
    buffer_store_dwordx2 v[52:53], v34, s[12:15], 0 offen offset:96
    v_cvt_pk_bf16_f32 v54, v182, v183
    v_cvt_pk_bf16_f32 v55, v184, v185
    buffer_store_dwordx2 v[54:55], v34, s[12:15], 0 offen offset:128
L_end:
    s_endpgm
L_slow:
    s_lshl_b32 s40, s5, 12
    v_subrev_u32 v13, s40, v13
    v_subrev_u32 v14, s40, v14
    v_subrev_u32 v15, s40, v15
    v_subrev_u32 v16, s40, v16
    v_subrev_u32 v17, s40, v17
    v_subrev_u32 v18, s40, v18
    s_and_b32 s40, s5, 1
    s_lshr_b32 s41, s5, 1
    s_mul_i32 s41, s41, 3
    s_add_u32 s40, s40, s41
    s_add_u32 s40, s40, 1
    s_lshl_b32 s34, s40, 13
    s_sub_u32 s40, s34, 98304
    v_add_u32 v1, s40, v1
    v_add_u32 v2, s40, v2
    v_add_u32 v3, s40, v3
    v_add_u32 v4, s40, v4
    v_add_u32 v5, s34, v5
    v_add_u32 v6, s34, v6
    v_add_u32 v7, s34, v7
    v_add_u32 v8, s34, v8
    v_add_u32 v9, s34, v9
    v_add_u32 v10, s34, v10
    v_add_u32 v11, s34, v11
    v_add_u32 v12, s34, v12
    v_mov_b32 v212, 0xff800000
    v_mov_b32 v216, 0
    v_mov_b32 v213, 0xff800000
    v_mov_b32 v217, 0
    v_mov_b32 v214, 0xff800000
    v_mov_b32 v218, 0
    v_mov_b32 v215, 0xff800000
    v_mov_b32 v219, 0
    v_accvgpr_write_b32 a0, 0
    v_accvgpr_write_b32 a1, 0
    v_accvgpr_write_b32 a2, 0
    v_accvgpr_write_b32 a3, 0
    v_accvgpr_write_b32 a4, 0
    v_accvgpr_write_b32 a5, 0
    v_accvgpr_write_b32 a6, 0
    v_accvgpr_write_b32 a7, 0
    v_accvgpr_write_b32 a8, 0
    v_accvgpr_write_b32 a9, 0
    v_accvgpr_write_b32 a10, 0
    v_accvgpr_write_b32 a11, 0
    v_accvgpr_write_b32 a12, 0
    v_accvgpr_write_b32 a13, 0
    v_accvgpr_write_b32 a14, 0
    v_accvgpr_write_b32 a15, 0
    v_accvgpr_write_b32 a16, 0
    v_accvgpr_write_b32 a17, 0
    v_accvgpr_write_b32 a18, 0
    v_accvgpr_write_b32 a19, 0
    v_accvgpr_write_b32 a20, 0
    v_accvgpr_write_b32 a21, 0
    v_accvgpr_write_b32 a22, 0
    v_accvgpr_write_b32 a23, 0
    v_accvgpr_write_b32 a24, 0
    v_accvgpr_write_b32 a25, 0
    v_accvgpr_write_b32 a26, 0
    v_accvgpr_write_b32 a27, 0
    v_accvgpr_write_b32 a28, 0
    v_accvgpr_write_b32 a29, 0
    v_accvgpr_write_b32 a30, 0
    v_accvgpr_write_b32 a31, 0
    v_accvgpr_write_b32 a32, 0
    v_accvgpr_write_b32 a33, 0
    v_accvgpr_write_b32 a34, 0
    v_accvgpr_write_b32 a35, 0
    v_accvgpr_write_b32 a36, 0
    v_accvgpr_write_b32 a37, 0
    v_accvgpr_write_b32 a38, 0
    v_accvgpr_write_b32 a39, 0
    v_accvgpr_write_b32 a40, 0
    v_accvgpr_write_b32 a41, 0
    v_accvgpr_write_b32 a42, 0
    v_accvgpr_write_b32 a43, 0
    v_accvgpr_write_b32 a44, 0
    v_accvgpr_write_b32 a45, 0
    v_accvgpr_write_b32 a46, 0
    v_accvgpr_write_b32 a47, 0
    v_accvgpr_write_b32 a48, 0
    v_accvgpr_write_b32 a49, 0
    v_accvgpr_write_b32 a50, 0
    v_accvgpr_write_b32 a51, 0
    v_accvgpr_write_b32 a52, 0
    v_accvgpr_write_b32 a53, 0
    v_accvgpr_write_b32 a54, 0
    v_accvgpr_write_b32 a55, 0
    v_accvgpr_write_b32 a56, 0
    v_accvgpr_write_b32 a57, 0
    v_accvgpr_write_b32 a58, 0
    v_accvgpr_write_b32 a59, 0
    v_accvgpr_write_b32 a60, 0
    v_accvgpr_write_b32 a61, 0
    v_accvgpr_write_b32 a62, 0
    v_accvgpr_write_b32 a63, 0
    v_accvgpr_write_b32 a64, 0
    v_accvgpr_write_b32 a65, 0
    v_accvgpr_write_b32 a66, 0
    v_accvgpr_write_b32 a67, 0
    v_accvgpr_write_b32 a68, 0
    v_accvgpr_write_b32 a69, 0
    v_accvgpr_write_b32 a70, 0
    v_accvgpr_write_b32 a71, 0
    v_accvgpr_write_b32 a72, 0
    v_accvgpr_write_b32 a73, 0
    v_accvgpr_write_b32 a74, 0
    v_accvgpr_write_b32 a75, 0
    v_accvgpr_write_b32 a76, 0
    v_accvgpr_write_b32 a77, 0
    v_accvgpr_write_b32 a78, 0
    v_accvgpr_write_b32 a79, 0
    v_accvgpr_write_b32 a80, 0
    v_accvgpr_write_b32 a81, 0
    v_accvgpr_write_b32 a82, 0
    v_accvgpr_write_b32 a83, 0
    v_accvgpr_write_b32 a84, 0
    v_accvgpr_write_b32 a85, 0
    v_accvgpr_write_b32 a86, 0
    v_accvgpr_write_b32 a87, 0
    v_accvgpr_write_b32 a88, 0
    v_accvgpr_write_b32 a89, 0
    v_accvgpr_write_b32 a90, 0
    v_accvgpr_write_b32 a91, 0
    v_accvgpr_write_b32 a92, 0
    v_accvgpr_write_b32 a93, 0
    v_accvgpr_write_b32 a94, 0
    v_accvgpr_write_b32 a95, 0
    v_accvgpr_write_b32 a96, 0
    v_accvgpr_write_b32 a97, 0
    v_accvgpr_write_b32 a98, 0
    v_accvgpr_write_b32 a99, 0
    v_accvgpr_write_b32 a100, 0
    v_accvgpr_write_b32 a101, 0
    v_accvgpr_write_b32 a102, 0
    v_accvgpr_write_b32 a103, 0
    v_accvgpr_write_b32 a104, 0
    v_accvgpr_write_b32 a105, 0
    v_accvgpr_write_b32 a106, 0
    v_accvgpr_write_b32 a107, 0
    v_accvgpr_write_b32 a108, 0
    v_accvgpr_write_b32 a109, 0
    v_accvgpr_write_b32 a110, 0
    v_accvgpr_write_b32 a111, 0
    v_accvgpr_write_b32 a112, 0
    v_accvgpr_write_b32 a113, 0
    v_accvgpr_write_b32 a114, 0
    v_accvgpr_write_b32 a115, 0
    v_accvgpr_write_b32 a116, 0
    v_accvgpr_write_b32 a117, 0
    v_accvgpr_write_b32 a118, 0
    v_accvgpr_write_b32 a119, 0
    v_accvgpr_write_b32 a120, 0
    v_accvgpr_write_b32 a121, 0
    v_accvgpr_write_b32 a122, 0
    v_accvgpr_write_b32 a123, 0
    v_accvgpr_write_b32 a124, 0
    v_accvgpr_write_b32 a125, 0
    v_accvgpr_write_b32 a126, 0
    v_accvgpr_write_b32 a127, 0
    s_mov_b32 s28, 0
L_slow_loop:
    s_add_u32 m0, s34, 0
    s_add_u32 s40, s28, 0
    buffer_load_dwordx4 v13, s[8:11], s40 offen offset:0 lds
    buffer_load_dwordx4 v14, s[8:11], s40 offen offset:1024 lds
    buffer_load_dwordx4 v15, s[8:11], s40 offen offset:2048 lds
    buffer_load_dwordx4 v16, s[8:11], s40 offen offset:3072 lds
    s_add_u32 m0, s34, 4096
    s_add_u32 s40, s28, 4096
    buffer_load_dwordx4 v13, s[8:11], s40 offen offset:0 lds
    buffer_load_dwordx4 v14, s[8:11], s40 offen offset:1024 lds
    buffer_load_dwordx4 v15, s[8:11], s40 offen offset:2048 lds
    buffer_load_dwordx4 v16, s[8:11], s40 offen offset:3072 lds
    s_waitcnt vmcnt(0)
    ds_read_b128 v[148:151], v1 offset:0
    ds_read_b128 v[152:155], v2 offset:0
    ds_read_b128 v[156:159], v3 offset:0
    ds_read_b128 v[160:163], v4 offset:0
    ds_read_b128 v[164:167], v1 offset:4096
    ds_read_b128 v[168:171], v2 offset:4096
    ds_read_b128 v[172:175], v3 offset:4096
    ds_read_b128 v[176:179], v4 offset:4096
    s_waitcnt lgkmcnt(0)
    s_add_u32 m0, s34, 0
    s_add_u32 s40, s28, 0
    buffer_load_dwordx4 v17, s[12:15], s40 offen offset:0 lds
    buffer_load_dwordx4 v18, s[12:15], s40 offen offset:1024 lds
    buffer_load_dwordx4 v17, s[12:15], s40 offen offset:2048 lds
    buffer_load_dwordx4 v18, s[12:15], s40 offen offset:3072 lds
    s_add_u32 m0, s34, 4096
    s_add_u32 s40, s28, 4096
    buffer_load_dwordx4 v17, s[12:15], s40 offen offset:0 lds
    buffer_load_dwordx4 v18, s[12:15], s40 offen offset:1024 lds
    buffer_load_dwordx4 v17, s[12:15], s40 offen offset:2048 lds
    buffer_load_dwordx4 v18, s[12:15], s40 offen offset:3072 lds
    s_waitcnt vmcnt(0)
    ds_read_b64_tr_b16 v[196:197], v5 offset:0
    ds_read_b64_tr_b16 v[198:199], v5 offset:4096
    ds_read_b64_tr_b16 v[200:201], v6 offset:0
    ds_read_b64_tr_b16 v[202:203], v6 offset:4096
    ds_read_b64_tr_b16 v[204:205], v7 offset:0
    ds_read_b64_tr_b16 v[206:207], v7 offset:4096
    ds_read_b64_tr_b16 v[208:209], v8 offset:0
    ds_read_b64_tr_b16 v[210:211], v8 offset:4096
    ds_read_b64_tr_b16 v[228:229], v9 offset:0
    ds_read_b64_tr_b16 v[230:231], v9 offset:4096
    ds_read_b64_tr_b16 v[232:233], v10 offset:0
    ds_read_b64_tr_b16 v[234:235], v10 offset:4096
    ds_read_b64_tr_b16 v[236:237], v11 offset:0
    ds_read_b64_tr_b16 v[238:239], v11 offset:4096
    ds_read_b64_tr_b16 v[240:241], v12 offset:0
    ds_read_b64_tr_b16 v[242:243], v12 offset:4096
    v_mfma_f32_16x16x32_bf16 v[116:119], v[148:151], v[36:39], 0
    v_mfma_f32_16x16x32_bf16 v[116:119], v[152:155], v[40:43], v[116:119]
    v_mfma_f32_16x16x32_bf16 v[116:119], v[156:159], v[44:47], v[116:119]
    v_mfma_f32_16x16x32_bf16 v[116:119], v[160:163], v[48:51], v[116:119]
    v_mfma_f32_16x16x32_bf16 v[132:135], v[164:167], v[36:39], 0
    v_mfma_f32_16x16x32_bf16 v[132:135], v[168:171], v[40:43], v[132:135]
    v_mfma_f32_16x16x32_bf16 v[132:135], v[172:175], v[44:47], v[132:135]
    v_mfma_f32_16x16x32_bf16 v[132:135], v[176:179], v[48:51], v[132:135]
    v_mfma_f32_16x16x32_bf16 v[120:123], v[160:163], v[64:67], 0
    v_mfma_f32_16x16x32_bf16 v[120:123], v[156:159], v[60:63], v[120:123]
    v_mfma_f32_16x16x32_bf16 v[120:123], v[152:155], v[56:59], v[120:123]
    v_mfma_f32_16x16x32_bf16 v[120:123], v[148:151], v[52:55], v[120:123]
    v_mfma_f32_16x16x32_bf16 v[136:139], v[176:179], v[64:67], 0
    v_mfma_f32_16x16x32_bf16 v[136:139], v[172:175], v[60:63], v[136:139]
    v_mfma_f32_16x16x32_bf16 v[136:139], v[168:171], v[56:59], v[136:139]
    v_mfma_f32_16x16x32_bf16 v[136:139], v[164:167], v[52:55], v[136:139]
    v_mfma_f32_16x16x32_bf16 v[124:127], v[148:151], v[68:71], 0
    v_mfma_f32_16x16x32_bf16 v[124:127], v[152:155], v[72:75], v[124:127]
    v_mfma_f32_16x16x32_bf16 v[124:127], v[156:159], v[76:79], v[124:127]
    v_mfma_f32_16x16x32_bf16 v[124:127], v[160:163], v[80:83], v[124:127]
    v_mfma_f32_16x16x32_bf16 v[140:143], v[164:167], v[68:71], 0
    v_mfma_f32_16x16x32_bf16 v[140:143], v[168:171], v[72:75], v[140:143]
    v_mfma_f32_16x16x32_bf16 v[140:143], v[172:175], v[76:79], v[140:143]
    v_mfma_f32_16x16x32_bf16 v[140:143], v[176:179], v[80:83], v[140:143]
    v_mfma_f32_16x16x32_bf16 v[128:131], v[160:163], v[96:99], 0
    v_mfma_f32_16x16x32_bf16 v[128:131], v[156:159], v[92:95], v[128:131]
    v_mfma_f32_16x16x32_bf16 v[128:131], v[152:155], v[88:91], v[128:131]
    v_mfma_f32_16x16x32_bf16 v[128:131], v[148:151], v[84:87], v[128:131]
    v_mfma_f32_16x16x32_bf16 v[144:147], v[176:179], v[96:99], 0
    v_mfma_f32_16x16x32_bf16 v[144:147], v[172:175], v[92:95], v[144:147]
    v_mfma_f32_16x16x32_bf16 v[144:147], v[168:171], v[88:91], v[144:147]
    v_mfma_f32_16x16x32_bf16 v[144:147], v[164:167], v[84:87], v[144:147]
    s_waitcnt lgkmcnt(0)
    s_nop 7
    v_max3_f32 v224, v116, v117, v118
    v_max3_f32 v224, v224, v119, v132
    v_max3_f32 v224, v224, v133, v134
    v_max3_f32 v224, v224, v135, v212
    v_mov_b32 v225, v224
    s_nop 1
    v_permlane32_swap_b32 v224, v225
    v_max_f32 v224, v224, v225
    v_mov_b32 v225, v224
    s_nop 1
    v_permlane16_swap_b32 v224, v225
    v_max_f32 v224, v224, v225
    v_sub_f32 v220, v212, v224
    v_exp_f32 v220, v220
    v_mov_b32 v212, v224
    v_sub_f32 v116, v116, v224
    v_sub_f32 v117, v117, v224
    v_sub_f32 v118, v118, v224
    v_sub_f32 v119, v119, v224
    v_sub_f32 v132, v132, v224
    v_sub_f32 v133, v133, v224
    v_sub_f32 v134, v134, v224
    v_sub_f32 v135, v135, v224
    v_mul_f32 v216, v216, v220
    v_exp_f32 v116, v116
    v_exp_f32 v117, v117
    v_exp_f32 v118, v118
    v_exp_f32 v119, v119
    v_exp_f32 v132, v132
    v_exp_f32 v133, v133
    v_exp_f32 v134, v134
    v_exp_f32 v135, v135
    v_accvgpr_read_b32 v224, a0
    v_accvgpr_read_b32 v225, a1
    v_accvgpr_read_b32 v226, a2
    v_accvgpr_read_b32 v227, a3
    v_mul_f32 v224, v224, v220
    v_mul_f32 v225, v225, v220
    v_mul_f32 v226, v226, v220
    v_mul_f32 v227, v227, v220
    v_accvgpr_write_b32 a0, v224
    v_accvgpr_write_b32 a1, v225
    v_accvgpr_write_b32 a2, v226
    v_accvgpr_write_b32 a3, v227
    v_accvgpr_read_b32 v224, a16
    v_accvgpr_read_b32 v225, a17
    v_accvgpr_read_b32 v226, a18
    v_accvgpr_read_b32 v227, a19
    v_mul_f32 v224, v224, v220
    v_mul_f32 v225, v225, v220
    v_mul_f32 v226, v226, v220
    v_mul_f32 v227, v227, v220
    v_accvgpr_write_b32 a16, v224
    v_accvgpr_write_b32 a17, v225
    v_accvgpr_write_b32 a18, v226
    v_accvgpr_write_b32 a19, v227
    v_accvgpr_read_b32 v224, a32
    v_accvgpr_read_b32 v225, a33
    v_accvgpr_read_b32 v226, a34
    v_accvgpr_read_b32 v227, a35
    v_mul_f32 v224, v224, v220
    v_mul_f32 v225, v225, v220
    v_mul_f32 v226, v226, v220
    v_mul_f32 v227, v227, v220
    v_accvgpr_write_b32 a32, v224
    v_accvgpr_write_b32 a33, v225
    v_accvgpr_write_b32 a34, v226
    v_accvgpr_write_b32 a35, v227
    v_accvgpr_read_b32 v224, a48
    v_accvgpr_read_b32 v225, a49
    v_accvgpr_read_b32 v226, a50
    v_accvgpr_read_b32 v227, a51
    v_mul_f32 v224, v224, v220
    v_mul_f32 v225, v225, v220
    v_mul_f32 v226, v226, v220
    v_mul_f32 v227, v227, v220
    v_accvgpr_write_b32 a48, v224
    v_accvgpr_write_b32 a49, v225
    v_accvgpr_write_b32 a50, v226
    v_accvgpr_write_b32 a51, v227
    v_accvgpr_read_b32 v224, a64
    v_accvgpr_read_b32 v225, a65
    v_accvgpr_read_b32 v226, a66
    v_accvgpr_read_b32 v227, a67
    v_mul_f32 v224, v224, v220
    v_mul_f32 v225, v225, v220
    v_mul_f32 v226, v226, v220
    v_mul_f32 v227, v227, v220
    v_accvgpr_write_b32 a64, v224
    v_accvgpr_write_b32 a65, v225
    v_accvgpr_write_b32 a66, v226
    v_accvgpr_write_b32 a67, v227
    v_accvgpr_read_b32 v224, a80
    v_accvgpr_read_b32 v225, a81
    v_accvgpr_read_b32 v226, a82
    v_accvgpr_read_b32 v227, a83
    v_mul_f32 v224, v224, v220
    v_mul_f32 v225, v225, v220
    v_mul_f32 v226, v226, v220
    v_mul_f32 v227, v227, v220
    v_accvgpr_write_b32 a80, v224
    v_accvgpr_write_b32 a81, v225
    v_accvgpr_write_b32 a82, v226
    v_accvgpr_write_b32 a83, v227
    v_accvgpr_read_b32 v224, a96
    v_accvgpr_read_b32 v225, a97
    v_accvgpr_read_b32 v226, a98
    v_accvgpr_read_b32 v227, a99
    v_mul_f32 v224, v224, v220
    v_mul_f32 v225, v225, v220
    v_mul_f32 v226, v226, v220
    v_mul_f32 v227, v227, v220
    v_accvgpr_write_b32 a96, v224
    v_accvgpr_write_b32 a97, v225
    v_accvgpr_write_b32 a98, v226
    v_accvgpr_write_b32 a99, v227
    v_accvgpr_read_b32 v224, a112
    v_accvgpr_read_b32 v225, a113
    v_accvgpr_read_b32 v226, a114
    v_accvgpr_read_b32 v227, a115
    v_mul_f32 v224, v224, v220
    v_mul_f32 v225, v225, v220
    v_mul_f32 v226, v226, v220
    v_mul_f32 v227, v227, v220
    v_accvgpr_write_b32 a112, v224
    v_accvgpr_write_b32 a113, v225
    v_accvgpr_write_b32 a114, v226
    v_accvgpr_write_b32 a115, v227
    v_add_f32 v216, v216, v116
    v_add_f32 v216, v216, v117
    v_add_f32 v216, v216, v118
    v_add_f32 v216, v216, v119
    v_add_f32 v216, v216, v132
    v_add_f32 v216, v216, v133
    v_add_f32 v216, v216, v134
    v_add_f32 v216, v216, v135
    v_cvt_pk_bf16_f32 v180, v116, v117
    v_cvt_pk_bf16_f32 v181, v118, v119
    v_cvt_pk_bf16_f32 v182, v132, v133
    v_cvt_pk_bf16_f32 v183, v134, v135
    s_nop 1
    v_mfma_f32_16x16x32_bf16 a[0:3], v[196:199], v[180:183], a[0:3]
    v_mfma_f32_16x16x32_bf16 a[16:19], v[200:203], v[180:183], a[16:19]
    v_mfma_f32_16x16x32_bf16 a[32:35], v[204:207], v[180:183], a[32:35]
    v_mfma_f32_16x16x32_bf16 a[48:51], v[208:211], v[180:183], a[48:51]
    v_mfma_f32_16x16x32_bf16 a[64:67], v[228:231], v[180:183], a[64:67]
    v_mfma_f32_16x16x32_bf16 a[80:83], v[232:235], v[180:183], a[80:83]
    v_mfma_f32_16x16x32_bf16 a[96:99], v[236:239], v[180:183], a[96:99]
    v_mfma_f32_16x16x32_bf16 a[112:115], v[240:243], v[180:183], a[112:115]
    v_max3_f32 v224, v120, v121, v122
    v_max3_f32 v224, v224, v123, v136
    v_max3_f32 v224, v224, v137, v138
    v_max3_f32 v224, v224, v139, v213
    v_mov_b32 v225, v224
    s_nop 1
    v_permlane32_swap_b32 v224, v225
    v_max_f32 v224, v224, v225
    v_mov_b32 v225, v224
    s_nop 1
    v_permlane16_swap_b32 v224, v225
    v_max_f32 v224, v224, v225
    v_sub_f32 v220, v213, v224
    v_exp_f32 v220, v220
    v_mov_b32 v213, v224
    v_sub_f32 v120, v120, v224
    v_sub_f32 v121, v121, v224
    v_sub_f32 v122, v122, v224
    v_sub_f32 v123, v123, v224
    v_sub_f32 v136, v136, v224
    v_sub_f32 v137, v137, v224
    v_sub_f32 v138, v138, v224
    v_sub_f32 v139, v139, v224
    v_mul_f32 v217, v217, v220
    v_exp_f32 v120, v120
    v_exp_f32 v121, v121
    v_exp_f32 v122, v122
    v_exp_f32 v123, v123
    v_exp_f32 v136, v136
    v_exp_f32 v137, v137
    v_exp_f32 v138, v138
    v_exp_f32 v139, v139
    v_accvgpr_read_b32 v224, a4
    v_accvgpr_read_b32 v225, a5
    v_accvgpr_read_b32 v226, a6
    v_accvgpr_read_b32 v227, a7
    v_mul_f32 v224, v224, v220
    v_mul_f32 v225, v225, v220
    v_mul_f32 v226, v226, v220
    v_mul_f32 v227, v227, v220
    v_accvgpr_write_b32 a4, v224
    v_accvgpr_write_b32 a5, v225
    v_accvgpr_write_b32 a6, v226
    v_accvgpr_write_b32 a7, v227
    v_accvgpr_read_b32 v224, a20
    v_accvgpr_read_b32 v225, a21
    v_accvgpr_read_b32 v226, a22
    v_accvgpr_read_b32 v227, a23
    v_mul_f32 v224, v224, v220
    v_mul_f32 v225, v225, v220
    v_mul_f32 v226, v226, v220
    v_mul_f32 v227, v227, v220
    v_accvgpr_write_b32 a20, v224
    v_accvgpr_write_b32 a21, v225
    v_accvgpr_write_b32 a22, v226
    v_accvgpr_write_b32 a23, v227
    v_accvgpr_read_b32 v224, a36
    v_accvgpr_read_b32 v225, a37
    v_accvgpr_read_b32 v226, a38
    v_accvgpr_read_b32 v227, a39
    v_mul_f32 v224, v224, v220
    v_mul_f32 v225, v225, v220
    v_mul_f32 v226, v226, v220
    v_mul_f32 v227, v227, v220
    v_accvgpr_write_b32 a36, v224
    v_accvgpr_write_b32 a37, v225
    v_accvgpr_write_b32 a38, v226
    v_accvgpr_write_b32 a39, v227
    v_accvgpr_read_b32 v224, a52
    v_accvgpr_read_b32 v225, a53
    v_accvgpr_read_b32 v226, a54
    v_accvgpr_read_b32 v227, a55
    v_mul_f32 v224, v224, v220
    v_mul_f32 v225, v225, v220
    v_mul_f32 v226, v226, v220
    v_mul_f32 v227, v227, v220
    v_accvgpr_write_b32 a52, v224
    v_accvgpr_write_b32 a53, v225
    v_accvgpr_write_b32 a54, v226
    v_accvgpr_write_b32 a55, v227
    v_accvgpr_read_b32 v224, a68
    v_accvgpr_read_b32 v225, a69
    v_accvgpr_read_b32 v226, a70
    v_accvgpr_read_b32 v227, a71
    v_mul_f32 v224, v224, v220
    v_mul_f32 v225, v225, v220
    v_mul_f32 v226, v226, v220
    v_mul_f32 v227, v227, v220
    v_accvgpr_write_b32 a68, v224
    v_accvgpr_write_b32 a69, v225
    v_accvgpr_write_b32 a70, v226
    v_accvgpr_write_b32 a71, v227
    v_accvgpr_read_b32 v224, a84
    v_accvgpr_read_b32 v225, a85
    v_accvgpr_read_b32 v226, a86
    v_accvgpr_read_b32 v227, a87
    v_mul_f32 v224, v224, v220
    v_mul_f32 v225, v225, v220
    v_mul_f32 v226, v226, v220
    v_mul_f32 v227, v227, v220
    v_accvgpr_write_b32 a84, v224
    v_accvgpr_write_b32 a85, v225
    v_accvgpr_write_b32 a86, v226
    v_accvgpr_write_b32 a87, v227
    v_accvgpr_read_b32 v224, a100
    v_accvgpr_read_b32 v225, a101
    v_accvgpr_read_b32 v226, a102
    v_accvgpr_read_b32 v227, a103
    v_mul_f32 v224, v224, v220
    v_mul_f32 v225, v225, v220
    v_mul_f32 v226, v226, v220
    v_mul_f32 v227, v227, v220
    v_accvgpr_write_b32 a100, v224
    v_accvgpr_write_b32 a101, v225
    v_accvgpr_write_b32 a102, v226
    v_accvgpr_write_b32 a103, v227
    v_accvgpr_read_b32 v224, a116
    v_accvgpr_read_b32 v225, a117
    v_accvgpr_read_b32 v226, a118
    v_accvgpr_read_b32 v227, a119
    v_mul_f32 v224, v224, v220
    v_mul_f32 v225, v225, v220
    v_mul_f32 v226, v226, v220
    v_mul_f32 v227, v227, v220
    v_accvgpr_write_b32 a116, v224
    v_accvgpr_write_b32 a117, v225
    v_accvgpr_write_b32 a118, v226
    v_accvgpr_write_b32 a119, v227
    v_add_f32 v217, v217, v120
    v_add_f32 v217, v217, v121
    v_add_f32 v217, v217, v122
    v_add_f32 v217, v217, v123
    v_add_f32 v217, v217, v136
    v_add_f32 v217, v217, v137
    v_add_f32 v217, v217, v138
    v_add_f32 v217, v217, v139
    v_cvt_pk_bf16_f32 v184, v120, v121
    v_cvt_pk_bf16_f32 v185, v122, v123
    v_cvt_pk_bf16_f32 v186, v136, v137
    v_cvt_pk_bf16_f32 v187, v138, v139
    s_nop 1
    v_mfma_f32_16x16x32_bf16 a[4:7], v[196:199], v[184:187], a[4:7]
    v_mfma_f32_16x16x32_bf16 a[20:23], v[200:203], v[184:187], a[20:23]
    v_mfma_f32_16x16x32_bf16 a[36:39], v[204:207], v[184:187], a[36:39]
    v_mfma_f32_16x16x32_bf16 a[52:55], v[208:211], v[184:187], a[52:55]
    v_mfma_f32_16x16x32_bf16 a[68:71], v[228:231], v[184:187], a[68:71]
    v_mfma_f32_16x16x32_bf16 a[84:87], v[232:235], v[184:187], a[84:87]
    v_mfma_f32_16x16x32_bf16 a[100:103], v[236:239], v[184:187], a[100:103]
    v_mfma_f32_16x16x32_bf16 a[116:119], v[240:243], v[184:187], a[116:119]
    v_max3_f32 v224, v124, v125, v126
    v_max3_f32 v224, v224, v127, v140
    v_max3_f32 v224, v224, v141, v142
    v_max3_f32 v224, v224, v143, v214
    v_mov_b32 v225, v224
    s_nop 1
    v_permlane32_swap_b32 v224, v225
    v_max_f32 v224, v224, v225
    v_mov_b32 v225, v224
    s_nop 1
    v_permlane16_swap_b32 v224, v225
    v_max_f32 v224, v224, v225
    v_sub_f32 v220, v214, v224
    v_exp_f32 v220, v220
    v_mov_b32 v214, v224
    v_sub_f32 v124, v124, v224
    v_sub_f32 v125, v125, v224
    v_sub_f32 v126, v126, v224
    v_sub_f32 v127, v127, v224
    v_sub_f32 v140, v140, v224
    v_sub_f32 v141, v141, v224
    v_sub_f32 v142, v142, v224
    v_sub_f32 v143, v143, v224
    v_mul_f32 v218, v218, v220
    v_exp_f32 v124, v124
    v_exp_f32 v125, v125
    v_exp_f32 v126, v126
    v_exp_f32 v127, v127
    v_exp_f32 v140, v140
    v_exp_f32 v141, v141
    v_exp_f32 v142, v142
    v_exp_f32 v143, v143
    v_accvgpr_read_b32 v224, a8
    v_accvgpr_read_b32 v225, a9
    v_accvgpr_read_b32 v226, a10
    v_accvgpr_read_b32 v227, a11
    v_mul_f32 v224, v224, v220
    v_mul_f32 v225, v225, v220
    v_mul_f32 v226, v226, v220
    v_mul_f32 v227, v227, v220
    v_accvgpr_write_b32 a8, v224
    v_accvgpr_write_b32 a9, v225
    v_accvgpr_write_b32 a10, v226
    v_accvgpr_write_b32 a11, v227
    v_accvgpr_read_b32 v224, a24
    v_accvgpr_read_b32 v225, a25
    v_accvgpr_read_b32 v226, a26
    v_accvgpr_read_b32 v227, a27
    v_mul_f32 v224, v224, v220
    v_mul_f32 v225, v225, v220
    v_mul_f32 v226, v226, v220
    v_mul_f32 v227, v227, v220
    v_accvgpr_write_b32 a24, v224
    v_accvgpr_write_b32 a25, v225
    v_accvgpr_write_b32 a26, v226
    v_accvgpr_write_b32 a27, v227
    v_accvgpr_read_b32 v224, a40
    v_accvgpr_read_b32 v225, a41
    v_accvgpr_read_b32 v226, a42
    v_accvgpr_read_b32 v227, a43
    v_mul_f32 v224, v224, v220
    v_mul_f32 v225, v225, v220
    v_mul_f32 v226, v226, v220
    v_mul_f32 v227, v227, v220
    v_accvgpr_write_b32 a40, v224
    v_accvgpr_write_b32 a41, v225
    v_accvgpr_write_b32 a42, v226
    v_accvgpr_write_b32 a43, v227
    v_accvgpr_read_b32 v224, a56
    v_accvgpr_read_b32 v225, a57
    v_accvgpr_read_b32 v226, a58
    v_accvgpr_read_b32 v227, a59
    v_mul_f32 v224, v224, v220
    v_mul_f32 v225, v225, v220
    v_mul_f32 v226, v226, v220
    v_mul_f32 v227, v227, v220
    v_accvgpr_write_b32 a56, v224
    v_accvgpr_write_b32 a57, v225
    v_accvgpr_write_b32 a58, v226
    v_accvgpr_write_b32 a59, v227
    v_accvgpr_read_b32 v224, a72
    v_accvgpr_read_b32 v225, a73
    v_accvgpr_read_b32 v226, a74
    v_accvgpr_read_b32 v227, a75
    v_mul_f32 v224, v224, v220
    v_mul_f32 v225, v225, v220
    v_mul_f32 v226, v226, v220
    v_mul_f32 v227, v227, v220
    v_accvgpr_write_b32 a72, v224
    v_accvgpr_write_b32 a73, v225
    v_accvgpr_write_b32 a74, v226
    v_accvgpr_write_b32 a75, v227
    v_accvgpr_read_b32 v224, a88
    v_accvgpr_read_b32 v225, a89
    v_accvgpr_read_b32 v226, a90
    v_accvgpr_read_b32 v227, a91
    v_mul_f32 v224, v224, v220
    v_mul_f32 v225, v225, v220
    v_mul_f32 v226, v226, v220
    v_mul_f32 v227, v227, v220
    v_accvgpr_write_b32 a88, v224
    v_accvgpr_write_b32 a89, v225
    v_accvgpr_write_b32 a90, v226
    v_accvgpr_write_b32 a91, v227
    v_accvgpr_read_b32 v224, a104
    v_accvgpr_read_b32 v225, a105
    v_accvgpr_read_b32 v226, a106
    v_accvgpr_read_b32 v227, a107
    v_mul_f32 v224, v224, v220
    v_mul_f32 v225, v225, v220
    v_mul_f32 v226, v226, v220
    v_mul_f32 v227, v227, v220
    v_accvgpr_write_b32 a104, v224
    v_accvgpr_write_b32 a105, v225
    v_accvgpr_write_b32 a106, v226
    v_accvgpr_write_b32 a107, v227
    v_accvgpr_read_b32 v224, a120
    v_accvgpr_read_b32 v225, a121
    v_accvgpr_read_b32 v226, a122
    v_accvgpr_read_b32 v227, a123
    v_mul_f32 v224, v224, v220
    v_mul_f32 v225, v225, v220
    v_mul_f32 v226, v226, v220
    v_mul_f32 v227, v227, v220
    v_accvgpr_write_b32 a120, v224
    v_accvgpr_write_b32 a121, v225
    v_accvgpr_write_b32 a122, v226
    v_accvgpr_write_b32 a123, v227
    v_add_f32 v218, v218, v124
    v_add_f32 v218, v218, v125
    v_add_f32 v218, v218, v126
    v_add_f32 v218, v218, v127
    v_add_f32 v218, v218, v140
    v_add_f32 v218, v218, v141
    v_add_f32 v218, v218, v142
    v_add_f32 v218, v218, v143
    v_cvt_pk_bf16_f32 v188, v124, v125
    v_cvt_pk_bf16_f32 v189, v126, v127
    v_cvt_pk_bf16_f32 v190, v140, v141
    v_cvt_pk_bf16_f32 v191, v142, v143
    s_nop 1
    v_mfma_f32_16x16x32_bf16 a[8:11], v[196:199], v[188:191], a[8:11]
    v_mfma_f32_16x16x32_bf16 a[24:27], v[200:203], v[188:191], a[24:27]
    v_mfma_f32_16x16x32_bf16 a[40:43], v[204:207], v[188:191], a[40:43]
    v_mfma_f32_16x16x32_bf16 a[56:59], v[208:211], v[188:191], a[56:59]
    v_mfma_f32_16x16x32_bf16 a[72:75], v[228:231], v[188:191], a[72:75]
    v_mfma_f32_16x16x32_bf16 a[88:91], v[232:235], v[188:191], a[88:91]
    v_mfma_f32_16x16x32_bf16 a[104:107], v[236:239], v[188:191], a[104:107]
    v_mfma_f32_16x16x32_bf16 a[120:123], v[240:243], v[188:191], a[120:123]
    v_max3_f32 v224, v128, v129, v130
    v_max3_f32 v224, v224, v131, v144
    v_max3_f32 v224, v224, v145, v146
    v_max3_f32 v224, v224, v147, v215
    v_mov_b32 v225, v224
    s_nop 1
    v_permlane32_swap_b32 v224, v225
    v_max_f32 v224, v224, v225
    v_mov_b32 v225, v224
    s_nop 1
    v_permlane16_swap_b32 v224, v225
    v_max_f32 v224, v224, v225
    v_sub_f32 v220, v215, v224
    v_exp_f32 v220, v220
    v_mov_b32 v215, v224
    v_sub_f32 v128, v128, v224
    v_sub_f32 v129, v129, v224
    v_sub_f32 v130, v130, v224
    v_sub_f32 v131, v131, v224
    v_sub_f32 v144, v144, v224
    v_sub_f32 v145, v145, v224
    v_sub_f32 v146, v146, v224
    v_sub_f32 v147, v147, v224
    v_mul_f32 v219, v219, v220
    v_exp_f32 v128, v128
    v_exp_f32 v129, v129
    v_exp_f32 v130, v130
    v_exp_f32 v131, v131
    v_exp_f32 v144, v144
    v_exp_f32 v145, v145
    v_exp_f32 v146, v146
    v_exp_f32 v147, v147
    v_accvgpr_read_b32 v224, a12
    v_accvgpr_read_b32 v225, a13
    v_accvgpr_read_b32 v226, a14
    v_accvgpr_read_b32 v227, a15
    v_mul_f32 v224, v224, v220
    v_mul_f32 v225, v225, v220
    v_mul_f32 v226, v226, v220
    v_mul_f32 v227, v227, v220
    v_accvgpr_write_b32 a12, v224
    v_accvgpr_write_b32 a13, v225
    v_accvgpr_write_b32 a14, v226
    v_accvgpr_write_b32 a15, v227
    v_accvgpr_read_b32 v224, a28
    v_accvgpr_read_b32 v225, a29
    v_accvgpr_read_b32 v226, a30
    v_accvgpr_read_b32 v227, a31
    v_mul_f32 v224, v224, v220
    v_mul_f32 v225, v225, v220
    v_mul_f32 v226, v226, v220
    v_mul_f32 v227, v227, v220
    v_accvgpr_write_b32 a28, v224
    v_accvgpr_write_b32 a29, v225
    v_accvgpr_write_b32 a30, v226
    v_accvgpr_write_b32 a31, v227
    v_accvgpr_read_b32 v224, a44
    v_accvgpr_read_b32 v225, a45
    v_accvgpr_read_b32 v226, a46
    v_accvgpr_read_b32 v227, a47
    v_mul_f32 v224, v224, v220
    v_mul_f32 v225, v225, v220
    v_mul_f32 v226, v226, v220
    v_mul_f32 v227, v227, v220
    v_accvgpr_write_b32 a44, v224
    v_accvgpr_write_b32 a45, v225
    v_accvgpr_write_b32 a46, v226
    v_accvgpr_write_b32 a47, v227
    v_accvgpr_read_b32 v224, a60
    v_accvgpr_read_b32 v225, a61
    v_accvgpr_read_b32 v226, a62
    v_accvgpr_read_b32 v227, a63
    v_mul_f32 v224, v224, v220
    v_mul_f32 v225, v225, v220
    v_mul_f32 v226, v226, v220
    v_mul_f32 v227, v227, v220
    v_accvgpr_write_b32 a60, v224
    v_accvgpr_write_b32 a61, v225
    v_accvgpr_write_b32 a62, v226
    v_accvgpr_write_b32 a63, v227
    v_accvgpr_read_b32 v224, a76
    v_accvgpr_read_b32 v225, a77
    v_accvgpr_read_b32 v226, a78
    v_accvgpr_read_b32 v227, a79
    v_mul_f32 v224, v224, v220
    v_mul_f32 v225, v225, v220
    v_mul_f32 v226, v226, v220
    v_mul_f32 v227, v227, v220
    v_accvgpr_write_b32 a76, v224
    v_accvgpr_write_b32 a77, v225
    v_accvgpr_write_b32 a78, v226
    v_accvgpr_write_b32 a79, v227
    v_accvgpr_read_b32 v224, a92
    v_accvgpr_read_b32 v225, a93
    v_accvgpr_read_b32 v226, a94
    v_accvgpr_read_b32 v227, a95
    v_mul_f32 v224, v224, v220
    v_mul_f32 v225, v225, v220
    v_mul_f32 v226, v226, v220
    v_mul_f32 v227, v227, v220
    v_accvgpr_write_b32 a92, v224
    v_accvgpr_write_b32 a93, v225
    v_accvgpr_write_b32 a94, v226
    v_accvgpr_write_b32 a95, v227
    v_accvgpr_read_b32 v224, a108
    v_accvgpr_read_b32 v225, a109
    v_accvgpr_read_b32 v226, a110
    v_accvgpr_read_b32 v227, a111
    v_mul_f32 v224, v224, v220
    v_mul_f32 v225, v225, v220
    v_mul_f32 v226, v226, v220
    v_mul_f32 v227, v227, v220
    v_accvgpr_write_b32 a108, v224
    v_accvgpr_write_b32 a109, v225
    v_accvgpr_write_b32 a110, v226
    v_accvgpr_write_b32 a111, v227
    v_accvgpr_read_b32 v224, a124
    v_accvgpr_read_b32 v225, a125
    v_accvgpr_read_b32 v226, a126
    v_accvgpr_read_b32 v227, a127
    v_mul_f32 v224, v224, v220
    v_mul_f32 v225, v225, v220
    v_mul_f32 v226, v226, v220
    v_mul_f32 v227, v227, v220
    v_accvgpr_write_b32 a124, v224
    v_accvgpr_write_b32 a125, v225
    v_accvgpr_write_b32 a126, v226
    v_accvgpr_write_b32 a127, v227
    v_add_f32 v219, v219, v128
    v_add_f32 v219, v219, v129
    v_add_f32 v219, v219, v130
    v_add_f32 v219, v219, v131
    v_add_f32 v219, v219, v144
    v_add_f32 v219, v219, v145
    v_add_f32 v219, v219, v146
    v_add_f32 v219, v219, v147
    v_cvt_pk_bf16_f32 v192, v128, v129
    v_cvt_pk_bf16_f32 v193, v130, v131
    v_cvt_pk_bf16_f32 v194, v144, v145
    v_cvt_pk_bf16_f32 v195, v146, v147
    s_nop 1
    v_mfma_f32_16x16x32_bf16 a[12:15], v[196:199], v[192:195], a[12:15]
    v_mfma_f32_16x16x32_bf16 a[28:31], v[200:203], v[192:195], a[28:31]
    v_mfma_f32_16x16x32_bf16 a[44:47], v[204:207], v[192:195], a[44:47]
    v_mfma_f32_16x16x32_bf16 a[60:63], v[208:211], v[192:195], a[60:63]
    v_mfma_f32_16x16x32_bf16 a[76:79], v[228:231], v[192:195], a[76:79]
    v_mfma_f32_16x16x32_bf16 a[92:95], v[232:235], v[192:195], a[92:95]
    v_mfma_f32_16x16x32_bf16 a[108:111], v[236:239], v[192:195], a[108:111]
    v_mfma_f32_16x16x32_bf16 a[124:127], v[240:243], v[192:195], a[124:127]
    s_add_u32 s28, s28, 8192
    s_cmp_lt_u32 s28, 524288
    s_cbranch_scc1 L_slow_loop
    v_mov_b32 v224, v216
    s_nop 1
    v_permlane32_swap_b32 v216, v224
    v_add_f32 v216, v216, v224
    v_mov_b32 v224, v216
    s_nop 1
    v_permlane16_swap_b32 v216, v224
    v_add_f32 v216, v216, v224
    v_rcp_f32 v100, v216
    v_mov_b32 v224, v217
    s_nop 1
    v_permlane32_swap_b32 v217, v224
    v_add_f32 v217, v217, v224
    v_mov_b32 v224, v217
    s_nop 1
    v_permlane16_swap_b32 v217, v224
    v_add_f32 v217, v217, v224
    v_rcp_f32 v101, v217
    v_mov_b32 v224, v218
    s_nop 1
    v_permlane32_swap_b32 v218, v224
    v_add_f32 v218, v218, v224
    v_mov_b32 v224, v218
    s_nop 1
    v_permlane16_swap_b32 v218, v224
    v_add_f32 v218, v218, v224
    v_rcp_f32 v102, v218
    v_mov_b32 v224, v219
    s_nop 1
    v_permlane32_swap_b32 v219, v224
    v_add_f32 v219, v219, v224
    v_mov_b32 v224, v219
    s_nop 1
    v_permlane16_swap_b32 v219, v224
    v_add_f32 v219, v219, v224
    v_rcp_f32 v103, v219
    s_mov_b32 s36, 0
    v_accvgpr_read_b32 v120, a0
    v_accvgpr_read_b32 v121, a1
    v_accvgpr_read_b32 v122, a2
    v_accvgpr_read_b32 v123, a3
    v_accvgpr_read_b32 v124, a16
    v_accvgpr_read_b32 v125, a17
    v_accvgpr_read_b32 v126, a18
    v_accvgpr_read_b32 v127, a19
    v_mul_f32 v120, v120, v100
    v_mul_f32 v121, v121, v100
    v_mul_f32 v122, v122, v100
    v_mul_f32 v123, v123, v100
    v_mul_f32 v124, v124, v100
    v_mul_f32 v125, v125, v100
    v_mul_f32 v126, v126, v100
    v_mul_f32 v127, v127, v100
    v_cvt_pk_bf16_f32 v152, v120, v121
    v_cvt_pk_bf16_f32 v153, v122, v123
    v_cvt_pk_bf16_f32 v154, v124, v125
    v_cvt_pk_bf16_f32 v155, v126, v127
    buffer_store_dwordx4 v[152:155], v110, s[24:27], s36 offen offset:0 sc1
    v_accvgpr_read_b32 v128, a4
    v_accvgpr_read_b32 v129, a5
    v_accvgpr_read_b32 v130, a6
    v_accvgpr_read_b32 v131, a7
    v_accvgpr_read_b32 v132, a20
    v_accvgpr_read_b32 v133, a21
    v_accvgpr_read_b32 v134, a22
    v_accvgpr_read_b32 v135, a23
    v_mul_f32 v128, v128, v101
    v_mul_f32 v129, v129, v101
    v_mul_f32 v130, v130, v101
    v_mul_f32 v131, v131, v101
    v_mul_f32 v132, v132, v101
    v_mul_f32 v133, v133, v101
    v_mul_f32 v134, v134, v101
    v_mul_f32 v135, v135, v101
    v_cvt_pk_bf16_f32 v156, v128, v129
    v_cvt_pk_bf16_f32 v157, v130, v131
    v_cvt_pk_bf16_f32 v158, v132, v133
    v_cvt_pk_bf16_f32 v159, v134, v135
    buffer_store_dwordx4 v[156:159], v110, s[24:27], s36 offen offset:1024 sc1
    v_accvgpr_read_b32 v136, a8
    v_accvgpr_read_b32 v137, a9
    v_accvgpr_read_b32 v138, a10
    v_accvgpr_read_b32 v139, a11
    v_accvgpr_read_b32 v140, a24
    v_accvgpr_read_b32 v141, a25
    v_accvgpr_read_b32 v142, a26
    v_accvgpr_read_b32 v143, a27
    v_mul_f32 v136, v136, v102
    v_mul_f32 v137, v137, v102
    v_mul_f32 v138, v138, v102
    v_mul_f32 v139, v139, v102
    v_mul_f32 v140, v140, v102
    v_mul_f32 v141, v141, v102
    v_mul_f32 v142, v142, v102
    v_mul_f32 v143, v143, v102
    v_cvt_pk_bf16_f32 v160, v136, v137
    v_cvt_pk_bf16_f32 v161, v138, v139
    v_cvt_pk_bf16_f32 v162, v140, v141
    v_cvt_pk_bf16_f32 v163, v142, v143
    buffer_store_dwordx4 v[160:163], v110, s[24:27], s36 offen offset:2048 sc1
    v_accvgpr_read_b32 v144, a12
    v_accvgpr_read_b32 v145, a13
    v_accvgpr_read_b32 v146, a14
    v_accvgpr_read_b32 v147, a15
    v_accvgpr_read_b32 v148, a28
    v_accvgpr_read_b32 v149, a29
    v_accvgpr_read_b32 v150, a30
    v_accvgpr_read_b32 v151, a31
    v_mul_f32 v144, v144, v103
    v_mul_f32 v145, v145, v103
    v_mul_f32 v146, v146, v103
    v_mul_f32 v147, v147, v103
    v_mul_f32 v148, v148, v103
    v_mul_f32 v149, v149, v103
    v_mul_f32 v150, v150, v103
    v_mul_f32 v151, v151, v103
    v_cvt_pk_bf16_f32 v164, v144, v145
    v_cvt_pk_bf16_f32 v165, v146, v147
    v_cvt_pk_bf16_f32 v166, v148, v149
    v_cvt_pk_bf16_f32 v167, v150, v151
    buffer_store_dwordx4 v[164:167], v110, s[24:27], s36 offen offset:3072 sc1
    s_mov_b32 s36, 4096
    v_accvgpr_read_b32 v120, a32
    v_accvgpr_read_b32 v121, a33
    v_accvgpr_read_b32 v122, a34
    v_accvgpr_read_b32 v123, a35
    v_accvgpr_read_b32 v124, a48
    v_accvgpr_read_b32 v125, a49
    v_accvgpr_read_b32 v126, a50
    v_accvgpr_read_b32 v127, a51
    v_mul_f32 v120, v120, v100
    v_mul_f32 v121, v121, v100
    v_mul_f32 v122, v122, v100
    v_mul_f32 v123, v123, v100
    v_mul_f32 v124, v124, v100
    v_mul_f32 v125, v125, v100
    v_mul_f32 v126, v126, v100
    v_mul_f32 v127, v127, v100
    v_cvt_pk_bf16_f32 v152, v120, v121
    v_cvt_pk_bf16_f32 v153, v122, v123
    v_cvt_pk_bf16_f32 v154, v124, v125
    v_cvt_pk_bf16_f32 v155, v126, v127
    buffer_store_dwordx4 v[152:155], v110, s[24:27], s36 offen offset:0 sc1
    v_accvgpr_read_b32 v128, a36
    v_accvgpr_read_b32 v129, a37
    v_accvgpr_read_b32 v130, a38
    v_accvgpr_read_b32 v131, a39
    v_accvgpr_read_b32 v132, a52
    v_accvgpr_read_b32 v133, a53
    v_accvgpr_read_b32 v134, a54
    v_accvgpr_read_b32 v135, a55
    v_mul_f32 v128, v128, v101
    v_mul_f32 v129, v129, v101
    v_mul_f32 v130, v130, v101
    v_mul_f32 v131, v131, v101
    v_mul_f32 v132, v132, v101
    v_mul_f32 v133, v133, v101
    v_mul_f32 v134, v134, v101
    v_mul_f32 v135, v135, v101
    v_cvt_pk_bf16_f32 v156, v128, v129
    v_cvt_pk_bf16_f32 v157, v130, v131
    v_cvt_pk_bf16_f32 v158, v132, v133
    v_cvt_pk_bf16_f32 v159, v134, v135
    buffer_store_dwordx4 v[156:159], v110, s[24:27], s36 offen offset:1024 sc1
    v_accvgpr_read_b32 v136, a40
    v_accvgpr_read_b32 v137, a41
    v_accvgpr_read_b32 v138, a42
    v_accvgpr_read_b32 v139, a43
    v_accvgpr_read_b32 v140, a56
    v_accvgpr_read_b32 v141, a57
    v_accvgpr_read_b32 v142, a58
    v_accvgpr_read_b32 v143, a59
    v_mul_f32 v136, v136, v102
    v_mul_f32 v137, v137, v102
    v_mul_f32 v138, v138, v102
    v_mul_f32 v139, v139, v102
    v_mul_f32 v140, v140, v102
    v_mul_f32 v141, v141, v102
    v_mul_f32 v142, v142, v102
    v_mul_f32 v143, v143, v102
    v_cvt_pk_bf16_f32 v160, v136, v137
    v_cvt_pk_bf16_f32 v161, v138, v139
    v_cvt_pk_bf16_f32 v162, v140, v141
    v_cvt_pk_bf16_f32 v163, v142, v143
    buffer_store_dwordx4 v[160:163], v110, s[24:27], s36 offen offset:2048 sc1
    v_accvgpr_read_b32 v144, a44
    v_accvgpr_read_b32 v145, a45
    v_accvgpr_read_b32 v146, a46
    v_accvgpr_read_b32 v147, a47
    v_accvgpr_read_b32 v148, a60
    v_accvgpr_read_b32 v149, a61
    v_accvgpr_read_b32 v150, a62
    v_accvgpr_read_b32 v151, a63
    v_mul_f32 v144, v144, v103
    v_mul_f32 v145, v145, v103
    v_mul_f32 v146, v146, v103
    v_mul_f32 v147, v147, v103
    v_mul_f32 v148, v148, v103
    v_mul_f32 v149, v149, v103
    v_mul_f32 v150, v150, v103
    v_mul_f32 v151, v151, v103
    v_cvt_pk_bf16_f32 v164, v144, v145
    v_cvt_pk_bf16_f32 v165, v146, v147
    v_cvt_pk_bf16_f32 v166, v148, v149
    v_cvt_pk_bf16_f32 v167, v150, v151
    buffer_store_dwordx4 v[164:167], v110, s[24:27], s36 offen offset:3072 sc1
    s_mov_b32 s36, 8192
    v_accvgpr_read_b32 v120, a64
    v_accvgpr_read_b32 v121, a65
    v_accvgpr_read_b32 v122, a66
    v_accvgpr_read_b32 v123, a67
    v_accvgpr_read_b32 v124, a80
    v_accvgpr_read_b32 v125, a81
    v_accvgpr_read_b32 v126, a82
    v_accvgpr_read_b32 v127, a83
    v_mul_f32 v120, v120, v100
    v_mul_f32 v121, v121, v100
    v_mul_f32 v122, v122, v100
    v_mul_f32 v123, v123, v100
    v_mul_f32 v124, v124, v100
    v_mul_f32 v125, v125, v100
    v_mul_f32 v126, v126, v100
    v_mul_f32 v127, v127, v100
    v_cvt_pk_bf16_f32 v152, v120, v121
    v_cvt_pk_bf16_f32 v153, v122, v123
    v_cvt_pk_bf16_f32 v154, v124, v125
    v_cvt_pk_bf16_f32 v155, v126, v127
    buffer_store_dwordx4 v[152:155], v110, s[24:27], s36 offen offset:0 sc1
    v_accvgpr_read_b32 v128, a68
    v_accvgpr_read_b32 v129, a69
    v_accvgpr_read_b32 v130, a70
    v_accvgpr_read_b32 v131, a71
    v_accvgpr_read_b32 v132, a84
    v_accvgpr_read_b32 v133, a85
    v_accvgpr_read_b32 v134, a86
    v_accvgpr_read_b32 v135, a87
    v_mul_f32 v128, v128, v101
    v_mul_f32 v129, v129, v101
    v_mul_f32 v130, v130, v101
    v_mul_f32 v131, v131, v101
    v_mul_f32 v132, v132, v101
    v_mul_f32 v133, v133, v101
    v_mul_f32 v134, v134, v101
    v_mul_f32 v135, v135, v101
    v_cvt_pk_bf16_f32 v156, v128, v129
    v_cvt_pk_bf16_f32 v157, v130, v131
    v_cvt_pk_bf16_f32 v158, v132, v133
    v_cvt_pk_bf16_f32 v159, v134, v135
    buffer_store_dwordx4 v[156:159], v110, s[24:27], s36 offen offset:1024 sc1
    v_accvgpr_read_b32 v136, a72
    v_accvgpr_read_b32 v137, a73
    v_accvgpr_read_b32 v138, a74
    v_accvgpr_read_b32 v139, a75
    v_accvgpr_read_b32 v140, a88
    v_accvgpr_read_b32 v141, a89
    v_accvgpr_read_b32 v142, a90
    v_accvgpr_read_b32 v143, a91
    v_mul_f32 v136, v136, v102
    v_mul_f32 v137, v137, v102
    v_mul_f32 v138, v138, v102
    v_mul_f32 v139, v139, v102
    v_mul_f32 v140, v140, v102
    v_mul_f32 v141, v141, v102
    v_mul_f32 v142, v142, v102
    v_mul_f32 v143, v143, v102
    v_cvt_pk_bf16_f32 v160, v136, v137
    v_cvt_pk_bf16_f32 v161, v138, v139
    v_cvt_pk_bf16_f32 v162, v140, v141
    v_cvt_pk_bf16_f32 v163, v142, v143
    buffer_store_dwordx4 v[160:163], v110, s[24:27], s36 offen offset:2048 sc1
    v_accvgpr_read_b32 v144, a76
    v_accvgpr_read_b32 v145, a77
    v_accvgpr_read_b32 v146, a78
    v_accvgpr_read_b32 v147, a79
    v_accvgpr_read_b32 v148, a92
    v_accvgpr_read_b32 v149, a93
    v_accvgpr_read_b32 v150, a94
    v_accvgpr_read_b32 v151, a95
    v_mul_f32 v144, v144, v103
    v_mul_f32 v145, v145, v103
    v_mul_f32 v146, v146, v103
    v_mul_f32 v147, v147, v103
    v_mul_f32 v148, v148, v103
    v_mul_f32 v149, v149, v103
    v_mul_f32 v150, v150, v103
    v_mul_f32 v151, v151, v103
    v_cvt_pk_bf16_f32 v164, v144, v145
    v_cvt_pk_bf16_f32 v165, v146, v147
    v_cvt_pk_bf16_f32 v166, v148, v149
    v_cvt_pk_bf16_f32 v167, v150, v151
    buffer_store_dwordx4 v[164:167], v110, s[24:27], s36 offen offset:3072 sc1
    s_mov_b32 s36, 12288
    v_accvgpr_read_b32 v120, a96
    v_accvgpr_read_b32 v121, a97
    v_accvgpr_read_b32 v122, a98
    v_accvgpr_read_b32 v123, a99
    v_accvgpr_read_b32 v124, a112
    v_accvgpr_read_b32 v125, a113
    v_accvgpr_read_b32 v126, a114
    v_accvgpr_read_b32 v127, a115
    v_mul_f32 v120, v120, v100
    v_mul_f32 v121, v121, v100
    v_mul_f32 v122, v122, v100
    v_mul_f32 v123, v123, v100
    v_mul_f32 v124, v124, v100
    v_mul_f32 v125, v125, v100
    v_mul_f32 v126, v126, v100
    v_mul_f32 v127, v127, v100
    v_cvt_pk_bf16_f32 v152, v120, v121
    v_cvt_pk_bf16_f32 v153, v122, v123
    v_cvt_pk_bf16_f32 v154, v124, v125
    v_cvt_pk_bf16_f32 v155, v126, v127
    buffer_store_dwordx4 v[152:155], v110, s[24:27], s36 offen offset:0 sc1
    v_accvgpr_read_b32 v128, a100
    v_accvgpr_read_b32 v129, a101
    v_accvgpr_read_b32 v130, a102
    v_accvgpr_read_b32 v131, a103
    v_accvgpr_read_b32 v132, a116
    v_accvgpr_read_b32 v133, a117
    v_accvgpr_read_b32 v134, a118
    v_accvgpr_read_b32 v135, a119
    v_mul_f32 v128, v128, v101
    v_mul_f32 v129, v129, v101
    v_mul_f32 v130, v130, v101
    v_mul_f32 v131, v131, v101
    v_mul_f32 v132, v132, v101
    v_mul_f32 v133, v133, v101
    v_mul_f32 v134, v134, v101
    v_mul_f32 v135, v135, v101
    v_cvt_pk_bf16_f32 v156, v128, v129
    v_cvt_pk_bf16_f32 v157, v130, v131
    v_cvt_pk_bf16_f32 v158, v132, v133
    v_cvt_pk_bf16_f32 v159, v134, v135
    buffer_store_dwordx4 v[156:159], v110, s[24:27], s36 offen offset:1024 sc1
    v_accvgpr_read_b32 v136, a104
    v_accvgpr_read_b32 v137, a105
    v_accvgpr_read_b32 v138, a106
    v_accvgpr_read_b32 v139, a107
    v_accvgpr_read_b32 v140, a120
    v_accvgpr_read_b32 v141, a121
    v_accvgpr_read_b32 v142, a122
    v_accvgpr_read_b32 v143, a123
    v_mul_f32 v136, v136, v102
    v_mul_f32 v137, v137, v102
    v_mul_f32 v138, v138, v102
    v_mul_f32 v139, v139, v102
    v_mul_f32 v140, v140, v102
    v_mul_f32 v141, v141, v102
    v_mul_f32 v142, v142, v102
    v_mul_f32 v143, v143, v102
    v_cvt_pk_bf16_f32 v160, v136, v137
    v_cvt_pk_bf16_f32 v161, v138, v139
    v_cvt_pk_bf16_f32 v162, v140, v141
    v_cvt_pk_bf16_f32 v163, v142, v143
    buffer_store_dwordx4 v[160:163], v110, s[24:27], s36 offen offset:2048 sc1
    v_accvgpr_read_b32 v144, a108
    v_accvgpr_read_b32 v145, a109
    v_accvgpr_read_b32 v146, a110
    v_accvgpr_read_b32 v147, a111
    v_accvgpr_read_b32 v148, a124
    v_accvgpr_read_b32 v149, a125
    v_accvgpr_read_b32 v150, a126
    v_accvgpr_read_b32 v151, a127
    v_mul_f32 v144, v144, v103
    v_mul_f32 v145, v145, v103
    v_mul_f32 v146, v146, v103
    v_mul_f32 v147, v147, v103
    v_mul_f32 v148, v148, v103
    v_mul_f32 v149, v149, v103
    v_mul_f32 v150, v150, v103
    v_mul_f32 v151, v151, v103
    v_cvt_pk_bf16_f32 v164, v144, v145
    v_cvt_pk_bf16_f32 v165, v146, v147
    v_cvt_pk_bf16_f32 v166, v148, v149
    v_cvt_pk_bf16_f32 v167, v150, v151
    buffer_store_dwordx4 v[164:167], v110, s[24:27], s36 offen offset:3072 sc1
    s_mov_b32 s45, 61440
    buffer_load_dwordx4 a[0:3], v114, s[20:23], s45 offen offset:1024 sc1
    s_mov_b32 s45, 61440
    buffer_load_dwordx4 a[4:7], v114, s[20:23], s45 offen offset:2048 sc1
    s_mov_b32 s45, 61440
    buffer_load_dwordx4 a[8:11], v114, s[20:23], s45 offen offset:3072 sc1
    s_mov_b32 s45, 61440
    buffer_load_dwordx4 a[12:15], v115, s[20:23], s45 offen offset:0 sc1
    s_mov_b32 s45, 81920
    buffer_load_dwordx4 a[16:19], v114, s[20:23], s45 offen offset:0 sc1
    s_mov_b32 s45, 81920
    buffer_load_dwordx4 a[20:23], v114, s[20:23], s45 offen offset:1024 sc1
    s_mov_b32 s45, 81920
    buffer_load_dwordx4 a[24:27], v114, s[20:23], s45 offen offset:2048 sc1
    s_mov_b32 s45, 81920
    buffer_load_dwordx4 a[28:31], v114, s[20:23], s45 offen offset:3072 sc1
    s_mov_b32 s45, 81920
    buffer_load_dwordx4 a[32:35], v115, s[20:23], s45 offen offset:0 sc1
    s_mov_b32 s45, 102400
    buffer_load_dwordx4 a[36:39], v114, s[20:23], s45 offen offset:0 sc1
    s_mov_b32 s45, 102400
    buffer_load_dwordx4 a[40:43], v114, s[20:23], s45 offen offset:1024 sc1
    s_mov_b32 s45, 102400
    buffer_load_dwordx4 a[44:47], v114, s[20:23], s45 offen offset:2048 sc1
    s_mov_b32 s45, 102400
    buffer_load_dwordx4 a[48:51], v114, s[20:23], s45 offen offset:3072 sc1
    s_mov_b32 s45, 102400
    buffer_load_dwordx4 a[52:55], v115, s[20:23], s45 offen offset:0 sc1
    s_mov_b32 s45, 122880
    buffer_load_dwordx4 a[56:59], v114, s[20:23], s45 offen offset:0 sc1
    s_mov_b32 s45, 122880
    buffer_load_dwordx4 a[60:63], v114, s[20:23], s45 offen offset:1024 sc1
    s_mov_b32 s45, 122880
    buffer_load_dwordx4 a[64:67], v114, s[20:23], s45 offen offset:2048 sc1
    s_mov_b32 s45, 122880
    buffer_load_dwordx4 a[68:71], v114, s[20:23], s45 offen offset:3072 sc1
    s_mov_b32 s45, 122880
    buffer_load_dwordx4 a[72:75], v115, s[20:23], s45 offen offset:0 sc1
    s_mov_b32 s45, 143360
    buffer_load_dwordx4 a[76:79], v114, s[20:23], s45 offen offset:0 sc1
    s_mov_b32 s45, 143360
    buffer_load_dwordx4 a[80:83], v114, s[20:23], s45 offen offset:1024 sc1
    s_mov_b32 s45, 143360
    buffer_load_dwordx4 a[84:87], v114, s[20:23], s45 offen offset:2048 sc1
    s_mov_b32 s45, 143360
    buffer_load_dwordx4 a[88:91], v114, s[20:23], s45 offen offset:3072 sc1
    s_mov_b32 s45, 143360
    buffer_load_dwordx4 a[92:95], v115, s[20:23], s45 offen offset:0 sc1
    s_waitcnt vmcnt(0)
    s_branch L_published
L_spin_rows:
    s_mov_b32 s7, 32768
L_retry_rows:
    s_sleep 2
    buffer_load_dword v252, off, s[92:95], s74 sc1
    s_waitcnt vmcnt(0)
    v_cmp_gt_u32 vcc, 32, v252
    s_and_b64 vcc, vcc, exec
    s_cbranch_scc0 L_back_rows
    s_sub_u32 s7, s7, 1
    s_cbranch_scc0 L_retry_rows
    s_branch L_back_rows
L_spin_all:
    s_mov_b32 s7, 32768
L_retry_all:
    s_sleep 2
    buffer_load_dword v252, v253, s[92:95], 0 offen sc1
    s_waitcnt vmcnt(0)
    v_cmp_gt_u32 vcc, 32, v252
    s_and_b64 vcc, vcc, exec
    s_cbranch_scc0 L_back_all
    s_sub_u32 s7, s7, 1
    s_cbranch_scc0 L_retry_all
    s_branch L_back_all
L_rt_keys:
    s_lshl_b32 s40, s5, 13
    s_add_u32 s40, s40, 0x280008
    v_lshlrev_b32 v253, 4, v19
    buffer_load_dword v28, v253, s[76:79], s40 offen offset:0 sc1
    buffer_load_dword v29, v253, s[76:79], s40 offen offset:1024 sc1
    buffer_load_dword v30, v253, s[76:79], s40 offen offset:2048 sc1
    buffer_load_dword v31, v253, s[76:79], s40 offen offset:3072 sc1
    s_add_u32 s40, s40, 4096
    buffer_load_dword v32, v253, s[76:79], s40 offen offset:0 sc1
    buffer_load_dword v33, v253, s[76:79], s40 offen offset:1024 sc1
    buffer_load_dword v34, v253, s[76:79], s40 offen offset:2048 sc1
    buffer_load_dword v35, v253, s[76:79], s40 offen offset:3072 sc1
    s_branch L_rt_back_keys
L_rt_local:
    s_waitcnt vmcnt(11)
    s_mov_b32 s42, -1
    v_sub_u32 v20, s42, v28
    v_sub_u32 v21, s42, v29
    v_sub_u32 v22, s42, v30
    v_min3_u32 v20, v20, v21, v22
    v_sub_u32 v21, s42, v31
    v_sub_u32 v22, s42, v32
    v_min3_u32 v20, v20, v21, v22
    v_sub_u32 v21, s42, v33
    v_sub_u32 v22, s42, v34
    v_min3_u32 v20, v20, v21, v22
    v_sub_u32 v21, s42, v35
    v_min_u32 v20, v20, v21
    s_nop 1
    v_min_u32_dpp v20, v20, v20 row_shr:1 row_mask:0xf bank_mask:0xf
    s_nop 1
    v_min_u32_dpp v20, v20, v20 row_shr:2 row_mask:0xf bank_mask:0xf
    s_nop 1
    v_min_u32_dpp v20, v20, v20 row_shr:4 row_mask:0xf bank_mask:0xf
    s_nop 1
    v_min_u32_dpp v20, v20, v20 row_shr:8 row_mask:0xf bank_mask:0xf
    s_nop 1
    v_min_u32_dpp v20, v20, v20 row_bcast:15 row_mask:0xa bank_mask:0xf
    s_nop 1
    v_min_u32_dpp v20, v20, v20 row_bcast:31 row_mask:0xc bank_mask:0xf
    s_nop 0
    v_readlane_b32 s50, v20, 63
    s_sub_u32 s50, s42, s50
    s_sub_u32 s42, s50, 1
    v_sub_u32 v20, s42, v28
    v_sub_u32 v21, s42, v29
    v_sub_u32 v22, s42, v30
    v_min3_u32 v20, v20, v21, v22
    v_sub_u32 v21, s42, v31
    v_sub_u32 v22, s42, v32
    v_min3_u32 v20, v20, v21, v22
    v_sub_u32 v21, s42, v33
    v_sub_u32 v22, s42, v34
    v_min3_u32 v20, v20, v21, v22
    v_sub_u32 v21, s42, v35
    v_min_u32 v20, v20, v21
    s_nop 1
    v_min_u32_dpp v20, v20, v20 row_shr:1 row_mask:0xf bank_mask:0xf
    s_nop 1
    v_min_u32_dpp v20, v20, v20 row_shr:2 row_mask:0xf bank_mask:0xf
    s_nop 1
    v_min_u32_dpp v20, v20, v20 row_shr:4 row_mask:0xf bank_mask:0xf
    s_nop 1
    v_min_u32_dpp v20, v20, v20 row_shr:8 row_mask:0xf bank_mask:0xf
    s_nop 1
    v_min_u32_dpp v20, v20, v20 row_bcast:15 row_mask:0xa bank_mask:0xf
    s_nop 1
    v_min_u32_dpp v20, v20, v20 row_bcast:31 row_mask:0xc bank_mask:0xf
    s_nop 0
    v_readlane_b32 s51, v20, 63
    s_sub_u32 s51, s42, s51
    s_sub_u32 s42, s51, 1
    v_sub_u32 v20, s42, v28
    v_sub_u32 v21, s42, v29
    v_sub_u32 v22, s42, v30
    v_min3_u32 v20, v20, v21, v22
    v_sub_u32 v21, s42, v31
    v_sub_u32 v22, s42, v32
    v_min3_u32 v20, v20, v21, v22
    v_sub_u32 v21, s42, v33
    v_sub_u32 v22, s42, v34
    v_min3_u32 v20, v20, v21, v22
    v_sub_u32 v21, s42, v35
    v_min_u32 v20, v20, v21
    s_nop 1
    v_min_u32_dpp v20, v20, v20 row_shr:1 row_mask:0xf bank_mask:0xf
    s_nop 1
    v_min_u32_dpp v20, v20, v20 row_shr:2 row_mask:0xf bank_mask:0xf
    s_nop 1
    v_min_u32_dpp v20, v20, v20 row_shr:4 row_mask:0xf bank_mask:0xf
    s_nop 1
    v_min_u32_dpp v20, v20, v20 row_shr:8 row_mask:0xf bank_mask:0xf
    s_nop 1
    v_min_u32_dpp v20, v20, v20 row_bcast:15 row_mask:0xa bank_mask:0xf
    s_nop 1
    v_min_u32_dpp v20, v20, v20 row_bcast:31 row_mask:0xc bank_mask:0xf
    s_nop 0
    v_readlane_b32 s52, v20, 63
    s_sub_u32 s52, s42, s52
    s_sub_u32 s42, s52, 1
    v_sub_u32 v20, s42, v28
    v_sub_u32 v21, s42, v29
    v_sub_u32 v22, s42, v30
    v_min3_u32 v20, v20, v21, v22
    v_sub_u32 v21, s42, v31
    v_sub_u32 v22, s42, v32
    v_min3_u32 v20, v20, v21, v22
    v_sub_u32 v21, s42, v33
    v_sub_u32 v22, s42, v34
    v_min3_u32 v20, v20, v21, v22
    v_sub_u32 v21, s42, v35
    v_min_u32 v20, v20, v21
    s_nop 1
    v_min_u32_dpp v20, v20, v20 row_shr:1 row_mask:0xf bank_mask:0xf
    s_nop 1
    v_min_u32_dpp v20, v20, v20 row_shr:2 row_mask:0xf bank_mask:0xf
    s_nop 1
    v_min_u32_dpp v20, v20, v20 row_shr:4 row_mask:0xf bank_mask:0xf
    s_nop 1
    v_min_u32_dpp v20, v20, v20 row_shr:8 row_mask:0xf bank_mask:0xf
    s_nop 1
    v_min_u32_dpp v20, v20, v20 row_bcast:15 row_mask:0xa bank_mask:0xf
    s_nop 1
    v_min_u32_dpp v20, v20, v20 row_bcast:31 row_mask:0xc bank_mask:0xf
    s_nop 0
    v_readlane_b32 s53, v20, 63
    s_sub_u32 s53, s42, s53
    s_sub_u32 s42, s53, 1
    v_sub_u32 v20, s42, v28
    v_sub_u32 v21, s42, v29
    v_sub_u32 v22, s42, v30
    v_min3_u32 v20, v20, v21, v22
    v_sub_u32 v21, s42, v31
    v_sub_u32 v22, s42, v32
    v_min3_u32 v20, v20, v21, v22
    v_sub_u32 v21, s42, v33
    v_sub_u32 v22, s42, v34
    v_min3_u32 v20, v20, v21, v22
    v_sub_u32 v21, s42, v35
    v_min_u32 v20, v20, v21
    s_nop 1
    v_min_u32_dpp v20, v20, v20 row_shr:1 row_mask:0xf bank_mask:0xf
    s_nop 1
    v_min_u32_dpp v20, v20, v20 row_shr:2 row_mask:0xf bank_mask:0xf
    s_nop 1
    v_min_u32_dpp v20, v20, v20 row_shr:4 row_mask:0xf bank_mask:0xf
    s_nop 1
    v_min_u32_dpp v20, v20, v20 row_shr:8 row_mask:0xf bank_mask:0xf
    s_nop 1
    v_min_u32_dpp v20, v20, v20 row_bcast:15 row_mask:0xa bank_mask:0xf
    s_nop 1
    v_min_u32_dpp v20, v20, v20 row_bcast:31 row_mask:0xc bank_mask:0xf
    s_nop 0
    v_readlane_b32 s54, v20, 63
    s_sub_u32 s54, s42, s54
    s_sub_u32 s42, s54, 1
    v_sub_u32 v20, s42, v28
    v_sub_u32 v21, s42, v29
    v_sub_u32 v22, s42, v30
    v_min3_u32 v20, v20, v21, v22
    v_sub_u32 v21, s42, v31
    v_sub_u32 v22, s42, v32
    v_min3_u32 v20, v20, v21, v22
    v_sub_u32 v21, s42, v33
    v_sub_u32 v22, s42, v34
    v_min3_u32 v20, v20, v21, v22
    v_sub_u32 v21, s42, v35
    v_min_u32 v20, v20, v21
    s_nop 1
    v_min_u32_dpp v20, v20, v20 row_shr:1 row_mask:0xf bank_mask:0xf
    s_nop 1
    v_min_u32_dpp v20, v20, v20 row_shr:2 row_mask:0xf bank_mask:0xf
    s_nop 1
    v_min_u32_dpp v20, v20, v20 row_shr:4 row_mask:0xf bank_mask:0xf
    s_nop 1
    v_min_u32_dpp v20, v20, v20 row_shr:8 row_mask:0xf bank_mask:0xf
    s_nop 1
    v_min_u32_dpp v20, v20, v20 row_bcast:15 row_mask:0xa bank_mask:0xf
    s_nop 1
    v_min_u32_dpp v20, v20, v20 row_bcast:31 row_mask:0xc bank_mask:0xf
    s_nop 0
    v_readlane_b32 s55, v20, 63
    s_sub_u32 s55, s42, s55
    s_sub_u32 s42, s55, 1
    v_sub_u32 v20, s42, v28
    v_sub_u32 v21, s42, v29
    v_sub_u32 v22, s42, v30
    v_min3_u32 v20, v20, v21, v22
    v_sub_u32 v21, s42, v31
    v_sub_u32 v22, s42, v32
    v_min3_u32 v20, v20, v21, v22
    v_sub_u32 v21, s42, v33
    v_sub_u32 v22, s42, v34
    v_min3_u32 v20, v20, v21, v22
    v_sub_u32 v21, s42, v35
    v_min_u32 v20, v20, v21
    s_nop 1
    v_min_u32_dpp v20, v20, v20 row_shr:1 row_mask:0xf bank_mask:0xf
    s_nop 1
    v_min_u32_dpp v20, v20, v20 row_shr:2 row_mask:0xf bank_mask:0xf
    s_nop 1
    v_min_u32_dpp v20, v20, v20 row_shr:4 row_mask:0xf bank_mask:0xf
    s_nop 1
    v_min_u32_dpp v20, v20, v20 row_shr:8 row_mask:0xf bank_mask:0xf
    s_nop 1
    v_min_u32_dpp v20, v20, v20 row_bcast:15 row_mask:0xa bank_mask:0xf
    s_nop 1
    v_min_u32_dpp v20, v20, v20 row_bcast:31 row_mask:0xc bank_mask:0xf
    s_nop 0
    v_readlane_b32 s56, v20, 63
    s_sub_u32 s56, s42, s56
    s_sub_u32 s42, s56, 1
    v_sub_u32 v20, s42, v28
    v_sub_u32 v21, s42, v29
    v_sub_u32 v22, s42, v30
    v_min3_u32 v20, v20, v21, v22
    v_sub_u32 v21, s42, v31
    v_sub_u32 v22, s42, v32
    v_min3_u32 v20, v20, v21, v22
    v_sub_u32 v21, s42, v33
    v_sub_u32 v22, s42, v34
    v_min3_u32 v20, v20, v21, v22
    v_sub_u32 v21, s42, v35
    v_min_u32 v20, v20, v21
    s_nop 1
    v_min_u32_dpp v20, v20, v20 row_shr:1 row_mask:0xf bank_mask:0xf
    s_nop 1
    v_min_u32_dpp v20, v20, v20 row_shr:2 row_mask:0xf bank_mask:0xf
    s_nop 1
    v_min_u32_dpp v20, v20, v20 row_shr:4 row_mask:0xf bank_mask:0xf
    s_nop 1
    v_min_u32_dpp v20, v20, v20 row_shr:8 row_mask:0xf bank_mask:0xf
    s_nop 1
    v_min_u32_dpp v20, v20, v20 row_bcast:15 row_mask:0xa bank_mask:0xf
    s_nop 1
    v_min_u32_dpp v20, v20, v20 row_bcast:31 row_mask:0xc bank_mask:0xf
    s_nop 0
    v_readlane_b32 s57, v20, 63
    s_sub_u32 s57, s42, s57
    s_sub_u32 s42, s57, 1
    v_mov_b32 v20, s50
    v_writelane_b32 v20, s51, 1
    v_writelane_b32 v20, s52, 2
    v_writelane_b32 v20, s53, 3
    v_writelane_b32 v20, s54, 4
    v_writelane_b32 v20, s55, 5
    v_writelane_b32 v20, s56, 6
    v_writelane_b32 v20, s57, 7
    s_lshl_b32 s42, s5, 8
    s_add_u32 s42, s42, 86016
    v_lshl_add_u32 v21, v19, 2, s42
    ds_write_b32 v21, v20
    s_waitcnt lgkmcnt(0)
    s_branch L_rt_back_local
L_rt_merge:
    v_bfe_u32 v21, v19, 3, 2
    v_lshlrev_b32 v21, 8, v21
    v_and_b32 v20, 7, v19
    v_lshl_add_u32 v21, v20, 2, v21
    v_add_u32 v21, 86016, v21
    ds_read_b32 v20, v21
    s_waitcnt lgkmcnt(0)
    s_mov_b32 s42, -1
    v_sub_u32 v21, s42, v20
    s_nop 1
    v_min_u32_dpp v21, v21, v21 row_shr:1 row_mask:0xf bank_mask:0xf
    s_nop 1
    v_min_u32_dpp v21, v21, v21 row_shr:2 row_mask:0xf bank_mask:0xf
    s_nop 1
    v_min_u32_dpp v21, v21, v21 row_shr:4 row_mask:0xf bank_mask:0xf
    s_nop 1
    v_min_u32_dpp v21, v21, v21 row_shr:8 row_mask:0xf bank_mask:0xf
    s_nop 1
    v_min_u32_dpp v21, v21, v21 row_bcast:15 row_mask:0xa bank_mask:0xf
    s_nop 1
    v_min_u32_dpp v21, v21, v21 row_bcast:31 row_mask:0xc bank_mask:0xf
    s_nop 0
    v_readlane_b32 s50, v21, 63
    s_sub_u32 s50, s42, s50
    s_sub_u32 s42, s50, 1
    v_sub_u32 v21, s42, v20
    s_nop 1
    v_min_u32_dpp v21, v21, v21 row_shr:1 row_mask:0xf bank_mask:0xf
    s_nop 1
    v_min_u32_dpp v21, v21, v21 row_shr:2 row_mask:0xf bank_mask:0xf
    s_nop 1
    v_min_u32_dpp v21, v21, v21 row_shr:4 row_mask:0xf bank_mask:0xf
    s_nop 1
    v_min_u32_dpp v21, v21, v21 row_shr:8 row_mask:0xf bank_mask:0xf
    s_nop 1
    v_min_u32_dpp v21, v21, v21 row_bcast:15 row_mask:0xa bank_mask:0xf
    s_nop 1
    v_min_u32_dpp v21, v21, v21 row_bcast:31 row_mask:0xc bank_mask:0xf
    s_nop 0
    v_readlane_b32 s51, v21, 63
    s_sub_u32 s51, s42, s51
    s_sub_u32 s42, s51, 1
    v_sub_u32 v21, s42, v20
    s_nop 1
    v_min_u32_dpp v21, v21, v21 row_shr:1 row_mask:0xf bank_mask:0xf
    s_nop 1
    v_min_u32_dpp v21, v21, v21 row_shr:2 row_mask:0xf bank_mask:0xf
    s_nop 1
    v_min_u32_dpp v21, v21, v21 row_shr:4 row_mask:0xf bank_mask:0xf
    s_nop 1
    v_min_u32_dpp v21, v21, v21 row_shr:8 row_mask:0xf bank_mask:0xf
    s_nop 1
    v_min_u32_dpp v21, v21, v21 row_bcast:15 row_mask:0xa bank_mask:0xf
    s_nop 1
    v_min_u32_dpp v21, v21, v21 row_bcast:31 row_mask:0xc bank_mask:0xf
    s_nop 0
    v_readlane_b32 s52, v21, 63
    s_sub_u32 s52, s42, s52
    s_sub_u32 s42, s52, 1
    v_sub_u32 v21, s42, v20
    s_nop 1
    v_min_u32_dpp v21, v21, v21 row_shr:1 row_mask:0xf bank_mask:0xf
    s_nop 1
    v_min_u32_dpp v21, v21, v21 row_shr:2 row_mask:0xf bank_mask:0xf
    s_nop 1
    v_min_u32_dpp v21, v21, v21 row_shr:4 row_mask:0xf bank_mask:0xf
    s_nop 1
    v_min_u32_dpp v21, v21, v21 row_shr:8 row_mask:0xf bank_mask:0xf
    s_nop 1
    v_min_u32_dpp v21, v21, v21 row_bcast:15 row_mask:0xa bank_mask:0xf
    s_nop 1
    v_min_u32_dpp v21, v21, v21 row_bcast:31 row_mask:0xc bank_mask:0xf
    s_nop 0
    v_readlane_b32 s53, v21, 63
    s_sub_u32 s53, s42, s53
    s_sub_u32 s42, s53, 1
    v_sub_u32 v21, s42, v20
    s_nop 1
    v_min_u32_dpp v21, v21, v21 row_shr:1 row_mask:0xf bank_mask:0xf
    s_nop 1
    v_min_u32_dpp v21, v21, v21 row_shr:2 row_mask:0xf bank_mask:0xf
    s_nop 1
    v_min_u32_dpp v21, v21, v21 row_shr:4 row_mask:0xf bank_mask:0xf
    s_nop 1
    v_min_u32_dpp v21, v21, v21 row_shr:8 row_mask:0xf bank_mask:0xf
    s_nop 1
    v_min_u32_dpp v21, v21, v21 row_bcast:15 row_mask:0xa bank_mask:0xf
    s_nop 1
    v_min_u32_dpp v21, v21, v21 row_bcast:31 row_mask:0xc bank_mask:0xf
    s_nop 0
    v_readlane_b32 s54, v21, 63
    s_sub_u32 s54, s42, s54
    s_sub_u32 s42, s54, 1
    v_sub_u32 v21, s42, v20
    s_nop 1
    v_min_u32_dpp v21, v21, v21 row_shr:1 row_mask:0xf bank_mask:0xf
    s_nop 1
    v_min_u32_dpp v21, v21, v21 row_shr:2 row_mask:0xf bank_mask:0xf
    s_nop 1
    v_min_u32_dpp v21, v21, v21 row_shr:4 row_mask:0xf bank_mask:0xf
    s_nop 1
    v_min_u32_dpp v21, v21, v21 row_shr:8 row_mask:0xf bank_mask:0xf
    s_nop 1
    v_min_u32_dpp v21, v21, v21 row_bcast:15 row_mask:0xa bank_mask:0xf
    s_nop 1
    v_min_u32_dpp v21, v21, v21 row_bcast:31 row_mask:0xc bank_mask:0xf
    s_nop 0
    v_readlane_b32 s55, v21, 63
    s_sub_u32 s55, s42, s55
    s_sub_u32 s42, s55, 1
    v_sub_u32 v21, s42, v20
    s_nop 1
    v_min_u32_dpp v21, v21, v21 row_shr:1 row_mask:0xf bank_mask:0xf
    s_nop 1
    v_min_u32_dpp v21, v21, v21 row_shr:2 row_mask:0xf bank_mask:0xf
    s_nop 1
    v_min_u32_dpp v21, v21, v21 row_shr:4 row_mask:0xf bank_mask:0xf
    s_nop 1
    v_min_u32_dpp v21, v21, v21 row_shr:8 row_mask:0xf bank_mask:0xf
    s_nop 1
    v_min_u32_dpp v21, v21, v21 row_bcast:15 row_mask:0xa bank_mask:0xf
    s_nop 1
    v_min_u32_dpp v21, v21, v21 row_bcast:31 row_mask:0xc bank_mask:0xf
    s_nop 0
    v_readlane_b32 s56, v21, 63
    s_sub_u32 s56, s42, s56
    s_sub_u32 s42, s56, 1
    v_sub_u32 v21, s42, v20
    s_nop 1
    v_min_u32_dpp v21, v21, v21 row_shr:1 row_mask:0xf bank_mask:0xf
    s_nop 1
    v_min_u32_dpp v21, v21, v21 row_shr:2 row_mask:0xf bank_mask:0xf
    s_nop 1
    v_min_u32_dpp v21, v21, v21 row_shr:4 row_mask:0xf bank_mask:0xf
    s_nop 1
    v_min_u32_dpp v21, v21, v21 row_shr:8 row_mask:0xf bank_mask:0xf
    s_nop 1
    v_min_u32_dpp v21, v21, v21 row_bcast:15 row_mask:0xa bank_mask:0xf
    s_nop 1
    v_min_u32_dpp v21, v21, v21 row_bcast:31 row_mask:0xc bank_mask:0xf
    s_nop 0
    v_readlane_b32 s57, v21, 63
    s_sub_u32 s57, s42, s57
    s_sub_u32 s42, s57, 1
    v_mov_b32 v20, s50
    v_writelane_b32 v20, s51, 1
    v_writelane_b32 v20, s52, 2
    v_writelane_b32 v20, s53, 3
    v_writelane_b32 v20, s54, 4
    v_writelane_b32 v20, s55, 5
    v_writelane_b32 v20, s56, 6
    v_writelane_b32 v20, s57, 7
    v_lshlrev_b32 v21, 2, v19
    s_mov_b32 s42, 0x29b000
    s_mov_b64 exec, 0xff
    buffer_store_dword v20, v21, s[76:79], s42 offen sc1
    s_mov_b64 exec, -1
    s_branch L_rt_back_merge
L_site0:
    s_mov_b32 s43, m0
    s_mov_b32 m0, s38
    s_add_u32 s38, s38, 1024
    buffer_load_dwordx4 v24, s[16:19], s37 offen lds
    s_mov_b32 m0, s43
    s_add_u32 s37, s37, 221184
    s_cmp_eq_u32 s35, 9
    s_cselect_b32 s36, 4, s36
    s_branch L_site_back0
L_site1:
    s_mov_b32 s43, m0
    s_mov_b32 m0, s38
    s_add_u32 s38, s38, 1024
    buffer_load_dwordx4 v24, s[16:19], s37 offen lds
    s_mov_b32 m0, s43
    s_add_u32 s37, s37, 221184
    s_cmp_eq_u32 s35, 9
    s_cselect_b32 s36, 4, s36
    s_branch L_site_back1
L_once_pack:
    s_mov_b64 exec, 1
    buffer_store_dword v27, off, s[76:79], s75 sc1
    s_mov_b64 exec, -1
    s_branch L_once_back_pack
L_site2:
    s_mov_b32 s43, m0
    s_mov_b32 m0, s38
    s_add_u32 s38, s38, 1024
    buffer_load_dwordx4 v24, s[16:19], s37 offen lds
    s_mov_b32 m0, s43
    s_add_u32 s37, s37, 221184
    s_cmp_eq_u32 s35, 9
    s_cselect_b32 s36, 4, s36
    s_branch L_site_back2
L_site3:
    s_mov_b32 s43, m0
    s_mov_b32 m0, s38
    s_add_u32 s38, s38, 1024
    buffer_load_dwordx4 v24, s[16:19], s37 offen lds
    s_mov_b32 m0, s43
    s_add_u32 s37, s37, 221184
    s_cmp_eq_u32 s35, 9
    s_cselect_b32 s36, 4, s36
    s_branch L_site_back3
L_spin_pack:
    s_mov_b32 s7, 32768
L_retry_pack:
    s_sleep 2
    buffer_load_dwordx4 v[28:31], v32, s[76:79], 0 offen sc1
    s_waitcnt vmcnt(0)
    v_min3_u32 v28, v28, v29, v30
    v_min_u32 v28, v28, v31
    v_cmp_gt_u32 vcc, 1, v28
    s_and_b64 vcc, vcc, exec
    s_cbranch_scc0 L_back_pack
    s_sub_u32 s7, s7, 1
    s_cbranch_scc0 L_retry_pack
    s_branch L_back_pack
L_spin_sel:
    s_mov_b32 s7, 32768
L_retry_sel:
    s_sleep 2
    buffer_load_dword v249, v21, s[76:79], 0 offen sc1
    s_waitcnt vmcnt(0)
    v_cmp_eq_u32 vcc, 0, v249
    s_and_b64 vcc, vcc, exec
    s_cbranch_scc0 L_back_sel
    s_sub_u32 s7, s7, 1
    s_cbranch_scc0 L_retry_sel
    s_branch L_back_sel
L_spin_ffn:
    s_mov_b32 s7, 32768
L_retry_ffn:
    s_sleep 2
    buffer_load_dwordx4 v[252:255], v20, s[76:79], 0 offen sc1
    s_waitcnt vmcnt(0)
    v_min3_u32 v252, v252, v253, v254
    v_min_u32 v252, v252, v255
    v_cmp_gt_u32 vcc, 2, v252
    s_and_b64 vcc, vcc, exec
    s_cbranch_scc0 L_back_ffn
    s_sub_u32 s7, s7, 1
    s_cbranch_scc0 L_retry_ffn
    s_branch L_back_ffn
L_spin_o:
    s_mov_b32 s7, 32768
L_retry_o:
    s_sleep 2
    buffer_load_dwordx4 v[252:255], v1, s[76:79], 0 offen sc1
    s_waitcnt vmcnt(0)
    v_min3_u32 v252, v252, v253, v254
    v_min_u32 v252, v252, v255
    v_cmp_gt_u32 vcc, 1, v252
    s_and_b64 vcc, vcc, exec
    s_cbranch_scc0 L_back_o
    s_sub_u32 s7, s7, 1
    s_cbranch_scc0 L_retry_o
    s_branch L_back_o
L_spin_upd:
    s_mov_b32 s7, 32768
L_retry_upd:
    s_sleep 2
    buffer_load_dwordx4 v[252:255], v1, s[76:79], 0 offen sc1
    s_waitcnt vmcnt(0)
    v_min3_u32 v252, v252, v253, v254
    v_min_u32 v252, v252, v255
    v_cmp_gt_u32 vcc, 3, v252
    s_and_b64 vcc, vcc, exec
    s_cbranch_scc0 L_back_upd
    s_sub_u32 s7, s7, 1
    s_cbranch_scc0 L_retry_upd
    s_branch L_back_upd
L_code_end:
    s_endpgm

.section .rodata,"a"
.p2align 6
.amdhsa_kernel recurrent_scan__mha_block_cached__moe_arch_mod__prompt_kernel
  .amdhsa_next_free_vgpr 512
  .amdhsa_next_free_sgpr 102
  .amdhsa_accum_offset 256
  .amdhsa_group_segment_fixed_size 0
  .amdhsa_kernarg_size 104
  .amdhsa_user_sgpr_count 2
  .amdhsa_user_sgpr_kernarg_segment_ptr 1
  .amdhsa_system_sgpr_workgroup_id_x 1
  .amdhsa_float_denorm_mode_32 3
.end_amdhsa_kernel
```

```asm
; @launch grid=(256,1,1) block=(256,1,1) lds=163840
.amdgcn_target "amdgcn-amd-amdhsa--gfx950"
.text
.globl recurrent_scan__mha_block_cached__moe_arch_mod__prompt_kernel
.p2align 8
.type recurrent_scan__mha_block_cached__moe_arch_mod__prompt_kernel,@function
recurrent_scan__mha_block_cached__moe_arch_mod__prompt_kernel:
    s_cmp_ge_u32 s2, 256
    s_cbranch_scc1 L_end
    s_load_dwordx16 s[48:63], s[0:1], 0
    s_load_dwordx8 s[64:71], s[0:1], 64
    s_load_dwordx2 s[72:73], s[0:1], 96
    s_getpc_b64 s[40:41]
L_touch:
    s_bfe_u32 s42, s2, 0x20003
    s_lshl_b32 s42, s42, 8
    v_add_u32 v252, s42, v0
    v_min_u32 v252, (L_code_end - L_touch) / 128, v252
    v_lshlrev_b32 v252, 7, v252
    global_load_dword a120, v252, s[40:41]
    v_lshrrev_b32 v116, 6, v0
    v_and_b32 v19, 63, v0
    s_and_b32 s40, s2, 7
    v_readfirstlane_b32 s5, v116
    s_lshl_b32 s40, s40, 2
    s_bfe_u32 s41, s2, 0x20003
    s_add_u32 s3, s40, s41
    s_lshr_b32 s4, s2, 5
    s_lshl_b32 s74, s4, 5
    s_add_u32 s6, s74, s3
    v_lshrrev_b32 v118, 4, v19
    v_and_b32 v117, 15, v19
    v_lshlrev_b32 v119, 1, v118
    v_xor_b32 v119, v117, v119
    s_lshl_b32 s42, s5, 4
    v_add_u32 v120, s42, v118
    v_lshlrev_b32 v121, 4, v119
    v_xor_b32 v122, 0x80, v121
    v_lshl_add_u32 v123, v120, 13, v121
    v_lshl_add_u32 v116, v120, 13, v122
    v_add_u32 v44, 0, v123
    v_add_u32 v45, 31744, v123
    v_add_u32 v46, 63488, v116
    v_add_u32 v47, 95232, v116
    v_lshl_add_u32 v17, v120, 8, v121
    v_lshl_add_u32 v18, v120, 8, v122
    v_xor_b32 v117, v117, v118
    v_xor_b32 v121, 0, v117
    v_lshlrev_b32 v121, 4, v121
    v_lshl_add_u32 v13, v120, 8, v121
    v_xor_b32 v121, 4, v117
    v_lshlrev_b32 v121, 4, v121
    v_lshl_add_u32 v14, v120, 8, v121
    v_xor_b32 v121, 8, v117
    v_lshlrev_b32 v121, 4, v121
    v_lshl_add_u32 v15, v120, 8, v121
    v_xor_b32 v121, 12, v117
    v_lshlrev_b32 v121, 4, v121
    v_lshl_add_u32 v16, v120, 8, v121
    v_lshrrev_b32 v116, 3, v19
    v_and_b32 v117, 7, v19
    v_xor_b32 v117, v117, v118
    v_mul_u32_u24 v116, 1280, v116
    s_mul_i32 s42, s5, 81920
    v_lshl_add_u32 v119, v117, 4, v116
    v_xor_b32 v117, 4, v117
    v_lshl_add_u32 v120, v117, 4, v116
    v_add_u32 v119, s42, v119
    v_add_u32 v120, s42, v120
    v_add_u32 v36, 0, v119
    v_add_u32 v37, 9216, v120
    v_add_u32 v38, 18432, v119
    v_add_u32 v39, 27648, v120
    v_add_u32 v40, 40960, v119
    v_add_u32 v41, 50176, v120
    v_add_u32 v42, 59392, v119
    v_add_u32 v43, 68608, v120
    s_lshl_b32 s43, s6, 2
    s_add_u32 s43, s43, s5
    s_lshl_b32 s43, s43, 1
    s_mul_i32 s38, s5, 24576
    s_lshl_b32 s40, s5, 12
    s_add_u32 s39, s40, 98304
    s_mov_b32 s34, s39
    s_mov_b32 s28, 0
    s_mov_b32 s29, 0
    s_and_b32 s40, s3, 31
    s_mul_i32 s40, s40, 10
    s_lshr_b32 s40, s40, 5
    s_lshl_b32 s36, s40, 7
    s_waitcnt lgkmcnt(0)
    s_mov_b32 s88, s48
    s_mov_b32 s89, s49
    s_mov_b32 s90, 0x280000
    s_mov_b32 s91, 0x20000
    s_mov_b32 s92, s60
    s_mov_b32 s93, s61
    s_mov_b32 s94, 0x500
    s_mov_b32 s95, 0x20000
    s_lshl_b32 s40, s3, 8
    s_add_u32 s20, s54, s40
    s_addc_u32 s21, s55, 0
    s_mov_b32 s22, 0x4fe100
    s_mov_b32 s23, 0x20000
    s_mul_i32 s40, s4, 327680
    s_add_u32 s16, s48, s40
    s_addc_u32 s17, s49, 0
    s_mov_b32 s18, 0x50000
    s_mov_b32 s19, 0x20000
    s_add_u32 m0, s39, 0
    s_mov_b32 s37, 0
    buffer_load_dwordx4 v44, s[20:23], s37 offen offset:0 lds
    buffer_load_dwordx4 v45, s[20:23], s37 offen offset:1024 lds
    buffer_load_dwordx4 v46, s[20:23], s37 offen offset:2048 lds
    buffer_load_dwordx4 v47, s[20:23], s37 offen offset:3072 lds
    s_add_u32 m0, s38, 0
    s_mov_b32 s36, 0
    buffer_load_dwordx4 v36, s[16:19], s36 offen offset:0 lds
    buffer_load_dwordx4 v37, s[16:19], s36 offen offset:1024 lds
    buffer_load_dwordx4 v38, s[16:19], s36 offen offset:2048 lds
    buffer_load_dwordx4 v39, s[16:19], s36 offen offset:3072 lds
    s_add_u32 m0, s38, 4096
    s_nop 0
    buffer_load_dwordx4 v40, s[16:19], s36 offen offset:0 lds
    buffer_load_dwordx4 v41, s[16:19], s36 offen offset:1024 lds
    buffer_load_dwordx4 v42, s[16:19], s36 offen offset:2048 lds
    buffer_load_dwordx4 v43, s[16:19], s36 offen offset:3072 lds
    v_lshrrev_b32 v108, 5, v19
    v_add_u32 v108, s43, v108
    v_and_b32 v110, 31, v19
    v_lshlrev_b32 v110, 3, v110
    v_mul_u32_u24 v109, 1280, v108
    v_add_u32 v109, v109, v110
    buffer_load_dwordx2 v[60:61], v109, s[88:91], 0 offen offset:0
    buffer_load_dwordx2 v[62:63], v109, s[88:91], 0 offen offset:256
    buffer_load_dwordx2 v[64:65], v109, s[88:91], 0 offen offset:512
    buffer_load_dwordx2 v[66:67], v109, s[88:91], 0 offen offset:768
    buffer_load_dwordx2 v[68:69], v109, s[88:91], 0 offen offset:1024
    buffer_load_dwordx2 v[70:71], v110, s[92:95], 0 offen offset:0
    buffer_load_dwordx2 v[72:73], v110, s[92:95], 0 offen offset:256
    buffer_load_dwordx2 v[74:75], v110, s[92:95], 0 offen offset:512
    buffer_load_dwordx2 v[76:77], v110, s[92:95], 0 offen offset:768
    buffer_load_dwordx2 v[78:79], v110, s[92:95], 0 offen offset:1024
    s_lshl_b32 s40, s3, 19
    s_add_u32 s8, s50, s40
    s_addc_u32 s9, s51, 0
    s_mov_b32 s10, 0x80000
    s_mov_b32 s11, 0x20000
    s_add_u32 s12, s52, s40
    s_addc_u32 s13, s53, 0
    s_mov_b32 s14, 0x80000
    s_mov_b32 s15, 0x20000
    s_and_b32 s40, s5, 1
    s_lshl_b32 s40, s40, 12
    s_cmp_ge_u32 s5, 2
    s_cselect_b32 s30, 32, 8
    s_cselect_b32 s31, 40, 16
    s_cselect_b32 s32, 0, 56
    s_cselect_b32 s33, 48, 24
    s_lshl_b32 s30, s30, 10
    s_add_u32 s30, s30, s40
    s_lshl_b32 s31, s31, 10
    s_add_u32 s31, s31, s40
    s_lshl_b32 s32, s32, 10
    s_add_u32 s32, s32, s40
    s_lshl_b32 s33, s33, 10
    s_add_u32 s33, s33, s40
    s_mov_b32 s44, 0x3e0293ee
    s_mov_b32 s45, 4096
    s_mov_b32 s76, s72
    s_mov_b32 s77, s73
    s_mov_b32 s78, 0x2500000
    s_mov_b32 s79, 0x20000
    s_mov_b32 s92, s70
    s_mov_b32 s93, s71
    s_mov_b32 s94, 0x100
    s_mov_b32 s95, 0x20000
    s_lshl_b32 s41, s4, 2
    s_add_u32 s41, s41, s5
    s_lshl_b32 s40, s41, 5
    s_add_u32 s40, s40, s3
    s_lshl_b32 s40, s40, 14
    s_add_u32 s40, s40, 0x400000
    s_add_u32 s24, s72, s40
    s_addc_u32 s25, s73, 0
    s_mov_b32 s26, 0x4000
    s_mov_b32 s27, 0x20000
    s_and_b32 s42, s3, 3
    s_lshl_b32 s42, s42, 2
    s_lshr_b32 s40, s6, 2
    s_lshl_b32 s40, s40, 7
    s_add_u32 s40, s40, s42
    s_add_u32 s75, s40, 0x290000
    s_lshr_b32 s40, s3, 2
    s_lshl_b32 s40, s40, 7
    s_add_u32 s40, s40, s42
    s_lshl_b32 s42, s41, 10
    s_add_u32 s40, s40, s42
    s_add_u32 s58, s40, 0x292000
    s_cmp_eq_u32 s5, 0
    s_cselect_b32 s59, 5, 8
    s_lshl_b32 s41, s41, 10
    s_add_u32 s46, s41, 0x280000
    v_lshrrev_b32 v116, 4, v19
    v_and_b32 v117, 15, v19
    v_lshlrev_b32 v59, 4, v117
    v_xor_b32 v118, v116, v117
    v_lshlrev_b32 v119, 8, v117
    v_add_u32 v119, 98304, v119
    s_add_u32 s41, s5, 0
    s_and_b32 s41, s41, 3
    s_lshl_b32 s41, s41, 2
    v_xor_b32 v120, s41, v118
    v_lshl_add_u32 v1, v120, 4, v119
    s_add_u32 s41, s5, 1
    s_and_b32 s41, s41, 3
    s_lshl_b32 s41, s41, 2
    v_xor_b32 v120, s41, v118
    v_lshl_add_u32 v2, v120, 4, v119
    s_add_u32 s41, s5, 2
    s_and_b32 s41, s41, 3
    s_lshl_b32 s41, s41, 2
    v_xor_b32 v120, s41, v118
    v_lshl_add_u32 v3, v120, 4, v119
    s_add_u32 s41, s5, 3
    s_and_b32 s41, s41, 3
    s_lshl_b32 s41, s41, 2
    v_xor_b32 v120, s41, v118
    v_lshl_add_u32 v4, v120, 4, v119
    v_lshrrev_b32 v118, 1, v117
    v_xor_b32 v118, v116, v118
    v_lshlrev_b32 v119, 7, v117
    v_add_u32 v119, s38, v119
    v_xor_b32 v120, 0, v118
    v_lshl_add_u32 v48, v120, 4, v119
    v_xor_b32 v120, 4, v118
    v_lshl_add_u32 v49, v120, 4, v119
    v_bfe_u32 v118, v19, 2, 2
    v_bfe_u32 v119, v19, 2, 3
    v_and_b32 v120, 3, v19
    v_lshlrev_b32 v120, 3, v120
    v_lshl_add_u32 v121, v116, 2, v118
    v_lshl_add_u32 v121, v121, 8, v120
    v_lshl_add_u32 v122, v116, 3, v118
    v_lshl_add_u32 v122, v122, 8, v120
    v_add_u32 v122, 98304, v122
    v_xor_b32 v123, 0, v119
    v_lshl_add_u32 v5, v123, 5, v121
    v_xor_b32 v123, 1, v119
    v_lshl_add_u32 v6, v123, 5, v121
    v_xor_b32 v123, 2, v119
    v_lshl_add_u32 v7, v123, 5, v121
    v_xor_b32 v123, 3, v119
    v_lshl_add_u32 v8, v123, 5, v121
    v_xor_b32 v123, 4, v119
    v_lshl_add_u32 v9, v123, 5, v121
    v_xor_b32 v123, 5, v119
    v_lshl_add_u32 v10, v123, 5, v121
    v_xor_b32 v123, 6, v119
    v_lshl_add_u32 v11, v123, 5, v121
    v_xor_b32 v123, 7, v119
    v_lshl_add_u32 v12, v123, 5, v121
    s_lshl_b32 s42, s5, 1
    s_add_u32 s41, s42, 0
    s_and_b32 s41, s41, 7
    v_xor_b32 v123, s41, v119
    v_lshl_add_u32 v50, v123, 5, v122
    s_add_u32 s41, s42, 1
    s_and_b32 s41, s41, 7
    v_xor_b32 v123, s41, v119
    v_lshl_add_u32 v51, v123, 5, v122
    s_add_u32 s41, s42, 2
    s_and_b32 s41, s41, 7
    v_xor_b32 v123, s41, v119
    v_lshl_add_u32 v52, v123, 5, v122
    s_add_u32 s41, s42, 3
    s_and_b32 s41, s41, 7
    v_xor_b32 v123, s41, v119
    v_lshl_add_u32 v53, v123, 5, v122
    s_add_u32 s41, s42, 4
    s_and_b32 s41, s41, 7
    v_xor_b32 v123, s41, v119
    v_lshl_add_u32 v54, v123, 5, v122
    s_add_u32 s41, s42, 5
    s_and_b32 s41, s41, 7
    v_xor_b32 v123, s41, v119
    v_lshl_add_u32 v55, v123, 5, v122
    s_add_u32 s41, s42, 6
    s_and_b32 s41, s41, 7
    v_xor_b32 v123, s41, v119
    v_lshl_add_u32 v56, v123, 5, v122
    s_add_u32 s41, s42, 7
    s_and_b32 s41, s41, 7
    v_xor_b32 v123, s41, v119
    v_lshl_add_u32 v57, v123, 5, v122
    s_lshl_b32 s41, s5, 7
    s_add_u32 s41, s41, 86016
    v_lshl_add_u32 v58, v116, 4, s41
    v_mov_b32 v32, 0x3f803f80
    v_mov_b32 v33, 0x3f803f80
    v_mov_b32 v34, 0x3f803f80
    v_mov_b32 v35, 0x3f803f80
    v_and_b32 v120, 1, v19
    v_cmp_eq_u32 vcc, 0, v120
    v_mov_b32 v121, 0x44444444
    v_mov_b32 v122, 0xeeeeeeee
    v_cndmask_b32 v248, v122, v121, vcc
    v_and_b32 v120, 2, v19
    v_cmp_eq_u32 vcc, 0, v120
    v_mov_b32 v27, 1
    v_mov_b32 v28, 0
    v_cndmask_b32 v244, 0, v32, vcc
    v_cndmask_b32 v245, 0, v32, vcc
    v_cndmask_b32 v246, 0, v32, vcc
    v_cndmask_b32 v247, 0, v32, vcc
    v_accvgpr_write_b32 a224, 0
    v_accvgpr_write_b32 a225, 0
    v_accvgpr_write_b32 a226, 0
    v_accvgpr_write_b32 a227, 0
    v_accvgpr_write_b32 a228, 0
    v_accvgpr_write_b32 a229, 0
    v_accvgpr_write_b32 a230, 0
    v_accvgpr_write_b32 a231, 0
    v_accvgpr_write_b32 a232, 0
    v_accvgpr_write_b32 a233, 0
    v_accvgpr_write_b32 a234, 0
    v_accvgpr_write_b32 a235, 0
    v_accvgpr_write_b32 a236, 0
    v_accvgpr_write_b32 a237, 0
    v_accvgpr_write_b32 a238, 0
    v_accvgpr_write_b32 a239, 0
    s_mul_i32 s47, s5, 5120
    s_mov_b32 s96, s56
    s_mov_b32 s97, s57
    s_mov_b32 s98, 0x500000
    s_mov_b32 s99, 0x20000
    s_lshr_b32 s40, s6, 1
    s_and_b32 s41, s6, 1
    s_lshl_b32 s41, s41, 2
    s_add_u32 s41, s41, s5
    s_add_u32 s47, s47, 65536
    s_mul_i32 s42, s40, 40960
    s_mul_i32 s43, s41, 160
    s_add_u32 s42, s42, s43
    v_add_u32 v25, 0, v19
    v_mul_u32_u24 v26, 6554, v25
    v_lshrrev_b32 v26, 16, v26
    v_mul_u32_u24 v20, 1120, v26
    v_lshl_add_u32 v20, v25, 4, v20
    v_add_u32 v20, s42, v20
    v_add_u32 v25, 64, v19
    v_mul_u32_u24 v26, 6554, v25
    v_lshrrev_b32 v26, 16, v26
    v_mul_u32_u24 v21, 1120, v26
    v_lshl_add_u32 v21, v25, 4, v21
    v_add_u32 v21, s42, v21
    v_add_u32 v25, 128, v19
    v_mul_u32_u24 v26, 6554, v25
    v_lshrrev_b32 v26, 16, v26
    v_mul_u32_u24 v22, 1120, v26
    v_lshl_add_u32 v22, v25, 4, v22
    v_add_u32 v22, s42, v22
    v_add_u32 v25, 192, v19
    v_mul_u32_u24 v26, 6554, v25
    v_lshrrev_b32 v26, 16, v26
    v_mul_u32_u24 v23, 1120, v26
    v_lshl_add_u32 v23, v25, 4, v23
    v_add_u32 v23, s42, v23
    v_add_u32 v25, 256, v19
    v_mul_u32_u24 v26, 6554, v25
    v_lshrrev_b32 v26, 16, v26
    v_mul_u32_u24 v24, 1120, v26
    v_lshl_add_u32 v24, v25, 4, v24
    v_add_u32 v24, s42, v24
    v_lshrrev_b32 v25, 2, v19
    v_mul_u32_u24 v25, 160, v25
    v_and_b32 v26, 3, v19
    v_lshl_add_u32 v25, v26, 3, v25
    v_add_u32 v25, s47, v25
    s_lshl_b32 s42, s41, 7
    s_add_u32 s42, s42, s40
    s_mul_i32 s42, s42, 5120
    s_add_u32 s42, s42, 0x1400000
    v_lshlrev_b32 v26, 4, v19
    v_add_u32 v26, s42, v26
    s_add_u32 m0, s39, 16384
    s_mov_b32 s37, 524288
    buffer_load_dwordx4 v44, s[20:23], s37 offen offset:0 lds
    buffer_load_dwordx4 v45, s[20:23], s37 offen offset:1024 lds
    buffer_load_dwordx4 v46, s[20:23], s37 offen offset:2048 lds
    buffer_load_dwordx4 v47, s[20:23], s37 offen offset:3072 lds
    s_add_u32 m0, s38, 8192
    s_mov_b32 s36, 128
    buffer_load_dwordx4 v36, s[16:19], s36 offen offset:0 lds
    buffer_load_dwordx4 v37, s[16:19], s36 offen offset:1024 lds
    buffer_load_dwordx4 v38, s[16:19], s36 offen offset:2048 lds
    buffer_load_dwordx4 v39, s[16:19], s36 offen offset:3072 lds
    s_add_u32 m0, s38, 12288
    s_nop 0
    buffer_load_dwordx4 v40, s[16:19], s36 offen offset:0 lds
    buffer_load_dwordx4 v41, s[16:19], s36 offen offset:1024 lds
    buffer_load_dwordx4 v42, s[16:19], s36 offen offset:2048 lds
    buffer_load_dwordx4 v43, s[16:19], s36 offen offset:3072 lds
    s_add_u32 m0, s39, 32768
    s_mov_b32 s37, 1048576
    buffer_load_dwordx4 v44, s[20:23], s37 offen offset:0 lds
    buffer_load_dwordx4 v45, s[20:23], s37 offen offset:1024 lds
    buffer_load_dwordx4 v46, s[20:23], s37 offen offset:2048 lds
    buffer_load_dwordx4 v47, s[20:23], s37 offen offset:3072 lds
    s_waitcnt vmcnt(26)
    s_barrier
    ds_read_b64_tr_b16 a[0:1], v50 offset:0
    ds_read_b64_tr_b16 a[2:3], v50 offset:1024
    ds_read_b128 a[32:35], v48 offset:0
    ds_read_b128 a[36:39], v48 offset:2048
    ds_read_b128 a[40:43], v48 offset:4096
    ds_read_b128 a[44:47], v48 offset:6144
    ds_read_b64_tr_b16 a[4:5], v51 offset:0
    ds_read_b64_tr_b16 a[6:7], v51 offset:1024
    ds_read_b64_tr_b16 a[8:9], v52 offset:0
    ds_read_b64_tr_b16 a[10:11], v52 offset:1024
    ds_read_b64_tr_b16 a[12:13], v53 offset:0
    ds_read_b64_tr_b16 a[14:15], v53 offset:1024
    ds_read_b64_tr_b16 a[16:17], v54 offset:0
    ds_read_b64_tr_b16 a[18:19], v54 offset:1024
    ds_read_b64_tr_b16 a[20:21], v55 offset:0
    ds_read_b64_tr_b16 a[22:23], v55 offset:1024
    ds_read_b64_tr_b16 a[24:25], v56 offset:0
    ds_read_b64_tr_b16 a[26:27], v56 offset:1024
    ds_read_b64_tr_b16 a[28:29], v57 offset:0
    ds_read_b64_tr_b16 a[30:31], v57 offset:1024
    s_waitcnt lgkmcnt(0)
    v_mfma_f32_16x16x32_bf16 v[100:103], a[0:3], v[32:35], 0
    s_waitcnt vmcnt(16)
    ds_read_b64_tr_b16 a[48:49], v50 offset:8192
    v_mfma_f32_16x16x32_bf16 v[104:107], a[4:7], v[32:35], 0
    s_add_u32 m0, s38, 16384
    s_mov_b32 s36, 256
    ds_read_b64_tr_b16 a[50:51], v50 offset:9216
    v_mfma_f32_16x16x32_bf16 v[116:119], a[0:3], a[32:35], 0
    s_lshl_b32 s40, s6, 7
    buffer_load_dwordx4 v36, s[16:19], s36 offen offset:0 lds
    v_mfma_f32_16x16x32_bf16 v[148:151], a[0:3], a[36:39], 0
    s_add_u32 s41, s40, 0x292000
    ds_read_b128 a[80:83], v49 offset:0
    v_mfma_f32_16x16x32_bf16 v[180:183], a[0:3], a[40:43], 0
    s_add_u32 s40, s40, 0x290000
    ds_read_b128 a[84:87], v49 offset:2048
    v_mfma_f32_16x16x32_bf16 v[212:215], a[0:3], a[44:47], 0
    s_cmp_lt_u32 s6, 64
    s_cselect_b32 s40, s40, 0x2500000
    buffer_load_dwordx4 v37, s[16:19], s36 offen offset:1024 lds
    v_mfma_f32_16x16x32_bf16 v[216:219], a[4:7], a[44:47], 0
    s_cmp_eq_u32 s5, 1
    s_cselect_b32 s40, s40, 0x2500000
    ds_read_b128 a[88:91], v49 offset:4096
    v_mfma_f32_16x16x32_bf16 v[184:187], a[4:7], a[40:43], 0
    s_cmp_eq_u32 s5, 0
    s_cselect_b32 s40, s41, s40
    ds_read_b128 a[92:95], v49 offset:6144
    v_mfma_f32_16x16x32_bf16 v[152:155], a[4:7], a[36:39], 0
    s_add_u32 s41, s41, 0xe000
    ds_read_b64_tr_b16 a[52:53], v51 offset:8192
    v_mfma_f32_16x16x32_bf16 v[120:123], a[4:7], a[32:35], 0
    s_cmp_eq_u32 s5, 3
    s_cselect_b32 s40, s41, s40
    buffer_load_dwordx4 v38, s[16:19], s36 offen offset:2048 lds
    v_mfma_f32_16x16x32_bf16 v[124:127], a[8:11], a[32:35], 0
    s_lshl_b32 s41, s6, 2
    ds_read_b64_tr_b16 a[54:55], v51 offset:9216
    v_mfma_f32_16x16x32_bf16 v[156:159], a[8:11], a[36:39], 0
    s_add_u32 s41, s41, s5
    ds_read_b64_tr_b16 a[56:57], v52 offset:8192
    v_mfma_f32_16x16x32_bf16 v[188:191], a[8:11], a[40:43], 0
    s_cmp_eq_u32 s41, 1022
    s_cselect_b32 s40, 0x29b000, s40
    ds_read_b64_tr_b16 a[58:59], v52 offset:9216
    v_mfma_f32_16x16x32_bf16 v[220:223], a[8:11], a[44:47], 0
    s_lshl_b32 s41, s6, 7
    buffer_load_dwordx4 v39, s[16:19], s36 offen offset:3072 lds
    v_mfma_f32_16x16x32_bf16 v[224:227], a[12:15], a[44:47], 0
    s_add_u32 s41, s41, 0x29c000
    ds_read_b64_tr_b16 a[60:61], v53 offset:8192
    v_mfma_f32_16x16x32_bf16 v[192:195], a[12:15], a[40:43], 0
    s_xor_b32 s42, s5, 2
    ds_read_b64_tr_b16 a[62:63], v53 offset:9216
    v_mfma_f32_16x16x32_bf16 v[160:163], a[12:15], a[36:39], 0
    s_add_u32 m0, s38, 20480
    ds_read_b64_tr_b16 a[64:65], v54 offset:8192
    v_mfma_f32_16x16x32_bf16 v[128:131], a[12:15], a[32:35], 0
    s_lshl_b32 s42, s42, 8
    buffer_load_dwordx4 v40, s[16:19], s36 offen offset:0 lds
    v_mfma_f32_16x16x32_bf16 v[132:135], a[16:19], a[32:35], 0
    s_add_u32 s42, s42, s6
    ds_read_b64_tr_b16 a[66:67], v54 offset:9216
    v_mfma_f32_16x16x32_bf16 v[164:167], a[16:19], a[36:39], 0
    s_cmp_lt_u32 s42, 80
    s_cselect_b32 s40, s41, s40
    s_cselect_b32 s41, -1, 0
    ds_read_b64_tr_b16 a[68:69], v55 offset:8192
    v_mov_b32 v28, s41
    v_lshlrev_b32 v29, 2, v19
    v_mfma_f32_16x16x32_bf16 v[196:199], a[16:19], a[40:43], 0
    buffer_load_dwordx4 v41, s[16:19], s36 offen offset:1024 lds
    s_mov_b32 exec_hi, 0
    buffer_store_dword v28, v29, s[76:79], s40 offen sc1
    s_mov_b32 exec_hi, -1
    v_lshlrev_b32 v80, 16, v60
    v_and_b32 v81, 0xffff0000, v60
    v_lshlrev_b32 v82, 16, v61
    v_and_b32 v83, 0xffff0000, v61
    v_lshlrev_b32 v84, 16, v62
    v_and_b32 v85, 0xffff0000, v62
    v_mfma_f32_16x16x32_bf16 v[228:231], a[16:19], a[44:47], 0
    ds_read_b64_tr_b16 a[70:71], v55 offset:9216
    v_lshlrev_b32 v86, 16, v63
    v_mfma_f32_16x16x32_bf16 v[232:235], a[20:23], a[44:47], 0
    ds_read_b64_tr_b16 a[72:73], v56 offset:8192
    v_and_b32 v87, 0xffff0000, v63
    v_lshlrev_b32 v88, 16, v64
    v_mfma_f32_16x16x32_bf16 v[200:203], a[20:23], a[40:43], 0
    ds_read_b64_tr_b16 a[74:75], v56 offset:9216
    v_and_b32 v89, 0xffff0000, v64
    v_mfma_f32_16x16x32_bf16 v[168:171], a[20:23], a[36:39], 0
    buffer_load_dwordx4 v42, s[16:19], s36 offen offset:2048 lds
    v_lshlrev_b32 v90, 16, v65
    v_mfma_f32_16x16x32_bf16 v[136:139], a[20:23], a[32:35], 0
    ds_read_b64_tr_b16 a[76:77], v57 offset:8192
    v_and_b32 v91, 0xffff0000, v65
    v_lshlrev_b32 v92, 16, v66
    v_mfma_f32_16x16x32_bf16 v[140:143], a[24:27], a[32:35], 0
    ds_read_b64_tr_b16 a[78:79], v57 offset:9216
    v_and_b32 v93, 0xffff0000, v66
    v_mfma_f32_16x16x32_bf16 v[172:175], a[24:27], a[36:39], 0
    v_lshlrev_b32 v94, 16, v67
    v_and_b32 v95, 0xffff0000, v67
    v_mfma_f32_16x16x32_bf16 v[204:207], a[24:27], a[40:43], 0
    buffer_load_dwordx4 v43, s[16:19], s36 offen offset:3072 lds
    v_lshlrev_b32 v96, 16, v68
    v_mfma_f32_16x16x32_bf16 v[236:239], a[24:27], a[44:47], 0
    v_and_b32 v97, 0xffff0000, v68
    v_lshlrev_b32 v98, 16, v69
    v_mfma_f32_16x16x32_bf16 v[240:243], a[28:31], a[44:47], 0
    v_and_b32 v99, 0xffff0000, v69
    v_add_f32 v109, v80, v81
    v_mfma_f32_16x16x32_bf16 v[208:211], a[28:31], a[40:43], 0
    v_add_f32 v110, v82, v83
    v_add_f32 v109, v109, v84
    v_mfma_f32_16x16x32_bf16 v[176:179], a[28:31], a[36:39], 0
    v_add_f32 v110, v110, v85
    v_add_f32 v109, v109, v86
    v_mfma_f32_16x16x32_bf16 v[144:147], a[28:31], a[32:35], 0
    v_add_f32 v110, v110, v87
    v_add_f32 v109, v109, v88
    s_waitcnt vmcnt(13) lgkmcnt(0)
    s_barrier
    v_mfma_f32_16x16x32_bf16 v[100:103], a[48:51], v[32:35], v[100:103]
    ds_read_b64_tr_b16 a[0:1], v50 offset:16384
    v_add_f32 v110, v110, v89
    v_mfma_f32_16x16x32_bf16 v[104:107], a[52:55], v[32:35], v[104:107]
    s_add_u32 m0, s39, 0
    s_mov_b32 s37, 1572864
    ds_read_b64_tr_b16 a[2:3], v50 offset:17408
    v_add_f32 v109, v109, v90
    v_mfma_f32_16x16x32_bf16 v[116:119], a[48:51], a[80:83], v[116:119]
    buffer_load_dwordx4 v44, s[20:23], s37 offen offset:0 lds
    v_mfma_f32_16x16x32_bf16 v[148:151], a[48:51], a[84:87], v[148:151]
    ds_read_b128 a[32:35], v48 offset:8192
    v_add_f32 v110, v110, v91
    v_mfma_f32_16x16x32_bf16 v[180:183], a[48:51], a[88:91], v[180:183]
    ds_read_b128 a[36:39], v48 offset:10240
    v_add_f32 v109, v109, v92
    v_mfma_f32_16x16x32_bf16 v[212:215], a[48:51], a[92:95], v[212:215]
    ds_read_b128 a[40:43], v48 offset:12288
    v_add_f32 v110, v110, v93
    v_mfma_f32_16x16x32_bf16 v[216:219], a[52:55], a[92:95], v[216:219]
    ds_read_b128 a[44:47], v48 offset:14336
    v_add_f32 v109, v109, v94
    v_mfma_f32_16x16x32_bf16 v[184:187], a[52:55], a[88:91], v[184:187]
    buffer_load_dwordx4 v45, s[20:23], s37 offen offset:1024 lds
    v_add_f32 v110, v110, v95
    v_mfma_f32_16x16x32_bf16 v[152:155], a[52:55], a[84:87], v[152:155]
    ds_read_b64_tr_b16 a[4:5], v51 offset:16384
    v_add_f32 v109, v109, v96
    v_add_f32 v110, v110, v97
    v_mfma_f32_16x16x32_bf16 v[120:123], a[52:55], a[80:83], v[120:123]
    ds_read_b64_tr_b16 a[6:7], v51 offset:17408
    v_add_f32 v109, v109, v98
    v_mfma_f32_16x16x32_bf16 v[124:127], a[56:59], a[80:83], v[124:127]
    ds_read_b64_tr_b16 a[8:9], v52 offset:16384
    v_add_f32 v110, v110, v99
    v_mfma_f32_16x16x32_bf16 v[156:159], a[56:59], a[84:87], v[156:159]
    ds_read_b64_tr_b16 a[10:11], v52 offset:17408
    v_add_f32 v109, v109, v110
    v_mfma_f32_16x16x32_bf16 v[188:191], a[56:59], a[88:91], v[188:191]
    buffer_load_dwordx4 v46, s[20:23], s37 offen offset:2048 lds
    v_add_f32_dpp v109, v109, v109 quad_perm:[1,0,3,2] row_mask:0xf bank_mask:0xf
    v_mfma_f32_16x16x32_bf16 v[220:223], a[56:59], a[92:95], v[220:223]
    ds_read_b64_tr_b16 a[12:13], v53 offset:16384
    v_add_f32_dpp v109, v109, v109 quad_perm:[2,3,0,1] row_mask:0xf bank_mask:0xf
    v_mfma_f32_16x16x32_bf16 v[224:227], a[60:63], a[92:95], v[224:227]
    ds_read_b64_tr_b16 a[14:15], v53 offset:17408
    v_add_f32_dpp v109, v109, v109 row_half_mirror row_mask:0xf bank_mask:0xf
    v_mfma_f32_16x16x32_bf16 v[192:195], a[60:63], a[88:91], v[192:195]
    ds_read_b64_tr_b16 a[16:17], v54 offset:16384
    v_add_f32_dpp v109, v109, v109 row_mirror row_mask:0xf bank_mask:0xf
    v_mov_b32 v110, v109
    v_mfma_f32_16x16x32_bf16 v[160:163], a[60:63], a[84:87], v[160:163]
    ds_read_b64_tr_b16 a[18:19], v54 offset:17408
    v_permlane16_swap_b32 v109, v110
    v_add_f32 v109, v109, v110
    v_mul_f32 v111, 0x3acccccd, v109
    v_mfma_f32_16x16x32_bf16 v[128:131], a[60:63], a[80:83], v[128:131]
    buffer_load_dwordx4 v47, s[20:23], s37 offen offset:3072 lds
    v_sub_f32 v60, v80, v111
    v_mfma_f32_16x16x32_bf16 v[132:135], a[64:67], a[80:83], v[132:135]
    ds_read_b64_tr_b16 a[20:21], v55 offset:16384
    v_mul_f32 v109, v60, v60
    v_mfma_f32_16x16x32_bf16 v[164:167], a[64:67], a[84:87], v[164:167]
    ds_read_b64_tr_b16 a[22:23], v55 offset:17408
    v_sub_f32 v61, v81, v111
    v_mul_f32 v112, v61, v61
    v_mfma_f32_16x16x32_bf16 v[196:199], a[64:67], a[88:91], v[196:199]
    ds_read_b64_tr_b16 a[24:25], v56 offset:16384
    v_sub_f32 v60, v82, v111
    v_mfma_f32_16x16x32_bf16 v[228:231], a[64:67], a[92:95], v[228:231]
    s_add_u32 m0, s38, 0
    s_mov_b32 s36, 384
    ds_read_b64_tr_b16 a[26:27], v56 offset:17408
    v_fmac_f32 v109, v60, v60
    v_mfma_f32_16x16x32_bf16 v[232:235], a[68:71], a[92:95], v[232:235]
    buffer_load_dwordx4 v36, s[16:19], s36 offen offset:0 lds
    v_sub_f32 v61, v83, v111
    v_fmac_f32 v112, v61, v61
    v_mfma_f32_16x16x32_bf16 v[200:203], a[68:71], a[88:91], v[200:203]
    ds_read_b64_tr_b16 a[28:29], v57 offset:16384
    v_sub_f32 v60, v84, v111
    v_mfma_f32_16x16x32_bf16 v[168:171], a[68:71], a[84:87], v[168:171]
    ds_read_b64_tr_b16 a[30:31], v57 offset:17408
    v_fmac_f32 v109, v60, v60
    v_mfma_f32_16x16x32_bf16 v[136:139], a[68:71], a[80:83], v[136:139]
    v_sub_f32 v61, v85, v111
    v_fmac_f32 v112, v61, v61
    v_mfma_f32_16x16x32_bf16 v[140:143], a[72:75], a[80:83], v[140:143]
    v_sub_f32 v60, v86, v111
    v_fmac_f32 v109, v60, v60
    v_mfma_f32_16x16x32_bf16 v[172:175], a[72:75], a[84:87], v[172:175]
    buffer_load_dwordx4 v37, s[16:19], s36 offen offset:1024 lds
    v_sub_f32 v61, v87, v111
    v_mfma_f32_16x16x32_bf16 v[204:207], a[72:75], a[88:91], v[204:207]
    v_fmac_f32 v112, v61, v61
    v_sub_f32 v60, v88, v111
    v_mfma_f32_16x16x32_bf16 v[236:239], a[72:75], a[92:95], v[236:239]
    v_fmac_f32 v109, v60, v60
    v_sub_f32 v61, v89, v111
    v_mfma_f32_16x16x32_bf16 v[240:243], a[76:79], a[92:95], v[240:243]
    v_fmac_f32 v112, v61, v61
    v_sub_f32 v60, v90, v111
    v_mfma_f32_16x16x32_bf16 v[208:211], a[76:79], a[88:91], v[208:211]
    v_fmac_f32 v109, v60, v60
    v_sub_f32 v61, v91, v111
    v_mfma_f32_16x16x32_bf16 v[176:179], a[76:79], a[84:87], v[176:179]
    v_fmac_f32 v112, v61, v61
    v_sub_f32 v60, v92, v111
    v_mfma_f32_16x16x32_bf16 v[144:147], a[76:79], a[80:83], v[144:147]
    v_fmac_f32 v109, v60, v60
    v_sub_f32 v61, v93, v111
    s_waitcnt lgkmcnt(0)
    v_mfma_f32_16x16x32_bf16 v[100:103], a[0:3], v[32:35], v[100:103]
    ds_read_b64_tr_b16 a[48:49], v50 offset:24576
    v_fmac_f32 v112, v61, v61
    v_mfma_f32_16x16x32_bf16 v[104:107], a[4:7], v[32:35], v[104:107]
    ds_read_b64_tr_b16 a[50:51], v50 offset:25600
    v_sub_f32 v60, v94, v111
    v_mfma_f32_16x16x32_bf16 v[116:119], a[0:3], a[32:35], v[116:119]
    buffer_load_dwordx4 v38, s[16:19], s36 offen offset:2048 lds
    v_mfma_f32_16x16x32_bf16 v[148:151], a[0:3], a[36:39], v[148:151]
    ds_read_b128 a[80:83], v49 offset:8192
    v_fmac_f32 v109, v60, v60
    v_mfma_f32_16x16x32_bf16 v[180:183], a[0:3], a[40:43], v[180:183]
    ds_read_b128 a[84:87], v49 offset:10240
    v_sub_f32 v61, v95, v111
    v_mfma_f32_16x16x32_bf16 v[212:215], a[0:3], a[44:47], v[212:215]
    ds_read_b128 a[88:91], v49 offset:12288
    v_fmac_f32 v112, v61, v61
    v_mfma_f32_16x16x32_bf16 v[216:219], a[4:7], a[44:47], v[216:219]
    ds_read_b128 a[92:95], v49 offset:14336
    v_sub_f32 v60, v96, v111
    v_mfma_f32_16x16x32_bf16 v[184:187], a[4:7], a[40:43], v[184:187]
    buffer_load_dwordx4 v39, s[16:19], s36 offen offset:3072 lds
    v_fmac_f32 v109, v60, v60
    v_mfma_f32_16x16x32_bf16 v[152:155], a[4:7], a[36:39], v[152:155]
    ds_read_b64_tr_b16 a[52:53], v51 offset:24576
    v_sub_f32 v61, v97, v111
    v_mfma_f32_16x16x32_bf16 v[120:123], a[4:7], a[32:35], v[120:123]
    ds_read_b64_tr_b16 a[54:55], v51 offset:25600
    v_fmac_f32 v112, v61, v61
    v_mfma_f32_16x16x32_bf16 v[124:127], a[8:11], a[32:35], v[124:127]
    ds_read_b64_tr_b16 a[56:57], v52 offset:24576
    v_sub_f32 v60, v98, v111
    v_mfma_f32_16x16x32_bf16 v[156:159], a[8:11], a[36:39], v[156:159]
    s_add_u32 m0, s38, 4096
    ds_read_b64_tr_b16 a[58:59], v52 offset:25600
    v_fmac_f32 v109, v60, v60
    v_sub_f32 v61, v99, v111
    v_mfma_f32_16x16x32_bf16 v[188:191], a[8:11], a[40:43], v[188:191]
    buffer_load_dwordx4 v40, s[16:19], s36 offen offset:0 lds
    v_fmac_f32 v112, v61, v61
    v_mfma_f32_16x16x32_bf16 v[220:223], a[8:11], a[44:47], v[220:223]
    ds_read_b64_tr_b16 a[60:61], v53 offset:24576
    v_add_f32 v109, v109, v112
    v_mfma_f32_16x16x32_bf16 v[224:227], a[12:15], a[44:47], v[224:227]
    ds_read_b64_tr_b16 a[62:63], v53 offset:25600
    v_add_f32_dpp v109, v109, v109 quad_perm:[1,0,3,2] row_mask:0xf bank_mask:0xf
    v_mfma_f32_16x16x32_bf16 v[192:195], a[12:15], a[40:43], v[192:195]
    ds_read_b64_tr_b16 a[64:65], v54 offset:24576
    v_add_f32_dpp v109, v109, v109 quad_perm:[2,3,0,1] row_mask:0xf bank_mask:0xf
    v_mfma_f32_16x16x32_bf16 v[160:163], a[12:15], a[36:39], v[160:163]
    ds_read_b64_tr_b16 a[66:67], v54 offset:25600
    v_add_f32_dpp v109, v109, v109 row_half_mirror row_mask:0xf bank_mask:0xf
    v_mfma_f32_16x16x32_bf16 v[128:131], a[12:15], a[32:35], v[128:131]
    buffer_load_dwordx4 v41, s[16:19], s36 offen offset:1024 lds
    v_add_f32_dpp v109, v109, v109 row_mirror row_mask:0xf bank_mask:0xf
    v_mov_b32 v110, v109
    v_mfma_f32_16x16x32_bf16 v[132:135], a[16:19], a[32:35], v[132:135]
    ds_read_b64_tr_b16 a[68:69], v55 offset:24576
    v_permlane16_swap_b32 v109, v110
    v_add_f32 v109, v109, v110
    v_mfma_f32_16x16x32_bf16 v[164:167], a[16:19], a[36:39], v[164:167]
    ds_read_b64_tr_b16 a[70:71], v55 offset:25600
    v_mul_f32 v109, 0x3acccccd, v109
    v_cvt_pk_bf16_f32 v110, v111, v109
    v_mfma_f32_16x16x32_bf16 v[196:199], a[16:19], a[40:43], v[196:199]
    ds_read_b64_tr_b16 a[72:73], v56 offset:24576
    v_lshlrev_b32 v111, 16, v110
    v_mfma_f32_16x16x32_bf16 v[228:231], a[16:19], a[44:47], v[228:231]
    ds_read_b64_tr_b16 a[74:75], v56 offset:25600
    v_and_b32 v109, 0xffff0000, v110
    v_mfma_f32_16x16x32_bf16 v[232:235], a[20:23], a[44:47], v[232:235]
    buffer_load_dwordx4 v42, s[16:19], s36 offen offset:2048 lds
    v_add_f32 v109, 0x3727c5ac, v109
    v_cvt_pk_bf16_f32 v109, v109, v109
    v_mfma_f32_16x16x32_bf16 v[200:203], a[20:23], a[40:43], v[200:203]
    ds_read_b64_tr_b16 a[76:77], v57 offset:24576
    v_lshlrev_b32 v109, 16, v109
    v_mfma_f32_16x16x32_bf16 v[168:171], a[20:23], a[36:39], v[168:171]
    ds_read_b64_tr_b16 a[78:79], v57 offset:25600
    v_sqrt_f32 v109, v109
    v_mfma_f32_16x16x32_bf16 v[136:139], a[20:23], a[32:35], v[136:139]
    v_sub_f32 v80, v80, v111
    v_sub_f32 v81, v81, v111
    v_mfma_f32_16x16x32_bf16 v[140:143], a[24:27], a[32:35], v[140:143]
    v_sub_f32 v82, v82, v111
    v_sub_f32 v83, v83, v111
    v_mfma_f32_16x16x32_bf16 v[172:175], a[24:27], a[36:39], v[172:175]
    buffer_load_dwordx4 v43, s[16:19], s36 offen offset:3072 lds
    v_sub_f32 v84, v84, v111
    v_mfma_f32_16x16x32_bf16 v[204:207], a[24:27], a[40:43], v[204:207]
    v_sub_f32 v85, v85, v111
    v_sub_f32 v86, v86, v111
    v_mfma_f32_16x16x32_bf16 v[236:239], a[24:27], a[44:47], v[236:239]
    v_sub_f32 v87, v87, v111
    v_sub_f32 v88, v88, v111
    v_mfma_f32_16x16x32_bf16 v[240:243], a[28:31], a[44:47], v[240:243]
    v_sub_f32 v89, v89, v111
    v_sub_f32 v90, v90, v111
    v_mfma_f32_16x16x32_bf16 v[208:211], a[28:31], a[40:43], v[208:211]
    v_sub_f32 v91, v91, v111
    v_sub_f32 v92, v92, v111
    v_mfma_f32_16x16x32_bf16 v[176:179], a[28:31], a[36:39], v[176:179]
    v_sub_f32 v93, v93, v111
    v_sub_f32 v94, v94, v111
    v_mfma_f32_16x16x32_bf16 v[144:147], a[28:31], a[32:35], v[144:147]
    v_sub_f32 v95, v95, v111
    v_sub_f32 v96, v96, v111
    s_waitcnt vmcnt(12) lgkmcnt(0)
    s_barrier
    v_mfma_f32_16x16x32_bf16 v[100:103], a[48:51], v[32:35], v[100:103]
    ds_read_b64_tr_b16 a[0:1], v50 offset:32768
    v_sub_f32 v97, v97, v111
    v_mfma_f32_16x16x32_bf16 v[104:107], a[52:55], v[32:35], v[104:107]
    s_add_u32 m0, s39, 16384
    s_mov_b32 s37, 2097152
    ds_read_b64_tr_b16 a[2:3], v50 offset:33792
    v_sub_f32 v98, v98, v111
    v_mfma_f32_16x16x32_bf16 v[116:119], a[48:51], a[80:83], v[116:119]
    buffer_load_dwordx4 v44, s[20:23], s37 offen offset:0 lds
    v_mfma_f32_16x16x32_bf16 v[148:151], a[48:51], a[84:87], v[148:151]
    ds_read_b128 a[32:35], v48 offset:16384
    v_sub_f32 v99, v99, v111
    v_mfma_f32_16x16x32_bf16 v[180:183], a[48:51], a[88:91], v[180:183]
    ds_read_b128 a[36:39], v48 offset:18432
    v_cvt_pk_bf16_f32 v109, v109, v109
    v_mfma_f32_16x16x32_bf16 v[212:215], a[48:51], a[92:95], v[212:215]
    ds_read_b128 a[40:43], v48 offset:20480
    v_lshlrev_b32 v109, 16, v109
    v_mfma_f32_16x16x32_bf16 v[216:219], a[52:55], a[92:95], v[216:219]
    ds_read_b128 a[44:47], v48 offset:22528
    v_rcp_f32 v112, v109
    v_mfma_f32_16x16x32_bf16 v[184:187], a[52:55], a[88:91], v[184:187]
    buffer_load_dwordx4 v45, s[20:23], s37 offen offset:1024 lds
    v_cvt_pk_bf16_f32 v60, v80, v81
    v_mfma_f32_16x16x32_bf16 v[152:155], a[52:55], a[84:87], v[152:155]
    ds_read_b64_tr_b16 a[4:5], v51 offset:32768
    v_cvt_pk_bf16_f32 v61, v82, v83
    v_mfma_f32_16x16x32_bf16 v[120:123], a[52:55], a[80:83], v[120:123]
    ds_read_b64_tr_b16 a[6:7], v51 offset:33792
    v_cvt_pk_bf16_f32 v62, v84, v85
    v_mfma_f32_16x16x32_bf16 v[124:127], a[56:59], a[80:83], v[124:127]
    ds_read_b64_tr_b16 a[8:9], v52 offset:32768
    v_cvt_pk_bf16_f32 v63, v86, v87
    v_mfma_f32_16x16x32_bf16 v[156:159], a[56:59], a[84:87], v[156:159]
    ds_read_b64_tr_b16 a[10:11], v52 offset:33792
    v_cvt_pk_bf16_f32 v64, v88, v89
    v_cvt_pk_bf16_f32 v65, v90, v91
    v_mfma_f32_16x16x32_bf16 v[188:191], a[56:59], a[88:91], v[188:191]
    buffer_load_dwordx4 v46, s[20:23], s37 offen offset:2048 lds
    v_cvt_pk_bf16_f32 v66, v92, v93
    v_mfma_f32_16x16x32_bf16 v[220:223], a[56:59], a[92:95], v[220:223]
    ds_read_b64_tr_b16 a[12:13], v53 offset:32768
    v_cvt_pk_bf16_f32 v67, v94, v95
    v_mfma_f32_16x16x32_bf16 v[224:227], a[60:63], a[92:95], v[224:227]
    ds_read_b64_tr_b16 a[14:15], v53 offset:33792
    v_cvt_pk_bf16_f32 v68, v96, v97
    v_cvt_pk_bf16_f32 v69, v98, v99
    v_mfma_f32_16x16x32_bf16 v[192:195], a[60:63], a[88:91], v[192:195]
    ds_read_b64_tr_b16 a[16:17], v54 offset:32768
    v_lshlrev_b32 v80, 16, v60
    v_mfma_f32_16x16x32_bf16 v[160:163], a[60:63], a[84:87], v[160:163]
    ds_read_b64_tr_b16 a[18:19], v54 offset:33792
    v_and_b32 v81, 0xffff0000, v60
    v_lshlrev_b32 v82, 16, v61
    v_mfma_f32_16x16x32_bf16 v[128:131], a[60:63], a[80:83], v[128:131]
    buffer_load_dwordx4 v47, s[20:23], s37 offen offset:3072 lds
    v_and_b32 v83, 0xffff0000, v61
    v_mfma_f32_16x16x32_bf16 v[132:135], a[64:67], a[80:83], v[132:135]
    ds_read_b64_tr_b16 a[20:21], v55 offset:32768
    v_lshlrev_b32 v84, 16, v62
    v_mfma_f32_16x16x32_bf16 v[164:167], a[64:67], a[84:87], v[164:167]
    ds_read_b64_tr_b16 a[22:23], v55 offset:33792
    v_and_b32 v85, 0xffff0000, v62
    v_lshlrev_b32 v86, 16, v63
    v_mfma_f32_16x16x32_bf16 v[196:199], a[64:67], a[88:91], v[196:199]
    ds_read_b64_tr_b16 a[24:25], v56 offset:32768
    v_and_b32 v87, 0xffff0000, v63
    v_mfma_f32_16x16x32_bf16 v[228:231], a[64:67], a[92:95], v[228:231]
    s_add_u32 m0, s38, 8192
    s_mov_b32 s36, 512
    ds_read_b64_tr_b16 a[26:27], v56 offset:33792
    v_lshlrev_b32 v88, 16, v64
    v_mfma_f32_16x16x32_bf16 v[232:235], a[68:71], a[92:95], v[232:235]
    buffer_load_dwordx4 v36, s[16:19], s36 offen offset:0 lds
    v_and_b32 v89, 0xffff0000, v64
    v_lshlrev_b32 v90, 16, v65
    v_mfma_f32_16x16x32_bf16 v[200:203], a[68:71], a[88:91], v[200:203]
    ds_read_b64_tr_b16 a[28:29], v57 offset:32768
    v_and_b32 v91, 0xffff0000, v65
    v_mfma_f32_16x16x32_bf16 v[168:171], a[68:71], a[84:87], v[168:171]
    ds_read_b64_tr_b16 a[30:31], v57 offset:33792
    v_lshlrev_b32 v92, 16, v66
    v_mfma_f32_16x16x32_bf16 v[136:139], a[68:71], a[80:83], v[136:139]
    v_and_b32 v93, 0xffff0000, v66
    v_lshlrev_b32 v94, 16, v67
    v_mfma_f32_16x16x32_bf16 v[140:143], a[72:75], a[80:83], v[140:143]
    v_and_b32 v95, 0xffff0000, v67
    v_lshlrev_b32 v96, 16, v68
    v_mfma_f32_16x16x32_bf16 v[172:175], a[72:75], a[84:87], v[172:175]
    buffer_load_dwordx4 v37, s[16:19], s36 offen offset:1024 lds
    v_and_b32 v97, 0xffff0000, v68
    v_mfma_f32_16x16x32_bf16 v[204:207], a[72:75], a[88:91], v[204:207]
    v_lshlrev_b32 v98, 16, v69
    v_and_b32 v99, 0xffff0000, v69
    v_mfma_f32_16x16x32_bf16 v[236:239], a[72:75], a[92:95], v[236:239]
    v_mul_f32 v80, v80, v112
    v_mul_f32 v81, v81, v112
    v_mfma_f32_16x16x32_bf16 v[240:243], a[76:79], a[92:95], v[240:243]
    v_mul_f32 v82, v82, v112
    v_mul_f32 v83, v83, v112
    v_mfma_f32_16x16x32_bf16 v[208:211], a[76:79], a[88:91], v[208:211]
    v_mul_f32 v84, v84, v112
    v_mul_f32 v85, v85, v112
    v_mfma_f32_16x16x32_bf16 v[176:179], a[76:79], a[84:87], v[176:179]
    v_mul_f32 v86, v86, v112
    v_mul_f32 v87, v87, v112
    v_mfma_f32_16x16x32_bf16 v[144:147], a[76:79], a[80:83], v[144:147]
    v_mul_f32 v88, v88, v112
    v_mul_f32 v89, v89, v112
    s_waitcnt lgkmcnt(0)
    v_mfma_f32_16x16x32_bf16 v[100:103], a[0:3], v[32:35], v[100:103]
    ds_read_b64_tr_b16 a[48:49], v50 offset:40960
    v_mul_f32 v90, v90, v112
    v_mfma_f32_16x16x32_bf16 v[104:107], a[4:7], v[32:35], v[104:107]
    ds_read_b64_tr_b16 a[50:51], v50 offset:41984
    v_mul_f32 v91, v91, v112
    v_mfma_f32_16x16x32_bf16 v[116:119], a[0:3], a[32:35], v[116:119]
    buffer_load_dwordx4 v38, s[16:19], s36 offen offset:2048 lds
    v_mfma_f32_16x16x32_bf16 v[148:151], a[0:3], a[36:39], v[148:151]
    ds_read_b128 a[80:83], v49 offset:16384
    v_mul_f32 v92, v92, v112
    v_mfma_f32_16x16x32_bf16 v[180:183], a[0:3], a[40:43], v[180:183]
    ds_read_b128 a[84:87], v49 offset:18432
    v_mul_f32 v93, v93, v112
    v_mfma_f32_16x16x32_bf16 v[212:215], a[0:3], a[44:47], v[212:215]
    ds_read_b128 a[88:91], v49 offset:20480
    v_mul_f32 v94, v94, v112
    v_mfma_f32_16x16x32_bf16 v[216:219], a[4:7], a[44:47], v[216:219]
    ds_read_b128 a[92:95], v49 offset:22528
    v_mul_f32 v95, v95, v112
    v_mfma_f32_16x16x32_bf16 v[184:187], a[4:7], a[40:43], v[184:187]
    buffer_load_dwordx4 v39, s[16:19], s36 offen offset:3072 lds
    v_mul_f32 v96, v96, v112
    v_mfma_f32_16x16x32_bf16 v[152:155], a[4:7], a[36:39], v[152:155]
    ds_read_b64_tr_b16 a[52:53], v51 offset:40960
    v_mul_f32 v97, v97, v112
    v_mfma_f32_16x16x32_bf16 v[120:123], a[4:7], a[32:35], v[120:123]
    ds_read_b64_tr_b16 a[54:55], v51 offset:41984
    v_mul_f32 v98, v98, v112
    v_mfma_f32_16x16x32_bf16 v[124:127], a[8:11], a[32:35], v[124:127]
    ds_read_b64_tr_b16 a[56:57], v52 offset:40960
    v_mul_f32 v99, v99, v112
    v_mfma_f32_16x16x32_bf16 v[156:159], a[8:11], a[36:39], v[156:159]
    s_add_u32 m0, s38, 12288
    ds_read_b64_tr_b16 a[58:59], v52 offset:41984
    v_cvt_pk_bf16_f32 v60, v80, v81
    v_cvt_pk_bf16_f32 v61, v82, v83
    v_mfma_f32_16x16x32_bf16 v[188:191], a[8:11], a[40:43], v[188:191]
    buffer_load_dwordx4 v40, s[16:19], s36 offen offset:0 lds
    v_cvt_pk_bf16_f32 v62, v84, v85
    v_mfma_f32_16x16x32_bf16 v[220:223], a[8:11], a[44:47], v[220:223]
    ds_read_b64_tr_b16 a[60:61], v53 offset:40960
    v_cvt_pk_bf16_f32 v63, v86, v87
    v_mfma_f32_16x16x32_bf16 v[224:227], a[12:15], a[44:47], v[224:227]
    ds_read_b64_tr_b16 a[62:63], v53 offset:41984
    v_cvt_pk_bf16_f32 v64, v88, v89
    v_cvt_pk_bf16_f32 v65, v90, v91
    v_mfma_f32_16x16x32_bf16 v[192:195], a[12:15], a[40:43], v[192:195]
    ds_read_b64_tr_b16 a[64:65], v54 offset:40960
    v_cvt_pk_bf16_f32 v66, v92, v93
    v_mfma_f32_16x16x32_bf16 v[160:163], a[12:15], a[36:39], v[160:163]
    ds_read_b64_tr_b16 a[66:67], v54 offset:41984
    v_cvt_pk_bf16_f32 v67, v94, v95
    v_cvt_pk_bf16_f32 v68, v96, v97
    v_mfma_f32_16x16x32_bf16 v[128:131], a[12:15], a[32:35], v[128:131]
    buffer_load_dwordx4 v41, s[16:19], s36 offen offset:1024 lds
    v_cvt_pk_bf16_f32 v69, v98, v99
    v_mfma_f32_16x16x32_bf16 v[132:135], a[16:19], a[32:35], v[132:135]
    ds_read_b64_tr_b16 a[68:69], v55 offset:40960
    v_mov_b32 v109, 0
    v_mfma_f32_16x16x32_bf16 v[164:167], a[16:19], a[36:39], v[164:167]
    ds_read_b64_tr_b16 a[70:71], v55 offset:41984
    v_dot2c_f32_bf16 v109, v60, v70
    v_dot2c_f32_bf16 v109, v61, v71
    v_dot2c_f32_bf16 v109, v62, v72
    v_dot2c_f32_bf16 v109, v63, v73
    v_dot2c_f32_bf16 v109, v64, v74
    v_dot2c_f32_bf16 v109, v65, v75
    v_dot2c_f32_bf16 v109, v66, v76
    v_dot2c_f32_bf16 v109, v67, v77
    v_dot2c_f32_bf16 v109, v68, v78
    v_dot2c_f32_bf16 v109, v69, v79
    s_nop 2
    v_mfma_f32_16x16x32_bf16 v[196:199], a[16:19], a[40:43], v[196:199]
    ds_read_b64_tr_b16 a[72:73], v56 offset:40960
    v_add_f32_dpp v109, v109, v109 quad_perm:[1,0,3,2] row_mask:0xf bank_mask:0xf
    v_mfma_f32_16x16x32_bf16 v[228:231], a[16:19], a[44:47], v[228:231]
    ds_read_b64_tr_b16 a[74:75], v56 offset:41984
    v_add_f32_dpp v109, v109, v109 quad_perm:[2,3,0,1] row_mask:0xf bank_mask:0xf
    v_mfma_f32_16x16x32_bf16 v[232:235], a[20:23], a[44:47], v[232:235]
    buffer_load_dwordx4 v42, s[16:19], s36 offen offset:2048 lds
    v_add_f32_dpp v109, v109, v109 row_half_mirror row_mask:0xf bank_mask:0xf
    v_mfma_f32_16x16x32_bf16 v[200:203], a[20:23], a[40:43], v[200:203]
    ds_read_b64_tr_b16 a[76:77], v57 offset:40960
    v_add_f32_dpp v109, v109, v109 row_mirror row_mask:0xf bank_mask:0xf
    v_mov_b32 v110, v109
    v_mfma_f32_16x16x32_bf16 v[168:171], a[20:23], a[36:39], v[168:171]
    ds_read_b64_tr_b16 a[78:79], v57 offset:41984
    v_permlane16_swap_b32 v109, v110
    v_add_f32 v109, v109, v110
    v_mfma_f32_16x16x32_bf16 v[136:139], a[20:23], a[32:35], v[136:139]
    v_cvt_pk_bf16_f32 v109, v109, v109
    v_lshlrev_b32 v109, 16, v109
    v_mfma_f32_16x16x32_bf16 v[140:143], a[24:27], a[32:35], v[140:143]
    v_ashrrev_i32 v110, 31, v109
    v_or_b32 v110, 0x80000000, v110
    v_mfma_f32_16x16x32_bf16 v[172:175], a[24:27], a[36:39], v[172:175]
    buffer_load_dwordx4 v43, s[16:19], s36 offen offset:3072 lds
    v_xor_b32 v109, v109, v110
    v_mfma_f32_16x16x32_bf16 v[204:207], a[24:27], a[40:43], v[204:207]
    v_and_b32 v109, 0xffff0000, v109
    v_sub_u32 v110, 0xffff, v108
    v_mfma_f32_16x16x32_bf16 v[236:239], a[24:27], a[44:47], v[236:239]
    v_or_b32 v62, v109, v110
    v_mov_b32 v60, v111
    v_mfma_f32_16x16x32_bf16 v[240:243], a[28:31], a[44:47], v[240:243]
    v_mov_b32 v61, v112
    v_mov_b32 v63, 0
    v_mfma_f32_16x16x32_bf16 v[208:211], a[28:31], a[40:43], v[208:211]
    v_lshlrev_b32 v110, 4, v108
    v_mfma_f32_16x16x32_bf16 v[176:179], a[28:31], a[36:39], v[176:179]
    s_mov_b32 s40, 0x280000
    s_mov_b32 exec_lo, 1
    s_mov_b32 exec_hi, 1
    buffer_store_dwordx4 v[60:63], v110, s[76:79], s40 offen sc1
    s_mov_b64 exec, -1
    v_mfma_f32_16x16x32_bf16 v[144:147], a[28:31], a[32:35], v[144:147]
    s_waitcnt vmcnt(13) lgkmcnt(0)
    s_barrier
    v_mfma_f32_16x16x32_bf16 v[100:103], a[48:51], v[32:35], v[100:103]
    ds_read_b64_tr_b16 a[0:1], v50 offset:0
    v_mfma_f32_16x16x32_bf16 v[104:107], a[52:55], v[32:35], v[104:107]
    s_add_u32 m0, s39, 32768
    s_mov_b32 s37, 2621440
    ds_read_b64_tr_b16 a[2:3], v50 offset:1024
    v_mfma_f32_16x16x32_bf16 v[116:119], a[48:51], a[80:83], v[116:119]
    buffer_load_dwordx4 v44, s[20:23], s37 offen offset:0 lds
    v_mfma_f32_16x16x32_bf16 v[148:151], a[48:51], a[84:87], v[148:151]
    ds_read_b128 a[32:35], v48 offset:0
    v_mfma_f32_16x16x32_bf16 v[180:183], a[48:51], a[88:91], v[180:183]
    ds_read_b128 a[36:39], v48 offset:2048
    v_mfma_f32_16x16x32_bf16 v[212:215], a[48:51], a[92:95], v[212:215]
    ds_read_b128 a[40:43], v48 offset:4096
    v_mfma_f32_16x16x32_bf16 v[216:219], a[52:55], a[92:95], v[216:219]
    ds_read_b128 a[44:47], v48 offset:6144
    v_mfma_f32_16x16x32_bf16 v[184:187], a[52:55], a[88:91], v[184:187]
    buffer_load_dwordx4 v45, s[20:23], s37 offen offset:1024 lds
    v_mfma_f32_16x16x32_bf16 v[152:155], a[52:55], a[84:87], v[152:155]
    ds_read_b64_tr_b16 a[4:5], v51 offset:0
    v_mfma_f32_16x16x32_bf16 v[120:123], a[52:55], a[80:83], v[120:123]
    ds_read_b64_tr_b16 a[6:7], v51 offset:1024
    v_mfma_f32_16x16x32_bf16 v[124:127], a[56:59], a[80:83], v[124:127]
    ds_read_b64_tr_b16 a[8:9], v52 offset:0
    v_mfma_f32_16x16x32_bf16 v[156:159], a[56:59], a[84:87], v[156:159]
    ds_read_b64_tr_b16 a[10:11], v52 offset:1024
    v_mfma_f32_16x16x32_bf16 v[188:191], a[56:59], a[88:91], v[188:191]
    buffer_load_dwordx4 v46, s[20:23], s37 offen offset:2048 lds
    v_mfma_f32_16x16x32_bf16 v[220:223], a[56:59], a[92:95], v[220:223]
    ds_read_b64_tr_b16 a[12:13], v53 offset:0
    v_mfma_f32_16x16x32_bf16 v[224:227], a[60:63], a[92:95], v[224:227]
    ds_read_b64_tr_b16 a[14:15], v53 offset:1024
    v_mfma_f32_16x16x32_bf16 v[192:195], a[60:63], a[88:91], v[192:195]
    ds_read_b64_tr_b16 a[16:17], v54 offset:0
    v_mfma_f32_16x16x32_bf16 v[160:163], a[60:63], a[84:87], v[160:163]
    ds_read_b64_tr_b16 a[18:19], v54 offset:1024
    v_mfma_f32_16x16x32_bf16 v[128:131], a[60:63], a[80:83], v[128:131]
    buffer_load_dwordx4 v47, s[20:23], s37 offen offset:3072 lds
    v_mfma_f32_16x16x32_bf16 v[132:135], a[64:67], a[80:83], v[132:135]
    ds_read_b64_tr_b16 a[20:21], v55 offset:0
    v_mfma_f32_16x16x32_bf16 v[164:167], a[64:67], a[84:87], v[164:167]
    ds_read_b64_tr_b16 a[22:23], v55 offset:1024
    v_mfma_f32_16x16x32_bf16 v[196:199], a[64:67], a[88:91], v[196:199]
    ds_read_b64_tr_b16 a[24:25], v56 offset:0
    v_mfma_f32_16x16x32_bf16 v[228:231], a[64:67], a[92:95], v[228:231]
    s_add_u32 m0, s38, 16384
    s_mov_b32 s36, 640
    ds_read_b64_tr_b16 a[26:27], v56 offset:1024
    v_mfma_f32_16x16x32_bf16 v[232:235], a[68:71], a[92:95], v[232:235]
    buffer_load_dwordx4 v36, s[16:19], s36 offen offset:0 lds
    v_mfma_f32_16x16x32_bf16 v[200:203], a[68:71], a[88:91], v[200:203]
    ds_read_b64_tr_b16 a[28:29], v57 offset:0
    v_mfma_f32_16x16x32_bf16 v[168:171], a[68:71], a[84:87], v[168:171]
    ds_read_b64_tr_b16 a[30:31], v57 offset:1024
    v_mfma_f32_16x16x32_bf16 v[136:139], a[68:71], a[80:83], v[136:139]
    v_mfma_f32_16x16x32_bf16 v[140:143], a[72:75], a[80:83], v[140:143]
    v_mfma_f32_16x16x32_bf16 v[172:175], a[72:75], a[84:87], v[172:175]
    buffer_load_dwordx4 v37, s[16:19], s36 offen offset:1024 lds
    v_mfma_f32_16x16x32_bf16 v[204:207], a[72:75], a[88:91], v[204:207]
    v_mfma_f32_16x16x32_bf16 v[236:239], a[72:75], a[92:95], v[236:239]
    v_mfma_f32_16x16x32_bf16 v[240:243], a[76:79], a[92:95], v[240:243]
    v_mfma_f32_16x16x32_bf16 v[208:211], a[76:79], a[88:91], v[208:211]
    v_mfma_f32_16x16x32_bf16 v[176:179], a[76:79], a[84:87], v[176:179]
    v_mfma_f32_16x16x32_bf16 v[144:147], a[76:79], a[80:83], v[144:147]
    s_waitcnt lgkmcnt(0)
    v_mfma_f32_16x16x32_bf16 v[100:103], a[0:3], v[32:35], v[100:103]
    ds_read_b64_tr_b16 a[48:49], v50 offset:8192
    v_mfma_f32_16x16x32_bf16 v[104:107], a[4:7], v[32:35], v[104:107]
    ds_read_b64_tr_b16 a[50:51], v50 offset:9216
    v_mfma_f32_16x16x32_bf16 v[116:119], a[0:3], a[32:35], v[116:119]
    buffer_load_dwordx4 v38, s[16:19], s36 offen offset:2048 lds
    v_mfma_f32_16x16x32_bf16 v[148:151], a[0:3], a[36:39], v[148:151]
    ds_read_b128 a[80:83], v49 offset:0
    v_mfma_f32_16x16x32_bf16 v[180:183], a[0:3], a[40:43], v[180:183]
    ds_read_b128 a[84:87], v49 offset:2048
    v_mfma_f32_16x16x32_bf16 v[212:215], a[0:3], a[44:47], v[212:215]
    ds_read_b128 a[88:91], v49 offset:4096
    v_mfma_f32_16x16x32_bf16 v[216:219], a[4:7], a[44:47], v[216:219]
    ds_read_b128 a[92:95], v49 offset:6144
    v_mfma_f32_16x16x32_bf16 v[184:187], a[4:7], a[40:43], v[184:187]
    buffer_load_dwordx4 v39, s[16:19], s36 offen offset:3072 lds
    v_mfma_f32_16x16x32_bf16 v[152:155], a[4:7], a[36:39], v[152:155]
    ds_read_b64_tr_b16 a[52:53], v51 offset:8192
    v_mfma_f32_16x16x32_bf16 v[120:123], a[4:7], a[32:35], v[120:123]
    ds_read_b64_tr_b16 a[54:55], v51 offset:9216
    v_mfma_f32_16x16x32_bf16 v[124:127], a[8:11], a[32:35], v[124:127]
    ds_read_b64_tr_b16 a[56:57], v52 offset:8192
    v_mfma_f32_16x16x32_bf16 v[156:159], a[8:11], a[36:39], v[156:159]
    s_add_u32 m0, s38, 20480
    ds_read_b64_tr_b16 a[58:59], v52 offset:9216
    v_mfma_f32_16x16x32_bf16 v[188:191], a[8:11], a[40:43], v[188:191]
    buffer_load_dwordx4 v40, s[16:19], s36 offen offset:0 lds
    v_mfma_f32_16x16x32_bf16 v[220:223], a[8:11], a[44:47], v[220:223]
    ds_read_b64_tr_b16 a[60:61], v53 offset:8192
    v_mfma_f32_16x16x32_bf16 v[224:227], a[12:15], a[44:47], v[224:227]
    ds_read_b64_tr_b16 a[62:63], v53 offset:9216
    v_mfma_f32_16x16x32_bf16 v[192:195], a[12:15], a[40:43], v[192:195]
    ds_read_b64_tr_b16 a[64:65], v54 offset:8192
    v_mfma_f32_16x16x32_bf16 v[160:163], a[12:15], a[36:39], v[160:163]
    ds_read_b64_tr_b16 a[66:67], v54 offset:9216
    v_mfma_f32_16x16x32_bf16 v[128:131], a[12:15], a[32:35], v[128:131]
    buffer_load_dwordx4 v41, s[16:19], s36 offen offset:1024 lds
    v_mfma_f32_16x16x32_bf16 v[132:135], a[16:19], a[32:35], v[132:135]
    ds_read_b64_tr_b16 a[68:69], v55 offset:8192
    v_mfma_f32_16x16x32_bf16 v[164:167], a[16:19], a[36:39], v[164:167]
    ds_read_b64_tr_b16 a[70:71], v55 offset:9216
    v_mfma_f32_16x16x32_bf16 v[196:199], a[16:19], a[40:43], v[196:199]
    ds_read_b64_tr_b16 a[72:73], v56 offset:8192
    v_mfma_f32_16x16x32_bf16 v[228:231], a[16:19], a[44:47], v[228:231]
    ds_read_b64_tr_b16 a[74:75], v56 offset:9216
    v_mfma_f32_16x16x32_bf16 v[232:235], a[20:23], a[44:47], v[232:235]
    buffer_load_dwordx4 v42, s[16:19], s36 offen offset:2048 lds
    v_mfma_f32_16x16x32_bf16 v[200:203], a[20:23], a[40:43], v[200:203]
    ds_read_b64_tr_b16 a[76:77], v57 offset:8192
    v_mfma_f32_16x16x32_bf16 v[168:171], a[20:23], a[36:39], v[168:171]
    ds_read_b64_tr_b16 a[78:79], v57 offset:9216
    v_mfma_f32_16x16x32_bf16 v[136:139], a[20:23], a[32:35], v[136:139]
    v_mfma_f32_16x16x32_bf16 v[140:143], a[24:27], a[32:35], v[140:143]
    v_mfma_f32_16x16x32_bf16 v[172:175], a[24:27], a[36:39], v[172:175]
    buffer_load_dwordx4 v43, s[16:19], s36 offen offset:3072 lds
    v_mfma_f32_16x16x32_bf16 v[204:207], a[24:27], a[40:43], v[204:207]
    v_mfma_f32_16x16x32_bf16 v[236:239], a[24:27], a[44:47], v[236:239]
    v_mfma_f32_16x16x32_bf16 v[240:243], a[28:31], a[44:47], v[240:243]
    v_mfma_f32_16x16x32_bf16 v[208:211], a[28:31], a[40:43], v[208:211]
    v_mfma_f32_16x16x32_bf16 v[176:179], a[28:31], a[36:39], v[176:179]
    v_mfma_f32_16x16x32_bf16 v[144:147], a[28:31], a[32:35], v[144:147]
    s_waitcnt vmcnt(13) lgkmcnt(0)
    s_barrier
    v_mfma_f32_16x16x32_bf16 v[100:103], a[48:51], v[32:35], v[100:103]
    ds_read_b64_tr_b16 a[0:1], v50 offset:16384
    v_mfma_f32_16x16x32_bf16 v[104:107], a[52:55], v[32:35], v[104:107]
    s_add_u32 m0, s39, 0
    s_mov_b32 s37, 3145728
    ds_read_b64_tr_b16 a[2:3], v50 offset:17408
    v_mfma_f32_16x16x32_bf16 v[116:119], a[48:51], a[80:83], v[116:119]
    buffer_load_dwordx4 v44, s[20:23], s37 offen offset:0 lds
    v_mfma_f32_16x16x32_bf16 v[148:151], a[48:51], a[84:87], v[148:151]
    ds_read_b128 a[32:35], v48 offset:8192
    v_mfma_f32_16x16x32_bf16 v[180:183], a[48:51], a[88:91], v[180:183]
    ds_read_b128 a[36:39], v48 offset:10240
    v_mfma_f32_16x16x32_bf16 v[212:215], a[48:51], a[92:95], v[212:215]
    ds_read_b128 a[40:43], v48 offset:12288
    v_mfma_f32_16x16x32_bf16 v[216:219], a[52:55], a[92:95], v[216:219]
    ds_read_b128 a[44:47], v48 offset:14336
    v_mfma_f32_16x16x32_bf16 v[184:187], a[52:55], a[88:91], v[184:187]
    buffer_load_dwordx4 v45, s[20:23], s37 offen offset:1024 lds
    v_mfma_f32_16x16x32_bf16 v[152:155], a[52:55], a[84:87], v[152:155]
    ds_read_b64_tr_b16 a[4:5], v51 offset:16384
    v_mfma_f32_16x16x32_bf16 v[120:123], a[52:55], a[80:83], v[120:123]
    ds_read_b64_tr_b16 a[6:7], v51 offset:17408
    v_mfma_f32_16x16x32_bf16 v[124:127], a[56:59], a[80:83], v[124:127]
    ds_read_b64_tr_b16 a[8:9], v52 offset:16384
    v_mfma_f32_16x16x32_bf16 v[156:159], a[56:59], a[84:87], v[156:159]
    ds_read_b64_tr_b16 a[10:11], v52 offset:17408
    v_mfma_f32_16x16x32_bf16 v[188:191], a[56:59], a[88:91], v[188:191]
    buffer_load_dwordx4 v46, s[20:23], s37 offen offset:2048 lds
    v_mfma_f32_16x16x32_bf16 v[220:223], a[56:59], a[92:95], v[220:223]
    ds_read_b64_tr_b16 a[12:13], v53 offset:16384
    v_mfma_f32_16x16x32_bf16 v[224:227], a[60:63], a[92:95], v[224:227]
    ds_read_b64_tr_b16 a[14:15], v53 offset:17408
    v_mfma_f32_16x16x32_bf16 v[192:195], a[60:63], a[88:91], v[192:195]
    ds_read_b64_tr_b16 a[16:17], v54 offset:16384
    v_mfma_f32_16x16x32_bf16 v[160:163], a[60:63], a[84:87], v[160:163]
    ds_read_b64_tr_b16 a[18:19], v54 offset:17408
    v_mfma_f32_16x16x32_bf16 v[128:131], a[60:63], a[80:83], v[128:131]
    buffer_load_dwordx4 v47, s[20:23], s37 offen offset:3072 lds
    v_mfma_f32_16x16x32_bf16 v[132:135], a[64:67], a[80:83], v[132:135]
    ds_read_b64_tr_b16 a[20:21], v55 offset:16384
    v_mfma_f32_16x16x32_bf16 v[164:167], a[64:67], a[84:87], v[164:167]
    ds_read_b64_tr_b16 a[22:23], v55 offset:17408
    v_mfma_f32_16x16x32_bf16 v[196:199], a[64:67], a[88:91], v[196:199]
    ds_read_b64_tr_b16 a[24:25], v56 offset:16384
    v_mfma_f32_16x16x32_bf16 v[228:231], a[64:67], a[92:95], v[228:231]
    s_add_u32 m0, s38, 0
    s_mov_b32 s36, 768
    ds_read_b64_tr_b16 a[26:27], v56 offset:17408
    v_mfma_f32_16x16x32_bf16 v[232:235], a[68:71], a[92:95], v[232:235]
    buffer_load_dwordx4 v36, s[16:19], s36 offen offset:0 lds
    v_mfma_f32_16x16x32_bf16 v[200:203], a[68:71], a[88:91], v[200:203]
    ds_read_b64_tr_b16 a[28:29], v57 offset:16384
    v_mfma_f32_16x16x32_bf16 v[168:171], a[68:71], a[84:87], v[168:171]
    ds_read_b64_tr_b16 a[30:31], v57 offset:17408
    v_mfma_f32_16x16x32_bf16 v[136:139], a[68:71], a[80:83], v[136:139]
    v_mfma_f32_16x16x32_bf16 v[140:143], a[72:75], a[80:83], v[140:143]
    v_mfma_f32_16x16x32_bf16 v[172:175], a[72:75], a[84:87], v[172:175]
    buffer_load_dwordx4 v37, s[16:19], s36 offen offset:1024 lds
    v_mfma_f32_16x16x32_bf16 v[204:207], a[72:75], a[88:91], v[204:207]
    v_mfma_f32_16x16x32_bf16 v[236:239], a[72:75], a[92:95], v[236:239]
    v_mfma_f32_16x16x32_bf16 v[240:243], a[76:79], a[92:95], v[240:243]
    v_mfma_f32_16x16x32_bf16 v[208:211], a[76:79], a[88:91], v[208:211]
    v_mfma_f32_16x16x32_bf16 v[176:179], a[76:79], a[84:87], v[176:179]
    v_mfma_f32_16x16x32_bf16 v[144:147], a[76:79], a[80:83], v[144:147]
    s_waitcnt lgkmcnt(0)
    v_mfma_f32_16x16x32_bf16 v[100:103], a[0:3], v[32:35], v[100:103]
    ds_read_b64_tr_b16 a[48:49], v50 offset:24576
    v_mfma_f32_16x16x32_bf16 v[104:107], a[4:7], v[32:35], v[104:107]
    ds_read_b64_tr_b16 a[50:51], v50 offset:25600
    v_mfma_f32_16x16x32_bf16 v[116:119], a[0:3], a[32:35], v[116:119]
    buffer_load_dwordx4 v38, s[16:19], s36 offen offset:2048 lds
    v_mfma_f32_16x16x32_bf16 v[148:151], a[0:3], a[36:39], v[148:151]
    ds_read_b128 a[80:83], v49 offset:8192
    v_mfma_f32_16x16x32_bf16 v[180:183], a[0:3], a[40:43], v[180:183]
    ds_read_b128 a[84:87], v49 offset:10240
    v_mfma_f32_16x16x32_bf16 v[212:215], a[0:3], a[44:47], v[212:215]
    ds_read_b128 a[88:91], v49 offset:12288
    v_mfma_f32_16x16x32_bf16 v[216:219], a[4:7], a[44:47], v[216:219]
    ds_read_b128 a[92:95], v49 offset:14336
    v_mfma_f32_16x16x32_bf16 v[184:187], a[4:7], a[40:43], v[184:187]
    buffer_load_dwordx4 v39, s[16:19], s36 offen offset:3072 lds
    v_mfma_f32_16x16x32_bf16 v[152:155], a[4:7], a[36:39], v[152:155]
    ds_read_b64_tr_b16 a[52:53], v51 offset:24576
    v_mfma_f32_16x16x32_bf16 v[120:123], a[4:7], a[32:35], v[120:123]
    ds_read_b64_tr_b16 a[54:55], v51 offset:25600
    v_mfma_f32_16x16x32_bf16 v[124:127], a[8:11], a[32:35], v[124:127]
    ds_read_b64_tr_b16 a[56:57], v52 offset:24576
    v_mfma_f32_16x16x32_bf16 v[156:159], a[8:11], a[36:39], v[156:159]
    s_add_u32 m0, s38, 4096
    ds_read_b64_tr_b16 a[58:59], v52 offset:25600
    v_mfma_f32_16x16x32_bf16 v[188:191], a[8:11], a[40:43], v[188:191]
    buffer_load_dwordx4 v40, s[16:19], s36 offen offset:0 lds
    v_mfma_f32_16x16x32_bf16 v[220:223], a[8:11], a[44:47], v[220:223]
    ds_read_b64_tr_b16 a[60:61], v53 offset:24576
    v_mfma_f32_16x16x32_bf16 v[224:227], a[12:15], a[44:47], v[224:227]
    ds_read_b64_tr_b16 a[62:63], v53 offset:25600
    v_mfma_f32_16x16x32_bf16 v[192:195], a[12:15], a[40:43], v[192:195]
    ds_read_b64_tr_b16 a[64:65], v54 offset:24576
    v_mfma_f32_16x16x32_bf16 v[160:163], a[12:15], a[36:39], v[160:163]
    ds_read_b64_tr_b16 a[66:67], v54 offset:25600
    v_mfma_f32_16x16x32_bf16 v[128:131], a[12:15], a[32:35], v[128:131]
    buffer_load_dwordx4 v41, s[16:19], s36 offen offset:1024 lds
    v_mfma_f32_16x16x32_bf16 v[132:135], a[16:19], a[32:35], v[132:135]
    ds_read_b64_tr_b16 a[68:69], v55 offset:24576
    v_mfma_f32_16x16x32_bf16 v[164:167], a[16:19], a[36:39], v[164:167]
    ds_read_b64_tr_b16 a[70:71], v55 offset:25600
    v_mfma_f32_16x16x32_bf16 v[196:199], a[16:19], a[40:43], v[196:199]
    ds_read_b64_tr_b16 a[72:73], v56 offset:24576
    v_mfma_f32_16x16x32_bf16 v[228:231], a[16:19], a[44:47], v[228:231]
    ds_read_b64_tr_b16 a[74:75], v56 offset:25600
    v_mfma_f32_16x16x32_bf16 v[232:235], a[20:23], a[44:47], v[232:235]
    buffer_load_dwordx4 v42, s[16:19], s36 offen offset:2048 lds
    v_mfma_f32_16x16x32_bf16 v[200:203], a[20:23], a[40:43], v[200:203]
    ds_read_b64_tr_b16 a[76:77], v57 offset:24576
    v_mfma_f32_16x16x32_bf16 v[168:171], a[20:23], a[36:39], v[168:171]
    ds_read_b64_tr_b16 a[78:79], v57 offset:25600
    v_mfma_f32_16x16x32_bf16 v[136:139], a[20:23], a[32:35], v[136:139]
    v_mfma_f32_16x16x32_bf16 v[140:143], a[24:27], a[32:35], v[140:143]
    v_mfma_f32_16x16x32_bf16 v[172:175], a[24:27], a[36:39], v[172:175]
    buffer_load_dwordx4 v43, s[16:19], s36 offen offset:3072 lds
    v_mfma_f32_16x16x32_bf16 v[204:207], a[24:27], a[40:43], v[204:207]
    v_mfma_f32_16x16x32_bf16 v[236:239], a[24:27], a[44:47], v[236:239]
    v_mfma_f32_16x16x32_bf16 v[240:243], a[28:31], a[44:47], v[240:243]
    v_mfma_f32_16x16x32_bf16 v[208:211], a[28:31], a[40:43], v[208:211]
    v_mfma_f32_16x16x32_bf16 v[176:179], a[28:31], a[36:39], v[176:179]
    v_mfma_f32_16x16x32_bf16 v[144:147], a[28:31], a[32:35], v[144:147]
    s_waitcnt vmcnt(12) lgkmcnt(0)
    s_barrier
    s_cmp_lg_u32 s5, 0
    s_cbranch_scc1 L_signalled
    s_mov_b64 exec, 1
    buffer_atomic_add v27, off, s[92:95], s74 sc1
    s_mov_b64 exec, -1
L_signalled:
    v_mfma_f32_16x16x32_bf16 v[100:103], a[48:51], v[32:35], v[100:103]
    ds_read_b64_tr_b16 a[0:1], v50 offset:32768
    v_mfma_f32_16x16x32_bf16 v[104:107], a[52:55], v[32:35], v[104:107]
    s_add_u32 m0, s39, 16384
    s_mov_b32 s37, 3670016
    ds_read_b64_tr_b16 a[2:3], v50 offset:33792
    v_mfma_f32_16x16x32_bf16 v[116:119], a[48:51], a[80:83], v[116:119]
    buffer_load_dwordx4 v44, s[20:23], s37 offen offset:0 lds
    v_mfma_f32_16x16x32_bf16 v[148:151], a[48:51], a[84:87], v[148:151]
    ds_read_b128 a[32:35], v48 offset:16384
    v_mfma_f32_16x16x32_bf16 v[180:183], a[48:51], a[88:91], v[180:183]
    ds_read_b128 a[36:39], v48 offset:18432
    v_mfma_f32_16x16x32_bf16 v[212:215], a[48:51], a[92:95], v[212:215]
    buffer_load_dwordx4 v45, s[20:23], s37 offen offset:1024 lds
    v_mfma_f32_16x16x32_bf16 v[216:219], a[52:55], a[92:95], v[216:219]
    ds_read_b128 a[40:43], v48 offset:20480
    v_mfma_f32_16x16x32_bf16 v[184:187], a[52:55], a[88:91], v[184:187]
    ds_read_b128 a[44:47], v48 offset:22528
    v_mfma_f32_16x16x32_bf16 v[152:155], a[52:55], a[84:87], v[152:155]
    ds_read_b64_tr_b16 a[4:5], v51 offset:32768
    v_mfma_f32_16x16x32_bf16 v[120:123], a[52:55], a[80:83], v[120:123]
    buffer_load_dwordx4 v46, s[20:23], s37 offen offset:2048 lds
    v_mfma_f32_16x16x32_bf16 v[124:127], a[56:59], a[80:83], v[124:127]
    ds_read_b64_tr_b16 a[6:7], v51 offset:33792
    v_mfma_f32_16x16x32_bf16 v[156:159], a[56:59], a[84:87], v[156:159]
    ds_read_b64_tr_b16 a[8:9], v52 offset:32768
    v_mfma_f32_16x16x32_bf16 v[188:191], a[56:59], a[88:91], v[188:191]
    ds_read_b64_tr_b16 a[10:11], v52 offset:33792
    v_mfma_f32_16x16x32_bf16 v[220:223], a[56:59], a[92:95], v[220:223]
    buffer_load_dwordx4 v47, s[20:23], s37 offen offset:3072 lds
    v_mfma_f32_16x16x32_bf16 v[224:227], a[60:63], a[92:95], v[224:227]
    ds_read_b64_tr_b16 a[12:13], v53 offset:32768
    v_mfma_f32_16x16x32_bf16 v[192:195], a[60:63], a[88:91], v[192:195]
    ds_read_b64_tr_b16 a[14:15], v53 offset:33792
    v_mfma_f32_16x16x32_bf16 v[160:163], a[60:63], a[84:87], v[160:163]
    s_add_u32 m0, s38, 8192
    s_mov_b32 s36, 896
    ds_read_b64_tr_b16 a[16:17], v54 offset:32768
    v_mfma_f32_16x16x32_bf16 v[128:131], a[60:63], a[80:83], v[128:131]
    buffer_load_dwordx4 v36, s[16:19], s36 offen offset:0 lds
    v_mfma_f32_16x16x32_bf16 v[132:135], a[64:67], a[80:83], v[132:135]
    ds_read_b64_tr_b16 a[18:19], v54 offset:33792
    v_mfma_f32_16x16x32_bf16 v[164:167], a[64:67], a[84:87], v[164:167]
    ds_read_b64_tr_b16 a[20:21], v55 offset:32768
    v_mfma_f32_16x16x32_bf16 v[196:199], a[64:67], a[88:91], v[196:199]
    buffer_load_dwordx4 v37, s[16:19], s36 offen offset:1024 lds
    v_mfma_f32_16x16x32_bf16 v[228:231], a[64:67], a[92:95], v[228:231]
    ds_read_b64_tr_b16 a[22:23], v55 offset:33792
    v_mfma_f32_16x16x32_bf16 v[232:235], a[68:71], a[92:95], v[232:235]
    ds_read_b64_tr_b16 a[24:25], v56 offset:32768
    v_mfma_f32_16x16x32_bf16 v[200:203], a[68:71], a[88:91], v[200:203]
    ds_read_b64_tr_b16 a[26:27], v56 offset:33792
    v_mfma_f32_16x16x32_bf16 v[168:171], a[68:71], a[84:87], v[168:171]
    buffer_load_dwordx4 v38, s[16:19], s36 offen offset:2048 lds
    v_mfma_f32_16x16x32_bf16 v[136:139], a[68:71], a[80:83], v[136:139]
    ds_read_b64_tr_b16 a[28:29], v57 offset:32768
    v_mfma_f32_16x16x32_bf16 v[140:143], a[72:75], a[80:83], v[140:143]
    ds_read_b64_tr_b16 a[30:31], v57 offset:33792
    v_mfma_f32_16x16x32_bf16 v[172:175], a[72:75], a[84:87], v[172:175]
    v_mfma_f32_16x16x32_bf16 v[204:207], a[72:75], a[88:91], v[204:207]
    buffer_load_dwordx4 v39, s[16:19], s36 offen offset:3072 lds
    v_mfma_f32_16x16x32_bf16 v[236:239], a[72:75], a[92:95], v[236:239]
    v_mfma_f32_16x16x32_bf16 v[240:243], a[76:79], a[92:95], v[240:243]
    v_mfma_f32_16x16x32_bf16 v[208:211], a[76:79], a[88:91], v[208:211]
    v_mfma_f32_16x16x32_bf16 v[176:179], a[76:79], a[84:87], v[176:179]
    v_mfma_f32_16x16x32_bf16 v[144:147], a[76:79], a[80:83], v[144:147]
    s_waitcnt lgkmcnt(0)
    v_mfma_f32_16x16x32_bf16 v[100:103], a[0:3], v[32:35], v[100:103]
    ds_read_b64_tr_b16 a[48:49], v50 offset:40960
    v_mfma_f32_16x16x32_bf16 v[104:107], a[4:7], v[32:35], v[104:107]
    s_add_u32 m0, s38, 12288
    ds_read_b64_tr_b16 a[50:51], v50 offset:41984
    v_mfma_f32_16x16x32_bf16 v[116:119], a[0:3], a[32:35], v[116:119]
    buffer_load_dwordx4 v40, s[16:19], s36 offen offset:0 lds
    v_mfma_f32_16x16x32_bf16 v[148:151], a[0:3], a[36:39], v[148:151]
    ds_read_b128 a[80:83], v49 offset:16384
    v_mfma_f32_16x16x32_bf16 v[180:183], a[0:3], a[40:43], v[180:183]
    ds_read_b128 a[84:87], v49 offset:18432
    v_mfma_f32_16x16x32_bf16 v[212:215], a[0:3], a[44:47], v[212:215]
    buffer_load_dwordx4 v41, s[16:19], s36 offen offset:1024 lds
    v_mfma_f32_16x16x32_bf16 v[216:219], a[4:7], a[44:47], v[216:219]
    ds_read_b128 a[88:91], v49 offset:20480
    v_mfma_f32_16x16x32_bf16 v[184:187], a[4:7], a[40:43], v[184:187]
    ds_read_b128 a[92:95], v49 offset:22528
    v_mfma_f32_16x16x32_bf16 v[152:155], a[4:7], a[36:39], v[152:155]
    ds_read_b64_tr_b16 a[52:53], v51 offset:40960
    v_mfma_f32_16x16x32_bf16 v[120:123], a[4:7], a[32:35], v[120:123]
    buffer_load_dwordx4 v42, s[16:19], s36 offen offset:2048 lds
    v_mfma_f32_16x16x32_bf16 v[124:127], a[8:11], a[32:35], v[124:127]
    ds_read_b64_tr_b16 a[54:55], v51 offset:41984
    v_mfma_f32_16x16x32_bf16 v[156:159], a[8:11], a[36:39], v[156:159]
    ds_read_b64_tr_b16 a[56:57], v52 offset:40960
    v_mfma_f32_16x16x32_bf16 v[188:191], a[8:11], a[40:43], v[188:191]
    ds_read_b64_tr_b16 a[58:59], v52 offset:41984
    v_mfma_f32_16x16x32_bf16 v[220:223], a[8:11], a[44:47], v[220:223]
    buffer_load_dwordx4 v43, s[16:19], s36 offen offset:3072 lds
    v_mfma_f32_16x16x32_bf16 v[224:227], a[12:15], a[44:47], v[224:227]
    ds_read_b64_tr_b16 a[60:61], v53 offset:40960
    v_mfma_f32_16x16x32_bf16 v[192:195], a[12:15], a[40:43], v[192:195]
    ds_read_b64_tr_b16 a[62:63], v53 offset:41984
    v_mfma_f32_16x16x32_bf16 v[160:163], a[12:15], a[36:39], v[160:163]
    s_add_u32 m0, s34, 49152
    ds_read_b64_tr_b16 a[64:65], v54 offset:40960
    v_mfma_f32_16x16x32_bf16 v[128:131], a[12:15], a[32:35], v[128:131]
    buffer_load_dwordx4 v13, s[8:11], s28 offen offset:0 lds
    v_mfma_f32_16x16x32_bf16 v[132:135], a[16:19], a[32:35], v[132:135]
    ds_read_b64_tr_b16 a[66:67], v54 offset:41984
    v_mfma_f32_16x16x32_bf16 v[164:167], a[16:19], a[36:39], v[164:167]
    ds_read_b64_tr_b16 a[68:69], v55 offset:40960
    v_mfma_f32_16x16x32_bf16 v[196:199], a[16:19], a[40:43], v[196:199]
    buffer_load_dwordx4 v14, s[8:11], s28 offen offset:1024 lds
    v_mfma_f32_16x16x32_bf16 v[228:231], a[16:19], a[44:47], v[228:231]
    ds_read_b64_tr_b16 a[70:71], v55 offset:41984
    v_mfma_f32_16x16x32_bf16 v[232:235], a[20:23], a[44:47], v[232:235]
    ds_read_b64_tr_b16 a[72:73], v56 offset:40960
    v_mfma_f32_16x16x32_bf16 v[200:203], a[20:23], a[40:43], v[200:203]
    ds_read_b64_tr_b16 a[74:75], v56 offset:41984
    v_mfma_f32_16x16x32_bf16 v[168:171], a[20:23], a[36:39], v[168:171]
    buffer_load_dwordx4 v15, s[8:11], s28 offen offset:2048 lds
    v_mfma_f32_16x16x32_bf16 v[136:139], a[20:23], a[32:35], v[136:139]
    ds_read_b64_tr_b16 a[76:77], v57 offset:40960
    v_mfma_f32_16x16x32_bf16 v[140:143], a[24:27], a[32:35], v[140:143]
    ds_read_b64_tr_b16 a[78:79], v57 offset:41984
    v_mfma_f32_16x16x32_bf16 v[172:175], a[24:27], a[36:39], v[172:175]
    v_mfma_f32_16x16x32_bf16 v[204:207], a[24:27], a[40:43], v[204:207]
    buffer_load_dwordx4 v16, s[8:11], s28 offen offset:3072 lds
    v_mfma_f32_16x16x32_bf16 v[236:239], a[24:27], a[44:47], v[236:239]
    v_mfma_f32_16x16x32_bf16 v[240:243], a[28:31], a[44:47], v[240:243]
    v_mfma_f32_16x16x32_bf16 v[208:211], a[28:31], a[40:43], v[208:211]
    v_mfma_f32_16x16x32_bf16 v[176:179], a[28:31], a[36:39], v[176:179]
    v_mfma_f32_16x16x32_bf16 v[144:147], a[28:31], a[32:35], v[144:147]
    s_add_u32 s28, s28, 16384
    s_waitcnt vmcnt(16) lgkmcnt(0)
    s_barrier
    v_mfma_f32_16x16x32_bf16 v[100:103], a[48:51], v[32:35], v[100:103]
    ds_read_b64_tr_b16 a[0:1], v50 offset:0
    v_mfma_f32_16x16x32_bf16 v[104:107], a[52:55], v[32:35], v[104:107]
    s_add_u32 m0, s39, 32768
    s_mov_b32 s37, 4194304
    ds_read_b64_tr_b16 a[2:3], v50 offset:1024
    v_mfma_f32_16x16x32_bf16 v[116:119], a[48:51], a[80:83], v[116:119]
    buffer_load_dwordx4 v44, s[20:23], s37 offen offset:0 lds
    v_mfma_f32_16x16x32_bf16 v[148:151], a[48:51], a[84:87], v[148:151]
    ds_read_b128 a[32:35], v48 offset:0
    v_mfma_f32_16x16x32_bf16 v[180:183], a[48:51], a[88:91], v[180:183]
    ds_read_b128 a[36:39], v48 offset:2048
    v_mfma_f32_16x16x32_bf16 v[212:215], a[48:51], a[92:95], v[212:215]
    ds_read_b128 a[40:43], v48 offset:4096
    v_mfma_f32_16x16x32_bf16 v[216:219], a[52:55], a[92:95], v[216:219]
    ds_read_b128 a[44:47], v48 offset:6144
    v_mfma_f32_16x16x32_bf16 v[184:187], a[52:55], a[88:91], v[184:187]
    buffer_load_dwordx4 v45, s[20:23], s37 offen offset:1024 lds
    v_mfma_f32_16x16x32_bf16 v[152:155], a[52:55], a[84:87], v[152:155]
    ds_read_b64_tr_b16 a[4:5], v51 offset:0
    v_mfma_f32_16x16x32_bf16 v[120:123], a[52:55], a[80:83], v[120:123]
    ds_read_b64_tr_b16 a[6:7], v51 offset:1024
    v_mfma_f32_16x16x32_bf16 v[124:127], a[56:59], a[80:83], v[124:127]
    ds_read_b64_tr_b16 a[8:9], v52 offset:0
    v_mfma_f32_16x16x32_bf16 v[156:159], a[56:59], a[84:87], v[156:159]
    ds_read_b64_tr_b16 a[10:11], v52 offset:1024
    v_mfma_f32_16x16x32_bf16 v[188:191], a[56:59], a[88:91], v[188:191]
    buffer_load_dwordx4 v46, s[20:23], s37 offen offset:2048 lds
    v_mfma_f32_16x16x32_bf16 v[220:223], a[56:59], a[92:95], v[220:223]
    ds_read_b64_tr_b16 a[12:13], v53 offset:0
    v_mfma_f32_16x16x32_bf16 v[224:227], a[60:63], a[92:95], v[224:227]
    ds_read_b64_tr_b16 a[14:15], v53 offset:1024
    v_mfma_f32_16x16x32_bf16 v[192:195], a[60:63], a[88:91], v[192:195]
    ds_read_b64_tr_b16 a[16:17], v54 offset:0
    v_mfma_f32_16x16x32_bf16 v[160:163], a[60:63], a[84:87], v[160:163]
    ds_read_b64_tr_b16 a[18:19], v54 offset:1024
    v_mfma_f32_16x16x32_bf16 v[128:131], a[60:63], a[80:83], v[128:131]
    buffer_load_dwordx4 v47, s[20:23], s37 offen offset:3072 lds
    v_mfma_f32_16x16x32_bf16 v[132:135], a[64:67], a[80:83], v[132:135]
    ds_read_b64_tr_b16 a[20:21], v55 offset:0
    v_mfma_f32_16x16x32_bf16 v[164:167], a[64:67], a[84:87], v[164:167]
    ds_read_b64_tr_b16 a[22:23], v55 offset:1024
    v_mfma_f32_16x16x32_bf16 v[196:199], a[64:67], a[88:91], v[196:199]
    ds_read_b64_tr_b16 a[24:25], v56 offset:0
    v_mfma_f32_16x16x32_bf16 v[228:231], a[64:67], a[92:95], v[228:231]
    s_add_u32 m0, s38, 16384
    s_mov_b32 s36, 1024
    ds_read_b64_tr_b16 a[26:27], v56 offset:1024
    v_mfma_f32_16x16x32_bf16 v[232:235], a[68:71], a[92:95], v[232:235]
    buffer_load_dwordx4 v36, s[16:19], s36 offen offset:0 lds
    v_mfma_f32_16x16x32_bf16 v[200:203], a[68:71], a[88:91], v[200:203]
    ds_read_b64_tr_b16 a[28:29], v57 offset:0
    v_mfma_f32_16x16x32_bf16 v[168:171], a[68:71], a[84:87], v[168:171]
    ds_read_b64_tr_b16 a[30:31], v57 offset:1024
    v_mfma_f32_16x16x32_bf16 v[136:139], a[68:71], a[80:83], v[136:139]
    v_mfma_f32_16x16x32_bf16 v[140:143], a[72:75], a[80:83], v[140:143]
    v_mfma_f32_16x16x32_bf16 v[172:175], a[72:75], a[84:87], v[172:175]
    buffer_load_dwordx4 v37, s[16:19], s36 offen offset:1024 lds
    v_mfma_f32_16x16x32_bf16 v[204:207], a[72:75], a[88:91], v[204:207]
    v_mfma_f32_16x16x32_bf16 v[236:239], a[72:75], a[92:95], v[236:239]
    v_mfma_f32_16x16x32_bf16 v[240:243], a[76:79], a[92:95], v[240:243]
    v_mfma_f32_16x16x32_bf16 v[208:211], a[76:79], a[88:91], v[208:211]
    v_mfma_f32_16x16x32_bf16 v[176:179], a[76:79], a[84:87], v[176:179]
    v_mfma_f32_16x16x32_bf16 v[144:147], a[76:79], a[80:83], v[144:147]
    s_waitcnt lgkmcnt(0)
    v_mfma_f32_16x16x32_bf16 v[100:103], a[0:3], v[32:35], v[100:103]
    ds_read_b64_tr_b16 a[48:49], v50 offset:8192
    v_mfma_f32_16x16x32_bf16 v[104:107], a[4:7], v[32:35], v[104:107]
    ds_read_b64_tr_b16 a[50:51], v50 offset:9216
    v_mfma_f32_16x16x32_bf16 v[116:119], a[0:3], a[32:35], v[116:119]
    buffer_load_dwordx4 v38, s[16:19], s36 offen offset:2048 lds
    v_mfma_f32_16x16x32_bf16 v[148:151], a[0:3], a[36:39], v[148:151]
    ds_read_b128 a[80:83], v49 offset:0
    v_mfma_f32_16x16x32_bf16 v[180:183], a[0:3], a[40:43], v[180:183]
    ds_read_b128 a[84:87], v49 offset:2048
    v_mfma_f32_16x16x32_bf16 v[212:215], a[0:3], a[44:47], v[212:215]
    ds_read_b128 a[88:91], v49 offset:4096
    v_mfma_f32_16x16x32_bf16 v[216:219], a[4:7], a[44:47], v[216:219]
    ds_read_b128 a[92:95], v49 offset:6144
    v_mfma_f32_16x16x32_bf16 v[184:187], a[4:7], a[40:43], v[184:187]
    buffer_load_dwordx4 v39, s[16:19], s36 offen offset:3072 lds
    v_mfma_f32_16x16x32_bf16 v[152:155], a[4:7], a[36:39], v[152:155]
    ds_read_b64_tr_b16 a[52:53], v51 offset:8192
    v_mfma_f32_16x16x32_bf16 v[120:123], a[4:7], a[32:35], v[120:123]
    ds_read_b64_tr_b16 a[54:55], v51 offset:9216
    v_mfma_f32_16x16x32_bf16 v[124:127], a[8:11], a[32:35], v[124:127]
    ds_read_b64_tr_b16 a[56:57], v52 offset:8192
    v_mfma_f32_16x16x32_bf16 v[156:159], a[8:11], a[36:39], v[156:159]
    s_add_u32 m0, s38, 20480
    ds_read_b64_tr_b16 a[58:59], v52 offset:9216
    v_mfma_f32_16x16x32_bf16 v[188:191], a[8:11], a[40:43], v[188:191]
    buffer_load_dwordx4 v40, s[16:19], s36 offen offset:0 lds
    v_mfma_f32_16x16x32_bf16 v[220:223], a[8:11], a[44:47], v[220:223]
    ds_read_b64_tr_b16 a[60:61], v53 offset:8192
    v_mfma_f32_16x16x32_bf16 v[224:227], a[12:15], a[44:47], v[224:227]
    ds_read_b64_tr_b16 a[62:63], v53 offset:9216
    v_mfma_f32_16x16x32_bf16 v[192:195], a[12:15], a[40:43], v[192:195]
    ds_read_b64_tr_b16 a[64:65], v54 offset:8192
    v_mfma_f32_16x16x32_bf16 v[160:163], a[12:15], a[36:39], v[160:163]
    ds_read_b64_tr_b16 a[66:67], v54 offset:9216
    v_mfma_f32_16x16x32_bf16 v[128:131], a[12:15], a[32:35], v[128:131]
    buffer_load_dwordx4 v41, s[16:19], s36 offen offset:1024 lds
    v_mfma_f32_16x16x32_bf16 v[132:135], a[16:19], a[32:35], v[132:135]
    ds_read_b64_tr_b16 a[68:69], v55 offset:8192
    v_mfma_f32_16x16x32_bf16 v[164:167], a[16:19], a[36:39], v[164:167]
    ds_read_b64_tr_b16 a[70:71], v55 offset:9216
    v_mfma_f32_16x16x32_bf16 v[196:199], a[16:19], a[40:43], v[196:199]
    ds_read_b64_tr_b16 a[72:73], v56 offset:8192
    v_mfma_f32_16x16x32_bf16 v[228:231], a[16:19], a[44:47], v[228:231]
    ds_read_b64_tr_b16 a[74:75], v56 offset:9216
    v_mfma_f32_16x16x32_bf16 v[232:235], a[20:23], a[44:47], v[232:235]
    buffer_load_dwordx4 v42, s[16:19], s36 offen offset:2048 lds
    v_mfma_f32_16x16x32_bf16 v[200:203], a[20:23], a[40:43], v[200:203]
    ds_read_b64_tr_b16 a[76:77], v57 offset:8192
    v_mfma_f32_16x16x32_bf16 v[168:171], a[20:23], a[36:39], v[168:171]
    ds_read_b64_tr_b16 a[78:79], v57 offset:9216
    v_mfma_f32_16x16x32_bf16 v[136:139], a[20:23], a[32:35], v[136:139]
    v_mfma_f32_16x16x32_bf16 v[140:143], a[24:27], a[32:35], v[140:143]
    v_mfma_f32_16x16x32_bf16 v[172:175], a[24:27], a[36:39], v[172:175]
    buffer_load_dwordx4 v43, s[16:19], s36 offen offset:3072 lds
    v_mfma_f32_16x16x32_bf16 v[204:207], a[24:27], a[40:43], v[204:207]
    v_mfma_f32_16x16x32_bf16 v[236:239], a[24:27], a[44:47], v[236:239]
    v_mfma_f32_16x16x32_bf16 v[240:243], a[28:31], a[44:47], v[240:243]
    v_mfma_f32_16x16x32_bf16 v[208:211], a[28:31], a[40:43], v[208:211]
    v_mfma_f32_16x16x32_bf16 v[176:179], a[28:31], a[36:39], v[176:179]
    v_mfma_f32_16x16x32_bf16 v[144:147], a[28:31], a[32:35], v[144:147]
    s_waitcnt vmcnt(16) lgkmcnt(0)
    s_barrier
    v_mfma_f32_16x16x32_bf16 v[100:103], a[48:51], v[32:35], v[100:103]
    ds_read_b64_tr_b16 a[0:1], v50 offset:16384
    v_mfma_f32_16x16x32_bf16 v[104:107], a[52:55], v[32:35], v[104:107]
    s_add_u32 m0, s39, 0
    s_mov_b32 s37, 4718592
    ds_read_b64_tr_b16 a[2:3], v50 offset:17408
    v_mfma_f32_16x16x32_bf16 v[116:119], a[48:51], a[80:83], v[116:119]
    buffer_load_dwordx4 v44, s[20:23], s37 offen offset:0 lds
    v_mfma_f32_16x16x32_bf16 v[148:151], a[48:51], a[84:87], v[148:151]
    ds_read_b128 a[32:35], v48 offset:8192
    v_mfma_f32_16x16x32_bf16 v[180:183], a[48:51], a[88:91], v[180:183]
    ds_read_b128 a[36:39], v48 offset:10240
    v_mfma_f32_16x16x32_bf16 v[212:215], a[48:51], a[92:95], v[212:215]
    ds_read_b128 a[40:43], v48 offset:12288
    v_mfma_f32_16x16x32_bf16 v[216:219], a[52:55], a[92:95], v[216:219]
    ds_read_b128 a[44:47], v48 offset:14336
    v_mfma_f32_16x16x32_bf16 v[184:187], a[52:55], a[88:91], v[184:187]
    buffer_load_dwordx4 v45, s[20:23], s37 offen offset:1024 lds
    v_mfma_f32_16x16x32_bf16 v[152:155], a[52:55], a[84:87], v[152:155]
    ds_read_b64_tr_b16 a[4:5], v51 offset:16384
    v_mfma_f32_16x16x32_bf16 v[120:123], a[52:55], a[80:83], v[120:123]
    ds_read_b64_tr_b16 a[6:7], v51 offset:17408
    v_mfma_f32_16x16x32_bf16 v[124:127], a[56:59], a[80:83], v[124:127]
    ds_read_b64_tr_b16 a[8:9], v52 offset:16384
    v_mfma_f32_16x16x32_bf16 v[156:159], a[56:59], a[84:87], v[156:159]
    ds_read_b64_tr_b16 a[10:11], v52 offset:17408
    v_mfma_f32_16x16x32_bf16 v[188:191], a[56:59], a[88:91], v[188:191]
    buffer_load_dwordx4 v46, s[20:23], s37 offen offset:2048 lds
    v_mfma_f32_16x16x32_bf16 v[220:223], a[56:59], a[92:95], v[220:223]
    ds_read_b64_tr_b16 a[12:13], v53 offset:16384
    v_mfma_f32_16x16x32_bf16 v[224:227], a[60:63], a[92:95], v[224:227]
    ds_read_b64_tr_b16 a[14:15], v53 offset:17408
    v_mfma_f32_16x16x32_bf16 v[192:195], a[60:63], a[88:91], v[192:195]
    ds_read_b64_tr_b16 a[16:17], v54 offset:16384
    v_mfma_f32_16x16x32_bf16 v[160:163], a[60:63], a[84:87], v[160:163]
    ds_read_b64_tr_b16 a[18:19], v54 offset:17408
    v_mfma_f32_16x16x32_bf16 v[128:131], a[60:63], a[80:83], v[128:131]
    buffer_load_dwordx4 v47, s[20:23], s37 offen offset:3072 lds
    v_mfma_f32_16x16x32_bf16 v[132:135], a[64:67], a[80:83], v[132:135]
    ds_read_b64_tr_b16 a[20:21], v55 offset:16384
    v_mfma_f32_16x16x32_bf16 v[164:167], a[64:67], a[84:87], v[164:167]
    ds_read_b64_tr_b16 a[22:23], v55 offset:17408
    v_mfma_f32_16x16x32_bf16 v[196:199], a[64:67], a[88:91], v[196:199]
    ds_read_b64_tr_b16 a[24:25], v56 offset:16384
    v_mfma_f32_16x16x32_bf16 v[228:231], a[64:67], a[92:95], v[228:231]
    s_add_u32 m0, s38, 0
    s_mov_b32 s36, 1152
    ds_read_b64_tr_b16 a[26:27], v56 offset:17408
    v_mfma_f32_16x16x32_bf16 v[232:235], a[68:71], a[92:95], v[232:235]
    buffer_load_dword v252, off, s[92:95], s74 sc1
    buffer_load_dwordx4 v36, s[16:19], s36 offen offset:0 lds
    v_mfma_f32_16x16x32_bf16 v[200:203], a[68:71], a[88:91], v[200:203]
    ds_read_b64_tr_b16 a[28:29], v57 offset:16384
    v_mfma_f32_16x16x32_bf16 v[168:171], a[68:71], a[84:87], v[168:171]
    ds_read_b64_tr_b16 a[30:31], v57 offset:17408
    v_mfma_f32_16x16x32_bf16 v[136:139], a[68:71], a[80:83], v[136:139]
    v_mfma_f32_16x16x32_bf16 v[140:143], a[72:75], a[80:83], v[140:143]
    v_mfma_f32_16x16x32_bf16 v[172:175], a[72:75], a[84:87], v[172:175]
    buffer_load_dwordx4 v37, s[16:19], s36 offen offset:1024 lds
    v_mfma_f32_16x16x32_bf16 v[204:207], a[72:75], a[88:91], v[204:207]
    v_mfma_f32_16x16x32_bf16 v[236:239], a[72:75], a[92:95], v[236:239]
    v_mfma_f32_16x16x32_bf16 v[240:243], a[76:79], a[92:95], v[240:243]
    v_mfma_f32_16x16x32_bf16 v[208:211], a[76:79], a[88:91], v[208:211]
    v_mfma_f32_16x16x32_bf16 v[176:179], a[76:79], a[84:87], v[176:179]
    v_mfma_f32_16x16x32_bf16 v[144:147], a[76:79], a[80:83], v[144:147]
    s_waitcnt lgkmcnt(0)
    v_mfma_f32_16x16x32_bf16 v[100:103], a[0:3], v[32:35], v[100:103]
    ds_read_b64_tr_b16 a[48:49], v50 offset:24576
    v_mfma_f32_16x16x32_bf16 v[104:107], a[4:7], v[32:35], v[104:107]
    ds_read_b64_tr_b16 a[50:51], v50 offset:25600
    v_mfma_f32_16x16x32_bf16 v[116:119], a[0:3], a[32:35], v[116:119]
    buffer_load_dwordx4 v38, s[16:19], s36 offen offset:2048 lds
    v_mfma_f32_16x16x32_bf16 v[148:151], a[0:3], a[36:39], v[148:151]
    ds_read_b128 a[80:83], v49 offset:8192
    v_mfma_f32_16x16x32_bf16 v[180:183], a[0:3], a[40:43], v[180:183]
    ds_read_b128 a[84:87], v49 offset:10240
    v_mfma_f32_16x16x32_bf16 v[212:215], a[0:3], a[44:47], v[212:215]
    ds_read_b128 a[88:91], v49 offset:12288
    v_mfma_f32_16x16x32_bf16 v[216:219], a[4:7], a[44:47], v[216:219]
    ds_read_b128 a[92:95], v49 offset:14336
    v_mfma_f32_16x16x32_bf16 v[184:187], a[4:7], a[40:43], v[184:187]
    buffer_load_dwordx4 v39, s[16:19], s36 offen offset:3072 lds
    v_mfma_f32_16x16x32_bf16 v[152:155], a[4:7], a[36:39], v[152:155]
    ds_read_b64_tr_b16 a[52:53], v51 offset:24576
    v_mfma_f32_16x16x32_bf16 v[120:123], a[4:7], a[32:35], v[120:123]
    ds_read_b64_tr_b16 a[54:55], v51 offset:25600
    v_mfma_f32_16x16x32_bf16 v[124:127], a[8:11], a[32:35], v[124:127]
    ds_read_b64_tr_b16 a[56:57], v52 offset:24576
    v_mfma_f32_16x16x32_bf16 v[156:159], a[8:11], a[36:39], v[156:159]
    s_add_u32 m0, s38, 4096
    ds_read_b64_tr_b16 a[58:59], v52 offset:25600
    v_mfma_f32_16x16x32_bf16 v[188:191], a[8:11], a[40:43], v[188:191]
    buffer_load_dwordx4 v40, s[16:19], s36 offen offset:0 lds
    v_mfma_f32_16x16x32_bf16 v[220:223], a[8:11], a[44:47], v[220:223]
    ds_read_b64_tr_b16 a[60:61], v53 offset:24576
    v_mfma_f32_16x16x32_bf16 v[224:227], a[12:15], a[44:47], v[224:227]
    ds_read_b64_tr_b16 a[62:63], v53 offset:25600
    v_mfma_f32_16x16x32_bf16 v[192:195], a[12:15], a[40:43], v[192:195]
    ds_read_b64_tr_b16 a[64:65], v54 offset:24576
    v_mfma_f32_16x16x32_bf16 v[160:163], a[12:15], a[36:39], v[160:163]
    ds_read_b64_tr_b16 a[66:67], v54 offset:25600
    v_mfma_f32_16x16x32_bf16 v[128:131], a[12:15], a[32:35], v[128:131]
    buffer_load_dwordx4 v41, s[16:19], s36 offen offset:1024 lds
    v_mfma_f32_16x16x32_bf16 v[132:135], a[16:19], a[32:35], v[132:135]
    ds_read_b64_tr_b16 a[68:69], v55 offset:24576
    v_mfma_f32_16x16x32_bf16 v[164:167], a[16:19], a[36:39], v[164:167]
    ds_read_b64_tr_b16 a[70:71], v55 offset:25600
    v_mfma_f32_16x16x32_bf16 v[196:199], a[16:19], a[40:43], v[196:199]
    ds_read_b64_tr_b16 a[72:73], v56 offset:24576
    v_mfma_f32_16x16x32_bf16 v[228:231], a[16:19], a[44:47], v[228:231]
    ds_read_b64_tr_b16 a[74:75], v56 offset:25600
    v_mfma_f32_16x16x32_bf16 v[232:235], a[20:23], a[44:47], v[232:235]
    buffer_load_dwordx4 v42, s[16:19], s36 offen offset:2048 lds
    v_mfma_f32_16x16x32_bf16 v[200:203], a[20:23], a[40:43], v[200:203]
    ds_read_b64_tr_b16 a[76:77], v57 offset:24576
    v_mfma_f32_16x16x32_bf16 v[168:171], a[20:23], a[36:39], v[168:171]
    ds_read_b64_tr_b16 a[78:79], v57 offset:25600
    v_mfma_f32_16x16x32_bf16 v[136:139], a[20:23], a[32:35], v[136:139]
    v_mfma_f32_16x16x32_bf16 v[140:143], a[24:27], a[32:35], v[140:143]
    v_mfma_f32_16x16x32_bf16 v[172:175], a[24:27], a[36:39], v[172:175]
    buffer_load_dwordx4 v43, s[16:19], s36 offen offset:3072 lds
    v_mfma_f32_16x16x32_bf16 v[204:207], a[24:27], a[40:43], v[204:207]
    v_mfma_f32_16x16x32_bf16 v[236:239], a[24:27], a[44:47], v[236:239]
    v_mfma_f32_16x16x32_bf16 v[240:243], a[28:31], a[44:47], v[240:243]
    v_mfma_f32_16x16x32_bf16 v[208:211], a[28:31], a[40:43], v[208:211]
    v_mfma_f32_16x16x32_bf16 v[176:179], a[28:31], a[36:39], v[176:179]
    v_mfma_f32_16x16x32_bf16 v[144:147], a[28:31], a[32:35], v[144:147]
    s_waitcnt vmcnt(13) lgkmcnt(0)
    s_barrier
    v_mfma_f32_16x16x32_bf16 v[100:103], a[48:51], v[32:35], v[100:103]
    ds_read_b64_tr_b16 a[0:1], v50 offset:32768
    v_mfma_f32_16x16x32_bf16 v[104:107], a[52:55], v[32:35], v[104:107]
    s_add_u32 m0, s34, 16384
    ds_read_b64_tr_b16 a[2:3], v50 offset:33792
    v_mfma_f32_16x16x32_bf16 v[116:119], a[48:51], a[80:83], v[116:119]
    buffer_load_dwordx4 v13, s[8:11], s28 offen offset:0 lds
    v_mfma_f32_16x16x32_bf16 v[148:151], a[48:51], a[84:87], v[148:151]
    ds_read_b128 a[32:35], v48 offset:16384
    v_mfma_f32_16x16x32_bf16 v[180:183], a[48:51], a[88:91], v[180:183]
    ds_read_b128 a[36:39], v48 offset:18432
    v_mfma_f32_16x16x32_bf16 v[212:215], a[48:51], a[92:95], v[212:215]
    ds_read_b128 a[40:43], v48 offset:20480
    v_mfma_f32_16x16x32_bf16 v[216:219], a[52:55], a[92:95], v[216:219]
    ds_read_b128 a[44:47], v48 offset:22528
    v_mfma_f32_16x16x32_bf16 v[184:187], a[52:55], a[88:91], v[184:187]
    ds_read_b64_tr_b16 a[4:5], v51 offset:32768
    v_mfma_f32_16x16x32_bf16 v[152:155], a[52:55], a[84:87], v[152:155]
    ds_read_b64_tr_b16 a[6:7], v51 offset:33792
    v_mfma_f32_16x16x32_bf16 v[120:123], a[52:55], a[80:83], v[120:123]
    ds_read_b64_tr_b16 a[8:9], v52 offset:32768
    v_mfma_f32_16x16x32_bf16 v[124:127], a[56:59], a[80:83], v[124:127]
    ds_read_b64_tr_b16 a[10:11], v52 offset:33792
    v_mfma_f32_16x16x32_bf16 v[156:159], a[56:59], a[84:87], v[156:159]
    ds_read_b64_tr_b16 a[12:13], v53 offset:32768
    v_mfma_f32_16x16x32_bf16 v[188:191], a[56:59], a[88:91], v[188:191]
    ds_read_b64_tr_b16 a[14:15], v53 offset:33792
    v_mfma_f32_16x16x32_bf16 v[220:223], a[56:59], a[92:95], v[220:223]
    ds_read_b64_tr_b16 a[16:17], v54 offset:32768
    v_mfma_f32_16x16x32_bf16 v[224:227], a[60:63], a[92:95], v[224:227]
    ds_read_b64_tr_b16 a[18:19], v54 offset:33792
    v_mfma_f32_16x16x32_bf16 v[192:195], a[60:63], a[88:91], v[192:195]
    ds_read_b64_tr_b16 a[20:21], v55 offset:32768
    v_mfma_f32_16x16x32_bf16 v[160:163], a[60:63], a[84:87], v[160:163]
    ds_read_b64_tr_b16 a[22:23], v55 offset:33792
    v_mfma_f32_16x16x32_bf16 v[128:131], a[60:63], a[80:83], v[128:131]
    buffer_load_dwordx4 v14, s[8:11], s28 offen offset:1024 lds
    v_mfma_f32_16x16x32_bf16 v[132:135], a[64:67], a[80:83], v[132:135]
    ds_read_b64_tr_b16 a[24:25], v56 offset:32768
    v_mfma_f32_16x16x32_bf16 v[164:167], a[64:67], a[84:87], v[164:167]
    ds_read_b64_tr_b16 a[26:27], v56 offset:33792
    v_mfma_f32_16x16x32_bf16 v[196:199], a[64:67], a[88:91], v[196:199]
    ds_read_b64_tr_b16 a[28:29], v57 offset:32768
    v_mfma_f32_16x16x32_bf16 v[228:231], a[64:67], a[92:95], v[228:231]
    s_waitcnt vmcnt(10)
    v_cmp_gt_u32 vcc, 32, v252
    s_and_b64 vcc, vcc, exec
    s_cbranch_scc1 L_spin_rows
L_back_rows:
    buffer_load_dwordx2 v[108:109], v59, s[76:79], s46 offen offset:0 sc1
    buffer_load_dwordx2 v[110:111], v59, s[76:79], s46 offen offset:256 sc1
    buffer_load_dwordx2 v[112:113], v59, s[76:79], s46 offen offset:512 sc1
    buffer_load_dwordx2 v[114:115], v59, s[76:79], s46 offen offset:768 sc1
    ds_read_b64_tr_b16 a[30:31], v57 offset:33792
    v_mfma_f32_16x16x32_bf16 v[232:235], a[68:71], a[92:95], v[232:235]
    v_mfma_f32_16x16x32_bf16 v[200:203], a[68:71], a[88:91], v[200:203]
    v_mfma_f32_16x16x32_bf16 v[168:171], a[68:71], a[84:87], v[168:171]
    v_mfma_f32_16x16x32_bf16 v[136:139], a[68:71], a[80:83], v[136:139]
    v_mfma_f32_16x16x32_bf16 v[140:143], a[72:75], a[80:83], v[140:143]
    v_mfma_f32_16x16x32_bf16 v[172:175], a[72:75], a[84:87], v[172:175]
    v_mfma_f32_16x16x32_bf16 v[204:207], a[72:75], a[88:91], v[204:207]
    v_mfma_f32_16x16x32_bf16 v[236:239], a[72:75], a[92:95], v[236:239]
    v_mfma_f32_16x16x32_bf16 v[240:243], a[76:79], a[92:95], v[240:243]
    v_mfma_f32_16x16x32_bf16 v[208:211], a[76:79], a[88:91], v[208:211]
    v_mfma_f32_16x16x32_bf16 v[176:179], a[76:79], a[84:87], v[176:179]
    v_mfma_f32_16x16x32_bf16 v[144:147], a[76:79], a[80:83], v[144:147]
    s_waitcnt lgkmcnt(0)
    v_mfma_f32_16x16x32_bf16 v[100:103], a[0:3], v[32:35], v[100:103]
    ds_read_b64_tr_b16 a[48:49], v50 offset:40960
    v_mfma_f32_16x16x32_bf16 v[104:107], a[4:7], v[32:35], v[104:107]
    ds_read_b64_tr_b16 a[50:51], v50 offset:41984
    v_mfma_f32_16x16x32_bf16 v[116:119], a[0:3], a[32:35], v[116:119]
    buffer_load_dwordx4 v15, s[8:11], s28 offen offset:2048 lds
    v_mfma_f32_16x16x32_bf16 v[148:151], a[0:3], a[36:39], v[148:151]
    ds_read_b128 a[80:83], v49 offset:16384
    v_mfma_f32_16x16x32_bf16 v[180:183], a[0:3], a[40:43], v[180:183]
    ds_read_b128 a[84:87], v49 offset:18432
    v_mfma_f32_16x16x32_bf16 v[212:215], a[0:3], a[44:47], v[212:215]
    ds_read_b128 a[88:91], v49 offset:20480
    v_mfma_f32_16x16x32_bf16 v[216:219], a[4:7], a[44:47], v[216:219]
    ds_read_b128 a[92:95], v49 offset:22528
    v_mfma_f32_16x16x32_bf16 v[184:187], a[4:7], a[40:43], v[184:187]
    ds_read_b64_tr_b16 a[52:53], v51 offset:40960
    v_mfma_f32_16x16x32_bf16 v[152:155], a[4:7], a[36:39], v[152:155]
    ds_read_b64_tr_b16 a[54:55], v51 offset:41984
    v_mfma_f32_16x16x32_bf16 v[120:123], a[4:7], a[32:35], v[120:123]
    ds_read_b64_tr_b16 a[56:57], v52 offset:40960
    v_mfma_f32_16x16x32_bf16 v[124:127], a[8:11], a[32:35], v[124:127]
    ds_read_b64_tr_b16 a[58:59], v52 offset:41984
    v_mfma_f32_16x16x32_bf16 v[156:159], a[8:11], a[36:39], v[156:159]
    ds_read_b64_tr_b16 a[60:61], v53 offset:40960
    v_mfma_f32_16x16x32_bf16 v[188:191], a[8:11], a[40:43], v[188:191]
    ds_read_b64_tr_b16 a[62:63], v53 offset:41984
    v_mfma_f32_16x16x32_bf16 v[220:223], a[8:11], a[44:47], v[220:223]
    ds_read_b64_tr_b16 a[64:65], v54 offset:40960
    v_mfma_f32_16x16x32_bf16 v[224:227], a[12:15], a[44:47], v[224:227]
    ds_read_b64_tr_b16 a[66:67], v54 offset:41984
    v_mfma_f32_16x16x32_bf16 v[192:195], a[12:15], a[40:43], v[192:195]
    ds_read_b64_tr_b16 a[68:69], v55 offset:40960
    v_mfma_f32_16x16x32_bf16 v[160:163], a[12:15], a[36:39], v[160:163]
    ds_read_b64_tr_b16 a[70:71], v55 offset:41984
    v_mfma_f32_16x16x32_bf16 v[128:131], a[12:15], a[32:35], v[128:131]
    buffer_load_dwordx4 v16, s[8:11], s28 offen offset:3072 lds
    v_mfma_f32_16x16x32_bf16 v[132:135], a[16:19], a[32:35], v[132:135]
    ds_read_b64_tr_b16 a[72:73], v56 offset:40960
    v_mfma_f32_16x16x32_bf16 v[164:167], a[16:19], a[36:39], v[164:167]
    ds_read_b64_tr_b16 a[74:75], v56 offset:41984
    v_mfma_f32_16x16x32_bf16 v[196:199], a[16:19], a[40:43], v[196:199]
    ds_read_b64_tr_b16 a[76:77], v57 offset:40960
    v_mfma_f32_16x16x32_bf16 v[228:231], a[16:19], a[44:47], v[228:231]
    ds_read_b64_tr_b16 a[78:79], v57 offset:41984
    v_mfma_f32_16x16x32_bf16 v[232:235], a[20:23], a[44:47], v[232:235]
    v_mfma_f32_16x16x32_bf16 v[200:203], a[20:23], a[40:43], v[200:203]
    v_mfma_f32_16x16x32_bf16 v[168:171], a[20:23], a[36:39], v[168:171]
    v_mfma_f32_16x16x32_bf16 v[136:139], a[20:23], a[32:35], v[136:139]
    v_mfma_f32_16x16x32_bf16 v[140:143], a[24:27], a[32:35], v[140:143]
    v_mfma_f32_16x16x32_bf16 v[172:175], a[24:27], a[36:39], v[172:175]
    v_mfma_f32_16x16x32_bf16 v[204:207], a[24:27], a[40:43], v[204:207]
    v_mfma_f32_16x16x32_bf16 v[236:239], a[24:27], a[44:47], v[236:239]
    v_mfma_f32_16x16x32_bf16 v[240:243], a[28:31], a[44:47], v[240:243]
    v_mfma_f32_16x16x32_bf16 v[208:211], a[28:31], a[40:43], v[208:211]
    v_mfma_f32_16x16x32_bf16 v[176:179], a[28:31], a[36:39], v[176:179]
    v_mfma_f32_16x16x32_bf16 v[144:147], a[28:31], a[32:35], v[144:147]
    s_add_u32 s28, s28, 16384
    s_waitcnt vmcnt(8) lgkmcnt(0)
    s_barrier
    v_mfma_f32_16x16x32_bf16 v[100:103], a[48:51], v[32:35], v[100:103]
    ds_read_b64_tr_b16 a[0:1], v50 offset:0
    v_mfma_f32_16x16x32_bf16 v[104:107], a[52:55], v[32:35], v[104:107]
    s_add_u32 m0, s34, 32768
    ds_read_b64_tr_b16 a[2:3], v50 offset:1024
    v_mfma_f32_16x16x32_bf16 v[116:119], a[48:51], a[80:83], v[116:119]
    buffer_load_dwordx4 v13, s[8:11], s28 offen offset:0 lds
    v_mfma_f32_16x16x32_bf16 v[148:151], a[48:51], a[84:87], v[148:151]
    ds_read_b128 a[32:35], v48 offset:0
    v_mfma_f32_16x16x32_bf16 v[180:183], a[48:51], a[88:91], v[180:183]
    ds_read_b128 a[36:39], v48 offset:2048
    v_mfma_f32_16x16x32_bf16 v[212:215], a[48:51], a[92:95], v[212:215]
    ds_read_b128 a[40:43], v48 offset:4096
    v_mfma_f32_16x16x32_bf16 v[216:219], a[52:55], a[92:95], v[216:219]
    ds_read_b128 a[44:47], v48 offset:6144
    v_mfma_f32_16x16x32_bf16 v[184:187], a[52:55], a[88:91], v[184:187]
    ds_read_b64_tr_b16 a[4:5], v51 offset:0
    v_mfma_f32_16x16x32_bf16 v[152:155], a[52:55], a[84:87], v[152:155]
    ds_read_b64_tr_b16 a[6:7], v51 offset:1024
    v_mfma_f32_16x16x32_bf16 v[120:123], a[52:55], a[80:83], v[120:123]
    buffer_load_dwordx4 v14, s[8:11], s28 offen offset:1024 lds
    v_mfma_f32_16x16x32_bf16 v[124:127], a[56:59], a[80:83], v[124:127]
    ds_read_b64_tr_b16 a[8:9], v52 offset:0
    v_mfma_f32_16x16x32_bf16 v[156:159], a[56:59], a[84:87], v[156:159]
    ds_read_b64_tr_b16 a[10:11], v52 offset:1024
    v_mfma_f32_16x16x32_bf16 v[188:191], a[56:59], a[88:91], v[188:191]
    ds_read_b64_tr_b16 a[12:13], v53 offset:0
    v_mfma_f32_16x16x32_bf16 v[220:223], a[56:59], a[92:95], v[220:223]
    ds_read_b64_tr_b16 a[14:15], v53 offset:1024
    v_mfma_f32_16x16x32_bf16 v[224:227], a[60:63], a[92:95], v[224:227]
    ds_read_b64_tr_b16 a[16:17], v54 offset:0
    v_mfma_f32_16x16x32_bf16 v[192:195], a[60:63], a[88:91], v[192:195]
    ds_read_b64_tr_b16 a[18:19], v54 offset:1024
    v_mfma_f32_16x16x32_bf16 v[160:163], a[60:63], a[84:87], v[160:163]
    ds_read_b64_tr_b16 a[20:21], v55 offset:0
    v_mfma_f32_16x16x32_bf16 v[128:131], a[60:63], a[80:83], v[128:131]
    buffer_load_dwordx4 v15, s[8:11], s28 offen offset:2048 lds
    v_mfma_f32_16x16x32_bf16 v[132:135], a[64:67], a[80:83], v[132:135]
    ds_read_b64_tr_b16 a[22:23], v55 offset:1024
    v_mfma_f32_16x16x32_bf16 v[164:167], a[64:67], a[84:87], v[164:167]
    ds_read_b64_tr_b16 a[24:25], v56 offset:0
    v_mfma_f32_16x16x32_bf16 v[196:199], a[64:67], a[88:91], v[196:199]
    ds_read_b64_tr_b16 a[26:27], v56 offset:1024
    v_mfma_f32_16x16x32_bf16 v[228:231], a[64:67], a[92:95], v[228:231]
    ds_read_b64_tr_b16 a[28:29], v57 offset:0
    v_mfma_f32_16x16x32_bf16 v[232:235], a[68:71], a[92:95], v[232:235]
    ds_read_b64_tr_b16 a[30:31], v57 offset:1024
    v_mfma_f32_16x16x32_bf16 v[200:203], a[68:71], a[88:91], v[200:203]
    v_mfma_f32_16x16x32_bf16 v[168:171], a[68:71], a[84:87], v[168:171]
    buffer_load_dwordx4 v16, s[8:11], s28 offen offset:3072 lds
    v_mfma_f32_16x16x32_bf16 v[136:139], a[68:71], a[80:83], v[136:139]
    v_mfma_f32_16x16x32_bf16 v[140:143], a[72:75], a[80:83], v[140:143]
    v_mfma_f32_16x16x32_bf16 v[172:175], a[72:75], a[84:87], v[172:175]
    v_mfma_f32_16x16x32_bf16 v[204:207], a[72:75], a[88:91], v[204:207]
    v_mfma_f32_16x16x32_bf16 v[236:239], a[72:75], a[92:95], v[236:239]
    v_mfma_f32_16x16x32_bf16 v[240:243], a[76:79], a[92:95], v[240:243]
    v_mfma_f32_16x16x32_bf16 v[208:211], a[76:79], a[88:91], v[208:211]
    v_mfma_f32_16x16x32_bf16 v[176:179], a[76:79], a[84:87], v[176:179]
    v_mfma_f32_16x16x32_bf16 v[144:147], a[76:79], a[80:83], v[144:147]
    s_waitcnt lgkmcnt(0)
    v_mfma_f32_16x16x32_bf16 v[100:103], a[0:3], v[32:35], v[100:103]
    ds_read_b64_tr_b16 a[48:49], v50 offset:8192
    v_mfma_f32_16x16x32_bf16 v[104:107], a[4:7], v[32:35], v[104:107]
    s_add_u32 s28, s28, 16384
    s_mov_b32 m0, s30
    ds_read_b64_tr_b16 a[50:51], v50 offset:9216
    v_mfma_f32_16x16x32_bf16 v[116:119], a[0:3], a[32:35], v[116:119]
    buffer_load_dwordx4 v17, s[12:15], s29 offen offset:0 lds
    v_mfma_f32_16x16x32_bf16 v[148:151], a[0:3], a[36:39], v[148:151]
    ds_read_b64_tr_b16 a[52:53], v51 offset:8192
    v_mfma_f32_16x16x32_bf16 v[180:183], a[0:3], a[40:43], v[180:183]
    ds_read_b64_tr_b16 a[54:55], v51 offset:9216
    v_mfma_f32_16x16x32_bf16 v[212:215], a[0:3], a[44:47], v[212:215]
    ds_read_b128 a[80:83], v49 offset:0
    v_mfma_f32_16x16x32_bf16 v[216:219], a[4:7], a[44:47], v[216:219]
    ds_read_b128 a[84:87], v49 offset:2048
    v_mfma_f32_16x16x32_bf16 v[184:187], a[4:7], a[40:43], v[184:187]
    ds_read_b128 a[88:91], v49 offset:4096
    v_mfma_f32_16x16x32_bf16 v[152:155], a[4:7], a[36:39], v[152:155]
    ds_read_b128 a[92:95], v49 offset:6144
    v_mfma_f32_16x16x32_bf16 v[120:123], a[4:7], a[32:35], v[120:123]
    buffer_load_dwordx4 v18, s[12:15], s29 offen offset:1024 lds
    v_mfma_f32_16x16x32_bf16 v[124:127], a[8:11], a[32:35], v[124:127]
    ds_read_b64_tr_b16 a[56:57], v52 offset:8192
    v_mfma_f32_16x16x32_bf16 v[156:159], a[8:11], a[36:39], v[156:159]
    ds_read_b64_tr_b16 a[58:59], v52 offset:9216
    v_mfma_f32_16x16x32_bf16 v[188:191], a[8:11], a[40:43], v[188:191]
    ds_read_b64_tr_b16 a[60:61], v53 offset:8192
    v_mfma_f32_16x16x32_bf16 v[220:223], a[8:11], a[44:47], v[220:223]
    ds_read_b64_tr_b16 a[62:63], v53 offset:9216
    v_mfma_f32_16x16x32_bf16 v[224:227], a[12:15], a[44:47], v[224:227]
    ds_read_b64_tr_b16 a[64:65], v54 offset:8192
    v_mfma_f32_16x16x32_bf16 v[192:195], a[12:15], a[40:43], v[192:195]
    s_waitcnt lgkmcnt(9)
    ds_read_b64_tr_b16 a[66:67], v54 offset:9216
    v_mfma_f32_16x16x32_bf16 v[100:103], a[48:51], v[32:35], v[100:103]
    ds_read_b64_tr_b16 a[68:69], v55 offset:8192
    v_mfma_f32_16x16x32_bf16 v[104:107], a[52:55], v[32:35], v[104:107]
    buffer_load_dwordx4 v17, s[12:15], s29 offen offset:2048 lds
    v_mfma_f32_16x16x32_bf16 v[160:163], a[12:15], a[36:39], v[160:163]
    ds_read_b64_tr_b16 a[70:71], v55 offset:9216
    v_mfma_f32_16x16x32_bf16 v[128:131], a[12:15], a[32:35], v[128:131]
    ds_read_b64_tr_b16 a[72:73], v56 offset:8192
    v_mfma_f32_16x16x32_bf16 v[132:135], a[16:19], a[32:35], v[132:135]
    ds_read_b64_tr_b16 a[74:75], v56 offset:9216
    v_mfma_f32_16x16x32_bf16 v[164:167], a[16:19], a[36:39], v[164:167]
    ds_read_b64_tr_b16 a[76:77], v57 offset:8192
    v_mfma_f32_16x16x32_bf16 v[196:199], a[16:19], a[40:43], v[196:199]
    ds_read_b64_tr_b16 a[78:79], v57 offset:9216
    v_mfma_f32_16x16x32_bf16 v[228:231], a[16:19], a[44:47], v[228:231]
    ds_write_b128 v58, v[100:103] offset:0
    v_mfma_f32_16x16x32_bf16 v[232:235], a[20:23], a[44:47], v[232:235]
    buffer_load_dwordx4 v18, s[12:15], s29 offen offset:3072 lds
    v_mfma_f32_16x16x32_bf16 v[200:203], a[20:23], a[40:43], v[200:203]
    ds_write_b128 v58, v[104:107] offset:64
    v_mfma_f32_16x16x32_bf16 v[168:171], a[20:23], a[36:39], v[168:171]
    ds_write_b128 v58, v[100:103] offset:512
    v_mfma_f32_16x16x32_bf16 v[136:139], a[20:23], a[32:35], v[136:139]
    ds_write_b128 v58, v[104:107] offset:576
    v_mfma_f32_16x16x32_bf16 v[140:143], a[24:27], a[32:35], v[140:143]
    v_mfma_f32_16x16x32_bf16 v[172:175], a[24:27], a[36:39], v[172:175]
    v_mfma_f32_16x16x32_bf16 v[204:207], a[24:27], a[40:43], v[204:207]
    v_mfma_f32_16x16x32_bf16 v[236:239], a[24:27], a[44:47], v[236:239]
    v_mfma_f32_16x16x32_bf16 v[240:243], a[28:31], a[44:47], v[240:243]
    v_mfma_f32_16x16x32_bf16 v[208:211], a[28:31], a[40:43], v[208:211]
    v_mfma_f32_16x16x32_bf16 v[176:179], a[28:31], a[36:39], v[176:179]
    v_mfma_f32_16x16x32_bf16 v[144:147], a[28:31], a[32:35], v[144:147]
    s_add_u32 s29, s29, 16384
    s_waitcnt vmcnt(10) lgkmcnt(0)
    s_barrier
    v_mfma_f32_16x16x32_bf16 v[116:119], a[48:51], a[80:83], v[116:119]
    ds_read_b128 v[68:71], v58 offset:0
    v_mfma_f32_16x16x32_bf16 v[120:123], a[52:55], a[80:83], v[120:123]
    ds_read_b128 v[72:75], v58 offset:64
    v_mul_f32 v109, s44, v109
    v_mfma_f32_16x16x32_bf16 v[124:127], a[56:59], a[80:83], v[124:127]
    ds_read_b128 v[76:79], v58 offset:128
    v_mul_f32 v111, s44, v111
    v_mfma_f32_16x16x32_bf16 v[128:131], a[60:63], a[80:83], v[128:131]
    ds_read_b128 v[80:83], v58 offset:192
    v_mul_f32 v113, s44, v113
    v_mfma_f32_16x16x32_bf16 v[132:135], a[64:67], a[80:83], v[132:135]
    ds_read_b128 v[84:87], v58 offset:256
    v_mfma_f32_16x16x32_bf16 v[136:139], a[68:71], a[80:83], v[136:139]
    ds_read_b128 v[88:91], v58 offset:320
    v_mul_f32 v115, s44, v115
    v_mfma_f32_16x16x32_bf16 v[140:143], a[72:75], a[80:83], v[140:143]
    ds_read_b128 v[92:95], v58 offset:384
    v_and_b32 v253, 7, v19
    v_mfma_f32_16x16x32_bf16 v[144:147], a[76:79], a[80:83], v[144:147]
    ds_read_b128 v[96:99], v58 offset:448
    v_lshlrev_b32 v253, 5, v253
    v_mfma_f32_16x16x32_bf16 v[148:151], a[48:51], a[84:87], v[148:151]
    ds_read_b128 a[128:131], v1 offset:49152
    v_mfma_f32_16x16x32_bf16 v[152:155], a[52:55], a[84:87], v[152:155]
    ds_read_b128 a[132:135], v2 offset:49152
    v_mfma_f32_16x16x32_bf16 v[156:159], a[56:59], a[84:87], v[156:159]
    ds_read_b128 a[136:139], v3 offset:49152
    v_mfma_f32_16x16x32_bf16 v[160:163], a[60:63], a[84:87], v[160:163]
    ds_read_b128 a[140:143], v4 offset:49152
    v_mfma_f32_16x16x32_bf16 v[164:167], a[64:67], a[84:87], v[164:167]
    ds_read_b128 a[144:147], v1 offset:53248
    v_mfma_f32_16x16x32_bf16 v[168:171], a[68:71], a[84:87], v[168:171]
    ds_read_b128 a[148:151], v2 offset:53248
    v_mfma_f32_16x16x32_bf16 v[172:175], a[72:75], a[84:87], v[172:175]
    ds_read_b128 a[152:155], v3 offset:53248
    v_mfma_f32_16x16x32_bf16 v[176:179], a[76:79], a[84:87], v[176:179]
    ds_read_b128 a[156:159], v4 offset:53248
    buffer_load_dword v252, v253, s[92:95], 0 offen sc1
    s_waitcnt lgkmcnt(8)
    v_pk_fma_f32 v[116:117], v[108:109], v[68:69], v[116:117] op_sel_hi:[0,1,1] neg_lo:[1,0,0] neg_hi:[1,0,0]
    v_pk_fma_f32 v[118:119], v[108:109], v[70:71], v[118:119] op_sel_hi:[0,1,1] neg_lo:[1,0,0] neg_hi:[1,0,0]
    v_pk_fma_f32 v[120:121], v[108:109], v[72:73], v[120:121] op_sel_hi:[0,1,1] neg_lo:[1,0,0] neg_hi:[1,0,0]
    v_pk_fma_f32 v[122:123], v[108:109], v[74:75], v[122:123] op_sel_hi:[0,1,1] neg_lo:[1,0,0] neg_hi:[1,0,0]
    v_pk_fma_f32 v[124:125], v[108:109], v[76:77], v[124:125] op_sel_hi:[0,1,1] neg_lo:[1,0,0] neg_hi:[1,0,0]
    v_pk_fma_f32 v[126:127], v[108:109], v[78:79], v[126:127] op_sel_hi:[0,1,1] neg_lo:[1,0,0] neg_hi:[1,0,0]
    v_pk_fma_f32 v[128:129], v[108:109], v[80:81], v[128:129] op_sel_hi:[0,1,1] neg_lo:[1,0,0] neg_hi:[1,0,0]
    v_pk_fma_f32 v[130:131], v[108:109], v[82:83], v[130:131] op_sel_hi:[0,1,1] neg_lo:[1,0,0] neg_hi:[1,0,0]
    v_pk_fma_f32 v[132:133], v[108:109], v[84:85], v[132:133] op_sel_hi:[0,1,1] neg_lo:[1,0,0] neg_hi:[1,0,0]
    v_pk_fma_f32 v[134:135], v[108:109], v[86:87], v[134:135] op_sel_hi:[0,1,1] neg_lo:[1,0,0] neg_hi:[1,0,0]
    v_pk_fma_f32 v[136:137], v[108:109], v[88:89], v[136:137] op_sel_hi:[0,1,1] neg_lo:[1,0,0] neg_hi:[1,0,0]
    v_pk_fma_f32 v[138:139], v[108:109], v[90:91], v[138:139] op_sel_hi:[0,1,1] neg_lo:[1,0,0] neg_hi:[1,0,0]
    v_pk_fma_f32 v[140:141], v[108:109], v[92:93], v[140:141] op_sel_hi:[0,1,1] neg_lo:[1,0,0] neg_hi:[1,0,0]
    v_pk_fma_f32 v[142:143], v[108:109], v[94:95], v[142:143] op_sel_hi:[0,1,1] neg_lo:[1,0,0] neg_hi:[1,0,0]
    v_pk_fma_f32 v[144:145], v[108:109], v[96:97], v[144:145] op_sel_hi:[0,1,1] neg_lo:[1,0,0] neg_hi:[1,0,0]
    v_pk_fma_f32 v[146:147], v[108:109], v[98:99], v[146:147] op_sel_hi:[0,1,1] neg_lo:[1,0,0] neg_hi:[1,0,0]
    v_pk_mul_f32 v[116:117], v[116:117], v[108:109] op_sel:[0,1] op_sel_hi:[1,1]
    v_pk_mul_f32 v[118:119], v[118:119], v[108:109] op_sel:[0,1] op_sel_hi:[1,1]
    v_pk_mul_f32 v[120:121], v[120:121], v[108:109] op_sel:[0,1] op_sel_hi:[1,1]
    v_pk_mul_f32 v[122:123], v[122:123], v[108:109] op_sel:[0,1] op_sel_hi:[1,1]
    v_pk_mul_f32 v[124:125], v[124:125], v[108:109] op_sel:[0,1] op_sel_hi:[1,1]
    v_pk_mul_f32 v[126:127], v[126:127], v[108:109] op_sel:[0,1] op_sel_hi:[1,1]
    v_pk_mul_f32 v[128:129], v[128:129], v[108:109] op_sel:[0,1] op_sel_hi:[1,1]
    v_pk_mul_f32 v[130:131], v[130:131], v[108:109] op_sel:[0,1] op_sel_hi:[1,1]
    v_pk_mul_f32 v[132:133], v[132:133], v[108:109] op_sel:[0,1] op_sel_hi:[1,1]
    v_pk_mul_f32 v[134:135], v[134:135], v[108:109] op_sel:[0,1] op_sel_hi:[1,1]
    v_pk_mul_f32 v[136:137], v[136:137], v[108:109] op_sel:[0,1] op_sel_hi:[1,1]
    v_pk_mul_f32 v[138:139], v[138:139], v[108:109] op_sel:[0,1] op_sel_hi:[1,1]
    v_pk_mul_f32 v[140:141], v[140:141], v[108:109] op_sel:[0,1] op_sel_hi:[1,1]
    v_pk_mul_f32 v[142:143], v[142:143], v[108:109] op_sel:[0,1] op_sel_hi:[1,1]
    v_pk_mul_f32 v[144:145], v[144:145], v[108:109] op_sel:[0,1] op_sel_hi:[1,1]
    v_pk_mul_f32 v[146:147], v[146:147], v[108:109] op_sel:[0,1] op_sel_hi:[1,1]
    v_mfma_f32_16x16x32_bf16 v[180:183], a[48:51], a[88:91], v[180:183]
    ds_read_b128 a[160:163], v1 offset:57344
    v_cvt_pk_bf16_f32 v36, v116, v117
    v_cvt_pk_bf16_f32 v37, v118, v119
    v_cvt_pk_bf16_f32 v38, v120, v121
    v_cvt_pk_bf16_f32 v39, v122, v123
    v_mfma_f32_16x16x32_bf16 v[184:187], a[52:55], a[88:91], v[184:187]
    ds_read_b128 a[164:167], v2 offset:57344
    v_cvt_pk_bf16_f32 v40, v124, v125
    v_cvt_pk_bf16_f32 v41, v126, v127
    v_cvt_pk_bf16_f32 v42, v128, v129
    v_cvt_pk_bf16_f32 v43, v130, v131
    v_mfma_f32_16x16x32_bf16 v[188:191], a[56:59], a[88:91], v[188:191]
    ds_read_b128 a[168:171], v3 offset:57344
    v_cvt_pk_bf16_f32 v44, v132, v133
    v_cvt_pk_bf16_f32 v45, v134, v135
    v_cvt_pk_bf16_f32 v46, v136, v137
    v_cvt_pk_bf16_f32 v47, v138, v139
    v_mfma_f32_16x16x32_bf16 v[192:195], a[60:63], a[88:91], v[192:195]
    ds_read_b128 a[172:175], v4 offset:57344
    v_cvt_pk_bf16_f32 v48, v140, v141
    v_cvt_pk_bf16_f32 v49, v142, v143
    v_cvt_pk_bf16_f32 v50, v144, v145
    v_cvt_pk_bf16_f32 v51, v146, v147
    v_mfma_f32_16x16x32_bf16 v[196:199], a[64:67], a[88:91], v[196:199]
    ds_read_b128 a[176:179], v1 offset:61440
    v_permlane32_swap_b32 v36, v38
    v_permlane32_swap_b32 v37, v39
    v_permlane32_swap_b32 v40, v42
    v_permlane32_swap_b32 v41, v43
    v_mfma_f32_16x16x32_bf16 v[200:203], a[68:71], a[88:91], v[200:203]
    ds_read_b128 a[180:183], v2 offset:61440
    v_permlane32_swap_b32 v44, v46
    v_permlane32_swap_b32 v45, v47
    v_permlane32_swap_b32 v48, v50
    v_permlane32_swap_b32 v49, v51
    v_mfma_f32_16x16x32_bf16 v[204:207], a[72:75], a[88:91], v[204:207]
    ds_read_b128 a[184:187], v3 offset:61440
    v_permlane16_swap_b32 v36, v38
    v_permlane16_swap_b32 v37, v39
    v_permlane16_swap_b32 v40, v42
    v_permlane16_swap_b32 v41, v43
    v_mfma_f32_16x16x32_bf16 v[208:211], a[76:79], a[88:91], v[208:211]
    ds_read_b128 a[188:191], v4 offset:61440
    v_permlane16_swap_b32 v44, v46
    v_permlane16_swap_b32 v45, v47
    v_permlane16_swap_b32 v48, v50
    v_permlane16_swap_b32 v49, v51
    v_pk_fma_f32 v[148:149], v[110:111], v[68:69], v[148:149] op_sel_hi:[0,1,1] neg_lo:[1,0,0] neg_hi:[1,0,0]
    v_pk_fma_f32 v[150:151], v[110:111], v[70:71], v[150:151] op_sel_hi:[0,1,1] neg_lo:[1,0,0] neg_hi:[1,0,0]
    v_pk_fma_f32 v[152:153], v[110:111], v[72:73], v[152:153] op_sel_hi:[0,1,1] neg_lo:[1,0,0] neg_hi:[1,0,0]
    v_pk_fma_f32 v[154:155], v[110:111], v[74:75], v[154:155] op_sel_hi:[0,1,1] neg_lo:[1,0,0] neg_hi:[1,0,0]
    v_pk_fma_f32 v[156:157], v[110:111], v[76:77], v[156:157] op_sel_hi:[0,1,1] neg_lo:[1,0,0] neg_hi:[1,0,0]
    v_pk_fma_f32 v[158:159], v[110:111], v[78:79], v[158:159] op_sel_hi:[0,1,1] neg_lo:[1,0,0] neg_hi:[1,0,0]
    v_pk_fma_f32 v[160:161], v[110:111], v[80:81], v[160:161] op_sel_hi:[0,1,1] neg_lo:[1,0,0] neg_hi:[1,0,0]
    v_pk_fma_f32 v[162:163], v[110:111], v[82:83], v[162:163] op_sel_hi:[0,1,1] neg_lo:[1,0,0] neg_hi:[1,0,0]
    v_pk_fma_f32 v[164:165], v[110:111], v[84:85], v[164:165] op_sel_hi:[0,1,1] neg_lo:[1,0,0] neg_hi:[1,0,0]
    v_pk_fma_f32 v[166:167], v[110:111], v[86:87], v[166:167] op_sel_hi:[0,1,1] neg_lo:[1,0,0] neg_hi:[1,0,0]
    v_pk_fma_f32 v[168:169], v[110:111], v[88:89], v[168:169] op_sel_hi:[0,1,1] neg_lo:[1,0,0] neg_hi:[1,0,0]
    v_pk_fma_f32 v[170:171], v[110:111], v[90:91], v[170:171] op_sel_hi:[0,1,1] neg_lo:[1,0,0] neg_hi:[1,0,0]
    v_pk_fma_f32 v[172:173], v[110:111], v[92:93], v[172:173] op_sel_hi:[0,1,1] neg_lo:[1,0,0] neg_hi:[1,0,0]
    v_pk_fma_f32 v[174:175], v[110:111], v[94:95], v[174:175] op_sel_hi:[0,1,1] neg_lo:[1,0,0] neg_hi:[1,0,0]
    v_pk_fma_f32 v[176:177], v[110:111], v[96:97], v[176:177] op_sel_hi:[0,1,1] neg_lo:[1,0,0] neg_hi:[1,0,0]
    v_pk_fma_f32 v[178:179], v[110:111], v[98:99], v[178:179] op_sel_hi:[0,1,1] neg_lo:[1,0,0] neg_hi:[1,0,0]
    v_pk_mul_f32 v[148:149], v[148:149], v[110:111] op_sel:[0,1] op_sel_hi:[1,1]
    v_pk_mul_f32 v[150:151], v[150:151], v[110:111] op_sel:[0,1] op_sel_hi:[1,1]
    v_pk_mul_f32 v[152:153], v[152:153], v[110:111] op_sel:[0,1] op_sel_hi:[1,1]
    v_pk_mul_f32 v[154:155], v[154:155], v[110:111] op_sel:[0,1] op_sel_hi:[1,1]
    v_pk_mul_f32 v[156:157], v[156:157], v[110:111] op_sel:[0,1] op_sel_hi:[1,1]
    v_pk_mul_f32 v[158:159], v[158:159], v[110:111] op_sel:[0,1] op_sel_hi:[1,1]
    v_pk_mul_f32 v[160:161], v[160:161], v[110:111] op_sel:[0,1] op_sel_hi:[1,1]
    v_pk_mul_f32 v[162:163], v[162:163], v[110:111] op_sel:[0,1] op_sel_hi:[1,1]
    v_pk_mul_f32 v[164:165], v[164:165], v[110:111] op_sel:[0,1] op_sel_hi:[1,1]
    v_pk_mul_f32 v[166:167], v[166:167], v[110:111] op_sel:[0,1] op_sel_hi:[1,1]
    v_pk_mul_f32 v[168:169], v[168:169], v[110:111] op_sel:[0,1] op_sel_hi:[1,1]
    v_pk_mul_f32 v[170:171], v[170:171], v[110:111] op_sel:[0,1] op_sel_hi:[1,1]
    v_pk_mul_f32 v[172:173], v[172:173], v[110:111] op_sel:[0,1] op_sel_hi:[1,1]
    v_pk_mul_f32 v[174:175], v[174:175], v[110:111] op_sel:[0,1] op_sel_hi:[1,1]
    v_pk_mul_f32 v[176:177], v[176:177], v[110:111] op_sel:[0,1] op_sel_hi:[1,1]
    v_pk_mul_f32 v[178:179], v[178:179], v[110:111] op_sel:[0,1] op_sel_hi:[1,1]
    v_mfma_f32_16x16x32_bf16 v[212:215], a[48:51], a[92:95], v[212:215]
    s_add_u32 m0, s47, 0
    s_nop 0
    buffer_load_dwordx4 v20, s[96:99], 0 offen lds
    v_cvt_pk_bf16_f32 v52, v148, v149
    v_cvt_pk_bf16_f32 v53, v150, v151
    v_cvt_pk_bf16_f32 v54, v152, v153
    v_cvt_pk_bf16_f32 v55, v154, v155
    v_mfma_f32_16x16x32_bf16 v[216:219], a[52:55], a[92:95], v[216:219]
    s_add_u32 m0, s47, 1024
    s_nop 0
    buffer_load_dwordx4 v21, s[96:99], 0 offen lds
    v_cvt_pk_bf16_f32 v56, v156, v157
    v_cvt_pk_bf16_f32 v57, v158, v159
    v_cvt_pk_bf16_f32 v58, v160, v161
    v_cvt_pk_bf16_f32 v59, v162, v163
    v_mfma_f32_16x16x32_bf16 v[220:223], a[56:59], a[92:95], v[220:223]
    s_add_u32 m0, s47, 2048
    s_nop 0
    buffer_load_dwordx4 v22, s[96:99], 0 offen lds
    v_cvt_pk_bf16_f32 v60, v164, v165
    v_cvt_pk_bf16_f32 v61, v166, v167
    v_cvt_pk_bf16_f32 v62, v168, v169
    v_cvt_pk_bf16_f32 v63, v170, v171
    v_mfma_f32_16x16x32_bf16 v[224:227], a[60:63], a[92:95], v[224:227]
    s_add_u32 m0, s47, 3072
    s_nop 0
    buffer_load_dwordx4 v23, s[96:99], 0 offen lds
    v_cvt_pk_bf16_f32 v64, v172, v173
    v_cvt_pk_bf16_f32 v65, v174, v175
    v_cvt_pk_bf16_f32 v66, v176, v177
    v_cvt_pk_bf16_f32 v67, v178, v179
    v_mfma_f32_16x16x32_bf16 v[228:231], a[64:67], a[92:95], v[228:231]
    s_add_u32 m0, s47, 4096
    s_nop 0
    buffer_load_dwordx4 v24, s[96:99], 0 offen lds
    v_permlane32_swap_b32 v52, v54
    v_permlane32_swap_b32 v53, v55
    v_permlane32_swap_b32 v56, v58
    v_permlane32_swap_b32 v57, v59
    v_mfma_f32_16x16x32_bf16 v[232:235], a[68:71], a[92:95], v[232:235]
    v_permlane32_swap_b32 v60, v62
    v_permlane32_swap_b32 v61, v63
    v_permlane32_swap_b32 v64, v66
    v_permlane32_swap_b32 v65, v67
    v_mfma_f32_16x16x32_bf16 v[236:239], a[72:75], a[92:95], v[236:239]
    v_permlane16_swap_b32 v52, v54
    v_permlane16_swap_b32 v53, v55
    v_permlane16_swap_b32 v56, v58
    v_permlane16_swap_b32 v57, v59
    v_mfma_f32_16x16x32_bf16 v[240:243], a[76:79], a[92:95], v[240:243]
    v_permlane16_swap_b32 v60, v62
    v_permlane16_swap_b32 v61, v63
    v_permlane16_swap_b32 v64, v66
    v_permlane16_swap_b32 v65, v67
    v_pk_fma_f32 v[180:181], v[112:113], v[68:69], v[180:181] op_sel_hi:[0,1,1] neg_lo:[1,0,0] neg_hi:[1,0,0]
    v_pk_fma_f32 v[182:183], v[112:113], v[70:71], v[182:183] op_sel_hi:[0,1,1] neg_lo:[1,0,0] neg_hi:[1,0,0]
    v_pk_fma_f32 v[184:185], v[112:113], v[72:73], v[184:185] op_sel_hi:[0,1,1] neg_lo:[1,0,0] neg_hi:[1,0,0]
    v_pk_fma_f32 v[186:187], v[112:113], v[74:75], v[186:187] op_sel_hi:[0,1,1] neg_lo:[1,0,0] neg_hi:[1,0,0]
    v_pk_fma_f32 v[188:189], v[112:113], v[76:77], v[188:189] op_sel_hi:[0,1,1] neg_lo:[1,0,0] neg_hi:[1,0,0]
    v_pk_fma_f32 v[190:191], v[112:113], v[78:79], v[190:191] op_sel_hi:[0,1,1] neg_lo:[1,0,0] neg_hi:[1,0,0]
    v_pk_fma_f32 v[192:193], v[112:113], v[80:81], v[192:193] op_sel_hi:[0,1,1] neg_lo:[1,0,0] neg_hi:[1,0,0]
    v_pk_fma_f32 v[194:195], v[112:113], v[82:83], v[194:195] op_sel_hi:[0,1,1] neg_lo:[1,0,0] neg_hi:[1,0,0]
    v_pk_fma_f32 v[196:197], v[112:113], v[84:85], v[196:197] op_sel_hi:[0,1,1] neg_lo:[1,0,0] neg_hi:[1,0,0]
    v_pk_fma_f32 v[198:199], v[112:113], v[86:87], v[198:199] op_sel_hi:[0,1,1] neg_lo:[1,0,0] neg_hi:[1,0,0]
    v_pk_fma_f32 v[200:201], v[112:113], v[88:89], v[200:201] op_sel_hi:[0,1,1] neg_lo:[1,0,0] neg_hi:[1,0,0]
    v_pk_fma_f32 v[202:203], v[112:113], v[90:91], v[202:203] op_sel_hi:[0,1,1] neg_lo:[1,0,0] neg_hi:[1,0,0]
    v_pk_fma_f32 v[204:205], v[112:113], v[92:93], v[204:205] op_sel_hi:[0,1,1] neg_lo:[1,0,0] neg_hi:[1,0,0]
    v_pk_fma_f32 v[206:207], v[112:113], v[94:95], v[206:207] op_sel_hi:[0,1,1] neg_lo:[1,0,0] neg_hi:[1,0,0]
    v_pk_fma_f32 v[208:209], v[112:113], v[96:97], v[208:209] op_sel_hi:[0,1,1] neg_lo:[1,0,0] neg_hi:[1,0,0]
    v_pk_fma_f32 v[210:211], v[112:113], v[98:99], v[210:211] op_sel_hi:[0,1,1] neg_lo:[1,0,0] neg_hi:[1,0,0]
    v_pk_mul_f32 v[180:181], v[180:181], v[112:113] op_sel:[0,1] op_sel_hi:[1,1]
    v_pk_mul_f32 v[182:183], v[182:183], v[112:113] op_sel:[0,1] op_sel_hi:[1,1]
    v_pk_mul_f32 v[184:185], v[184:185], v[112:113] op_sel:[0,1] op_sel_hi:[1,1]
    v_pk_mul_f32 v[186:187], v[186:187], v[112:113] op_sel:[0,1] op_sel_hi:[1,1]
    v_pk_mul_f32 v[188:189], v[188:189], v[112:113] op_sel:[0,1] op_sel_hi:[1,1]
    v_pk_mul_f32 v[190:191], v[190:191], v[112:113] op_sel:[0,1] op_sel_hi:[1,1]
    v_pk_mul_f32 v[192:193], v[192:193], v[112:113] op_sel:[0,1] op_sel_hi:[1,1]
    v_pk_mul_f32 v[194:195], v[194:195], v[112:113] op_sel:[0,1] op_sel_hi:[1,1]
    v_pk_mul_f32 v[196:197], v[196:197], v[112:113] op_sel:[0,1] op_sel_hi:[1,1]
    v_pk_mul_f32 v[198:199], v[198:199], v[112:113] op_sel:[0,1] op_sel_hi:[1,1]
    v_pk_mul_f32 v[200:201], v[200:201], v[112:113] op_sel:[0,1] op_sel_hi:[1,1]
    v_pk_mul_f32 v[202:203], v[202:203], v[112:113] op_sel:[0,1] op_sel_hi:[1,1]
    v_pk_mul_f32 v[204:205], v[204:205], v[112:113] op_sel:[0,1] op_sel_hi:[1,1]
    v_pk_mul_f32 v[206:207], v[206:207], v[112:113] op_sel:[0,1] op_sel_hi:[1,1]
    v_pk_mul_f32 v[208:209], v[208:209], v[112:113] op_sel:[0,1] op_sel_hi:[1,1]
    v_pk_mul_f32 v[210:211], v[210:211], v[112:113] op_sel:[0,1] op_sel_hi:[1,1]
    v_pk_fma_f32 v[212:213], v[114:115], v[68:69], v[212:213] op_sel_hi:[0,1,1] neg_lo:[1,0,0] neg_hi:[1,0,0]
    v_pk_fma_f32 v[214:215], v[114:115], v[70:71], v[214:215] op_sel_hi:[0,1,1] neg_lo:[1,0,0] neg_hi:[1,0,0]
    v_pk_fma_f32 v[216:217], v[114:115], v[72:73], v[216:217] op_sel_hi:[0,1,1] neg_lo:[1,0,0] neg_hi:[1,0,0]
    v_pk_fma_f32 v[218:219], v[114:115], v[74:75], v[218:219] op_sel_hi:[0,1,1] neg_lo:[1,0,0] neg_hi:[1,0,0]
    v_pk_fma_f32 v[220:221], v[114:115], v[76:77], v[220:221] op_sel_hi:[0,1,1] neg_lo:[1,0,0] neg_hi:[1,0,0]
    v_pk_fma_f32 v[222:223], v[114:115], v[78:79], v[222:223] op_sel_hi:[0,1,1] neg_lo:[1,0,0] neg_hi:[1,0,0]
    v_pk_fma_f32 v[224:225], v[114:115], v[80:81], v[224:225] op_sel_hi:[0,1,1] neg_lo:[1,0,0] neg_hi:[1,0,0]
    v_pk_fma_f32 v[226:227], v[114:115], v[82:83], v[226:227] op_sel_hi:[0,1,1] neg_lo:[1,0,0] neg_hi:[1,0,0]
    v_pk_fma_f32 v[228:229], v[114:115], v[84:85], v[228:229] op_sel_hi:[0,1,1] neg_lo:[1,0,0] neg_hi:[1,0,0]
    v_pk_fma_f32 v[230:231], v[114:115], v[86:87], v[230:231] op_sel_hi:[0,1,1] neg_lo:[1,0,0] neg_hi:[1,0,0]
    v_pk_fma_f32 v[232:233], v[114:115], v[88:89], v[232:233] op_sel_hi:[0,1,1] neg_lo:[1,0,0] neg_hi:[1,0,0]
    v_pk_fma_f32 v[234:235], v[114:115], v[90:91], v[234:235] op_sel_hi:[0,1,1] neg_lo:[1,0,0] neg_hi:[1,0,0]
    v_pk_fma_f32 v[236:237], v[114:115], v[92:93], v[236:237] op_sel_hi:[0,1,1] neg_lo:[1,0,0] neg_hi:[1,0,0]
    v_pk_fma_f32 v[238:239], v[114:115], v[94:95], v[238:239] op_sel_hi:[0,1,1] neg_lo:[1,0,0] neg_hi:[1,0,0]
    v_pk_fma_f32 v[240:241], v[114:115], v[96:97], v[240:241] op_sel_hi:[0,1,1] neg_lo:[1,0,0] neg_hi:[1,0,0]
    v_pk_fma_f32 v[242:243], v[114:115], v[98:99], v[242:243] op_sel_hi:[0,1,1] neg_lo:[1,0,0] neg_hi:[1,0,0]
    s_waitcnt lgkmcnt(0)
    v_mfma_f32_16x16x32_bf16 v[116:119], a[128:131], v[36:39], 0
    v_cvt_pk_bf16_f32 v68, v180, v181
    v_cvt_pk_bf16_f32 v69, v182, v183
    v_cvt_pk_bf16_f32 v70, v184, v185
    v_cvt_pk_bf16_f32 v71, v186, v187
    v_mfma_f32_16x16x32_bf16 v[116:119], a[132:135], v[40:43], v[116:119]
    v_cvt_pk_bf16_f32 v72, v188, v189
    v_cvt_pk_bf16_f32 v73, v190, v191
    v_cvt_pk_bf16_f32 v74, v192, v193
    v_cvt_pk_bf16_f32 v75, v194, v195
    v_mfma_f32_16x16x32_bf16 v[116:119], a[136:139], v[44:47], v[116:119]
    v_cvt_pk_bf16_f32 v76, v196, v197
    v_cvt_pk_bf16_f32 v77, v198, v199
    v_cvt_pk_bf16_f32 v78, v200, v201
    v_cvt_pk_bf16_f32 v79, v202, v203
    v_mfma_f32_16x16x32_bf16 v[116:119], a[140:143], v[48:51], v[116:119]
    v_cvt_pk_bf16_f32 v80, v204, v205
    v_cvt_pk_bf16_f32 v81, v206, v207
    v_cvt_pk_bf16_f32 v82, v208, v209
    v_cvt_pk_bf16_f32 v83, v210, v211
    v_mfma_f32_16x16x32_bf16 v[132:135], a[144:147], v[36:39], 0
    v_permlane32_swap_b32 v68, v70
    v_permlane32_swap_b32 v69, v71
    v_permlane32_swap_b32 v72, v74
    v_permlane32_swap_b32 v73, v75
    v_mfma_f32_16x16x32_bf16 v[132:135], a[148:151], v[40:43], v[132:135]
    v_permlane32_swap_b32 v76, v78
    v_permlane32_swap_b32 v77, v79
    v_permlane32_swap_b32 v80, v82
    v_permlane32_swap_b32 v81, v83
    v_mfma_f32_16x16x32_bf16 v[132:135], a[152:155], v[44:47], v[132:135]
    v_permlane16_swap_b32 v68, v70
    v_permlane16_swap_b32 v69, v71
    v_permlane16_swap_b32 v72, v74
    v_permlane16_swap_b32 v73, v75
    v_mfma_f32_16x16x32_bf16 v[132:135], a[156:159], v[48:51], v[132:135]
    v_permlane16_swap_b32 v76, v78
    v_permlane16_swap_b32 v77, v79
    v_permlane16_swap_b32 v80, v82
    v_permlane16_swap_b32 v81, v83
    v_pk_mul_f32 v[212:213], v[212:213], v[114:115] op_sel:[0,1] op_sel_hi:[1,1]
    v_pk_mul_f32 v[214:215], v[214:215], v[114:115] op_sel:[0,1] op_sel_hi:[1,1]
    v_pk_mul_f32 v[216:217], v[216:217], v[114:115] op_sel:[0,1] op_sel_hi:[1,1]
    v_pk_mul_f32 v[218:219], v[218:219], v[114:115] op_sel:[0,1] op_sel_hi:[1,1]
    v_pk_mul_f32 v[220:221], v[220:221], v[114:115] op_sel:[0,1] op_sel_hi:[1,1]
    v_pk_mul_f32 v[222:223], v[222:223], v[114:115] op_sel:[0,1] op_sel_hi:[1,1]
    v_pk_mul_f32 v[224:225], v[224:225], v[114:115] op_sel:[0,1] op_sel_hi:[1,1]
    v_pk_mul_f32 v[226:227], v[226:227], v[114:115] op_sel:[0,1] op_sel_hi:[1,1]
    v_pk_mul_f32 v[228:229], v[228:229], v[114:115] op_sel:[0,1] op_sel_hi:[1,1]
    v_pk_mul_f32 v[230:231], v[230:231], v[114:115] op_sel:[0,1] op_sel_hi:[1,1]
    v_pk_mul_f32 v[232:233], v[232:233], v[114:115] op_sel:[0,1] op_sel_hi:[1,1]
    v_pk_mul_f32 v[234:235], v[234:235], v[114:115] op_sel:[0,1] op_sel_hi:[1,1]
    v_pk_mul_f32 v[236:237], v[236:237], v[114:115] op_sel:[0,1] op_sel_hi:[1,1]
    v_pk_mul_f32 v[238:239], v[238:239], v[114:115] op_sel:[0,1] op_sel_hi:[1,1]
    v_pk_mul_f32 v[240:241], v[240:241], v[114:115] op_sel:[0,1] op_sel_hi:[1,1]
    v_pk_mul_f32 v[242:243], v[242:243], v[114:115] op_sel:[0,1] op_sel_hi:[1,1]
    v_mfma_f32_16x16x32_bf16 v[120:123], a[140:143], v[64:67], 0
    v_cvt_pk_bf16_f32 v84, v212, v213
    v_cvt_pk_bf16_f32 v85, v214, v215
    v_cvt_pk_bf16_f32 v86, v216, v217
    v_cvt_pk_bf16_f32 v87, v218, v219
    v_mfma_f32_16x16x32_bf16 v[120:123], a[136:139], v[60:63], v[120:123]
    v_cvt_pk_bf16_f32 v88, v220, v221
    v_cvt_pk_bf16_f32 v89, v222, v223
    v_cvt_pk_bf16_f32 v90, v224, v225
    v_cvt_pk_bf16_f32 v91, v226, v227
    v_mfma_f32_16x16x32_bf16 v[120:123], a[132:135], v[56:59], v[120:123]
    v_cvt_pk_bf16_f32 v92, v228, v229
    v_cvt_pk_bf16_f32 v93, v230, v231
    v_cvt_pk_bf16_f32 v94, v232, v233
    v_cvt_pk_bf16_f32 v95, v234, v235
    v_mfma_f32_16x16x32_bf16 v[120:123], a[128:131], v[52:55], v[120:123]
    v_cvt_pk_bf16_f32 v96, v236, v237
    v_cvt_pk_bf16_f32 v97, v238, v239
    v_cvt_pk_bf16_f32 v98, v240, v241
    v_cvt_pk_bf16_f32 v99, v242, v243
    v_mfma_f32_16x16x32_bf16 v[136:139], a[156:159], v[64:67], 0
    v_permlane32_swap_b32 v84, v86
    v_permlane32_swap_b32 v85, v87
    v_permlane32_swap_b32 v88, v90
    v_permlane32_swap_b32 v89, v91
    v_mfma_f32_16x16x32_bf16 v[136:139], a[152:155], v[60:63], v[136:139]
    v_permlane32_swap_b32 v92, v94
    v_permlane32_swap_b32 v93, v95
    v_permlane32_swap_b32 v96, v98
    v_permlane32_swap_b32 v97, v99
    v_mfma_f32_16x16x32_bf16 v[136:139], a[148:151], v[56:59], v[136:139]
    v_permlane16_swap_b32 v84, v86
    v_permlane16_swap_b32 v85, v87
    v_permlane16_swap_b32 v88, v90
    v_permlane16_swap_b32 v89, v91
    v_mfma_f32_16x16x32_bf16 v[136:139], a[144:147], v[52:55], v[136:139]
    v_permlane16_swap_b32 v92, v94
    v_permlane16_swap_b32 v93, v95
    v_permlane16_swap_b32 v96, v98
    v_permlane16_swap_b32 v97, v99
    v_mfma_f32_16x16x32_bf16 v[124:127], a[128:131], v[68:71], 0
    v_max3_f32 v28, v116, v117, v118
    v_max3_f32 v30, v120, v121, v122
    v_mfma_f32_16x16x32_bf16 v[124:127], a[132:135], v[72:75], v[124:127]
    v_max3_f32 v29, v119, v132, v133
    v_max3_f32 v31, v123, v136, v137
    v_max3_f32 v28, v28, v134, v135
    v_mfma_f32_16x16x32_bf16 v[124:127], a[136:139], v[76:79], v[124:127]
    v_max3_f32 v30, v30, v138, v139
    v_max_f32 v28, v28, v29
    v_max_f32 v30, v30, v31
    v_mfma_f32_16x16x32_bf16 v[124:127], a[140:143], v[80:83], v[124:127]
    v_mov_b32 v29, v28
    v_mov_b32 v31, v30
    s_nop 0
    v_permlane32_swap_b32 v28, v29
    v_mfma_f32_16x16x32_bf16 v[140:143], a[144:147], v[68:71], 0
    v_permlane32_swap_b32 v30, v31
    v_max_f32 v28, v28, v29
    v_mfma_f32_16x16x32_bf16 v[140:143], a[148:151], v[72:75], v[140:143]
    v_max_f32 v30, v30, v31
    v_mov_b32 v29, v28
    v_mov_b32 v31, v30
    v_mfma_f32_16x16x32_bf16 v[140:143], a[152:155], v[76:79], v[140:143]
    v_permlane16_swap_b32 v28, v29
    v_permlane16_swap_b32 v30, v31
    v_max_f32 v28, v28, v29
    v_mfma_f32_16x16x32_bf16 v[140:143], a[156:159], v[80:83], v[140:143]
    v_max_f32 v30, v30, v31
    v_sub_f32 v100, 0, v28
    v_sub_f32 v104, 0, v30
    v_mfma_f32_16x16x32_bf16 v[128:131], a[140:143], v[96:99], 0
    v_sub_f32 v101, 0, v28
    v_sub_f32 v105, 0, v30
    v_mfma_f32_16x16x32_bf16 v[128:131], a[136:139], v[92:95], v[128:131]
    v_sub_f32 v102, 0, v28
    v_sub_f32 v106, 0, v30
    v_sub_f32 v103, 0, v28
    v_mfma_f32_16x16x32_bf16 v[128:131], a[132:135], v[88:91], v[128:131]
    v_sub_f32 v107, 0, v30
    v_sub_f32 v116, v116, v28
    v_sub_f32 v120, v120, v30
    v_mfma_f32_16x16x32_bf16 v[128:131], a[128:131], v[84:87], v[128:131]
    v_sub_f32 v117, v117, v28
    v_sub_f32 v121, v121, v30
    v_sub_f32 v118, v118, v28
    v_mfma_f32_16x16x32_bf16 v[144:147], a[156:159], v[96:99], 0
    v_sub_f32 v122, v122, v30
    v_sub_f32 v119, v119, v28
    v_mfma_f32_16x16x32_bf16 v[144:147], a[152:155], v[92:95], v[144:147]
    v_sub_f32 v123, v123, v30
    v_sub_f32 v132, v132, v28
    v_sub_f32 v136, v136, v30
    v_mfma_f32_16x16x32_bf16 v[144:147], a[148:151], v[88:91], v[144:147]
    v_sub_f32 v133, v133, v28
    v_sub_f32 v137, v137, v30
    v_sub_f32 v134, v134, v28
    v_mfma_f32_16x16x32_bf16 v[144:147], a[144:147], v[84:87], v[144:147]
    v_sub_f32 v138, v138, v30
    v_sub_f32 v135, v135, v28
    v_sub_f32 v139, v139, v30
    s_waitcnt vmcnt(14)
    s_barrier
    v_mfma_f32_16x16x32_bf16 v[148:151], a[160:163], v[36:39], v[100:103]
    s_add_u32 m0, s34, 0
    s_nop 0
    s_nop 0
    s_nop 0
    v_mfma_f32_16x16x32_bf16 v[148:151], a[164:167], v[40:43], v[148:151]
    ds_read_b128 a[128:131], v1 offset:16384
    s_nop 0
    v_max3_f32 v32, v124, v125, v126
    v_max3_f32 v34, v128, v129, v130
    v_mfma_f32_16x16x32_bf16 v[148:151], a[168:171], v[44:47], v[148:151]
    ds_read_b128 a[132:135], v2 offset:16384
    v_max3_f32 v33, v127, v140, v141
    v_max3_f32 v35, v131, v144, v145
    v_max3_f32 v32, v32, v142, v143
    v_mfma_f32_16x16x32_bf16 v[148:151], a[172:175], v[48:51], v[148:151]
    buffer_load_dwordx4 v13, s[8:11], s28 offen offset:0 lds
    v_max3_f32 v34, v34, v146, v147
    v_max_f32 v32, v32, v33
    v_max_f32 v34, v34, v35
    v_mfma_f32_16x16x32_bf16 v[152:155], a[172:175], v[64:67], v[104:107]
    v_mov_b32 v33, v32
    v_mov_b32 v35, v34
    s_nop 0
    v_permlane32_swap_b32 v32, v33
    v_mfma_f32_16x16x32_bf16 v[152:155], a[168:171], v[60:63], v[152:155]
    v_permlane32_swap_b32 v34, v35
    v_max_f32 v32, v32, v33
    v_max_f32 v34, v34, v35
    v_mfma_f32_16x16x32_bf16 v[152:155], a[164:167], v[56:59], v[152:155]
    v_mov_b32 v33, v32
    v_mov_b32 v35, v34
    s_nop 0
    v_permlane16_swap_b32 v32, v33
    v_mfma_f32_16x16x32_bf16 v[152:155], a[160:163], v[52:55], v[152:155]
    v_permlane16_swap_b32 v34, v35
    v_max_f32 v32, v32, v33
    v_max_f32 v34, v34, v35
    v_mfma_f32_16x16x32_bf16 v[164:167], a[176:179], v[36:39], v[100:103]
    v_sub_f32 v108, 0, v32
    v_sub_f32 v112, 0, v34
    v_sub_f32 v109, 0, v32
    v_mfma_f32_16x16x32_bf16 v[164:167], a[180:183], v[40:43], v[164:167]
    v_sub_f32 v113, 0, v34
    v_sub_f32 v110, 0, v32
    v_sub_f32 v114, 0, v34
    v_mfma_f32_16x16x32_bf16 v[164:167], a[184:187], v[44:47], v[164:167]
    v_sub_f32 v111, 0, v32
    v_sub_f32 v115, 0, v34
    v_sub_f32 v124, v124, v32
    v_mfma_f32_16x16x32_bf16 v[164:167], a[188:191], v[48:51], v[164:167]
    v_sub_f32 v128, v128, v34
    v_sub_f32 v125, v125, v32
    v_sub_f32 v129, v129, v34
    v_mfma_f32_16x16x32_bf16 v[168:171], a[188:191], v[64:67], v[104:107]
    v_sub_f32 v126, v126, v32
    v_sub_f32 v130, v130, v34
    v_sub_f32 v127, v127, v32
    v_mfma_f32_16x16x32_bf16 v[168:171], a[184:187], v[60:63], v[168:171]
    v_sub_f32 v131, v131, v34
    v_sub_f32 v140, v140, v32
    v_sub_f32 v144, v144, v34
    v_mfma_f32_16x16x32_bf16 v[168:171], a[180:183], v[56:59], v[168:171]
    v_sub_f32 v141, v141, v32
    v_sub_f32 v145, v145, v34
    v_sub_f32 v142, v142, v32
    v_mfma_f32_16x16x32_bf16 v[168:171], a[176:179], v[52:55], v[168:171]
    v_sub_f32 v146, v146, v34
    v_sub_f32 v143, v143, v32
    v_sub_f32 v147, v147, v34
    s_nop 0
    v_mfma_f32_16x16x32_bf16 v[156:159], a[160:163], v[68:71], v[108:111]
    ds_read_b128 a[136:139], v3 offset:16384
    v_mfma_f32_16x16x32_bf16 v[156:159], a[164:167], v[72:75], v[156:159]
    ds_read_b128 a[140:143], v4 offset:16384
    v_mfma_f32_16x16x32_bf16 v[156:159], a[168:171], v[76:79], v[156:159]
    buffer_load_dwordx4 v14, s[8:11], s28 offen offset:1024 lds
    v_mfma_f32_16x16x32_bf16 v[156:159], a[172:175], v[80:83], v[156:159]
    v_mfma_f32_16x16x32_bf16 v[160:163], a[172:175], v[96:99], v[112:115]
    v_mfma_f32_16x16x32_bf16 v[160:163], a[168:171], v[92:95], v[160:163]
    v_mfma_f32_16x16x32_bf16 v[160:163], a[164:167], v[88:91], v[160:163]
    v_mfma_f32_16x16x32_bf16 v[160:163], a[160:163], v[84:87], v[160:163]
    s_waitcnt lgkmcnt(2)
    v_mfma_f32_16x16x32_bf16 v[172:175], a[176:179], v[68:71], v[108:111]
    s_waitcnt vmcnt(7)
    ds_read_b128 a[144:147], v1 offset:20480
    v_exp_f32 v116, v116
    v_mfma_f32_16x16x32_bf16 v[172:175], a[180:183], v[72:75], v[172:175]
    ds_read_b128 a[148:151], v2 offset:20480
    v_exp_f32 v117, v117
    v_mfma_f32_16x16x32_bf16 v[172:175], a[184:187], v[76:79], v[172:175]
    v_cvt_pk_bf16_f32 v180, v116, v117
    v_exp_f32 v118, v118
    v_mfma_f32_16x16x32_bf16 v[172:175], a[188:191], v[80:83], v[172:175]
    v_exp_f32 v119, v119
    v_mfma_f32_16x16x32_bf16 v[176:179], a[188:191], v[96:99], v[112:115]
    v_cvt_pk_bf16_f32 v181, v118, v119
    v_exp_f32 v120, v120
    v_mfma_f32_16x16x32_bf16 v[176:179], a[184:187], v[92:95], v[176:179]
    v_exp_f32 v121, v121
    v_mfma_f32_16x16x32_bf16 v[176:179], a[180:183], v[88:91], v[176:179]
    buffer_load_dwordx4 v15, s[8:11], s28 offen offset:2048 lds
    v_cvt_pk_bf16_f32 v188, v120, v121
    v_exp_f32 v122, v122
    v_mfma_f32_16x16x32_bf16 v[176:179], a[176:179], v[84:87], v[176:179]
    s_waitcnt lgkmcnt(2)
    v_exp_f32 v123, v123
    v_mfma_f32_16x16x32_bf16 v[116:119], a[128:131], v[36:39], v[100:103]
    ds_read_b128 a[152:155], v3 offset:20480
    v_cvt_pk_bf16_f32 v189, v122, v123
    v_exp_f32 v124, v124
    v_mfma_f32_16x16x32_bf16 v[116:119], a[132:135], v[40:43], v[116:119]
    ds_read_b128 a[156:159], v4 offset:20480
    v_exp_f32 v125, v125
    v_mfma_f32_16x16x32_bf16 v[116:119], a[136:139], v[44:47], v[116:119]
    v_cvt_pk_bf16_f32 v196, v124, v125
    v_exp_f32 v126, v126
    v_cmp_gt_u32 vcc, 32, v252
    s_and_b64 vcc, vcc, exec
    s_cbranch_scc1 L_spin_all
L_back_all:
    v_mfma_f32_16x16x32_bf16 v[116:119], a[140:143], v[48:51], v[116:119]
    s_cmp_eq_u32 s6, 255
    s_cbranch_scc1 L_rt_keys
L_rt_back_keys:
    v_exp_f32 v127, v127
    v_mfma_f32_16x16x32_bf16 v[120:123], a[140:143], v[64:67], v[104:107]
    v_cvt_pk_bf16_f32 v197, v126, v127
    v_exp_f32 v128, v128
    v_mfma_f32_16x16x32_bf16 v[120:123], a[136:139], v[60:63], v[120:123]
    v_exp_f32 v129, v129
    v_mfma_f32_16x16x32_bf16 v[120:123], a[132:135], v[56:59], v[120:123]
    buffer_load_dwordx4 v16, s[8:11], s28 offen offset:3072 lds
    v_cvt_pk_bf16_f32 v204, v128, v129
    v_exp_f32 v130, v130
    v_mfma_f32_16x16x32_bf16 v[120:123], a[128:131], v[52:55], v[120:123]
    s_waitcnt lgkmcnt(2)
    v_exp_f32 v131, v131
    v_mfma_f32_16x16x32_bf16 v[124:127], a[128:131], v[68:71], v[108:111]
    ds_read_b128 a[160:163], v1 offset:24576
    v_cvt_pk_bf16_f32 v205, v130, v131
    v_exp_f32 v132, v132
    v_mfma_f32_16x16x32_bf16 v[124:127], a[132:135], v[72:75], v[124:127]
    ds_read_b128 a[164:167], v2 offset:24576
    v_exp_f32 v133, v133
    v_mfma_f32_16x16x32_bf16 v[124:127], a[136:139], v[76:79], v[124:127]
    v_cvt_pk_bf16_f32 v182, v132, v133
    v_exp_f32 v134, v134
    v_mfma_f32_16x16x32_bf16 v[124:127], a[140:143], v[80:83], v[124:127]
    v_exp_f32 v135, v135
    v_mfma_f32_16x16x32_bf16 v[128:131], a[140:143], v[96:99], v[112:115]
    v_cvt_pk_bf16_f32 v183, v134, v135
    v_exp_f32 v136, v136
    v_mfma_f32_16x16x32_bf16 v[128:131], a[136:139], v[92:95], v[128:131]
    s_add_u32 s28, s28, 16384
    s_mov_b32 m0, s31
    v_exp_f32 v137, v137
    v_mfma_f32_16x16x32_bf16 v[128:131], a[132:135], v[88:91], v[128:131]
    buffer_load_dwordx4 v17, s[12:15], s29 offen offset:0 lds
    v_cvt_pk_bf16_f32 v190, v136, v137
    v_exp_f32 v138, v138
    v_mfma_f32_16x16x32_bf16 v[128:131], a[128:131], v[84:87], v[128:131]
    s_waitcnt lgkmcnt(2)
    v_exp_f32 v139, v139
    v_mfma_f32_16x16x32_bf16 v[132:135], a[144:147], v[36:39], v[100:103]
    ds_read_b128 a[168:171], v3 offset:24576
    v_cvt_pk_bf16_f32 v191, v138, v139
    v_exp_f32 v140, v140
    v_mfma_f32_16x16x32_bf16 v[132:135], a[148:151], v[40:43], v[132:135]
    ds_read_b128 a[172:175], v4 offset:24576
    v_exp_f32 v141, v141
    v_mfma_f32_16x16x32_bf16 v[132:135], a[152:155], v[44:47], v[132:135]
    v_cvt_pk_bf16_f32 v198, v140, v141
    v_exp_f32 v142, v142
    v_mfma_f32_16x16x32_bf16 v[132:135], a[156:159], v[48:51], v[132:135]
    v_exp_f32 v143, v143
    v_mfma_f32_16x16x32_bf16 v[136:139], a[156:159], v[64:67], v[104:107]
    v_cvt_pk_bf16_f32 v199, v142, v143
    v_exp_f32 v144, v144
    v_mfma_f32_16x16x32_bf16 v[136:139], a[152:155], v[60:63], v[136:139]
    v_exp_f32 v145, v145
    v_mfma_f32_16x16x32_bf16 v[136:139], a[148:151], v[56:59], v[136:139]
    buffer_load_dwordx4 v18, s[12:15], s29 offen offset:1024 lds
    v_cvt_pk_bf16_f32 v206, v144, v145
    v_exp_f32 v146, v146
    v_mfma_f32_16x16x32_bf16 v[136:139], a[144:147], v[52:55], v[136:139]
    s_waitcnt lgkmcnt(2)
    v_exp_f32 v147, v147
    v_mfma_f32_16x16x32_bf16 v[140:143], a[144:147], v[68:71], v[108:111]
    ds_read_b128 a[176:179], v1 offset:28672
    v_cvt_pk_bf16_f32 v207, v146, v147
    v_exp_f32 v148, v148
    v_mfma_f32_16x16x32_bf16 v[140:143], a[148:151], v[72:75], v[140:143]
    ds_read_b128 a[180:183], v2 offset:28672
    v_exp_f32 v149, v149
    v_mfma_f32_16x16x32_bf16 v[140:143], a[152:155], v[76:79], v[140:143]
    v_cvt_pk_bf16_f32 v184, v148, v149
    v_exp_f32 v150, v150
    v_mfma_f32_16x16x32_bf16 v[140:143], a[156:159], v[80:83], v[140:143]
    v_exp_f32 v151, v151
    v_mfma_f32_16x16x32_bf16 v[144:147], a[156:159], v[96:99], v[112:115]
    v_cvt_pk_bf16_f32 v185, v150, v151
    v_exp_f32 v152, v152
    v_mfma_f32_16x16x32_bf16 v[144:147], a[152:155], v[92:95], v[144:147]
    v_exp_f32 v153, v153
    v_mfma_f32_16x16x32_bf16 v[144:147], a[148:151], v[88:91], v[144:147]
    buffer_load_dwordx4 v17, s[12:15], s29 offen offset:2048 lds
    v_cvt_pk_bf16_f32 v192, v152, v153
    v_exp_f32 v154, v154
    v_mfma_f32_16x16x32_bf16 v[144:147], a[144:147], v[84:87], v[144:147]
    s_waitcnt lgkmcnt(2)
    v_exp_f32 v155, v155
    v_mfma_f32_16x16x32_bf16 v[148:151], a[160:163], v[36:39], v[100:103]
    ds_read_b128 a[184:187], v3 offset:28672
    v_cvt_pk_bf16_f32 v193, v154, v155
    v_exp_f32 v156, v156
    v_mfma_f32_16x16x32_bf16 v[148:151], a[164:167], v[40:43], v[148:151]
    ds_read_b128 a[188:191], v4 offset:28672
    v_exp_f32 v157, v157
    v_mfma_f32_16x16x32_bf16 v[148:151], a[168:171], v[44:47], v[148:151]
    v_cvt_pk_bf16_f32 v200, v156, v157
    v_exp_f32 v158, v158
    v_mfma_f32_16x16x32_bf16 v[148:151], a[172:175], v[48:51], v[148:151]
    v_exp_f32 v159, v159
    v_mfma_f32_16x16x32_bf16 v[152:155], a[172:175], v[64:67], v[104:107]
    v_cvt_pk_bf16_f32 v201, v158, v159
    v_exp_f32 v160, v160
    v_mfma_f32_16x16x32_bf16 v[152:155], a[168:171], v[60:63], v[152:155]
    v_exp_f32 v161, v161
    v_mfma_f32_16x16x32_bf16 v[152:155], a[164:167], v[56:59], v[152:155]
    buffer_load_dwordx4 v18, s[12:15], s29 offen offset:3072 lds
    v_cvt_pk_bf16_f32 v208, v160, v161
    v_exp_f32 v162, v162
    v_mfma_f32_16x16x32_bf16 v[152:155], a[160:163], v[52:55], v[152:155]
    s_waitcnt vmcnt(14) lgkmcnt(2)
    s_barrier
    s_add_u32 s29, s29, 16384
    v_exp_f32 v163, v163
    v_mfma_f32_16x16x32_bf16 v[156:159], a[160:163], v[68:71], v[108:111]
    s_waitcnt vmcnt(8)
    ds_read_b64_tr_b16 a[192:193], v5 offset:8192
    v_cvt_pk_bf16_f32 v209, v162, v163
    v_exp_f32 v164, v164
    v_mfma_f32_16x16x32_bf16 v[156:159], a[164:167], v[72:75], v[156:159]
    ds_read_b64_tr_b16 a[194:195], v5 offset:12288
    v_exp_f32 v165, v165
    v_mfma_f32_16x16x32_bf16 v[156:159], a[168:171], v[76:79], v[156:159]
    ds_read_b128 a[128:131], v1 offset:32768
    ds_read_b64_tr_b16 a[240:241], v25 offset:0
    v_cvt_pk_bf16_f32 v186, v164, v165
    v_exp_f32 v166, v166
    v_mfma_f32_16x16x32_bf16 v[156:159], a[172:175], v[80:83], v[156:159]
    ds_read_b64_tr_b16 a[196:197], v5 offset:32768
    v_exp_f32 v167, v167
    v_mfma_f32_16x16x32_bf16 v[160:163], a[172:175], v[96:99], v[112:115]
    ds_read_b64_tr_b16 a[198:199], v5 offset:36864
    ds_read_b64_tr_b16 a[242:243], v25 offset:2560
    v_cvt_pk_bf16_f32 v187, v166, v167
    v_exp_f32 v168, v168
    v_mfma_f32_16x16x32_bf16 v[160:163], a[168:171], v[92:95], v[160:163]
    s_add_u32 m0, s34, 49152
    ds_read_b128 a[132:135], v2 offset:32768
    ds_read_b64_tr_b16 a[244:245], v25 offset:32
    v_exp_f32 v169, v169
    v_mfma_f32_16x16x32_bf16 v[160:163], a[164:167], v[88:91], v[160:163]
    buffer_load_dwordx4 v13, s[8:11], s28 offen offset:0 lds
    v_cvt_pk_bf16_f32 v194, v168, v169
    v_exp_f32 v170, v170
    v_mfma_f32_16x16x32_bf16 v[160:163], a[160:163], v[84:87], v[160:163]
    s_waitcnt lgkmcnt(6)
    ds_read_b64_tr_b16 a[246:247], v25 offset:2592
    v_exp_f32 v171, v171
    v_mfma_f32_16x16x32_bf16 v[164:167], a[176:179], v[36:39], v[100:103]
    ds_read_b64_tr_b16 a[200:201], v6 offset:8192
    ds_read_b64_tr_b16 a[248:249], v25 offset:64
    v_cvt_pk_bf16_f32 v195, v170, v171
    v_exp_f32 v172, v172
    v_mfma_f32_16x16x32_bf16 v[164:167], a[180:183], v[40:43], v[164:167]
    ds_read_b64_tr_b16 a[202:203], v6 offset:12288
    v_exp_f32 v173, v173
    v_mfma_f32_16x16x32_bf16 v[164:167], a[184:187], v[44:47], v[164:167]
    ds_read_b128 a[136:139], v3 offset:32768
    ds_read_b64_tr_b16 a[250:251], v25 offset:2624
    v_cvt_pk_bf16_f32 v202, v172, v173
    v_exp_f32 v174, v174
    v_mfma_f32_16x16x32_bf16 v[164:167], a[188:191], v[48:51], v[164:167]
    ds_read_b64_tr_b16 a[204:205], v6 offset:32768
    ds_read_b64_tr_b16 a[252:253], v25 offset:96
    v_exp_f32 v175, v175
    v_mfma_f32_16x16x32_bf16 v[168:171], a[188:191], v[64:67], v[104:107]
    ds_read_b64_tr_b16 a[206:207], v6 offset:36864
    v_cvt_pk_bf16_f32 v203, v174, v175
    v_exp_f32 v176, v176
    v_mfma_f32_16x16x32_bf16 v[168:171], a[184:187], v[60:63], v[168:171]
    ds_read_b128 a[140:143], v4 offset:32768
    ds_read_b64_tr_b16 a[254:255], v25 offset:2656
    v_exp_f32 v177, v177
    v_mfma_f32_16x16x32_bf16 v[168:171], a[180:183], v[56:59], v[168:171]
    buffer_load_dwordx4 v14, s[8:11], s28 offen offset:1024 lds
    ds_read_b64_tr_b16 v[252:253], v25 offset:128
    v_cvt_pk_bf16_f32 v210, v176, v177
    v_exp_f32 v178, v178
    v_mfma_f32_16x16x32_bf16 v[168:171], a[176:179], v[52:55], v[168:171]
    s_waitcnt lgkmcnt(6)
    ds_read_b64_tr_b16 v[254:255], v25 offset:2688
    v_exp_f32 v179, v179
    v_mfma_f32_16x16x32_bf16 v[172:175], a[176:179], v[68:71], v[108:111]
    s_mov_b32 s16, s62
    v_exp_f32 v116, v116
    v_mfma_f32_16x16x32_bf16 v[172:175], a[180:183], v[72:75], v[172:175]
    s_mov_b32 s17, s63
    ds_read_b64_tr_b16 a[208:209], v7 offset:8192
    v_cvt_pk_bf16_f32 v211, v178, v179
    v_mfma_f32_16x16x32_bf16 v[172:175], a[184:187], v[76:79], v[172:175]
    s_mov_b32 s18, 0x21c000
    v_exp_f32 v117, v117
    v_mfma_f32_16x16x32_bf16 v[172:175], a[188:191], v[80:83], v[172:175]
    s_mov_b32 s19, 0x20000
    ds_read_b64_tr_b16 a[210:211], v7 offset:12288
    v_mfma_f32_16x16x32_bf16 v[176:179], a[188:191], v[96:99], v[112:115]
    s_mov_b32 s20, s64
    v_exp_f32 v118, v118
    v_mfma_f32_16x16x32_bf16 v[176:179], a[184:187], v[92:95], v[176:179]
    s_mov_b32 s21, s65
    ds_read_b128 a[144:147], v1 offset:36864
    v_cvt_pk_bf16_f32 v212, v116, v117
    v_mfma_f32_16x16x32_bf16 v[176:179], a[180:183], v[88:91], v[176:179]
    s_mov_b32 s22, 0x21c000
    v_exp_f32 v119, v119
    v_mfma_f32_16x16x32_bf16 v[176:179], a[176:179], v[84:87], v[176:179]
    s_mov_b32 s23, 0x20000
    ds_read_b64_tr_b16 a[212:213], v7 offset:32768
    v_mfma_f32_16x16x32_bf16 a[0:3], a[192:195], v[180:183], 0
    s_mov_b32 s96, s66
    v_exp_f32 v120, v120
    v_mfma_f32_16x16x32_bf16 a[0:3], a[196:199], v[184:187], a[0:3]
    s_mov_b32 s97, s67
    ds_read_b64_tr_b16 a[214:215], v7 offset:36864
    v_cvt_pk_bf16_f32 v213, v118, v119
    v_mfma_f32_16x16x32_bf16 a[4:7], a[196:199], v[192:195], 0
    s_mov_b32 s98, 0x21c000
    v_exp_f32 v121, v121
    v_mfma_f32_16x16x32_bf16 a[4:7], a[192:195], v[188:191], a[4:7]
    s_mov_b32 s99, 0x20000
    ds_read_b128 a[148:151], v2 offset:36864
    v_cvt_pk_bf16_f32 v220, v120, v121
    v_mfma_f32_16x16x32_bf16 a[8:11], a[192:195], v[196:199], 0
    v_exp_f32 v122, v122
    v_mfma_f32_16x16x32_bf16 a[8:11], a[196:199], v[200:203], a[8:11]
    buffer_load_dwordx4 v15, s[8:11], s28 offen offset:2048 lds
    v_mfma_f32_16x16x32_bf16 a[12:15], a[196:199], v[208:211], 0
    v_exp_f32 v123, v123
    v_mfma_f32_16x16x32_bf16 a[12:15], a[192:195], v[204:207], a[12:15]
    s_waitcnt lgkmcnt(6)
    v_mul_u32_u24 v24, 3456, v19
    v_mfma_f32_16x16x32_bf16 v[116:119], a[128:131], v[36:39], v[100:103]
    s_lshl_b32 s40, s6, 4
    v_exp_f32 v124, v124
    v_mfma_f32_16x16x32_bf16 v[116:119], a[132:135], v[40:43], v[116:119]
    ds_read_b64_tr_b16 a[216:217], v8 offset:8192
    v_cvt_pk_bf16_f32 v221, v122, v123
    v_mfma_f32_16x16x32_bf16 v[116:119], a[136:139], v[44:47], v[116:119]
    v_exp_f32 v125, v125
    v_mfma_f32_16x16x32_bf16 v[116:119], a[140:143], v[48:51], v[116:119]
    ds_read_b64_tr_b16 a[218:219], v8 offset:12288
    v_add_u32 v24, s40, v24
    v_mfma_f32_16x16x32_bf16 v[120:123], a[140:143], v[64:67], v[104:107]
    s_cmp_ge_u32 s5, 2
    s_cselect_b32 s16, s20, s16
    s_cselect_b32 s17, s21, s17
    v_exp_f32 v126, v126
    v_mfma_f32_16x16x32_bf16 v[120:123], a[136:139], v[60:63], v[120:123]
    s_cmp_ge_u32 s6, 216
    s_cselect_b32 s18, 0, s18
    ds_read_b128 a[152:155], v3 offset:36864
    v_cvt_pk_bf16_f32 v228, v124, v125
    v_mfma_f32_16x16x32_bf16 v[120:123], a[132:135], v[56:59], v[120:123]
    s_and_b32 s40, s5, 1
    v_exp_f32 v127, v127
    v_mfma_f32_16x16x32_bf16 v[120:123], a[128:131], v[52:55], v[120:123]
    s_mul_i32 s37, s40, 1105920
    ds_read_b64_tr_b16 a[220:221], v8 offset:32768
    v_mfma_f32_16x16x32_bf16 a[16:19], a[200:203], v[180:183], 0
    s_mul_i32 s38, s5, 5120
    v_exp_f32 v128, v128
    v_mfma_f32_16x16x32_bf16 a[16:19], a[204:207], v[184:187], a[16:19]
    s_add_u32 s38, s38, 65536
    ds_read_b64_tr_b16 a[222:223], v8 offset:36864
    v_cvt_pk_bf16_f32 v229, v126, v127
    v_mfma_f32_16x16x32_bf16 a[20:23], a[204:207], v[192:195], 0
    s_mov_b32 s36, 4
    buffer_store_dwordx4 a[240:243], v26, s[76:79], 0 offen offset:0 sc1
    v_exp_f32 v129, v129
    v_mfma_f32_16x16x32_bf16 a[20:23], a[200:203], v[188:191], a[20:23]
    ds_read_b128 a[156:159], v4 offset:36864
    v_mfma_f32_16x16x32_bf16 a[24:27], a[200:203], v[196:199], 0
    v_exp_f32 v130, v130
    v_mfma_f32_16x16x32_bf16 a[24:27], a[204:207], v[200:203], a[24:27]
    v_cvt_pk_bf16_f32 v236, v128, v129
    v_mfma_f32_16x16x32_bf16 a[28:31], a[204:207], v[208:211], 0
    v_exp_f32 v131, v131
    v_mfma_f32_16x16x32_bf16 a[28:31], a[200:203], v[204:207], a[28:31]
    buffer_load_dwordx4 v16, s[8:11], s28 offen offset:3072 lds
    v_smfmac_f32_16x16x64_bf16 a[224:227], v[244:247], v[180:187], v248
    s_waitcnt lgkmcnt(6)
    buffer_store_dwordx4 a[244:247], v26, s[76:79], 0 offen offset:1024 sc1
    v_mfma_f32_16x16x32_bf16 v[124:127], a[128:131], v[68:71], v[108:111]
    v_exp_f32 v132, v132
    v_mfma_f32_16x16x32_bf16 v[124:127], a[132:135], v[72:75], v[124:127]
    ds_read_b64_tr_b16 a[192:193], v9 offset:8192
    v_cvt_pk_bf16_f32 v237, v130, v131
    v_mfma_f32_16x16x32_bf16 v[124:127], a[136:139], v[76:79], v[124:127]
    v_exp_f32 v133, v133
    v_mfma_f32_16x16x32_bf16 v[124:127], a[140:143], v[80:83], v[124:127]
    ds_read_b64_tr_b16 a[194:195], v9 offset:12288
    v_mfma_f32_16x16x32_bf16 v[128:131], a[140:143], v[96:99], v[112:115]
    v_exp_f32 v134, v134
    v_mfma_f32_16x16x32_bf16 v[128:131], a[136:139], v[92:95], v[128:131]
    ds_read_b128 a[160:163], v1 offset:40960
    v_cvt_pk_bf16_f32 v214, v132, v133
    v_mfma_f32_16x16x32_bf16 v[128:131], a[132:135], v[88:91], v[128:131]
    v_exp_f32 v135, v135
    v_mfma_f32_16x16x32_bf16 v[128:131], a[128:131], v[84:87], v[128:131]
    ds_read_b64_tr_b16 a[196:197], v9 offset:32768
    v_mfma_f32_16x16x32_bf16 a[32:35], a[208:211], v[180:183], 0
    v_exp_f32 v136, v136
    v_mfma_f32_16x16x32_bf16 a[32:35], a[212:215], v[184:187], a[32:35]
    ds_read_b64_tr_b16 a[198:199], v9 offset:36864
    v_cvt_pk_bf16_f32 v215, v134, v135
    v_mfma_f32_16x16x32_bf16 a[36:39], a[212:215], v[192:195], 0
    v_exp_f32 v137, v137
    v_mfma_f32_16x16x32_bf16 a[36:39], a[208:211], v[188:191], a[36:39]
    ds_read_b128 a[164:167], v2 offset:40960
    v_cvt_pk_bf16_f32 v222, v136, v137
    v_mfma_f32_16x16x32_bf16 a[40:43], a[208:211], v[196:199], 0
    s_add_u32 s28, s28, 16384
    s_mov_b32 m0, s32
    buffer_store_dwordx4 a[248:251], v26, s[76:79], 0 offen offset:2048 sc1
    v_exp_f32 v138, v138
    v_mfma_f32_16x16x32_bf16 a[40:43], a[212:215], v[200:203], a[40:43]
    buffer_load_dwordx4 v17, s[12:15], s29 offen offset:0 lds
    v_mfma_f32_16x16x32_bf16 a[44:47], a[212:215], v[208:211], 0
    v_exp_f32 v139, v139
    v_mfma_f32_16x16x32_bf16 a[44:47], a[208:211], v[204:207], a[44:47]
    s_waitcnt lgkmcnt(6)
    buffer_store_dwordx4 a[252:255], v26, s[76:79], 0 offen offset:3072 sc1
    v_mfma_f32_16x16x32_bf16 v[132:135], a[144:147], v[36:39], v[100:103]
    v_exp_f32 v140, v140
    v_mfma_f32_16x16x32_bf16 v[132:135], a[148:151], v[40:43], v[132:135]
    ds_read_b64_tr_b16 a[200:201], v10 offset:8192
    v_cvt_pk_bf16_f32 v223, v138, v139
    v_mfma_f32_16x16x32_bf16 v[132:135], a[152:155], v[44:47], v[132:135]
    v_exp_f32 v141, v141
    v_mfma_f32_16x16x32_bf16 v[132:135], a[156:159], v[48:51], v[132:135]
    ds_read_b64_tr_b16 a[202:203], v10 offset:12288
    v_mfma_f32_16x16x32_bf16 v[136:139], a[156:159], v[64:67], v[104:107]
    v_exp_f32 v142, v142
    v_mfma_f32_16x16x32_bf16 v[136:139], a[152:155], v[60:63], v[136:139]
    ds_read_b128 a[168:171], v3 offset:40960
    v_cvt_pk_bf16_f32 v230, v140, v141
    v_mfma_f32_16x16x32_bf16 v[136:139], a[148:151], v[56:59], v[136:139]
    v_exp_f32 v143, v143
    v_mfma_f32_16x16x32_bf16 v[136:139], a[144:147], v[52:55], v[136:139]
    ds_read_b64_tr_b16 a[204:205], v10 offset:32768
    v_mfma_f32_16x16x32_bf16 a[48:51], a[216:219], v[180:183], 0
    v_exp_f32 v144, v144
    v_mfma_f32_16x16x32_bf16 a[48:51], a[220:223], v[184:187], a[48:51]
    ds_read_b64_tr_b16 a[206:207], v10 offset:36864
    v_cvt_pk_bf16_f32 v231, v142, v143
    v_mfma_f32_16x16x32_bf16 a[52:55], a[220:223], v[192:195], 0
    v_exp_f32 v145, v145
    v_mfma_f32_16x16x32_bf16 a[52:55], a[216:219], v[188:191], a[52:55]
    ds_read_b128 a[172:175], v4 offset:40960
    v_mfma_f32_16x16x32_bf16 a[56:59], a[216:219], v[196:199], 0
    v_exp_f32 v146, v146
    v_mfma_f32_16x16x32_bf16 a[56:59], a[220:223], v[200:203], a[56:59]
    v_cvt_pk_bf16_f32 v238, v144, v145
    v_mfma_f32_16x16x32_bf16 a[60:63], a[220:223], v[208:211], 0
    v_exp_f32 v147, v147
    v_mfma_f32_16x16x32_bf16 a[60:63], a[216:219], v[204:207], a[60:63]
    buffer_load_dwordx4 v18, s[12:15], s29 offen offset:1024 lds
    v_smfmac_f32_16x16x64_bf16 a[228:231], v[244:247], v[188:195], v248
    s_waitcnt lgkmcnt(6)
    buffer_store_dwordx4 v[252:255], v26, s[76:79], s45 offen offset:0 sc1
    v_mfma_f32_16x16x32_bf16 v[140:143], a[144:147], v[68:71], v[108:111]
    s_cmp_eq_u32 s6, 255
    s_cbranch_scc1 L_rt_local
L_rt_back_local:
    v_exp_f32 v148, v148
    v_mfma_f32_16x16x32_bf16 v[140:143], a[148:151], v[72:75], v[140:143]
    ds_read_b64_tr_b16 a[208:209], v11 offset:8192
    v_cvt_pk_bf16_f32 v239, v146, v147
    v_mfma_f32_16x16x32_bf16 v[140:143], a[152:155], v[76:79], v[140:143]
    v_exp_f32 v149, v149
    v_mfma_f32_16x16x32_bf16 v[140:143], a[156:159], v[80:83], v[140:143]
    ds_read_b64_tr_b16 a[210:211], v11 offset:12288
    v_mfma_f32_16x16x32_bf16 v[144:147], a[156:159], v[96:99], v[112:115]
    v_exp_f32 v150, v150
    v_mfma_f32_16x16x32_bf16 v[144:147], a[152:155], v[92:95], v[144:147]
    ds_read_b128 a[176:179], v1 offset:45056
    v_cvt_pk_bf16_f32 v216, v148, v149
    v_mfma_f32_16x16x32_bf16 v[144:147], a[148:151], v[88:91], v[144:147]
    v_exp_f32 v151, v151
    v_mfma_f32_16x16x32_bf16 v[144:147], a[144:147], v[84:87], v[144:147]
    ds_read_b64_tr_b16 a[212:213], v11 offset:32768
    v_mfma_f32_16x16x32_bf16 a[64:67], a[192:195], v[180:183], 0
    v_exp_f32 v152, v152
    v_mfma_f32_16x16x32_bf16 a[64:67], a[196:199], v[184:187], a[64:67]
    ds_read_b64_tr_b16 a[214:215], v11 offset:36864
    v_cvt_pk_bf16_f32 v217, v150, v151
    v_mfma_f32_16x16x32_bf16 a[68:71], a[196:199], v[192:195], 0
    v_exp_f32 v153, v153
    v_mfma_f32_16x16x32_bf16 a[68:71], a[192:195], v[188:191], a[68:71]
    ds_read_b128 a[180:183], v2 offset:45056
    v_cvt_pk_bf16_f32 v224, v152, v153
    v_mfma_f32_16x16x32_bf16 a[72:75], a[192:195], v[196:199], 0
    v_exp_f32 v154, v154
    v_mfma_f32_16x16x32_bf16 a[72:75], a[196:199], v[200:203], a[72:75]
    buffer_load_dwordx4 v17, s[12:15], s29 offen offset:2048 lds
    v_mfma_f32_16x16x32_bf16 a[76:79], a[196:199], v[208:211], 0
    v_exp_f32 v155, v155
    v_mfma_f32_16x16x32_bf16 a[76:79], a[192:195], v[204:207], a[76:79]
    s_waitcnt lgkmcnt(6)
    v_mfma_f32_16x16x32_bf16 v[148:151], a[160:163], v[36:39], v[100:103]
    v_exp_f32 v156, v156
    v_mfma_f32_16x16x32_bf16 v[148:151], a[164:167], v[40:43], v[148:151]
    ds_read_b64_tr_b16 a[216:217], v12 offset:8192
    v_cvt_pk_bf16_f32 v225, v154, v155
    v_mfma_f32_16x16x32_bf16 v[148:151], a[168:171], v[44:47], v[148:151]
    v_exp_f32 v157, v157
    v_mfma_f32_16x16x32_bf16 v[148:151], a[172:175], v[48:51], v[148:151]
    ds_read_b64_tr_b16 a[218:219], v12 offset:12288
    v_mfma_f32_16x16x32_bf16 v[152:155], a[172:175], v[64:67], v[104:107]
    v_exp_f32 v158, v158
    v_mfma_f32_16x16x32_bf16 v[152:155], a[168:171], v[60:63], v[152:155]
    ds_read_b128 a[184:187], v3 offset:45056
    v_cvt_pk_bf16_f32 v232, v156, v157
    v_mfma_f32_16x16x32_bf16 v[152:155], a[164:167], v[56:59], v[152:155]
    v_exp_f32 v159, v159
    v_mfma_f32_16x16x32_bf16 v[152:155], a[160:163], v[52:55], v[152:155]
    ds_read_b64_tr_b16 a[220:221], v12 offset:32768
    v_mfma_f32_16x16x32_bf16 a[80:83], a[200:203], v[180:183], 0
    v_exp_f32 v160, v160
    v_mfma_f32_16x16x32_bf16 a[80:83], a[204:207], v[184:187], a[80:83]
    ds_read_b64_tr_b16 a[222:223], v12 offset:36864
    v_cvt_pk_bf16_f32 v233, v158, v159
    v_mfma_f32_16x16x32_bf16 a[84:87], a[204:207], v[192:195], 0
    v_exp_f32 v161, v161
    v_mfma_f32_16x16x32_bf16 a[84:87], a[200:203], v[188:191], a[84:87]
    ds_read_b128 a[188:191], v4 offset:45056
    v_mfma_f32_16x16x32_bf16 a[88:91], a[200:203], v[196:199], 0
    v_exp_f32 v162, v162
    v_mfma_f32_16x16x32_bf16 a[88:91], a[204:207], v[200:203], a[88:91]
    v_cvt_pk_bf16_f32 v240, v160, v161
    v_mfma_f32_16x16x32_bf16 a[92:95], a[204:207], v[208:211], 0
    v_exp_f32 v163, v163
    v_mfma_f32_16x16x32_bf16 a[92:95], a[200:203], v[204:207], a[92:95]
    buffer_load_dwordx4 v18, s[12:15], s29 offen offset:3072 lds
    v_smfmac_f32_16x16x64_bf16 a[232:235], v[244:247], v[196:203], v248
    s_waitcnt vmcnt(13) lgkmcnt(6)
    s_barrier
    s_add_u32 s29, s29, 16384
    v_mfma_f32_16x16x32_bf16 v[156:159], a[160:163], v[68:71], v[108:111]
    v_exp_f32 v164, v164
    v_mfma_f32_16x16x32_bf16 v[156:159], a[164:167], v[72:75], v[156:159]
    ds_read_b64_tr_b16 a[192:193], v5 offset:16384
    v_cvt_pk_bf16_f32 v241, v162, v163
    v_mfma_f32_16x16x32_bf16 v[156:159], a[168:171], v[76:79], v[156:159]
    v_exp_f32 v165, v165
    v_mfma_f32_16x16x32_bf16 v[156:159], a[172:175], v[80:83], v[156:159]
    ds_read_b64_tr_b16 a[194:195], v5 offset:20480
    v_mfma_f32_16x16x32_bf16 v[160:163], a[172:175], v[96:99], v[112:115]
    v_exp_f32 v166, v166
    v_mfma_f32_16x16x32_bf16 v[160:163], a[168:171], v[92:95], v[160:163]
    ds_read_b128 a[128:131], v1 offset:0
    v_cvt_pk_bf16_f32 v218, v164, v165
    v_mfma_f32_16x16x32_bf16 v[160:163], a[164:167], v[88:91], v[160:163]
    v_exp_f32 v167, v167
    v_mfma_f32_16x16x32_bf16 v[160:163], a[160:163], v[84:87], v[160:163]
    ds_read_b64_tr_b16 a[196:197], v5 offset:40960
    v_mfma_f32_16x16x32_bf16 a[96:99], a[208:211], v[180:183], 0
    v_exp_f32 v168, v168
    v_mfma_f32_16x16x32_bf16 a[96:99], a[212:215], v[184:187], a[96:99]
    ds_read_b64_tr_b16 a[198:199], v5 offset:45056
    v_cvt_pk_bf16_f32 v219, v166, v167
    v_mfma_f32_16x16x32_bf16 a[100:103], a[212:215], v[192:195], 0
    v_exp_f32 v169, v169
    v_mfma_f32_16x16x32_bf16 a[100:103], a[208:211], v[188:191], a[100:103]
    ds_read_b128 a[132:135], v2 offset:0
    v_cvt_pk_bf16_f32 v226, v168, v169
    v_mfma_f32_16x16x32_bf16 a[104:107], a[208:211], v[196:199], 0
    s_add_u32 m0, s34, 16384
    v_exp_f32 v170, v170
    v_mfma_f32_16x16x32_bf16 a[104:107], a[212:215], v[200:203], a[104:107]
    buffer_load_dwordx4 v13, s[8:11], s28 offen offset:0 lds
    v_mfma_f32_16x16x32_bf16 a[108:111], a[212:215], v[208:211], 0
    v_exp_f32 v171, v171
    v_mfma_f32_16x16x32_bf16 a[108:111], a[208:211], v[204:207], a[108:111]
    s_waitcnt lgkmcnt(6)
    v_mfma_f32_16x16x32_bf16 v[164:167], a[176:179], v[36:39], v[100:103]
    s_cmp_eq_u32 s6, 255
    s_cbranch_scc1 L_rt_merge
L_rt_back_merge:
    v_exp_f32 v172, v172
    v_mfma_f32_16x16x32_bf16 v[164:167], a[180:183], v[40:43], v[164:167]
    ds_read_b64_tr_b16 a[200:201], v6 offset:16384
    v_cvt_pk_bf16_f32 v227, v170, v171
    v_mfma_f32_16x16x32_bf16 v[164:167], a[184:187], v[44:47], v[164:167]
    v_exp_f32 v173, v173
    v_mfma_f32_16x16x32_bf16 v[164:167], a[188:191], v[48:51], v[164:167]
    ds_read_b64_tr_b16 a[202:203], v6 offset:20480
    v_mfma_f32_16x16x32_bf16 v[168:171], a[188:191], v[64:67], v[104:107]
    v_exp_f32 v174, v174
    v_mfma_f32_16x16x32_bf16 v[168:171], a[184:187], v[60:63], v[168:171]
    ds_read_b128 a[136:139], v3 offset:0
    v_cvt_pk_bf16_f32 v234, v172, v173
    v_mfma_f32_16x16x32_bf16 v[168:171], a[180:183], v[56:59], v[168:171]
    v_exp_f32 v175, v175
    v_mfma_f32_16x16x32_bf16 v[168:171], a[176:179], v[52:55], v[168:171]
    ds_read_b64_tr_b16 a[204:205], v6 offset:40960
    v_mfma_f32_16x16x32_bf16 a[112:115], a[216:219], v[180:183], 0
    v_exp_f32 v176, v176
    v_mfma_f32_16x16x32_bf16 a[112:115], a[220:223], v[184:187], a[112:115]
    ds_read_b64_tr_b16 a[206:207], v6 offset:45056
    v_cvt_pk_bf16_f32 v235, v174, v175
    v_mfma_f32_16x16x32_bf16 a[116:119], a[220:223], v[192:195], 0
    v_exp_f32 v177, v177
    v_mfma_f32_16x16x32_bf16 a[116:119], a[216:219], v[188:191], a[116:119]
    ds_read_b128 a[140:143], v4 offset:0
    v_mfma_f32_16x16x32_bf16 a[120:123], a[216:219], v[196:199], 0
    v_exp_f32 v178, v178
    v_mfma_f32_16x16x32_bf16 a[120:123], a[220:223], v[200:203], a[120:123]
    v_cvt_pk_bf16_f32 v242, v176, v177
    v_mfma_f32_16x16x32_bf16 a[124:127], a[220:223], v[208:211], 0
    v_exp_f32 v179, v179
    v_mfma_f32_16x16x32_bf16 a[124:127], a[216:219], v[204:207], a[124:127]
    buffer_load_dwordx4 v14, s[8:11], s28 offen offset:1024 lds
    v_smfmac_f32_16x16x64_bf16 a[236:239], v[244:247], v[204:211], v248
    s_waitcnt lgkmcnt(6)
    s_mov_b32 s35, 5
.p2align 6
L_attn_loop:
    v_mfma_f32_16x16x32_bf16 v[172:175], a[176:179], v[68:71], v[108:111]
    v_exp_f32 v116, v116
    v_mfma_f32_16x16x32_bf16 v[172:175], a[180:183], v[72:75], v[172:175]
    ds_read_b64_tr_b16 a[208:209], v7 offset:16384
    v_cvt_pk_bf16_f32 v243, v178, v179
    v_mfma_f32_16x16x32_bf16 v[172:175], a[184:187], v[76:79], v[172:175]
    v_exp_f32 v117, v117
    v_mfma_f32_16x16x32_bf16 v[172:175], a[188:191], v[80:83], v[172:175]
    ds_read_b64_tr_b16 a[210:211], v7 offset:20480
    v_mfma_f32_16x16x32_bf16 v[176:179], a[188:191], v[96:99], v[112:115]
    v_exp_f32 v118, v118
    v_mfma_f32_16x16x32_bf16 v[176:179], a[184:187], v[92:95], v[176:179]
    ds_read_b128 a[144:147], v1 offset:4096
    v_cvt_pk_bf16_f32 v180, v116, v117
    v_mfma_f32_16x16x32_bf16 v[176:179], a[180:183], v[88:91], v[176:179]
    v_exp_f32 v119, v119
    v_mfma_f32_16x16x32_bf16 v[176:179], a[176:179], v[84:87], v[176:179]
    ds_read_b64_tr_b16 a[212:213], v7 offset:40960
    v_mfma_f32_16x16x32_bf16 a[0:3], a[192:195], v[212:215], a[0:3]
    v_exp_f32 v120, v120
    v_mfma_f32_16x16x32_bf16 a[0:3], a[196:199], v[216:219], a[0:3]
    ds_read_b64_tr_b16 a[214:215], v7 offset:45056
    v_cvt_pk_bf16_f32 v181, v118, v119
    v_mfma_f32_16x16x32_bf16 a[4:7], a[196:199], v[224:227], a[4:7]
    v_exp_f32 v121, v121
    v_mfma_f32_16x16x32_bf16 a[4:7], a[192:195], v[220:223], a[4:7]
    ds_read_b128 a[148:151], v2 offset:4096
    v_cvt_pk_bf16_f32 v188, v120, v121
    v_mfma_f32_16x16x32_bf16 a[8:11], a[192:195], v[228:231], a[8:11]
    v_exp_f32 v122, v122
    v_mfma_f32_16x16x32_bf16 a[8:11], a[196:199], v[232:235], a[8:11]
    buffer_load_dwordx4 v15, s[8:11], s28 offen offset:2048 lds
    v_mfma_f32_16x16x32_bf16 a[12:15], a[196:199], v[240:243], a[12:15]
    v_exp_f32 v123, v123
    v_mfma_f32_16x16x32_bf16 a[12:15], a[192:195], v[236:239], a[12:15]
    s_waitcnt lgkmcnt(6)
    v_mfma_f32_16x16x32_bf16 v[116:119], a[128:131], v[36:39], v[100:103]
    v_exp_f32 v124, v124
    v_mfma_f32_16x16x32_bf16 v[116:119], a[132:135], v[40:43], v[116:119]
    ds_read_b64_tr_b16 a[216:217], v8 offset:16384
    v_cvt_pk_bf16_f32 v189, v122, v123
    v_mfma_f32_16x16x32_bf16 v[116:119], a[136:139], v[44:47], v[116:119]
    v_exp_f32 v125, v125
    v_mfma_f32_16x16x32_bf16 v[116:119], a[140:143], v[48:51], v[116:119]
    ds_read_b64_tr_b16 a[218:219], v8 offset:20480
    v_mfma_f32_16x16x32_bf16 v[120:123], a[140:143], v[64:67], v[104:107]
    v_exp_f32 v126, v126
    v_mfma_f32_16x16x32_bf16 v[120:123], a[136:139], v[60:63], v[120:123]
    ds_read_b128 a[152:155], v3 offset:4096
    v_cvt_pk_bf16_f32 v196, v124, v125
    v_mfma_f32_16x16x32_bf16 v[120:123], a[132:135], v[56:59], v[120:123]
    v_exp_f32 v127, v127
    v_mfma_f32_16x16x32_bf16 v[120:123], a[128:131], v[52:55], v[120:123]
    ds_read_b64_tr_b16 a[220:221], v8 offset:40960
    v_mfma_f32_16x16x32_bf16 a[16:19], a[200:203], v[212:215], a[16:19]
    v_exp_f32 v128, v128
    v_mfma_f32_16x16x32_bf16 a[16:19], a[204:207], v[216:219], a[16:19]
    ds_read_b64_tr_b16 a[222:223], v8 offset:45056
    v_cvt_pk_bf16_f32 v197, v126, v127
    v_mfma_f32_16x16x32_bf16 a[20:23], a[204:207], v[224:227], a[20:23]
    v_exp_f32 v129, v129
    v_mfma_f32_16x16x32_bf16 a[20:23], a[200:203], v[220:223], a[20:23]
    ds_read_b128 a[156:159], v4 offset:4096
    v_mfma_f32_16x16x32_bf16 a[24:27], a[200:203], v[228:231], a[24:27]
    v_exp_f32 v130, v130
    v_mfma_f32_16x16x32_bf16 a[24:27], a[204:207], v[232:235], a[24:27]
    v_cvt_pk_bf16_f32 v204, v128, v129
    v_mfma_f32_16x16x32_bf16 a[28:31], a[204:207], v[240:243], a[28:31]
    v_exp_f32 v131, v131
    v_mfma_f32_16x16x32_bf16 a[28:31], a[200:203], v[236:239], a[28:31]
    buffer_load_dwordx4 v16, s[8:11], s28 offen offset:3072 lds
    v_smfmac_f32_16x16x64_bf16 a[224:227], v[244:247], v[212:219], v248
    s_waitcnt lgkmcnt(6)
    v_mfma_f32_16x16x32_bf16 v[124:127], a[128:131], v[68:71], v[108:111]
    s_cmp_eq_u32 s36, 0
    s_cbranch_scc1 L_site0
L_site_back0:
    v_exp_f32 v132, v132
    v_mfma_f32_16x16x32_bf16 v[124:127], a[132:135], v[72:75], v[124:127]
    ds_read_b64_tr_b16 a[192:193], v9 offset:16384
    v_cvt_pk_bf16_f32 v205, v130, v131
    v_mfma_f32_16x16x32_bf16 v[124:127], a[136:139], v[76:79], v[124:127]
    v_exp_f32 v133, v133
    v_mfma_f32_16x16x32_bf16 v[124:127], a[140:143], v[80:83], v[124:127]
    ds_read_b64_tr_b16 a[194:195], v9 offset:20480
    v_mfma_f32_16x16x32_bf16 v[128:131], a[140:143], v[96:99], v[112:115]
    v_exp_f32 v134, v134
    v_mfma_f32_16x16x32_bf16 v[128:131], a[136:139], v[92:95], v[128:131]
    ds_read_b128 a[160:163], v1 offset:8192
    v_cvt_pk_bf16_f32 v182, v132, v133
    v_mfma_f32_16x16x32_bf16 v[128:131], a[132:135], v[88:91], v[128:131]
    v_exp_f32 v135, v135
    v_mfma_f32_16x16x32_bf16 v[128:131], a[128:131], v[84:87], v[128:131]
    ds_read_b64_tr_b16 a[196:197], v9 offset:40960
    v_mfma_f32_16x16x32_bf16 a[32:35], a[208:211], v[212:215], a[32:35]
    v_exp_f32 v136, v136
    v_mfma_f32_16x16x32_bf16 a[32:35], a[212:215], v[216:219], a[32:35]
    ds_read_b64_tr_b16 a[198:199], v9 offset:45056
    v_cvt_pk_bf16_f32 v183, v134, v135
    v_mfma_f32_16x16x32_bf16 a[36:39], a[212:215], v[224:227], a[36:39]
    v_exp_f32 v137, v137
    v_mfma_f32_16x16x32_bf16 a[36:39], a[208:211], v[220:223], a[36:39]
    ds_read_b128 a[164:167], v2 offset:8192
    v_cvt_pk_bf16_f32 v190, v136, v137
    v_mfma_f32_16x16x32_bf16 a[40:43], a[208:211], v[228:231], a[40:43]
    s_add_u32 s28, s28, 16384
    s_mov_b32 m0, s33
    v_exp_f32 v138, v138
    v_mfma_f32_16x16x32_bf16 a[40:43], a[212:215], v[232:235], a[40:43]
    buffer_load_dwordx4 v17, s[12:15], s29 offen offset:0 lds
    v_mfma_f32_16x16x32_bf16 a[44:47], a[212:215], v[240:243], a[44:47]
    v_exp_f32 v139, v139
    v_mfma_f32_16x16x32_bf16 a[44:47], a[208:211], v[236:239], a[44:47]
    s_waitcnt lgkmcnt(6)
    v_mfma_f32_16x16x32_bf16 v[132:135], a[144:147], v[36:39], v[100:103]
    v_exp_f32 v140, v140
    v_mfma_f32_16x16x32_bf16 v[132:135], a[148:151], v[40:43], v[132:135]
    ds_read_b64_tr_b16 a[200:201], v10 offset:16384
    v_cvt_pk_bf16_f32 v191, v138, v139
    v_mfma_f32_16x16x32_bf16 v[132:135], a[152:155], v[44:47], v[132:135]
    v_exp_f32 v141, v141
    v_mfma_f32_16x16x32_bf16 v[132:135], a[156:159], v[48:51], v[132:135]
    ds_read_b64_tr_b16 a[202:203], v10 offset:20480
    v_mfma_f32_16x16x32_bf16 v[136:139], a[156:159], v[64:67], v[104:107]
    v_exp_f32 v142, v142
    v_mfma_f32_16x16x32_bf16 v[136:139], a[152:155], v[60:63], v[136:139]
    ds_read_b128 a[168:171], v3 offset:8192
    v_cvt_pk_bf16_f32 v198, v140, v141
    v_mfma_f32_16x16x32_bf16 v[136:139], a[148:151], v[56:59], v[136:139]
    v_exp_f32 v143, v143
    v_mfma_f32_16x16x32_bf16 v[136:139], a[144:147], v[52:55], v[136:139]
    ds_read_b64_tr_b16 a[204:205], v10 offset:40960
    v_mfma_f32_16x16x32_bf16 a[48:51], a[216:219], v[212:215], a[48:51]
    v_exp_f32 v144, v144
    v_mfma_f32_16x16x32_bf16 a[48:51], a[220:223], v[216:219], a[48:51]
    ds_read_b64_tr_b16 a[206:207], v10 offset:45056
    v_cvt_pk_bf16_f32 v199, v142, v143
    v_mfma_f32_16x16x32_bf16 a[52:55], a[220:223], v[224:227], a[52:55]
    v_exp_f32 v145, v145
    v_mfma_f32_16x16x32_bf16 a[52:55], a[216:219], v[220:223], a[52:55]
    ds_read_b128 a[172:175], v4 offset:8192
    v_mfma_f32_16x16x32_bf16 a[56:59], a[216:219], v[228:231], a[56:59]
    v_exp_f32 v146, v146
    v_mfma_f32_16x16x32_bf16 a[56:59], a[220:223], v[232:235], a[56:59]
    v_cvt_pk_bf16_f32 v206, v144, v145
    v_mfma_f32_16x16x32_bf16 a[60:63], a[220:223], v[240:243], a[60:63]
    v_exp_f32 v147, v147
    v_mfma_f32_16x16x32_bf16 a[60:63], a[216:219], v[236:239], a[60:63]
    buffer_load_dwordx4 v18, s[12:15], s29 offen offset:1024 lds
    v_smfmac_f32_16x16x64_bf16 a[228:231], v[244:247], v[220:227], v248
    s_waitcnt lgkmcnt(6)
    v_mfma_f32_16x16x32_bf16 v[140:143], a[144:147], v[68:71], v[108:111]
    v_exp_f32 v148, v148
    v_mfma_f32_16x16x32_bf16 v[140:143], a[148:151], v[72:75], v[140:143]
    ds_read_b64_tr_b16 a[208:209], v11 offset:16384
    v_cvt_pk_bf16_f32 v207, v146, v147
    v_mfma_f32_16x16x32_bf16 v[140:143], a[152:155], v[76:79], v[140:143]
    v_exp_f32 v149, v149
    v_mfma_f32_16x16x32_bf16 v[140:143], a[156:159], v[80:83], v[140:143]
    ds_read_b64_tr_b16 a[210:211], v11 offset:20480
    v_mfma_f32_16x16x32_bf16 v[144:147], a[156:159], v[96:99], v[112:115]
    v_exp_f32 v150, v150
    v_mfma_f32_16x16x32_bf16 v[144:147], a[152:155], v[92:95], v[144:147]
    ds_read_b128 a[176:179], v1 offset:12288
    v_cvt_pk_bf16_f32 v184, v148, v149
    v_mfma_f32_16x16x32_bf16 v[144:147], a[148:151], v[88:91], v[144:147]
    v_exp_f32 v151, v151
    v_mfma_f32_16x16x32_bf16 v[144:147], a[144:147], v[84:87], v[144:147]
    ds_read_b64_tr_b16 a[212:213], v11 offset:40960
    v_mfma_f32_16x16x32_bf16 a[64:67], a[192:195], v[212:215], a[64:67]
    v_exp_f32 v152, v152
    v_mfma_f32_16x16x32_bf16 a[64:67], a[196:199], v[216:219], a[64:67]
    ds_read_b64_tr_b16 a[214:215], v11 offset:45056
    v_cvt_pk_bf16_f32 v185, v150, v151
    v_mfma_f32_16x16x32_bf16 a[68:71], a[196:199], v[224:227], a[68:71]
    v_exp_f32 v153, v153
    v_mfma_f32_16x16x32_bf16 a[68:71], a[192:195], v[220:223], a[68:71]
    ds_read_b128 a[180:183], v2 offset:12288
    v_cvt_pk_bf16_f32 v192, v152, v153
    v_mfma_f32_16x16x32_bf16 a[72:75], a[192:195], v[228:231], a[72:75]
    v_exp_f32 v154, v154
    v_mfma_f32_16x16x32_bf16 a[72:75], a[196:199], v[232:235], a[72:75]
    buffer_load_dwordx4 v17, s[12:15], s29 offen offset:2048 lds
    v_mfma_f32_16x16x32_bf16 a[76:79], a[196:199], v[240:243], a[76:79]
    v_exp_f32 v155, v155
    v_mfma_f32_16x16x32_bf16 a[76:79], a[192:195], v[236:239], a[76:79]
    s_waitcnt lgkmcnt(6)
    v_mfma_f32_16x16x32_bf16 v[148:151], a[160:163], v[36:39], v[100:103]
    v_exp_f32 v156, v156
    v_mfma_f32_16x16x32_bf16 v[148:151], a[164:167], v[40:43], v[148:151]
    ds_read_b64_tr_b16 a[216:217], v12 offset:16384
    v_cvt_pk_bf16_f32 v193, v154, v155
    v_mfma_f32_16x16x32_bf16 v[148:151], a[168:171], v[44:47], v[148:151]
    v_exp_f32 v157, v157
    v_mfma_f32_16x16x32_bf16 v[148:151], a[172:175], v[48:51], v[148:151]
    ds_read_b64_tr_b16 a[218:219], v12 offset:20480
    v_mfma_f32_16x16x32_bf16 v[152:155], a[172:175], v[64:67], v[104:107]
    v_exp_f32 v158, v158
    v_mfma_f32_16x16x32_bf16 v[152:155], a[168:171], v[60:63], v[152:155]
    ds_read_b128 a[184:187], v3 offset:12288
    v_cvt_pk_bf16_f32 v200, v156, v157
    v_mfma_f32_16x16x32_bf16 v[152:155], a[164:167], v[56:59], v[152:155]
    v_exp_f32 v159, v159
    v_mfma_f32_16x16x32_bf16 v[152:155], a[160:163], v[52:55], v[152:155]
    ds_read_b64_tr_b16 a[220:221], v12 offset:40960
    v_mfma_f32_16x16x32_bf16 a[80:83], a[200:203], v[212:215], a[80:83]
    v_exp_f32 v160, v160
    v_mfma_f32_16x16x32_bf16 a[80:83], a[204:207], v[216:219], a[80:83]
    ds_read_b64_tr_b16 a[222:223], v12 offset:45056
    v_cvt_pk_bf16_f32 v201, v158, v159
    v_mfma_f32_16x16x32_bf16 a[84:87], a[204:207], v[224:227], a[84:87]
    v_exp_f32 v161, v161
    v_mfma_f32_16x16x32_bf16 a[84:87], a[200:203], v[220:223], a[84:87]
    ds_read_b128 a[188:191], v4 offset:12288
    v_mfma_f32_16x16x32_bf16 a[88:91], a[200:203], v[228:231], a[88:91]
    v_exp_f32 v162, v162
    v_mfma_f32_16x16x32_bf16 a[88:91], a[204:207], v[232:235], a[88:91]
    v_cvt_pk_bf16_f32 v208, v160, v161
    v_mfma_f32_16x16x32_bf16 a[92:95], a[204:207], v[240:243], a[92:95]
    v_exp_f32 v163, v163
    v_mfma_f32_16x16x32_bf16 a[92:95], a[200:203], v[236:239], a[92:95]
    buffer_load_dwordx4 v18, s[12:15], s29 offen offset:3072 lds
    v_smfmac_f32_16x16x64_bf16 a[232:235], v[244:247], v[228:235], v248
    s_waitcnt vmcnt(8) lgkmcnt(6)
    s_barrier
    s_add_u32 s29, s29, 16384
    v_mfma_f32_16x16x32_bf16 v[156:159], a[160:163], v[68:71], v[108:111]
    v_exp_f32 v164, v164
    v_mfma_f32_16x16x32_bf16 v[156:159], a[164:167], v[72:75], v[156:159]
    ds_read_b64_tr_b16 a[192:193], v5 offset:57344
    v_cvt_pk_bf16_f32 v209, v162, v163
    v_mfma_f32_16x16x32_bf16 v[156:159], a[168:171], v[76:79], v[156:159]
    v_exp_f32 v165, v165
    v_mfma_f32_16x16x32_bf16 v[156:159], a[172:175], v[80:83], v[156:159]
    ds_read_b64_tr_b16 a[194:195], v5 offset:61440
    v_mfma_f32_16x16x32_bf16 v[160:163], a[172:175], v[96:99], v[112:115]
    v_exp_f32 v166, v166
    v_mfma_f32_16x16x32_bf16 v[160:163], a[168:171], v[92:95], v[160:163]
    ds_read_b128 a[128:131], v1 offset:49152
    v_cvt_pk_bf16_f32 v186, v164, v165
    v_mfma_f32_16x16x32_bf16 v[160:163], a[164:167], v[88:91], v[160:163]
    v_exp_f32 v167, v167
    v_mfma_f32_16x16x32_bf16 v[160:163], a[160:163], v[84:87], v[160:163]
    ds_read_b64_tr_b16 a[196:197], v5 offset:0
    v_mfma_f32_16x16x32_bf16 a[96:99], a[208:211], v[212:215], a[96:99]
    v_exp_f32 v168, v168
    v_mfma_f32_16x16x32_bf16 a[96:99], a[212:215], v[216:219], a[96:99]
    ds_read_b64_tr_b16 a[198:199], v5 offset:4096
    v_cvt_pk_bf16_f32 v187, v166, v167
    v_mfma_f32_16x16x32_bf16 a[100:103], a[212:215], v[224:227], a[100:103]
    v_exp_f32 v169, v169
    v_mfma_f32_16x16x32_bf16 a[100:103], a[208:211], v[220:223], a[100:103]
    ds_read_b128 a[132:135], v2 offset:49152
    v_cvt_pk_bf16_f32 v194, v168, v169
    v_mfma_f32_16x16x32_bf16 a[104:107], a[208:211], v[228:231], a[104:107]
    s_add_u32 m0, s34, 32768
    v_exp_f32 v170, v170
    v_mfma_f32_16x16x32_bf16 a[104:107], a[212:215], v[232:235], a[104:107]
    buffer_load_dwordx4 v13, s[8:11], s28 offen offset:0 lds
    v_mfma_f32_16x16x32_bf16 a[108:111], a[212:215], v[240:243], a[108:111]
    v_exp_f32 v171, v171
    v_mfma_f32_16x16x32_bf16 a[108:111], a[208:211], v[236:239], a[108:111]
    s_waitcnt lgkmcnt(6)
    v_mfma_f32_16x16x32_bf16 v[164:167], a[176:179], v[36:39], v[100:103]
    v_exp_f32 v172, v172
    v_mfma_f32_16x16x32_bf16 v[164:167], a[180:183], v[40:43], v[164:167]
    ds_read_b64_tr_b16 a[200:201], v6 offset:57344
    v_cvt_pk_bf16_f32 v195, v170, v171
    v_mfma_f32_16x16x32_bf16 v[164:167], a[184:187], v[44:47], v[164:167]
    v_exp_f32 v173, v173
    v_mfma_f32_16x16x32_bf16 v[164:167], a[188:191], v[48:51], v[164:167]
    ds_read_b64_tr_b16 a[202:203], v6 offset:61440
    v_mfma_f32_16x16x32_bf16 v[168:171], a[188:191], v[64:67], v[104:107]
    v_exp_f32 v174, v174
    v_mfma_f32_16x16x32_bf16 v[168:171], a[184:187], v[60:63], v[168:171]
    ds_read_b128 a[136:139], v3 offset:49152
    v_cvt_pk_bf16_f32 v202, v172, v173
    v_mfma_f32_16x16x32_bf16 v[168:171], a[180:183], v[56:59], v[168:171]
    v_exp_f32 v175, v175
    v_mfma_f32_16x16x32_bf16 v[168:171], a[176:179], v[52:55], v[168:171]
    ds_read_b64_tr_b16 a[204:205], v6 offset:0
    v_mfma_f32_16x16x32_bf16 a[112:115], a[216:219], v[212:215], a[112:115]
    v_exp_f32 v176, v176
    v_mfma_f32_16x16x32_bf16 a[112:115], a[220:223], v[216:219], a[112:115]
    ds_read_b64_tr_b16 a[206:207], v6 offset:4096
    v_cvt_pk_bf16_f32 v203, v174, v175
    v_mfma_f32_16x16x32_bf16 a[116:119], a[220:223], v[224:227], a[116:119]
    v_exp_f32 v177, v177
    v_mfma_f32_16x16x32_bf16 a[116:119], a[216:219], v[220:223], a[116:119]
    ds_read_b128 a[140:143], v4 offset:49152
    v_mfma_f32_16x16x32_bf16 a[120:123], a[216:219], v[228:231], a[120:123]
    v_exp_f32 v178, v178
    v_mfma_f32_16x16x32_bf16 a[120:123], a[220:223], v[232:235], a[120:123]
    v_cvt_pk_bf16_f32 v210, v176, v177
    v_mfma_f32_16x16x32_bf16 a[124:127], a[220:223], v[240:243], a[124:127]
    v_exp_f32 v179, v179
    v_mfma_f32_16x16x32_bf16 a[124:127], a[216:219], v[236:239], a[124:127]
    buffer_load_dwordx4 v14, s[8:11], s28 offen offset:1024 lds
    v_smfmac_f32_16x16x64_bf16 a[236:239], v[244:247], v[236:243], v248
    s_waitcnt lgkmcnt(6)
    v_mfma_f32_16x16x32_bf16 v[172:175], a[176:179], v[68:71], v[108:111]
    v_exp_f32 v116, v116
    v_mfma_f32_16x16x32_bf16 v[172:175], a[180:183], v[72:75], v[172:175]
    ds_read_b64_tr_b16 a[208:209], v7 offset:57344
    v_cvt_pk_bf16_f32 v211, v178, v179
    v_mfma_f32_16x16x32_bf16 v[172:175], a[184:187], v[76:79], v[172:175]
    v_exp_f32 v117, v117
    v_mfma_f32_16x16x32_bf16 v[172:175], a[188:191], v[80:83], v[172:175]
    ds_read_b64_tr_b16 a[210:211], v7 offset:61440
    v_mfma_f32_16x16x32_bf16 v[176:179], a[188:191], v[96:99], v[112:115]
    v_exp_f32 v118, v118
    v_mfma_f32_16x16x32_bf16 v[176:179], a[184:187], v[92:95], v[176:179]
    ds_read_b128 a[144:147], v1 offset:53248
    v_cvt_pk_bf16_f32 v212, v116, v117
    v_mfma_f32_16x16x32_bf16 v[176:179], a[180:183], v[88:91], v[176:179]
    v_exp_f32 v119, v119
    v_mfma_f32_16x16x32_bf16 v[176:179], a[176:179], v[84:87], v[176:179]
    ds_read_b64_tr_b16 a[212:213], v7 offset:0
    v_mfma_f32_16x16x32_bf16 a[0:3], a[192:195], v[180:183], a[0:3]
    v_exp_f32 v120, v120
    v_mfma_f32_16x16x32_bf16 a[0:3], a[196:199], v[184:187], a[0:3]
    ds_read_b64_tr_b16 a[214:215], v7 offset:4096
    v_cvt_pk_bf16_f32 v213, v118, v119
    v_mfma_f32_16x16x32_bf16 a[4:7], a[196:199], v[192:195], a[4:7]
    v_exp_f32 v121, v121
    v_mfma_f32_16x16x32_bf16 a[4:7], a[192:195], v[188:191], a[4:7]
    ds_read_b128 a[148:151], v2 offset:53248
    v_cvt_pk_bf16_f32 v220, v120, v121
    v_mfma_f32_16x16x32_bf16 a[8:11], a[192:195], v[196:199], a[8:11]
    v_exp_f32 v122, v122
    v_mfma_f32_16x16x32_bf16 a[8:11], a[196:199], v[200:203], a[8:11]
    buffer_load_dwordx4 v15, s[8:11], s28 offen offset:2048 lds
    v_mfma_f32_16x16x32_bf16 a[12:15], a[196:199], v[208:211], a[12:15]
    v_exp_f32 v123, v123
    v_mfma_f32_16x16x32_bf16 a[12:15], a[192:195], v[204:207], a[12:15]
    s_waitcnt lgkmcnt(6)
    v_mfma_f32_16x16x32_bf16 v[116:119], a[128:131], v[36:39], v[100:103]
    v_exp_f32 v124, v124
    v_mfma_f32_16x16x32_bf16 v[116:119], a[132:135], v[40:43], v[116:119]
    ds_read_b64_tr_b16 a[216:217], v8 offset:57344
    v_cvt_pk_bf16_f32 v221, v122, v123
    v_mfma_f32_16x16x32_bf16 v[116:119], a[136:139], v[44:47], v[116:119]
    v_exp_f32 v125, v125
    v_mfma_f32_16x16x32_bf16 v[116:119], a[140:143], v[48:51], v[116:119]
    ds_read_b64_tr_b16 a[218:219], v8 offset:61440
    v_mfma_f32_16x16x32_bf16 v[120:123], a[140:143], v[64:67], v[104:107]
    v_exp_f32 v126, v126
    v_mfma_f32_16x16x32_bf16 v[120:123], a[136:139], v[60:63], v[120:123]
    ds_read_b128 a[152:155], v3 offset:53248
    v_cvt_pk_bf16_f32 v228, v124, v125
    v_mfma_f32_16x16x32_bf16 v[120:123], a[132:135], v[56:59], v[120:123]
    v_exp_f32 v127, v127
    v_mfma_f32_16x16x32_bf16 v[120:123], a[128:131], v[52:55], v[120:123]
    ds_read_b64_tr_b16 a[220:221], v8 offset:0
    v_mfma_f32_16x16x32_bf16 a[16:19], a[200:203], v[180:183], a[16:19]
    v_exp_f32 v128, v128
    v_mfma_f32_16x16x32_bf16 a[16:19], a[204:207], v[184:187], a[16:19]
    ds_read_b64_tr_b16 a[222:223], v8 offset:4096
    v_cvt_pk_bf16_f32 v229, v126, v127
    v_mfma_f32_16x16x32_bf16 a[20:23], a[204:207], v[192:195], a[20:23]
    v_exp_f32 v129, v129
    v_mfma_f32_16x16x32_bf16 a[20:23], a[200:203], v[188:191], a[20:23]
    ds_read_b128 a[156:159], v4 offset:53248
    v_mfma_f32_16x16x32_bf16 a[24:27], a[200:203], v[196:199], a[24:27]
    v_exp_f32 v130, v130
    v_mfma_f32_16x16x32_bf16 a[24:27], a[204:207], v[200:203], a[24:27]
    v_cvt_pk_bf16_f32 v236, v128, v129
    v_mfma_f32_16x16x32_bf16 a[28:31], a[204:207], v[208:211], a[28:31]
    v_exp_f32 v131, v131
    v_mfma_f32_16x16x32_bf16 a[28:31], a[200:203], v[204:207], a[28:31]
    buffer_load_dwordx4 v16, s[8:11], s28 offen offset:3072 lds
    v_smfmac_f32_16x16x64_bf16 a[224:227], v[244:247], v[180:187], v248
    s_waitcnt lgkmcnt(6)
    v_mfma_f32_16x16x32_bf16 v[124:127], a[128:131], v[68:71], v[108:111]
    s_cmp_eq_u32 s36, 1
    s_cbranch_scc1 L_site1
L_site_back1:
    v_exp_f32 v132, v132
    v_mfma_f32_16x16x32_bf16 v[124:127], a[132:135], v[72:75], v[124:127]
    ds_read_b64_tr_b16 a[192:193], v9 offset:57344
    v_cvt_pk_bf16_f32 v237, v130, v131
    v_mfma_f32_16x16x32_bf16 v[124:127], a[136:139], v[76:79], v[124:127]
    v_exp_f32 v133, v133
    v_mfma_f32_16x16x32_bf16 v[124:127], a[140:143], v[80:83], v[124:127]
    ds_read_b64_tr_b16 a[194:195], v9 offset:61440
    v_mfma_f32_16x16x32_bf16 v[128:131], a[140:143], v[96:99], v[112:115]
    v_exp_f32 v134, v134
    v_mfma_f32_16x16x32_bf16 v[128:131], a[136:139], v[92:95], v[128:131]
    ds_read_b128 a[160:163], v1 offset:57344
    v_cvt_pk_bf16_f32 v214, v132, v133
    v_mfma_f32_16x16x32_bf16 v[128:131], a[132:135], v[88:91], v[128:131]
    v_exp_f32 v135, v135
    v_mfma_f32_16x16x32_bf16 v[128:131], a[128:131], v[84:87], v[128:131]
    ds_read_b64_tr_b16 a[196:197], v9 offset:0
    v_mfma_f32_16x16x32_bf16 a[32:35], a[208:211], v[180:183], a[32:35]
    v_exp_f32 v136, v136
    v_mfma_f32_16x16x32_bf16 a[32:35], a[212:215], v[184:187], a[32:35]
    ds_read_b64_tr_b16 a[198:199], v9 offset:4096
    v_cvt_pk_bf16_f32 v215, v134, v135
    v_mfma_f32_16x16x32_bf16 a[36:39], a[212:215], v[192:195], a[36:39]
    v_exp_f32 v137, v137
    v_mfma_f32_16x16x32_bf16 a[36:39], a[208:211], v[188:191], a[36:39]
    ds_read_b128 a[164:167], v2 offset:57344
    v_cvt_pk_bf16_f32 v222, v136, v137
    v_mfma_f32_16x16x32_bf16 a[40:43], a[208:211], v[196:199], a[40:43]
    s_add_u32 s28, s28, 16384
    s_mov_b32 m0, s30
    v_exp_f32 v138, v138
    v_mfma_f32_16x16x32_bf16 a[40:43], a[212:215], v[200:203], a[40:43]
    buffer_load_dwordx4 v17, s[12:15], s29 offen offset:0 lds
    v_mfma_f32_16x16x32_bf16 a[44:47], a[212:215], v[208:211], a[44:47]
    v_exp_f32 v139, v139
    v_mfma_f32_16x16x32_bf16 a[44:47], a[208:211], v[204:207], a[44:47]
    s_waitcnt lgkmcnt(6)
    v_mfma_f32_16x16x32_bf16 v[132:135], a[144:147], v[36:39], v[100:103]
    v_exp_f32 v140, v140
    v_mfma_f32_16x16x32_bf16 v[132:135], a[148:151], v[40:43], v[132:135]
    ds_read_b64_tr_b16 a[200:201], v10 offset:57344
    v_cvt_pk_bf16_f32 v223, v138, v139
    v_mfma_f32_16x16x32_bf16 v[132:135], a[152:155], v[44:47], v[132:135]
    v_exp_f32 v141, v141
    v_mfma_f32_16x16x32_bf16 v[132:135], a[156:159], v[48:51], v[132:135]
    ds_read_b64_tr_b16 a[202:203], v10 offset:61440
    v_mfma_f32_16x16x32_bf16 v[136:139], a[156:159], v[64:67], v[104:107]
    v_exp_f32 v142, v142
    v_mfma_f32_16x16x32_bf16 v[136:139], a[152:155], v[60:63], v[136:139]
    ds_read_b128 a[168:171], v3 offset:57344
    v_cvt_pk_bf16_f32 v230, v140, v141
    v_mfma_f32_16x16x32_bf16 v[136:139], a[148:151], v[56:59], v[136:139]
    v_exp_f32 v143, v143
    v_mfma_f32_16x16x32_bf16 v[136:139], a[144:147], v[52:55], v[136:139]
    ds_read_b64_tr_b16 a[204:205], v10 offset:0
    v_mfma_f32_16x16x32_bf16 a[48:51], a[216:219], v[180:183], a[48:51]
    v_exp_f32 v144, v144
    v_mfma_f32_16x16x32_bf16 a[48:51], a[220:223], v[184:187], a[48:51]
    ds_read_b64_tr_b16 a[206:207], v10 offset:4096
    v_cvt_pk_bf16_f32 v231, v142, v143
    v_mfma_f32_16x16x32_bf16 a[52:55], a[220:223], v[192:195], a[52:55]
    v_exp_f32 v145, v145
    v_mfma_f32_16x16x32_bf16 a[52:55], a[216:219], v[188:191], a[52:55]
    ds_read_b128 a[172:175], v4 offset:57344
    v_mfma_f32_16x16x32_bf16 a[56:59], a[216:219], v[196:199], a[56:59]
    v_exp_f32 v146, v146
    v_mfma_f32_16x16x32_bf16 a[56:59], a[220:223], v[200:203], a[56:59]
    v_cvt_pk_bf16_f32 v238, v144, v145
    v_mfma_f32_16x16x32_bf16 a[60:63], a[220:223], v[208:211], a[60:63]
    v_exp_f32 v147, v147
    v_mfma_f32_16x16x32_bf16 a[60:63], a[216:219], v[204:207], a[60:63]
    buffer_load_dwordx4 v18, s[12:15], s29 offen offset:1024 lds
    v_smfmac_f32_16x16x64_bf16 a[228:231], v[244:247], v[188:195], v248
    s_waitcnt lgkmcnt(6)
    v_mfma_f32_16x16x32_bf16 v[140:143], a[144:147], v[68:71], v[108:111]
    v_exp_f32 v148, v148
    v_mfma_f32_16x16x32_bf16 v[140:143], a[148:151], v[72:75], v[140:143]
    ds_read_b64_tr_b16 a[208:209], v11 offset:57344
    v_cvt_pk_bf16_f32 v239, v146, v147
    v_mfma_f32_16x16x32_bf16 v[140:143], a[152:155], v[76:79], v[140:143]
    v_exp_f32 v149, v149
    v_mfma_f32_16x16x32_bf16 v[140:143], a[156:159], v[80:83], v[140:143]
    ds_read_b64_tr_b16 a[210:211], v11 offset:61440
    v_mfma_f32_16x16x32_bf16 v[144:147], a[156:159], v[96:99], v[112:115]
    v_exp_f32 v150, v150
    v_mfma_f32_16x16x32_bf16 v[144:147], a[152:155], v[92:95], v[144:147]
    ds_read_b128 a[176:179], v1 offset:61440
    v_cvt_pk_bf16_f32 v216, v148, v149
    v_mfma_f32_16x16x32_bf16 v[144:147], a[148:151], v[88:91], v[144:147]
    v_exp_f32 v151, v151
    v_mfma_f32_16x16x32_bf16 v[144:147], a[144:147], v[84:87], v[144:147]
    ds_read_b64_tr_b16 a[212:213], v11 offset:0
    v_mfma_f32_16x16x32_bf16 a[64:67], a[192:195], v[180:183], a[64:67]
    v_exp_f32 v152, v152
    v_mfma_f32_16x16x32_bf16 a[64:67], a[196:199], v[184:187], a[64:67]
    ds_read_b64_tr_b16 a[214:215], v11 offset:4096
    v_cvt_pk_bf16_f32 v217, v150, v151
    v_mfma_f32_16x16x32_bf16 a[68:71], a[196:199], v[192:195], a[68:71]
    v_exp_f32 v153, v153
    v_mfma_f32_16x16x32_bf16 a[68:71], a[192:195], v[188:191], a[68:71]
    ds_read_b128 a[180:183], v2 offset:61440
    v_cvt_pk_bf16_f32 v224, v152, v153
    v_mfma_f32_16x16x32_bf16 a[72:75], a[192:195], v[196:199], a[72:75]
    v_exp_f32 v154, v154
    v_mfma_f32_16x16x32_bf16 a[72:75], a[196:199], v[200:203], a[72:75]
    buffer_load_dwordx4 v17, s[12:15], s29 offen offset:2048 lds
    v_mfma_f32_16x16x32_bf16 a[76:79], a[196:199], v[208:211], a[76:79]
    v_exp_f32 v155, v155
    v_mfma_f32_16x16x32_bf16 a[76:79], a[192:195], v[204:207], a[76:79]
    s_waitcnt lgkmcnt(6)
    v_mfma_f32_16x16x32_bf16 v[148:151], a[160:163], v[36:39], v[100:103]
    v_exp_f32 v156, v156
    v_mfma_f32_16x16x32_bf16 v[148:151], a[164:167], v[40:43], v[148:151]
    ds_read_b64_tr_b16 a[216:217], v12 offset:57344
    v_cvt_pk_bf16_f32 v225, v154, v155
    v_mfma_f32_16x16x32_bf16 v[148:151], a[168:171], v[44:47], v[148:151]
    v_exp_f32 v157, v157
    v_mfma_f32_16x16x32_bf16 v[148:151], a[172:175], v[48:51], v[148:151]
    ds_read_b64_tr_b16 a[218:219], v12 offset:61440
    v_mfma_f32_16x16x32_bf16 v[152:155], a[172:175], v[64:67], v[104:107]
    v_exp_f32 v158, v158
    v_mfma_f32_16x16x32_bf16 v[152:155], a[168:171], v[60:63], v[152:155]
    ds_read_b128 a[184:187], v3 offset:61440
    v_cvt_pk_bf16_f32 v232, v156, v157
    v_mfma_f32_16x16x32_bf16 v[152:155], a[164:167], v[56:59], v[152:155]
    v_exp_f32 v159, v159
    v_mfma_f32_16x16x32_bf16 v[152:155], a[160:163], v[52:55], v[152:155]
    ds_read_b64_tr_b16 a[220:221], v12 offset:0
    v_mfma_f32_16x16x32_bf16 a[80:83], a[200:203], v[180:183], a[80:83]
    v_exp_f32 v160, v160
    v_mfma_f32_16x16x32_bf16 a[80:83], a[204:207], v[184:187], a[80:83]
    ds_read_b64_tr_b16 a[222:223], v12 offset:4096
    v_cvt_pk_bf16_f32 v233, v158, v159
    v_mfma_f32_16x16x32_bf16 a[84:87], a[204:207], v[192:195], a[84:87]
    v_exp_f32 v161, v161
    v_mfma_f32_16x16x32_bf16 a[84:87], a[200:203], v[188:191], a[84:87]
    ds_read_b128 a[188:191], v4 offset:61440
    v_mfma_f32_16x16x32_bf16 a[88:91], a[200:203], v[196:199], a[88:91]
    v_exp_f32 v162, v162
    v_mfma_f32_16x16x32_bf16 a[88:91], a[204:207], v[200:203], a[88:91]
    v_cvt_pk_bf16_f32 v240, v160, v161
    v_mfma_f32_16x16x32_bf16 a[92:95], a[204:207], v[208:211], a[92:95]
    v_exp_f32 v163, v163
    v_mfma_f32_16x16x32_bf16 a[92:95], a[200:203], v[204:207], a[92:95]
    buffer_load_dwordx4 v18, s[12:15], s29 offen offset:3072 lds
    v_smfmac_f32_16x16x64_bf16 a[232:235], v[244:247], v[196:203], v248
    s_waitcnt vmcnt(8) lgkmcnt(6)
    s_barrier
    s_add_u32 s29, s29, 16384
    v_mfma_f32_16x16x32_bf16 v[156:159], a[160:163], v[68:71], v[108:111]
    v_exp_f32 v164, v164
    v_mfma_f32_16x16x32_bf16 v[156:159], a[164:167], v[72:75], v[156:159]
    ds_read_b64_tr_b16 a[192:193], v5 offset:24576
    v_cvt_pk_bf16_f32 v241, v162, v163
    v_mfma_f32_16x16x32_bf16 v[156:159], a[168:171], v[76:79], v[156:159]
    v_exp_f32 v165, v165
    v_mfma_f32_16x16x32_bf16 v[156:159], a[172:175], v[80:83], v[156:159]
    ds_read_b64_tr_b16 a[194:195], v5 offset:28672
    v_mfma_f32_16x16x32_bf16 v[160:163], a[172:175], v[96:99], v[112:115]
    v_exp_f32 v166, v166
    v_mfma_f32_16x16x32_bf16 v[160:163], a[168:171], v[92:95], v[160:163]
    ds_read_b128 a[128:131], v1 offset:16384
    v_cvt_pk_bf16_f32 v218, v164, v165
    v_mfma_f32_16x16x32_bf16 v[160:163], a[164:167], v[88:91], v[160:163]
    v_exp_f32 v167, v167
    v_mfma_f32_16x16x32_bf16 v[160:163], a[160:163], v[84:87], v[160:163]
    ds_read_b64_tr_b16 a[196:197], v5 offset:49152
    v_mfma_f32_16x16x32_bf16 a[96:99], a[208:211], v[180:183], a[96:99]
    v_exp_f32 v168, v168
    v_mfma_f32_16x16x32_bf16 a[96:99], a[212:215], v[184:187], a[96:99]
    ds_read_b64_tr_b16 a[198:199], v5 offset:53248
    v_cvt_pk_bf16_f32 v219, v166, v167
    v_mfma_f32_16x16x32_bf16 a[100:103], a[212:215], v[192:195], a[100:103]
    v_exp_f32 v169, v169
    v_mfma_f32_16x16x32_bf16 a[100:103], a[208:211], v[188:191], a[100:103]
    ds_read_b128 a[132:135], v2 offset:16384
    v_cvt_pk_bf16_f32 v226, v168, v169
    v_mfma_f32_16x16x32_bf16 a[104:107], a[208:211], v[196:199], a[104:107]
    s_add_u32 m0, s34, 0
    v_exp_f32 v170, v170
    v_mfma_f32_16x16x32_bf16 a[104:107], a[212:215], v[200:203], a[104:107]
    buffer_load_dwordx4 v13, s[8:11], s28 offen offset:0 lds
    v_mfma_f32_16x16x32_bf16 a[108:111], a[212:215], v[208:211], a[108:111]
    v_exp_f32 v171, v171
    v_mfma_f32_16x16x32_bf16 a[108:111], a[208:211], v[204:207], a[108:111]
    s_waitcnt lgkmcnt(6)
    v_mfma_f32_16x16x32_bf16 v[164:167], a[176:179], v[36:39], v[100:103]
    s_cmp_eq_u32 s59, s35
    s_cbranch_scc1 L_once_pack
L_once_back_pack:
    v_exp_f32 v172, v172
    v_mfma_f32_16x16x32_bf16 v[164:167], a[180:183], v[40:43], v[164:167]
    ds_read_b64_tr_b16 a[200:201], v6 offset:24576
    v_cvt_pk_bf16_f32 v227, v170, v171
    v_mfma_f32_16x16x32_bf16 v[164:167], a[184:187], v[44:47], v[164:167]
    v_exp_f32 v173, v173
    v_mfma_f32_16x16x32_bf16 v[164:167], a[188:191], v[48:51], v[164:167]
    ds_read_b64_tr_b16 a[202:203], v6 offset:28672
    v_mfma_f32_16x16x32_bf16 v[168:171], a[188:191], v[64:67], v[104:107]
    v_exp_f32 v174, v174
    v_mfma_f32_16x16x32_bf16 v[168:171], a[184:187], v[60:63], v[168:171]
    ds_read_b128 a[136:139], v3 offset:16384
    v_cvt_pk_bf16_f32 v234, v172, v173
    v_mfma_f32_16x16x32_bf16 v[168:171], a[180:183], v[56:59], v[168:171]
    v_exp_f32 v175, v175
    v_mfma_f32_16x16x32_bf16 v[168:171], a[176:179], v[52:55], v[168:171]
    ds_read_b64_tr_b16 a[204:205], v6 offset:49152
    v_mfma_f32_16x16x32_bf16 a[112:115], a[216:219], v[180:183], a[112:115]
    v_exp_f32 v176, v176
    v_mfma_f32_16x16x32_bf16 a[112:115], a[220:223], v[184:187], a[112:115]
    ds_read_b64_tr_b16 a[206:207], v6 offset:53248
    v_cvt_pk_bf16_f32 v235, v174, v175
    v_mfma_f32_16x16x32_bf16 a[116:119], a[220:223], v[192:195], a[116:119]
    v_exp_f32 v177, v177
    v_mfma_f32_16x16x32_bf16 a[116:119], a[216:219], v[188:191], a[116:119]
    ds_read_b128 a[140:143], v4 offset:16384
    v_mfma_f32_16x16x32_bf16 a[120:123], a[216:219], v[196:199], a[120:123]
    v_exp_f32 v178, v178
    v_mfma_f32_16x16x32_bf16 a[120:123], a[220:223], v[200:203], a[120:123]
    v_cvt_pk_bf16_f32 v242, v176, v177
    v_mfma_f32_16x16x32_bf16 a[124:127], a[220:223], v[208:211], a[124:127]
    v_exp_f32 v179, v179
    v_mfma_f32_16x16x32_bf16 a[124:127], a[216:219], v[204:207], a[124:127]
    buffer_load_dwordx4 v14, s[8:11], s28 offen offset:1024 lds
    v_smfmac_f32_16x16x64_bf16 a[236:239], v[244:247], v[204:211], v248
    s_waitcnt lgkmcnt(6)
    v_mfma_f32_16x16x32_bf16 v[172:175], a[176:179], v[68:71], v[108:111]
    v_exp_f32 v116, v116
    v_mfma_f32_16x16x32_bf16 v[172:175], a[180:183], v[72:75], v[172:175]
    ds_read_b64_tr_b16 a[208:209], v7 offset:24576
    v_cvt_pk_bf16_f32 v243, v178, v179
    v_mfma_f32_16x16x32_bf16 v[172:175], a[184:187], v[76:79], v[172:175]
    v_exp_f32 v117, v117
    v_mfma_f32_16x16x32_bf16 v[172:175], a[188:191], v[80:83], v[172:175]
    ds_read_b64_tr_b16 a[210:211], v7 offset:28672
    v_mfma_f32_16x16x32_bf16 v[176:179], a[188:191], v[96:99], v[112:115]
    v_exp_f32 v118, v118
    v_mfma_f32_16x16x32_bf16 v[176:179], a[184:187], v[92:95], v[176:179]
    ds_read_b128 a[144:147], v1 offset:20480
    v_cvt_pk_bf16_f32 v180, v116, v117
    v_mfma_f32_16x16x32_bf16 v[176:179], a[180:183], v[88:91], v[176:179]
    v_exp_f32 v119, v119
    v_mfma_f32_16x16x32_bf16 v[176:179], a[176:179], v[84:87], v[176:179]
    ds_read_b64_tr_b16 a[212:213], v7 offset:49152
    v_mfma_f32_16x16x32_bf16 a[0:3], a[192:195], v[212:215], a[0:3]
    v_exp_f32 v120, v120
    v_mfma_f32_16x16x32_bf16 a[0:3], a[196:199], v[216:219], a[0:3]
    ds_read_b64_tr_b16 a[214:215], v7 offset:53248
    v_cvt_pk_bf16_f32 v181, v118, v119
    v_mfma_f32_16x16x32_bf16 a[4:7], a[196:199], v[224:227], a[4:7]
    v_exp_f32 v121, v121
    v_mfma_f32_16x16x32_bf16 a[4:7], a[192:195], v[220:223], a[4:7]
    ds_read_b128 a[148:151], v2 offset:20480
    v_cvt_pk_bf16_f32 v188, v120, v121
    v_mfma_f32_16x16x32_bf16 a[8:11], a[192:195], v[228:231], a[8:11]
    v_exp_f32 v122, v122
    v_mfma_f32_16x16x32_bf16 a[8:11], a[196:199], v[232:235], a[8:11]
    buffer_load_dwordx4 v15, s[8:11], s28 offen offset:2048 lds
    v_mfma_f32_16x16x32_bf16 a[12:15], a[196:199], v[240:243], a[12:15]
    v_exp_f32 v123, v123
    v_mfma_f32_16x16x32_bf16 a[12:15], a[192:195], v[236:239], a[12:15]
    s_waitcnt lgkmcnt(6)
    v_mfma_f32_16x16x32_bf16 v[116:119], a[128:131], v[36:39], v[100:103]
    v_exp_f32 v124, v124
    v_mfma_f32_16x16x32_bf16 v[116:119], a[132:135], v[40:43], v[116:119]
    ds_read_b64_tr_b16 a[216:217], v8 offset:24576
    v_cvt_pk_bf16_f32 v189, v122, v123
    v_mfma_f32_16x16x32_bf16 v[116:119], a[136:139], v[44:47], v[116:119]
    v_exp_f32 v125, v125
    v_mfma_f32_16x16x32_bf16 v[116:119], a[140:143], v[48:51], v[116:119]
    ds_read_b64_tr_b16 a[218:219], v8 offset:28672
    v_mfma_f32_16x16x32_bf16 v[120:123], a[140:143], v[64:67], v[104:107]
    v_exp_f32 v126, v126
    v_mfma_f32_16x16x32_bf16 v[120:123], a[136:139], v[60:63], v[120:123]
    ds_read_b128 a[152:155], v3 offset:20480
    v_cvt_pk_bf16_f32 v196, v124, v125
    v_mfma_f32_16x16x32_bf16 v[120:123], a[132:135], v[56:59], v[120:123]
    v_exp_f32 v127, v127
    v_mfma_f32_16x16x32_bf16 v[120:123], a[128:131], v[52:55], v[120:123]
    ds_read_b64_tr_b16 a[220:221], v8 offset:49152
    v_mfma_f32_16x16x32_bf16 a[16:19], a[200:203], v[212:215], a[16:19]
    v_exp_f32 v128, v128
    v_mfma_f32_16x16x32_bf16 a[16:19], a[204:207], v[216:219], a[16:19]
    ds_read_b64_tr_b16 a[222:223], v8 offset:53248
    v_cvt_pk_bf16_f32 v197, v126, v127
    v_mfma_f32_16x16x32_bf16 a[20:23], a[204:207], v[224:227], a[20:23]
    v_exp_f32 v129, v129
    v_mfma_f32_16x16x32_bf16 a[20:23], a[200:203], v[220:223], a[20:23]
    ds_read_b128 a[156:159], v4 offset:20480
    v_mfma_f32_16x16x32_bf16 a[24:27], a[200:203], v[228:231], a[24:27]
    v_exp_f32 v130, v130
    v_mfma_f32_16x16x32_bf16 a[24:27], a[204:207], v[232:235], a[24:27]
    v_cvt_pk_bf16_f32 v204, v128, v129
    v_mfma_f32_16x16x32_bf16 a[28:31], a[204:207], v[240:243], a[28:31]
    v_exp_f32 v131, v131
    v_mfma_f32_16x16x32_bf16 a[28:31], a[200:203], v[236:239], a[28:31]
    buffer_load_dwordx4 v16, s[8:11], s28 offen offset:3072 lds
    v_smfmac_f32_16x16x64_bf16 a[224:227], v[244:247], v[212:219], v248
    s_waitcnt lgkmcnt(6)
    v_mfma_f32_16x16x32_bf16 v[124:127], a[128:131], v[68:71], v[108:111]
    s_cmp_eq_u32 s36, 2
    s_cbranch_scc1 L_site2
L_site_back2:
    v_exp_f32 v132, v132
    v_mfma_f32_16x16x32_bf16 v[124:127], a[132:135], v[72:75], v[124:127]
    ds_read_b64_tr_b16 a[192:193], v9 offset:24576
    v_cvt_pk_bf16_f32 v205, v130, v131
    v_mfma_f32_16x16x32_bf16 v[124:127], a[136:139], v[76:79], v[124:127]
    v_exp_f32 v133, v133
    v_mfma_f32_16x16x32_bf16 v[124:127], a[140:143], v[80:83], v[124:127]
    ds_read_b64_tr_b16 a[194:195], v9 offset:28672
    v_mfma_f32_16x16x32_bf16 v[128:131], a[140:143], v[96:99], v[112:115]
    v_exp_f32 v134, v134
    v_mfma_f32_16x16x32_bf16 v[128:131], a[136:139], v[92:95], v[128:131]
    ds_read_b128 a[160:163], v1 offset:24576
    v_cvt_pk_bf16_f32 v182, v132, v133
    v_mfma_f32_16x16x32_bf16 v[128:131], a[132:135], v[88:91], v[128:131]
    v_exp_f32 v135, v135
    v_mfma_f32_16x16x32_bf16 v[128:131], a[128:131], v[84:87], v[128:131]
    ds_read_b64_tr_b16 a[196:197], v9 offset:49152
    v_mfma_f32_16x16x32_bf16 a[32:35], a[208:211], v[212:215], a[32:35]
    v_exp_f32 v136, v136
    v_mfma_f32_16x16x32_bf16 a[32:35], a[212:215], v[216:219], a[32:35]
    ds_read_b64_tr_b16 a[198:199], v9 offset:53248
    v_cvt_pk_bf16_f32 v183, v134, v135
    v_mfma_f32_16x16x32_bf16 a[36:39], a[212:215], v[224:227], a[36:39]
    v_exp_f32 v137, v137
    v_mfma_f32_16x16x32_bf16 a[36:39], a[208:211], v[220:223], a[36:39]
    ds_read_b128 a[164:167], v2 offset:24576
    v_cvt_pk_bf16_f32 v190, v136, v137
    v_mfma_f32_16x16x32_bf16 a[40:43], a[208:211], v[228:231], a[40:43]
    s_add_u32 s28, s28, 16384
    s_mov_b32 m0, s31
    v_exp_f32 v138, v138
    v_mfma_f32_16x16x32_bf16 a[40:43], a[212:215], v[232:235], a[40:43]
    buffer_load_dwordx4 v17, s[12:15], s29 offen offset:0 lds
    v_mfma_f32_16x16x32_bf16 a[44:47], a[212:215], v[240:243], a[44:47]
    v_exp_f32 v139, v139
    v_mfma_f32_16x16x32_bf16 a[44:47], a[208:211], v[236:239], a[44:47]
    s_waitcnt lgkmcnt(6)
    v_mfma_f32_16x16x32_bf16 v[132:135], a[144:147], v[36:39], v[100:103]
    v_exp_f32 v140, v140
    v_mfma_f32_16x16x32_bf16 v[132:135], a[148:151], v[40:43], v[132:135]
    ds_read_b64_tr_b16 a[200:201], v10 offset:24576
    v_cvt_pk_bf16_f32 v191, v138, v139
    v_mfma_f32_16x16x32_bf16 v[132:135], a[152:155], v[44:47], v[132:135]
    v_exp_f32 v141, v141
    v_mfma_f32_16x16x32_bf16 v[132:135], a[156:159], v[48:51], v[132:135]
    ds_read_b64_tr_b16 a[202:203], v10 offset:28672
    v_mfma_f32_16x16x32_bf16 v[136:139], a[156:159], v[64:67], v[104:107]
    v_exp_f32 v142, v142
    v_mfma_f32_16x16x32_bf16 v[136:139], a[152:155], v[60:63], v[136:139]
    ds_read_b128 a[168:171], v3 offset:24576
    v_cvt_pk_bf16_f32 v198, v140, v141
    v_mfma_f32_16x16x32_bf16 v[136:139], a[148:151], v[56:59], v[136:139]
    v_exp_f32 v143, v143
    v_mfma_f32_16x16x32_bf16 v[136:139], a[144:147], v[52:55], v[136:139]
    ds_read_b64_tr_b16 a[204:205], v10 offset:49152
    v_mfma_f32_16x16x32_bf16 a[48:51], a[216:219], v[212:215], a[48:51]
    v_exp_f32 v144, v144
    v_mfma_f32_16x16x32_bf16 a[48:51], a[220:223], v[216:219], a[48:51]
    ds_read_b64_tr_b16 a[206:207], v10 offset:53248
    v_cvt_pk_bf16_f32 v199, v142, v143
    v_mfma_f32_16x16x32_bf16 a[52:55], a[220:223], v[224:227], a[52:55]
    v_exp_f32 v145, v145
    v_mfma_f32_16x16x32_bf16 a[52:55], a[216:219], v[220:223], a[52:55]
    ds_read_b128 a[172:175], v4 offset:24576
    v_mfma_f32_16x16x32_bf16 a[56:59], a[216:219], v[228:231], a[56:59]
    v_exp_f32 v146, v146
    v_mfma_f32_16x16x32_bf16 a[56:59], a[220:223], v[232:235], a[56:59]
    v_cvt_pk_bf16_f32 v206, v144, v145
    v_mfma_f32_16x16x32_bf16 a[60:63], a[220:223], v[240:243], a[60:63]
    v_exp_f32 v147, v147
    v_mfma_f32_16x16x32_bf16 a[60:63], a[216:219], v[236:239], a[60:63]
    buffer_load_dwordx4 v18, s[12:15], s29 offen offset:1024 lds
    v_smfmac_f32_16x16x64_bf16 a[228:231], v[244:247], v[220:227], v248
    s_waitcnt lgkmcnt(6)
    v_mfma_f32_16x16x32_bf16 v[140:143], a[144:147], v[68:71], v[108:111]
    v_exp_f32 v148, v148
    v_mfma_f32_16x16x32_bf16 v[140:143], a[148:151], v[72:75], v[140:143]
    ds_read_b64_tr_b16 a[208:209], v11 offset:24576
    v_cvt_pk_bf16_f32 v207, v146, v147
    v_mfma_f32_16x16x32_bf16 v[140:143], a[152:155], v[76:79], v[140:143]
    v_exp_f32 v149, v149
    v_mfma_f32_16x16x32_bf16 v[140:143], a[156:159], v[80:83], v[140:143]
    ds_read_b64_tr_b16 a[210:211], v11 offset:28672
    v_mfma_f32_16x16x32_bf16 v[144:147], a[156:159], v[96:99], v[112:115]
    v_exp_f32 v150, v150
    v_mfma_f32_16x16x32_bf16 v[144:147], a[152:155], v[92:95], v[144:147]
    ds_read_b128 a[176:179], v1 offset:28672
    v_cvt_pk_bf16_f32 v184, v148, v149
    v_mfma_f32_16x16x32_bf16 v[144:147], a[148:151], v[88:91], v[144:147]
    v_exp_f32 v151, v151
    v_mfma_f32_16x16x32_bf16 v[144:147], a[144:147], v[84:87], v[144:147]
    ds_read_b64_tr_b16 a[212:213], v11 offset:49152
    v_mfma_f32_16x16x32_bf16 a[64:67], a[192:195], v[212:215], a[64:67]
    v_exp_f32 v152, v152
    v_mfma_f32_16x16x32_bf16 a[64:67], a[196:199], v[216:219], a[64:67]
    ds_read_b64_tr_b16 a[214:215], v11 offset:53248
    v_cvt_pk_bf16_f32 v185, v150, v151
    v_mfma_f32_16x16x32_bf16 a[68:71], a[196:199], v[224:227], a[68:71]
    v_exp_f32 v153, v153
    v_mfma_f32_16x16x32_bf16 a[68:71], a[192:195], v[220:223], a[68:71]
    ds_read_b128 a[180:183], v2 offset:28672
    v_cvt_pk_bf16_f32 v192, v152, v153
    v_mfma_f32_16x16x32_bf16 a[72:75], a[192:195], v[228:231], a[72:75]
    v_exp_f32 v154, v154
    v_mfma_f32_16x16x32_bf16 a[72:75], a[196:199], v[232:235], a[72:75]
    buffer_load_dwordx4 v17, s[12:15], s29 offen offset:2048 lds
    v_mfma_f32_16x16x32_bf16 a[76:79], a[196:199], v[240:243], a[76:79]
    v_exp_f32 v155, v155
    v_mfma_f32_16x16x32_bf16 a[76:79], a[192:195], v[236:239], a[76:79]
    s_waitcnt lgkmcnt(6)
    v_mfma_f32_16x16x32_bf16 v[148:151], a[160:163], v[36:39], v[100:103]
    v_exp_f32 v156, v156
    v_mfma_f32_16x16x32_bf16 v[148:151], a[164:167], v[40:43], v[148:151]
    ds_read_b64_tr_b16 a[216:217], v12 offset:24576
    v_cvt_pk_bf16_f32 v193, v154, v155
    v_mfma_f32_16x16x32_bf16 v[148:151], a[168:171], v[44:47], v[148:151]
    v_exp_f32 v157, v157
    v_mfma_f32_16x16x32_bf16 v[148:151], a[172:175], v[48:51], v[148:151]
    ds_read_b64_tr_b16 a[218:219], v12 offset:28672
    v_mfma_f32_16x16x32_bf16 v[152:155], a[172:175], v[64:67], v[104:107]
    v_exp_f32 v158, v158
    v_mfma_f32_16x16x32_bf16 v[152:155], a[168:171], v[60:63], v[152:155]
    ds_read_b128 a[184:187], v3 offset:28672
    v_cvt_pk_bf16_f32 v200, v156, v157
    v_mfma_f32_16x16x32_bf16 v[152:155], a[164:167], v[56:59], v[152:155]
    v_exp_f32 v159, v159
    v_mfma_f32_16x16x32_bf16 v[152:155], a[160:163], v[52:55], v[152:155]
    ds_read_b64_tr_b16 a[220:221], v12 offset:49152
    v_mfma_f32_16x16x32_bf16 a[80:83], a[200:203], v[212:215], a[80:83]
    v_exp_f32 v160, v160
    v_mfma_f32_16x16x32_bf16 a[80:83], a[204:207], v[216:219], a[80:83]
    ds_read_b64_tr_b16 a[222:223], v12 offset:53248
    v_cvt_pk_bf16_f32 v201, v158, v159
    v_mfma_f32_16x16x32_bf16 a[84:87], a[204:207], v[224:227], a[84:87]
    v_exp_f32 v161, v161
    v_mfma_f32_16x16x32_bf16 a[84:87], a[200:203], v[220:223], a[84:87]
    ds_read_b128 a[188:191], v4 offset:28672
    v_mfma_f32_16x16x32_bf16 a[88:91], a[200:203], v[228:231], a[88:91]
    v_exp_f32 v162, v162
    v_mfma_f32_16x16x32_bf16 a[88:91], a[204:207], v[232:235], a[88:91]
    v_cvt_pk_bf16_f32 v208, v160, v161
    v_mfma_f32_16x16x32_bf16 a[92:95], a[204:207], v[240:243], a[92:95]
    v_exp_f32 v163, v163
    v_mfma_f32_16x16x32_bf16 a[92:95], a[200:203], v[236:239], a[92:95]
    buffer_load_dwordx4 v18, s[12:15], s29 offen offset:3072 lds
    v_smfmac_f32_16x16x64_bf16 a[232:235], v[244:247], v[228:235], v248
    s_waitcnt vmcnt(8) lgkmcnt(6)
    s_barrier
    s_add_u32 s29, s29, 16384
    v_mfma_f32_16x16x32_bf16 v[156:159], a[160:163], v[68:71], v[108:111]
    v_exp_f32 v164, v164
    v_mfma_f32_16x16x32_bf16 v[156:159], a[164:167], v[72:75], v[156:159]
    ds_read_b64_tr_b16 a[192:193], v5 offset:8192
    v_cvt_pk_bf16_f32 v209, v162, v163
    v_mfma_f32_16x16x32_bf16 v[156:159], a[168:171], v[76:79], v[156:159]
    v_exp_f32 v165, v165
    v_mfma_f32_16x16x32_bf16 v[156:159], a[172:175], v[80:83], v[156:159]
    ds_read_b64_tr_b16 a[194:195], v5 offset:12288
    v_mfma_f32_16x16x32_bf16 v[160:163], a[172:175], v[96:99], v[112:115]
    v_exp_f32 v166, v166
    v_mfma_f32_16x16x32_bf16 v[160:163], a[168:171], v[92:95], v[160:163]
    ds_read_b128 a[128:131], v1 offset:32768
    v_cvt_pk_bf16_f32 v186, v164, v165
    v_mfma_f32_16x16x32_bf16 v[160:163], a[164:167], v[88:91], v[160:163]
    v_exp_f32 v167, v167
    v_mfma_f32_16x16x32_bf16 v[160:163], a[160:163], v[84:87], v[160:163]
    ds_read_b64_tr_b16 a[196:197], v5 offset:32768
    v_mfma_f32_16x16x32_bf16 a[96:99], a[208:211], v[212:215], a[96:99]
    v_exp_f32 v168, v168
    v_mfma_f32_16x16x32_bf16 a[96:99], a[212:215], v[216:219], a[96:99]
    ds_read_b64_tr_b16 a[198:199], v5 offset:36864
    v_cvt_pk_bf16_f32 v187, v166, v167
    v_mfma_f32_16x16x32_bf16 a[100:103], a[212:215], v[224:227], a[100:103]
    v_exp_f32 v169, v169
    v_mfma_f32_16x16x32_bf16 a[100:103], a[208:211], v[220:223], a[100:103]
    ds_read_b128 a[132:135], v2 offset:32768
    v_cvt_pk_bf16_f32 v194, v168, v169
    v_mfma_f32_16x16x32_bf16 a[104:107], a[208:211], v[228:231], a[104:107]
    s_add_u32 m0, s34, 49152
    v_exp_f32 v170, v170
    v_mfma_f32_16x16x32_bf16 a[104:107], a[212:215], v[232:235], a[104:107]
    buffer_load_dwordx4 v13, s[8:11], s28 offen offset:0 lds
    v_mfma_f32_16x16x32_bf16 a[108:111], a[212:215], v[240:243], a[108:111]
    v_exp_f32 v171, v171
    v_mfma_f32_16x16x32_bf16 a[108:111], a[208:211], v[236:239], a[108:111]
    s_waitcnt lgkmcnt(6)
    v_mfma_f32_16x16x32_bf16 v[164:167], a[176:179], v[36:39], v[100:103]
    v_exp_f32 v172, v172
    v_mfma_f32_16x16x32_bf16 v[164:167], a[180:183], v[40:43], v[164:167]
    ds_read_b64_tr_b16 a[200:201], v6 offset:8192
    v_cvt_pk_bf16_f32 v195, v170, v171
    v_mfma_f32_16x16x32_bf16 v[164:167], a[184:187], v[44:47], v[164:167]
    v_exp_f32 v173, v173
    v_mfma_f32_16x16x32_bf16 v[164:167], a[188:191], v[48:51], v[164:167]
    ds_read_b64_tr_b16 a[202:203], v6 offset:12288
    v_mfma_f32_16x16x32_bf16 v[168:171], a[188:191], v[64:67], v[104:107]
    v_exp_f32 v174, v174
    v_mfma_f32_16x16x32_bf16 v[168:171], a[184:187], v[60:63], v[168:171]
    ds_read_b128 a[136:139], v3 offset:32768
    v_cvt_pk_bf16_f32 v202, v172, v173
    v_mfma_f32_16x16x32_bf16 v[168:171], a[180:183], v[56:59], v[168:171]
    v_exp_f32 v175, v175
    v_mfma_f32_16x16x32_bf16 v[168:171], a[176:179], v[52:55], v[168:171]
    ds_read_b64_tr_b16 a[204:205], v6 offset:32768
    v_mfma_f32_16x16x32_bf16 a[112:115], a[216:219], v[212:215], a[112:115]
    v_exp_f32 v176, v176
    v_mfma_f32_16x16x32_bf16 a[112:115], a[220:223], v[216:219], a[112:115]
    ds_read_b64_tr_b16 a[206:207], v6 offset:36864
    v_cvt_pk_bf16_f32 v203, v174, v175
    v_mfma_f32_16x16x32_bf16 a[116:119], a[220:223], v[224:227], a[116:119]
    v_exp_f32 v177, v177
    v_mfma_f32_16x16x32_bf16 a[116:119], a[216:219], v[220:223], a[116:119]
    ds_read_b128 a[140:143], v4 offset:32768
    v_mfma_f32_16x16x32_bf16 a[120:123], a[216:219], v[228:231], a[120:123]
    v_exp_f32 v178, v178
    v_mfma_f32_16x16x32_bf16 a[120:123], a[220:223], v[232:235], a[120:123]
    v_cvt_pk_bf16_f32 v210, v176, v177
    v_mfma_f32_16x16x32_bf16 a[124:127], a[220:223], v[240:243], a[124:127]
    v_exp_f32 v179, v179
    v_mfma_f32_16x16x32_bf16 a[124:127], a[216:219], v[236:239], a[124:127]
    buffer_load_dwordx4 v14, s[8:11], s28 offen offset:1024 lds
    v_smfmac_f32_16x16x64_bf16 a[236:239], v[244:247], v[236:243], v248
    s_waitcnt lgkmcnt(6)
    v_mfma_f32_16x16x32_bf16 v[172:175], a[176:179], v[68:71], v[108:111]
    v_exp_f32 v116, v116
    v_mfma_f32_16x16x32_bf16 v[172:175], a[180:183], v[72:75], v[172:175]
    ds_read_b64_tr_b16 a[208:209], v7 offset:8192
    v_cvt_pk_bf16_f32 v211, v178, v179
    v_mfma_f32_16x16x32_bf16 v[172:175], a[184:187], v[76:79], v[172:175]
    v_exp_f32 v117, v117
    v_mfma_f32_16x16x32_bf16 v[172:175], a[188:191], v[80:83], v[172:175]
    ds_read_b64_tr_b16 a[210:211], v7 offset:12288
    v_mfma_f32_16x16x32_bf16 v[176:179], a[188:191], v[96:99], v[112:115]
    v_exp_f32 v118, v118
    v_mfma_f32_16x16x32_bf16 v[176:179], a[184:187], v[92:95], v[176:179]
    ds_read_b128 a[144:147], v1 offset:36864
    v_cvt_pk_bf16_f32 v212, v116, v117
    v_mfma_f32_16x16x32_bf16 v[176:179], a[180:183], v[88:91], v[176:179]
    v_exp_f32 v119, v119
    v_mfma_f32_16x16x32_bf16 v[176:179], a[176:179], v[84:87], v[176:179]
    ds_read_b64_tr_b16 a[212:213], v7 offset:32768
    v_mfma_f32_16x16x32_bf16 a[0:3], a[192:195], v[180:183], a[0:3]
    v_exp_f32 v120, v120
    v_mfma_f32_16x16x32_bf16 a[0:3], a[196:199], v[184:187], a[0:3]
    ds_read_b64_tr_b16 a[214:215], v7 offset:36864
    v_cvt_pk_bf16_f32 v213, v118, v119
    v_mfma_f32_16x16x32_bf16 a[4:7], a[196:199], v[192:195], a[4:7]
    v_exp_f32 v121, v121
    v_mfma_f32_16x16x32_bf16 a[4:7], a[192:195], v[188:191], a[4:7]
    ds_read_b128 a[148:151], v2 offset:36864
    v_cvt_pk_bf16_f32 v220, v120, v121
    v_mfma_f32_16x16x32_bf16 a[8:11], a[192:195], v[196:199], a[8:11]
    v_exp_f32 v122, v122
    v_mfma_f32_16x16x32_bf16 a[8:11], a[196:199], v[200:203], a[8:11]
    buffer_load_dwordx4 v15, s[8:11], s28 offen offset:2048 lds
    v_mfma_f32_16x16x32_bf16 a[12:15], a[196:199], v[208:211], a[12:15]
    v_exp_f32 v123, v123
    v_mfma_f32_16x16x32_bf16 a[12:15], a[192:195], v[204:207], a[12:15]
    s_waitcnt lgkmcnt(6)
    v_mfma_f32_16x16x32_bf16 v[116:119], a[128:131], v[36:39], v[100:103]
    v_exp_f32 v124, v124
    v_mfma_f32_16x16x32_bf16 v[116:119], a[132:135], v[40:43], v[116:119]
    ds_read_b64_tr_b16 a[216:217], v8 offset:8192
    v_cvt_pk_bf16_f32 v221, v122, v123
    v_mfma_f32_16x16x32_bf16 v[116:119], a[136:139], v[44:47], v[116:119]
    v_exp_f32 v125, v125
    v_mfma_f32_16x16x32_bf16 v[116:119], a[140:143], v[48:51], v[116:119]
    ds_read_b64_tr_b16 a[218:219], v8 offset:12288
    v_mfma_f32_16x16x32_bf16 v[120:123], a[140:143], v[64:67], v[104:107]
    v_exp_f32 v126, v126
    v_mfma_f32_16x16x32_bf16 v[120:123], a[136:139], v[60:63], v[120:123]
    ds_read_b128 a[152:155], v3 offset:36864
    v_cvt_pk_bf16_f32 v228, v124, v125
    v_mfma_f32_16x16x32_bf16 v[120:123], a[132:135], v[56:59], v[120:123]
    v_exp_f32 v127, v127
    v_mfma_f32_16x16x32_bf16 v[120:123], a[128:131], v[52:55], v[120:123]
    ds_read_b64_tr_b16 a[220:221], v8 offset:32768
    v_mfma_f32_16x16x32_bf16 a[16:19], a[200:203], v[180:183], a[16:19]
    v_exp_f32 v128, v128
    v_mfma_f32_16x16x32_bf16 a[16:19], a[204:207], v[184:187], a[16:19]
    ds_read_b64_tr_b16 a[222:223], v8 offset:36864
    v_cvt_pk_bf16_f32 v229, v126, v127
    v_mfma_f32_16x16x32_bf16 a[20:23], a[204:207], v[192:195], a[20:23]
    v_exp_f32 v129, v129
    v_mfma_f32_16x16x32_bf16 a[20:23], a[200:203], v[188:191], a[20:23]
    ds_read_b128 a[156:159], v4 offset:36864
    v_mfma_f32_16x16x32_bf16 a[24:27], a[200:203], v[196:199], a[24:27]
    v_exp_f32 v130, v130
    v_mfma_f32_16x16x32_bf16 a[24:27], a[204:207], v[200:203], a[24:27]
    v_cvt_pk_bf16_f32 v236, v128, v129
    v_mfma_f32_16x16x32_bf16 a[28:31], a[204:207], v[208:211], a[28:31]
    v_exp_f32 v131, v131
    v_mfma_f32_16x16x32_bf16 a[28:31], a[200:203], v[204:207], a[28:31]
    buffer_load_dwordx4 v16, s[8:11], s28 offen offset:3072 lds
    v_smfmac_f32_16x16x64_bf16 a[224:227], v[244:247], v[180:187], v248
    s_waitcnt lgkmcnt(6)
    v_mfma_f32_16x16x32_bf16 v[124:127], a[128:131], v[68:71], v[108:111]
    s_cmp_eq_u32 s36, 3
    s_cbranch_scc1 L_site3
L_site_back3:
    v_exp_f32 v132, v132
    v_mfma_f32_16x16x32_bf16 v[124:127], a[132:135], v[72:75], v[124:127]
    ds_read_b64_tr_b16 a[192:193], v9 offset:8192
    v_cvt_pk_bf16_f32 v237, v130, v131
    v_mfma_f32_16x16x32_bf16 v[124:127], a[136:139], v[76:79], v[124:127]
    v_exp_f32 v133, v133
    v_mfma_f32_16x16x32_bf16 v[124:127], a[140:143], v[80:83], v[124:127]
    ds_read_b64_tr_b16 a[194:195], v9 offset:12288
    v_mfma_f32_16x16x32_bf16 v[128:131], a[140:143], v[96:99], v[112:115]
    v_exp_f32 v134, v134
    v_mfma_f32_16x16x32_bf16 v[128:131], a[136:139], v[92:95], v[128:131]
    ds_read_b128 a[160:163], v1 offset:40960
    v_cvt_pk_bf16_f32 v214, v132, v133
    v_mfma_f32_16x16x32_bf16 v[128:131], a[132:135], v[88:91], v[128:131]
    v_exp_f32 v135, v135
    v_mfma_f32_16x16x32_bf16 v[128:131], a[128:131], v[84:87], v[128:131]
    ds_read_b64_tr_b16 a[196:197], v9 offset:32768
    v_mfma_f32_16x16x32_bf16 a[32:35], a[208:211], v[180:183], a[32:35]
    v_exp_f32 v136, v136
    v_mfma_f32_16x16x32_bf16 a[32:35], a[212:215], v[184:187], a[32:35]
    ds_read_b64_tr_b16 a[198:199], v9 offset:36864
    v_cvt_pk_bf16_f32 v215, v134, v135
    v_mfma_f32_16x16x32_bf16 a[36:39], a[212:215], v[192:195], a[36:39]
    v_exp_f32 v137, v137
    v_mfma_f32_16x16x32_bf16 a[36:39], a[208:211], v[188:191], a[36:39]
    ds_read_b128 a[164:167], v2 offset:40960
    v_cvt_pk_bf16_f32 v222, v136, v137
    v_mfma_f32_16x16x32_bf16 a[40:43], a[208:211], v[196:199], a[40:43]
    s_add_u32 s28, s28, 16384
    s_mov_b32 m0, s32
    v_exp_f32 v138, v138
    v_mfma_f32_16x16x32_bf16 a[40:43], a[212:215], v[200:203], a[40:43]
    buffer_load_dwordx4 v17, s[12:15], s29 offen offset:0 lds
    v_mfma_f32_16x16x32_bf16 a[44:47], a[212:215], v[208:211], a[44:47]
    v_exp_f32 v139, v139
    v_mfma_f32_16x16x32_bf16 a[44:47], a[208:211], v[204:207], a[44:47]
    s_waitcnt lgkmcnt(6)
    v_mfma_f32_16x16x32_bf16 v[132:135], a[144:147], v[36:39], v[100:103]
    v_exp_f32 v140, v140
    v_mfma_f32_16x16x32_bf16 v[132:135], a[148:151], v[40:43], v[132:135]
    ds_read_b64_tr_b16 a[200:201], v10 offset:8192
    v_cvt_pk_bf16_f32 v223, v138, v139
    v_mfma_f32_16x16x32_bf16 v[132:135], a[152:155], v[44:47], v[132:135]
    v_exp_f32 v141, v141
    v_mfma_f32_16x16x32_bf16 v[132:135], a[156:159], v[48:51], v[132:135]
    ds_read_b64_tr_b16 a[202:203], v10 offset:12288
    v_mfma_f32_16x16x32_bf16 v[136:139], a[156:159], v[64:67], v[104:107]
    v_exp_f32 v142, v142
    v_mfma_f32_16x16x32_bf16 v[136:139], a[152:155], v[60:63], v[136:139]
    ds_read_b128 a[168:171], v3 offset:40960
    v_cvt_pk_bf16_f32 v230, v140, v141
    v_mfma_f32_16x16x32_bf16 v[136:139], a[148:151], v[56:59], v[136:139]
    v_exp_f32 v143, v143
    v_mfma_f32_16x16x32_bf16 v[136:139], a[144:147], v[52:55], v[136:139]
    ds_read_b64_tr_b16 a[204:205], v10 offset:32768
    v_mfma_f32_16x16x32_bf16 a[48:51], a[216:219], v[180:183], a[48:51]
    v_exp_f32 v144, v144
    v_mfma_f32_16x16x32_bf16 a[48:51], a[220:223], v[184:187], a[48:51]
    ds_read_b64_tr_b16 a[206:207], v10 offset:36864
    v_cvt_pk_bf16_f32 v231, v142, v143
    v_mfma_f32_16x16x32_bf16 a[52:55], a[220:223], v[192:195], a[52:55]
    v_exp_f32 v145, v145
    v_mfma_f32_16x16x32_bf16 a[52:55], a[216:219], v[188:191], a[52:55]
    ds_read_b128 a[172:175], v4 offset:40960
    v_mfma_f32_16x16x32_bf16 a[56:59], a[216:219], v[196:199], a[56:59]
    v_exp_f32 v146, v146
    v_mfma_f32_16x16x32_bf16 a[56:59], a[220:223], v[200:203], a[56:59]
    v_cvt_pk_bf16_f32 v238, v144, v145
    v_mfma_f32_16x16x32_bf16 a[60:63], a[220:223], v[208:211], a[60:63]
    v_exp_f32 v147, v147
    v_mfma_f32_16x16x32_bf16 a[60:63], a[216:219], v[204:207], a[60:63]
    buffer_load_dwordx4 v18, s[12:15], s29 offen offset:1024 lds
    v_smfmac_f32_16x16x64_bf16 a[228:231], v[244:247], v[188:195], v248
    s_waitcnt lgkmcnt(6)
    v_mfma_f32_16x16x32_bf16 v[140:143], a[144:147], v[68:71], v[108:111]
    v_exp_f32 v148, v148
    v_mfma_f32_16x16x32_bf16 v[140:143], a[148:151], v[72:75], v[140:143]
    ds_read_b64_tr_b16 a[208:209], v11 offset:8192
    v_cvt_pk_bf16_f32 v239, v146, v147
    v_mfma_f32_16x16x32_bf16 v[140:143], a[152:155], v[76:79], v[140:143]
    v_exp_f32 v149, v149
    v_mfma_f32_16x16x32_bf16 v[140:143], a[156:159], v[80:83], v[140:143]
    ds_read_b64_tr_b16 a[210:211], v11 offset:12288
    v_mfma_f32_16x16x32_bf16 v[144:147], a[156:159], v[96:99], v[112:115]
    v_exp_f32 v150, v150
    v_mfma_f32_16x16x32_bf16 v[144:147], a[152:155], v[92:95], v[144:147]
    ds_read_b128 a[176:179], v1 offset:45056
    v_cvt_pk_bf16_f32 v216, v148, v149
    v_mfma_f32_16x16x32_bf16 v[144:147], a[148:151], v[88:91], v[144:147]
    v_exp_f32 v151, v151
    v_mfma_f32_16x16x32_bf16 v[144:147], a[144:147], v[84:87], v[144:147]
    ds_read_b64_tr_b16 a[212:213], v11 offset:32768
    v_mfma_f32_16x16x32_bf16 a[64:67], a[192:195], v[180:183], a[64:67]
    v_exp_f32 v152, v152
    v_mfma_f32_16x16x32_bf16 a[64:67], a[196:199], v[184:187], a[64:67]
    ds_read_b64_tr_b16 a[214:215], v11 offset:36864
    v_cvt_pk_bf16_f32 v217, v150, v151
    v_mfma_f32_16x16x32_bf16 a[68:71], a[196:199], v[192:195], a[68:71]
    v_exp_f32 v153, v153
    v_mfma_f32_16x16x32_bf16 a[68:71], a[192:195], v[188:191], a[68:71]
    ds_read_b128 a[180:183], v2 offset:45056
    v_cvt_pk_bf16_f32 v224, v152, v153
    v_mfma_f32_16x16x32_bf16 a[72:75], a[192:195], v[196:199], a[72:75]
    v_exp_f32 v154, v154
    v_mfma_f32_16x16x32_bf16 a[72:75], a[196:199], v[200:203], a[72:75]
    buffer_load_dwordx4 v17, s[12:15], s29 offen offset:2048 lds
    v_mfma_f32_16x16x32_bf16 a[76:79], a[196:199], v[208:211], a[76:79]
    v_exp_f32 v155, v155
    v_mfma_f32_16x16x32_bf16 a[76:79], a[192:195], v[204:207], a[76:79]
    s_waitcnt lgkmcnt(6)
    v_mfma_f32_16x16x32_bf16 v[148:151], a[160:163], v[36:39], v[100:103]
    v_exp_f32 v156, v156
    v_mfma_f32_16x16x32_bf16 v[148:151], a[164:167], v[40:43], v[148:151]
    ds_read_b64_tr_b16 a[216:217], v12 offset:8192
    v_cvt_pk_bf16_f32 v225, v154, v155
    v_mfma_f32_16x16x32_bf16 v[148:151], a[168:171], v[44:47], v[148:151]
    v_exp_f32 v157, v157
    v_mfma_f32_16x16x32_bf16 v[148:151], a[172:175], v[48:51], v[148:151]
    ds_read_b64_tr_b16 a[218:219], v12 offset:12288
    v_mfma_f32_16x16x32_bf16 v[152:155], a[172:175], v[64:67], v[104:107]
    v_exp_f32 v158, v158
    v_mfma_f32_16x16x32_bf16 v[152:155], a[168:171], v[60:63], v[152:155]
    ds_read_b128 a[184:187], v3 offset:45056
    v_cvt_pk_bf16_f32 v232, v156, v157
    v_mfma_f32_16x16x32_bf16 v[152:155], a[164:167], v[56:59], v[152:155]
    v_exp_f32 v159, v159
    v_mfma_f32_16x16x32_bf16 v[152:155], a[160:163], v[52:55], v[152:155]
    ds_read_b64_tr_b16 a[220:221], v12 offset:32768
    v_mfma_f32_16x16x32_bf16 a[80:83], a[200:203], v[180:183], a[80:83]
    v_exp_f32 v160, v160
    v_mfma_f32_16x16x32_bf16 a[80:83], a[204:207], v[184:187], a[80:83]
    ds_read_b64_tr_b16 a[222:223], v12 offset:36864
    v_cvt_pk_bf16_f32 v233, v158, v159
    v_mfma_f32_16x16x32_bf16 a[84:87], a[204:207], v[192:195], a[84:87]
    v_exp_f32 v161, v161
    v_mfma_f32_16x16x32_bf16 a[84:87], a[200:203], v[188:191], a[84:87]
    ds_read_b128 a[188:191], v4 offset:45056
    v_mfma_f32_16x16x32_bf16 a[88:91], a[200:203], v[196:199], a[88:91]
    v_exp_f32 v162, v162
    v_mfma_f32_16x16x32_bf16 a[88:91], a[204:207], v[200:203], a[88:91]
    v_cvt_pk_bf16_f32 v240, v160, v161
    v_mfma_f32_16x16x32_bf16 a[92:95], a[204:207], v[208:211], a[92:95]
    v_exp_f32 v163, v163
    v_mfma_f32_16x16x32_bf16 a[92:95], a[200:203], v[204:207], a[92:95]
    buffer_load_dwordx4 v18, s[12:15], s29 offen offset:3072 lds
    v_smfmac_f32_16x16x64_bf16 a[232:235], v[244:247], v[196:203], v248
    s_waitcnt vmcnt(8) lgkmcnt(6)
    s_barrier
    s_add_u32 s29, s29, 16384
    v_mfma_f32_16x16x32_bf16 v[156:159], a[160:163], v[68:71], v[108:111]
    v_exp_f32 v164, v164
    v_mfma_f32_16x16x32_bf16 v[156:159], a[164:167], v[72:75], v[156:159]
    ds_read_b64_tr_b16 a[192:193], v5 offset:16384
    v_cvt_pk_bf16_f32 v241, v162, v163
    v_mfma_f32_16x16x32_bf16 v[156:159], a[168:171], v[76:79], v[156:159]
    v_exp_f32 v165, v165
    v_mfma_f32_16x16x32_bf16 v[156:159], a[172:175], v[80:83], v[156:159]
    ds_read_b64_tr_b16 a[194:195], v5 offset:20480
    v_mfma_f32_16x16x32_bf16 v[160:163], a[172:175], v[96:99], v[112:115]
    v_exp_f32 v166, v166
    v_mfma_f32_16x16x32_bf16 v[160:163], a[168:171], v[92:95], v[160:163]
    ds_read_b128 a[128:131], v1 offset:0
    v_cvt_pk_bf16_f32 v218, v164, v165
    v_mfma_f32_16x16x32_bf16 v[160:163], a[164:167], v[88:91], v[160:163]
    v_exp_f32 v167, v167
    v_mfma_f32_16x16x32_bf16 v[160:163], a[160:163], v[84:87], v[160:163]
    ds_read_b64_tr_b16 a[196:197], v5 offset:40960
    v_mfma_f32_16x16x32_bf16 a[96:99], a[208:211], v[180:183], a[96:99]
    v_exp_f32 v168, v168
    v_mfma_f32_16x16x32_bf16 a[96:99], a[212:215], v[184:187], a[96:99]
    ds_read_b64_tr_b16 a[198:199], v5 offset:45056
    v_cvt_pk_bf16_f32 v219, v166, v167
    v_mfma_f32_16x16x32_bf16 a[100:103], a[212:215], v[192:195], a[100:103]
    v_exp_f32 v169, v169
    v_mfma_f32_16x16x32_bf16 a[100:103], a[208:211], v[188:191], a[100:103]
    ds_read_b128 a[132:135], v2 offset:0
    v_cvt_pk_bf16_f32 v226, v168, v169
    v_mfma_f32_16x16x32_bf16 a[104:107], a[208:211], v[196:199], a[104:107]
    s_add_u32 m0, s34, 16384
    v_exp_f32 v170, v170
    v_mfma_f32_16x16x32_bf16 a[104:107], a[212:215], v[200:203], a[104:107]
    buffer_load_dwordx4 v13, s[8:11], s28 offen offset:0 lds
    v_mfma_f32_16x16x32_bf16 a[108:111], a[212:215], v[208:211], a[108:111]
    v_exp_f32 v171, v171
    v_mfma_f32_16x16x32_bf16 a[108:111], a[208:211], v[204:207], a[108:111]
    s_waitcnt lgkmcnt(6)
    v_mfma_f32_16x16x32_bf16 v[164:167], a[176:179], v[36:39], v[100:103]
    s_mov_b32 s36, s5
    v_exp_f32 v172, v172
    v_mfma_f32_16x16x32_bf16 v[164:167], a[180:183], v[40:43], v[164:167]
    ds_read_b64_tr_b16 a[200:201], v6 offset:16384
    v_cvt_pk_bf16_f32 v227, v170, v171
    v_mfma_f32_16x16x32_bf16 v[164:167], a[184:187], v[44:47], v[164:167]
    v_exp_f32 v173, v173
    v_mfma_f32_16x16x32_bf16 v[164:167], a[188:191], v[48:51], v[164:167]
    ds_read_b64_tr_b16 a[202:203], v6 offset:20480
    v_mfma_f32_16x16x32_bf16 v[168:171], a[188:191], v[64:67], v[104:107]
    v_exp_f32 v174, v174
    v_mfma_f32_16x16x32_bf16 v[168:171], a[184:187], v[60:63], v[168:171]
    ds_read_b128 a[136:139], v3 offset:0
    v_cvt_pk_bf16_f32 v234, v172, v173
    v_mfma_f32_16x16x32_bf16 v[168:171], a[180:183], v[56:59], v[168:171]
    v_exp_f32 v175, v175
    v_mfma_f32_16x16x32_bf16 v[168:171], a[176:179], v[52:55], v[168:171]
    ds_read_b64_tr_b16 a[204:205], v6 offset:40960
    v_mfma_f32_16x16x32_bf16 a[112:115], a[216:219], v[180:183], a[112:115]
    v_exp_f32 v176, v176
    v_mfma_f32_16x16x32_bf16 a[112:115], a[220:223], v[184:187], a[112:115]
    ds_read_b64_tr_b16 a[206:207], v6 offset:45056
    v_cvt_pk_bf16_f32 v235, v174, v175
    v_mfma_f32_16x16x32_bf16 a[116:119], a[220:223], v[192:195], a[116:119]
    v_exp_f32 v177, v177
    v_mfma_f32_16x16x32_bf16 a[116:119], a[216:219], v[188:191], a[116:119]
    ds_read_b128 a[140:143], v4 offset:0
    v_mfma_f32_16x16x32_bf16 a[120:123], a[216:219], v[196:199], a[120:123]
    v_exp_f32 v178, v178
    v_mfma_f32_16x16x32_bf16 a[120:123], a[220:223], v[200:203], a[120:123]
    v_cvt_pk_bf16_f32 v242, v176, v177
    v_mfma_f32_16x16x32_bf16 a[124:127], a[220:223], v[208:211], a[124:127]
    v_exp_f32 v179, v179
    v_mfma_f32_16x16x32_bf16 a[124:127], a[216:219], v[204:207], a[124:127]
    buffer_load_dwordx4 v14, s[8:11], s28 offen offset:1024 lds
    v_smfmac_f32_16x16x64_bf16 a[236:239], v[244:247], v[204:211], v248
    s_waitcnt lgkmcnt(6)
    s_sub_u32 s35, s35, 1
    s_cbranch_scc0 L_attn_loop
    v_mfma_f32_16x16x32_bf16 v[172:175], a[176:179], v[68:71], v[108:111]
    s_bfe_u32 s47, s2, 0x10003
    v_exp_f32 v116, v116
    v_mfma_f32_16x16x32_bf16 v[172:175], a[180:183], v[72:75], v[172:175]
    s_bfe_u32 s40, s2, 0x20001
    ds_read_b64_tr_b16 a[208:209], v7 offset:16384
    v_cvt_pk_bf16_f32 v243, v178, v179
    v_mfma_f32_16x16x32_bf16 v[172:175], a[184:187], v[76:79], v[172:175]
    s_lshl_b32 s40, s40, 3
    v_exp_f32 v117, v117
    v_mfma_f32_16x16x32_bf16 v[172:175], a[188:191], v[80:83], v[172:175]
    s_bfe_u32 s41, s2, 0x30003
    ds_read_b64_tr_b16 a[210:211], v7 offset:20480
    v_and_b32 v21, 7, v19
    v_mfma_f32_16x16x32_bf16 v[176:179], a[188:191], v[96:99], v[112:115]
    s_add_u32 s87, s40, s41
    v_exp_f32 v118, v118
    v_mfma_f32_16x16x32_bf16 v[176:179], a[184:187], v[92:95], v[176:179]
    s_and_b32 s40, s2, 1
    ds_read_b128 a[144:147], v1 offset:4096
    v_cvt_pk_bf16_f32 v180, v116, v117
    v_mfma_f32_16x16x32_bf16 v[176:179], a[180:183], v[88:91], v[176:179]
    s_lshl_b32 s40, s40, 2
    v_exp_f32 v119, v119
    v_mfma_f32_16x16x32_bf16 v[176:179], a[176:179], v[84:87], v[176:179]
    s_lshr_b32 s41, s2, 6
    ds_read_b64_tr_b16 a[212:213], v7 offset:40960
    v_lshlrev_b32 v21, 2, v21
    v_mfma_f32_16x16x32_bf16 a[0:3], a[192:195], v[212:215], a[0:3]
    s_add_u32 s100, s40, s41
    v_exp_f32 v120, v120
    v_mfma_f32_16x16x32_bf16 a[0:3], a[196:199], v[216:219], a[0:3]
    s_add_u32 s16, s72, 0x1a00000
    s_addc_u32 s17, s73, 0
    ds_read_b64_tr_b16 a[214:215], v7 offset:45056
    v_cvt_pk_bf16_f32 v181, v118, v119
    v_mfma_f32_16x16x32_bf16 a[4:7], a[196:199], v[224:227], a[4:7]
    s_mov_b32 s18, 0x438000
    v_exp_f32 v121, v121
    v_mfma_f32_16x16x32_bf16 a[4:7], a[192:195], v[220:223], a[4:7]
    s_mov_b32 s19, 0x20000
    ds_read_b128 a[148:151], v2 offset:4096
    v_cvt_pk_bf16_f32 v188, v120, v121
    v_mfma_f32_16x16x32_bf16 a[8:11], a[192:195], v[228:231], a[8:11]
    v_exp_f32 v122, v122
    v_mfma_f32_16x16x32_bf16 a[8:11], a[196:199], v[232:235], a[8:11]
    buffer_load_dwordx4 v15, s[8:11], s28 offen offset:2048 lds
    v_add_u32 v21, 0x29b000, v21
    v_mfma_f32_16x16x32_bf16 a[12:15], a[196:199], v[240:243], a[12:15]
    v_exp_f32 v123, v123
    v_mfma_f32_16x16x32_bf16 a[12:15], a[192:195], v[236:239], a[12:15]
    s_waitcnt lgkmcnt(6)
    buffer_load_dword v249, v21, s[76:79], 0 offen sc1
    v_mfma_f32_16x16x32_bf16 v[116:119], a[128:131], v[36:39], v[100:103]
    v_exp_f32 v124, v124
    v_mfma_f32_16x16x32_bf16 v[116:119], a[132:135], v[40:43], v[116:119]
    ds_read_b64_tr_b16 a[216:217], v8 offset:16384
    v_cvt_pk_bf16_f32 v189, v122, v123
    v_mfma_f32_16x16x32_bf16 v[116:119], a[136:139], v[44:47], v[116:119]
    v_exp_f32 v125, v125
    v_mfma_f32_16x16x32_bf16 v[116:119], a[140:143], v[48:51], v[116:119]
    ds_read_b64_tr_b16 a[218:219], v8 offset:20480
    v_lshlrev_b32 v32, 7, v19
    v_mfma_f32_16x16x32_bf16 v[120:123], a[140:143], v[64:67], v[104:107]
    v_exp_f32 v126, v126
    v_mfma_f32_16x16x32_bf16 v[120:123], a[136:139], v[60:63], v[120:123]
    ds_read_b128 a[152:155], v3 offset:4096
    v_cvt_pk_bf16_f32 v196, v124, v125
    v_mfma_f32_16x16x32_bf16 v[120:123], a[132:135], v[56:59], v[120:123]
    v_exp_f32 v127, v127
    v_mfma_f32_16x16x32_bf16 v[120:123], a[128:131], v[52:55], v[120:123]
    ds_read_b64_tr_b16 a[220:221], v8 offset:40960
    v_add_u32 v32, 0x290000, v32
    v_mfma_f32_16x16x32_bf16 a[16:19], a[200:203], v[212:215], a[16:19]
    v_exp_f32 v128, v128
    v_mfma_f32_16x16x32_bf16 a[16:19], a[204:207], v[216:219], a[16:19]
    ds_read_b64_tr_b16 a[222:223], v8 offset:45056
    v_cvt_pk_bf16_f32 v197, v126, v127
    v_mfma_f32_16x16x32_bf16 a[20:23], a[204:207], v[224:227], a[20:23]
    v_exp_f32 v129, v129
    v_mfma_f32_16x16x32_bf16 a[20:23], a[200:203], v[220:223], a[20:23]
    ds_read_b128 a[156:159], v4 offset:4096
    v_mfma_f32_16x16x32_bf16 a[24:27], a[200:203], v[228:231], a[24:27]
    v_exp_f32 v130, v130
    v_mfma_f32_16x16x32_bf16 a[24:27], a[204:207], v[232:235], a[24:27]
    v_cvt_pk_bf16_f32 v204, v128, v129
    v_mfma_f32_16x16x32_bf16 a[28:31], a[204:207], v[240:243], a[28:31]
    v_exp_f32 v131, v131
    v_mfma_f32_16x16x32_bf16 a[28:31], a[200:203], v[236:239], a[28:31]
    buffer_load_dwordx4 v16, s[8:11], s28 offen offset:3072 lds
    v_smfmac_f32_16x16x64_bf16 a[224:227], v[244:247], v[212:219], v248
    s_waitcnt lgkmcnt(6)
    buffer_load_dwordx4 v[28:31], v32, s[76:79], 0 offen sc1
    v_mfma_f32_16x16x32_bf16 v[124:127], a[128:131], v[68:71], v[108:111]
    v_exp_f32 v132, v132
    v_mfma_f32_16x16x32_bf16 v[124:127], a[132:135], v[72:75], v[124:127]
    ds_read_b64_tr_b16 a[192:193], v9 offset:16384
    v_cvt_pk_bf16_f32 v205, v130, v131
    v_mfma_f32_16x16x32_bf16 v[124:127], a[136:139], v[76:79], v[124:127]
    v_exp_f32 v133, v133
    v_mfma_f32_16x16x32_bf16 v[124:127], a[140:143], v[80:83], v[124:127]
    ds_read_b64_tr_b16 a[194:195], v9 offset:20480
    v_mov_b32 v24, 0x3f803f80
    v_mfma_f32_16x16x32_bf16 v[128:131], a[140:143], v[96:99], v[112:115]
    v_exp_f32 v134, v134
    v_mfma_f32_16x16x32_bf16 v[128:131], a[136:139], v[92:95], v[128:131]
    ds_read_b128 a[160:163], v1 offset:8192
    v_cvt_pk_bf16_f32 v182, v132, v133
    v_mfma_f32_16x16x32_bf16 v[128:131], a[132:135], v[88:91], v[128:131]
    v_exp_f32 v135, v135
    v_accvgpr_write_b32 a240, v24
    v_mfma_f32_16x16x32_bf16 v[128:131], a[128:131], v[84:87], v[128:131]
    ds_read_b64_tr_b16 a[196:197], v9 offset:40960
    v_accvgpr_write_b32 a241, v24
    v_mfma_f32_16x16x32_bf16 a[32:35], a[208:211], v[212:215], a[32:35]
    v_exp_f32 v136, v136
    v_mfma_f32_16x16x32_bf16 a[32:35], a[212:215], v[216:219], a[32:35]
    ds_read_b64_tr_b16 a[198:199], v9 offset:45056
    v_cvt_pk_bf16_f32 v183, v134, v135
    v_lshlrev_b32 v25, 4, v19
    v_mfma_f32_16x16x32_bf16 a[36:39], a[212:215], v[224:227], a[36:39]
    s_mul_i32 s40, s5, 3072
    v_exp_f32 v137, v137
    v_mfma_f32_16x16x32_bf16 a[36:39], a[208:211], v[220:223], a[36:39]
    s_mul_i32 s41, s6, 10240
    ds_read_b128 a[164:167], v2 offset:8192
    v_cvt_pk_bf16_f32 v190, v136, v137
    v_mfma_f32_16x16x32_bf16 a[40:43], a[208:211], v[228:231], a[40:43]
    s_add_u32 s28, s28, 16384
    s_mov_b32 m0, s33
    v_exp_f32 v138, v138
    v_accvgpr_write_b32 a242, v24
    v_mfma_f32_16x16x32_bf16 a[40:43], a[212:215], v[232:235], a[40:43]
    s_add_u32 s41, s41, s40
    buffer_load_dwordx4 v17, s[12:15], s29 offen offset:0 lds
    v_mfma_f32_16x16x32_bf16 a[44:47], a[212:215], v[240:243], a[44:47]
    v_exp_f32 v139, v139
    v_mfma_f32_16x16x32_bf16 a[44:47], a[208:211], v[236:239], a[44:47]
    s_waitcnt lgkmcnt(6)
    v_accvgpr_write_b32 a243, v24
    v_accvgpr_write_b32 a244, v24
    v_mfma_f32_16x16x32_bf16 v[132:135], a[144:147], v[36:39], v[100:103]
    v_exp_f32 v140, v140
    v_mfma_f32_16x16x32_bf16 v[132:135], a[148:151], v[40:43], v[132:135]
    ds_read_b64_tr_b16 a[200:201], v10 offset:16384
    v_cvt_pk_bf16_f32 v191, v138, v139
    v_mfma_f32_16x16x32_bf16 v[132:135], a[152:155], v[44:47], v[132:135]
    v_exp_f32 v141, v141
    v_mfma_f32_16x16x32_bf16 v[132:135], a[156:159], v[48:51], v[132:135]
    ds_read_b64_tr_b16 a[202:203], v10 offset:20480
    v_accvgpr_write_b32 a245, v24
    v_mfma_f32_16x16x32_bf16 v[136:139], a[156:159], v[64:67], v[104:107]
    v_exp_f32 v142, v142
    v_mfma_f32_16x16x32_bf16 v[136:139], a[152:155], v[60:63], v[136:139]
    ds_read_b128 a[168:171], v3 offset:8192
    v_cvt_pk_bf16_f32 v198, v140, v141
    v_mfma_f32_16x16x32_bf16 v[136:139], a[148:151], v[56:59], v[136:139]
    v_exp_f32 v143, v143
    v_mfma_f32_16x16x32_bf16 v[136:139], a[144:147], v[52:55], v[136:139]
    ds_read_b64_tr_b16 a[204:205], v10 offset:40960
    v_accvgpr_write_b32 a246, v24
    v_mfma_f32_16x16x32_bf16 a[48:51], a[216:219], v[212:215], a[48:51]
    v_exp_f32 v144, v144
    v_mfma_f32_16x16x32_bf16 a[48:51], a[220:223], v[216:219], a[48:51]
    ds_read_b64_tr_b16 a[206:207], v10 offset:45056
    v_cvt_pk_bf16_f32 v199, v142, v143
    v_mfma_f32_16x16x32_bf16 a[52:55], a[220:223], v[224:227], a[52:55]
    v_exp_f32 v145, v145
    v_mfma_f32_16x16x32_bf16 a[52:55], a[216:219], v[220:223], a[52:55]
    ds_read_b128 a[172:175], v4 offset:8192
    v_accvgpr_write_b32 a247, v24
    v_mfma_f32_16x16x32_bf16 a[56:59], a[216:219], v[228:231], a[56:59]
    v_exp_f32 v146, v146
    v_mfma_f32_16x16x32_bf16 a[56:59], a[220:223], v[232:235], a[56:59]
    v_cvt_pk_bf16_f32 v206, v144, v145
    v_accvgpr_write_b32 a248, v24
    v_mfma_f32_16x16x32_bf16 a[60:63], a[220:223], v[240:243], a[60:63]
    v_exp_f32 v147, v147
    v_mfma_f32_16x16x32_bf16 a[60:63], a[216:219], v[236:239], a[60:63]
    buffer_load_dwordx4 v18, s[12:15], s29 offen offset:1024 lds
    v_smfmac_f32_16x16x64_bf16 a[228:231], v[244:247], v[220:227], v248
    s_waitcnt lgkmcnt(6)
    v_accvgpr_write_b32 a249, v24
    v_accvgpr_write_b32 a250, v24
    v_mfma_f32_16x16x32_bf16 v[140:143], a[144:147], v[68:71], v[108:111]
    v_exp_f32 v148, v148
    v_mfma_f32_16x16x32_bf16 v[140:143], a[148:151], v[72:75], v[140:143]
    ds_read_b64_tr_b16 a[208:209], v11 offset:16384
    v_cvt_pk_bf16_f32 v207, v146, v147
    v_mfma_f32_16x16x32_bf16 v[140:143], a[152:155], v[76:79], v[140:143]
    v_exp_f32 v149, v149
    v_mfma_f32_16x16x32_bf16 v[140:143], a[156:159], v[80:83], v[140:143]
    ds_read_b64_tr_b16 a[210:211], v11 offset:20480
    v_accvgpr_write_b32 a251, v24
    v_mfma_f32_16x16x32_bf16 v[144:147], a[156:159], v[96:99], v[112:115]
    v_exp_f32 v150, v150
    v_mfma_f32_16x16x32_bf16 v[144:147], a[152:155], v[92:95], v[144:147]
    ds_read_b128 a[176:179], v1 offset:12288
    v_cvt_pk_bf16_f32 v184, v148, v149
    v_mfma_f32_16x16x32_bf16 v[144:147], a[148:151], v[88:91], v[144:147]
    v_exp_f32 v151, v151
    v_mfma_f32_16x16x32_bf16 v[144:147], a[144:147], v[84:87], v[144:147]
    ds_read_b64_tr_b16 a[212:213], v11 offset:40960
    v_accvgpr_write_b32 a252, v24
    v_mfma_f32_16x16x32_bf16 a[64:67], a[192:195], v[212:215], a[64:67]
    v_exp_f32 v152, v152
    v_mfma_f32_16x16x32_bf16 a[64:67], a[196:199], v[216:219], a[64:67]
    ds_read_b64_tr_b16 a[214:215], v11 offset:45056
    v_cvt_pk_bf16_f32 v185, v150, v151
    v_mfma_f32_16x16x32_bf16 a[68:71], a[196:199], v[224:227], a[68:71]
    v_exp_f32 v153, v153
    v_mfma_f32_16x16x32_bf16 a[68:71], a[192:195], v[220:223], a[68:71]
    ds_read_b128 a[180:183], v2 offset:12288
    v_cvt_pk_bf16_f32 v192, v152, v153
    v_mfma_f32_16x16x32_bf16 a[72:75], a[192:195], v[228:231], a[72:75]
    v_exp_f32 v154, v154
    v_mfma_f32_16x16x32_bf16 a[72:75], a[196:199], v[232:235], a[72:75]
    buffer_load_dwordx4 v17, s[12:15], s29 offen offset:2048 lds
    s_mov_b32 s43, m0
    s_add_u32 m0, s40, 86016
    s_nop 0
    buffer_load_dwordx4 v25, s[96:99], s41 offen offset:0 lds
    s_mov_b32 m0, s43
    v_accvgpr_write_b32 a253, v24
    v_mfma_f32_16x16x32_bf16 a[76:79], a[196:199], v[240:243], a[76:79]
    v_exp_f32 v155, v155
    v_mfma_f32_16x16x32_bf16 a[76:79], a[192:195], v[236:239], a[76:79]
    s_waitcnt lgkmcnt(6)
    v_accvgpr_write_b32 a254, v24
    v_accvgpr_write_b32 a255, v24
    v_mfma_f32_16x16x32_bf16 v[148:151], a[160:163], v[36:39], v[100:103]
    v_exp_f32 v156, v156
    v_mfma_f32_16x16x32_bf16 v[148:151], a[164:167], v[40:43], v[148:151]
    ds_read_b64_tr_b16 a[216:217], v12 offset:16384
    v_cvt_pk_bf16_f32 v193, v154, v155
    v_mfma_f32_16x16x32_bf16 v[148:151], a[168:171], v[44:47], v[148:151]
    v_exp_f32 v157, v157
    v_mfma_f32_16x16x32_bf16 v[148:151], a[172:175], v[48:51], v[148:151]
    ds_read_b64_tr_b16 a[218:219], v12 offset:20480
    v_mov_b32 v252, v24
    v_mfma_f32_16x16x32_bf16 v[152:155], a[172:175], v[64:67], v[104:107]
    v_exp_f32 v158, v158
    v_mfma_f32_16x16x32_bf16 v[152:155], a[168:171], v[60:63], v[152:155]
    ds_read_b128 a[184:187], v3 offset:12288
    v_cvt_pk_bf16_f32 v200, v156, v157
    v_mfma_f32_16x16x32_bf16 v[152:155], a[164:167], v[56:59], v[152:155]
    v_exp_f32 v159, v159
    v_mfma_f32_16x16x32_bf16 v[152:155], a[160:163], v[52:55], v[152:155]
    ds_read_b64_tr_b16 a[220:221], v12 offset:40960
    s_mov_b32 s43, m0
    s_add_u32 m0, s40, 86016
    s_nop 0
    buffer_load_dwordx4 v25, s[96:99], s41 offen offset:1024 lds
    s_mov_b32 m0, s43
    v_mov_b32 v253, v24
    v_mfma_f32_16x16x32_bf16 a[80:83], a[200:203], v[212:215], a[80:83]
    v_exp_f32 v160, v160
    v_mfma_f32_16x16x32_bf16 a[80:83], a[204:207], v[216:219], a[80:83]
    ds_read_b64_tr_b16 a[222:223], v12 offset:45056
    v_cvt_pk_bf16_f32 v201, v158, v159
    v_mfma_f32_16x16x32_bf16 a[84:87], a[204:207], v[224:227], a[84:87]
    v_exp_f32 v161, v161
    v_mfma_f32_16x16x32_bf16 a[84:87], a[200:203], v[220:223], a[84:87]
    ds_read_b128 a[188:191], v4 offset:12288
    v_mov_b32 v254, v24
    v_mfma_f32_16x16x32_bf16 a[88:91], a[200:203], v[228:231], a[88:91]
    v_exp_f32 v162, v162
    v_mfma_f32_16x16x32_bf16 a[88:91], a[204:207], v[232:235], a[88:91]
    v_cvt_pk_bf16_f32 v208, v160, v161
    v_mov_b32 v255, v24
    v_mfma_f32_16x16x32_bf16 a[92:95], a[204:207], v[240:243], a[92:95]
    v_exp_f32 v163, v163
    v_mfma_f32_16x16x32_bf16 a[92:95], a[200:203], v[236:239], a[92:95]
    buffer_load_dwordx4 v18, s[12:15], s29 offen offset:3072 lds
    v_smfmac_f32_16x16x64_bf16 a[232:235], v[244:247], v[228:235], v248
    s_waitcnt vmcnt(12) lgkmcnt(6)
    s_barrier
    s_add_u32 s29, s29, 16384
    s_mov_b32 s43, m0
    s_add_u32 m0, s40, 86016
    s_nop 0
    buffer_load_dwordx4 v25, s[96:99], s41 offen offset:2048 lds
    s_mov_b32 m0, s43
    v_mfma_f32_16x16x32_bf16 v[156:159], a[160:163], v[68:71], v[108:111]
    s_waitcnt vmcnt(7)
    v_exp_f32 v164, v164
    v_mfma_f32_16x16x32_bf16 v[156:159], a[164:167], v[72:75], v[156:159]
    ds_read_b64_tr_b16 a[192:193], v5 offset:57344
    v_cvt_pk_bf16_f32 v209, v162, v163
    v_mfma_f32_16x16x32_bf16 v[156:159], a[168:171], v[76:79], v[156:159]
    v_exp_f32 v165, v165
    v_mfma_f32_16x16x32_bf16 v[156:159], a[172:175], v[80:83], v[156:159]
    ds_read_b64_tr_b16 a[194:195], v5 offset:61440
    v_cmp_eq_u32 vcc, 0, v249
    s_and_b64 vcc, vcc, exec
    s_cbranch_scc1 L_spin_sel
L_back_sel:
    v_mfma_f32_16x16x32_bf16 v[160:163], a[172:175], v[96:99], v[112:115]
    v_exp_f32 v166, v166
    v_mfma_f32_16x16x32_bf16 v[160:163], a[168:171], v[92:95], v[160:163]
    ds_read_b128 a[128:131], v1 offset:49152
    v_cvt_pk_bf16_f32 v186, v164, v165
    v_mfma_f32_16x16x32_bf16 v[160:163], a[164:167], v[88:91], v[160:163]
    v_exp_f32 v167, v167
    v_mfma_f32_16x16x32_bf16 v[160:163], a[160:163], v[84:87], v[160:163]
    ds_read_b64_tr_b16 a[196:197], v5 offset:0
    v_min3_u32 v28, v28, v29, v30
    v_mfma_f32_16x16x32_bf16 a[96:99], a[208:211], v[212:215], a[96:99]
    v_exp_f32 v168, v168
    v_mfma_f32_16x16x32_bf16 a[96:99], a[212:215], v[216:219], a[96:99]
    ds_read_b64_tr_b16 a[198:199], v5 offset:4096
    v_cvt_pk_bf16_f32 v187, v166, v167
    v_mfma_f32_16x16x32_bf16 a[100:103], a[212:215], v[224:227], a[100:103]
    v_exp_f32 v169, v169
    v_mfma_f32_16x16x32_bf16 a[100:103], a[208:211], v[220:223], a[100:103]
    ds_read_b128 a[132:135], v2 offset:49152
    v_cvt_pk_bf16_f32 v194, v168, v169
    v_mfma_f32_16x16x32_bf16 a[104:107], a[208:211], v[228:231], a[104:107]
    s_add_u32 m0, s34, 32768
    v_exp_f32 v170, v170
    v_mfma_f32_16x16x32_bf16 a[104:107], a[212:215], v[232:235], a[104:107]
    buffer_load_dwordx4 v13, s[8:11], s28 offen offset:0 lds
    v_mfma_f32_16x16x32_bf16 a[108:111], a[212:215], v[240:243], a[108:111]
    v_exp_f32 v171, v171
    v_mfma_f32_16x16x32_bf16 a[108:111], a[208:211], v[236:239], a[108:111]
    s_waitcnt lgkmcnt(6)
    v_min_u32 v28, v28, v31
    v_cmp_gt_u32 vcc, 1, v28
    s_and_b64 vcc, vcc, exec
    s_cbranch_scc1 L_spin_pack
L_back_pack:
    v_mfma_f32_16x16x32_bf16 v[164:167], a[176:179], v[36:39], v[100:103]
    v_exp_f32 v172, v172
    v_mfma_f32_16x16x32_bf16 v[164:167], a[180:183], v[40:43], v[164:167]
    ds_read_b64_tr_b16 a[200:201], v6 offset:57344
    v_cvt_pk_bf16_f32 v195, v170, v171
    v_mfma_f32_16x16x32_bf16 v[164:167], a[184:187], v[44:47], v[164:167]
    v_exp_f32 v173, v173
    v_mfma_f32_16x16x32_bf16 v[164:167], a[188:191], v[48:51], v[164:167]
    ds_read_b64_tr_b16 a[202:203], v6 offset:61440
    v_mfma_f32_16x16x32_bf16 v[168:171], a[188:191], v[64:67], v[104:107]
    v_exp_f32 v174, v174
    v_mfma_f32_16x16x32_bf16 v[168:171], a[184:187], v[60:63], v[168:171]
    ds_read_b128 a[136:139], v3 offset:49152
    v_cvt_pk_bf16_f32 v202, v172, v173
    v_mfma_f32_16x16x32_bf16 v[168:171], a[180:183], v[56:59], v[168:171]
    v_exp_f32 v175, v175
    v_mfma_f32_16x16x32_bf16 v[168:171], a[176:179], v[52:55], v[168:171]
    ds_read_b64_tr_b16 a[204:205], v6 offset:0
    v_mfma_f32_16x16x32_bf16 a[112:115], a[216:219], v[212:215], a[112:115]
    v_exp_f32 v176, v176
    v_mfma_f32_16x16x32_bf16 a[112:115], a[220:223], v[216:219], a[112:115]
    ds_read_b64_tr_b16 a[206:207], v6 offset:4096
    v_cvt_pk_bf16_f32 v203, v174, v175
    v_mfma_f32_16x16x32_bf16 a[116:119], a[220:223], v[224:227], a[116:119]
    v_exp_f32 v177, v177
    v_mfma_f32_16x16x32_bf16 a[116:119], a[216:219], v[220:223], a[116:119]
    ds_read_b128 a[140:143], v4 offset:49152
    v_mfma_f32_16x16x32_bf16 a[120:123], a[216:219], v[228:231], a[120:123]
    v_exp_f32 v178, v178
    v_mfma_f32_16x16x32_bf16 a[120:123], a[220:223], v[232:235], a[120:123]
    v_cvt_pk_bf16_f32 v210, v176, v177
    v_mfma_f32_16x16x32_bf16 a[124:127], a[220:223], v[240:243], a[124:127]
    v_exp_f32 v179, v179
    v_mfma_f32_16x16x32_bf16 a[124:127], a[216:219], v[236:239], a[124:127]
    buffer_load_dwordx4 v14, s[8:11], s28 offen offset:1024 lds
    v_smfmac_f32_16x16x64_bf16 a[236:239], v[244:247], v[236:243], v248
    s_waitcnt lgkmcnt(6)
    v_mfma_f32_16x16x32_bf16 v[172:175], a[176:179], v[68:71], v[108:111]
    v_exp_f32 v116, v116
    v_mfma_f32_16x16x32_bf16 v[172:175], a[180:183], v[72:75], v[172:175]
    ds_read_b64_tr_b16 a[208:209], v7 offset:57344
    v_cvt_pk_bf16_f32 v211, v178, v179
    v_mfma_f32_16x16x32_bf16 v[172:175], a[184:187], v[76:79], v[172:175]
    v_exp_f32 v117, v117
    v_mfma_f32_16x16x32_bf16 v[172:175], a[188:191], v[80:83], v[172:175]
    ds_read_b64_tr_b16 a[210:211], v7 offset:61440
    v_mov_b32 v22, v249
    v_mfma_f32_16x16x32_bf16 v[176:179], a[188:191], v[96:99], v[112:115]
    v_exp_f32 v118, v118
    v_mfma_f32_16x16x32_bf16 v[176:179], a[184:187], v[92:95], v[176:179]
    ds_read_b128 a[144:147], v1 offset:53248
    v_cvt_pk_bf16_f32 v212, v116, v117
    v_mfma_f32_16x16x32_bf16 v[176:179], a[180:183], v[88:91], v[176:179]
    v_exp_f32 v119, v119
    v_mfma_f32_16x16x32_bf16 v[176:179], a[176:179], v[84:87], v[176:179]
    ds_read_b64_tr_b16 a[212:213], v7 offset:0
    v_not_b32 v22, v22
    v_mfma_f32_16x16x32_bf16 a[0:3], a[192:195], v[180:183], a[0:3]
    v_exp_f32 v120, v120
    v_mfma_f32_16x16x32_bf16 a[0:3], a[196:199], v[184:187], a[0:3]
    ds_read_b64_tr_b16 a[214:215], v7 offset:4096
    v_cvt_pk_bf16_f32 v213, v118, v119
    v_mfma_f32_16x16x32_bf16 a[4:7], a[196:199], v[192:195], a[4:7]
    v_exp_f32 v121, v121
    v_mfma_f32_16x16x32_bf16 a[4:7], a[192:195], v[188:191], a[4:7]
    ds_read_b128 a[148:151], v2 offset:53248
    v_cvt_pk_bf16_f32 v220, v120, v121
    v_mfma_f32_16x16x32_bf16 a[8:11], a[192:195], v[196:199], a[8:11]
    v_exp_f32 v122, v122
    v_and_b32 v22, 0x7ff, v22
    v_mfma_f32_16x16x32_bf16 a[8:11], a[196:199], v[200:203], a[8:11]
    buffer_load_dwordx4 v15, s[8:11], s28 offen offset:2048 lds
    v_mfma_f32_16x16x32_bf16 a[12:15], a[196:199], v[208:211], a[12:15]
    v_exp_f32 v123, v123
    v_mfma_f32_16x16x32_bf16 a[12:15], a[192:195], v[204:207], a[12:15]
    s_waitcnt lgkmcnt(6)
    v_lshrrev_b32 v24, 4, v19
    v_lshlrev_b32 v23, 4, v22
    v_mfma_f32_16x16x32_bf16 v[116:119], a[128:131], v[36:39], v[100:103]
    v_exp_f32 v124, v124
    v_mfma_f32_16x16x32_bf16 v[116:119], a[132:135], v[40:43], v[116:119]
    ds_read_b64_tr_b16 a[216:217], v8 offset:57344
    v_cvt_pk_bf16_f32 v221, v122, v123
    v_mfma_f32_16x16x32_bf16 v[116:119], a[136:139], v[44:47], v[116:119]
    v_exp_f32 v125, v125
    v_mfma_f32_16x16x32_bf16 v[116:119], a[140:143], v[48:51], v[116:119]
    ds_read_b64_tr_b16 a[218:219], v8 offset:61440
    v_mul_u32_u24 v22, 1280, v22
    v_mfma_f32_16x16x32_bf16 v[120:123], a[140:143], v[64:67], v[104:107]
    v_exp_f32 v126, v126
    v_mfma_f32_16x16x32_bf16 v[120:123], a[136:139], v[60:63], v[120:123]
    ds_read_b128 a[152:155], v3 offset:53248
    v_cvt_pk_bf16_f32 v228, v124, v125
    v_mfma_f32_16x16x32_bf16 v[120:123], a[132:135], v[56:59], v[120:123]
    v_exp_f32 v127, v127
    v_mfma_f32_16x16x32_bf16 v[120:123], a[128:131], v[52:55], v[120:123]
    ds_read_b64_tr_b16 a[220:221], v8 offset:0
    v_lshl_add_u32 v22, v24, 4, v22
    v_mfma_f32_16x16x32_bf16 a[16:19], a[200:203], v[180:183], a[16:19]
    s_mul_i32 s40, s5, 320
    v_exp_f32 v128, v128
    v_mfma_f32_16x16x32_bf16 a[16:19], a[204:207], v[184:187], a[16:19]
    s_mov_b32 s41, 0x280000
    ds_read_b64_tr_b16 a[222:223], v8 offset:4096
    v_cvt_pk_bf16_f32 v229, v126, v127
    v_mfma_f32_16x16x32_bf16 a[20:23], a[204:207], v[192:195], a[20:23]
    v_exp_f32 v129, v129
    v_mfma_f32_16x16x32_bf16 a[20:23], a[200:203], v[188:191], a[20:23]
    ds_read_b128 a[156:159], v4 offset:53248
    v_mfma_f32_16x16x32_bf16 a[24:27], a[200:203], v[196:199], a[24:27]
    v_exp_f32 v130, v130
    v_mfma_f32_16x16x32_bf16 a[24:27], a[204:207], v[200:203], a[24:27]
    v_cvt_pk_bf16_f32 v236, v128, v129
    v_mfma_f32_16x16x32_bf16 a[28:31], a[204:207], v[208:211], a[28:31]
    v_exp_f32 v131, v131
    v_mfma_f32_16x16x32_bf16 a[28:31], a[200:203], v[204:207], a[28:31]
    buffer_load_dwordx4 v16, s[8:11], s28 offen offset:3072 lds
    v_smfmac_f32_16x16x64_bf16 a[224:227], v[244:247], v[180:187], v248
    s_waitcnt lgkmcnt(6)
    buffer_load_dwordx2 v[20:21], v23, s[76:79], s41 offen sc1
    v_mfma_f32_16x16x32_bf16 v[124:127], a[128:131], v[68:71], v[108:111]
    v_exp_f32 v132, v132
    v_mfma_f32_16x16x32_bf16 v[124:127], a[132:135], v[72:75], v[124:127]
    ds_read_b64_tr_b16 a[192:193], v9 offset:57344
    v_cvt_pk_bf16_f32 v237, v130, v131
    v_mfma_f32_16x16x32_bf16 v[124:127], a[136:139], v[76:79], v[124:127]
    v_exp_f32 v133, v133
    v_mfma_f32_16x16x32_bf16 v[124:127], a[140:143], v[80:83], v[124:127]
    ds_read_b64_tr_b16 a[194:195], v9 offset:61440
    v_mfma_f32_16x16x32_bf16 v[128:131], a[140:143], v[96:99], v[112:115]
    v_exp_f32 v134, v134
    v_mfma_f32_16x16x32_bf16 v[128:131], a[136:139], v[92:95], v[128:131]
    ds_read_b128 a[160:163], v1 offset:57344
    v_cvt_pk_bf16_f32 v214, v132, v133
    v_mfma_f32_16x16x32_bf16 v[128:131], a[132:135], v[88:91], v[128:131]
    v_exp_f32 v135, v135
    v_mfma_f32_16x16x32_bf16 v[128:131], a[128:131], v[84:87], v[128:131]
    ds_read_b64_tr_b16 a[196:197], v9 offset:0
    v_mfma_f32_16x16x32_bf16 a[32:35], a[208:211], v[180:183], a[32:35]
    v_exp_f32 v136, v136
    v_mfma_f32_16x16x32_bf16 a[32:35], a[212:215], v[184:187], a[32:35]
    ds_read_b64_tr_b16 a[198:199], v9 offset:4096
    v_cvt_pk_bf16_f32 v215, v134, v135
    v_mfma_f32_16x16x32_bf16 a[36:39], a[212:215], v[192:195], a[36:39]
    v_exp_f32 v137, v137
    v_mfma_f32_16x16x32_bf16 a[36:39], a[208:211], v[188:191], a[36:39]
    ds_read_b128 a[164:167], v2 offset:57344
    v_cvt_pk_bf16_f32 v222, v136, v137
    v_mfma_f32_16x16x32_bf16 a[40:43], a[208:211], v[196:199], a[40:43]
    s_add_u32 s28, s28, 16384
    s_mov_b32 m0, s30
    v_exp_f32 v138, v138
    v_mfma_f32_16x16x32_bf16 a[40:43], a[212:215], v[200:203], a[40:43]
    buffer_load_dwordx4 v17, s[12:15], s29 offen offset:0 lds
    v_mfma_f32_16x16x32_bf16 a[44:47], a[212:215], v[208:211], a[44:47]
    s_mov_b32 exec_lo, 0x00ff00ff
    s_mov_b32 exec_hi, 0x00ff00ff
    buffer_load_dwordx4 a[240:243], v22, s[88:91], s40 offen offset:0
    s_mov_b64 exec, -1
    v_exp_f32 v139, v139
    v_mfma_f32_16x16x32_bf16 a[44:47], a[208:211], v[204:207], a[44:47]
    s_waitcnt lgkmcnt(6)
    s_mov_b32 exec_lo, 0x00ff00ff
    s_mov_b32 exec_hi, 0x00ff00ff
    buffer_load_dwordx4 a[244:247], v22, s[88:91], s40 offen offset:64
    s_mov_b64 exec, -1
    v_mfma_f32_16x16x32_bf16 v[132:135], a[144:147], v[36:39], v[100:103]
    v_exp_f32 v140, v140
    v_mfma_f32_16x16x32_bf16 v[132:135], a[148:151], v[40:43], v[132:135]
    ds_read_b64_tr_b16 a[200:201], v10 offset:57344
    v_cvt_pk_bf16_f32 v223, v138, v139
    v_mfma_f32_16x16x32_bf16 v[132:135], a[152:155], v[44:47], v[132:135]
    v_exp_f32 v141, v141
    v_mfma_f32_16x16x32_bf16 v[132:135], a[156:159], v[48:51], v[132:135]
    ds_read_b64_tr_b16 a[202:203], v10 offset:61440
    v_mfma_f32_16x16x32_bf16 v[136:139], a[156:159], v[64:67], v[104:107]
    v_exp_f32 v142, v142
    v_mfma_f32_16x16x32_bf16 v[136:139], a[152:155], v[60:63], v[136:139]
    ds_read_b128 a[168:171], v3 offset:57344
    v_cvt_pk_bf16_f32 v230, v140, v141
    v_mfma_f32_16x16x32_bf16 v[136:139], a[148:151], v[56:59], v[136:139]
    v_exp_f32 v143, v143
    v_mfma_f32_16x16x32_bf16 v[136:139], a[144:147], v[52:55], v[136:139]
    ds_read_b64_tr_b16 a[204:205], v10 offset:0
    s_mov_b32 exec_lo, 0x00ff00ff
    s_mov_b32 exec_hi, 0x00ff00ff
    buffer_load_dwordx4 a[248:251], v22, s[88:91], s40 offen offset:128
    s_mov_b64 exec, -1
    v_mfma_f32_16x16x32_bf16 a[48:51], a[216:219], v[180:183], a[48:51]
    v_exp_f32 v144, v144
    v_mfma_f32_16x16x32_bf16 a[48:51], a[220:223], v[184:187], a[48:51]
    ds_read_b64_tr_b16 a[206:207], v10 offset:4096
    v_cvt_pk_bf16_f32 v231, v142, v143
    v_mfma_f32_16x16x32_bf16 a[52:55], a[220:223], v[192:195], a[52:55]
    v_exp_f32 v145, v145
    v_mfma_f32_16x16x32_bf16 a[52:55], a[216:219], v[188:191], a[52:55]
    ds_read_b128 a[172:175], v4 offset:57344
    v_mfma_f32_16x16x32_bf16 a[56:59], a[216:219], v[196:199], a[56:59]
    s_mov_b32 exec_lo, 0x00ff00ff
    s_mov_b32 exec_hi, 0x00ff00ff
    buffer_load_dwordx4 a[252:255], v22, s[88:91], s40 offen offset:192
    s_mov_b64 exec, -1
    v_exp_f32 v146, v146
    v_mfma_f32_16x16x32_bf16 a[56:59], a[220:223], v[200:203], a[56:59]
    v_cvt_pk_bf16_f32 v238, v144, v145
    v_mfma_f32_16x16x32_bf16 a[60:63], a[220:223], v[208:211], a[60:63]
    v_exp_f32 v147, v147
    v_mfma_f32_16x16x32_bf16 a[60:63], a[216:219], v[204:207], a[60:63]
    buffer_load_dwordx4 v18, s[12:15], s29 offen offset:1024 lds
    v_smfmac_f32_16x16x64_bf16 a[228:231], v[244:247], v[188:195], v248
    s_waitcnt lgkmcnt(6)
    s_mov_b32 exec_lo, 0x00ff00ff
    s_mov_b32 exec_hi, 0x00ff00ff
    buffer_load_dwordx4 v[252:255], v22, s[88:91], s40 offen offset:256
    s_mov_b64 exec, -1
    v_mfma_f32_16x16x32_bf16 v[140:143], a[144:147], v[68:71], v[108:111]
    v_exp_f32 v148, v148
    v_mfma_f32_16x16x32_bf16 v[140:143], a[148:151], v[72:75], v[140:143]
    ds_read_b64_tr_b16 a[208:209], v11 offset:57344
    v_cvt_pk_bf16_f32 v239, v146, v147
    v_mfma_f32_16x16x32_bf16 v[140:143], a[152:155], v[76:79], v[140:143]
    v_exp_f32 v149, v149
    v_lshrrev_b32 v22, 4, v19
    v_mfma_f32_16x16x32_bf16 v[140:143], a[156:159], v[80:83], v[140:143]
    ds_read_b64_tr_b16 a[210:211], v11 offset:61440
    v_bfe_u32 v24, v19, 2, 2
    v_mfma_f32_16x16x32_bf16 v[144:147], a[156:159], v[96:99], v[112:115]
    v_exp_f32 v150, v150
    v_mfma_f32_16x16x32_bf16 v[144:147], a[152:155], v[92:95], v[144:147]
    ds_read_b128 a[176:179], v1 offset:61440
    v_cvt_pk_bf16_f32 v216, v148, v149
    v_mfma_f32_16x16x32_bf16 v[144:147], a[148:151], v[88:91], v[144:147]
    v_exp_f32 v151, v151
    v_lshl_add_u32 v22, v22, 3, v24
    v_mfma_f32_16x16x32_bf16 v[144:147], a[144:147], v[84:87], v[144:147]
    ds_read_b64_tr_b16 a[212:213], v11 offset:0
    v_and_b32 v24, 1, v19
    v_mfma_f32_16x16x32_bf16 a[64:67], a[192:195], v[180:183], a[64:67]
    v_exp_f32 v152, v152
    v_mfma_f32_16x16x32_bf16 a[64:67], a[196:199], v[184:187], a[64:67]
    ds_read_b64_tr_b16 a[214:215], v11 offset:4096
    v_cvt_pk_bf16_f32 v217, v150, v151
    v_mfma_f32_16x16x32_bf16 a[68:71], a[196:199], v[192:195], a[68:71]
    v_exp_f32 v153, v153
    v_mfma_f32_16x16x32_bf16 a[68:71], a[192:195], v[188:191], a[68:71]
    ds_read_b128 a[180:183], v2 offset:61440
    v_cvt_pk_bf16_f32 v224, v152, v153
    v_lshl_add_u32 v22, v22, 1, v24
    v_mfma_f32_16x16x32_bf16 a[72:75], a[192:195], v[196:199], a[72:75]
    v_exp_f32 v154, v154
    v_mfma_f32_16x16x32_bf16 a[72:75], a[196:199], v[200:203], a[72:75]
    buffer_load_dwordx4 v17, s[12:15], s29 offen offset:2048 lds
    v_bfe_u32 v24, v19, 1, 1
    v_mfma_f32_16x16x32_bf16 a[76:79], a[196:199], v[208:211], a[76:79]
    v_exp_f32 v155, v155
    v_mfma_f32_16x16x32_bf16 a[76:79], a[192:195], v[204:207], a[76:79]
    s_waitcnt lgkmcnt(6)
    v_mul_u32_u24 v24, 10240, v24
    v_lshl_add_u32 v22, v22, 3, v24
    v_mfma_f32_16x16x32_bf16 v[148:151], a[160:163], v[36:39], v[100:103]
    s_mul_i32 s42, s5, 2560
    v_exp_f32 v156, v156
    v_mfma_f32_16x16x32_bf16 v[148:151], a[164:167], v[40:43], v[148:151]
    s_add_u32 s42, s42, 65536
    ds_read_b64_tr_b16 a[216:217], v12 offset:57344
    v_cvt_pk_bf16_f32 v225, v154, v155
    v_mfma_f32_16x16x32_bf16 v[148:151], a[168:171], v[44:47], v[148:151]
    v_exp_f32 v157, v157
    v_mfma_f32_16x16x32_bf16 v[148:151], a[172:175], v[48:51], v[148:151]
    ds_read_b64_tr_b16 a[218:219], v12 offset:61440
    v_add_u32 v22, s42, v22
    v_mfma_f32_16x16x32_bf16 v[152:155], a[172:175], v[64:67], v[104:107]
    s_mov_b32 s42, 65536
    v_exp_f32 v158, v158
    v_mfma_f32_16x16x32_bf16 v[152:155], a[168:171], v[60:63], v[152:155]
    ds_read_b128 a[184:187], v3 offset:61440
    v_cvt_pk_bf16_f32 v232, v156, v157
    v_mfma_f32_16x16x32_bf16 v[152:155], a[164:167], v[56:59], v[152:155]
    v_exp_f32 v159, v159
    v_mfma_f32_16x16x32_bf16 v[152:155], a[160:163], v[52:55], v[152:155]
    ds_read_b64_tr_b16 a[220:221], v12 offset:0
    v_lshl_add_u32 v23, v19, 4, s42
    v_mfma_f32_16x16x32_bf16 a[80:83], a[200:203], v[180:183], a[80:83]
    v_exp_f32 v160, v160
    v_mfma_f32_16x16x32_bf16 a[80:83], a[204:207], v[184:187], a[80:83]
    ds_read_b64_tr_b16 a[222:223], v12 offset:4096
    v_cvt_pk_bf16_f32 v233, v158, v159
    v_mfma_f32_16x16x32_bf16 a[84:87], a[204:207], v[192:195], a[84:87]
    v_exp_f32 v161, v161
    v_mfma_f32_16x16x32_bf16 a[84:87], a[200:203], v[188:191], a[84:87]
    ds_read_b128 a[188:191], v4 offset:61440
    v_readlane_b32 s50, v249, 0
    v_mfma_f32_16x16x32_bf16 a[88:91], a[200:203], v[196:199], a[88:91]
    v_exp_f32 v162, v162
    v_mfma_f32_16x16x32_bf16 a[88:91], a[204:207], v[200:203], a[88:91]
    v_cvt_pk_bf16_f32 v240, v160, v161
    v_readlane_b32 s51, v249, 1
    v_mfma_f32_16x16x32_bf16 a[92:95], a[204:207], v[208:211], a[92:95]
    v_exp_f32 v163, v163
    v_mfma_f32_16x16x32_bf16 a[92:95], a[200:203], v[204:207], a[92:95]
    buffer_load_dwordx4 v18, s[12:15], s29 offen offset:3072 lds
    v_smfmac_f32_16x16x64_bf16 a[232:235], v[244:247], v[196:203], v248
    s_waitcnt vmcnt(15) lgkmcnt(6)
    s_barrier
    s_add_u32 s29, s29, 16384
    v_readlane_b32 s52, v249, 2
    v_mfma_f32_16x16x32_bf16 v[156:159], a[160:163], v[68:71], v[108:111]
    v_exp_f32 v164, v164
    v_mfma_f32_16x16x32_bf16 v[156:159], a[164:167], v[72:75], v[156:159]
    ds_read_b64_tr_b16 a[192:193], v5 offset:24576
    v_cvt_pk_bf16_f32 v241, v162, v163
    v_mfma_f32_16x16x32_bf16 v[156:159], a[168:171], v[76:79], v[156:159]
    v_exp_f32 v165, v165
    v_mfma_f32_16x16x32_bf16 v[156:159], a[172:175], v[80:83], v[156:159]
    ds_read_b64_tr_b16 a[194:195], v5 offset:28672
    v_readlane_b32 s53, v249, 3
    v_mfma_f32_16x16x32_bf16 v[160:163], a[172:175], v[96:99], v[112:115]
    v_exp_f32 v166, v166
    v_mfma_f32_16x16x32_bf16 v[160:163], a[168:171], v[92:95], v[160:163]
    ds_read_b128 a[128:131], v1 offset:16384
    v_cvt_pk_bf16_f32 v218, v164, v165
    v_mfma_f32_16x16x32_bf16 v[160:163], a[164:167], v[88:91], v[160:163]
    v_exp_f32 v167, v167
    v_mfma_f32_16x16x32_bf16 v[160:163], a[160:163], v[84:87], v[160:163]
    ds_read_b64_tr_b16 a[196:197], v5 offset:49152
    v_readlane_b32 s54, v249, 4
    v_mfma_f32_16x16x32_bf16 a[96:99], a[208:211], v[180:183], a[96:99]
    v_exp_f32 v168, v168
    v_mfma_f32_16x16x32_bf16 a[96:99], a[212:215], v[184:187], a[96:99]
    ds_read_b64_tr_b16 a[198:199], v5 offset:53248
    v_cvt_pk_bf16_f32 v219, v166, v167
    v_mfma_f32_16x16x32_bf16 a[100:103], a[212:215], v[192:195], a[100:103]
    v_exp_f32 v169, v169
    v_mfma_f32_16x16x32_bf16 a[100:103], a[208:211], v[188:191], a[100:103]
    ds_read_b128 a[132:135], v2 offset:16384
    v_cvt_pk_bf16_f32 v226, v168, v169
    v_readlane_b32 s55, v249, 5
    v_mfma_f32_16x16x32_bf16 a[104:107], a[208:211], v[196:199], a[104:107]
    s_add_u32 m0, s34, 0
    v_exp_f32 v170, v170
    v_mfma_f32_16x16x32_bf16 a[104:107], a[212:215], v[200:203], a[104:107]
    buffer_load_dwordx4 v13, s[8:11], s28 offen offset:0 lds
    v_readlane_b32 s56, v249, 6
    v_mfma_f32_16x16x32_bf16 a[108:111], a[212:215], v[208:211], a[108:111]
    v_exp_f32 v171, v171
    v_mfma_f32_16x16x32_bf16 a[108:111], a[208:211], v[204:207], a[108:111]
    s_waitcnt lgkmcnt(6)
    v_readlane_b32 s57, v249, 7
    v_mfma_f32_16x16x32_bf16 v[164:167], a[176:179], v[36:39], v[100:103]
    v_exp_f32 v172, v172
    v_mfma_f32_16x16x32_bf16 v[164:167], a[180:183], v[40:43], v[164:167]
    ds_read_b64_tr_b16 a[200:201], v6 offset:24576
    v_cvt_pk_bf16_f32 v227, v170, v171
    v_mfma_f32_16x16x32_bf16 v[164:167], a[184:187], v[44:47], v[164:167]
    v_exp_f32 v173, v173
    v_mfma_f32_16x16x32_bf16 v[164:167], a[188:191], v[48:51], v[164:167]
    ds_read_b64_tr_b16 a[202:203], v6 offset:28672
    v_mfma_f32_16x16x32_bf16 v[168:171], a[188:191], v[64:67], v[104:107]
    v_exp_f32 v174, v174
    v_mfma_f32_16x16x32_bf16 v[168:171], a[184:187], v[60:63], v[168:171]
    ds_read_b128 a[136:139], v3 offset:16384
    v_cvt_pk_bf16_f32 v234, v172, v173
    v_mfma_f32_16x16x32_bf16 v[168:171], a[180:183], v[56:59], v[168:171]
    v_exp_f32 v175, v175
    v_mfma_f32_16x16x32_bf16 v[168:171], a[176:179], v[52:55], v[168:171]
    ds_read_b64_tr_b16 a[204:205], v6 offset:49152
    ds_read_b64_tr_b16 v[24:25], v22 offset:0
    v_mfma_f32_16x16x32_bf16 a[112:115], a[216:219], v[180:183], a[112:115]
    v_exp_f32 v176, v176
    v_mfma_f32_16x16x32_bf16 a[112:115], a[220:223], v[184:187], a[112:115]
    ds_read_b64_tr_b16 a[206:207], v6 offset:53248
    v_cvt_pk_bf16_f32 v235, v174, v175
    v_mfma_f32_16x16x32_bf16 a[116:119], a[220:223], v[192:195], a[116:119]
    v_exp_f32 v177, v177
    v_mfma_f32_16x16x32_bf16 a[116:119], a[216:219], v[188:191], a[116:119]
    ds_read_b128 a[140:143], v4 offset:16384
    ds_read_b64_tr_b16 v[26:27], v22 offset:64
    v_mfma_f32_16x16x32_bf16 a[120:123], a[216:219], v[196:199], a[120:123]
    v_exp_f32 v178, v178
    v_mfma_f32_16x16x32_bf16 a[120:123], a[220:223], v[200:203], a[120:123]
    ds_read_b64_tr_b16 v[28:29], v22 offset:512
    v_cvt_pk_bf16_f32 v242, v176, v177
    v_mfma_f32_16x16x32_bf16 a[124:127], a[220:223], v[208:211], a[124:127]
    v_exp_f32 v179, v179
    v_mfma_f32_16x16x32_bf16 a[124:127], a[216:219], v[204:207], a[124:127]
    buffer_load_dwordx4 v14, s[8:11], s28 offen offset:1024 lds
    v_smfmac_f32_16x16x64_bf16 a[236:239], v[244:247], v[204:211], v248
    s_waitcnt lgkmcnt(6)
    ds_read_b64_tr_b16 v[30:31], v22 offset:576
    v_mfma_f32_16x16x32_bf16 v[172:175], a[176:179], v[68:71], v[108:111]
    v_exp_f32 v116, v116
    v_mfma_f32_16x16x32_bf16 v[172:175], a[180:183], v[72:75], v[172:175]
    ds_read_b64_tr_b16 a[208:209], v7 offset:24576
    v_cvt_pk_bf16_f32 v243, v178, v179
    v_mfma_f32_16x16x32_bf16 v[172:175], a[184:187], v[76:79], v[172:175]
    v_exp_f32 v117, v117
    v_mfma_f32_16x16x32_bf16 v[172:175], a[188:191], v[80:83], v[172:175]
    ds_read_b64_tr_b16 a[210:211], v7 offset:28672
    v_mfma_f32_16x16x32_bf16 v[176:179], a[188:191], v[96:99], v[112:115]
    v_exp_f32 v118, v118
    v_mfma_f32_16x16x32_bf16 v[176:179], a[184:187], v[92:95], v[176:179]
    ds_read_b128 a[144:147], v1 offset:20480
    v_cvt_pk_bf16_f32 v180, v116, v117
    v_mfma_f32_16x16x32_bf16 v[176:179], a[180:183], v[88:91], v[176:179]
    v_exp_f32 v119, v119
    v_mfma_f32_16x16x32_bf16 v[176:179], a[176:179], v[84:87], v[176:179]
    ds_read_b64_tr_b16 a[212:213], v7 offset:49152
    v_mfma_f32_16x16x32_bf16 a[0:3], a[192:195], v[212:215], a[0:3]
    v_exp_f32 v120, v120
    v_mfma_f32_16x16x32_bf16 a[0:3], a[196:199], v[216:219], a[0:3]
    ds_read_b64_tr_b16 a[214:215], v7 offset:53248
    v_cvt_pk_bf16_f32 v181, v118, v119
    v_mfma_f32_16x16x32_bf16 a[4:7], a[196:199], v[224:227], a[4:7]
    v_exp_f32 v121, v121
    v_mfma_f32_16x16x32_bf16 a[4:7], a[192:195], v[220:223], a[4:7]
    ds_read_b128 a[148:151], v2 offset:20480
    v_cvt_pk_bf16_f32 v188, v120, v121
    v_mfma_f32_16x16x32_bf16 a[8:11], a[192:195], v[228:231], a[8:11]
    v_exp_f32 v122, v122
    v_mfma_f32_16x16x32_bf16 a[8:11], a[196:199], v[232:235], a[8:11]
    buffer_load_dwordx4 v15, s[8:11], s28 offen offset:2048 lds
    v_mfma_f32_16x16x32_bf16 a[12:15], a[196:199], v[240:243], a[12:15]
    v_exp_f32 v123, v123
    v_mfma_f32_16x16x32_bf16 a[12:15], a[192:195], v[236:239], a[12:15]
    s_waitcnt lgkmcnt(6)
    v_mfma_f32_16x16x32_bf16 v[116:119], a[128:131], v[36:39], v[100:103]
    s_waitcnt vmcnt(5)
    v_exp_f32 v124, v124
    v_mfma_f32_16x16x32_bf16 v[32:35], v[24:27], a[240:243], 0
    v_mfma_f32_16x16x32_bf16 v[32:35], v[28:31], a[244:247], v[32:35]
    ds_read_b64_tr_b16 v[24:25], v22 offset:1024
    v_mfma_f32_16x16x32_bf16 v[116:119], a[132:135], v[40:43], v[116:119]
    ds_read_b64_tr_b16 a[216:217], v8 offset:24576
    v_cvt_pk_bf16_f32 v189, v122, v123
    v_mfma_f32_16x16x32_bf16 v[116:119], a[136:139], v[44:47], v[116:119]
    v_exp_f32 v125, v125
    v_mfma_f32_16x16x32_bf16 v[116:119], a[140:143], v[48:51], v[116:119]
    ds_read_b64_tr_b16 a[218:219], v8 offset:28672
    v_mfma_f32_16x16x32_bf16 v[120:123], a[140:143], v[64:67], v[104:107]
    v_exp_f32 v126, v126
    v_mfma_f32_16x16x32_bf16 v[120:123], a[136:139], v[60:63], v[120:123]
    ds_read_b128 a[152:155], v3 offset:20480
    v_cvt_pk_bf16_f32 v196, v124, v125
    v_mfma_f32_16x16x32_bf16 v[120:123], a[132:135], v[56:59], v[120:123]
    v_exp_f32 v127, v127
    v_mfma_f32_16x16x32_bf16 v[120:123], a[128:131], v[52:55], v[120:123]
    ds_read_b64_tr_b16 a[220:221], v8 offset:49152
    v_mfma_f32_16x16x32_bf16 a[16:19], a[200:203], v[212:215], a[16:19]
    v_exp_f32 v128, v128
    v_mfma_f32_16x16x32_bf16 a[16:19], a[204:207], v[216:219], a[16:19]
    ds_read_b64_tr_b16 a[222:223], v8 offset:53248
    v_cvt_pk_bf16_f32 v197, v126, v127
    v_mfma_f32_16x16x32_bf16 a[20:23], a[204:207], v[224:227], a[20:23]
    v_exp_f32 v129, v129
    v_mfma_f32_16x16x32_bf16 a[20:23], a[200:203], v[220:223], a[20:23]
    ds_read_b128 a[156:159], v4 offset:20480
    v_mfma_f32_16x16x32_bf16 a[24:27], a[200:203], v[228:231], a[24:27]
    v_exp_f32 v130, v130
    v_mfma_f32_16x16x32_bf16 a[24:27], a[204:207], v[232:235], a[24:27]
    ds_read_b64_tr_b16 v[26:27], v22 offset:1088
    v_cvt_pk_bf16_f32 v204, v128, v129
    v_mfma_f32_16x16x32_bf16 a[28:31], a[204:207], v[240:243], a[28:31]
    v_exp_f32 v131, v131
    v_mfma_f32_16x16x32_bf16 a[28:31], a[200:203], v[236:239], a[28:31]
    buffer_load_dwordx4 v16, s[8:11], s28 offen offset:3072 lds
    v_smfmac_f32_16x16x64_bf16 a[224:227], v[244:247], v[212:219], v248
    s_waitcnt lgkmcnt(6)
    ds_read_b64_tr_b16 v[28:29], v22 offset:1536
    ds_read_b64_tr_b16 v[30:31], v22 offset:1600
    v_mfma_f32_16x16x32_bf16 v[124:127], a[128:131], v[68:71], v[108:111]
    s_mul_i32 s40, s5, 2560
    v_exp_f32 v132, v132
    v_mfma_f32_16x16x32_bf16 v[124:127], a[132:135], v[72:75], v[124:127]
    ds_read_b64_tr_b16 a[192:193], v9 offset:24576
    v_cvt_pk_bf16_f32 v205, v130, v131
    v_mfma_f32_16x16x32_bf16 v[124:127], a[136:139], v[76:79], v[124:127]
    v_exp_f32 v133, v133
    v_add_u32 v0, s40, v23
    v_mfma_f32_16x16x32_bf16 v[124:127], a[140:143], v[80:83], v[124:127]
    s_nop 0
    ds_read_b64_tr_b16 a[194:195], v9 offset:28672
    v_mfma_f32_16x16x32_bf16 v[128:131], a[140:143], v[96:99], v[112:115]
    s_nop 0
    v_exp_f32 v134, v134
    v_mfma_f32_16x16x32_bf16 v[128:131], a[136:139], v[92:95], v[128:131]
    s_nop 0
    ds_read_b128 a[160:163], v1 offset:24576
    v_cvt_pk_bf16_f32 v182, v132, v133
    v_mfma_f32_16x16x32_bf16 v[128:131], a[132:135], v[88:91], v[128:131]
    s_nop 0
    v_exp_f32 v135, v135
    v_mfma_f32_16x16x32_bf16 v[128:131], a[128:131], v[84:87], v[128:131]
    s_nop 0
    ds_read_b64_tr_b16 a[196:197], v9 offset:49152
    v_mfma_f32_16x16x32_bf16 a[32:35], a[208:211], v[212:215], a[32:35]
    s_nop 0
    v_exp_f32 v136, v136
    v_mfma_f32_16x16x32_bf16 a[32:35], a[212:215], v[216:219], a[32:35]
    s_waitcnt lgkmcnt(4)
    ds_read_b64_tr_b16 a[198:199], v9 offset:53248
    v_cvt_pk_bf16_f32 v183, v134, v135
    v_mfma_f32_16x16x32_bf16 v[32:35], v[24:27], a[248:251], v[32:35]
    v_mfma_f32_16x16x32_bf16 v[32:35], v[28:31], a[252:255], v[32:35]
    ds_read_b64_tr_b16 v[24:25], v22 offset:2048
    v_mfma_f32_16x16x32_bf16 a[36:39], a[212:215], v[224:227], a[36:39]
    v_exp_f32 v137, v137
    v_mfma_f32_16x16x32_bf16 a[36:39], a[208:211], v[220:223], a[36:39]
    ds_read_b128 a[164:167], v2 offset:24576
    v_cvt_pk_bf16_f32 v190, v136, v137
    v_mfma_f32_16x16x32_bf16 a[40:43], a[208:211], v[228:231], a[40:43]
    s_add_u32 s28, s28, 16384
    s_mov_b32 m0, s31
    v_exp_f32 v138, v138
    v_mfma_f32_16x16x32_bf16 a[40:43], a[212:215], v[232:235], a[40:43]
    buffer_load_dwordx4 v17, s[12:15], s29 offen offset:0 lds
    v_mfma_f32_16x16x32_bf16 a[44:47], a[212:215], v[240:243], a[44:47]
    v_exp_f32 v139, v139
    v_mfma_f32_16x16x32_bf16 a[44:47], a[208:211], v[236:239], a[44:47]
    s_waitcnt lgkmcnt(6)
    ds_read_b64_tr_b16 v[26:27], v22 offset:2112
    v_mfma_f32_16x16x32_bf16 v[132:135], a[144:147], v[36:39], v[100:103]
    s_nop 0
    v_exp_f32 v140, v140
    v_mfma_f32_16x16x32_bf16 v[132:135], a[148:151], v[40:43], v[132:135]
    s_nop 0
    ds_read_b64_tr_b16 a[200:201], v10 offset:24576
    v_cvt_pk_bf16_f32 v191, v138, v139
    v_mfma_f32_16x16x32_bf16 v[132:135], a[152:155], v[44:47], v[132:135]
    s_nop 0
    v_exp_f32 v141, v141
    v_mfma_f32_16x16x32_bf16 v[132:135], a[156:159], v[48:51], v[132:135]
    s_nop 0
    ds_read_b64_tr_b16 a[202:203], v10 offset:28672
    v_mfma_f32_16x16x32_bf16 v[136:139], a[156:159], v[64:67], v[104:107]
    s_nop 0
    v_exp_f32 v142, v142
    v_mfma_f32_16x16x32_bf16 v[136:139], a[152:155], v[60:63], v[136:139]
    s_nop 0
    ds_read_b128 a[168:171], v3 offset:24576
    v_cvt_pk_bf16_f32 v198, v140, v141
    v_mfma_f32_16x16x32_bf16 v[136:139], a[148:151], v[56:59], v[136:139]
    s_nop 0
    v_exp_f32 v143, v143
    v_mfma_f32_16x16x32_bf16 v[136:139], a[144:147], v[52:55], v[136:139]
    s_nop 0
    ds_read_b64_tr_b16 a[204:205], v10 offset:49152
    v_mfma_f32_16x16x32_bf16 a[48:51], a[216:219], v[212:215], a[48:51]
    s_waitcnt lgkmcnt(4)
    v_exp_f32 v144, v144
    v_mfma_f32_16x16x32_bf16 v[32:35], v[24:27], v[252:255], v[32:35]
    v_mfma_f32_16x16x32_bf16 a[48:51], a[220:223], v[216:219], a[48:51]
    ds_read_b64_tr_b16 a[206:207], v10 offset:53248
    v_cvt_pk_bf16_f32 v199, v142, v143
    v_mfma_f32_16x16x32_bf16 a[52:55], a[220:223], v[224:227], a[52:55]
    v_exp_f32 v145, v145
    v_mfma_f32_16x16x32_bf16 a[52:55], a[216:219], v[220:223], a[52:55]
    ds_read_b128 a[172:175], v4 offset:24576
    v_mfma_f32_16x16x32_bf16 a[56:59], a[216:219], v[228:231], a[56:59]
    v_exp_f32 v146, v146
    v_mfma_f32_16x16x32_bf16 a[56:59], a[220:223], v[232:235], a[56:59]
    v_cvt_pk_bf16_f32 v206, v144, v145
    v_mfma_f32_16x16x32_bf16 a[60:63], a[220:223], v[240:243], a[60:63]
    v_exp_f32 v147, v147
    v_mfma_f32_16x16x32_bf16 a[60:63], a[216:219], v[236:239], a[60:63]
    buffer_load_dwordx4 v18, s[12:15], s29 offen offset:1024 lds
    v_smfmac_f32_16x16x64_bf16 a[228:231], v[244:247], v[220:227], v248
    s_waitcnt lgkmcnt(6)
    v_mfma_f32_16x16x32_bf16 v[140:143], a[144:147], v[68:71], v[108:111]
    s_nop 0
    v_exp_f32 v148, v148
    v_mfma_f32_16x16x32_bf16 v[140:143], a[148:151], v[72:75], v[140:143]
    s_nop 0
    ds_read_b64_tr_b16 a[208:209], v11 offset:24576
    v_cvt_pk_bf16_f32 v207, v146, v147
    v_mfma_f32_16x16x32_bf16 v[140:143], a[152:155], v[76:79], v[140:143]
    s_nop 0
    v_exp_f32 v149, v149
    v_mfma_f32_16x16x32_bf16 v[140:143], a[156:159], v[80:83], v[140:143]
    ds_read_b64_tr_b16 a[210:211], v11 offset:28672
    v_mfma_f32_16x16x32_bf16 v[144:147], a[156:159], v[96:99], v[112:115]
    v_exp_f32 v150, v150
    v_mfma_f32_16x16x32_bf16 v[144:147], a[152:155], v[92:95], v[144:147]
    ds_read_b128 a[176:179], v1 offset:28672
    v_cvt_pk_bf16_f32 v184, v148, v149
    v_mfma_f32_16x16x32_bf16 v[144:147], a[148:151], v[88:91], v[144:147]
    v_exp_f32 v151, v151
    v_mfma_f32_16x16x32_bf16 v[144:147], a[144:147], v[84:87], v[144:147]
    ds_read_b64_tr_b16 a[212:213], v11 offset:49152
    ds_write_b128 v0, v[32:35]
    v_bfe_u32 v22, v19, 2, 3
    v_mfma_f32_16x16x32_bf16 a[64:67], a[192:195], v[212:215], a[64:67]
    v_exp_f32 v152, v152
    v_mul_u32_u24 v22, 160, v22
    v_mfma_f32_16x16x32_bf16 a[64:67], a[196:199], v[216:219], a[64:67]
    ds_read_b64_tr_b16 a[214:215], v11 offset:53248
    v_cvt_pk_bf16_f32 v185, v150, v151
    v_mfma_f32_16x16x32_bf16 a[68:71], a[196:199], v[224:227], a[68:71]
    v_exp_f32 v153, v153
    v_and_b32 v28, 3, v19
    v_mfma_f32_16x16x32_bf16 a[68:71], a[192:195], v[220:223], a[68:71]
    ds_read_b128 a[180:183], v2 offset:28672
    v_cvt_pk_bf16_f32 v192, v152, v153
    v_add_u32 v22, v22, v28
    v_mfma_f32_16x16x32_bf16 a[72:75], a[192:195], v[228:231], a[72:75]
    s_mul_i32 s42, s5, 320
    v_exp_f32 v154, v154
    v_mfma_f32_16x16x32_bf16 a[72:75], a[196:199], v[232:235], a[72:75]
    s_add_u32 s42, s42, 86016
    buffer_load_dwordx4 v17, s[12:15], s29 offen offset:2048 lds
    v_mfma_f32_16x16x32_bf16 a[76:79], a[196:199], v[240:243], a[76:79]
    v_exp_f32 v155, v155
    v_mfma_f32_16x16x32_bf16 a[76:79], a[192:195], v[236:239], a[76:79]
    s_waitcnt lgkmcnt(6)
    v_lshl_add_u32 v22, v22, 3, s42
    v_mfma_f32_16x16x32_bf16 v[148:151], a[160:163], v[36:39], v[100:103]
    v_exp_f32 v156, v156
    v_mfma_f32_16x16x32_bf16 v[148:151], a[164:167], v[40:43], v[148:151]
    ds_read_b64_tr_b16 a[216:217], v12 offset:24576
    v_cvt_pk_bf16_f32 v193, v154, v155
    v_mfma_f32_16x16x32_bf16 v[148:151], a[168:171], v[44:47], v[148:151]
    v_exp_f32 v157, v157
    v_mfma_f32_16x16x32_bf16 v[148:151], a[172:175], v[48:51], v[148:151]
    ds_read_b64_tr_b16 a[218:219], v12 offset:28672
    v_mfma_f32_16x16x32_bf16 v[152:155], a[172:175], v[64:67], v[104:107]
    v_exp_f32 v158, v158
    v_mfma_f32_16x16x32_bf16 v[152:155], a[168:171], v[60:63], v[152:155]
    ds_read_b128 a[184:187], v3 offset:28672
    v_cvt_pk_bf16_f32 v200, v156, v157
    v_mfma_f32_16x16x32_bf16 v[152:155], a[164:167], v[56:59], v[152:155]
    v_exp_f32 v159, v159
    v_mfma_f32_16x16x32_bf16 v[152:155], a[160:163], v[52:55], v[152:155]
    ds_read_b64_tr_b16 a[220:221], v12 offset:49152
    v_mfma_f32_16x16x32_bf16 a[80:83], a[200:203], v[212:215], a[80:83]
    v_exp_f32 v160, v160
    v_mfma_f32_16x16x32_bf16 a[80:83], a[204:207], v[216:219], a[80:83]
    ds_read_b64_tr_b16 a[222:223], v12 offset:53248
    v_cvt_pk_bf16_f32 v201, v158, v159
    v_mfma_f32_16x16x32_bf16 a[84:87], a[204:207], v[224:227], a[84:87]
    v_exp_f32 v161, v161
    v_mfma_f32_16x16x32_bf16 a[84:87], a[200:203], v[220:223], a[84:87]
    ds_read_b128 a[188:191], v4 offset:28672
    v_mfma_f32_16x16x32_bf16 a[88:91], a[200:203], v[228:231], a[88:91]
    v_exp_f32 v162, v162
    v_mfma_f32_16x16x32_bf16 a[88:91], a[204:207], v[232:235], a[88:91]
    v_cvt_pk_bf16_f32 v208, v160, v161
    v_mfma_f32_16x16x32_bf16 a[92:95], a[204:207], v[240:243], a[92:95]
    v_exp_f32 v163, v163
    v_mfma_f32_16x16x32_bf16 a[92:95], a[200:203], v[236:239], a[92:95]
    buffer_load_dwordx4 v18, s[12:15], s29 offen offset:3072 lds
    v_smfmac_f32_16x16x64_bf16 a[232:235], v[244:247], v[228:235], v248
    s_waitcnt vmcnt(8) lgkmcnt(6)
    s_barrier
    s_add_u32 s29, s29, 16384
    v_mfma_f32_16x16x32_bf16 v[156:159], a[160:163], v[68:71], v[108:111]
    v_exp_f32 v164, v164
    v_mfma_f32_16x16x32_bf16 v[156:159], a[164:167], v[72:75], v[156:159]
    ds_read_b64_tr_b16 a[192:193], v5 offset:8192
    v_cvt_pk_bf16_f32 v209, v162, v163
    v_mfma_f32_16x16x32_bf16 v[156:159], a[168:171], v[76:79], v[156:159]
    v_exp_f32 v165, v165
    v_mfma_f32_16x16x32_bf16 v[156:159], a[172:175], v[80:83], v[156:159]
    ds_read_b64_tr_b16 a[194:195], v5 offset:12288
    ds_read_b128 v[24:27], v23 offset:0
    v_mfma_f32_16x16x32_bf16 v[160:163], a[172:175], v[96:99], v[112:115]
    v_exp_f32 v166, v166
    v_mfma_f32_16x16x32_bf16 v[160:163], a[168:171], v[92:95], v[160:163]
    ds_read_b128 a[128:131], v1 offset:32768
    v_cvt_pk_bf16_f32 v186, v164, v165
    v_mfma_f32_16x16x32_bf16 v[160:163], a[164:167], v[88:91], v[160:163]
    v_exp_f32 v167, v167
    v_mfma_f32_16x16x32_bf16 v[160:163], a[160:163], v[84:87], v[160:163]
    ds_read_b64_tr_b16 a[196:197], v5 offset:32768
    ds_read_b128 v[28:31], v23 offset:2560
    v_mfma_f32_16x16x32_bf16 a[96:99], a[208:211], v[212:215], a[96:99]
    v_exp_f32 v168, v168
    v_mfma_f32_16x16x32_bf16 a[96:99], a[212:215], v[216:219], a[96:99]
    ds_read_b64_tr_b16 a[198:199], v5 offset:36864
    v_cvt_pk_bf16_f32 v187, v166, v167
    v_mfma_f32_16x16x32_bf16 a[100:103], a[212:215], v[224:227], a[100:103]
    v_exp_f32 v169, v169
    v_mfma_f32_16x16x32_bf16 a[100:103], a[208:211], v[220:223], a[100:103]
    ds_read_b128 a[132:135], v2 offset:32768
    v_cvt_pk_bf16_f32 v194, v168, v169
    v_mfma_f32_16x16x32_bf16 a[104:107], a[208:211], v[228:231], a[104:107]
    s_mov_b32 m0, s32
    v_exp_f32 v170, v170
    v_mfma_f32_16x16x32_bf16 a[104:107], a[212:215], v[232:235], a[104:107]
    buffer_load_dwordx4 v17, s[12:15], s29 offen offset:0 lds
    v_mfma_f32_16x16x32_bf16 a[108:111], a[212:215], v[240:243], a[108:111]
    v_exp_f32 v171, v171
    v_mfma_f32_16x16x32_bf16 a[108:111], a[208:211], v[236:239], a[108:111]
    s_waitcnt lgkmcnt(6)
    ds_read_b128 v[32:35], v23 offset:5120
    ds_read_b128 v[252:255], v23 offset:7680
    v_mfma_f32_16x16x32_bf16 v[164:167], a[176:179], v[36:39], v[100:103]
    v_exp_f32 v172, v172
    v_mfma_f32_16x16x32_bf16 v[164:167], a[180:183], v[40:43], v[164:167]
    ds_read_b64_tr_b16 a[200:201], v6 offset:8192
    v_cvt_pk_bf16_f32 v195, v170, v171
    v_mfma_f32_16x16x32_bf16 v[164:167], a[184:187], v[44:47], v[164:167]
    v_exp_f32 v173, v173
    v_mfma_f32_16x16x32_bf16 v[164:167], a[188:191], v[48:51], v[164:167]
    ds_read_b64_tr_b16 a[202:203], v6 offset:12288
    v_mfma_f32_16x16x32_bf16 v[168:171], a[188:191], v[64:67], v[104:107]
    v_exp_f32 v174, v174
    v_mfma_f32_16x16x32_bf16 v[168:171], a[184:187], v[60:63], v[168:171]
    ds_read_b128 a[136:139], v3 offset:32768
    v_cvt_pk_bf16_f32 v202, v172, v173
    v_mfma_f32_16x16x32_bf16 v[168:171], a[180:183], v[56:59], v[168:171]
    v_exp_f32 v175, v175
    v_mfma_f32_16x16x32_bf16 v[168:171], a[176:179], v[52:55], v[168:171]
    ds_read_b64_tr_b16 a[204:205], v6 offset:32768
    ds_read_b64_tr_b16 a[240:241], v22 offset:0
    v_mfma_f32_16x16x32_bf16 a[112:115], a[216:219], v[212:215], a[112:115]
    v_exp_f32 v176, v176
    v_mfma_f32_16x16x32_bf16 a[112:115], a[220:223], v[216:219], a[112:115]
    ds_read_b64_tr_b16 a[206:207], v6 offset:36864
    v_cvt_pk_bf16_f32 v203, v174, v175
    v_mfma_f32_16x16x32_bf16 a[116:119], a[220:223], v[224:227], a[116:119]
    v_exp_f32 v177, v177
    v_mfma_f32_16x16x32_bf16 a[116:119], a[216:219], v[220:223], a[116:119]
    ds_read_b128 a[140:143], v4 offset:32768
    ds_read_b64_tr_b16 a[242:243], v22 offset:32
    v_mfma_f32_16x16x32_bf16 a[120:123], a[216:219], v[228:231], a[120:123]
    v_exp_f32 v178, v178
    v_mfma_f32_16x16x32_bf16 a[120:123], a[220:223], v[232:235], a[120:123]
    ds_read_b64_tr_b16 a[244:245], v22 offset:64
    v_cvt_pk_bf16_f32 v210, v176, v177
    v_mfma_f32_16x16x32_bf16 a[124:127], a[220:223], v[240:243], a[124:127]
    v_exp_f32 v179, v179
    v_mfma_f32_16x16x32_bf16 a[124:127], a[216:219], v[236:239], a[124:127]
    buffer_load_dwordx4 v18, s[12:15], s29 offen offset:1024 lds
    v_smfmac_f32_16x16x64_bf16 a[236:239], v[244:247], v[236:243], v248
    s_waitcnt lgkmcnt(6)
    ds_read_b64_tr_b16 a[246:247], v22 offset:96
    v_mfma_f32_16x16x32_bf16 v[172:175], a[176:179], v[68:71], v[108:111]
    v_exp_f32 v116, v116
    v_mfma_f32_16x16x32_bf16 v[172:175], a[180:183], v[72:75], v[172:175]
    ds_read_b64_tr_b16 a[208:209], v7 offset:8192
    v_cvt_pk_bf16_f32 v211, v178, v179
    v_add_f32 v24, v24, v28
    v_mfma_f32_16x16x32_bf16 v[172:175], a[184:187], v[76:79], v[172:175]
    v_exp_f32 v117, v117
    v_add_f32 v25, v25, v29
    v_mfma_f32_16x16x32_bf16 v[172:175], a[188:191], v[80:83], v[172:175]
    ds_read_b64_tr_b16 a[210:211], v7 offset:12288
    v_add_f32 v26, v26, v30
    v_mfma_f32_16x16x32_bf16 v[176:179], a[188:191], v[96:99], v[112:115]
    v_exp_f32 v118, v118
    v_mfma_f32_16x16x32_bf16 v[176:179], a[184:187], v[92:95], v[176:179]
    ds_read_b128 a[144:147], v1 offset:36864
    v_cvt_pk_bf16_f32 v212, v116, v117
    v_add_f32 v27, v27, v31
    v_mfma_f32_16x16x32_bf16 v[176:179], a[180:183], v[88:91], v[176:179]
    v_exp_f32 v119, v119
    v_add_f32 v24, v24, v32
    v_mfma_f32_16x16x32_bf16 v[176:179], a[176:179], v[84:87], v[176:179]
    ds_read_b64_tr_b16 a[212:213], v7 offset:32768
    v_add_f32 v25, v25, v33
    v_mfma_f32_16x16x32_bf16 a[0:3], a[192:195], v[180:183], a[0:3]
    v_exp_f32 v120, v120
    v_mfma_f32_16x16x32_bf16 a[0:3], a[196:199], v[184:187], a[0:3]
    ds_read_b64_tr_b16 a[214:215], v7 offset:36864
    v_cvt_pk_bf16_f32 v213, v118, v119
    v_add_f32 v26, v26, v34
    v_mfma_f32_16x16x32_bf16 a[4:7], a[196:199], v[192:195], a[4:7]
    v_exp_f32 v121, v121
    v_add_f32 v27, v27, v35
    v_mfma_f32_16x16x32_bf16 a[4:7], a[192:195], v[188:191], a[4:7]
    ds_read_b128 a[148:151], v2 offset:36864
    v_cvt_pk_bf16_f32 v220, v120, v121
    v_add_f32 v24, v24, v252
    v_mfma_f32_16x16x32_bf16 a[8:11], a[192:195], v[196:199], a[8:11]
    v_exp_f32 v122, v122
    v_mfma_f32_16x16x32_bf16 a[8:11], a[196:199], v[200:203], a[8:11]
    buffer_load_dwordx4 v17, s[12:15], s29 offen offset:2048 lds
    v_add_f32 v25, v25, v253
    v_mfma_f32_16x16x32_bf16 a[12:15], a[196:199], v[208:211], a[12:15]
    v_exp_f32 v123, v123
    v_add_f32 v26, v26, v254
    v_mfma_f32_16x16x32_bf16 a[12:15], a[192:195], v[204:207], a[12:15]
    s_waitcnt lgkmcnt(6)
    ds_read_b64_tr_b16 a[248:249], v22 offset:128
    v_add_f32 v27, v27, v255
    v_mfma_f32_16x16x32_bf16 v[116:119], a[128:131], v[36:39], v[100:103]
    v_exp_f32 v124, v124
    v_mfma_f32_16x16x32_bf16 v[116:119], a[132:135], v[40:43], v[116:119]
    ds_read_b64_tr_b16 a[216:217], v8 offset:8192
    v_cvt_pk_bf16_f32 v221, v122, v123
    v_mov_b32_dpp v28, v24 row_newbcast:8 row_mask:0xf bank_mask:0xf
    v_mfma_f32_16x16x32_bf16 v[116:119], a[136:139], v[44:47], v[116:119]
    v_exp_f32 v125, v125
    v_mov_b32_dpp v29, v25 row_newbcast:8 row_mask:0xf bank_mask:0xf
    v_mfma_f32_16x16x32_bf16 v[116:119], a[140:143], v[48:51], v[116:119]
    ds_read_b64_tr_b16 a[218:219], v8 offset:12288
    v_mov_b32_dpp v30, v26 row_newbcast:8 row_mask:0xf bank_mask:0xf
    v_mfma_f32_16x16x32_bf16 v[120:123], a[140:143], v[64:67], v[104:107]
    v_exp_f32 v126, v126
    v_mfma_f32_16x16x32_bf16 v[120:123], a[136:139], v[60:63], v[120:123]
    ds_read_b128 a[152:155], v3 offset:36864
    v_cvt_pk_bf16_f32 v228, v124, v125
    v_mov_b32_dpp v31, v27 row_newbcast:8 row_mask:0xf bank_mask:0xf
    v_mfma_f32_16x16x32_bf16 v[120:123], a[132:135], v[56:59], v[120:123]
    v_exp_f32 v127, v127
    v_mfma_f32_16x16x32_bf16 v[120:123], a[128:131], v[52:55], v[120:123]
    ds_read_b64_tr_b16 a[220:221], v8 offset:32768
    v_fma_f32 v24, -v20, v28, v24
    v_mfma_f32_16x16x32_bf16 a[16:19], a[200:203], v[180:183], a[16:19]
    v_exp_f32 v128, v128
    v_fma_f32 v25, -v20, v29, v25
    v_mfma_f32_16x16x32_bf16 a[16:19], a[204:207], v[184:187], a[16:19]
    ds_read_b64_tr_b16 a[222:223], v8 offset:36864
    v_cvt_pk_bf16_f32 v229, v126, v127
    v_fma_f32 v26, -v20, v30, v26
    v_mfma_f32_16x16x32_bf16 a[20:23], a[204:207], v[192:195], a[20:23]
    v_exp_f32 v129, v129
    v_mfma_f32_16x16x32_bf16 a[20:23], a[200:203], v[188:191], a[20:23]
    ds_read_b128 a[156:159], v4 offset:36864
    v_fma_f32 v27, -v20, v31, v27
    v_mfma_f32_16x16x32_bf16 a[24:27], a[200:203], v[196:199], a[24:27]
    v_exp_f32 v130, v130
    v_mul_f32 v24, v24, v21
    v_mfma_f32_16x16x32_bf16 a[24:27], a[204:207], v[200:203], a[24:27]
    v_cvt_pk_bf16_f32 v236, v128, v129
    v_mul_f32 v25, v25, v21
    v_mfma_f32_16x16x32_bf16 a[28:31], a[204:207], v[208:211], a[28:31]
    v_exp_f32 v131, v131
    v_mfma_f32_16x16x32_bf16 a[28:31], a[200:203], v[204:207], a[28:31]
    buffer_load_dwordx4 v18, s[12:15], s29 offen offset:3072 lds
    v_mul_f32 v26, v26, v21
    v_smfmac_f32_16x16x64_bf16 a[224:227], v[244:247], v[180:187], v248
    s_waitcnt lgkmcnt(6)
    s_add_u32 s29, s29, 16384
    ds_read_b64_tr_b16 a[250:251], v22 offset:160
    ds_read_b64_tr_b16 a[252:253], v22 offset:192
    ds_read_b64_tr_b16 a[254:255], v22 offset:224
    v_mul_f32 v27, v27, v21
    v_cvt_pk_bf16_f32 v28, v24, v25
    v_mfma_f32_16x16x32_bf16 v[124:127], a[128:131], v[68:71], v[108:111]
    v_exp_f32 v132, v132
    v_mfma_f32_16x16x32_bf16 v[124:127], a[132:135], v[72:75], v[124:127]
    ds_read_b64_tr_b16 a[192:193], v9 offset:8192
    v_cvt_pk_bf16_f32 v237, v130, v131
    v_mfma_f32_16x16x32_bf16 v[124:127], a[136:139], v[76:79], v[124:127]
    v_exp_f32 v133, v133
    v_cvt_pk_bf16_f32 v29, v26, v27
    v_mfma_f32_16x16x32_bf16 v[124:127], a[140:143], v[80:83], v[124:127]
    ds_read_b64_tr_b16 a[194:195], v9 offset:12288
    v_lshlrev_b32 v24, 16, v28
    v_mfma_f32_16x16x32_bf16 v[128:131], a[140:143], v[96:99], v[112:115]
    v_exp_f32 v134, v134
    v_mfma_f32_16x16x32_bf16 v[128:131], a[136:139], v[92:95], v[128:131]
    ds_read_b128 a[160:163], v1 offset:40960
    v_cvt_pk_bf16_f32 v214, v132, v133
    v_and_b32 v25, 0xffff0000, v28
    v_mfma_f32_16x16x32_bf16 v[128:131], a[132:135], v[88:91], v[128:131]
    v_exp_f32 v135, v135
    v_lshlrev_b32 v26, 16, v29
    v_mfma_f32_16x16x32_bf16 v[128:131], a[128:131], v[84:87], v[128:131]
    ds_read_b64_tr_b16 a[196:197], v9 offset:32768
    v_and_b32 v27, 0xffff0000, v29
    v_mfma_f32_16x16x32_bf16 a[32:35], a[208:211], v[180:183], a[32:35]
    v_exp_f32 v136, v136
    v_mfma_f32_16x16x32_bf16 a[32:35], a[212:215], v[184:187], a[32:35]
    ds_read_b64_tr_b16 a[198:199], v9 offset:36864
    v_cvt_pk_bf16_f32 v215, v134, v135
    v_mov_b32 v32, v24
    v_mfma_f32_16x16x32_bf16 a[36:39], a[212:215], v[192:195], a[36:39]
    v_exp_f32 v137, v137
    v_mov_b32 v33, v25
    v_mfma_f32_16x16x32_bf16 a[36:39], a[208:211], v[188:191], a[36:39]
    ds_read_b128 a[164:167], v2 offset:40960
    v_mov_b32 v34, v26
    v_mfma_f32_16x16x32_bf16 a[40:43], a[208:211], v[196:199], a[40:43]
    v_exp_f32 v138, v138
    v_mfma_f32_16x16x32_bf16 a[40:43], a[212:215], v[200:203], a[40:43]
    v_cvt_pk_bf16_f32 v222, v136, v137
    v_mov_b32 v35, v27
    v_mfma_f32_16x16x32_bf16 a[44:47], a[212:215], v[208:211], a[44:47]
    v_exp_f32 v139, v139
    v_permlane32_swap_b32 v24, v32
    v_mfma_f32_16x16x32_bf16 a[44:47], a[208:211], v[204:207], a[44:47]
    s_waitcnt lgkmcnt(6)
    v_permlane32_swap_b32 v25, v33
    v_mfma_f32_16x16x32_bf16 v[132:135], a[144:147], v[36:39], v[100:103]
    s_mul_i32 s46, s5, 10240
    v_exp_f32 v140, v140
    v_mfma_f32_16x16x32_bf16 v[132:135], a[148:151], v[40:43], v[132:135]
    s_lshl_b32 s40, s100, 1
    ds_read_b64_tr_b16 a[200:201], v10 offset:8192
    v_cvt_pk_bf16_f32 v223, v138, v139
    v_permlane32_swap_b32 v26, v34
    v_mfma_f32_16x16x32_bf16 v[132:135], a[152:155], v[44:47], v[132:135]
    s_add_u32 s40, s40, s47
    v_exp_f32 v141, v141
    v_permlane32_swap_b32 v27, v35
    v_mfma_f32_16x16x32_bf16 v[132:135], a[156:159], v[48:51], v[132:135]
    s_mul_i32 s40, s40, 327680
    ds_read_b64_tr_b16 a[202:203], v10 offset:12288
    v_mul_f32 v28, 0xbfb8aa3b, v24
    v_mfma_f32_16x16x32_bf16 v[136:139], a[156:159], v[64:67], v[104:107]
    s_add_u32 s40, s40, 0x1400000
    v_exp_f32 v142, v142
    v_mfma_f32_16x16x32_bf16 v[136:139], a[152:155], v[60:63], v[136:139]
    s_add_u32 s20, s72, s40
    s_addc_u32 s21, s73, 0
    ds_read_b128 a[168:171], v3 offset:40960
    v_cvt_pk_bf16_f32 v230, v140, v141
    v_mul_f32 v29, 0xbfb8aa3b, v25
    v_mfma_f32_16x16x32_bf16 v[136:139], a[148:151], v[56:59], v[136:139]
    s_mov_b32 s22, 0x50000
    v_exp_f32 v143, v143
    v_mfma_f32_16x16x32_bf16 v[136:139], a[144:147], v[52:55], v[136:139]
    s_mov_b32 s23, 0x20000
    ds_read_b64_tr_b16 a[204:205], v10 offset:32768
    v_mul_f32 v30, 0xbfb8aa3b, v26
    v_mfma_f32_16x16x32_bf16 a[48:51], a[216:219], v[180:183], a[48:51]
    s_mul_i32 s40, s5, 5120
    v_exp_f32 v144, v144
    v_mul_f32 v31, 0xbfb8aa3b, v27
    v_mfma_f32_16x16x32_bf16 a[48:51], a[220:223], v[184:187], a[48:51]
    ds_read_b64_tr_b16 a[206:207], v10 offset:36864
    v_cvt_pk_bf16_f32 v231, v142, v143
    v_exp_f32 v28, v28
    v_mfma_f32_16x16x32_bf16 a[52:55], a[220:223], v[192:195], a[52:55]
    v_exp_f32 v145, v145
    v_mfma_f32_16x16x32_bf16 a[52:55], a[216:219], v[188:191], a[52:55]
    ds_read_b128 a[172:175], v4 offset:40960
    v_exp_f32 v29, v29
    v_mfma_f32_16x16x32_bf16 a[56:59], a[216:219], v[196:199], a[56:59]
    v_exp_f32 v146, v146
    v_exp_f32 v30, v30
    v_mfma_f32_16x16x32_bf16 a[56:59], a[220:223], v[200:203], a[56:59]
    v_cvt_pk_bf16_f32 v238, v144, v145
    v_lshl_add_u32 v254, v19, 4, s40
    v_mfma_f32_16x16x32_bf16 a[60:63], a[220:223], v[208:211], a[60:63]
    v_exp_f32 v147, v147
    v_exp_f32 v31, v31
    v_mfma_f32_16x16x32_bf16 a[60:63], a[216:219], v[204:207], a[60:63]
    v_add_f32 v28, 1.0, v28
    v_add_f32 v29, 1.0, v29
    v_smfmac_f32_16x16x64_bf16 a[228:231], v[244:247], v[188:195], v248
    s_waitcnt lgkmcnt(6)
    v_add_f32 v30, 1.0, v30
    v_add_f32 v31, 1.0, v31
    v_mfma_f32_16x16x32_bf16 v[140:143], a[144:147], v[68:71], v[108:111]
    v_exp_f32 v148, v148
    v_mfma_f32_16x16x32_bf16 v[140:143], a[148:151], v[72:75], v[140:143]
    ds_read_b64_tr_b16 a[208:209], v11 offset:8192
    v_cvt_pk_bf16_f32 v239, v146, v147
    v_mfma_f32_16x16x32_bf16 v[140:143], a[152:155], v[76:79], v[140:143]
    v_exp_f32 v149, v149
    v_mfma_f32_16x16x32_bf16 v[140:143], a[156:159], v[80:83], v[140:143]
    ds_read_b64_tr_b16 a[210:211], v11 offset:12288
    v_rcp_f32 v28, v28
    v_mfma_f32_16x16x32_bf16 v[144:147], a[156:159], v[96:99], v[112:115]
    v_exp_f32 v150, v150
    v_mfma_f32_16x16x32_bf16 v[144:147], a[152:155], v[92:95], v[144:147]
    ds_read_b128 a[176:179], v1 offset:45056
    v_cvt_pk_bf16_f32 v216, v148, v149
    v_rcp_f32 v29, v29
    v_mfma_f32_16x16x32_bf16 v[144:147], a[148:151], v[88:91], v[144:147]
    v_exp_f32 v151, v151
    v_rcp_f32 v30, v30
    v_mfma_f32_16x16x32_bf16 v[144:147], a[144:147], v[84:87], v[144:147]
    ds_read_b64_tr_b16 a[212:213], v11 offset:32768
    v_rcp_f32 v31, v31
    v_mfma_f32_16x16x32_bf16 a[64:67], a[192:195], v[180:183], a[64:67]
    v_exp_f32 v152, v152
    v_mfma_f32_16x16x32_bf16 a[64:67], a[196:199], v[184:187], a[64:67]
    ds_read_b64_tr_b16 a[214:215], v11 offset:36864
    v_cvt_pk_bf16_f32 v217, v150, v151
    v_mul_f32 v24, v24, v28
    v_mfma_f32_16x16x32_bf16 a[68:71], a[196:199], v[192:195], a[68:71]
    v_exp_f32 v153, v153
    v_mul_f32 v25, v25, v29
    v_mfma_f32_16x16x32_bf16 a[68:71], a[192:195], v[188:191], a[68:71]
    ds_read_b128 a[180:183], v2 offset:45056
    v_mul_f32 v26, v26, v30
    v_mfma_f32_16x16x32_bf16 a[72:75], a[192:195], v[196:199], a[72:75]
    v_exp_f32 v154, v154
    v_mfma_f32_16x16x32_bf16 a[72:75], a[196:199], v[200:203], a[72:75]
    v_cvt_pk_bf16_f32 v224, v152, v153
    v_mul_f32 v27, v27, v31
    v_mfma_f32_16x16x32_bf16 a[76:79], a[196:199], v[208:211], a[76:79]
    v_exp_f32 v155, v155
    v_cvt_pk_bf16_f32 v28, v24, v25
    v_mfma_f32_16x16x32_bf16 a[76:79], a[192:195], v[204:207], a[76:79]
    s_waitcnt lgkmcnt(6)
    v_cvt_pk_bf16_f32 v29, v26, v27
    v_lshlrev_b32 v24, 16, v28
    v_mfma_f32_16x16x32_bf16 v[148:151], a[160:163], v[36:39], v[100:103]
    v_exp_f32 v156, v156
    v_mfma_f32_16x16x32_bf16 v[148:151], a[164:167], v[40:43], v[148:151]
    ds_read_b64_tr_b16 a[216:217], v12 offset:8192
    v_cvt_pk_bf16_f32 v225, v154, v155
    v_mfma_f32_16x16x32_bf16 v[148:151], a[168:171], v[44:47], v[148:151]
    v_exp_f32 v157, v157
    v_and_b32 v25, 0xffff0000, v28
    v_mfma_f32_16x16x32_bf16 v[148:151], a[172:175], v[48:51], v[148:151]
    ds_read_b64_tr_b16 a[218:219], v12 offset:12288
    v_lshlrev_b32 v26, 16, v29
    v_mfma_f32_16x16x32_bf16 v[152:155], a[172:175], v[64:67], v[104:107]
    v_exp_f32 v158, v158
    v_mfma_f32_16x16x32_bf16 v[152:155], a[168:171], v[60:63], v[152:155]
    ds_read_b128 a[184:187], v3 offset:45056
    v_cvt_pk_bf16_f32 v232, v156, v157
    v_and_b32 v27, 0xffff0000, v29
    v_mfma_f32_16x16x32_bf16 v[152:155], a[164:167], v[56:59], v[152:155]
    v_exp_f32 v159, v159
    v_mfma_f32_16x16x32_bf16 v[152:155], a[160:163], v[52:55], v[152:155]
    ds_read_b64_tr_b16 a[220:221], v12 offset:32768
    v_mul_f32 v24, v24, v32
    v_mfma_f32_16x16x32_bf16 a[80:83], a[200:203], v[180:183], a[80:83]
    v_exp_f32 v160, v160
    v_mul_f32 v25, v25, v33
    v_mfma_f32_16x16x32_bf16 a[80:83], a[204:207], v[184:187], a[80:83]
    ds_read_b64_tr_b16 a[222:223], v12 offset:36864
    v_cvt_pk_bf16_f32 v233, v158, v159
    v_mul_f32 v26, v26, v34
    v_mfma_f32_16x16x32_bf16 a[84:87], a[204:207], v[192:195], a[84:87]
    v_exp_f32 v161, v161
    v_mfma_f32_16x16x32_bf16 a[84:87], a[200:203], v[188:191], a[84:87]
    ds_read_b128 a[188:191], v4 offset:45056
    v_mul_f32 v27, v27, v35
    v_mfma_f32_16x16x32_bf16 a[88:91], a[200:203], v[196:199], a[88:91]
    v_exp_f32 v162, v162
    v_cmp_gt_u32 vcc, 32, v19
    v_mfma_f32_16x16x32_bf16 a[88:91], a[204:207], v[200:203], a[88:91]
    v_cvt_pk_bf16_f32 v240, v160, v161
    v_cvt_pk_bf16_f32 v252, v24, v25
    v_mfma_f32_16x16x32_bf16 a[92:95], a[204:207], v[208:211], a[92:95]
    v_exp_f32 v163, v163
    v_mfma_f32_16x16x32_bf16 a[92:95], a[200:203], v[204:207], a[92:95]
    v_cvt_pk_bf16_f32 v253, v26, v27
    v_cndmask_b32 v252, 0, v252, vcc
    v_smfmac_f32_16x16x64_bf16 a[232:235], v[244:247], v[196:203], v248
    s_waitcnt vmcnt(4) lgkmcnt(0)
    s_barrier
    v_cndmask_b32 v253, 0, v253, vcc
    v_and_b32 v23, 7, v19
    v_mfma_f32_16x16x32_bf16 v[156:159], a[160:163], v[68:71], v[108:111]
    v_exp_f32 v164, v164
    v_mfma_f32_16x16x32_bf16 v[156:159], a[164:167], v[72:75], v[156:159]
    ds_read_b64_tr_b16 a[192:193], v5 offset:16384
    v_cvt_pk_bf16_f32 v241, v162, v163
    v_mfma_f32_16x16x32_bf16 v[156:159], a[168:171], v[76:79], v[156:159]
    v_exp_f32 v165, v165
    v_mfma_f32_16x16x32_bf16 v[156:159], a[172:175], v[80:83], v[156:159]
    ds_read_b64_tr_b16 a[194:195], v5 offset:20480
    v_mul_u32_u24 v23, 34560, v23
    v_mfma_f32_16x16x32_bf16 v[160:163], a[172:175], v[96:99], v[112:115]
    v_exp_f32 v166, v166
    v_mfma_f32_16x16x32_bf16 v[160:163], a[168:171], v[92:95], v[160:163]
    ds_read_b128 a[128:131], v1 offset:0
    v_cvt_pk_bf16_f32 v218, v164, v165
    v_lshrrev_b32 v0, 4, v19
    v_mfma_f32_16x16x32_bf16 v[160:163], a[164:167], v[88:91], v[160:163]
    v_exp_f32 v167, v167
    v_add_u32 v23, v23, v0
    v_mfma_f32_16x16x32_bf16 v[160:163], a[160:163], v[84:87], v[160:163]
    ds_read_b64_tr_b16 a[196:197], v5 offset:40960
    v_and_b32 v0, 8, v19
    v_mfma_f32_16x16x32_bf16 a[96:99], a[208:211], v[180:183], a[96:99]
    v_exp_f32 v168, v168
    v_mfma_f32_16x16x32_bf16 a[96:99], a[212:215], v[184:187], a[96:99]
    ds_read_b64_tr_b16 a[198:199], v5 offset:45056
    v_cvt_pk_bf16_f32 v219, v166, v167
    v_lshrrev_b32 v0, 1, v0
    v_mfma_f32_16x16x32_bf16 a[100:103], a[212:215], v[192:195], a[100:103]
    v_exp_f32 v169, v169
    v_add_lshl_u32 v23, v23, v0, 4
    v_mfma_f32_16x16x32_bf16 a[100:103], a[208:211], v[188:191], a[100:103]
    s_mul_i32 s42, s5, 1080
    ds_read_b128 a[132:135], v2 offset:0
    v_cvt_pk_bf16_f32 v226, v168, v169
    v_mfma_f32_16x16x32_bf16 a[104:107], a[208:211], v[196:199], a[104:107]
    s_add_u32 s42, s42, s6
    v_exp_f32 v170, v170
    v_mfma_f32_16x16x32_bf16 a[104:107], a[212:215], v[200:203], a[104:107]
    s_lshl_b32 s42, s42, 7
    s_mov_b32 m0, s33
    s_nop 0
    buffer_load_dwordx4 v17, s[12:15], s29 offen offset:0 lds
    v_mfma_f32_16x16x32_bf16 a[108:111], a[212:215], v[208:211], a[108:111]
    s_cmp_lt_u32 s6, 216
    s_cselect_b32 s42, s42, 0x438000
    v_exp_f32 v171, v171
    v_mfma_f32_16x16x32_bf16 a[108:111], a[208:211], v[204:207], a[108:111]
    s_waitcnt lgkmcnt(6)
    s_add_u32 m0, s46, 122880
    s_mov_b32 s45, 245760
    buffer_load_dwordx4 v254, s[20:23], s45 offen sc1 lds
    v_mfma_f32_16x16x32_bf16 v[164:167], a[176:179], v[36:39], v[100:103]
    v_exp_f32 v172, v172
    v_mfma_f32_16x16x16_bf16 v[24:27], a[240:241], v[252:253], 0
    v_mfma_f32_16x16x16_bf16 v[28:31], a[242:243], v[252:253], 0
    s_nop 0
    s_add_u32 m0, s46, 123904
    s_mov_b32 s45, 246784
    buffer_load_dwordx4 v254, s[20:23], s45 offen sc1 lds
    v_mfma_f32_16x16x32_bf16 v[164:167], a[180:183], v[40:43], v[164:167]
    s_nop 0
    ds_read_b64_tr_b16 a[200:201], v6 offset:16384
    v_cvt_pk_bf16_f32 v227, v170, v171
    v_mfma_f32_16x16x32_bf16 v[164:167], a[184:187], v[44:47], v[164:167]
    s_nop 0
    v_exp_f32 v173, v173
    v_mfma_f32_16x16x32_bf16 v[164:167], a[188:191], v[48:51], v[164:167]
    s_nop 0
    ds_read_b64_tr_b16 a[202:203], v6 offset:20480
    v_mov_b32_dpp v24, v28 row_shr:8 row_mask:0xf bank_mask:0xc
    v_mfma_f32_16x16x32_bf16 v[168:171], a[188:191], v[64:67], v[104:107]
    v_exp_f32 v174, v174
    v_mfma_f32_16x16x32_bf16 v[168:171], a[184:187], v[60:63], v[168:171]
    ds_read_b128 a[136:139], v3 offset:0
    v_cvt_pk_bf16_f32 v234, v172, v173
    v_mfma_f32_16x16x32_bf16 v[168:171], a[180:183], v[56:59], v[168:171]
    v_exp_f32 v175, v175
    v_mfma_f32_16x16x32_bf16 v[168:171], a[176:179], v[52:55], v[168:171]
    ds_read_b64_tr_b16 a[204:205], v6 offset:40960
    v_mov_b32_dpp v25, v29 row_shr:8 row_mask:0xf bank_mask:0xc
    v_mfma_f32_16x16x32_bf16 a[112:115], a[216:219], v[180:183], a[112:115]
    v_exp_f32 v176, v176
    v_mfma_f32_16x16x32_bf16 a[112:115], a[220:223], v[184:187], a[112:115]
    ds_read_b64_tr_b16 a[206:207], v6 offset:45056
    v_cvt_pk_bf16_f32 v235, v174, v175
    v_mfma_f32_16x16x32_bf16 a[116:119], a[220:223], v[192:195], a[116:119]
    v_exp_f32 v177, v177
    v_mov_b32_dpp v26, v30 row_shr:8 row_mask:0xf bank_mask:0xc
    v_mfma_f32_16x16x32_bf16 a[116:119], a[216:219], v[188:191], a[116:119]
    ds_read_b128 a[140:143], v4 offset:0
    v_mov_b32_dpp v27, v31 row_shr:8 row_mask:0xf bank_mask:0xc
    v_mfma_f32_16x16x32_bf16 a[120:123], a[216:219], v[196:199], a[120:123]
    v_exp_f32 v178, v178
    v_mfma_f32_16x16x32_bf16 a[120:123], a[220:223], v[200:203], a[120:123]
    buffer_store_dwordx4 v[24:27], v23, s[16:19], s42 offen sc1
    v_cvt_pk_bf16_f32 v242, v176, v177
    v_mfma_f32_16x16x32_bf16 a[124:127], a[220:223], v[208:211], a[124:127]
    s_add_u32 s42, s42, 27648
    v_exp_f32 v179, v179
    v_mfma_f32_16x16x32_bf16 a[124:127], a[216:219], v[204:207], a[124:127]
    s_mov_b32 m0, s33
    s_nop 0
    buffer_load_dwordx4 v18, s[12:15], s29 offen offset:1024 lds
    v_smfmac_f32_16x16x64_bf16 a[236:239], v[244:247], v[204:211], v248
    s_waitcnt lgkmcnt(6)
    ds_read_b64_tr_b16 a[240:241], v22 offset:256
    ds_read_b64_tr_b16 a[242:243], v22 offset:288
    v_mfma_f32_16x16x32_bf16 v[172:175], a[176:179], v[68:71], v[108:111]
    v_exp_f32 v116, v116
    v_mfma_f32_16x16x16_bf16 v[32:35], a[244:245], v[252:253], 0
    v_mfma_f32_16x16x16_bf16 v[28:31], a[246:247], v[252:253], 0
    s_nop 0
    s_add_u32 m0, s46, 124928
    s_mov_b32 s45, 247808
    buffer_load_dwordx4 v254, s[20:23], s45 offen sc1 lds
    v_mfma_f32_16x16x32_bf16 v[172:175], a[180:183], v[72:75], v[172:175]
    s_nop 0
    ds_read_b64_tr_b16 a[208:209], v7 offset:16384
    v_cvt_pk_bf16_f32 v243, v178, v179
    v_mfma_f32_16x16x32_bf16 v[172:175], a[184:187], v[76:79], v[172:175]
    s_nop 0
    v_exp_f32 v117, v117
    v_mfma_f32_16x16x32_bf16 v[172:175], a[188:191], v[80:83], v[172:175]
    s_nop 0
    ds_read_b64_tr_b16 a[210:211], v7 offset:20480
    v_mov_b32_dpp v32, v28 row_shr:8 row_mask:0xf bank_mask:0xc
    v_mfma_f32_16x16x32_bf16 v[176:179], a[188:191], v[96:99], v[112:115]
    v_exp_f32 v118, v118
    v_mfma_f32_16x16x32_bf16 v[176:179], a[184:187], v[92:95], v[176:179]
    ds_read_b128 a[144:147], v1 offset:4096
    v_cvt_pk_bf16_f32 v180, v116, v117
    v_mfma_f32_16x16x32_bf16 v[176:179], a[180:183], v[88:91], v[176:179]
    v_exp_f32 v119, v119
    v_mfma_f32_16x16x32_bf16 v[176:179], a[176:179], v[84:87], v[176:179]
    ds_read_b64_tr_b16 a[212:213], v7 offset:40960
    v_mov_b32_dpp v33, v29 row_shr:8 row_mask:0xf bank_mask:0xc
    v_mfma_f32_16x16x32_bf16 a[0:3], a[192:195], v[212:215], a[0:3]
    v_exp_f32 v120, v120
    v_mfma_f32_16x16x32_bf16 a[0:3], a[196:199], v[216:219], a[0:3]
    ds_read_b64_tr_b16 a[214:215], v7 offset:45056
    v_cvt_pk_bf16_f32 v181, v118, v119
    v_mfma_f32_16x16x32_bf16 a[4:7], a[196:199], v[224:227], a[4:7]
    v_exp_f32 v121, v121
    v_mfma_f32_16x16x32_bf16 a[4:7], a[192:195], v[220:223], a[4:7]
    ds_read_b128 a[148:151], v2 offset:4096
    v_cvt_pk_bf16_f32 v188, v120, v121
    v_mov_b32_dpp v34, v30 row_shr:8 row_mask:0xf bank_mask:0xc
    v_mfma_f32_16x16x32_bf16 a[8:11], a[192:195], v[228:231], a[8:11]
    v_exp_f32 v122, v122
    v_mfma_f32_16x16x32_bf16 a[8:11], a[196:199], v[232:235], a[8:11]
    s_mov_b32 m0, s33
    s_nop 0
    buffer_load_dwordx4 v17, s[12:15], s29 offen offset:2048 lds
    v_mov_b32_dpp v35, v31 row_shr:8 row_mask:0xf bank_mask:0xc
    v_mfma_f32_16x16x32_bf16 a[12:15], a[196:199], v[240:243], a[12:15]
    buffer_store_dwordx4 v[32:35], v23, s[16:19], s42 offen sc1
    v_exp_f32 v123, v123
    v_mfma_f32_16x16x32_bf16 a[12:15], a[192:195], v[236:239], a[12:15]
    s_waitcnt lgkmcnt(6)
    s_add_u32 s42, s42, 27648
    s_add_u32 m0, s46, 125952
    s_mov_b32 s45, 248832
    buffer_load_dwordx4 v254, s[20:23], s45 offen sc1 lds
    v_mfma_f32_16x16x32_bf16 v[116:119], a[128:131], v[36:39], v[100:103]
    v_exp_f32 v124, v124
    v_mfma_f32_16x16x16_bf16 v[24:27], a[248:249], v[252:253], 0
    v_mfma_f32_16x16x16_bf16 v[28:31], a[250:251], v[252:253], 0
    s_nop 0
    s_add_u32 m0, s46, 126976
    s_mov_b32 s45, 249856
    buffer_load_dwordx4 v254, s[20:23], s45 offen sc1 lds
    v_mfma_f32_16x16x32_bf16 v[116:119], a[132:135], v[40:43], v[116:119]
    s_nop 0
    ds_read_b64_tr_b16 a[216:217], v8 offset:16384
    v_cvt_pk_bf16_f32 v189, v122, v123
    v_mfma_f32_16x16x32_bf16 v[116:119], a[136:139], v[44:47], v[116:119]
    s_nop 0
    v_exp_f32 v125, v125
    v_mfma_f32_16x16x32_bf16 v[116:119], a[140:143], v[48:51], v[116:119]
    s_nop 0
    ds_read_b64_tr_b16 a[218:219], v8 offset:20480
    v_mov_b32_dpp v24, v28 row_shr:8 row_mask:0xf bank_mask:0xc
    v_mfma_f32_16x16x32_bf16 v[120:123], a[140:143], v[64:67], v[104:107]
    v_exp_f32 v126, v126
    v_mfma_f32_16x16x32_bf16 v[120:123], a[136:139], v[60:63], v[120:123]
    ds_read_b128 a[152:155], v3 offset:4096
    v_cvt_pk_bf16_f32 v196, v124, v125
    v_mfma_f32_16x16x32_bf16 v[120:123], a[132:135], v[56:59], v[120:123]
    v_exp_f32 v127, v127
    v_mfma_f32_16x16x32_bf16 v[120:123], a[128:131], v[52:55], v[120:123]
    ds_read_b64_tr_b16 a[220:221], v8 offset:40960
    v_mov_b32_dpp v25, v29 row_shr:8 row_mask:0xf bank_mask:0xc
    v_mfma_f32_16x16x32_bf16 a[16:19], a[200:203], v[212:215], a[16:19]
    v_exp_f32 v128, v128
    v_mfma_f32_16x16x32_bf16 a[16:19], a[204:207], v[216:219], a[16:19]
    ds_read_b64_tr_b16 a[222:223], v8 offset:45056
    v_cvt_pk_bf16_f32 v197, v126, v127
    v_mfma_f32_16x16x32_bf16 a[20:23], a[204:207], v[224:227], a[20:23]
    v_exp_f32 v129, v129
    v_mfma_f32_16x16x32_bf16 a[20:23], a[200:203], v[220:223], a[20:23]
    ds_read_b128 a[156:159], v4 offset:4096
    v_mov_b32_dpp v26, v30 row_shr:8 row_mask:0xf bank_mask:0xc
    v_mfma_f32_16x16x32_bf16 a[24:27], a[200:203], v[228:231], a[24:27]
    v_exp_f32 v130, v130
    v_mfma_f32_16x16x32_bf16 a[24:27], a[204:207], v[232:235], a[24:27]
    v_cvt_pk_bf16_f32 v204, v128, v129
    v_mov_b32_dpp v27, v31 row_shr:8 row_mask:0xf bank_mask:0xc
    v_mfma_f32_16x16x32_bf16 a[28:31], a[204:207], v[240:243], a[28:31]
    v_exp_f32 v131, v131
    v_mfma_f32_16x16x32_bf16 a[28:31], a[200:203], v[236:239], a[28:31]
    s_mov_b32 m0, s33
    s_nop 0
    buffer_load_dwordx4 v18, s[12:15], s29 offen offset:3072 lds
    buffer_store_dwordx4 v[24:27], v23, s[16:19], s42 offen sc1
    v_smfmac_f32_16x16x64_bf16 a[224:227], v[244:247], v[212:219], v248
    s_waitcnt lgkmcnt(6)
    s_add_u32 s29, s29, 16384
    s_add_u32 s42, s42, 27648
    s_add_u32 m0, s46, 128000
    s_mov_b32 s45, 266240
    buffer_load_dwordx4 v254, s[20:23], s45 offen sc1 lds
    v_mfma_f32_16x16x32_bf16 v[124:127], a[128:131], v[68:71], v[108:111]
    v_exp_f32 v132, v132
    v_mfma_f32_16x16x16_bf16 v[32:35], a[252:253], v[252:253], 0
    v_mfma_f32_16x16x16_bf16 v[28:31], a[254:255], v[252:253], 0
    s_nop 0
    s_add_u32 m0, s46, 129024
    s_mov_b32 s45, 267264
    buffer_load_dwordx4 v254, s[20:23], s45 offen sc1 lds
    v_mfma_f32_16x16x32_bf16 v[124:127], a[132:135], v[72:75], v[124:127]
    s_nop 0
    ds_read_b64_tr_b16 a[192:193], v9 offset:16384
    v_cvt_pk_bf16_f32 v205, v130, v131
    v_mfma_f32_16x16x32_bf16 v[124:127], a[136:139], v[76:79], v[124:127]
    s_nop 0
    v_exp_f32 v133, v133
    v_mfma_f32_16x16x32_bf16 v[124:127], a[140:143], v[80:83], v[124:127]
    s_nop 0
    ds_read_b64_tr_b16 a[194:195], v9 offset:20480
    v_mov_b32_dpp v32, v28 row_shr:8 row_mask:0xf bank_mask:0xc
    v_mfma_f32_16x16x32_bf16 v[128:131], a[140:143], v[96:99], v[112:115]
    v_exp_f32 v134, v134
    v_mfma_f32_16x16x32_bf16 v[128:131], a[136:139], v[92:95], v[128:131]
    ds_read_b128 a[160:163], v1 offset:8192
    v_cvt_pk_bf16_f32 v182, v132, v133
    v_mfma_f32_16x16x32_bf16 v[128:131], a[132:135], v[88:91], v[128:131]
    v_exp_f32 v135, v135
    v_mfma_f32_16x16x32_bf16 v[128:131], a[128:131], v[84:87], v[128:131]
    ds_read_b64_tr_b16 a[196:197], v9 offset:40960
    v_mov_b32_dpp v33, v29 row_shr:8 row_mask:0xf bank_mask:0xc
    v_mfma_f32_16x16x32_bf16 a[32:35], a[208:211], v[212:215], a[32:35]
    v_exp_f32 v136, v136
    v_mfma_f32_16x16x32_bf16 a[32:35], a[212:215], v[216:219], a[32:35]
    ds_read_b64_tr_b16 a[198:199], v9 offset:45056
    v_cvt_pk_bf16_f32 v183, v134, v135
    v_mfma_f32_16x16x32_bf16 a[36:39], a[212:215], v[224:227], a[36:39]
    v_exp_f32 v137, v137
    v_mfma_f32_16x16x32_bf16 a[36:39], a[208:211], v[220:223], a[36:39]
    ds_read_b128 a[164:167], v2 offset:8192
    v_mov_b32_dpp v34, v30 row_shr:8 row_mask:0xf bank_mask:0xc
    v_mfma_f32_16x16x32_bf16 a[40:43], a[208:211], v[228:231], a[40:43]
    v_exp_f32 v138, v138
    v_mfma_f32_16x16x32_bf16 a[40:43], a[212:215], v[232:235], a[40:43]
    v_cvt_pk_bf16_f32 v190, v136, v137
    v_mov_b32_dpp v35, v31 row_shr:8 row_mask:0xf bank_mask:0xc
    v_mfma_f32_16x16x32_bf16 a[44:47], a[212:215], v[240:243], a[44:47]
    buffer_store_dwordx4 v[32:35], v23, s[16:19], s42 offen sc1
    v_exp_f32 v139, v139
    v_mfma_f32_16x16x32_bf16 a[44:47], a[208:211], v[236:239], a[44:47]
    s_waitcnt lgkmcnt(6)
    s_add_u32 s42, s42, 27648
    s_add_u32 m0, s46, 130048
    s_mov_b32 s45, 268288
    buffer_load_dwordx4 v254, s[20:23], s45 offen sc1 lds
    v_mfma_f32_16x16x32_bf16 v[132:135], a[144:147], v[36:39], v[100:103]
    v_exp_f32 v140, v140
    v_mfma_f32_16x16x16_bf16 v[24:27], a[240:241], v[252:253], 0
    v_mfma_f32_16x16x16_bf16 v[28:31], a[242:243], v[252:253], 0
    s_nop 0
    s_add_u32 m0, s46, 131072
    s_mov_b32 s45, 269312
    buffer_load_dwordx4 v254, s[20:23], s45 offen sc1 lds
    v_mfma_f32_16x16x32_bf16 v[132:135], a[148:151], v[40:43], v[132:135]
    s_nop 0
    ds_read_b64_tr_b16 a[200:201], v10 offset:16384
    v_cvt_pk_bf16_f32 v191, v138, v139
    v_mfma_f32_16x16x32_bf16 v[132:135], a[152:155], v[44:47], v[132:135]
    s_nop 0
    v_exp_f32 v141, v141
    v_mfma_f32_16x16x32_bf16 v[132:135], a[156:159], v[48:51], v[132:135]
    s_nop 0
    ds_read_b64_tr_b16 a[202:203], v10 offset:20480
    v_mov_b32_dpp v24, v28 row_shr:8 row_mask:0xf bank_mask:0xc
    v_mfma_f32_16x16x32_bf16 v[136:139], a[156:159], v[64:67], v[104:107]
    v_exp_f32 v142, v142
    v_mfma_f32_16x16x32_bf16 v[136:139], a[152:155], v[60:63], v[136:139]
    ds_read_b128 a[168:171], v3 offset:8192
    v_cvt_pk_bf16_f32 v198, v140, v141
    v_mfma_f32_16x16x32_bf16 v[136:139], a[148:151], v[56:59], v[136:139]
    v_exp_f32 v143, v143
    v_mfma_f32_16x16x32_bf16 v[136:139], a[144:147], v[52:55], v[136:139]
    ds_read_b64_tr_b16 a[204:205], v10 offset:40960
    v_mov_b32_dpp v25, v29 row_shr:8 row_mask:0xf bank_mask:0xc
    v_mfma_f32_16x16x32_bf16 a[48:51], a[216:219], v[212:215], a[48:51]
    v_exp_f32 v144, v144
    v_mfma_f32_16x16x32_bf16 a[48:51], a[220:223], v[216:219], a[48:51]
    ds_read_b64_tr_b16 a[206:207], v10 offset:45056
    v_cvt_pk_bf16_f32 v199, v142, v143
    v_mfma_f32_16x16x32_bf16 a[52:55], a[220:223], v[224:227], a[52:55]
    v_exp_f32 v145, v145
    v_mfma_f32_16x16x32_bf16 a[52:55], a[216:219], v[220:223], a[52:55]
    ds_read_b128 a[172:175], v4 offset:8192
    v_mov_b32_dpp v26, v30 row_shr:8 row_mask:0xf bank_mask:0xc
    v_mfma_f32_16x16x32_bf16 a[56:59], a[216:219], v[228:231], a[56:59]
    v_exp_f32 v146, v146
    v_mfma_f32_16x16x32_bf16 a[56:59], a[220:223], v[232:235], a[56:59]
    v_cvt_pk_bf16_f32 v206, v144, v145
    v_mov_b32_dpp v27, v31 row_shr:8 row_mask:0xf bank_mask:0xc
    v_mfma_f32_16x16x32_bf16 a[60:63], a[220:223], v[240:243], a[60:63]
    v_exp_f32 v147, v147
    v_mfma_f32_16x16x32_bf16 a[60:63], a[216:219], v[236:239], a[60:63]
    buffer_store_dwordx4 v[24:27], v23, s[16:19], s42 offen sc1
    v_smfmac_f32_16x16x64_bf16 a[228:231], v[244:247], v[220:227], v248
    s_waitcnt lgkmcnt(6)
    s_add_u32 s42, s42, 27648
    s_add_u32 m0, s46, 132096
    s_mov_b32 s45, 270336
    buffer_load_dwordx4 v254, s[20:23], s45 offen sc1 lds
    v_mfma_f32_16x16x32_bf16 v[140:143], a[144:147], v[68:71], v[108:111]
    v_exp_f32 v148, v148
    v_mfma_f32_16x16x32_bf16 v[140:143], a[148:151], v[72:75], v[140:143]
    ds_read_b64_tr_b16 a[208:209], v11 offset:16384
    v_cvt_pk_bf16_f32 v207, v146, v147
    v_mfma_f32_16x16x32_bf16 v[140:143], a[152:155], v[76:79], v[140:143]
    v_exp_f32 v149, v149
    v_mfma_f32_16x16x32_bf16 v[140:143], a[156:159], v[80:83], v[140:143]
    ds_read_b64_tr_b16 a[210:211], v11 offset:20480
    v_mfma_f32_16x16x32_bf16 v[144:147], a[156:159], v[96:99], v[112:115]
    v_exp_f32 v150, v150
    v_mfma_f32_16x16x32_bf16 v[144:147], a[152:155], v[92:95], v[144:147]
    ds_read_b128 a[176:179], v1 offset:12288
    v_cvt_pk_bf16_f32 v184, v148, v149
    v_mfma_f32_16x16x32_bf16 v[144:147], a[148:151], v[88:91], v[144:147]
    v_exp_f32 v151, v151
    v_mfma_f32_16x16x32_bf16 v[144:147], a[144:147], v[84:87], v[144:147]
    ds_read_b64_tr_b16 a[212:213], v11 offset:40960
    v_mfma_f32_16x16x32_bf16 a[64:67], a[192:195], v[212:215], a[64:67]
    v_exp_f32 v152, v152
    v_mfma_f32_16x16x32_bf16 a[64:67], a[196:199], v[216:219], a[64:67]
    ds_read_b64_tr_b16 a[214:215], v11 offset:45056
    v_cvt_pk_bf16_f32 v185, v150, v151
    v_mfma_f32_16x16x32_bf16 a[68:71], a[196:199], v[224:227], a[68:71]
    v_exp_f32 v153, v153
    v_mfma_f32_16x16x32_bf16 a[68:71], a[192:195], v[220:223], a[68:71]
    ds_read_b128 a[180:183], v2 offset:12288
    v_mfma_f32_16x16x32_bf16 a[72:75], a[192:195], v[228:231], a[72:75]
    v_exp_f32 v154, v154
    v_mfma_f32_16x16x32_bf16 a[72:75], a[196:199], v[232:235], a[72:75]
    v_cvt_pk_bf16_f32 v192, v152, v153
    v_mfma_f32_16x16x32_bf16 a[76:79], a[196:199], v[240:243], a[76:79]
    v_exp_f32 v155, v155
    v_mfma_f32_16x16x32_bf16 a[76:79], a[192:195], v[236:239], a[76:79]
    s_waitcnt lgkmcnt(6)
    v_mfma_f32_16x16x32_bf16 v[148:151], a[160:163], v[36:39], v[100:103]
    v_exp_f32 v156, v156
    v_mfma_f32_16x16x32_bf16 v[148:151], a[164:167], v[40:43], v[148:151]
    ds_read_b64_tr_b16 a[216:217], v12 offset:16384
    v_cvt_pk_bf16_f32 v193, v154, v155
    v_mfma_f32_16x16x32_bf16 v[148:151], a[168:171], v[44:47], v[148:151]
    v_exp_f32 v157, v157
    v_mfma_f32_16x16x32_bf16 v[148:151], a[172:175], v[48:51], v[148:151]
    ds_read_b64_tr_b16 a[218:219], v12 offset:20480
    v_mfma_f32_16x16x32_bf16 v[152:155], a[172:175], v[64:67], v[104:107]
    v_exp_f32 v158, v158
    v_mfma_f32_16x16x32_bf16 v[152:155], a[168:171], v[60:63], v[152:155]
    ds_read_b128 a[184:187], v3 offset:12288
    v_cvt_pk_bf16_f32 v200, v156, v157
    v_mfma_f32_16x16x32_bf16 v[152:155], a[164:167], v[56:59], v[152:155]
    v_exp_f32 v159, v159
    v_mfma_f32_16x16x32_bf16 v[152:155], a[160:163], v[52:55], v[152:155]
    ds_read_b64_tr_b16 a[220:221], v12 offset:40960
    v_mfma_f32_16x16x32_bf16 a[80:83], a[200:203], v[212:215], a[80:83]
    v_exp_f32 v160, v160
    v_mfma_f32_16x16x32_bf16 a[80:83], a[204:207], v[216:219], a[80:83]
    ds_read_b64_tr_b16 a[222:223], v12 offset:45056
    v_cvt_pk_bf16_f32 v201, v158, v159
    v_mfma_f32_16x16x32_bf16 a[84:87], a[204:207], v[224:227], a[84:87]
    v_exp_f32 v161, v161
    v_mfma_f32_16x16x32_bf16 a[84:87], a[200:203], v[220:223], a[84:87]
    ds_read_b128 a[188:191], v4 offset:12288
    v_mfma_f32_16x16x32_bf16 a[88:91], a[200:203], v[228:231], a[88:91]
    v_exp_f32 v162, v162
    v_mfma_f32_16x16x32_bf16 a[88:91], a[204:207], v[232:235], a[88:91]
    v_cvt_pk_bf16_f32 v208, v160, v161
    v_mfma_f32_16x16x32_bf16 a[92:95], a[204:207], v[240:243], a[92:95]
    v_exp_f32 v163, v163
    v_mfma_f32_16x16x32_bf16 a[92:95], a[200:203], v[236:239], a[92:95]
    v_smfmac_f32_16x16x64_bf16 a[232:235], v[244:247], v[228:235], v248
    s_waitcnt vmcnt(19) lgkmcnt(0)
    s_barrier
    v_mfma_f32_16x16x32_bf16 v[156:159], a[160:163], v[68:71], v[108:111]
    v_exp_f32 v164, v164
    v_mfma_f32_16x16x32_bf16 v[156:159], a[164:167], v[72:75], v[156:159]
    ds_read_b64_tr_b16 a[192:193], v5 offset:57344
    v_cvt_pk_bf16_f32 v209, v162, v163
    v_mfma_f32_16x16x32_bf16 v[156:159], a[168:171], v[76:79], v[156:159]
    v_exp_f32 v165, v165
    v_mfma_f32_16x16x32_bf16 v[156:159], a[172:175], v[80:83], v[156:159]
    ds_read_b64_tr_b16 a[194:195], v5 offset:61440
    v_mfma_f32_16x16x32_bf16 v[160:163], a[172:175], v[96:99], v[112:115]
    v_exp_f32 v166, v166
    v_mfma_f32_16x16x32_bf16 v[160:163], a[168:171], v[92:95], v[160:163]
    ds_read_b64_tr_b16 a[196:197], v5 offset:0
    v_cvt_pk_bf16_f32 v186, v164, v165
    v_mfma_f32_16x16x32_bf16 v[160:163], a[164:167], v[88:91], v[160:163]
    s_add_u32 m0, s46, 81920
    s_mov_b32 s45, 286720
    buffer_load_dwordx4 v254, s[20:23], s45 offen sc1 lds
    v_exp_f32 v167, v167
    v_mfma_f32_16x16x32_bf16 v[160:163], a[160:163], v[84:87], v[160:163]
    ds_read_b64_tr_b16 a[198:199], v5 offset:4096
    v_mfma_f32_16x16x32_bf16 a[96:99], a[208:211], v[212:215], a[96:99]
    v_exp_f32 v168, v168
    v_mfma_f32_16x16x32_bf16 a[96:99], a[212:215], v[216:219], a[96:99]
    v_cvt_pk_bf16_f32 v187, v166, v167
    v_mfma_f32_16x16x32_bf16 a[100:103], a[212:215], v[224:227], a[100:103]
    v_exp_f32 v169, v169
    v_mfma_f32_16x16x32_bf16 a[100:103], a[208:211], v[220:223], a[100:103]
    s_add_u32 m0, s46, 82944
    s_mov_b32 s45, 287744
    buffer_load_dwordx4 v254, s[20:23], s45 offen sc1 lds
    v_mfma_f32_16x16x32_bf16 a[104:107], a[208:211], v[228:231], a[104:107]
    v_exp_f32 v170, v170
    v_mfma_f32_16x16x32_bf16 a[104:107], a[212:215], v[232:235], a[104:107]
    v_cvt_pk_bf16_f32 v194, v168, v169
    v_mfma_f32_16x16x32_bf16 a[108:111], a[212:215], v[240:243], a[108:111]
    v_exp_f32 v171, v171
    v_mfma_f32_16x16x32_bf16 a[108:111], a[208:211], v[236:239], a[108:111]
    s_waitcnt lgkmcnt(4)
    s_add_u32 m0, s46, 83968
    s_mov_b32 s45, 288768
    buffer_load_dwordx4 v254, s[20:23], s45 offen sc1 lds
    v_mfma_f32_16x16x32_bf16 v[164:167], a[176:179], v[36:39], v[100:103]
    v_exp_f32 v172, v172
    v_mfma_f32_16x16x32_bf16 v[164:167], a[180:183], v[40:43], v[164:167]
    ds_read_b64_tr_b16 a[200:201], v6 offset:57344
    v_cvt_pk_bf16_f32 v195, v170, v171
    v_mfma_f32_16x16x32_bf16 v[164:167], a[184:187], v[44:47], v[164:167]
    v_exp_f32 v173, v173
    v_mfma_f32_16x16x32_bf16 v[164:167], a[188:191], v[48:51], v[164:167]
    ds_read_b64_tr_b16 a[202:203], v6 offset:61440
    v_mfma_f32_16x16x32_bf16 v[168:171], a[188:191], v[64:67], v[104:107]
    v_exp_f32 v174, v174
    v_mfma_f32_16x16x32_bf16 v[168:171], a[184:187], v[60:63], v[168:171]
    ds_read_b64_tr_b16 a[204:205], v6 offset:0
    v_cvt_pk_bf16_f32 v202, v172, v173
    v_mfma_f32_16x16x32_bf16 v[168:171], a[180:183], v[56:59], v[168:171]
    v_exp_f32 v175, v175
    v_mfma_f32_16x16x32_bf16 v[168:171], a[176:179], v[52:55], v[168:171]
    ds_read_b64_tr_b16 a[206:207], v6 offset:4096
    v_mfma_f32_16x16x32_bf16 a[112:115], a[216:219], v[212:215], a[112:115]
    v_exp_f32 v176, v176
    v_mfma_f32_16x16x32_bf16 a[112:115], a[220:223], v[216:219], a[112:115]
    v_cvt_pk_bf16_f32 v203, v174, v175
    v_mfma_f32_16x16x32_bf16 a[116:119], a[220:223], v[224:227], a[116:119]
    s_add_u32 m0, s46, 84992
    s_mov_b32 s45, 289792
    buffer_load_dwordx4 v254, s[20:23], s45 offen sc1 lds
    v_exp_f32 v177, v177
    v_mfma_f32_16x16x32_bf16 a[116:119], a[216:219], v[220:223], a[116:119]
    s_add_u32 m0, s46, 86016
    s_mov_b32 s45, 290816
    buffer_load_dwordx4 v254, s[20:23], s45 offen sc1 lds
    v_mfma_f32_16x16x32_bf16 a[120:123], a[216:219], v[228:231], a[120:123]
    v_exp_f32 v178, v178
    v_mfma_f32_16x16x32_bf16 a[120:123], a[220:223], v[232:235], a[120:123]
    v_cvt_pk_bf16_f32 v210, v176, v177
    v_mfma_f32_16x16x32_bf16 a[124:127], a[220:223], v[240:243], a[124:127]
    v_exp_f32 v179, v179
    v_mfma_f32_16x16x32_bf16 a[124:127], a[216:219], v[236:239], a[124:127]
    v_smfmac_f32_16x16x64_bf16 a[236:239], v[244:247], v[236:243], v248
    s_waitcnt lgkmcnt(4)
    v_mfma_f32_16x16x32_bf16 v[172:175], a[176:179], v[68:71], v[108:111]
    v_exp_f32 v116, v116
    v_mfma_f32_16x16x32_bf16 v[172:175], a[180:183], v[72:75], v[172:175]
    ds_read_b64_tr_b16 a[208:209], v7 offset:57344
    v_cvt_pk_bf16_f32 v211, v178, v179
    v_mfma_f32_16x16x32_bf16 v[172:175], a[184:187], v[76:79], v[172:175]
    v_exp_f32 v117, v117
    v_mfma_f32_16x16x32_bf16 v[172:175], a[188:191], v[80:83], v[172:175]
    ds_read_b64_tr_b16 a[210:211], v7 offset:61440
    v_mfma_f32_16x16x32_bf16 v[176:179], a[188:191], v[96:99], v[112:115]
    v_exp_f32 v118, v118
    v_mfma_f32_16x16x32_bf16 v[176:179], a[184:187], v[92:95], v[176:179]
    ds_read_b64_tr_b16 a[212:213], v7 offset:0
    v_cvt_pk_bf16_f32 v212, v116, v117
    v_mfma_f32_16x16x32_bf16 v[176:179], a[180:183], v[88:91], v[176:179]
    v_exp_f32 v119, v119
    v_mfma_f32_16x16x32_bf16 v[176:179], a[176:179], v[84:87], v[176:179]
    ds_read_b64_tr_b16 a[214:215], v7 offset:4096
    v_mfma_f32_16x16x32_bf16 a[0:3], a[192:195], v[180:183], a[0:3]
    v_exp_f32 v120, v120
    v_mfma_f32_16x16x32_bf16 a[0:3], a[196:199], v[184:187], a[0:3]
    s_add_u32 m0, s46, 87040
    s_mov_b32 s45, 307200
    buffer_load_dwordx4 v254, s[20:23], s45 offen sc1 lds
    v_cvt_pk_bf16_f32 v213, v118, v119
    v_mfma_f32_16x16x32_bf16 a[4:7], a[196:199], v[192:195], a[4:7]
    v_exp_f32 v121, v121
    v_mfma_f32_16x16x32_bf16 a[4:7], a[192:195], v[188:191], a[4:7]
    s_add_u32 m0, s46, 88064
    s_mov_b32 s45, 308224
    buffer_load_dwordx4 v254, s[20:23], s45 offen sc1 lds
    v_mfma_f32_16x16x32_bf16 a[8:11], a[192:195], v[196:199], a[8:11]
    v_exp_f32 v122, v122
    v_mfma_f32_16x16x32_bf16 a[8:11], a[196:199], v[200:203], a[8:11]
    v_cvt_pk_bf16_f32 v220, v120, v121
    v_mfma_f32_16x16x32_bf16 a[12:15], a[196:199], v[208:211], a[12:15]
    v_exp_f32 v123, v123
    v_mfma_f32_16x16x32_bf16 a[12:15], a[192:195], v[204:207], a[12:15]
    s_waitcnt lgkmcnt(4)
    s_add_u32 m0, s46, 89088
    s_mov_b32 s45, 309248
    buffer_load_dwordx4 v254, s[20:23], s45 offen sc1 lds
    v_mfma_f32_16x16x32_bf16 a[16:19], a[200:203], v[180:183], a[16:19]
    ds_read_b64_tr_b16 a[216:217], v8 offset:57344
    v_cvt_pk_bf16_f32 v221, v122, v123
    v_exp_f32 v124, v124
    v_mfma_f32_16x16x32_bf16 a[16:19], a[204:207], v[184:187], a[16:19]
    ds_read_b64_tr_b16 a[218:219], v8 offset:61440
    v_exp_f32 v125, v125
    v_mfma_f32_16x16x32_bf16 a[20:23], a[204:207], v[192:195], a[20:23]
    ds_read_b64_tr_b16 a[220:221], v8 offset:0
    v_cvt_pk_bf16_f32 v228, v124, v125
    v_exp_f32 v126, v126
    v_mov_b32 v114, v254
    v_mfma_f32_16x16x32_bf16 a[20:23], a[200:203], v[188:191], a[20:23]
    ds_read_b64_tr_b16 a[222:223], v8 offset:4096
    v_exp_f32 v127, v127
    v_mfma_f32_16x16x32_bf16 a[24:27], a[200:203], v[196:199], a[24:27]
    v_cvt_pk_bf16_f32 v229, v126, v127
    v_exp_f32 v128, v128
    v_mfma_f32_16x16x32_bf16 a[24:27], a[204:207], v[200:203], a[24:27]
    v_exp_f32 v129, v129
    v_add_u32 v115, 4096, v254
    v_mfma_f32_16x16x32_bf16 a[28:31], a[204:207], v[208:211], a[28:31]
    v_cvt_pk_bf16_f32 v236, v128, v129
    v_exp_f32 v130, v130
    v_mfma_f32_16x16x32_bf16 a[28:31], a[200:203], v[204:207], a[28:31]
    v_exp_f32 v131, v131
    v_smfmac_f32_16x16x64_bf16 a[224:227], v[244:247], v[180:187], v248
    s_waitcnt lgkmcnt(4)
    s_add_u32 m0, s46, 90112
    s_mov_b32 s45, 310272
    buffer_load_dwordx4 v254, s[20:23], s45 offen sc1 lds
    v_mov_b32 v0, 2
    v_mfma_f32_16x16x32_bf16 a[32:35], a[208:211], v[180:183], a[32:35]
    ds_read_b64_tr_b16 a[192:193], v9 offset:57344
    v_cvt_pk_bf16_f32 v237, v130, v131
    v_exp_f32 v132, v132
    v_mfma_f32_16x16x32_bf16 a[32:35], a[212:215], v[184:187], a[32:35]
    ds_read_b64_tr_b16 a[194:195], v9 offset:61440
    v_exp_f32 v133, v133
    v_mfma_f32_16x16x32_bf16 a[36:39], a[212:215], v[192:195], a[36:39]
    ds_read_b64_tr_b16 a[196:197], v9 offset:0
    v_cvt_pk_bf16_f32 v214, v132, v133
    v_exp_f32 v134, v134
    v_mfma_f32_16x16x32_bf16 a[36:39], a[208:211], v[188:191], a[36:39]
    ds_read_b64_tr_b16 a[198:199], v9 offset:4096
    v_exp_f32 v135, v135
    v_mfma_f32_16x16x32_bf16 a[40:43], a[208:211], v[196:199], a[40:43]
    v_cvt_pk_bf16_f32 v215, v134, v135
    v_exp_f32 v136, v136
    v_mfma_f32_16x16x32_bf16 a[40:43], a[212:215], v[200:203], a[40:43]
    v_exp_f32 v137, v137
    v_mfma_f32_16x16x32_bf16 a[44:47], a[212:215], v[208:211], a[44:47]
    v_cvt_pk_bf16_f32 v222, v136, v137
    v_exp_f32 v138, v138
    v_mfma_f32_16x16x32_bf16 a[44:47], a[208:211], v[204:207], a[44:47]
    s_waitcnt lgkmcnt(4)
    s_add_u32 m0, s46, 91136
    s_mov_b32 s45, 311296
    buffer_load_dwordx4 v254, s[20:23], s45 offen sc1 lds
    v_exp_f32 v139, v139
    v_mfma_f32_16x16x32_bf16 a[48:51], a[216:219], v[180:183], a[48:51]
    s_mov_b32 s45, 0
    ds_read_b64_tr_b16 a[200:201], v10 offset:57344
    v_cvt_pk_bf16_f32 v223, v138, v139
    v_exp_f32 v140, v140
    v_mfma_f32_16x16x32_bf16 a[48:51], a[220:223], v[184:187], a[48:51]
    ds_read_b64_tr_b16 a[202:203], v10 offset:61440
    v_exp_f32 v141, v141
    v_mfma_f32_16x16x32_bf16 a[52:55], a[220:223], v[192:195], a[52:55]
    ds_read_b64_tr_b16 a[204:205], v10 offset:0
    buffer_load_dwordx4 a[128:131], v114, s[20:23], s45 offen offset:0 sc1
    v_cvt_pk_bf16_f32 v230, v140, v141
    v_exp_f32 v142, v142
    v_mfma_f32_16x16x32_bf16 a[52:55], a[216:219], v[188:191], a[52:55]
    s_mov_b32 s45, 0
    ds_read_b64_tr_b16 a[206:207], v10 offset:4096
    v_exp_f32 v143, v143
    v_mfma_f32_16x16x32_bf16 a[56:59], a[216:219], v[196:199], a[56:59]
    v_cvt_pk_bf16_f32 v231, v142, v143
    v_exp_f32 v144, v144
    v_mfma_f32_16x16x32_bf16 a[56:59], a[220:223], v[200:203], a[56:59]
    buffer_load_dwordx4 a[132:135], v114, s[20:23], s45 offen offset:1024 sc1
    v_exp_f32 v145, v145
    v_mfma_f32_16x16x32_bf16 a[60:63], a[220:223], v[208:211], a[60:63]
    s_mov_b32 s45, 0
    v_cvt_pk_bf16_f32 v238, v144, v145
    v_exp_f32 v146, v146
    v_mfma_f32_16x16x32_bf16 a[60:63], a[216:219], v[204:207], a[60:63]
    v_exp_f32 v147, v147
    v_smfmac_f32_16x16x64_bf16 a[228:231], v[244:247], v[188:195], v248
    s_waitcnt lgkmcnt(4)
    buffer_load_dwordx4 a[136:139], v114, s[20:23], s45 offen offset:2048 sc1
    v_mfma_f32_16x16x32_bf16 a[64:67], a[192:195], v[180:183], a[64:67]
    s_mov_b32 s45, 0
    ds_read_b64_tr_b16 a[208:209], v11 offset:57344
    v_cvt_pk_bf16_f32 v239, v146, v147
    v_exp_f32 v148, v148
    v_mfma_f32_16x16x32_bf16 a[64:67], a[196:199], v[184:187], a[64:67]
    ds_read_b64_tr_b16 a[210:211], v11 offset:61440
    buffer_load_dwordx4 a[140:143], v114, s[20:23], s45 offen offset:3072 sc1
    v_exp_f32 v149, v149
    v_mfma_f32_16x16x32_bf16 a[68:71], a[196:199], v[192:195], a[68:71]
    s_mov_b32 s45, 0
    ds_read_b64_tr_b16 a[212:213], v11 offset:0
    v_cvt_pk_bf16_f32 v216, v148, v149
    v_exp_f32 v150, v150
    v_mfma_f32_16x16x32_bf16 a[68:71], a[192:195], v[188:191], a[68:71]
    ds_read_b64_tr_b16 a[214:215], v11 offset:4096
    v_exp_f32 v151, v151
    v_mfma_f32_16x16x32_bf16 a[72:75], a[192:195], v[196:199], a[72:75]
    buffer_load_dwordx4 a[144:147], v115, s[20:23], s45 offen offset:0 sc1
    v_cvt_pk_bf16_f32 v217, v150, v151
    v_exp_f32 v152, v152
    v_mfma_f32_16x16x32_bf16 a[72:75], a[196:199], v[200:203], a[72:75]
    s_mov_b32 s45, 20480
    v_exp_f32 v153, v153
    v_mfma_f32_16x16x32_bf16 a[76:79], a[196:199], v[208:211], a[76:79]
    buffer_load_dwordx4 a[148:151], v114, s[20:23], s45 offen offset:0 sc1
    v_cvt_pk_bf16_f32 v224, v152, v153
    v_exp_f32 v154, v154
    v_mfma_f32_16x16x32_bf16 a[76:79], a[192:195], v[204:207], a[76:79]
    s_waitcnt lgkmcnt(4)
    v_exp_f32 v155, v155
    v_mfma_f32_16x16x32_bf16 a[80:83], a[200:203], v[180:183], a[80:83]
    s_mov_b32 s45, 20480
    ds_read_b64_tr_b16 a[216:217], v12 offset:57344
    v_cvt_pk_bf16_f32 v225, v154, v155
    v_exp_f32 v156, v156
    v_mfma_f32_16x16x32_bf16 a[80:83], a[204:207], v[184:187], a[80:83]
    ds_read_b64_tr_b16 a[218:219], v12 offset:61440
    buffer_load_dwordx4 a[152:155], v114, s[20:23], s45 offen offset:1024 sc1
    v_exp_f32 v157, v157
    v_mfma_f32_16x16x32_bf16 a[84:87], a[204:207], v[192:195], a[84:87]
    s_mov_b32 s45, 20480
    ds_read_b64_tr_b16 a[220:221], v12 offset:0
    v_cvt_pk_bf16_f32 v232, v156, v157
    v_exp_f32 v158, v158
    v_mfma_f32_16x16x32_bf16 a[84:87], a[200:203], v[188:191], a[84:87]
    ds_read_b64_tr_b16 a[222:223], v12 offset:4096
    v_exp_f32 v159, v159
    v_mfma_f32_16x16x32_bf16 a[88:91], a[200:203], v[196:199], a[88:91]
    buffer_load_dwordx4 a[156:159], v114, s[20:23], s45 offen offset:2048 sc1
    v_cvt_pk_bf16_f32 v233, v158, v159
    v_exp_f32 v160, v160
    v_mfma_f32_16x16x32_bf16 a[88:91], a[204:207], v[200:203], a[88:91]
    s_mov_b32 s45, 20480
    v_exp_f32 v161, v161
    v_mfma_f32_16x16x32_bf16 a[92:95], a[204:207], v[208:211], a[92:95]
    v_cvt_pk_bf16_f32 v240, v160, v161
    v_exp_f32 v162, v162
    v_mfma_f32_16x16x32_bf16 a[92:95], a[200:203], v[204:207], a[92:95]
    buffer_load_dwordx4 a[160:163], v114, s[20:23], s45 offen offset:3072 sc1
    v_exp_f32 v163, v163
    v_smfmac_f32_16x16x64_bf16 a[232:235], v[244:247], v[196:203], v248
    s_waitcnt vmcnt(20) lgkmcnt(0)
    s_barrier
    v_mfma_f32_16x16x32_bf16 a[96:99], a[208:211], v[180:183], a[96:99]
    s_mov_b32 s45, 20480
    ds_read_b64_tr_b16 a[192:193], v5 offset:24576
    buffer_load_dwordx4 a[164:167], v115, s[20:23], s45 offen offset:0 sc1
    v_cvt_pk_bf16_f32 v241, v162, v163
    v_exp_f32 v164, v164
    v_mfma_f32_16x16x32_bf16 a[96:99], a[212:215], v[184:187], a[96:99]
    s_mov_b32 s45, 40960
    ds_read_b64_tr_b16 a[194:195], v5 offset:28672
    v_exp_f32 v165, v165
    v_mfma_f32_16x16x32_bf16 a[100:103], a[212:215], v[192:195], a[100:103]
    ds_read_b64_tr_b16 a[196:197], v5 offset:49152
    v_cvt_pk_bf16_f32 v218, v164, v165
    v_exp_f32 v166, v166
    v_mfma_f32_16x16x32_bf16 a[100:103], a[208:211], v[188:191], a[100:103]
    ds_read_b64_tr_b16 a[198:199], v5 offset:53248
    buffer_load_dwordx4 a[168:171], v114, s[20:23], s45 offen offset:0 sc1
    v_exp_f32 v167, v167
    v_mfma_f32_16x16x32_bf16 a[104:107], a[208:211], v[196:199], a[104:107]
    s_mov_b32 s45, 40960
    v_cvt_pk_bf16_f32 v219, v166, v167
    v_exp_f32 v168, v168
    v_mfma_f32_16x16x32_bf16 a[104:107], a[212:215], v[200:203], a[104:107]
    buffer_load_dwordx4 a[172:175], v114, s[20:23], s45 offen offset:1024 sc1
    v_exp_f32 v169, v169
    v_mfma_f32_16x16x32_bf16 a[108:111], a[212:215], v[208:211], a[108:111]
    s_mov_b32 s45, 40960
    v_cvt_pk_bf16_f32 v226, v168, v169
    v_exp_f32 v170, v170
    v_mfma_f32_16x16x32_bf16 a[108:111], a[208:211], v[204:207], a[108:111]
    s_waitcnt lgkmcnt(4)
    s_cmp_lg_u32 s5, 0
    s_cbranch_scc1 L_ffn_flagged
    s_mov_b64 exec, 1
    buffer_store_dword v0, off, s[76:79], s75 sc1
    s_mov_b64 exec, -1
L_ffn_flagged:
    v_exp_f32 v171, v171
    v_mfma_f32_16x16x32_bf16 a[112:115], a[216:219], v[180:183], a[112:115]
    ds_read_b64_tr_b16 a[200:201], v6 offset:24576
    buffer_load_dwordx4 a[176:179], v114, s[20:23], s45 offen offset:2048 sc1
    v_cvt_pk_bf16_f32 v227, v170, v171
    v_exp_f32 v172, v172
    v_mfma_f32_16x16x32_bf16 a[112:115], a[220:223], v[184:187], a[112:115]
    s_mov_b32 s45, 40960
    ds_read_b64_tr_b16 a[202:203], v6 offset:28672
    v_exp_f32 v173, v173
    v_mfma_f32_16x16x32_bf16 a[116:119], a[220:223], v[192:195], a[116:119]
    ds_read_b64_tr_b16 a[204:205], v6 offset:49152
    v_cvt_pk_bf16_f32 v234, v172, v173
    v_exp_f32 v174, v174
    v_mfma_f32_16x16x32_bf16 a[116:119], a[216:219], v[188:191], a[116:119]
    ds_read_b64_tr_b16 a[206:207], v6 offset:53248
    buffer_load_dwordx4 a[180:183], v114, s[20:23], s45 offen offset:3072 sc1
    v_exp_f32 v175, v175
    v_mfma_f32_16x16x32_bf16 a[120:123], a[216:219], v[196:199], a[120:123]
    s_mov_b32 s45, 40960
    v_cvt_pk_bf16_f32 v235, v174, v175
    v_exp_f32 v176, v176
    v_mfma_f32_16x16x32_bf16 a[120:123], a[220:223], v[200:203], a[120:123]
    v_exp_f32 v177, v177
    v_mfma_f32_16x16x32_bf16 a[124:127], a[220:223], v[208:211], a[124:127]
    buffer_load_dwordx4 a[184:187], v115, s[20:23], s45 offen offset:0 sc1
    v_cvt_pk_bf16_f32 v242, v176, v177
    v_exp_f32 v178, v178
    v_mfma_f32_16x16x32_bf16 a[124:127], a[216:219], v[204:207], a[124:127]
    s_mov_b32 s45, 61440
    v_exp_f32 v179, v179
    v_smfmac_f32_16x16x64_bf16 a[236:239], v[244:247], v[204:211], v248
    s_waitcnt lgkmcnt(4)
    buffer_load_dwordx4 a[188:191], v114, s[20:23], s45 offen offset:0 sc1
    v_mfma_f32_16x16x32_bf16 a[0:3], a[192:195], v[212:215], a[0:3]
    s_lshl_b32 s40, s87, 2
    ds_read_b64_tr_b16 a[208:209], v7 offset:24576
    v_cvt_pk_bf16_f32 v243, v178, v179
    v_mfma_f32_16x16x32_bf16 a[0:3], a[196:199], v[216:219], a[0:3]
    s_add_u32 s40, s40, s5
    ds_read_b64_tr_b16 a[210:211], v7 offset:28672
    v_smfmac_f32_16x16x64_bf16 a[224:227], v[244:247], v[212:219], v248
    s_lshl_b32 s40, s40, 4
    ds_read_b64_tr_b16 a[212:213], v7 offset:49152
    v_and_b32 v35, 15, v19
    v_smfmac_f32_16x16x64_bf16 a[228:231], v[244:247], v[220:227], v248
    ds_read_b64_tr_b16 a[214:215], v7 offset:53248
    v_add_u32 v35, s40, v35
    v_smfmac_f32_16x16x64_bf16 a[232:235], v[244:247], v[228:235], v248
    v_mul_u32_u24 v34, 1280, v35
    v_lshrrev_b32 v116, 4, v19
    v_smfmac_f32_16x16x64_bf16 a[236:239], v[244:247], v[236:243], v248
    v_lshl_add_u32 v34, v116, 3, v34
    v_mfma_f32_16x16x32_bf16 a[4:7], a[196:199], v[224:227], a[4:7]
    s_mul_i32 s40, s100, 160
    v_add_u32 v34, s40, v34
    v_lshlrev_b32 v116, 4, v35
    v_mfma_f32_16x16x32_bf16 a[4:7], a[192:195], v[220:223], a[4:7]
    s_mov_b32 s40, 0x280000
    buffer_load_dwordx2 v[32:33], v116, s[76:79], s40 offen sc1
    v_mfma_f32_16x16x32_bf16 a[8:11], a[192:195], v[228:231], a[8:11]
    buffer_load_dwordx2 v[22:23], v34, s[88:91], 0 offen offset:0
    v_mfma_f32_16x16x32_bf16 a[8:11], a[196:199], v[232:235], a[8:11]
    buffer_load_dwordx2 v[24:25], v34, s[88:91], 0 offen offset:32
    v_mfma_f32_16x16x32_bf16 a[12:15], a[196:199], v[240:243], a[12:15]
    buffer_load_dwordx2 v[26:27], v34, s[88:91], 0 offen offset:64
    v_mfma_f32_16x16x32_bf16 a[12:15], a[192:195], v[236:239], a[12:15]
    s_waitcnt lgkmcnt(4)
    buffer_load_dwordx2 v[28:29], v34, s[88:91], 0 offen offset:96
    v_mfma_f32_16x16x32_bf16 a[16:19], a[200:203], v[212:215], a[16:19]
    ds_read_b64_tr_b16 a[216:217], v8 offset:24576
    v_accvgpr_read_b32 v100, a224
    v_mfma_f32_16x16x32_bf16 a[16:19], a[204:207], v[216:219], a[16:19]
    ds_read_b64_tr_b16 a[218:219], v8 offset:28672
    v_accvgpr_read_b32 v104, a225
    v_accvgpr_read_b32 v101, a228
    v_accvgpr_read_b32 v105, a229
    v_mfma_f32_16x16x32_bf16 a[20:23], a[204:207], v[224:227], a[20:23]
    ds_read_b64_tr_b16 a[220:221], v8 offset:49152
    v_accvgpr_read_b32 v102, a232
    v_accvgpr_read_b32 v106, a233
    v_mfma_f32_16x16x32_bf16 a[20:23], a[200:203], v[220:223], a[20:23]
    ds_read_b64_tr_b16 a[222:223], v8 offset:53248
    v_accvgpr_read_b32 v103, a236
    v_accvgpr_read_b32 v107, a237
    v_add_f32 v100, v100, v104
    v_mfma_f32_16x16x32_bf16 a[24:27], a[200:203], v[228:231], a[24:27]
    buffer_load_dwordx2 v[30:31], v34, s[88:91], 0 offen offset:128
    v_add_f32 v101, v101, v105
    v_add_f32 v102, v102, v106
    v_add_f32 v103, v103, v107
    v_mfma_f32_16x16x32_bf16 a[24:27], a[204:207], v[232:235], a[24:27]
    v_lshlrev_b32 v20, 7, v19
    v_add_u32 v20, 0x290000, v20
    v_maximum3_f32 v108, v100, v101, v102
    v_maximum3_f32 v108, v108, v103, v103
    v_mfma_f32_16x16x32_bf16 a[28:31], a[204:207], v[240:243], a[28:31]
    buffer_load_dwordx4 v[252:255], v20, s[76:79], 0 offen sc1
    v_mul_f32 v108, 0x4d800000, v108
    v_mov_b32 v109, 0
    v_lshlrev_b32 v110, 4, v19
    v_mfma_f32_16x16x32_bf16 a[28:31], a[200:203], v[236:239], a[28:31]
    s_waitcnt lgkmcnt(4)
    v_rcp_f32 v100, v100
    v_rcp_f32 v101, v101
    v_rcp_f32 v102, v102
    v_rcp_f32 v103, v103
    v_mfma_f32_16x16x32_bf16 a[32:35], a[208:211], v[212:215], a[32:35]
    s_mov_b32 s36, 0
    ds_read_b64_tr_b16 a[192:193], v9 offset:24576
    v_accvgpr_read_b32 v120, a0
    v_accvgpr_read_b32 v121, a1
    v_accvgpr_read_b32 v122, a2
    v_accvgpr_read_b32 v123, a3
    v_mfma_f32_16x16x32_bf16 a[32:35], a[212:215], v[216:219], a[32:35]
    ds_read_b64_tr_b16 a[194:195], v9 offset:28672
    v_accvgpr_read_b32 v124, a16
    v_accvgpr_read_b32 v125, a17
    v_accvgpr_read_b32 v126, a18
    v_accvgpr_read_b32 v127, a19
    v_maximum3_f32 v108, v108, |v120|, |v121|
    v_maximum3_f32 v109, v109, |v122|, |v123|
    v_mfma_f32_16x16x32_bf16 a[36:39], a[212:215], v[224:227], a[36:39]
    ds_read_b64_tr_b16 a[196:197], v9 offset:49152
    v_maximum3_f32 v108, v108, |v124|, |v125|
    v_maximum3_f32 v109, v109, |v126|, |v127|
    v_mul_f32 v120, v120, v100
    v_mul_f32 v121, v121, v100
    v_mul_f32 v122, v122, v100
    v_mul_f32 v123, v123, v100
    v_mfma_f32_16x16x32_bf16 a[36:39], a[208:211], v[220:223], a[36:39]
    ds_read_b64_tr_b16 a[198:199], v9 offset:53248
    v_mul_f32 v124, v124, v100
    v_mul_f32 v125, v125, v100
    v_mul_f32 v126, v126, v100
    v_mul_f32 v127, v127, v100
    v_cvt_pk_bf16_f32 v152, v120, v121
    v_cvt_pk_bf16_f32 v153, v122, v123
    v_cvt_pk_bf16_f32 v154, v124, v125
    v_mfma_f32_16x16x32_bf16 a[40:43], a[208:211], v[228:231], a[40:43]
    v_cvt_pk_bf16_f32 v155, v126, v127
    v_mfma_f32_16x16x32_bf16 a[40:43], a[212:215], v[232:235], a[40:43]
    buffer_store_dwordx4 v[152:155], v110, s[24:27], s36 offen offset:0 sc1
    v_accvgpr_read_b32 v128, a4
    v_accvgpr_read_b32 v129, a5
    v_accvgpr_read_b32 v130, a6
    v_accvgpr_read_b32 v131, a7
    v_accvgpr_read_b32 v132, a20
    v_accvgpr_read_b32 v133, a21
    v_accvgpr_read_b32 v134, a22
    v_accvgpr_read_b32 v135, a23
    v_maximum3_f32 v108, v108, |v128|, |v129|
    v_maximum3_f32 v109, v109, |v130|, |v131|
    v_mfma_f32_16x16x32_bf16 a[44:47], a[212:215], v[240:243], a[44:47]
    v_maximum3_f32 v108, v108, |v132|, |v133|
    v_maximum3_f32 v109, v109, |v134|, |v135|
    v_mul_f32 v128, v128, v101
    v_mul_f32 v129, v129, v101
    v_mul_f32 v130, v130, v101
    v_mul_f32 v131, v131, v101
    v_mul_f32 v132, v132, v101
    v_mfma_f32_16x16x32_bf16 a[44:47], a[208:211], v[236:239], a[44:47]
    s_waitcnt lgkmcnt(4)
    v_mul_f32 v133, v133, v101
    v_mul_f32 v134, v134, v101
    v_mul_f32 v135, v135, v101
    v_cvt_pk_bf16_f32 v156, v128, v129
    v_cvt_pk_bf16_f32 v157, v130, v131
    v_cvt_pk_bf16_f32 v158, v132, v133
    v_mfma_f32_16x16x32_bf16 a[48:51], a[216:219], v[212:215], a[48:51]
    ds_read_b64_tr_b16 a[200:201], v10 offset:24576
    v_cvt_pk_bf16_f32 v159, v134, v135
    v_mfma_f32_16x16x32_bf16 a[48:51], a[220:223], v[216:219], a[48:51]
    ds_read_b64_tr_b16 a[202:203], v10 offset:28672
    buffer_store_dwordx4 v[156:159], v110, s[24:27], s36 offen offset:1024 sc1
    v_accvgpr_read_b32 v136, a8
    v_accvgpr_read_b32 v137, a9
    v_accvgpr_read_b32 v138, a10
    v_accvgpr_read_b32 v139, a11
    v_accvgpr_read_b32 v140, a24
    v_accvgpr_read_b32 v141, a25
    v_accvgpr_read_b32 v142, a26
    v_accvgpr_read_b32 v143, a27
    v_maximum3_f32 v108, v108, |v136|, |v137|
    v_maximum3_f32 v109, v109, |v138|, |v139|
    v_maximum3_f32 v108, v108, |v140|, |v141|
    v_mfma_f32_16x16x32_bf16 a[52:55], a[220:223], v[224:227], a[52:55]
    ds_read_b64_tr_b16 a[204:205], v10 offset:49152
    v_maximum3_f32 v109, v109, |v142|, |v143|
    v_mul_f32 v136, v136, v102
    v_mul_f32 v137, v137, v102
    v_mul_f32 v138, v138, v102
    v_mul_f32 v139, v139, v102
    v_mul_f32 v140, v140, v102
    v_mfma_f32_16x16x32_bf16 a[52:55], a[216:219], v[220:223], a[52:55]
    ds_read_b64_tr_b16 a[206:207], v10 offset:53248
    v_mul_f32 v141, v141, v102
    v_mul_f32 v142, v142, v102
    v_mul_f32 v143, v143, v102
    v_cvt_pk_bf16_f32 v160, v136, v137
    v_cvt_pk_bf16_f32 v161, v138, v139
    v_cvt_pk_bf16_f32 v162, v140, v141
    v_mfma_f32_16x16x32_bf16 a[56:59], a[216:219], v[228:231], a[56:59]
    v_cvt_pk_bf16_f32 v163, v142, v143
    v_mfma_f32_16x16x32_bf16 a[56:59], a[220:223], v[232:235], a[56:59]
    buffer_store_dwordx4 v[160:163], v110, s[24:27], s36 offen offset:2048 sc1
    v_accvgpr_read_b32 v144, a12
    v_accvgpr_read_b32 v145, a13
    v_accvgpr_read_b32 v146, a14
    v_accvgpr_read_b32 v147, a15
    v_accvgpr_read_b32 v148, a28
    v_accvgpr_read_b32 v149, a29
    v_accvgpr_read_b32 v150, a30
    v_accvgpr_read_b32 v151, a31
    v_maximum3_f32 v108, v108, |v144|, |v145|
    v_maximum3_f32 v109, v109, |v146|, |v147|
    v_maximum3_f32 v108, v108, |v148|, |v149|
    v_mfma_f32_16x16x32_bf16 a[60:63], a[220:223], v[240:243], a[60:63]
    v_maximum3_f32 v109, v109, |v150|, |v151|
    v_mul_f32 v144, v144, v103
    v_mul_f32 v145, v145, v103
    v_mul_f32 v146, v146, v103
    v_mul_f32 v147, v147, v103
    v_mul_f32 v148, v148, v103
    v_mfma_f32_16x16x32_bf16 a[60:63], a[216:219], v[236:239], a[60:63]
    s_waitcnt lgkmcnt(4)
    v_mul_f32 v149, v149, v103
    v_mul_f32 v150, v150, v103
    v_mul_f32 v151, v151, v103
    v_cvt_pk_bf16_f32 v164, v144, v145
    v_cvt_pk_bf16_f32 v165, v146, v147
    v_cvt_pk_bf16_f32 v166, v148, v149
    v_cvt_pk_bf16_f32 v167, v150, v151
    buffer_store_dwordx4 v[164:167], v110, s[24:27], s36 offen offset:3072 sc1
    v_mfma_f32_16x16x32_bf16 a[64:67], a[192:195], v[212:215], a[64:67]
    s_mov_b32 s36, 4096
    ds_read_b64_tr_b16 a[208:209], v11 offset:24576
    v_accvgpr_read_b32 v120, a32
    v_accvgpr_read_b32 v121, a33
    v_accvgpr_read_b32 v122, a34
    v_accvgpr_read_b32 v123, a35
    v_accvgpr_read_b32 v124, a48
    v_mfma_f32_16x16x32_bf16 a[64:67], a[196:199], v[216:219], a[64:67]
    ds_read_b64_tr_b16 a[210:211], v11 offset:28672
    v_accvgpr_read_b32 v125, a49
    v_accvgpr_read_b32 v126, a50
    v_accvgpr_read_b32 v127, a51
    v_maximum3_f32 v108, v108, |v120|, |v121|
    v_maximum3_f32 v109, v109, |v122|, |v123|
    v_maximum3_f32 v108, v108, |v124|, |v125|
    v_maximum3_f32 v109, v109, |v126|, |v127|
    v_mfma_f32_16x16x32_bf16 a[68:71], a[196:199], v[224:227], a[68:71]
    ds_read_b64_tr_b16 a[212:213], v11 offset:49152
    v_mul_f32 v120, v120, v100
    v_mul_f32 v121, v121, v100
    v_mul_f32 v122, v122, v100
    v_mul_f32 v123, v123, v100
    v_mul_f32 v124, v124, v100
    v_mul_f32 v125, v125, v100
    v_mul_f32 v126, v126, v100
    v_mfma_f32_16x16x32_bf16 a[68:71], a[192:195], v[220:223], a[68:71]
    ds_read_b64_tr_b16 a[214:215], v11 offset:53248
    v_mul_f32 v127, v127, v100
    v_cvt_pk_bf16_f32 v152, v120, v121
    v_cvt_pk_bf16_f32 v153, v122, v123
    v_cvt_pk_bf16_f32 v154, v124, v125
    v_cvt_pk_bf16_f32 v155, v126, v127
    v_mfma_f32_16x16x32_bf16 a[72:75], a[192:195], v[228:231], a[72:75]
    buffer_store_dwordx4 v[152:155], v110, s[24:27], s36 offen offset:0 sc1
    v_mfma_f32_16x16x32_bf16 a[72:75], a[196:199], v[232:235], a[72:75]
    s_mov_b32 s45, 61440
    buffer_load_dwordx4 a[0:3], v114, s[20:23], s45 offen offset:1024 sc1
    v_mfma_f32_16x16x32_bf16 a[76:79], a[196:199], v[240:243], a[76:79]
    s_mov_b32 s45, 61440
    buffer_load_dwordx4 a[4:7], v114, s[20:23], s45 offen offset:2048 sc1
    v_accvgpr_read_b32 v128, a36
    v_accvgpr_read_b32 v129, a37
    v_accvgpr_read_b32 v130, a38
    v_accvgpr_read_b32 v131, a39
    v_accvgpr_read_b32 v132, a52
    v_accvgpr_read_b32 v133, a53
    v_accvgpr_read_b32 v134, a54
    v_accvgpr_read_b32 v135, a55
    v_maximum3_f32 v108, v108, |v128|, |v129|
    v_maximum3_f32 v109, v109, |v130|, |v131|
    v_maximum3_f32 v108, v108, |v132|, |v133|
    v_maximum3_f32 v109, v109, |v134|, |v135|
    v_mul_f32 v128, v128, v101
    v_mul_f32 v129, v129, v101
    v_mul_f32 v130, v130, v101
    v_mul_f32 v131, v131, v101
    v_mul_f32 v132, v132, v101
    v_mul_f32 v133, v133, v101
    v_mul_f32 v134, v134, v101
    v_mul_f32 v135, v135, v101
    v_mfma_f32_16x16x32_bf16 a[76:79], a[192:195], v[236:239], a[76:79]
    s_waitcnt lgkmcnt(4)
    v_cvt_pk_bf16_f32 v156, v128, v129
    v_cvt_pk_bf16_f32 v157, v130, v131
    v_cvt_pk_bf16_f32 v158, v132, v133
    v_cvt_pk_bf16_f32 v159, v134, v135
    v_mfma_f32_16x16x32_bf16 a[80:83], a[200:203], v[212:215], a[80:83]
    ds_read_b64_tr_b16 a[216:217], v12 offset:24576
    buffer_store_dwordx4 v[156:159], v110, s[24:27], s36 offen offset:1024 sc1
    v_mfma_f32_16x16x32_bf16 a[80:83], a[204:207], v[216:219], a[80:83]
    s_mov_b32 s45, 61440
    ds_read_b64_tr_b16 a[218:219], v12 offset:28672
    buffer_load_dwordx4 a[8:11], v114, s[20:23], s45 offen offset:3072 sc1
    v_mfma_f32_16x16x32_bf16 a[84:87], a[204:207], v[224:227], a[84:87]
    s_mov_b32 s45, 61440
    ds_read_b64_tr_b16 a[220:221], v12 offset:49152
    buffer_load_dwordx4 a[12:15], v115, s[20:23], s45 offen offset:0 sc1
    v_accvgpr_read_b32 v136, a40
    v_accvgpr_read_b32 v137, a41
    v_accvgpr_read_b32 v138, a42
    v_accvgpr_read_b32 v139, a43
    v_accvgpr_read_b32 v140, a56
    v_accvgpr_read_b32 v141, a57
    v_accvgpr_read_b32 v142, a58
    v_accvgpr_read_b32 v143, a59
    v_maximum3_f32 v108, v108, |v136|, |v137|
    v_maximum3_f32 v109, v109, |v138|, |v139|
    v_maximum3_f32 v108, v108, |v140|, |v141|
    v_maximum3_f32 v109, v109, |v142|, |v143|
    v_mul_f32 v136, v136, v102
    v_mul_f32 v137, v137, v102
    v_mul_f32 v138, v138, v102
    v_mul_f32 v139, v139, v102
    v_mul_f32 v140, v140, v102
    v_mul_f32 v141, v141, v102
    v_mul_f32 v142, v142, v102
    v_mul_f32 v143, v143, v102
    v_mfma_f32_16x16x32_bf16 a[84:87], a[200:203], v[220:223], a[84:87]
    ds_read_b64_tr_b16 a[222:223], v12 offset:53248
    v_cvt_pk_bf16_f32 v160, v136, v137
    v_cvt_pk_bf16_f32 v161, v138, v139
    v_cvt_pk_bf16_f32 v162, v140, v141
    v_cvt_pk_bf16_f32 v163, v142, v143
    v_mfma_f32_16x16x32_bf16 a[88:91], a[200:203], v[228:231], a[88:91]
    buffer_store_dwordx4 v[160:163], v110, s[24:27], s36 offen offset:2048 sc1
    v_mfma_f32_16x16x32_bf16 a[88:91], a[204:207], v[232:235], a[88:91]
    s_mov_b32 s45, 81920
    buffer_load_dwordx4 a[16:19], v114, s[20:23], s45 offen offset:0 sc1
    v_mfma_f32_16x16x32_bf16 a[92:95], a[204:207], v[240:243], a[92:95]
    s_mov_b32 s45, 81920
    buffer_load_dwordx4 a[20:23], v114, s[20:23], s45 offen offset:1024 sc1
    v_accvgpr_read_b32 v144, a44
    v_accvgpr_read_b32 v145, a45
    v_accvgpr_read_b32 v146, a46
    v_accvgpr_read_b32 v147, a47
    v_accvgpr_read_b32 v148, a60
    v_accvgpr_read_b32 v149, a61
    v_accvgpr_read_b32 v150, a62
    v_accvgpr_read_b32 v151, a63
    v_maximum3_f32 v108, v108, |v144|, |v145|
    v_maximum3_f32 v109, v109, |v146|, |v147|
    v_maximum3_f32 v108, v108, |v148|, |v149|
    v_maximum3_f32 v109, v109, |v150|, |v151|
    v_mul_f32 v144, v144, v103
    v_mul_f32 v145, v145, v103
    v_mul_f32 v146, v146, v103
    v_mul_f32 v147, v147, v103
    v_mul_f32 v148, v148, v103
    v_mul_f32 v149, v149, v103
    v_mul_f32 v150, v150, v103
    v_mul_f32 v151, v151, v103
    v_mfma_f32_16x16x32_bf16 a[92:95], a[200:203], v[236:239], a[92:95]
    s_waitcnt lgkmcnt(4)
    v_cvt_pk_bf16_f32 v164, v144, v145
    v_cvt_pk_bf16_f32 v165, v146, v147
    v_cvt_pk_bf16_f32 v166, v148, v149
    v_cvt_pk_bf16_f32 v167, v150, v151
    buffer_store_dwordx4 v[164:167], v110, s[24:27], s36 offen offset:3072 sc1
    s_mov_b32 s45, 81920
    buffer_load_dwordx4 a[24:27], v114, s[20:23], s45 offen offset:2048 sc1
    s_mov_b32 s45, 81920
    buffer_load_dwordx4 a[28:31], v114, s[20:23], s45 offen offset:3072 sc1
    v_mfma_f32_16x16x32_bf16 a[96:99], a[208:211], v[212:215], a[96:99]
    s_mov_b32 s36, 8192
    v_accvgpr_read_b32 v120, a64
    v_accvgpr_read_b32 v121, a65
    v_accvgpr_read_b32 v122, a66
    v_accvgpr_read_b32 v123, a67
    v_accvgpr_read_b32 v124, a80
    v_mfma_f32_16x16x32_bf16 a[96:99], a[212:215], v[216:219], a[96:99]
    v_accvgpr_read_b32 v125, a81
    v_accvgpr_read_b32 v126, a82
    v_accvgpr_read_b32 v127, a83
    v_maximum3_f32 v108, v108, |v120|, |v121|
    v_maximum3_f32 v109, v109, |v122|, |v123|
    v_maximum3_f32 v108, v108, |v124|, |v125|
    v_maximum3_f32 v109, v109, |v126|, |v127|
    v_mfma_f32_16x16x32_bf16 a[100:103], a[212:215], v[224:227], a[100:103]
    v_mul_f32 v120, v120, v100
    v_mul_f32 v121, v121, v100
    v_mul_f32 v122, v122, v100
    v_mul_f32 v123, v123, v100
    v_mul_f32 v124, v124, v100
    v_mul_f32 v125, v125, v100
    v_mul_f32 v126, v126, v100
    v_mfma_f32_16x16x32_bf16 a[100:103], a[208:211], v[220:223], a[100:103]
    v_mul_f32 v127, v127, v100
    v_cvt_pk_bf16_f32 v152, v120, v121
    v_cvt_pk_bf16_f32 v153, v122, v123
    v_cvt_pk_bf16_f32 v154, v124, v125
    v_cvt_pk_bf16_f32 v155, v126, v127
    v_mfma_f32_16x16x32_bf16 a[104:107], a[208:211], v[228:231], a[104:107]
    buffer_store_dwordx4 v[152:155], v110, s[24:27], s36 offen offset:0 sc1
    v_mfma_f32_16x16x32_bf16 a[104:107], a[212:215], v[232:235], a[104:107]
    s_mov_b32 s45, 81920
    buffer_load_dwordx4 a[32:35], v115, s[20:23], s45 offen offset:0 sc1
    v_mfma_f32_16x16x32_bf16 a[108:111], a[212:215], v[240:243], a[108:111]
    s_mov_b32 s45, 102400
    buffer_load_dwordx4 a[36:39], v114, s[20:23], s45 offen offset:0 sc1
    v_accvgpr_read_b32 v128, a68
    v_accvgpr_read_b32 v129, a69
    v_accvgpr_read_b32 v130, a70
    v_accvgpr_read_b32 v131, a71
    v_accvgpr_read_b32 v132, a84
    v_accvgpr_read_b32 v133, a85
    v_accvgpr_read_b32 v134, a86
    v_accvgpr_read_b32 v135, a87
    v_maximum3_f32 v108, v108, |v128|, |v129|
    v_maximum3_f32 v109, v109, |v130|, |v131|
    v_maximum3_f32 v108, v108, |v132|, |v133|
    v_maximum3_f32 v109, v109, |v134|, |v135|
    v_mul_f32 v128, v128, v101
    v_mul_f32 v129, v129, v101
    v_mul_f32 v130, v130, v101
    v_mul_f32 v131, v131, v101
    v_mul_f32 v132, v132, v101
    v_mul_f32 v133, v133, v101
    v_mul_f32 v134, v134, v101
    v_mul_f32 v135, v135, v101
    v_mfma_f32_16x16x32_bf16 a[108:111], a[208:211], v[236:239], a[108:111]
    s_waitcnt lgkmcnt(0)
    v_cvt_pk_bf16_f32 v156, v128, v129
    v_cvt_pk_bf16_f32 v157, v130, v131
    v_cvt_pk_bf16_f32 v158, v132, v133
    v_cvt_pk_bf16_f32 v159, v134, v135
    v_mfma_f32_16x16x32_bf16 a[112:115], a[216:219], v[212:215], a[112:115]
    buffer_store_dwordx4 v[156:159], v110, s[24:27], s36 offen offset:1024 sc1
    v_mfma_f32_16x16x32_bf16 a[112:115], a[220:223], v[216:219], a[112:115]
    s_mov_b32 s45, 102400
    buffer_load_dwordx4 a[40:43], v114, s[20:23], s45 offen offset:1024 sc1
    v_mfma_f32_16x16x32_bf16 a[116:119], a[220:223], v[224:227], a[116:119]
    s_mov_b32 s45, 102400
    buffer_load_dwordx4 a[44:47], v114, s[20:23], s45 offen offset:2048 sc1
    v_accvgpr_read_b32 v136, a72
    v_accvgpr_read_b32 v137, a73
    v_accvgpr_read_b32 v138, a74
    v_accvgpr_read_b32 v139, a75
    v_accvgpr_read_b32 v140, a88
    v_accvgpr_read_b32 v141, a89
    v_accvgpr_read_b32 v142, a90
    v_accvgpr_read_b32 v143, a91
    v_maximum3_f32 v108, v108, |v136|, |v137|
    v_maximum3_f32 v109, v109, |v138|, |v139|
    v_maximum3_f32 v108, v108, |v140|, |v141|
    v_maximum3_f32 v109, v109, |v142|, |v143|
    v_mul_f32 v136, v136, v102
    v_mul_f32 v137, v137, v102
    v_mul_f32 v138, v138, v102
    v_mul_f32 v139, v139, v102
    v_mul_f32 v140, v140, v102
    v_mul_f32 v141, v141, v102
    v_mul_f32 v142, v142, v102
    v_mul_f32 v143, v143, v102
    v_mfma_f32_16x16x32_bf16 a[116:119], a[216:219], v[220:223], a[116:119]
    v_cvt_pk_bf16_f32 v160, v136, v137
    v_cvt_pk_bf16_f32 v161, v138, v139
    v_cvt_pk_bf16_f32 v162, v140, v141
    v_cvt_pk_bf16_f32 v163, v142, v143
    v_mfma_f32_16x16x32_bf16 a[120:123], a[216:219], v[228:231], a[120:123]
    buffer_store_dwordx4 v[160:163], v110, s[24:27], s36 offen offset:2048 sc1
    v_mfma_f32_16x16x32_bf16 a[120:123], a[220:223], v[232:235], a[120:123]
    s_mov_b32 s45, 102400
    buffer_load_dwordx4 a[48:51], v114, s[20:23], s45 offen offset:3072 sc1
    v_mfma_f32_16x16x32_bf16 a[124:127], a[220:223], v[240:243], a[124:127]
    s_mov_b32 s45, 102400
    buffer_load_dwordx4 a[52:55], v115, s[20:23], s45 offen offset:0 sc1
    v_accvgpr_read_b32 v144, a76
    v_accvgpr_read_b32 v145, a77
    v_accvgpr_read_b32 v146, a78
    v_accvgpr_read_b32 v147, a79
    v_accvgpr_read_b32 v148, a92
    v_accvgpr_read_b32 v149, a93
    v_accvgpr_read_b32 v150, a94
    v_accvgpr_read_b32 v151, a95
    v_maximum3_f32 v108, v108, |v144|, |v145|
    v_maximum3_f32 v109, v109, |v146|, |v147|
    v_maximum3_f32 v108, v108, |v148|, |v149|
    v_maximum3_f32 v109, v109, |v150|, |v151|
    v_mul_f32 v144, v144, v103
    v_mul_f32 v145, v145, v103
    v_mul_f32 v146, v146, v103
    v_mul_f32 v147, v147, v103
    v_mul_f32 v148, v148, v103
    v_mul_f32 v149, v149, v103
    v_mul_f32 v150, v150, v103
    v_mul_f32 v151, v151, v103
    v_mfma_f32_16x16x32_bf16 a[124:127], a[216:219], v[236:239], a[124:127]
    v_cvt_pk_bf16_f32 v164, v144, v145
    v_cvt_pk_bf16_f32 v165, v146, v147
    v_cvt_pk_bf16_f32 v166, v148, v149
    v_cvt_pk_bf16_f32 v167, v150, v151
    buffer_store_dwordx4 v[164:167], v110, s[24:27], s36 offen offset:3072 sc1
    s_mov_b32 s45, 122880
    buffer_load_dwordx4 a[56:59], v114, s[20:23], s45 offen offset:0 sc1
    s_mov_b32 s45, 122880
    buffer_load_dwordx4 a[60:63], v114, s[20:23], s45 offen offset:1024 sc1
    s_mov_b32 s36, 12288
    v_accvgpr_read_b32 v120, a96
    v_accvgpr_read_b32 v121, a97
    v_accvgpr_read_b32 v122, a98
    v_accvgpr_read_b32 v123, a99
    v_accvgpr_read_b32 v124, a112
    v_accvgpr_read_b32 v125, a113
    v_accvgpr_read_b32 v126, a114
    v_accvgpr_read_b32 v127, a115
    v_maximum3_f32 v108, v108, |v120|, |v121|
    v_maximum3_f32 v109, v109, |v122|, |v123|
    v_maximum3_f32 v108, v108, |v124|, |v125|
    v_maximum3_f32 v109, v109, |v126|, |v127|
    v_mul_f32 v120, v120, v100
    v_mul_f32 v121, v121, v100
    v_mul_f32 v122, v122, v100
    v_mul_f32 v123, v123, v100
    v_mul_f32 v124, v124, v100
    v_mul_f32 v125, v125, v100
    v_mul_f32 v126, v126, v100
    v_mul_f32 v127, v127, v100
    v_cvt_pk_bf16_f32 v152, v120, v121
    v_cvt_pk_bf16_f32 v153, v122, v123
    v_cvt_pk_bf16_f32 v154, v124, v125
    v_cvt_pk_bf16_f32 v155, v126, v127
    buffer_store_dwordx4 v[152:155], v110, s[24:27], s36 offen offset:0 sc1
    s_mov_b32 s45, 122880
    buffer_load_dwordx4 a[64:67], v114, s[20:23], s45 offen offset:2048 sc1
    s_mov_b32 s45, 122880
    buffer_load_dwordx4 a[68:71], v114, s[20:23], s45 offen offset:3072 sc1
    v_accvgpr_read_b32 v128, a100
    v_accvgpr_read_b32 v129, a101
    v_accvgpr_read_b32 v130, a102
    v_accvgpr_read_b32 v131, a103
    v_accvgpr_read_b32 v132, a116
    v_accvgpr_read_b32 v133, a117
    v_accvgpr_read_b32 v134, a118
    v_accvgpr_read_b32 v135, a119
    v_maximum3_f32 v108, v108, |v128|, |v129|
    v_maximum3_f32 v109, v109, |v130|, |v131|
    v_maximum3_f32 v108, v108, |v132|, |v133|
    v_maximum3_f32 v109, v109, |v134|, |v135|
    v_mul_f32 v128, v128, v101
    v_mul_f32 v129, v129, v101
    v_mul_f32 v130, v130, v101
    v_mul_f32 v131, v131, v101
    v_mul_f32 v132, v132, v101
    v_mul_f32 v133, v133, v101
    v_mul_f32 v134, v134, v101
    v_mul_f32 v135, v135, v101
    v_cvt_pk_bf16_f32 v156, v128, v129
    v_cvt_pk_bf16_f32 v157, v130, v131
    v_cvt_pk_bf16_f32 v158, v132, v133
    v_cvt_pk_bf16_f32 v159, v134, v135
    buffer_store_dwordx4 v[156:159], v110, s[24:27], s36 offen offset:1024 sc1
    s_mov_b32 s45, 122880
    buffer_load_dwordx4 a[72:75], v115, s[20:23], s45 offen offset:0 sc1
    s_mov_b32 s45, 143360
    buffer_load_dwordx4 a[76:79], v114, s[20:23], s45 offen offset:0 sc1
    v_accvgpr_read_b32 v136, a104
    v_accvgpr_read_b32 v137, a105
    v_accvgpr_read_b32 v138, a106
    v_accvgpr_read_b32 v139, a107
    v_accvgpr_read_b32 v140, a120
    v_accvgpr_read_b32 v141, a121
    v_accvgpr_read_b32 v142, a122
    v_accvgpr_read_b32 v143, a123
    v_maximum3_f32 v108, v108, |v136|, |v137|
    v_maximum3_f32 v109, v109, |v138|, |v139|
    v_maximum3_f32 v108, v108, |v140|, |v141|
    v_maximum3_f32 v109, v109, |v142|, |v143|
    v_mul_f32 v136, v136, v102
    v_mul_f32 v137, v137, v102
    v_mul_f32 v138, v138, v102
    v_mul_f32 v139, v139, v102
    v_mul_f32 v140, v140, v102
    v_mul_f32 v141, v141, v102
    v_mul_f32 v142, v142, v102
    v_mul_f32 v143, v143, v102
    v_cvt_pk_bf16_f32 v160, v136, v137
    v_cvt_pk_bf16_f32 v161, v138, v139
    v_cvt_pk_bf16_f32 v162, v140, v141
    v_cvt_pk_bf16_f32 v163, v142, v143
    buffer_store_dwordx4 v[160:163], v110, s[24:27], s36 offen offset:2048 sc1
    s_mov_b32 s45, 143360
    buffer_load_dwordx4 a[80:83], v114, s[20:23], s45 offen offset:1024 sc1
    s_mov_b32 s45, 143360
    buffer_load_dwordx4 a[84:87], v114, s[20:23], s45 offen offset:2048 sc1
    v_accvgpr_read_b32 v144, a108
    v_accvgpr_read_b32 v145, a109
    v_accvgpr_read_b32 v146, a110
    v_accvgpr_read_b32 v147, a111
    v_accvgpr_read_b32 v148, a124
    v_accvgpr_read_b32 v149, a125
    v_accvgpr_read_b32 v150, a126
    v_accvgpr_read_b32 v151, a127
    v_maximum3_f32 v108, v108, |v144|, |v145|
    v_maximum3_f32 v109, v109, |v146|, |v147|
    v_maximum3_f32 v108, v108, |v148|, |v149|
    v_maximum3_f32 v109, v109, |v150|, |v151|
    v_mul_f32 v144, v144, v103
    v_mul_f32 v145, v145, v103
    v_mul_f32 v146, v146, v103
    v_mul_f32 v147, v147, v103
    v_mul_f32 v148, v148, v103
    v_mul_f32 v149, v149, v103
    v_mul_f32 v150, v150, v103
    v_mul_f32 v151, v151, v103
    v_cvt_pk_bf16_f32 v164, v144, v145
    v_cvt_pk_bf16_f32 v165, v146, v147
    v_cvt_pk_bf16_f32 v166, v148, v149
    v_cvt_pk_bf16_f32 v167, v150, v151
    buffer_store_dwordx4 v[164:167], v110, s[24:27], s36 offen offset:3072 sc1
    s_mov_b32 s45, 143360
    buffer_load_dwordx4 a[88:91], v114, s[20:23], s45 offen offset:3072 sc1
    s_mov_b32 s45, 143360
    buffer_load_dwordx4 a[92:95], v115, s[20:23], s45 offen offset:0 sc1
    v_maximum3_f32 v108, v108, v109, v109
    v_cmp_ngt_f32 vcc, 0x7f800000, v108
    s_and_b64 vcc, vcc, exec
    s_cbranch_scc1 L_slow
L_published:
    v_mov_b32 v16, v114
    v_mov_b32 v17, v115
    v_mov_b32 v3, v249
    v_mov_b32 v2, 1
    s_waitcnt vmcnt(40)
    v_lshlrev_b32 v166, 16, v22
    v_and_b32 v167, 0xffff0000, v22
    v_lshlrev_b32 v168, 16, v23
    v_and_b32 v169, 0xffff0000, v23
    v_lshlrev_b32 v170, 16, v24
    v_and_b32 v171, 0xffff0000, v24
    v_lshlrev_b32 v172, 16, v25
    v_and_b32 v173, 0xffff0000, v25
    v_lshlrev_b32 v174, 16, v26
    v_and_b32 v175, 0xffff0000, v26
    v_lshlrev_b32 v176, 16, v27
    v_and_b32 v177, 0xffff0000, v27
    v_lshlrev_b32 v178, 16, v28
    v_and_b32 v179, 0xffff0000, v28
    v_lshlrev_b32 v180, 16, v29
    v_and_b32 v181, 0xffff0000, v29
    v_lshlrev_b32 v182, 16, v30
    v_and_b32 v183, 0xffff0000, v30
    v_lshlrev_b32 v184, 16, v31
    v_and_b32 v185, 0xffff0000, v31
    v_pk_add_f32 v[166:167], v[166:167], v[32:33] op_sel_hi:[1,0] neg_lo:[0,1] neg_hi:[0,1]
    v_pk_add_f32 v[168:169], v[168:169], v[32:33] op_sel_hi:[1,0] neg_lo:[0,1] neg_hi:[0,1]
    v_pk_add_f32 v[170:171], v[170:171], v[32:33] op_sel_hi:[1,0] neg_lo:[0,1] neg_hi:[0,1]
    v_pk_add_f32 v[172:173], v[172:173], v[32:33] op_sel_hi:[1,0] neg_lo:[0,1] neg_hi:[0,1]
    v_pk_add_f32 v[174:175], v[174:175], v[32:33] op_sel_hi:[1,0] neg_lo:[0,1] neg_hi:[0,1]
    v_pk_add_f32 v[176:177], v[176:177], v[32:33] op_sel_hi:[1,0] neg_lo:[0,1] neg_hi:[0,1]
    v_pk_add_f32 v[178:179], v[178:179], v[32:33] op_sel_hi:[1,0] neg_lo:[0,1] neg_hi:[0,1]
    v_pk_add_f32 v[180:181], v[180:181], v[32:33] op_sel_hi:[1,0] neg_lo:[0,1] neg_hi:[0,1]
    v_pk_add_f32 v[182:183], v[182:183], v[32:33] op_sel_hi:[1,0] neg_lo:[0,1] neg_hi:[0,1]
    v_pk_add_f32 v[184:185], v[184:185], v[32:33] op_sel_hi:[1,0] neg_lo:[0,1] neg_hi:[0,1]
    v_cvt_pk_bf16_f32 v36, v166, v167
    v_cvt_pk_bf16_f32 v37, v168, v169
    v_cvt_pk_bf16_f32 v38, v170, v171
    v_cvt_pk_bf16_f32 v39, v172, v173
    v_cvt_pk_bf16_f32 v40, v174, v175
    v_cvt_pk_bf16_f32 v41, v176, v177
    v_cvt_pk_bf16_f32 v42, v178, v179
    v_cvt_pk_bf16_f32 v43, v180, v181
    v_cvt_pk_bf16_f32 v44, v182, v183
    v_cvt_pk_bf16_f32 v45, v184, v185
    v_lshlrev_b32 v166, 16, v36
    v_and_b32 v167, 0xffff0000, v36
    v_lshlrev_b32 v168, 16, v37
    v_and_b32 v169, 0xffff0000, v37
    v_lshlrev_b32 v170, 16, v38
    v_and_b32 v171, 0xffff0000, v38
    v_lshlrev_b32 v172, 16, v39
    v_and_b32 v173, 0xffff0000, v39
    v_lshlrev_b32 v174, 16, v40
    v_and_b32 v175, 0xffff0000, v40
    v_lshlrev_b32 v176, 16, v41
    v_and_b32 v177, 0xffff0000, v41
    v_lshlrev_b32 v178, 16, v42
    v_and_b32 v179, 0xffff0000, v42
    v_lshlrev_b32 v180, 16, v43
    v_and_b32 v181, 0xffff0000, v43
    v_lshlrev_b32 v182, 16, v44
    v_and_b32 v183, 0xffff0000, v44
    v_lshlrev_b32 v184, 16, v45
    v_and_b32 v185, 0xffff0000, v45
    v_pk_mul_f32 v[166:167], v[166:167], v[32:33] op_sel:[0,1] op_sel_hi:[1,1]
    v_pk_mul_f32 v[168:169], v[168:169], v[32:33] op_sel:[0,1] op_sel_hi:[1,1]
    v_pk_mul_f32 v[170:171], v[170:171], v[32:33] op_sel:[0,1] op_sel_hi:[1,1]
    v_pk_mul_f32 v[172:173], v[172:173], v[32:33] op_sel:[0,1] op_sel_hi:[1,1]
    v_pk_mul_f32 v[174:175], v[174:175], v[32:33] op_sel:[0,1] op_sel_hi:[1,1]
    v_pk_mul_f32 v[176:177], v[176:177], v[32:33] op_sel:[0,1] op_sel_hi:[1,1]
    v_pk_mul_f32 v[178:179], v[178:179], v[32:33] op_sel:[0,1] op_sel_hi:[1,1]
    v_pk_mul_f32 v[180:181], v[180:181], v[32:33] op_sel:[0,1] op_sel_hi:[1,1]
    v_pk_mul_f32 v[182:183], v[182:183], v[32:33] op_sel:[0,1] op_sel_hi:[1,1]
    v_pk_mul_f32 v[184:185], v[184:185], v[32:33] op_sel:[0,1] op_sel_hi:[1,1]
    v_cvt_pk_bf16_f32 v36, v166, v167
    v_cvt_pk_bf16_f32 v37, v168, v169
    v_cvt_pk_bf16_f32 v38, v170, v171
    v_cvt_pk_bf16_f32 v39, v172, v173
    v_cvt_pk_bf16_f32 v40, v174, v175
    v_cvt_pk_bf16_f32 v41, v176, v177
    v_cvt_pk_bf16_f32 v42, v178, v179
    v_cvt_pk_bf16_f32 v43, v180, v181
    v_cvt_pk_bf16_f32 v44, v182, v183
    v_cvt_pk_bf16_f32 v45, v184, v185
    s_lshr_b32 s40, s87, 1
    s_lshl_b32 s40, s40, 2
    s_add_u32 s40, s40, s47
    s_lshl_b32 s40, s40, 18
    s_add_u32 s40, s40, 0x400000
    s_add_u32 s8, s72, s40
    s_addc_u32 s9, s73, 0
    s_mov_b32 s10, 0xc0000
    s_mov_b32 s11, 0x20000
    s_mov_b32 s12, s68
    s_mov_b32 s13, s69
    s_mov_b32 s14, 0x280000
    s_mov_b32 s15, 0x20000
    s_xor_b32 s40, s47, 1
    s_lshl_b32 s30, s40, 19
    s_lshl_b32 s31, s47, 19
    s_add_u32 s40, s5, 0
    s_and_b32 s40, s40, 3
    s_lshl_b32 s41, s5, 2
    s_add_u32 s41, s41, s40
    s_lshl_b32 s41, s41, 10
    v_lshl_add_u32 v4, v19, 4, s41
    s_add_u32 s40, s5, 1
    s_and_b32 s40, s40, 3
    s_lshl_b32 s41, s5, 2
    s_add_u32 s41, s41, s40
    s_lshl_b32 s41, s41, 10
    v_lshl_add_u32 v5, v19, 4, s41
    s_add_u32 s40, s5, 2
    s_and_b32 s40, s40, 3
    s_lshl_b32 s41, s5, 2
    s_add_u32 s41, s41, s40
    s_lshl_b32 s41, s41, 10
    v_lshl_add_u32 v6, v19, 4, s41
    s_add_u32 s40, s5, 3
    s_and_b32 s40, s40, 3
    s_lshl_b32 s41, s5, 2
    s_add_u32 s41, s41, s40
    s_lshl_b32 s41, s41, 10
    v_lshl_add_u32 v7, v19, 4, s41
    s_add_u32 s40, s46, 122880
    v_lshl_add_u32 v8, v19, 4, s40
    s_add_u32 s40, s46, 81920
    v_lshl_add_u32 v9, v19, 4, s40
    s_lshl_b32 s40, s46, 1
    v_lshl_add_u32 v10, v19, 4, s40
    s_waitcnt vmcnt(2)
    s_mov_b64 exec, 1
    buffer_store_dword v2, off, s[76:79], s58 sc1
    s_mov_b64 exec, -1
    v_min3_u32 v252, v252, v253, v254
    v_min_u32 v252, v252, v255
    v_cmp_gt_u32 vcc, 2, v252
    s_and_b64 vcc, vcc, exec
    s_cbranch_scc1 L_spin_ffn
L_back_ffn:
    s_mul_i32 s40, s6, 27648
    s_lshl_b32 s41, s5, 10
    s_add_u32 s40, s40, s41
    v_lshlrev_b32 v194, 4, v19
    buffer_load_dwordx4 v[166:169], v194, s[16:19], s40 offen sc1
    s_add_u32 s40, s40, 4096
    buffer_load_dwordx4 v[170:173], v194, s[16:19], s40 offen sc1
    s_add_u32 s40, s40, 4096
    buffer_load_dwordx4 v[174:177], v194, s[16:19], s40 offen sc1
    s_add_u32 s40, s40, 4096
    buffer_load_dwordx4 v[178:181], v194, s[16:19], s40 offen sc1
    s_add_u32 s40, s40, 4096
    buffer_load_dwordx4 v[182:185], v194, s[16:19], s40 offen sc1
    s_add_u32 s40, s40, 4096
    buffer_load_dwordx4 v[186:189], v194, s[16:19], s40 offen sc1
    s_add_u32 s40, s40, 4096
    s_cmp_eq_u32 s5, 3
    s_cselect_b32 s40, 0x438000, s40
    buffer_load_dwordx4 v[190:193], v194, s[16:19], s40 offen sc1
    s_and_b32 s40, s87, 30
    s_lshl_b32 s40, s40, 1
    s_add_u32 s40, s40, s47
    s_lshl_b32 s40, s40, 9
    s_mov_b32 s45, 163840
    buffer_load_dwordx4 v[46:49], v16, s[20:23], s45 offen offset:0 sc1
    s_add_u32 s40, s40, 0x292000
    v_bfe_u32 v1, v19, 2, 1
    v_lshlrev_b32 v1, 3, v1
    v_and_or_b32 v1, v19, 3, v1
    buffer_load_dwordx4 v[50:53], v16, s[20:23], s45 offen offset:1024 sc1
    v_lshl_add_u32 v1, v1, 7, s40
    v_mov_b32 v2, 3
    v_mov_b32 v11, 0x2500000
    s_not_b32 s40, s50
    buffer_load_dwordx4 v[54:57], v16, s[20:23], s45 offen offset:2048 sc1
    s_and_b32 s40, s40, 0x7ff
    v_cmp_eq_u32 vcc, s40, v35
    v_mov_b32 v12, 0x29c000
    s_nop 0
    buffer_load_dwordx4 v[58:61], v16, s[20:23], s45 offen offset:3072 sc1
    v_cndmask_b32 v11, v11, v12, vcc
    s_not_b32 s40, s51
    s_and_b32 s40, s40, 0x7ff
    v_cmp_eq_u32 vcc, s40, v35
    buffer_load_dwordx4 v[62:65], v17, s[20:23], s45 offen offset:0 sc1
    v_mov_b32 v12, 0x29c500
    s_nop 0
    v_cndmask_b32 v11, v11, v12, vcc
    s_not_b32 s40, s52
    s_mov_b32 s45, 184320
    buffer_load_dwordx4 v[66:69], v16, s[20:23], s45 offen offset:0 sc1
    s_and_b32 s40, s40, 0x7ff
    v_cmp_eq_u32 vcc, s40, v35
    v_mov_b32 v12, 0x29ca00
    s_nop 0
    buffer_load_dwordx4 v[70:73], v16, s[20:23], s45 offen offset:1024 sc1
    v_cndmask_b32 v11, v11, v12, vcc
    s_not_b32 s40, s53
    s_and_b32 s40, s40, 0x7ff
    v_cmp_eq_u32 vcc, s40, v35
    buffer_load_dwordx4 v[74:77], v16, s[20:23], s45 offen offset:2048 sc1
    v_mov_b32 v12, 0x29cf00
    s_nop 0
    v_cndmask_b32 v11, v11, v12, vcc
    s_not_b32 s40, s54
    buffer_load_dwordx4 v[78:81], v16, s[20:23], s45 offen offset:3072 sc1
    s_and_b32 s40, s40, 0x7ff
    v_cmp_eq_u32 vcc, s40, v35
    v_mov_b32 v12, 0x29d400
    s_nop 0
    buffer_load_dwordx4 v[82:85], v17, s[20:23], s45 offen offset:0 sc1
    v_cndmask_b32 v11, v11, v12, vcc
    s_not_b32 s40, s55
    s_and_b32 s40, s40, 0x7ff
    v_cmp_eq_u32 vcc, s40, v35
    v_mov_b32 v12, 0x29d900
    s_nop 0
    v_cndmask_b32 v11, v11, v12, vcc
    s_not_b32 s40, s56
    s_and_b32 s40, s40, 0x7ff
    v_cmp_eq_u32 vcc, s40, v35
    v_mov_b32 v12, 0x29de00
    s_nop 0
    v_cndmask_b32 v11, v11, v12, vcc
    s_not_b32 s40, s57
    s_and_b32 s40, s40, 0x7ff
    v_cmp_eq_u32 vcc, s40, v35
    v_mov_b32 v12, 0x29e300
    s_nop 0
    v_cndmask_b32 v11, v11, v12, vcc
    v_mul_u32_u24 v12, 1280, v35
    v_sub_u32 v12, v34, v12
    v_add_u32 v11, v11, v12
    buffer_load_dwordx4 v[252:255], v1, s[76:79], 0 offen sc1
    s_waitcnt vmcnt(11)
    v_add_f32 v166, v166, v170
    v_add_f32 v167, v167, v171
    v_add_f32 v168, v168, v172
    v_add_f32 v169, v169, v173
    v_add_f32 v166, v166, v174
    s_mov_b32 s45, 204800
    buffer_load_dwordx4 v[86:89], v16, s[20:23], s45 offen offset:0 sc1
    v_add_f32 v167, v167, v175
    v_add_f32 v168, v168, v176
    v_add_f32 v169, v169, v177
    v_add_f32 v166, v166, v178
    v_add_f32 v167, v167, v179
    buffer_load_dwordx4 v[90:93], v16, s[20:23], s45 offen offset:1024 sc1
    v_add_f32 v168, v168, v180
    v_add_f32 v169, v169, v181
    v_add_f32 v166, v166, v182
    v_add_f32 v167, v167, v183
    v_add_f32 v168, v168, v184
    buffer_load_dwordx4 v[94:97], v16, s[20:23], s45 offen offset:2048 sc1
    v_add_f32 v169, v169, v185
    v_add_f32 v166, v166, v186
    v_add_f32 v167, v167, v187
    v_add_f32 v168, v168, v188
    v_add_f32 v169, v169, v189
    buffer_load_dwordx4 v[98:101], v16, s[20:23], s45 offen offset:3072 sc1
    v_add_f32 v166, v166, v190
    v_add_f32 v167, v167, v191
    v_add_f32 v168, v168, v192
    v_add_f32 v169, v169, v193
    v_add_f32_dpp v166, v166, v166 row_ror:8 row_mask:0xf bank_mask:0xf
    buffer_load_dwordx4 v[102:105], v17, s[20:23], s45 offen offset:0 sc1
    v_add_f32_dpp v167, v167, v167 row_ror:8 row_mask:0xf bank_mask:0xf
    v_add_f32_dpp v168, v168, v168 row_ror:8 row_mask:0xf bank_mask:0xf
    v_add_f32_dpp v169, v169, v169 row_ror:8 row_mask:0xf bank_mask:0xf
    v_mov_b32 v170, v166
    v_mov_b32 v171, v167
    v_mov_b32 v172, v168
    v_mov_b32 v173, v169
    v_permlane16_swap_b32 v166, v170
    v_permlane16_swap_b32 v167, v171
    v_permlane16_swap_b32 v168, v172
    v_permlane16_swap_b32 v169, v173
    v_add_f32 v166, v166, v170
    v_add_f32 v167, v167, v171
    v_add_f32 v168, v168, v172
    v_add_f32 v169, v169, v173
    v_mov_b32 v170, v166
    v_mov_b32 v171, v167
    v_mov_b32 v172, v168
    v_mov_b32 v173, v169
    v_permlane32_swap_b32 v166, v170
    v_permlane32_swap_b32 v167, v171
    v_permlane32_swap_b32 v168, v172
    v_permlane32_swap_b32 v169, v173
    v_add_f32 v166, v166, v170
    v_add_f32 v167, v167, v171
    v_add_f32 v168, v168, v172
    v_add_f32 v169, v169, v173
    v_and_b32 v194, 7, v19
    v_lshlrev_b32 v194, 4, v194
    v_add_u32 v194, 0, v194
    s_lshl_b32 s40, s5, 7
    v_add_u32 v195, s40, v194
    ds_write_b128 v195, v[166:169]
    s_cmp_lg_u32 s5, 0
    s_cbranch_scc1 L_back_o
    s_waitcnt vmcnt(5)
    v_min3_u32 v252, v252, v253, v254
    v_min_u32 v252, v252, v255
    v_cmp_gt_u32 vcc, 1, v252
    s_and_b64 vcc, vcc, exec
    s_cbranch_scc1 L_spin_o
L_back_o:
    s_waitcnt lgkmcnt(0)
    s_barrier
    s_add_u32 s44, s30, 0
    buffer_load_dwordx4 a[96:99], v4, s[8:11], s44 offen sc1
    buffer_load_dwordx4 a[100:103], v5, s[8:11], s44 offen sc1
    buffer_load_dwordx4 a[104:107], v6, s[8:11], s44 offen sc1
    buffer_load_dwordx4 a[108:111], v7, s[8:11], s44 offen sc1
    s_add_u32 s44, s30, 16384
    buffer_load_dwordx4 a[112:115], v4, s[8:11], s44 offen sc1
    buffer_load_dwordx4 a[116:119], v5, s[8:11], s44 offen sc1
    buffer_load_dwordx4 a[120:123], v6, s[8:11], s44 offen sc1
    buffer_load_dwordx4 a[124:127], v7, s[8:11], s44 offen sc1
    s_add_u32 s44, s30, 32768
    buffer_load_dwordx4 a[192:195], v4, s[8:11], s44 offen sc1
    buffer_load_dwordx4 a[196:199], v5, s[8:11], s44 offen sc1
    buffer_load_dwordx4 a[200:203], v6, s[8:11], s44 offen sc1
    buffer_load_dwordx4 a[204:207], v7, s[8:11], s44 offen sc1
    s_add_u32 s44, s30, 49152
    buffer_load_dwordx4 a[208:211], v4, s[8:11], s44 offen sc1
    buffer_load_dwordx4 a[212:215], v5, s[8:11], s44 offen sc1
    buffer_load_dwordx4 a[216:219], v6, s[8:11], s44 offen sc1
    buffer_load_dwordx4 a[220:223], v7, s[8:11], s44 offen sc1
    s_mov_b32 s45, 225280
    buffer_load_dwordx4 v[106:109], v16, s[20:23], s45 offen offset:0 sc1
    buffer_load_dwordx4 v[110:113], v16, s[20:23], s45 offen offset:1024 sc1
    buffer_load_dwordx4 v[114:117], v16, s[20:23], s45 offen offset:2048 sc1
    buffer_load_dwordx4 v[118:121], v16, s[20:23], s45 offen offset:3072 sc1
    buffer_load_dwordx4 v[122:125], v17, s[20:23], s45 offen offset:0 sc1
    s_cmp_lg_u32 s5, 0
    s_cbranch_scc1 L_summed
    ds_read_b128 v[166:169], v194 offset:0
    ds_read_b128 v[170:173], v194 offset:128
    ds_read_b128 v[174:177], v194 offset:256
    ds_read_b128 v[178:181], v194 offset:384
    s_mul_i32 s42, s6, 3277
    s_lshr_b32 s42, s42, 16
    s_min_u32 s42, s42, 7
    v_readlane_b32 s40, v3, s42
    s_and_b32 s40, s40, 0xffff0000
    s_ashr_i32 s41, s40, 31
    s_andn2_b32 s41, 0x7fff0000, s41
    s_or_b32 s41, s41, 0x80000000
    s_xor_b32 s40, s40, s41
    v_mov_b32 v182, 0xbfb8aa3b
    v_mul_f32 v182, s40, v182
    v_exp_f32 v182, v182
    s_nop 0
    v_add_f32 v182, 1.0, v182
    v_rcp_f32 v182, v182
    s_nop 0
    v_cvt_pk_bf16_f32 v182, v182, v182
    v_lshlrev_b32 v182, 16, v182
    s_lshl_b32 s40, s6, 6
    s_add_u32 s40, s40, 0x29c000
    s_cmp_lt_u32 s6, 160
    s_cselect_b32 s40, s40, 0x2500000
    v_lshlrev_b32 v183, 3, v19
    s_waitcnt lgkmcnt(0)
    v_add_f32 v166, v166, v170
    v_add_f32 v167, v167, v171
    v_add_f32 v168, v168, v172
    v_add_f32 v169, v169, v173
    v_add_f32 v166, v166, v174
    v_add_f32 v167, v167, v175
    v_add_f32 v168, v168, v176
    v_add_f32 v169, v169, v177
    v_add_f32 v166, v166, v178
    v_add_f32 v167, v167, v179
    v_add_f32 v168, v168, v180
    v_add_f32 v169, v169, v181
    v_cvt_pk_bf16_f32 v170, v166, v167
    v_cvt_pk_bf16_f32 v171, v168, v169
    v_lshlrev_b32 v166, 16, v170
    v_and_b32 v167, 0xffff0000, v170
    v_lshlrev_b32 v168, 16, v171
    v_and_b32 v169, 0xffff0000, v171
    v_mul_f32 v166, v166, v182
    v_mul_f32 v167, v167, v182
    v_mul_f32 v168, v168, v182
    v_mul_f32 v169, v169, v182
    v_cvt_pk_bf16_f32 v170, v166, v167
    v_cvt_pk_bf16_f32 v171, v168, v169
    s_mov_b64 exec, 0xff
    buffer_store_dwordx2 v[170:171], v183, s[76:79], s40 offen sc1
    s_mov_b64 exec, -1
L_summed:
    s_waitcnt vmcnt(13)
    v_mfma_f32_16x16x32_bf16 v[166:169], a[128:131], a[96:99], 0
    v_mfma_f32_16x16x32_bf16 v[166:169], a[148:151], a[112:115], v[166:169]
    s_add_u32 s44, s30, 65536
    buffer_load_dwordx4 a[224:227], v4, s[8:11], s44 offen sc1
    v_mfma_f32_16x16x32_bf16 v[186:189], a[148:151], a[116:119], 0
    v_mfma_f32_16x16x32_bf16 v[186:189], a[128:131], a[100:103], v[186:189]
    v_mfma_f32_16x16x32_bf16 v[206:209], a[128:131], a[104:107], 0
    buffer_load_dwordx4 a[228:231], v5, s[8:11], s44 offen sc1
    v_mfma_f32_16x16x32_bf16 v[206:209], a[148:151], a[120:123], v[206:209]
    v_mfma_f32_16x16x32_bf16 v[226:229], a[148:151], a[124:127], 0
    v_mfma_f32_16x16x32_bf16 v[226:229], a[128:131], a[108:111], v[226:229]
    v_mfma_f32_16x16x32_bf16 v[170:173], a[132:135], a[96:99], 0
    buffer_load_dwordx4 a[232:235], v6, s[8:11], s44 offen sc1
    v_mfma_f32_16x16x32_bf16 v[170:173], a[152:155], a[112:115], v[170:173]
    v_mfma_f32_16x16x32_bf16 v[190:193], a[152:155], a[116:119], 0
    v_mfma_f32_16x16x32_bf16 v[190:193], a[132:135], a[100:103], v[190:193]
    v_mfma_f32_16x16x32_bf16 v[210:213], a[132:135], a[104:107], 0
    buffer_load_dwordx4 a[236:239], v7, s[8:11], s44 offen sc1
    v_mfma_f32_16x16x32_bf16 v[210:213], a[152:155], a[120:123], v[210:213]
    v_mfma_f32_16x16x32_bf16 v[230:233], a[152:155], a[124:127], 0
    v_mfma_f32_16x16x32_bf16 v[230:233], a[132:135], a[108:111], v[230:233]
    v_mfma_f32_16x16x32_bf16 v[174:177], a[136:139], a[96:99], 0
    s_add_u32 s44, s30, 81920
    buffer_load_dwordx4 a[240:243], v4, s[8:11], s44 offen sc1
    v_mfma_f32_16x16x32_bf16 v[174:177], a[156:159], a[112:115], v[174:177]
    v_mfma_f32_16x16x32_bf16 v[194:197], a[156:159], a[116:119], 0
    v_mfma_f32_16x16x32_bf16 v[194:197], a[136:139], a[100:103], v[194:197]
    buffer_load_dwordx4 a[244:247], v5, s[8:11], s44 offen sc1
    v_mfma_f32_16x16x32_bf16 v[214:217], a[136:139], a[104:107], 0
    v_mfma_f32_16x16x32_bf16 v[214:217], a[156:159], a[120:123], v[214:217]
    v_mfma_f32_16x16x32_bf16 v[234:237], a[156:159], a[124:127], 0
    v_mfma_f32_16x16x32_bf16 v[234:237], a[136:139], a[108:111], v[234:237]
    buffer_load_dwordx4 a[248:251], v6, s[8:11], s44 offen sc1
    v_mfma_f32_16x16x32_bf16 v[178:181], a[140:143], a[96:99], 0
    v_mfma_f32_16x16x32_bf16 v[178:181], a[160:163], a[112:115], v[178:181]
    v_mfma_f32_16x16x32_bf16 v[198:201], a[160:163], a[116:119], 0
    v_mfma_f32_16x16x32_bf16 v[198:201], a[140:143], a[100:103], v[198:201]
    buffer_load_dwordx4 a[252:255], v7, s[8:11], s44 offen sc1
    v_mfma_f32_16x16x32_bf16 v[218:221], a[140:143], a[104:107], 0
    v_mfma_f32_16x16x32_bf16 v[218:221], a[160:163], a[120:123], v[218:221]
    v_mfma_f32_16x16x32_bf16 v[238:241], a[160:163], a[124:127], 0
    v_mfma_f32_16x16x32_bf16 v[238:241], a[140:143], a[108:111], v[238:241]
    v_mfma_f32_16x16x32_bf16 v[182:185], a[144:147], a[96:99], 0
    v_mfma_f32_16x16x32_bf16 v[182:185], a[164:167], a[112:115], v[182:185]
    v_mfma_f32_16x16x32_bf16 v[202:205], a[164:167], a[116:119], 0
    v_mfma_f32_16x16x32_bf16 v[202:205], a[144:147], a[100:103], v[202:205]
    v_mfma_f32_16x16x32_bf16 v[222:225], a[144:147], a[104:107], 0
    v_mfma_f32_16x16x32_bf16 v[222:225], a[164:167], a[120:123], v[222:225]
    v_mfma_f32_16x16x32_bf16 v[242:245], a[164:167], a[124:127], 0
    v_mfma_f32_16x16x32_bf16 v[242:245], a[144:147], a[108:111], v[242:245]
    s_waitcnt vmcnt(13)
    v_mfma_f32_16x16x32_bf16 v[166:169], a[168:171], a[192:195], v[166:169]
    v_mfma_f32_16x16x32_bf16 v[166:169], a[188:191], a[208:211], v[166:169]
    s_add_u32 s44, s30, 196608
    buffer_load_dwordx4 a[96:99], v4, s[8:11], s44 offen sc1
    v_mfma_f32_16x16x32_bf16 v[186:189], a[188:191], a[212:215], v[186:189]
    v_mfma_f32_16x16x32_bf16 v[186:189], a[168:171], a[196:199], v[186:189]
    v_mfma_f32_16x16x32_bf16 v[206:209], a[168:171], a[200:203], v[206:209]
    buffer_load_dwordx4 a[100:103], v5, s[8:11], s44 offen sc1
    v_mfma_f32_16x16x32_bf16 v[206:209], a[188:191], a[216:219], v[206:209]
    v_mfma_f32_16x16x32_bf16 v[226:229], a[188:191], a[220:223], v[226:229]
    v_mfma_f32_16x16x32_bf16 v[226:229], a[168:171], a[204:207], v[226:229]
    v_mfma_f32_16x16x32_bf16 v[170:173], a[172:175], a[192:195], v[170:173]
    buffer_load_dwordx4 a[104:107], v6, s[8:11], s44 offen sc1
    v_mfma_f32_16x16x32_bf16 v[170:173], a[0:3], a[208:211], v[170:173]
    v_mfma_f32_16x16x32_bf16 v[190:193], a[0:3], a[212:215], v[190:193]
    v_mfma_f32_16x16x32_bf16 v[190:193], a[172:175], a[196:199], v[190:193]
    v_mfma_f32_16x16x32_bf16 v[210:213], a[172:175], a[200:203], v[210:213]
    buffer_load_dwordx4 a[108:111], v7, s[8:11], s44 offen sc1
    v_mfma_f32_16x16x32_bf16 v[210:213], a[0:3], a[216:219], v[210:213]
    v_mfma_f32_16x16x32_bf16 v[230:233], a[0:3], a[220:223], v[230:233]
    v_mfma_f32_16x16x32_bf16 v[230:233], a[172:175], a[204:207], v[230:233]
    v_mfma_f32_16x16x32_bf16 v[174:177], a[176:179], a[192:195], v[174:177]
    s_add_u32 s44, s30, 212992
    buffer_load_dwordx4 a[112:115], v4, s[8:11], s44 offen sc1
    v_mfma_f32_16x16x32_bf16 v[174:177], a[4:7], a[208:211], v[174:177]
    v_mfma_f32_16x16x32_bf16 v[194:197], a[4:7], a[212:215], v[194:197]
    v_mfma_f32_16x16x32_bf16 v[194:197], a[176:179], a[196:199], v[194:197]
    buffer_load_dwordx4 a[116:119], v5, s[8:11], s44 offen sc1
    v_mfma_f32_16x16x32_bf16 v[214:217], a[176:179], a[200:203], v[214:217]
    v_mfma_f32_16x16x32_bf16 v[214:217], a[4:7], a[216:219], v[214:217]
    v_mfma_f32_16x16x32_bf16 v[234:237], a[4:7], a[220:223], v[234:237]
    v_mfma_f32_16x16x32_bf16 v[234:237], a[176:179], a[204:207], v[234:237]
    buffer_load_dwordx4 a[120:123], v6, s[8:11], s44 offen sc1
    v_mfma_f32_16x16x32_bf16 v[178:181], a[180:183], a[192:195], v[178:181]
    v_mfma_f32_16x16x32_bf16 v[178:181], a[8:11], a[208:211], v[178:181]
    v_mfma_f32_16x16x32_bf16 v[198:201], a[8:11], a[212:215], v[198:201]
    v_mfma_f32_16x16x32_bf16 v[198:201], a[180:183], a[196:199], v[198:201]
    buffer_load_dwordx4 a[124:127], v7, s[8:11], s44 offen sc1
    v_mfma_f32_16x16x32_bf16 v[218:221], a[180:183], a[200:203], v[218:221]
    v_mfma_f32_16x16x32_bf16 v[218:221], a[8:11], a[216:219], v[218:221]
    v_mfma_f32_16x16x32_bf16 v[238:241], a[8:11], a[220:223], v[238:241]
    v_mfma_f32_16x16x32_bf16 v[238:241], a[180:183], a[204:207], v[238:241]
    v_mfma_f32_16x16x32_bf16 v[182:185], a[184:187], a[192:195], v[182:185]
    v_mfma_f32_16x16x32_bf16 v[182:185], a[12:15], a[208:211], v[182:185]
    v_mfma_f32_16x16x32_bf16 v[202:205], a[12:15], a[212:215], v[202:205]
    v_mfma_f32_16x16x32_bf16 v[202:205], a[184:187], a[196:199], v[202:205]
    v_mfma_f32_16x16x32_bf16 v[222:225], a[184:187], a[200:203], v[222:225]
    v_mfma_f32_16x16x32_bf16 v[222:225], a[12:15], a[216:219], v[222:225]
    v_mfma_f32_16x16x32_bf16 v[242:245], a[12:15], a[220:223], v[242:245]
    v_mfma_f32_16x16x32_bf16 v[242:245], a[184:187], a[204:207], v[242:245]
    s_waitcnt vmcnt(8)
    v_mfma_f32_16x16x32_bf16 v[166:169], a[16:19], a[224:227], v[166:169]
    v_mfma_f32_16x16x32_bf16 v[166:169], a[36:39], a[240:243], v[166:169]
    s_add_u32 s44, s30, 98304
    buffer_load_dwordx4 a[192:195], v4, s[8:11], s44 offen sc1
    v_mfma_f32_16x16x32_bf16 v[186:189], a[36:39], a[244:247], v[186:189]
    ds_read_b128 v[126:129], v8 offset:0
    v_mfma_f32_16x16x32_bf16 v[186:189], a[16:19], a[228:231], v[186:189]
    v_mfma_f32_16x16x32_bf16 v[206:209], a[16:19], a[232:235], v[206:209]
    buffer_load_dwordx4 a[196:199], v5, s[8:11], s44 offen sc1
    v_mfma_f32_16x16x32_bf16 v[206:209], a[36:39], a[248:251], v[206:209]
    ds_read_b128 v[130:133], v8 offset:1024
    v_mfma_f32_16x16x32_bf16 v[226:229], a[36:39], a[252:255], v[226:229]
    v_mfma_f32_16x16x32_bf16 v[226:229], a[16:19], a[236:239], v[226:229]
    ds_read_b128 v[134:137], v8 offset:2048
    v_mfma_f32_16x16x32_bf16 v[170:173], a[20:23], a[224:227], v[170:173]
    buffer_load_dwordx4 a[200:203], v6, s[8:11], s44 offen sc1
    v_mfma_f32_16x16x32_bf16 v[170:173], a[40:43], a[240:243], v[170:173]
    v_mfma_f32_16x16x32_bf16 v[190:193], a[40:43], a[244:247], v[190:193]
    ds_read_b128 v[138:141], v8 offset:3072
    v_mfma_f32_16x16x32_bf16 v[190:193], a[20:23], a[228:231], v[190:193]
    v_mfma_f32_16x16x32_bf16 v[210:213], a[20:23], a[232:235], v[210:213]
    buffer_load_dwordx4 a[204:207], v7, s[8:11], s44 offen sc1
    v_mfma_f32_16x16x32_bf16 v[210:213], a[40:43], a[248:251], v[210:213]
    ds_read_b128 v[142:145], v8 offset:4096
    v_mfma_f32_16x16x32_bf16 v[230:233], a[40:43], a[252:255], v[230:233]
    v_mfma_f32_16x16x32_bf16 v[230:233], a[20:23], a[236:239], v[230:233]
    ds_read_b128 v[146:149], v8 offset:5120
    v_mfma_f32_16x16x32_bf16 v[174:177], a[24:27], a[224:227], v[174:177]
    s_add_u32 s44, s30, 114688
    buffer_load_dwordx4 a[208:211], v4, s[8:11], s44 offen sc1
    v_mfma_f32_16x16x32_bf16 v[174:177], a[44:47], a[240:243], v[174:177]
    v_mfma_f32_16x16x32_bf16 v[194:197], a[44:47], a[244:247], v[194:197]
    ds_read_b128 v[150:153], v8 offset:6144
    v_mfma_f32_16x16x32_bf16 v[194:197], a[24:27], a[228:231], v[194:197]
    buffer_load_dwordx4 a[212:215], v5, s[8:11], s44 offen sc1
    v_mfma_f32_16x16x32_bf16 v[214:217], a[24:27], a[232:235], v[214:217]
    v_mfma_f32_16x16x32_bf16 v[214:217], a[44:47], a[248:251], v[214:217]
    ds_read_b128 v[154:157], v8 offset:7168
    v_mfma_f32_16x16x32_bf16 v[234:237], a[44:47], a[252:255], v[234:237]
    v_mfma_f32_16x16x32_bf16 v[234:237], a[24:27], a[236:239], v[234:237]
    buffer_load_dwordx4 a[216:219], v6, s[8:11], s44 offen sc1
    v_mfma_f32_16x16x32_bf16 v[178:181], a[28:31], a[224:227], v[178:181]
    ds_read_b128 v[158:161], v8 offset:8192
    v_mfma_f32_16x16x32_bf16 v[178:181], a[48:51], a[240:243], v[178:181]
    v_mfma_f32_16x16x32_bf16 v[198:201], a[48:51], a[244:247], v[198:201]
    ds_read_b128 v[162:165], v8 offset:9216
    v_mfma_f32_16x16x32_bf16 v[198:201], a[28:31], a[228:231], v[198:201]
    buffer_load_dwordx4 a[220:223], v7, s[8:11], s44 offen sc1
    v_mfma_f32_16x16x32_bf16 v[218:221], a[28:31], a[232:235], v[218:221]
    v_mfma_f32_16x16x32_bf16 v[218:221], a[48:51], a[248:251], v[218:221]
    v_mfma_f32_16x16x32_bf16 v[238:241], a[48:51], a[252:255], v[238:241]
    v_mfma_f32_16x16x32_bf16 v[238:241], a[28:31], a[236:239], v[238:241]
    v_mfma_f32_16x16x32_bf16 v[182:185], a[32:35], a[224:227], v[182:185]
    v_mfma_f32_16x16x32_bf16 v[182:185], a[52:55], a[240:243], v[182:185]
    v_mfma_f32_16x16x32_bf16 v[202:205], a[52:55], a[244:247], v[202:205]
    v_mfma_f32_16x16x32_bf16 v[202:205], a[32:35], a[228:231], v[202:205]
    v_mfma_f32_16x16x32_bf16 v[222:225], a[32:35], a[232:235], v[222:225]
    v_mfma_f32_16x16x32_bf16 v[222:225], a[52:55], a[248:251], v[222:225]
    v_mfma_f32_16x16x32_bf16 v[242:245], a[52:55], a[252:255], v[242:245]
    v_mfma_f32_16x16x32_bf16 v[242:245], a[32:35], a[236:239], v[242:245]
    s_waitcnt vmcnt(8) lgkmcnt(0)
    v_mfma_f32_16x16x32_bf16 v[166:169], v[126:129], a[96:99], v[166:169]
    v_mfma_f32_16x16x32_bf16 v[166:169], v[146:149], a[112:115], v[166:169]
    s_add_u32 s44, s30, 229376
    buffer_load_dwordx4 a[224:227], v4, s[8:11], s44 offen sc1
    v_mfma_f32_16x16x32_bf16 v[186:189], v[146:149], a[116:119], v[186:189]
    v_mfma_f32_16x16x32_bf16 v[186:189], v[126:129], a[100:103], v[186:189]
    v_mfma_f32_16x16x32_bf16 v[206:209], v[126:129], a[104:107], v[206:209]
    buffer_load_dwordx4 a[228:231], v5, s[8:11], s44 offen sc1
    v_mfma_f32_16x16x32_bf16 v[206:209], v[146:149], a[120:123], v[206:209]
    v_mfma_f32_16x16x32_bf16 v[226:229], v[146:149], a[124:127], v[226:229]
    v_mfma_f32_16x16x32_bf16 v[226:229], v[126:129], a[108:111], v[226:229]
    v_mfma_f32_16x16x32_bf16 v[170:173], v[130:133], a[96:99], v[170:173]
    buffer_load_dwordx4 a[232:235], v6, s[8:11], s44 offen sc1
    v_mfma_f32_16x16x32_bf16 v[170:173], v[150:153], a[112:115], v[170:173]
    v_mfma_f32_16x16x32_bf16 v[190:193], v[150:153], a[116:119], v[190:193]
    v_mfma_f32_16x16x32_bf16 v[190:193], v[130:133], a[100:103], v[190:193]
    v_mfma_f32_16x16x32_bf16 v[210:213], v[130:133], a[104:107], v[210:213]
    buffer_load_dwordx4 a[236:239], v7, s[8:11], s44 offen sc1
    v_mfma_f32_16x16x32_bf16 v[210:213], v[150:153], a[120:123], v[210:213]
    v_mfma_f32_16x16x32_bf16 v[230:233], v[150:153], a[124:127], v[230:233]
    v_mfma_f32_16x16x32_bf16 v[230:233], v[130:133], a[108:111], v[230:233]
    v_mfma_f32_16x16x32_bf16 v[174:177], v[134:137], a[96:99], v[174:177]
    s_add_u32 s44, s30, 245760
    buffer_load_dwordx4 a[240:243], v4, s[8:11], s44 offen sc1
    v_mfma_f32_16x16x32_bf16 v[174:177], v[154:157], a[112:115], v[174:177]
    v_mfma_f32_16x16x32_bf16 v[194:197], v[154:157], a[116:119], v[194:197]
    v_mfma_f32_16x16x32_bf16 v[194:197], v[134:137], a[100:103], v[194:197]
    buffer_load_dwordx4 a[244:247], v5, s[8:11], s44 offen sc1
    v_mfma_f32_16x16x32_bf16 v[214:217], v[134:137], a[104:107], v[214:217]
    v_mfma_f32_16x16x32_bf16 v[214:217], v[154:157], a[120:123], v[214:217]
    v_mfma_f32_16x16x32_bf16 v[234:237], v[154:157], a[124:127], v[234:237]
    v_mfma_f32_16x16x32_bf16 v[234:237], v[134:137], a[108:111], v[234:237]
    buffer_load_dwordx4 a[248:251], v6, s[8:11], s44 offen sc1
    v_mfma_f32_16x16x32_bf16 v[178:181], v[138:141], a[96:99], v[178:181]
    v_mfma_f32_16x16x32_bf16 v[178:181], v[158:161], a[112:115], v[178:181]
    v_mfma_f32_16x16x32_bf16 v[198:201], v[158:161], a[116:119], v[198:201]
    v_mfma_f32_16x16x32_bf16 v[198:201], v[138:141], a[100:103], v[198:201]
    buffer_load_dwordx4 a[252:255], v7, s[8:11], s44 offen sc1
    v_mfma_f32_16x16x32_bf16 v[218:221], v[138:141], a[104:107], v[218:221]
    v_mfma_f32_16x16x32_bf16 v[218:221], v[158:161], a[120:123], v[218:221]
    v_mfma_f32_16x16x32_bf16 v[238:241], v[158:161], a[124:127], v[238:241]
    v_mfma_f32_16x16x32_bf16 v[238:241], v[138:141], a[108:111], v[238:241]
    v_mfma_f32_16x16x32_bf16 v[182:185], v[142:145], a[96:99], v[182:185]
    v_mfma_f32_16x16x32_bf16 v[182:185], v[162:165], a[112:115], v[182:185]
    v_mfma_f32_16x16x32_bf16 v[202:205], v[162:165], a[116:119], v[202:205]
    v_mfma_f32_16x16x32_bf16 v[202:205], v[142:145], a[100:103], v[202:205]
    v_mfma_f32_16x16x32_bf16 v[222:225], v[142:145], a[104:107], v[222:225]
    v_mfma_f32_16x16x32_bf16 v[222:225], v[162:165], a[120:123], v[222:225]
    v_mfma_f32_16x16x32_bf16 v[242:245], v[162:165], a[124:127], v[242:245]
    v_mfma_f32_16x16x32_bf16 v[242:245], v[142:145], a[108:111], v[242:245]
    s_waitcnt vmcnt(8)
    v_mfma_f32_16x16x32_bf16 v[166:169], a[56:59], a[192:195], v[166:169]
    v_mfma_f32_16x16x32_bf16 v[166:169], a[76:79], a[208:211], v[166:169]
    s_add_u32 s44, s30, 131072
    buffer_load_dwordx4 a[96:99], v4, s[8:11], s44 offen sc1
    v_mfma_f32_16x16x32_bf16 v[186:189], a[76:79], a[212:215], v[186:189]
    ds_read_b128 v[126:129], v9 offset:0
    v_mfma_f32_16x16x32_bf16 v[186:189], a[56:59], a[196:199], v[186:189]
    v_mfma_f32_16x16x32_bf16 v[206:209], a[56:59], a[200:203], v[206:209]
    buffer_load_dwordx4 a[100:103], v5, s[8:11], s44 offen sc1
    v_mfma_f32_16x16x32_bf16 v[206:209], a[76:79], a[216:219], v[206:209]
    ds_read_b128 v[130:133], v9 offset:1024
    v_mfma_f32_16x16x32_bf16 v[226:229], a[76:79], a[220:223], v[226:229]
    v_mfma_f32_16x16x32_bf16 v[226:229], a[56:59], a[204:207], v[226:229]
    ds_read_b128 v[134:137], v9 offset:2048
    v_mfma_f32_16x16x32_bf16 v[170:173], a[60:63], a[192:195], v[170:173]
    buffer_load_dwordx4 a[104:107], v6, s[8:11], s44 offen sc1
    v_mfma_f32_16x16x32_bf16 v[170:173], a[80:83], a[208:211], v[170:173]
    v_mfma_f32_16x16x32_bf16 v[190:193], a[80:83], a[212:215], v[190:193]
    ds_read_b128 v[138:141], v9 offset:3072
    v_mfma_f32_16x16x32_bf16 v[190:193], a[60:63], a[196:199], v[190:193]
    v_mfma_f32_16x16x32_bf16 v[210:213], a[60:63], a[200:203], v[210:213]
    buffer_load_dwordx4 a[108:111], v7, s[8:11], s44 offen sc1
    v_mfma_f32_16x16x32_bf16 v[210:213], a[80:83], a[216:219], v[210:213]
    ds_read_b128 v[142:145], v9 offset:4096
    v_mfma_f32_16x16x32_bf16 v[230:233], a[80:83], a[220:223], v[230:233]
    v_mfma_f32_16x16x32_bf16 v[230:233], a[60:63], a[204:207], v[230:233]
    ds_read_b128 v[146:149], v9 offset:5120
    v_mfma_f32_16x16x32_bf16 v[174:177], a[64:67], a[192:195], v[174:177]
    s_add_u32 s44, s30, 147456
    buffer_load_dwordx4 a[112:115], v4, s[8:11], s44 offen sc1
    v_mfma_f32_16x16x32_bf16 v[174:177], a[84:87], a[208:211], v[174:177]
    v_mfma_f32_16x16x32_bf16 v[194:197], a[84:87], a[212:215], v[194:197]
    ds_read_b128 v[150:153], v9 offset:6144
    v_mfma_f32_16x16x32_bf16 v[194:197], a[64:67], a[196:199], v[194:197]
    buffer_load_dwordx4 a[116:119], v5, s[8:11], s44 offen sc1
    v_mfma_f32_16x16x32_bf16 v[214:217], a[64:67], a[200:203], v[214:217]
    v_mfma_f32_16x16x32_bf16 v[214:217], a[84:87], a[216:219], v[214:217]
    ds_read_b128 v[154:157], v9 offset:7168
    v_mfma_f32_16x16x32_bf16 v[234:237], a[84:87], a[220:223], v[234:237]
    v_mfma_f32_16x16x32_bf16 v[234:237], a[64:67], a[204:207], v[234:237]
    buffer_load_dwordx4 a[120:123], v6, s[8:11], s44 offen sc1
    v_mfma_f32_16x16x32_bf16 v[178:181], a[68:71], a[192:195], v[178:181]
    ds_read_b128 v[158:161], v9 offset:8192
    v_mfma_f32_16x16x32_bf16 v[178:181], a[88:91], a[208:211], v[178:181]
    v_mfma_f32_16x16x32_bf16 v[198:201], a[88:91], a[212:215], v[198:201]
    ds_read_b128 v[162:165], v9 offset:9216
    v_mfma_f32_16x16x32_bf16 v[198:201], a[68:71], a[196:199], v[198:201]
    buffer_load_dwordx4 a[124:127], v7, s[8:11], s44 offen sc1
    v_mfma_f32_16x16x32_bf16 v[218:221], a[68:71], a[200:203], v[218:221]
    v_mfma_f32_16x16x32_bf16 v[218:221], a[88:91], a[216:219], v[218:221]
    v_mfma_f32_16x16x32_bf16 v[238:241], a[88:91], a[220:223], v[238:241]
    v_mfma_f32_16x16x32_bf16 v[238:241], a[68:71], a[204:207], v[238:241]
    v_mfma_f32_16x16x32_bf16 v[182:185], a[72:75], a[192:195], v[182:185]
    v_mfma_f32_16x16x32_bf16 v[182:185], a[92:95], a[208:211], v[182:185]
    v_mfma_f32_16x16x32_bf16 v[202:205], a[92:95], a[212:215], v[202:205]
    v_mfma_f32_16x16x32_bf16 v[202:205], a[72:75], a[196:199], v[202:205]
    v_mfma_f32_16x16x32_bf16 v[222:225], a[72:75], a[200:203], v[222:225]
    v_mfma_f32_16x16x32_bf16 v[222:225], a[92:95], a[216:219], v[222:225]
    v_mfma_f32_16x16x32_bf16 v[242:245], a[92:95], a[220:223], v[242:245]
    v_mfma_f32_16x16x32_bf16 v[242:245], a[72:75], a[204:207], v[242:245]
    s_waitcnt vmcnt(8) lgkmcnt(0)
    v_mfma_f32_16x16x32_bf16 v[166:169], v[126:129], a[224:227], v[166:169]
    v_mfma_f32_16x16x32_bf16 v[166:169], v[146:149], a[240:243], v[166:169]
    s_add_u32 s44, s30, 163840
    buffer_load_dwordx4 a[192:195], v4, s[8:11], s44 offen sc1
    s_lshl_b32 s36, s2, 5
    v_mfma_f32_16x16x32_bf16 v[186:189], v[146:149], a[244:247], v[186:189]
    v_mfma_f32_16x16x32_bf16 v[186:189], v[126:129], a[228:231], v[186:189]
    s_add_u32 s36, s36, s5
    v_mfma_f32_16x16x32_bf16 v[206:209], v[126:129], a[232:235], v[206:209]
    buffer_load_dwordx4 a[196:199], v5, s[8:11], s44 offen sc1
    v_mfma_f32_16x16x32_bf16 v[206:209], v[146:149], a[248:251], v[206:209]
    s_lshl_b32 s36, s36, 2
    v_mfma_f32_16x16x32_bf16 v[226:229], v[146:149], a[252:255], v[226:229]
    s_add_u32 s36, s36, 0x2a0000
    v_mfma_f32_16x16x32_bf16 v[226:229], v[126:129], a[236:239], v[226:229]
    v_mfma_f32_16x16x32_bf16 v[170:173], v[130:133], a[224:227], v[170:173]
    buffer_load_dwordx4 a[200:203], v6, s[8:11], s44 offen sc1
    s_xor_b32 s37, s36, 1024
    v_mfma_f32_16x16x32_bf16 v[170:173], v[150:153], a[240:243], v[170:173]
    v_mfma_f32_16x16x32_bf16 v[190:193], v[150:153], a[244:247], v[190:193]
    s_sub_u32 s40, s5, 1
    v_mfma_f32_16x16x32_bf16 v[190:193], v[130:133], a[228:231], v[190:193]
    v_mfma_f32_16x16x32_bf16 v[210:213], v[130:133], a[232:235], v[210:213]
    buffer_load_dwordx4 a[204:207], v7, s[8:11], s44 offen sc1
    s_and_b32 s40, s40, 3
    v_mfma_f32_16x16x32_bf16 v[210:213], v[150:153], a[248:251], v[210:213]
    s_mul_i32 s40, s40, 20480
    v_mfma_f32_16x16x32_bf16 v[230:233], v[150:153], a[252:255], v[230:233]
    v_mfma_f32_16x16x32_bf16 v[230:233], v[130:133], a[236:239], v[230:233]
    v_lshl_add_u32 v13, v19, 4, s40
    v_mfma_f32_16x16x32_bf16 v[174:177], v[134:137], a[224:227], v[174:177]
    s_add_u32 s44, s30, 180224
    buffer_load_dwordx4 a[208:211], v4, s[8:11], s44 offen sc1
    v_mfma_f32_16x16x32_bf16 v[174:177], v[154:157], a[240:243], v[174:177]
    s_sub_u32 s40, s5, 2
    v_mfma_f32_16x16x32_bf16 v[194:197], v[154:157], a[244:247], v[194:197]
    v_mfma_f32_16x16x32_bf16 v[194:197], v[134:137], a[228:231], v[194:197]
    buffer_load_dwordx4 a[212:215], v5, s[8:11], s44 offen sc1
    s_and_b32 s40, s40, 3
    v_mfma_f32_16x16x32_bf16 v[214:217], v[134:137], a[232:235], v[214:217]
    s_mul_i32 s40, s40, 20480
    v_mfma_f32_16x16x32_bf16 v[214:217], v[154:157], a[248:251], v[214:217]
    v_mfma_f32_16x16x32_bf16 v[234:237], v[154:157], a[252:255], v[234:237]
    v_lshl_add_u32 v14, v19, 4, s40
    v_mfma_f32_16x16x32_bf16 v[234:237], v[134:137], a[236:239], v[234:237]
    buffer_load_dwordx4 a[216:219], v6, s[8:11], s44 offen sc1
    v_mfma_f32_16x16x32_bf16 v[178:181], v[138:141], a[224:227], v[178:181]
    s_sub_u32 s40, s5, 3
    v_mfma_f32_16x16x32_bf16 v[178:181], v[158:161], a[240:243], v[178:181]
    v_mfma_f32_16x16x32_bf16 v[198:201], v[158:161], a[244:247], v[198:201]
    s_and_b32 s40, s40, 3
    v_mfma_f32_16x16x32_bf16 v[198:201], v[138:141], a[228:231], v[198:201]
    buffer_load_dwordx4 a[220:223], v7, s[8:11], s44 offen sc1
    s_mul_i32 s40, s40, 20480
    v_mfma_f32_16x16x32_bf16 v[218:221], v[138:141], a[232:235], v[218:221]
    v_mfma_f32_16x16x32_bf16 v[218:221], v[158:161], a[248:251], v[218:221]
    v_lshl_add_u32 v15, v19, 4, s40
    v_mfma_f32_16x16x32_bf16 v[238:241], v[158:161], a[252:255], v[238:241]
    v_mfma_f32_16x16x32_bf16 v[238:241], v[138:141], a[236:239], v[238:241]
    s_lshl_b32 s40, s2, 2
    v_mfma_f32_16x16x32_bf16 v[182:185], v[142:145], a[224:227], v[182:185]
    v_mfma_f32_16x16x32_bf16 v[182:185], v[162:165], a[240:243], v[182:185]
    s_add_u32 s40, s40, s5
    v_mfma_f32_16x16x32_bf16 v[202:205], v[162:165], a[244:247], v[202:205]
    s_mul_i32 s40, s40, 5120
    v_mfma_f32_16x16x32_bf16 v[202:205], v[142:145], a[228:231], v[202:205]
    v_mfma_f32_16x16x32_bf16 v[222:225], v[142:145], a[232:235], v[222:225]
    s_add_u32 s40, s40, 0x2000000
    v_mfma_f32_16x16x32_bf16 v[222:225], v[162:165], a[248:251], v[222:225]
    v_mfma_f32_16x16x32_bf16 v[242:245], v[162:165], a[252:255], v[242:245]
    v_lshl_add_u32 v18, v19, 4, s40
    v_mfma_f32_16x16x32_bf16 v[242:245], v[142:145], a[236:239], v[242:245]
    s_mov_b32 s41, 4096
    s_waitcnt vmcnt(8)
    v_mfma_f32_16x16x32_bf16 v[166:169], v[46:49], a[96:99], v[166:169]
    v_mfma_f32_16x16x32_bf16 v[166:169], v[66:69], a[112:115], v[166:169]
    s_add_u32 s44, s31, 0
    buffer_load_dwordx4 a[224:227], v4, s[8:11], s44 offen sc1
    v_mfma_f32_16x16x32_bf16 v[186:189], v[66:69], a[116:119], v[186:189]
    v_mfma_f32_16x16x32_bf16 v[186:189], v[46:49], a[100:103], v[186:189]
    v_mfma_f32_16x16x32_bf16 v[206:209], v[46:49], a[104:107], v[206:209]
    buffer_load_dwordx4 a[228:231], v5, s[8:11], s44 offen sc1
    v_mfma_f32_16x16x32_bf16 v[206:209], v[66:69], a[120:123], v[206:209]
    v_mfma_f32_16x16x32_bf16 v[226:229], v[66:69], a[124:127], v[226:229]
    v_mfma_f32_16x16x32_bf16 v[226:229], v[46:49], a[108:111], v[226:229]
    v_mfma_f32_16x16x32_bf16 v[170:173], v[50:53], a[96:99], v[170:173]
    buffer_load_dwordx4 a[232:235], v6, s[8:11], s44 offen sc1
    v_mfma_f32_16x16x32_bf16 v[170:173], v[70:73], a[112:115], v[170:173]
    v_mfma_f32_16x16x32_bf16 v[190:193], v[70:73], a[116:119], v[190:193]
    v_mfma_f32_16x16x32_bf16 v[190:193], v[50:53], a[100:103], v[190:193]
    v_mfma_f32_16x16x32_bf16 v[210:213], v[50:53], a[104:107], v[210:213]
    buffer_load_dwordx4 a[236:239], v7, s[8:11], s44 offen sc1
    v_mfma_f32_16x16x32_bf16 v[210:213], v[70:73], a[120:123], v[210:213]
    v_mfma_f32_16x16x32_bf16 v[230:233], v[70:73], a[124:127], v[230:233]
    v_mfma_f32_16x16x32_bf16 v[230:233], v[50:53], a[108:111], v[230:233]
    v_mfma_f32_16x16x32_bf16 v[174:177], v[54:57], a[96:99], v[174:177]
    s_add_u32 s44, s31, 16384
    buffer_load_dwordx4 a[240:243], v4, s[8:11], s44 offen sc1
    v_mfma_f32_16x16x32_bf16 v[174:177], v[74:77], a[112:115], v[174:177]
    v_mfma_f32_16x16x32_bf16 v[194:197], v[74:77], a[116:119], v[194:197]
    v_mfma_f32_16x16x32_bf16 v[194:197], v[54:57], a[100:103], v[194:197]
    buffer_load_dwordx4 a[244:247], v5, s[8:11], s44 offen sc1
    v_mfma_f32_16x16x32_bf16 v[214:217], v[54:57], a[104:107], v[214:217]
    v_mfma_f32_16x16x32_bf16 v[214:217], v[74:77], a[120:123], v[214:217]
    v_mfma_f32_16x16x32_bf16 v[234:237], v[74:77], a[124:127], v[234:237]
    v_mfma_f32_16x16x32_bf16 v[234:237], v[54:57], a[108:111], v[234:237]
    buffer_load_dwordx4 a[248:251], v6, s[8:11], s44 offen sc1
    v_mfma_f32_16x16x32_bf16 v[178:181], v[58:61], a[96:99], v[178:181]
    v_mfma_f32_16x16x32_bf16 v[178:181], v[78:81], a[112:115], v[178:181]
    v_mfma_f32_16x16x32_bf16 v[198:201], v[78:81], a[116:119], v[198:201]
    v_mfma_f32_16x16x32_bf16 v[198:201], v[58:61], a[100:103], v[198:201]
    buffer_load_dwordx4 a[252:255], v7, s[8:11], s44 offen sc1
    v_mfma_f32_16x16x32_bf16 v[218:221], v[58:61], a[104:107], v[218:221]
    v_mfma_f32_16x16x32_bf16 v[218:221], v[78:81], a[120:123], v[218:221]
    v_mfma_f32_16x16x32_bf16 v[238:241], v[78:81], a[124:127], v[238:241]
    v_mfma_f32_16x16x32_bf16 v[238:241], v[58:61], a[108:111], v[238:241]
    v_mfma_f32_16x16x32_bf16 v[182:185], v[62:65], a[96:99], v[182:185]
    v_mfma_f32_16x16x32_bf16 v[182:185], v[82:85], a[112:115], v[182:185]
    v_mfma_f32_16x16x32_bf16 v[202:205], v[82:85], a[116:119], v[202:205]
    v_mfma_f32_16x16x32_bf16 v[202:205], v[62:65], a[100:103], v[202:205]
    v_mfma_f32_16x16x32_bf16 v[222:225], v[62:65], a[104:107], v[222:225]
    v_mfma_f32_16x16x32_bf16 v[222:225], v[82:85], a[120:123], v[222:225]
    v_mfma_f32_16x16x32_bf16 v[242:245], v[82:85], a[124:127], v[242:245]
    v_mfma_f32_16x16x32_bf16 v[242:245], v[62:65], a[108:111], v[242:245]
    s_waitcnt vmcnt(8)
    v_mfma_f32_16x16x32_bf16 v[186:189], v[86:89], a[196:199], v[186:189]
    v_mfma_f32_16x16x32_bf16 v[186:189], v[106:109], a[212:215], v[186:189]
    s_add_u32 s44, s31, 32768
    buffer_load_dwordx4 a[96:99], v4, s[8:11], s44 offen sc1
    v_mfma_f32_16x16x32_bf16 v[190:193], v[110:113], a[212:215], v[190:193]
    v_mfma_f32_16x16x32_bf16 v[190:193], v[90:93], a[196:199], v[190:193]
    v_mfma_f32_16x16x32_bf16 v[194:197], v[94:97], a[196:199], v[194:197]
    buffer_load_dwordx4 a[100:103], v5, s[8:11], s44 offen sc1
    v_mfma_f32_16x16x32_bf16 v[194:197], v[114:117], a[212:215], v[194:197]
    v_mfma_f32_16x16x32_bf16 v[198:201], v[118:121], a[212:215], v[198:201]
    v_mfma_f32_16x16x32_bf16 v[198:201], v[98:101], a[196:199], v[198:201]
    v_mfma_f32_16x16x32_bf16 v[202:205], v[102:105], a[196:199], v[202:205]
    buffer_load_dwordx4 a[104:107], v6, s[8:11], s44 offen sc1
    v_mfma_f32_16x16x32_bf16 v[202:205], v[122:125], a[212:215], v[202:205]
    ds_write_b128 v10, v[186:189] offset:0
    v_mfma_f32_16x16x32_bf16 v[206:209], v[106:109], a[216:219], v[206:209]
    v_mfma_f32_16x16x32_bf16 v[206:209], v[86:89], a[200:203], v[206:209]
    ds_write_b128 v10, v[190:193] offset:1024
    v_mfma_f32_16x16x32_bf16 v[210:213], v[90:93], a[200:203], v[210:213]
    buffer_load_dwordx4 a[108:111], v7, s[8:11], s44 offen sc1
    v_mfma_f32_16x16x32_bf16 v[210:213], v[110:113], a[216:219], v[210:213]
    ds_write_b128 v10, v[194:197] offset:2048
    v_mfma_f32_16x16x32_bf16 v[214:217], v[114:117], a[216:219], v[214:217]
    v_mfma_f32_16x16x32_bf16 v[214:217], v[94:97], a[200:203], v[214:217]
    ds_write_b128 v10, v[198:201] offset:3072
    v_mfma_f32_16x16x32_bf16 v[218:221], v[98:101], a[200:203], v[218:221]
    s_add_u32 s44, s31, 49152
    buffer_load_dwordx4 a[112:115], v4, s[8:11], s44 offen sc1
    v_mfma_f32_16x16x32_bf16 v[218:221], v[118:121], a[216:219], v[218:221]
    ds_write_b128 v10, v[202:205] offset:4096
    v_mfma_f32_16x16x32_bf16 v[222:225], v[122:125], a[216:219], v[222:225]
    v_mfma_f32_16x16x32_bf16 v[222:225], v[102:105], a[200:203], v[222:225]
    ds_write_b128 v10, v[206:209] offset:5120
    buffer_load_dwordx4 a[116:119], v5, s[8:11], s44 offen sc1
    v_mfma_f32_16x16x32_bf16 v[226:229], v[86:89], a[204:207], v[226:229]
    v_mfma_f32_16x16x32_bf16 v[226:229], v[106:109], a[220:223], v[226:229]
    ds_write_b128 v10, v[210:213] offset:6144
    v_mfma_f32_16x16x32_bf16 v[230:233], v[110:113], a[220:223], v[230:233]
    v_mfma_f32_16x16x32_bf16 v[230:233], v[90:93], a[204:207], v[230:233]
    ds_write_b128 v10, v[214:217] offset:7168
    buffer_load_dwordx4 a[120:123], v6, s[8:11], s44 offen sc1
    v_mfma_f32_16x16x32_bf16 v[234:237], v[94:97], a[204:207], v[234:237]
    v_mfma_f32_16x16x32_bf16 v[234:237], v[114:117], a[220:223], v[234:237]
    ds_write_b128 v10, v[218:221] offset:8192
    v_mfma_f32_16x16x32_bf16 v[238:241], v[118:121], a[220:223], v[238:241]
    v_mfma_f32_16x16x32_bf16 v[238:241], v[98:101], a[204:207], v[238:241]
    ds_write_b128 v10, v[222:225] offset:9216
    buffer_load_dwordx4 a[124:127], v7, s[8:11], s44 offen sc1
    v_mfma_f32_16x16x32_bf16 v[242:245], v[102:105], a[204:207], v[242:245]
    v_mfma_f32_16x16x32_bf16 v[242:245], v[122:125], a[220:223], v[242:245]
    ds_write_b128 v10, v[226:229] offset:10240
    v_mfma_f32_16x16x32_bf16 v[166:169], v[106:109], a[208:211], v[166:169]
    v_mfma_f32_16x16x32_bf16 v[166:169], v[86:89], a[192:195], v[166:169]
    ds_write_b128 v10, v[230:233] offset:11264
    v_mfma_f32_16x16x32_bf16 v[170:173], v[90:93], a[192:195], v[170:173]
    v_mfma_f32_16x16x32_bf16 v[170:173], v[110:113], a[208:211], v[170:173]
    ds_write_b128 v10, v[234:237] offset:12288
    v_mfma_f32_16x16x32_bf16 v[174:177], v[114:117], a[208:211], v[174:177]
    v_mfma_f32_16x16x32_bf16 v[174:177], v[94:97], a[192:195], v[174:177]
    ds_write_b128 v10, v[238:241] offset:13312
    v_mfma_f32_16x16x32_bf16 v[178:181], v[98:101], a[192:195], v[178:181]
    v_mfma_f32_16x16x32_bf16 v[178:181], v[118:121], a[208:211], v[178:181]
    ds_write_b128 v10, v[242:245] offset:14336
    v_mfma_f32_16x16x32_bf16 v[182:185], v[122:125], a[208:211], v[182:185]
    v_mfma_f32_16x16x32_bf16 v[182:185], v[102:105], a[192:195], v[182:185]
    s_waitcnt vmcnt(8)
    v_mfma_f32_16x16x32_bf16 v[186:189], a[128:131], a[228:231], 0
    s_nop 0
    v_mov_b32 v126, v166
    v_mfma_f32_16x16x32_bf16 v[186:189], a[148:151], a[244:247], v[186:189]
    s_add_u32 s44, s31, 65536
    buffer_load_dwordx4 a[192:195], v4, s[8:11], s44 offen sc1
    v_mov_b32 v127, v167
    v_mov_b32 v128, v168
    v_mov_b32 v129, v169
    v_mfma_f32_16x16x32_bf16 v[190:193], a[152:155], a[244:247], 0
    v_mov_b32 v130, v170
    v_mov_b32 v131, v171
    v_mov_b32 v132, v172
    v_mfma_f32_16x16x32_bf16 v[190:193], a[132:135], a[228:231], v[190:193]
    v_mov_b32 v133, v173
    s_waitcnt lgkmcnt(0)
    s_barrier
    v_mfma_f32_16x16x32_bf16 v[194:197], a[136:139], a[228:231], 0
    buffer_load_dwordx4 a[196:199], v5, s[8:11], s44 offen sc1
    ds_read_b128 v[146:149], v13 offset:0
    ds_read_b128 v[150:153], v13 offset:1024
    v_mfma_f32_16x16x32_bf16 v[194:197], a[156:159], a[244:247], v[194:197]
    ds_read_b128 v[154:157], v13 offset:2048
    ds_read_b128 v[158:161], v13 offset:3072
    ds_read_b128 v[162:165], v13 offset:4096
    v_mfma_f32_16x16x32_bf16 v[198:201], a[160:163], a[244:247], 0
    v_mov_b32 v134, v174
    v_mov_b32 v135, v175
    v_mov_b32 v136, v176
    v_mfma_f32_16x16x32_bf16 v[198:201], a[140:143], a[228:231], v[198:201]
    v_mov_b32 v137, v177
    v_mov_b32 v138, v178
    v_mov_b32 v139, v179
    v_mfma_f32_16x16x32_bf16 v[202:205], a[144:147], a[228:231], 0
    buffer_load_dwordx4 a[200:203], v6, s[8:11], s44 offen sc1
    v_mov_b32 v140, v180
    v_mov_b32 v141, v181
    v_mfma_f32_16x16x32_bf16 v[202:205], a[164:167], a[244:247], v[202:205]
    v_mov_b32 v142, v182
    v_mov_b32 v143, v183
    v_mov_b32 v144, v184
    v_mfma_f32_16x16x32_bf16 v[206:209], a[148:151], a[248:251], 0
    v_mov_b32 v145, v185
    s_waitcnt lgkmcnt(4)
    v_add_f32 v126, v126, v146
    v_mfma_f32_16x16x32_bf16 v[206:209], a[128:131], a[232:235], v[206:209]
    v_add_f32 v127, v127, v147
    v_add_f32 v128, v128, v148
    v_add_f32 v129, v129, v149
    v_mfma_f32_16x16x32_bf16 v[210:213], a[132:135], a[232:235], 0
    buffer_load_dwordx4 a[204:207], v7, s[8:11], s44 offen sc1
    ds_read_b128 v[146:149], v14 offset:5120
    s_waitcnt lgkmcnt(4)
    v_mfma_f32_16x16x32_bf16 v[210:213], a[152:155], a[248:251], v[210:213]
    v_add_f32 v130, v130, v150
    v_add_f32 v131, v131, v151
    v_add_f32 v132, v132, v152
    v_mfma_f32_16x16x32_bf16 v[214:217], a[156:159], a[248:251], 0
    v_add_f32 v133, v133, v153
    ds_read_b128 v[150:153], v14 offset:6144
    s_waitcnt lgkmcnt(4)
    v_mfma_f32_16x16x32_bf16 v[214:217], a[136:139], a[232:235], v[214:217]
    v_add_f32 v134, v134, v154
    v_add_f32 v135, v135, v155
    v_add_f32 v136, v136, v156
    v_mfma_f32_16x16x32_bf16 v[218:221], a[140:143], a[232:235], 0
    s_add_u32 s44, s31, 81920
    buffer_load_dwordx4 a[208:211], v4, s[8:11], s44 offen sc1
    v_add_f32 v137, v137, v157
    ds_read_b128 v[154:157], v14 offset:7168
    v_mfma_f32_16x16x32_bf16 v[218:221], a[160:163], a[248:251], v[218:221]
    s_waitcnt lgkmcnt(4)
    v_add_f32 v138, v138, v158
    v_add_f32 v139, v139, v159
    v_mfma_f32_16x16x32_bf16 v[222:225], a[164:167], a[248:251], 0
    v_add_f32 v140, v140, v160
    v_add_f32 v141, v141, v161
    ds_read_b128 v[158:161], v14 offset:8192
    v_mfma_f32_16x16x32_bf16 v[222:225], a[144:147], a[232:235], v[222:225]
    buffer_load_dwordx4 a[212:215], v5, s[8:11], s44 offen sc1
    s_waitcnt lgkmcnt(4)
    v_add_f32 v142, v142, v162
    v_add_f32 v143, v143, v163
    v_mfma_f32_16x16x32_bf16 v[226:229], a[128:131], a[236:239], 0
    v_add_f32 v144, v144, v164
    v_add_f32 v145, v145, v165
    v_mfma_f32_16x16x32_bf16 v[226:229], a[148:151], a[252:255], v[226:229]
    ds_read_b128 v[162:165], v14 offset:9216
    s_waitcnt lgkmcnt(4)
    v_add_f32 v126, v126, v146
    v_mfma_f32_16x16x32_bf16 v[230:233], a[152:155], a[252:255], 0
    v_add_f32 v127, v127, v147
    v_add_f32 v128, v128, v148
    v_add_f32 v129, v129, v149
    v_mfma_f32_16x16x32_bf16 v[230:233], a[132:135], a[236:239], v[230:233]
    buffer_load_dwordx4 a[216:219], v6, s[8:11], s44 offen sc1
    ds_read_b128 v[146:149], v15 offset:10240
    s_waitcnt lgkmcnt(4)
    v_add_f32 v130, v130, v150
    v_mfma_f32_16x16x32_bf16 v[234:237], a[136:139], a[236:239], 0
    v_add_f32 v131, v131, v151
    v_add_f32 v132, v132, v152
    v_mfma_f32_16x16x32_bf16 v[234:237], a[156:159], a[252:255], v[234:237]
    v_add_f32 v133, v133, v153
    ds_read_b128 v[150:153], v15 offset:11264
    s_waitcnt lgkmcnt(4)
    v_mfma_f32_16x16x32_bf16 v[238:241], a[160:163], a[252:255], 0
    v_add_f32 v134, v134, v154
    v_add_f32 v135, v135, v155
    v_add_f32 v136, v136, v156
    v_mfma_f32_16x16x32_bf16 v[238:241], a[140:143], a[236:239], v[238:241]
    buffer_load_dwordx4 a[220:223], v7, s[8:11], s44 offen sc1
    v_add_f32 v137, v137, v157
    ds_read_b128 v[154:157], v15 offset:12288
    s_waitcnt lgkmcnt(4)
    v_mfma_f32_16x16x32_bf16 v[242:245], a[144:147], a[236:239], 0
    v_add_f32 v138, v138, v158
    v_add_f32 v139, v139, v159
    v_mfma_f32_16x16x32_bf16 v[242:245], a[164:167], a[252:255], v[242:245]
    v_add_f32 v140, v140, v160
    v_add_f32 v141, v141, v161
    ds_read_b128 v[158:161], v15 offset:13312
    v_mfma_f32_16x16x32_bf16 v[166:169], a[148:151], a[240:243], 0
    s_waitcnt lgkmcnt(4)
    v_add_f32 v142, v142, v162
    v_add_f32 v143, v143, v163
    v_mfma_f32_16x16x32_bf16 v[166:169], a[128:131], a[224:227], v[166:169]
    v_add_f32 v144, v144, v164
    v_add_f32 v145, v145, v165
    ds_read_b128 v[162:165], v15 offset:14336
    v_mfma_f32_16x16x32_bf16 v[170:173], a[132:135], a[224:227], 0
    s_waitcnt lgkmcnt(4)
    v_add_f32 v126, v126, v146
    v_mfma_f32_16x16x32_bf16 v[170:173], a[152:155], a[240:243], v[170:173]
    v_add_f32 v127, v127, v147
    v_add_f32 v128, v128, v148
    v_add_f32 v129, v129, v149
    v_mfma_f32_16x16x32_bf16 v[174:177], a[156:159], a[240:243], 0
    s_waitcnt lgkmcnt(3)
    v_add_f32 v130, v130, v150
    v_add_f32 v131, v131, v151
    v_mfma_f32_16x16x32_bf16 v[174:177], a[136:139], a[224:227], v[174:177]
    v_add_f32 v132, v132, v152
    v_add_f32 v133, v133, v153
    s_waitcnt lgkmcnt(2)
    v_mfma_f32_16x16x32_bf16 v[178:181], a[140:143], a[224:227], 0
    v_add_f32 v134, v134, v154
    v_add_f32 v135, v135, v155
    v_mfma_f32_16x16x32_bf16 v[178:181], a[160:163], a[240:243], v[178:181]
    v_add_f32 v136, v136, v156
    v_add_f32 v137, v137, v157
    s_waitcnt lgkmcnt(1)
    v_mfma_f32_16x16x32_bf16 v[182:185], a[164:167], a[240:243], 0
    v_add_f32 v138, v138, v158
    v_add_f32 v139, v139, v159
    v_add_f32 v140, v140, v160
    v_mfma_f32_16x16x32_bf16 v[182:185], a[144:147], a[224:227], v[182:185]
    v_add_f32 v141, v141, v161
    s_waitcnt lgkmcnt(0)
    v_add_f32 v142, v142, v162
    s_waitcnt vmcnt(8)
    v_mfma_f32_16x16x32_bf16 v[166:169], a[168:171], a[96:99], v[166:169]
    v_mfma_f32_16x16x32_bf16 v[166:169], a[188:191], a[112:115], v[166:169]
    s_add_u32 s44, s31, 196608
    buffer_load_dwordx4 a[224:227], v4, s[8:11], s44 offen sc1
    v_mfma_f32_16x16x32_bf16 v[186:189], a[188:191], a[116:119], v[186:189]
    buffer_load_dwordx4 a[228:231], v5, s[8:11], s44 offen sc1
    v_mfma_f32_16x16x32_bf16 v[186:189], a[168:171], a[100:103], v[186:189]
    buffer_load_dwordx4 a[232:235], v6, s[8:11], s44 offen sc1
    v_add_f32 v143, v143, v163
    v_mfma_f32_16x16x32_bf16 v[206:209], a[168:171], a[104:107], v[206:209]
    buffer_load_dwordx4 a[236:239], v7, s[8:11], s44 offen sc1
    v_mfma_f32_16x16x32_bf16 v[206:209], a[188:191], a[120:123], v[206:209]
    v_mfma_f32_16x16x32_bf16 v[226:229], a[188:191], a[124:127], v[226:229]
    s_add_u32 s44, s31, 212992
    buffer_load_dwordx4 a[240:243], v4, s[8:11], s44 offen sc1
    v_add_f32 v144, v144, v164
    v_mfma_f32_16x16x32_bf16 v[226:229], a[168:171], a[108:111], v[226:229]
    buffer_load_dwordx4 a[244:247], v5, s[8:11], s44 offen sc1
    v_mfma_f32_16x16x32_bf16 v[170:173], a[172:175], a[96:99], v[170:173]
    buffer_load_dwordx4 a[248:251], v6, s[8:11], s44 offen sc1
    v_mfma_f32_16x16x32_bf16 v[170:173], a[0:3], a[112:115], v[170:173]
    buffer_load_dwordx4 a[252:255], v7, s[8:11], s44 offen sc1
    v_add_f32 v145, v145, v165
    v_mfma_f32_16x16x32_bf16 v[190:193], a[0:3], a[116:119], v[190:193]
    v_mfma_f32_16x16x32_bf16 v[190:193], a[172:175], a[100:103], v[190:193]
    v_mfma_f32_16x16x32_bf16 v[210:213], a[172:175], a[104:107], v[210:213]
    buffer_store_dwordx4 v[126:129], v18, s[76:79], 0 offen offset:0 sc1
    v_mfma_f32_16x16x32_bf16 v[210:213], a[0:3], a[120:123], v[210:213]
    v_mfma_f32_16x16x32_bf16 v[230:233], a[0:3], a[124:127], v[230:233]
    v_mfma_f32_16x16x32_bf16 v[230:233], a[172:175], a[108:111], v[230:233]
    v_mfma_f32_16x16x32_bf16 v[174:177], a[176:179], a[96:99], v[174:177]
    v_mfma_f32_16x16x32_bf16 v[174:177], a[4:7], a[112:115], v[174:177]
    v_mfma_f32_16x16x32_bf16 v[194:197], a[4:7], a[116:119], v[194:197]
    buffer_store_dwordx4 v[130:133], v18, s[76:79], 0 offen offset:1024 sc1
    v_mfma_f32_16x16x32_bf16 v[194:197], a[176:179], a[100:103], v[194:197]
    v_mfma_f32_16x16x32_bf16 v[214:217], a[176:179], a[104:107], v[214:217]
    v_mfma_f32_16x16x32_bf16 v[214:217], a[4:7], a[120:123], v[214:217]
    v_mfma_f32_16x16x32_bf16 v[234:237], a[4:7], a[124:127], v[234:237]
    v_mfma_f32_16x16x32_bf16 v[234:237], a[176:179], a[108:111], v[234:237]
    v_mfma_f32_16x16x32_bf16 v[178:181], a[180:183], a[96:99], v[178:181]
    buffer_store_dwordx4 v[134:137], v18, s[76:79], 0 offen offset:2048 sc1
    v_mfma_f32_16x16x32_bf16 v[178:181], a[8:11], a[112:115], v[178:181]
    v_mfma_f32_16x16x32_bf16 v[198:201], a[8:11], a[116:119], v[198:201]
    v_mfma_f32_16x16x32_bf16 v[198:201], a[180:183], a[100:103], v[198:201]
    v_mfma_f32_16x16x32_bf16 v[218:221], a[180:183], a[104:107], v[218:221]
    v_mfma_f32_16x16x32_bf16 v[218:221], a[8:11], a[120:123], v[218:221]
    v_mfma_f32_16x16x32_bf16 v[238:241], a[8:11], a[124:127], v[238:241]
    buffer_store_dwordx4 v[138:141], v18, s[76:79], 0 offen offset:3072 sc1
    v_mfma_f32_16x16x32_bf16 v[238:241], a[180:183], a[108:111], v[238:241]
    v_mfma_f32_16x16x32_bf16 v[182:185], a[184:187], a[96:99], v[182:185]
    v_mfma_f32_16x16x32_bf16 v[182:185], a[12:15], a[112:115], v[182:185]
    v_mfma_f32_16x16x32_bf16 v[202:205], a[12:15], a[116:119], v[202:205]
    v_mfma_f32_16x16x32_bf16 v[202:205], a[184:187], a[100:103], v[202:205]
    v_mfma_f32_16x16x32_bf16 v[222:225], a[184:187], a[104:107], v[222:225]
    buffer_store_dwordx4 v[142:145], v18, s[76:79], s41 offen offset:0 sc1
    v_mfma_f32_16x16x32_bf16 v[222:225], a[12:15], a[120:123], v[222:225]
    v_mfma_f32_16x16x32_bf16 v[242:245], a[12:15], a[124:127], v[242:245]
    v_mfma_f32_16x16x32_bf16 v[242:245], a[184:187], a[108:111], v[242:245]
    s_waitcnt vmcnt(13)
    v_mfma_f32_16x16x32_bf16 v[166:169], a[16:19], a[192:195], v[166:169]
    v_mfma_f32_16x16x32_bf16 v[166:169], a[36:39], a[208:211], v[166:169]
    s_add_u32 s44, s31, 98304
    buffer_load_dwordx4 a[96:99], v4, s[8:11], s44 offen sc1
    v_mfma_f32_16x16x32_bf16 v[186:189], a[36:39], a[212:215], v[186:189]
    v_mfma_f32_16x16x32_bf16 v[186:189], a[16:19], a[196:199], v[186:189]
    v_mfma_f32_16x16x32_bf16 v[206:209], a[16:19], a[200:203], v[206:209]
    buffer_load_dwordx4 a[100:103], v5, s[8:11], s44 offen sc1
    v_mfma_f32_16x16x32_bf16 v[206:209], a[36:39], a[216:219], v[206:209]
    v_mfma_f32_16x16x32_bf16 v[226:229], a[36:39], a[220:223], v[226:229]
    v_mfma_f32_16x16x32_bf16 v[226:229], a[16:19], a[204:207], v[226:229]
    v_mfma_f32_16x16x32_bf16 v[170:173], a[20:23], a[192:195], v[170:173]
    buffer_load_dwordx4 a[104:107], v6, s[8:11], s44 offen sc1
    v_mfma_f32_16x16x32_bf16 v[170:173], a[40:43], a[208:211], v[170:173]
    v_mfma_f32_16x16x32_bf16 v[190:193], a[40:43], a[212:215], v[190:193]
    v_mfma_f32_16x16x32_bf16 v[190:193], a[20:23], a[196:199], v[190:193]
    v_mfma_f32_16x16x32_bf16 v[210:213], a[20:23], a[200:203], v[210:213]
    buffer_load_dwordx4 a[108:111], v7, s[8:11], s44 offen sc1
    v_mfma_f32_16x16x32_bf16 v[210:213], a[40:43], a[216:219], v[210:213]
    v_mfma_f32_16x16x32_bf16 v[230:233], a[40:43], a[220:223], v[230:233]
    v_mfma_f32_16x16x32_bf16 v[230:233], a[20:23], a[204:207], v[230:233]
    ds_read_b128 v[126:129], v8 offset:0
    v_mfma_f32_16x16x32_bf16 v[174:177], a[24:27], a[192:195], v[174:177]
    s_add_u32 s44, s31, 114688
    buffer_load_dwordx4 a[112:115], v4, s[8:11], s44 offen sc1
    v_mfma_f32_16x16x32_bf16 v[174:177], a[44:47], a[208:211], v[174:177]
    v_mfma_f32_16x16x32_bf16 v[194:197], a[44:47], a[212:215], v[194:197]
    ds_read_b128 v[130:133], v8 offset:1024
    v_mfma_f32_16x16x32_bf16 v[194:197], a[24:27], a[196:199], v[194:197]
    buffer_load_dwordx4 a[116:119], v5, s[8:11], s44 offen sc1
    v_mfma_f32_16x16x32_bf16 v[214:217], a[24:27], a[200:203], v[214:217]
    v_mfma_f32_16x16x32_bf16 v[214:217], a[44:47], a[216:219], v[214:217]
    ds_read_b128 v[134:137], v8 offset:2048
    v_mfma_f32_16x16x32_bf16 v[234:237], a[44:47], a[220:223], v[234:237]
    v_mfma_f32_16x16x32_bf16 v[234:237], a[24:27], a[204:207], v[234:237]
    buffer_load_dwordx4 a[120:123], v6, s[8:11], s44 offen sc1
    v_mfma_f32_16x16x32_bf16 v[178:181], a[28:31], a[192:195], v[178:181]
    ds_read_b128 v[138:141], v8 offset:3072
    v_mfma_f32_16x16x32_bf16 v[178:181], a[48:51], a[208:211], v[178:181]
    v_mfma_f32_16x16x32_bf16 v[198:201], a[48:51], a[212:215], v[198:201]
    ds_read_b128 v[142:145], v8 offset:4096
    v_mfma_f32_16x16x32_bf16 v[198:201], a[28:31], a[196:199], v[198:201]
    buffer_load_dwordx4 a[124:127], v7, s[8:11], s44 offen sc1
    v_mfma_f32_16x16x32_bf16 v[218:221], a[28:31], a[200:203], v[218:221]
    v_mfma_f32_16x16x32_bf16 v[218:221], a[48:51], a[216:219], v[218:221]
    ds_read_b128 v[146:149], v8 offset:5120
    v_mfma_f32_16x16x32_bf16 v[238:241], a[48:51], a[220:223], v[238:241]
    v_mfma_f32_16x16x32_bf16 v[238:241], a[28:31], a[204:207], v[238:241]
    ds_read_b128 v[150:153], v8 offset:6144
    v_mfma_f32_16x16x32_bf16 v[182:185], a[32:35], a[192:195], v[182:185]
    v_mfma_f32_16x16x32_bf16 v[182:185], a[52:55], a[208:211], v[182:185]
    ds_read_b128 v[154:157], v8 offset:7168
    v_mfma_f32_16x16x32_bf16 v[202:205], a[52:55], a[212:215], v[202:205]
    v_mfma_f32_16x16x32_bf16 v[202:205], a[32:35], a[196:199], v[202:205]
    ds_read_b128 v[158:161], v8 offset:8192
    v_mfma_f32_16x16x32_bf16 v[222:225], a[32:35], a[200:203], v[222:225]
    v_mfma_f32_16x16x32_bf16 v[222:225], a[52:55], a[216:219], v[222:225]
    ds_read_b128 v[162:165], v8 offset:9216
    v_mfma_f32_16x16x32_bf16 v[242:245], a[52:55], a[220:223], v[242:245]
    buffer_load_dwordx2 v[20:21], v11, s[76:79], 0 offen offset:0 sc1
    buffer_load_dwordx2 v[246:247], v11, s[76:79], 0 offen offset:32 sc1
    buffer_load_dwordx2 v[248:249], v11, s[76:79], 0 offen offset:64 sc1
    buffer_load_dwordx2 v[252:253], v11, s[76:79], 0 offen offset:96 sc1
    buffer_load_dwordx2 v[254:255], v11, s[76:79], 0 offen offset:128 sc1
    v_mfma_f32_16x16x32_bf16 v[242:245], a[32:35], a[204:207], v[242:245]
    s_waitcnt vmcnt(18) lgkmcnt(0)
    v_mfma_f32_16x16x32_bf16 v[166:169], v[126:129], a[224:227], v[166:169]
    s_waitcnt vmcnt(13)
    s_mov_b64 exec, 1
    buffer_store_dword v2, off, s[76:79], s36 sc1
    s_mov_b64 exec, -1
    v_mfma_f32_16x16x32_bf16 v[166:169], v[146:149], a[240:243], v[166:169]
    s_add_u32 s44, s31, 229376
    buffer_load_dwordx4 a[192:195], v4, s[8:11], s44 offen sc1
    v_mfma_f32_16x16x32_bf16 v[186:189], v[146:149], a[244:247], v[186:189]
    v_mfma_f32_16x16x32_bf16 v[186:189], v[126:129], a[228:231], v[186:189]
    v_mfma_f32_16x16x32_bf16 v[206:209], v[126:129], a[232:235], v[206:209]
    buffer_load_dwordx4 a[196:199], v5, s[8:11], s44 offen sc1
    v_mfma_f32_16x16x32_bf16 v[206:209], v[146:149], a[248:251], v[206:209]
    v_mfma_f32_16x16x32_bf16 v[226:229], v[146:149], a[252:255], v[226:229]
    v_mfma_f32_16x16x32_bf16 v[226:229], v[126:129], a[236:239], v[226:229]
    v_mfma_f32_16x16x32_bf16 v[170:173], v[130:133], a[224:227], v[170:173]
    buffer_load_dwordx4 a[200:203], v6, s[8:11], s44 offen sc1
    v_mfma_f32_16x16x32_bf16 v[170:173], v[150:153], a[240:243], v[170:173]
    v_mfma_f32_16x16x32_bf16 v[190:193], v[150:153], a[244:247], v[190:193]
    v_mfma_f32_16x16x32_bf16 v[190:193], v[130:133], a[228:231], v[190:193]
    v_mfma_f32_16x16x32_bf16 v[210:213], v[130:133], a[232:235], v[210:213]
    buffer_load_dwordx4 a[204:207], v7, s[8:11], s44 offen sc1
    v_mfma_f32_16x16x32_bf16 v[210:213], v[150:153], a[248:251], v[210:213]
    v_mfma_f32_16x16x32_bf16 v[230:233], v[150:153], a[252:255], v[230:233]
    v_mfma_f32_16x16x32_bf16 v[230:233], v[130:133], a[236:239], v[230:233]
    v_mfma_f32_16x16x32_bf16 v[174:177], v[134:137], a[224:227], v[174:177]
    s_add_u32 s44, s31, 245760
    buffer_load_dwordx4 a[208:211], v4, s[8:11], s44 offen sc1
    v_mfma_f32_16x16x32_bf16 v[174:177], v[154:157], a[240:243], v[174:177]
    v_mfma_f32_16x16x32_bf16 v[194:197], v[154:157], a[244:247], v[194:197]
    v_mfma_f32_16x16x32_bf16 v[194:197], v[134:137], a[228:231], v[194:197]
    buffer_load_dwordx4 a[212:215], v5, s[8:11], s44 offen sc1
    v_mfma_f32_16x16x32_bf16 v[214:217], v[134:137], a[232:235], v[214:217]
    v_mfma_f32_16x16x32_bf16 v[214:217], v[154:157], a[248:251], v[214:217]
    v_mfma_f32_16x16x32_bf16 v[234:237], v[154:157], a[252:255], v[234:237]
    v_mfma_f32_16x16x32_bf16 v[234:237], v[134:137], a[236:239], v[234:237]
    buffer_load_dwordx4 a[216:219], v6, s[8:11], s44 offen sc1
    v_mfma_f32_16x16x32_bf16 v[178:181], v[138:141], a[224:227], v[178:181]
    v_mfma_f32_16x16x32_bf16 v[178:181], v[158:161], a[240:243], v[178:181]
    v_mfma_f32_16x16x32_bf16 v[198:201], v[158:161], a[244:247], v[198:201]
    v_mfma_f32_16x16x32_bf16 v[198:201], v[138:141], a[228:231], v[198:201]
    buffer_load_dwordx4 a[220:223], v7, s[8:11], s44 offen sc1
    v_mfma_f32_16x16x32_bf16 v[218:221], v[138:141], a[232:235], v[218:221]
    v_mfma_f32_16x16x32_bf16 v[218:221], v[158:161], a[248:251], v[218:221]
    v_mfma_f32_16x16x32_bf16 v[238:241], v[158:161], a[252:255], v[238:241]
    v_mfma_f32_16x16x32_bf16 v[238:241], v[138:141], a[236:239], v[238:241]
    v_mfma_f32_16x16x32_bf16 v[182:185], v[142:145], a[224:227], v[182:185]
    v_mfma_f32_16x16x32_bf16 v[182:185], v[162:165], a[240:243], v[182:185]
    v_mfma_f32_16x16x32_bf16 v[202:205], v[162:165], a[244:247], v[202:205]
    v_mfma_f32_16x16x32_bf16 v[202:205], v[142:145], a[228:231], v[202:205]
    v_mfma_f32_16x16x32_bf16 v[222:225], v[142:145], a[232:235], v[222:225]
    v_mfma_f32_16x16x32_bf16 v[222:225], v[162:165], a[248:251], v[222:225]
    v_mfma_f32_16x16x32_bf16 v[242:245], v[162:165], a[252:255], v[242:245]
    v_mfma_f32_16x16x32_bf16 v[242:245], v[142:145], a[236:239], v[242:245]
    s_waitcnt vmcnt(14)
    v_mfma_f32_16x16x32_bf16 v[166:169], a[56:59], a[96:99], v[166:169]
    v_mfma_f32_16x16x32_bf16 v[166:169], a[76:79], a[112:115], v[166:169]
    s_add_u32 s44, s31, 131072
    buffer_load_dwordx4 a[224:227], v4, s[8:11], s44 offen sc1
    v_mfma_f32_16x16x32_bf16 v[186:189], a[76:79], a[116:119], v[186:189]
    ds_read_b128 v[126:129], v9 offset:0
    v_mfma_f32_16x16x32_bf16 v[186:189], a[56:59], a[100:103], v[186:189]
    v_mfma_f32_16x16x32_bf16 v[206:209], a[56:59], a[104:107], v[206:209]
    buffer_load_dwordx4 a[228:231], v5, s[8:11], s44 offen sc1
    v_mfma_f32_16x16x32_bf16 v[206:209], a[76:79], a[120:123], v[206:209]
    ds_read_b128 v[130:133], v9 offset:1024
    v_mfma_f32_16x16x32_bf16 v[226:229], a[76:79], a[124:127], v[226:229]
    v_mfma_f32_16x16x32_bf16 v[226:229], a[56:59], a[108:111], v[226:229]
    ds_read_b128 v[134:137], v9 offset:2048
    v_mfma_f32_16x16x32_bf16 v[170:173], a[60:63], a[96:99], v[170:173]
    buffer_load_dwordx4 a[232:235], v6, s[8:11], s44 offen sc1
    v_mfma_f32_16x16x32_bf16 v[170:173], a[80:83], a[112:115], v[170:173]
    v_mfma_f32_16x16x32_bf16 v[190:193], a[80:83], a[116:119], v[190:193]
    ds_read_b128 v[138:141], v9 offset:3072
    v_mfma_f32_16x16x32_bf16 v[190:193], a[60:63], a[100:103], v[190:193]
    v_mfma_f32_16x16x32_bf16 v[210:213], a[60:63], a[104:107], v[210:213]
    buffer_load_dwordx4 a[236:239], v7, s[8:11], s44 offen sc1
    v_mfma_f32_16x16x32_bf16 v[210:213], a[80:83], a[120:123], v[210:213]
    ds_read_b128 v[142:145], v9 offset:4096
    v_mfma_f32_16x16x32_bf16 v[230:233], a[80:83], a[124:127], v[230:233]
    v_mfma_f32_16x16x32_bf16 v[230:233], a[60:63], a[108:111], v[230:233]
    ds_read_b128 v[146:149], v9 offset:5120
    v_mfma_f32_16x16x32_bf16 v[174:177], a[64:67], a[96:99], v[174:177]
    s_add_u32 s44, s31, 147456
    buffer_load_dwordx4 a[240:243], v4, s[8:11], s44 offen sc1
    v_mfma_f32_16x16x32_bf16 v[174:177], a[84:87], a[112:115], v[174:177]
    v_mfma_f32_16x16x32_bf16 v[194:197], a[84:87], a[116:119], v[194:197]
    ds_read_b128 v[150:153], v9 offset:6144
    v_mfma_f32_16x16x32_bf16 v[194:197], a[64:67], a[100:103], v[194:197]
    buffer_load_dwordx4 a[244:247], v5, s[8:11], s44 offen sc1
    v_mfma_f32_16x16x32_bf16 v[214:217], a[64:67], a[104:107], v[214:217]
    v_mfma_f32_16x16x32_bf16 v[214:217], a[84:87], a[120:123], v[214:217]
    ds_read_b128 v[154:157], v9 offset:7168
    v_mfma_f32_16x16x32_bf16 v[234:237], a[84:87], a[124:127], v[234:237]
    v_mfma_f32_16x16x32_bf16 v[234:237], a[64:67], a[108:111], v[234:237]
    buffer_load_dwordx4 a[248:251], v6, s[8:11], s44 offen sc1
    v_mfma_f32_16x16x32_bf16 v[178:181], a[68:71], a[96:99], v[178:181]
    ds_read_b128 v[158:161], v9 offset:8192
    v_mfma_f32_16x16x32_bf16 v[178:181], a[88:91], a[112:115], v[178:181]
    v_mfma_f32_16x16x32_bf16 v[198:201], a[88:91], a[116:119], v[198:201]
    ds_read_b128 v[162:165], v9 offset:9216
    v_mfma_f32_16x16x32_bf16 v[198:201], a[68:71], a[100:103], v[198:201]
    buffer_load_dwordx4 a[252:255], v7, s[8:11], s44 offen sc1
    v_mfma_f32_16x16x32_bf16 v[218:221], a[68:71], a[104:107], v[218:221]
    v_mfma_f32_16x16x32_bf16 v[218:221], a[88:91], a[120:123], v[218:221]
    v_mfma_f32_16x16x32_bf16 v[238:241], a[88:91], a[124:127], v[238:241]
    v_mfma_f32_16x16x32_bf16 v[238:241], a[68:71], a[108:111], v[238:241]
    v_mfma_f32_16x16x32_bf16 v[182:185], a[72:75], a[96:99], v[182:185]
    v_mfma_f32_16x16x32_bf16 v[182:185], a[92:95], a[112:115], v[182:185]
    v_mfma_f32_16x16x32_bf16 v[202:205], a[92:95], a[116:119], v[202:205]
    v_mfma_f32_16x16x32_bf16 v[202:205], a[72:75], a[100:103], v[202:205]
    v_mfma_f32_16x16x32_bf16 v[222:225], a[72:75], a[104:107], v[222:225]
    v_mfma_f32_16x16x32_bf16 v[222:225], a[92:95], a[120:123], v[222:225]
    v_mfma_f32_16x16x32_bf16 v[242:245], a[92:95], a[124:127], v[242:245]
    v_mfma_f32_16x16x32_bf16 v[242:245], a[72:75], a[108:111], v[242:245]
    s_waitcnt vmcnt(8) lgkmcnt(0)
    v_mfma_f32_16x16x32_bf16 v[166:169], v[126:129], a[192:195], v[166:169]
    v_max3_u32 v1, v20, v21, v246
    v_max3_u32 v1, v1, v247, v248
    v_max3_u32 v1, v1, v249, v252
    v_max3_u32 v1, v1, v253, v254
    v_max_u32 v1, v1, v255
    v_cmp_eq_u32 vcc, -1, v1
    s_and_b64 vcc, vcc, exec
    s_cbranch_scc1 L_spin_upd
L_back_upd:
    v_mfma_f32_16x16x32_bf16 v[166:169], v[146:149], a[208:211], v[166:169]
    s_add_u32 s44, s31, 163840
    buffer_load_dwordx4 a[96:99], v4, s[8:11], s44 offen sc1
    v_mfma_f32_16x16x32_bf16 v[186:189], v[146:149], a[212:215], v[186:189]
    v_mfma_f32_16x16x32_bf16 v[186:189], v[126:129], a[196:199], v[186:189]
    v_mfma_f32_16x16x32_bf16 v[206:209], v[126:129], a[200:203], v[206:209]
    buffer_load_dwordx4 a[100:103], v5, s[8:11], s44 offen sc1
    v_mfma_f32_16x16x32_bf16 v[206:209], v[146:149], a[216:219], v[206:209]
    v_mfma_f32_16x16x32_bf16 v[226:229], v[146:149], a[220:223], v[226:229]
    v_mfma_f32_16x16x32_bf16 v[226:229], v[126:129], a[204:207], v[226:229]
    v_mfma_f32_16x16x32_bf16 v[170:173], v[130:133], a[192:195], v[170:173]
    buffer_load_dwordx4 a[104:107], v6, s[8:11], s44 offen sc1
    v_mfma_f32_16x16x32_bf16 v[170:173], v[150:153], a[208:211], v[170:173]
    v_mfma_f32_16x16x32_bf16 v[190:193], v[150:153], a[212:215], v[190:193]
    v_mfma_f32_16x16x32_bf16 v[190:193], v[130:133], a[196:199], v[190:193]
    v_mfma_f32_16x16x32_bf16 v[210:213], v[130:133], a[200:203], v[210:213]
    buffer_load_dwordx4 a[108:111], v7, s[8:11], s44 offen sc1
    v_mfma_f32_16x16x32_bf16 v[210:213], v[150:153], a[216:219], v[210:213]
    v_mfma_f32_16x16x32_bf16 v[230:233], v[150:153], a[220:223], v[230:233]
    v_mfma_f32_16x16x32_bf16 v[230:233], v[130:133], a[204:207], v[230:233]
    v_mfma_f32_16x16x32_bf16 v[174:177], v[134:137], a[192:195], v[174:177]
    s_add_u32 s44, s31, 180224
    buffer_load_dwordx4 a[112:115], v4, s[8:11], s44 offen sc1
    v_mfma_f32_16x16x32_bf16 v[174:177], v[154:157], a[208:211], v[174:177]
    v_mfma_f32_16x16x32_bf16 v[194:197], v[154:157], a[212:215], v[194:197]
    v_mfma_f32_16x16x32_bf16 v[194:197], v[134:137], a[196:199], v[194:197]
    buffer_load_dwordx4 a[116:119], v5, s[8:11], s44 offen sc1
    v_mfma_f32_16x16x32_bf16 v[214:217], v[134:137], a[200:203], v[214:217]
    v_mfma_f32_16x16x32_bf16 v[214:217], v[154:157], a[216:219], v[214:217]
    v_mfma_f32_16x16x32_bf16 v[234:237], v[154:157], a[220:223], v[234:237]
    v_mfma_f32_16x16x32_bf16 v[234:237], v[134:137], a[204:207], v[234:237]
    buffer_load_dwordx4 a[120:123], v6, s[8:11], s44 offen sc1
    v_mfma_f32_16x16x32_bf16 v[178:181], v[138:141], a[192:195], v[178:181]
    v_mfma_f32_16x16x32_bf16 v[178:181], v[158:161], a[208:211], v[178:181]
    v_mfma_f32_16x16x32_bf16 v[198:201], v[158:161], a[212:215], v[198:201]
    v_mfma_f32_16x16x32_bf16 v[198:201], v[138:141], a[196:199], v[198:201]
    buffer_load_dwordx4 a[124:127], v7, s[8:11], s44 offen sc1
    v_mfma_f32_16x16x32_bf16 v[218:221], v[138:141], a[200:203], v[218:221]
    v_mfma_f32_16x16x32_bf16 v[218:221], v[158:161], a[216:219], v[218:221]
    v_mfma_f32_16x16x32_bf16 v[238:241], v[158:161], a[220:223], v[238:241]
    v_mfma_f32_16x16x32_bf16 v[238:241], v[138:141], a[204:207], v[238:241]
    v_mfma_f32_16x16x32_bf16 v[182:185], v[142:145], a[192:195], v[182:185]
    v_mfma_f32_16x16x32_bf16 v[182:185], v[162:165], a[208:211], v[182:185]
    v_mfma_f32_16x16x32_bf16 v[202:205], v[162:165], a[212:215], v[202:205]
    v_mfma_f32_16x16x32_bf16 v[202:205], v[142:145], a[196:199], v[202:205]
    v_mfma_f32_16x16x32_bf16 v[222:225], v[142:145], a[200:203], v[222:225]
    v_mfma_f32_16x16x32_bf16 v[222:225], v[162:165], a[216:219], v[222:225]
    v_mfma_f32_16x16x32_bf16 v[242:245], v[162:165], a[220:223], v[242:245]
    s_sub_u32 s40, s5, 1
    s_and_b32 s40, s40, 3
    s_mul_i32 s40, s40, 10240
    s_add_u32 s40, s40, 122880
    v_lshl_add_u32 v5, v19, 4, s40
    s_sub_u32 s40, s5, 2
    s_and_b32 s40, s40, 3
    s_mul_i32 s40, s40, 10240
    s_add_u32 s40, s40, 122880
    v_lshl_add_u32 v6, v19, 4, s40
    s_sub_u32 s40, s5, 3
    s_and_b32 s40, s40, 3
    s_mul_i32 s40, s40, 10240
    s_add_u32 s40, s40, 81920
    v_lshl_add_u32 v7, v19, 4, s40
    buffer_load_dword v1, off, s[76:79], s37 sc1
    v_mfma_f32_16x16x32_bf16 v[242:245], v[142:145], a[204:207], v[242:245]
    s_waitcnt vmcnt(9)
    v_mfma_f32_16x16x32_bf16 v[166:169], v[46:49], a[224:227], v[166:169]
    v_mfma_f32_16x16x32_bf16 v[166:169], v[66:69], a[240:243], v[166:169]
    v_lshlrev_b32 v126, 16, v36
    v_and_b32 v127, 0xffff0000, v36
    v_lshlrev_b32 v146, 16, v20
    v_and_b32 v147, 0xffff0000, v20
    v_mfma_f32_16x16x32_bf16 v[186:189], v[66:69], a[244:247], v[186:189]
    v_lshlrev_b32 v128, 16, v37
    v_and_b32 v129, 0xffff0000, v37
    v_lshlrev_b32 v148, 16, v21
    v_and_b32 v149, 0xffff0000, v21
    v_lshlrev_b32 v130, 16, v38
    v_mfma_f32_16x16x32_bf16 v[186:189], v[46:49], a[228:231], v[186:189]
    v_and_b32 v131, 0xffff0000, v38
    v_lshlrev_b32 v150, 16, v246
    v_and_b32 v151, 0xffff0000, v246
    v_lshlrev_b32 v132, 16, v39
    v_mfma_f32_16x16x32_bf16 v[206:209], v[46:49], a[232:235], v[206:209]
    v_and_b32 v133, 0xffff0000, v39
    v_lshlrev_b32 v152, 16, v247
    v_and_b32 v153, 0xffff0000, v247
    v_lshlrev_b32 v134, 16, v40
    v_and_b32 v135, 0xffff0000, v40
    v_mfma_f32_16x16x32_bf16 v[206:209], v[66:69], a[248:251], v[206:209]
    v_lshlrev_b32 v154, 16, v248
    v_and_b32 v155, 0xffff0000, v248
    v_lshlrev_b32 v136, 16, v41
    v_and_b32 v137, 0xffff0000, v41
    v_lshlrev_b32 v156, 16, v249
    v_mfma_f32_16x16x32_bf16 v[226:229], v[66:69], a[252:255], v[226:229]
    v_and_b32 v157, 0xffff0000, v249
    v_lshlrev_b32 v138, 16, v42
    v_and_b32 v139, 0xffff0000, v42
    v_lshlrev_b32 v158, 16, v252
    v_mfma_f32_16x16x32_bf16 v[226:229], v[46:49], a[236:239], v[226:229]
    v_and_b32 v159, 0xffff0000, v252
    v_lshlrev_b32 v140, 16, v43
    v_and_b32 v141, 0xffff0000, v43
    v_lshlrev_b32 v160, 16, v253
    v_and_b32 v161, 0xffff0000, v253
    v_mfma_f32_16x16x32_bf16 v[170:173], v[50:53], a[224:227], v[170:173]
    v_lshlrev_b32 v142, 16, v44
    v_and_b32 v143, 0xffff0000, v44
    v_lshlrev_b32 v162, 16, v254
    v_and_b32 v163, 0xffff0000, v254
    v_mfma_f32_16x16x32_bf16 v[170:173], v[70:73], a[240:243], v[170:173]
    v_lshlrev_b32 v144, 16, v45
    v_and_b32 v145, 0xffff0000, v45
    v_lshlrev_b32 v164, 16, v255
    v_and_b32 v165, 0xffff0000, v255
    v_add_f32 v126, v126, v146
    v_mfma_f32_16x16x32_bf16 v[190:193], v[70:73], a[244:247], v[190:193]
    v_add_f32 v127, v127, v147
    v_add_f32 v128, v128, v148
    v_add_f32 v129, v129, v149
    v_add_f32 v130, v130, v150
    v_add_f32 v131, v131, v151
    v_mfma_f32_16x16x32_bf16 v[190:193], v[50:53], a[228:231], v[190:193]
    v_add_f32 v132, v132, v152
    v_add_f32 v133, v133, v153
    v_add_f32 v134, v134, v154
    v_add_f32 v135, v135, v155
    v_mfma_f32_16x16x32_bf16 v[210:213], v[50:53], a[232:235], v[210:213]
    v_add_f32 v136, v136, v156
    v_add_f32 v137, v137, v157
    v_add_f32 v138, v138, v158
    v_add_f32 v139, v139, v159
    v_add_f32 v140, v140, v160
    v_mfma_f32_16x16x32_bf16 v[210:213], v[70:73], a[248:251], v[210:213]
    v_add_f32 v141, v141, v161
    v_add_f32 v142, v142, v162
    v_add_f32 v143, v143, v163
    v_add_f32 v144, v144, v164
    v_add_f32 v145, v145, v165
    v_mfma_f32_16x16x32_bf16 v[230:233], v[70:73], a[252:255], v[230:233]
    v_cvt_pk_bf16_f32 v146, v126, v127
    v_cvt_pk_bf16_f32 v147, v128, v129
    v_cvt_pk_bf16_f32 v148, v130, v131
    v_cvt_pk_bf16_f32 v149, v132, v133
    v_mfma_f32_16x16x32_bf16 v[230:233], v[50:53], a[236:239], v[230:233]
    v_cvt_pk_bf16_f32 v150, v134, v135
    v_cvt_pk_bf16_f32 v151, v136, v137
    v_cvt_pk_bf16_f32 v152, v138, v139
    v_cvt_pk_bf16_f32 v153, v140, v141
    v_cvt_pk_bf16_f32 v154, v142, v143
    v_mfma_f32_16x16x32_bf16 v[174:177], v[54:57], a[224:227], v[174:177]
    v_cvt_pk_bf16_f32 v155, v144, v145
    v_lshlrev_b32 v126, 16, v146
    v_and_b32 v127, 0xffff0000, v146
    v_lshlrev_b32 v128, 16, v147
    v_mfma_f32_16x16x32_bf16 v[174:177], v[74:77], a[240:243], v[174:177]
    v_and_b32 v129, 0xffff0000, v147
    v_lshlrev_b32 v130, 16, v148
    v_and_b32 v131, 0xffff0000, v148
    v_lshlrev_b32 v132, 16, v149
    v_and_b32 v133, 0xffff0000, v149
    v_mfma_f32_16x16x32_bf16 v[194:197], v[74:77], a[244:247], v[194:197]
    v_lshlrev_b32 v134, 16, v150
    v_and_b32 v135, 0xffff0000, v150
    v_lshlrev_b32 v136, 16, v151
    v_and_b32 v137, 0xffff0000, v151
    v_lshlrev_b32 v138, 16, v152
    v_mfma_f32_16x16x32_bf16 v[194:197], v[54:57], a[228:231], v[194:197]
    v_and_b32 v139, 0xffff0000, v152
    v_lshlrev_b32 v140, 16, v153
    v_and_b32 v141, 0xffff0000, v153
    v_lshlrev_b32 v142, 16, v154
    v_mfma_f32_16x16x32_bf16 v[214:217], v[54:57], a[232:235], v[214:217]
    v_and_b32 v143, 0xffff0000, v154
    v_lshlrev_b32 v144, 16, v155
    v_and_b32 v145, 0xffff0000, v155
    v_mul_f32 v146, 0xbfb8aa3b, v126
    v_mul_f32 v147, 0xbfb8aa3b, v127
    v_mfma_f32_16x16x32_bf16 v[214:217], v[74:77], a[248:251], v[214:217]
    v_mul_f32 v148, 0xbfb8aa3b, v128
    v_mul_f32 v149, 0xbfb8aa3b, v129
    v_mul_f32 v150, 0xbfb8aa3b, v130
    v_mul_f32 v151, 0xbfb8aa3b, v131
    v_mfma_f32_16x16x32_bf16 v[234:237], v[74:77], a[252:255], v[234:237]
    v_mul_f32 v152, 0xbfb8aa3b, v132
    v_mul_f32 v153, 0xbfb8aa3b, v133
    v_mul_f32 v154, 0xbfb8aa3b, v134
    v_mul_f32 v155, 0xbfb8aa3b, v135
    v_mul_f32 v156, 0xbfb8aa3b, v136
    v_mfma_f32_16x16x32_bf16 v[234:237], v[54:57], a[236:239], v[234:237]
    v_mul_f32 v157, 0xbfb8aa3b, v137
    v_mul_f32 v158, 0xbfb8aa3b, v138
    v_mul_f32 v159, 0xbfb8aa3b, v139
    v_mul_f32 v160, 0xbfb8aa3b, v140
    v_mul_f32 v161, 0xbfb8aa3b, v141
    v_mfma_f32_16x16x32_bf16 v[178:181], v[58:61], a[224:227], v[178:181]
    v_mul_f32 v162, 0xbfb8aa3b, v142
    v_mul_f32 v163, 0xbfb8aa3b, v143
    v_mul_f32 v164, 0xbfb8aa3b, v144
    v_mul_f32 v165, 0xbfb8aa3b, v145
    v_mfma_f32_16x16x32_bf16 v[178:181], v[78:81], a[240:243], v[178:181]
    v_exp_f32 v146, v146
    v_exp_f32 v147, v147
    v_exp_f32 v148, v148
    v_exp_f32 v149, v149
    v_exp_f32 v150, v150
    v_mfma_f32_16x16x32_bf16 v[198:201], v[78:81], a[244:247], v[198:201]
    v_exp_f32 v151, v151
    v_exp_f32 v152, v152
    v_exp_f32 v153, v153
    v_exp_f32 v154, v154
    v_exp_f32 v155, v155
    v_mfma_f32_16x16x32_bf16 v[198:201], v[58:61], a[228:231], v[198:201]
    v_exp_f32 v156, v156
    v_exp_f32 v157, v157
    v_exp_f32 v158, v158
    v_exp_f32 v159, v159
    v_mfma_f32_16x16x32_bf16 v[218:221], v[58:61], a[232:235], v[218:221]
    v_exp_f32 v160, v160
    v_exp_f32 v161, v161
    v_exp_f32 v162, v162
    v_exp_f32 v163, v163
    v_exp_f32 v164, v164
    v_mfma_f32_16x16x32_bf16 v[218:221], v[78:81], a[248:251], v[218:221]
    v_exp_f32 v165, v165
    v_add_f32 v146, 1.0, v146
    v_add_f32 v147, 1.0, v147
    v_add_f32 v148, 1.0, v148
    v_mfma_f32_16x16x32_bf16 v[238:241], v[78:81], a[252:255], v[238:241]
    v_add_f32 v149, 1.0, v149
    v_add_f32 v150, 1.0, v150
    v_add_f32 v151, 1.0, v151
    v_add_f32 v152, 1.0, v152
    v_add_f32 v153, 1.0, v153
    v_mfma_f32_16x16x32_bf16 v[238:241], v[58:61], a[236:239], v[238:241]
    v_add_f32 v154, 1.0, v154
    v_add_f32 v155, 1.0, v155
    v_add_f32 v156, 1.0, v156
    v_add_f32 v157, 1.0, v157
    v_add_f32 v158, 1.0, v158
    v_mfma_f32_16x16x32_bf16 v[182:185], v[62:65], a[224:227], v[182:185]
    v_add_f32 v159, 1.0, v159
    v_add_f32 v160, 1.0, v160
    v_add_f32 v161, 1.0, v161
    v_add_f32 v162, 1.0, v162
    v_mfma_f32_16x16x32_bf16 v[182:185], v[82:85], a[240:243], v[182:185]
    v_add_f32 v163, 1.0, v163
    v_add_f32 v164, 1.0, v164
    v_add_f32 v165, 1.0, v165
    v_rcp_f32 v146, v146
    v_rcp_f32 v147, v147
    v_mfma_f32_16x16x32_bf16 v[202:205], v[82:85], a[244:247], v[202:205]
    v_rcp_f32 v148, v148
    v_rcp_f32 v149, v149
    v_rcp_f32 v150, v150
    v_rcp_f32 v151, v151
    v_mfma_f32_16x16x32_bf16 v[202:205], v[62:65], a[228:231], v[202:205]
    v_rcp_f32 v152, v152
    v_rcp_f32 v153, v153
    v_rcp_f32 v154, v154
    v_rcp_f32 v155, v155
    v_rcp_f32 v156, v156
    v_mfma_f32_16x16x32_bf16 v[222:225], v[62:65], a[232:235], v[222:225]
    v_rcp_f32 v157, v157
    v_rcp_f32 v158, v158
    v_rcp_f32 v159, v159
    v_rcp_f32 v160, v160
    v_rcp_f32 v161, v161
    v_mfma_f32_16x16x32_bf16 v[222:225], v[82:85], a[248:251], v[222:225]
    v_rcp_f32 v162, v162
    v_rcp_f32 v163, v163
    v_rcp_f32 v164, v164
    v_rcp_f32 v165, v165
    v_mfma_f32_16x16x32_bf16 v[242:245], v[82:85], a[252:255], v[242:245]
    v_mul_f32 v126, v126, v146
    v_mul_f32 v127, v127, v147
    v_mul_f32 v128, v128, v148
    v_mul_f32 v129, v129, v149
    v_mul_f32 v130, v130, v150
    v_mfma_f32_16x16x32_bf16 v[242:245], v[62:65], a[236:239], v[242:245]
    v_mul_f32 v131, v131, v151
    v_mul_f32 v132, v132, v152
    v_mul_f32 v133, v133, v153
    v_mul_f32 v134, v134, v154
    v_mul_f32 v135, v135, v155
    s_waitcnt vmcnt(1)
    v_mfma_f32_16x16x32_bf16 v[186:189], v[86:89], a[100:103], v[186:189]
    s_waitcnt vmcnt(0)
    v_cmp_ne_u32 vcc, 3, v1
    s_and_b64 vcc, vcc, exec
    s_cbranch_scc1 L_spin_half
L_back_half:
    s_xor_b32 s40, s2, 8
    s_sub_u32 s40, s40, s2
    s_mul_i32 s40, s40, 20480
    v_add_u32 v18, s40, v18
    s_mov_b32 s41, 4096
    buffer_load_dwordx4 v[46:49], v18, s[76:79], 0 offen offset:0 sc1
    buffer_load_dwordx4 v[50:53], v18, s[76:79], 0 offen offset:1024 sc1
    buffer_load_dwordx4 v[54:57], v18, s[76:79], 0 offen offset:2048 sc1
    buffer_load_dwordx4 v[58:61], v18, s[76:79], 0 offen offset:3072 sc1
    buffer_load_dwordx4 v[62:65], v18, s[76:79], s41 offen offset:0 sc1
    v_mfma_f32_16x16x32_bf16 v[186:189], v[106:109], a[116:119], v[186:189]
    v_mul_f32 v136, v136, v156
    v_mfma_f32_16x16x32_bf16 v[190:193], v[110:113], a[116:119], v[190:193]
    v_mul_f32 v137, v137, v157
    v_mul_f32 v138, v138, v158
    v_mfma_f32_16x16x32_bf16 v[190:193], v[90:93], a[100:103], v[190:193]
    v_mul_f32 v139, v139, v159
    v_mfma_f32_16x16x32_bf16 v[194:197], v[94:97], a[100:103], v[194:197]
    v_mul_f32 v140, v140, v160
    v_mul_f32 v141, v141, v161
    v_mfma_f32_16x16x32_bf16 v[194:197], v[114:117], a[116:119], v[194:197]
    v_mul_f32 v142, v142, v162
    v_mfma_f32_16x16x32_bf16 v[198:201], v[118:121], a[116:119], v[198:201]
    v_mul_f32 v143, v143, v163
    v_mul_f32 v144, v144, v164
    v_mfma_f32_16x16x32_bf16 v[198:201], v[98:101], a[100:103], v[198:201]
    v_mul_f32 v145, v145, v165
    v_mfma_f32_16x16x32_bf16 v[202:205], v[102:105], a[100:103], v[202:205]
    v_cvt_pk_bf16_f32 v146, v126, v127
    v_cvt_pk_bf16_f32 v147, v128, v129
    v_mfma_f32_16x16x32_bf16 v[202:205], v[122:125], a[116:119], v[202:205]
    ds_write_b128 v8, v[186:189] offset:0
    v_cvt_pk_bf16_f32 v148, v130, v131
    v_mfma_f32_16x16x32_bf16 v[206:209], v[106:109], a[120:123], v[206:209]
    v_cvt_pk_bf16_f32 v149, v132, v133
    v_cvt_pk_bf16_f32 v150, v134, v135
    v_mfma_f32_16x16x32_bf16 v[206:209], v[86:89], a[104:107], v[206:209]
    ds_write_b128 v8, v[190:193] offset:1024
    v_cvt_pk_bf16_f32 v151, v136, v137
    v_mfma_f32_16x16x32_bf16 v[210:213], v[90:93], a[104:107], v[210:213]
    v_cvt_pk_bf16_f32 v152, v138, v139
    v_cvt_pk_bf16_f32 v153, v140, v141
    v_mfma_f32_16x16x32_bf16 v[210:213], v[110:113], a[120:123], v[210:213]
    ds_write_b128 v8, v[194:197] offset:2048
    v_cvt_pk_bf16_f32 v154, v142, v143
    v_cvt_pk_bf16_f32 v155, v144, v145
    v_mfma_f32_16x16x32_bf16 v[214:217], v[114:117], a[120:123], v[214:217]
    v_lshlrev_b32 v126, 16, v146
    v_mfma_f32_16x16x32_bf16 v[214:217], v[94:97], a[104:107], v[214:217]
    ds_write_b128 v8, v[198:201] offset:3072
    v_and_b32 v127, 0xffff0000, v146
    v_lshlrev_b32 v128, 16, v147
    v_mfma_f32_16x16x32_bf16 v[218:221], v[98:101], a[104:107], v[218:221]
    v_and_b32 v129, 0xffff0000, v147
    v_mfma_f32_16x16x32_bf16 v[218:221], v[118:121], a[120:123], v[218:221]
    ds_write_b128 v8, v[202:205] offset:4096
    v_lshlrev_b32 v130, 16, v148
    v_and_b32 v131, 0xffff0000, v148
    v_mfma_f32_16x16x32_bf16 v[222:225], v[122:125], a[120:123], v[222:225]
    v_lshlrev_b32 v132, 16, v149
    v_mfma_f32_16x16x32_bf16 v[222:225], v[102:105], a[104:107], v[222:225]
    ds_write_b128 v8, v[206:209] offset:5120
    v_and_b32 v133, 0xffff0000, v149
    v_lshlrev_b32 v134, 16, v150
    v_mfma_f32_16x16x32_bf16 v[226:229], v[86:89], a[108:111], v[226:229]
    v_and_b32 v135, 0xffff0000, v150
    v_mfma_f32_16x16x32_bf16 v[226:229], v[106:109], a[124:127], v[226:229]
    ds_write_b128 v8, v[210:213] offset:6144
    v_lshlrev_b32 v136, 16, v151
    v_and_b32 v137, 0xffff0000, v151
    v_mfma_f32_16x16x32_bf16 v[230:233], v[110:113], a[124:127], v[230:233]
    v_lshlrev_b32 v138, 16, v152
    v_mfma_f32_16x16x32_bf16 v[230:233], v[90:93], a[108:111], v[230:233]
    ds_write_b128 v8, v[214:217] offset:7168
    v_and_b32 v139, 0xffff0000, v152
    v_lshlrev_b32 v140, 16, v153
    v_mfma_f32_16x16x32_bf16 v[234:237], v[94:97], a[108:111], v[234:237]
    v_and_b32 v141, 0xffff0000, v153
    v_mfma_f32_16x16x32_bf16 v[234:237], v[114:117], a[124:127], v[234:237]
    ds_write_b128 v8, v[218:221] offset:8192
    v_lshlrev_b32 v142, 16, v154
    v_and_b32 v143, 0xffff0000, v154
    v_mfma_f32_16x16x32_bf16 v[238:241], v[118:121], a[124:127], v[238:241]
    v_lshlrev_b32 v144, 16, v155
    v_and_b32 v145, 0xffff0000, v155
    v_mfma_f32_16x16x32_bf16 v[238:241], v[98:101], a[108:111], v[238:241]
    ds_write_b128 v8, v[222:225] offset:9216
    v_lshlrev_b32 v146, 16, v22
    v_mfma_f32_16x16x32_bf16 v[242:245], v[102:105], a[108:111], v[242:245]
    v_and_b32 v147, 0xffff0000, v22
    v_lshlrev_b32 v148, 16, v23
    v_mfma_f32_16x16x32_bf16 v[242:245], v[122:125], a[124:127], v[242:245]
    ds_write_b128 v9, v[226:229] offset:0
    v_and_b32 v149, 0xffff0000, v23
    v_mfma_f32_16x16x32_bf16 v[166:169], v[106:109], a[112:115], v[166:169]
    v_lshlrev_b32 v150, 16, v24
    v_and_b32 v151, 0xffff0000, v24
    v_mfma_f32_16x16x32_bf16 v[166:169], v[86:89], a[96:99], v[166:169]
    ds_write_b128 v9, v[230:233] offset:1024
    v_lshlrev_b32 v152, 16, v25
    v_mfma_f32_16x16x32_bf16 v[170:173], v[90:93], a[96:99], v[170:173]
    v_and_b32 v153, 0xffff0000, v25
    v_lshlrev_b32 v154, 16, v26
    v_mfma_f32_16x16x32_bf16 v[170:173], v[110:113], a[112:115], v[170:173]
    ds_write_b128 v9, v[234:237] offset:2048
    v_and_b32 v155, 0xffff0000, v26
    v_mfma_f32_16x16x32_bf16 v[174:177], v[114:117], a[112:115], v[174:177]
    v_lshlrev_b32 v156, 16, v27
    v_and_b32 v157, 0xffff0000, v27
    v_mfma_f32_16x16x32_bf16 v[174:177], v[94:97], a[96:99], v[174:177]
    ds_write_b128 v9, v[238:241] offset:3072
    v_lshlrev_b32 v158, 16, v28
    v_mfma_f32_16x16x32_bf16 v[178:181], v[98:101], a[96:99], v[178:181]
    v_and_b32 v159, 0xffff0000, v28
    v_lshlrev_b32 v160, 16, v29
    v_mfma_f32_16x16x32_bf16 v[178:181], v[118:121], a[112:115], v[178:181]
    ds_write_b128 v9, v[242:245] offset:4096
    v_and_b32 v161, 0xffff0000, v29
    v_mfma_f32_16x16x32_bf16 v[182:185], v[122:125], a[112:115], v[182:185]
    v_lshlrev_b32 v162, 16, v30
    v_and_b32 v163, 0xffff0000, v30
    v_mfma_f32_16x16x32_bf16 v[182:185], v[102:105], a[96:99], v[182:185]
    v_lshlrev_b32 v164, 16, v31
    v_and_b32 v165, 0xffff0000, v31
    s_waitcnt lgkmcnt(0)
    s_barrier
    ds_read_b128 v[186:189], v5 offset:0
    ds_read_b128 v[190:193], v5 offset:1024
    ds_read_b128 v[194:197], v5 offset:2048
    ds_read_b128 v[198:201], v5 offset:3072
    ds_read_b128 v[202:205], v5 offset:4096
    ds_read_b128 v[206:209], v6 offset:5120
    ds_read_b128 v[210:213], v6 offset:6144
    ds_read_b128 v[214:217], v6 offset:7168
    ds_read_b128 v[218:221], v6 offset:8192
    ds_read_b128 v[222:225], v6 offset:9216
    ds_read_b128 v[226:229], v7 offset:0
    ds_read_b128 v[230:233], v7 offset:1024
    ds_read_b128 v[234:237], v7 offset:2048
    ds_read_b128 v[238:241], v7 offset:3072
    ds_read_b128 v[242:245], v7 offset:4096
    s_waitcnt lgkmcnt(10)
    v_pk_add_f32 v[166:167], v[166:167], v[186:187]
    v_pk_add_f32 v[168:169], v[168:169], v[188:189]
    v_pk_add_f32 v[170:171], v[170:171], v[190:191]
    v_pk_add_f32 v[172:173], v[172:173], v[192:193]
    v_pk_add_f32 v[174:175], v[174:175], v[194:195]
    v_pk_add_f32 v[176:177], v[176:177], v[196:197]
    v_pk_add_f32 v[178:179], v[178:179], v[198:199]
    v_pk_add_f32 v[180:181], v[180:181], v[200:201]
    v_pk_add_f32 v[182:183], v[182:183], v[202:203]
    v_pk_add_f32 v[184:185], v[184:185], v[204:205]
    s_waitcnt lgkmcnt(5)
    v_pk_add_f32 v[166:167], v[166:167], v[206:207]
    v_pk_add_f32 v[168:169], v[168:169], v[208:209]
    v_pk_add_f32 v[170:171], v[170:171], v[210:211]
    v_pk_add_f32 v[172:173], v[172:173], v[212:213]
    v_pk_add_f32 v[174:175], v[174:175], v[214:215]
    v_pk_add_f32 v[176:177], v[176:177], v[216:217]
    v_pk_add_f32 v[178:179], v[178:179], v[218:219]
    v_pk_add_f32 v[180:181], v[180:181], v[220:221]
    v_pk_add_f32 v[182:183], v[182:183], v[222:223]
    v_pk_add_f32 v[184:185], v[184:185], v[224:225]
    s_waitcnt lgkmcnt(0)
    v_pk_add_f32 v[166:167], v[166:167], v[226:227]
    v_pk_add_f32 v[168:169], v[168:169], v[228:229]
    v_pk_add_f32 v[170:171], v[170:171], v[230:231]
    v_pk_add_f32 v[172:173], v[172:173], v[232:233]
    v_pk_add_f32 v[174:175], v[174:175], v[234:235]
    v_pk_add_f32 v[176:177], v[176:177], v[236:237]
    v_pk_add_f32 v[178:179], v[178:179], v[238:239]
    v_pk_add_f32 v[180:181], v[180:181], v[240:241]
    v_pk_add_f32 v[182:183], v[182:183], v[242:243]
    v_pk_add_f32 v[184:185], v[184:185], v[244:245]
    s_waitcnt vmcnt(0)
    v_pk_add_f32 v[166:167], v[166:167], v[46:47]
    v_pk_add_f32 v[168:169], v[168:169], v[48:49]
    v_pk_add_f32 v[170:171], v[170:171], v[50:51]
    v_pk_add_f32 v[172:173], v[172:173], v[52:53]
    v_pk_add_f32 v[174:175], v[174:175], v[54:55]
    v_pk_add_f32 v[176:177], v[176:177], v[56:57]
    v_pk_add_f32 v[178:179], v[178:179], v[58:59]
    v_pk_add_f32 v[180:181], v[180:181], v[60:61]
    v_pk_add_f32 v[182:183], v[182:183], v[62:63]
    v_pk_add_f32 v[184:185], v[184:185], v[64:65]
    v_cvt_pk_bf16_f32 v66, v166, v167
    v_cvt_pk_bf16_f32 v67, v168, v169
    v_cvt_pk_bf16_f32 v68, v170, v171
    v_cvt_pk_bf16_f32 v69, v172, v173
    v_cvt_pk_bf16_f32 v70, v174, v175
    v_cvt_pk_bf16_f32 v71, v176, v177
    v_cvt_pk_bf16_f32 v72, v178, v179
    v_cvt_pk_bf16_f32 v73, v180, v181
    v_cvt_pk_bf16_f32 v74, v182, v183
    v_cvt_pk_bf16_f32 v75, v184, v185
    v_lshlrev_b32 v166, 16, v66
    v_and_b32 v167, 0xffff0000, v66
    v_lshlrev_b32 v168, 16, v67
    v_and_b32 v169, 0xffff0000, v67
    v_lshlrev_b32 v170, 16, v68
    v_and_b32 v171, 0xffff0000, v68
    v_lshlrev_b32 v172, 16, v69
    v_and_b32 v173, 0xffff0000, v69
    v_lshlrev_b32 v174, 16, v70
    v_and_b32 v175, 0xffff0000, v70
    v_lshlrev_b32 v176, 16, v71
    v_and_b32 v177, 0xffff0000, v71
    v_lshlrev_b32 v178, 16, v72
    v_and_b32 v179, 0xffff0000, v72
    v_lshlrev_b32 v180, 16, v73
    v_and_b32 v181, 0xffff0000, v73
    v_lshlrev_b32 v182, 16, v74
    v_and_b32 v183, 0xffff0000, v74
    v_lshlrev_b32 v184, 16, v75
    v_and_b32 v185, 0xffff0000, v75
    v_pk_mul_f32 v[166:167], v[166:167], v[126:127]
    v_pk_mul_f32 v[168:169], v[168:169], v[128:129]
    v_pk_mul_f32 v[170:171], v[170:171], v[130:131]
    v_pk_mul_f32 v[172:173], v[172:173], v[132:133]
    v_pk_mul_f32 v[174:175], v[174:175], v[134:135]
    v_pk_mul_f32 v[176:177], v[176:177], v[136:137]
    v_pk_mul_f32 v[178:179], v[178:179], v[138:139]
    v_pk_mul_f32 v[180:181], v[180:181], v[140:141]
    v_pk_mul_f32 v[182:183], v[182:183], v[142:143]
    v_pk_mul_f32 v[184:185], v[184:185], v[144:145]
    v_cvt_pk_bf16_f32 v66, v166, v167
    v_cvt_pk_bf16_f32 v67, v168, v169
    v_cvt_pk_bf16_f32 v68, v170, v171
    v_cvt_pk_bf16_f32 v69, v172, v173
    v_cvt_pk_bf16_f32 v70, v174, v175
    v_cvt_pk_bf16_f32 v71, v176, v177
    v_cvt_pk_bf16_f32 v72, v178, v179
    v_cvt_pk_bf16_f32 v73, v180, v181
    v_cvt_pk_bf16_f32 v74, v182, v183
    v_cvt_pk_bf16_f32 v75, v184, v185
    v_lshlrev_b32 v166, 16, v66
    v_and_b32 v167, 0xffff0000, v66
    v_lshlrev_b32 v168, 16, v67
    v_and_b32 v169, 0xffff0000, v67
    v_lshlrev_b32 v170, 16, v68
    v_and_b32 v171, 0xffff0000, v68
    v_lshlrev_b32 v172, 16, v69
    v_and_b32 v173, 0xffff0000, v69
    v_lshlrev_b32 v174, 16, v70
    v_and_b32 v175, 0xffff0000, v70
    v_lshlrev_b32 v176, 16, v71
    v_and_b32 v177, 0xffff0000, v71
    v_lshlrev_b32 v178, 16, v72
    v_and_b32 v179, 0xffff0000, v72
    v_lshlrev_b32 v180, 16, v73
    v_and_b32 v181, 0xffff0000, v73
    v_lshlrev_b32 v182, 16, v74
    v_and_b32 v183, 0xffff0000, v74
    v_lshlrev_b32 v184, 16, v75
    v_and_b32 v185, 0xffff0000, v75
    v_pk_add_f32 v[166:167], v[166:167], v[146:147]
    v_pk_add_f32 v[168:169], v[168:169], v[148:149]
    v_pk_add_f32 v[170:171], v[170:171], v[150:151]
    v_pk_add_f32 v[172:173], v[172:173], v[152:153]
    v_pk_add_f32 v[174:175], v[174:175], v[154:155]
    v_pk_add_f32 v[176:177], v[176:177], v[156:157]
    v_pk_add_f32 v[178:179], v[178:179], v[158:159]
    v_pk_add_f32 v[180:181], v[180:181], v[160:161]
    v_pk_add_f32 v[182:183], v[182:183], v[162:163]
    v_pk_add_f32 v[184:185], v[184:185], v[164:165]
    v_cvt_pk_bf16_f32 v66, v166, v167
    v_cvt_pk_bf16_f32 v67, v168, v169
    buffer_store_dwordx2 v[66:67], v34, s[12:15], 0 offen offset:0
    v_cvt_pk_bf16_f32 v68, v170, v171
    v_cvt_pk_bf16_f32 v69, v172, v173
    buffer_store_dwordx2 v[68:69], v34, s[12:15], 0 offen offset:32
    v_cvt_pk_bf16_f32 v70, v174, v175
    v_cvt_pk_bf16_f32 v71, v176, v177
    buffer_store_dwordx2 v[70:71], v34, s[12:15], 0 offen offset:64
    v_cvt_pk_bf16_f32 v72, v178, v179
    v_cvt_pk_bf16_f32 v73, v180, v181
    buffer_store_dwordx2 v[72:73], v34, s[12:15], 0 offen offset:96
    v_cvt_pk_bf16_f32 v74, v182, v183
    v_cvt_pk_bf16_f32 v75, v184, v185
    buffer_store_dwordx2 v[74:75], v34, s[12:15], 0 offen offset:128
L_end:
    s_endpgm
L_slow:
    s_lshl_b32 s40, s5, 12
    v_subrev_u32 v13, s40, v13
    v_subrev_u32 v14, s40, v14
    v_subrev_u32 v15, s40, v15
    v_subrev_u32 v16, s40, v16
    v_subrev_u32 v17, s40, v17
    v_subrev_u32 v18, s40, v18
    s_and_b32 s40, s5, 1
    s_lshr_b32 s41, s5, 1
    s_mul_i32 s41, s41, 3
    s_add_u32 s40, s40, s41
    s_add_u32 s40, s40, 1
    s_lshl_b32 s34, s40, 13
    s_sub_u32 s40, s34, 98304
    v_add_u32 v1, s40, v1
    v_add_u32 v2, s40, v2
    v_add_u32 v3, s40, v3
    v_add_u32 v4, s40, v4
    v_add_u32 v5, s34, v5
    v_add_u32 v6, s34, v6
    v_add_u32 v7, s34, v7
    v_add_u32 v8, s34, v8
    v_add_u32 v9, s34, v9
    v_add_u32 v10, s34, v10
    v_add_u32 v11, s34, v11
    v_add_u32 v12, s34, v12
    v_mov_b32 v212, 0xff800000
    v_mov_b32 v216, 0
    v_mov_b32 v213, 0xff800000
    v_mov_b32 v217, 0
    v_mov_b32 v214, 0xff800000
    v_mov_b32 v218, 0
    v_mov_b32 v215, 0xff800000
    v_mov_b32 v219, 0
    v_accvgpr_write_b32 a0, 0
    v_accvgpr_write_b32 a1, 0
    v_accvgpr_write_b32 a2, 0
    v_accvgpr_write_b32 a3, 0
    v_accvgpr_write_b32 a4, 0
    v_accvgpr_write_b32 a5, 0
    v_accvgpr_write_b32 a6, 0
    v_accvgpr_write_b32 a7, 0
    v_accvgpr_write_b32 a8, 0
    v_accvgpr_write_b32 a9, 0
    v_accvgpr_write_b32 a10, 0
    v_accvgpr_write_b32 a11, 0
    v_accvgpr_write_b32 a12, 0
    v_accvgpr_write_b32 a13, 0
    v_accvgpr_write_b32 a14, 0
    v_accvgpr_write_b32 a15, 0
    v_accvgpr_write_b32 a16, 0
    v_accvgpr_write_b32 a17, 0
    v_accvgpr_write_b32 a18, 0
    v_accvgpr_write_b32 a19, 0
    v_accvgpr_write_b32 a20, 0
    v_accvgpr_write_b32 a21, 0
    v_accvgpr_write_b32 a22, 0
    v_accvgpr_write_b32 a23, 0
    v_accvgpr_write_b32 a24, 0
    v_accvgpr_write_b32 a25, 0
    v_accvgpr_write_b32 a26, 0
    v_accvgpr_write_b32 a27, 0
    v_accvgpr_write_b32 a28, 0
    v_accvgpr_write_b32 a29, 0
    v_accvgpr_write_b32 a30, 0
    v_accvgpr_write_b32 a31, 0
    v_accvgpr_write_b32 a32, 0
    v_accvgpr_write_b32 a33, 0
    v_accvgpr_write_b32 a34, 0
    v_accvgpr_write_b32 a35, 0
    v_accvgpr_write_b32 a36, 0
    v_accvgpr_write_b32 a37, 0
    v_accvgpr_write_b32 a38, 0
    v_accvgpr_write_b32 a39, 0
    v_accvgpr_write_b32 a40, 0
    v_accvgpr_write_b32 a41, 0
    v_accvgpr_write_b32 a42, 0
    v_accvgpr_write_b32 a43, 0
    v_accvgpr_write_b32 a44, 0
    v_accvgpr_write_b32 a45, 0
    v_accvgpr_write_b32 a46, 0
    v_accvgpr_write_b32 a47, 0
    v_accvgpr_write_b32 a48, 0
    v_accvgpr_write_b32 a49, 0
    v_accvgpr_write_b32 a50, 0
    v_accvgpr_write_b32 a51, 0
    v_accvgpr_write_b32 a52, 0
    v_accvgpr_write_b32 a53, 0
    v_accvgpr_write_b32 a54, 0
    v_accvgpr_write_b32 a55, 0
    v_accvgpr_write_b32 a56, 0
    v_accvgpr_write_b32 a57, 0
    v_accvgpr_write_b32 a58, 0
    v_accvgpr_write_b32 a59, 0
    v_accvgpr_write_b32 a60, 0
    v_accvgpr_write_b32 a61, 0
    v_accvgpr_write_b32 a62, 0
    v_accvgpr_write_b32 a63, 0
    v_accvgpr_write_b32 a64, 0
    v_accvgpr_write_b32 a65, 0
    v_accvgpr_write_b32 a66, 0
    v_accvgpr_write_b32 a67, 0
    v_accvgpr_write_b32 a68, 0
    v_accvgpr_write_b32 a69, 0
    v_accvgpr_write_b32 a70, 0
    v_accvgpr_write_b32 a71, 0
    v_accvgpr_write_b32 a72, 0
    v_accvgpr_write_b32 a73, 0
    v_accvgpr_write_b32 a74, 0
    v_accvgpr_write_b32 a75, 0
    v_accvgpr_write_b32 a76, 0
    v_accvgpr_write_b32 a77, 0
    v_accvgpr_write_b32 a78, 0
    v_accvgpr_write_b32 a79, 0
    v_accvgpr_write_b32 a80, 0
    v_accvgpr_write_b32 a81, 0
    v_accvgpr_write_b32 a82, 0
    v_accvgpr_write_b32 a83, 0
    v_accvgpr_write_b32 a84, 0
    v_accvgpr_write_b32 a85, 0
    v_accvgpr_write_b32 a86, 0
    v_accvgpr_write_b32 a87, 0
    v_accvgpr_write_b32 a88, 0
    v_accvgpr_write_b32 a89, 0
    v_accvgpr_write_b32 a90, 0
    v_accvgpr_write_b32 a91, 0
    v_accvgpr_write_b32 a92, 0
    v_accvgpr_write_b32 a93, 0
    v_accvgpr_write_b32 a94, 0
    v_accvgpr_write_b32 a95, 0
    v_accvgpr_write_b32 a96, 0
    v_accvgpr_write_b32 a97, 0
    v_accvgpr_write_b32 a98, 0
    v_accvgpr_write_b32 a99, 0
    v_accvgpr_write_b32 a100, 0
    v_accvgpr_write_b32 a101, 0
    v_accvgpr_write_b32 a102, 0
    v_accvgpr_write_b32 a103, 0
    v_accvgpr_write_b32 a104, 0
    v_accvgpr_write_b32 a105, 0
    v_accvgpr_write_b32 a106, 0
    v_accvgpr_write_b32 a107, 0
    v_accvgpr_write_b32 a108, 0
    v_accvgpr_write_b32 a109, 0
    v_accvgpr_write_b32 a110, 0
    v_accvgpr_write_b32 a111, 0
    v_accvgpr_write_b32 a112, 0
    v_accvgpr_write_b32 a113, 0
    v_accvgpr_write_b32 a114, 0
    v_accvgpr_write_b32 a115, 0
    v_accvgpr_write_b32 a116, 0
    v_accvgpr_write_b32 a117, 0
    v_accvgpr_write_b32 a118, 0
    v_accvgpr_write_b32 a119, 0
    v_accvgpr_write_b32 a120, 0
    v_accvgpr_write_b32 a121, 0
    v_accvgpr_write_b32 a122, 0
    v_accvgpr_write_b32 a123, 0
    v_accvgpr_write_b32 a124, 0
    v_accvgpr_write_b32 a125, 0
    v_accvgpr_write_b32 a126, 0
    v_accvgpr_write_b32 a127, 0
    s_mov_b32 s28, 0
L_slow_loop:
    s_add_u32 m0, s34, 0
    s_add_u32 s40, s28, 0
    buffer_load_dwordx4 v13, s[8:11], s40 offen offset:0 lds
    buffer_load_dwordx4 v14, s[8:11], s40 offen offset:1024 lds
    buffer_load_dwordx4 v15, s[8:11], s40 offen offset:2048 lds
    buffer_load_dwordx4 v16, s[8:11], s40 offen offset:3072 lds
    s_add_u32 m0, s34, 4096
    s_add_u32 s40, s28, 4096
    buffer_load_dwordx4 v13, s[8:11], s40 offen offset:0 lds
    buffer_load_dwordx4 v14, s[8:11], s40 offen offset:1024 lds
    buffer_load_dwordx4 v15, s[8:11], s40 offen offset:2048 lds
    buffer_load_dwordx4 v16, s[8:11], s40 offen offset:3072 lds
    s_waitcnt vmcnt(0)
    ds_read_b128 v[148:151], v1 offset:0
    ds_read_b128 v[152:155], v2 offset:0
    ds_read_b128 v[156:159], v3 offset:0
    ds_read_b128 v[160:163], v4 offset:0
    ds_read_b128 v[164:167], v1 offset:4096
    ds_read_b128 v[168:171], v2 offset:4096
    ds_read_b128 v[172:175], v3 offset:4096
    ds_read_b128 v[176:179], v4 offset:4096
    s_waitcnt lgkmcnt(0)
    s_add_u32 m0, s34, 0
    s_add_u32 s40, s28, 0
    buffer_load_dwordx4 v17, s[12:15], s40 offen offset:0 lds
    buffer_load_dwordx4 v18, s[12:15], s40 offen offset:1024 lds
    buffer_load_dwordx4 v17, s[12:15], s40 offen offset:2048 lds
    buffer_load_dwordx4 v18, s[12:15], s40 offen offset:3072 lds
    s_add_u32 m0, s34, 4096
    s_add_u32 s40, s28, 4096
    buffer_load_dwordx4 v17, s[12:15], s40 offen offset:0 lds
    buffer_load_dwordx4 v18, s[12:15], s40 offen offset:1024 lds
    buffer_load_dwordx4 v17, s[12:15], s40 offen offset:2048 lds
    buffer_load_dwordx4 v18, s[12:15], s40 offen offset:3072 lds
    s_waitcnt vmcnt(0)
    ds_read_b64_tr_b16 v[196:197], v5 offset:0
    ds_read_b64_tr_b16 v[198:199], v5 offset:4096
    ds_read_b64_tr_b16 v[200:201], v6 offset:0
    ds_read_b64_tr_b16 v[202:203], v6 offset:4096
    ds_read_b64_tr_b16 v[204:205], v7 offset:0
    ds_read_b64_tr_b16 v[206:207], v7 offset:4096
    ds_read_b64_tr_b16 v[208:209], v8 offset:0
    ds_read_b64_tr_b16 v[210:211], v8 offset:4096
    ds_read_b64_tr_b16 v[228:229], v9 offset:0
    ds_read_b64_tr_b16 v[230:231], v9 offset:4096
    ds_read_b64_tr_b16 v[232:233], v10 offset:0
    ds_read_b64_tr_b16 v[234:235], v10 offset:4096
    ds_read_b64_tr_b16 v[236:237], v11 offset:0
    ds_read_b64_tr_b16 v[238:239], v11 offset:4096
    ds_read_b64_tr_b16 v[240:241], v12 offset:0
    ds_read_b64_tr_b16 v[242:243], v12 offset:4096
    v_mfma_f32_16x16x32_bf16 v[116:119], v[148:151], v[36:39], 0
    v_mfma_f32_16x16x32_bf16 v[116:119], v[152:155], v[40:43], v[116:119]
    v_mfma_f32_16x16x32_bf16 v[116:119], v[156:159], v[44:47], v[116:119]
    v_mfma_f32_16x16x32_bf16 v[116:119], v[160:163], v[48:51], v[116:119]
    v_mfma_f32_16x16x32_bf16 v[132:135], v[164:167], v[36:39], 0
    v_mfma_f32_16x16x32_bf16 v[132:135], v[168:171], v[40:43], v[132:135]
    v_mfma_f32_16x16x32_bf16 v[132:135], v[172:175], v[44:47], v[132:135]
    v_mfma_f32_16x16x32_bf16 v[132:135], v[176:179], v[48:51], v[132:135]
    v_mfma_f32_16x16x32_bf16 v[120:123], v[160:163], v[64:67], 0
    v_mfma_f32_16x16x32_bf16 v[120:123], v[156:159], v[60:63], v[120:123]
    v_mfma_f32_16x16x32_bf16 v[120:123], v[152:155], v[56:59], v[120:123]
    v_mfma_f32_16x16x32_bf16 v[120:123], v[148:151], v[52:55], v[120:123]
    v_mfma_f32_16x16x32_bf16 v[136:139], v[176:179], v[64:67], 0
    v_mfma_f32_16x16x32_bf16 v[136:139], v[172:175], v[60:63], v[136:139]
    v_mfma_f32_16x16x32_bf16 v[136:139], v[168:171], v[56:59], v[136:139]
    v_mfma_f32_16x16x32_bf16 v[136:139], v[164:167], v[52:55], v[136:139]
    v_mfma_f32_16x16x32_bf16 v[124:127], v[148:151], v[68:71], 0
    v_mfma_f32_16x16x32_bf16 v[124:127], v[152:155], v[72:75], v[124:127]
    v_mfma_f32_16x16x32_bf16 v[124:127], v[156:159], v[76:79], v[124:127]
    v_mfma_f32_16x16x32_bf16 v[124:127], v[160:163], v[80:83], v[124:127]
    v_mfma_f32_16x16x32_bf16 v[140:143], v[164:167], v[68:71], 0
    v_mfma_f32_16x16x32_bf16 v[140:143], v[168:171], v[72:75], v[140:143]
    v_mfma_f32_16x16x32_bf16 v[140:143], v[172:175], v[76:79], v[140:143]
    v_mfma_f32_16x16x32_bf16 v[140:143], v[176:179], v[80:83], v[140:143]
    v_mfma_f32_16x16x32_bf16 v[128:131], v[160:163], v[96:99], 0
    v_mfma_f32_16x16x32_bf16 v[128:131], v[156:159], v[92:95], v[128:131]
    v_mfma_f32_16x16x32_bf16 v[128:131], v[152:155], v[88:91], v[128:131]
    v_mfma_f32_16x16x32_bf16 v[128:131], v[148:151], v[84:87], v[128:131]
    v_mfma_f32_16x16x32_bf16 v[144:147], v[176:179], v[96:99], 0
    v_mfma_f32_16x16x32_bf16 v[144:147], v[172:175], v[92:95], v[144:147]
    v_mfma_f32_16x16x32_bf16 v[144:147], v[168:171], v[88:91], v[144:147]
    v_mfma_f32_16x16x32_bf16 v[144:147], v[164:167], v[84:87], v[144:147]
    s_waitcnt lgkmcnt(0)
    s_nop 7
    v_max3_f32 v224, v116, v117, v118
    v_max3_f32 v224, v224, v119, v132
    v_max3_f32 v224, v224, v133, v134
    v_max3_f32 v224, v224, v135, v212
    v_mov_b32 v225, v224
    s_nop 1
    v_permlane32_swap_b32 v224, v225
    v_max_f32 v224, v224, v225
    v_mov_b32 v225, v224
    s_nop 1
    v_permlane16_swap_b32 v224, v225
    v_max_f32 v224, v224, v225
    v_sub_f32 v220, v212, v224
    v_exp_f32 v220, v220
    v_mov_b32 v212, v224
    v_sub_f32 v116, v116, v224
    v_sub_f32 v117, v117, v224
    v_sub_f32 v118, v118, v224
    v_sub_f32 v119, v119, v224
    v_sub_f32 v132, v132, v224
    v_sub_f32 v133, v133, v224
    v_sub_f32 v134, v134, v224
    v_sub_f32 v135, v135, v224
    v_mul_f32 v216, v216, v220
    v_exp_f32 v116, v116
    v_exp_f32 v117, v117
    v_exp_f32 v118, v118
    v_exp_f32 v119, v119
    v_exp_f32 v132, v132
    v_exp_f32 v133, v133
    v_exp_f32 v134, v134
    v_exp_f32 v135, v135
    v_accvgpr_read_b32 v224, a0
    v_accvgpr_read_b32 v225, a1
    v_accvgpr_read_b32 v226, a2
    v_accvgpr_read_b32 v227, a3
    v_mul_f32 v224, v224, v220
    v_mul_f32 v225, v225, v220
    v_mul_f32 v226, v226, v220
    v_mul_f32 v227, v227, v220
    v_accvgpr_write_b32 a0, v224
    v_accvgpr_write_b32 a1, v225
    v_accvgpr_write_b32 a2, v226
    v_accvgpr_write_b32 a3, v227
    v_accvgpr_read_b32 v224, a16
    v_accvgpr_read_b32 v225, a17
    v_accvgpr_read_b32 v226, a18
    v_accvgpr_read_b32 v227, a19
    v_mul_f32 v224, v224, v220
    v_mul_f32 v225, v225, v220
    v_mul_f32 v226, v226, v220
    v_mul_f32 v227, v227, v220
    v_accvgpr_write_b32 a16, v224
    v_accvgpr_write_b32 a17, v225
    v_accvgpr_write_b32 a18, v226
    v_accvgpr_write_b32 a19, v227
    v_accvgpr_read_b32 v224, a32
    v_accvgpr_read_b32 v225, a33
    v_accvgpr_read_b32 v226, a34
    v_accvgpr_read_b32 v227, a35
    v_mul_f32 v224, v224, v220
    v_mul_f32 v225, v225, v220
    v_mul_f32 v226, v226, v220
    v_mul_f32 v227, v227, v220
    v_accvgpr_write_b32 a32, v224
    v_accvgpr_write_b32 a33, v225
    v_accvgpr_write_b32 a34, v226
    v_accvgpr_write_b32 a35, v227
    v_accvgpr_read_b32 v224, a48
    v_accvgpr_read_b32 v225, a49
    v_accvgpr_read_b32 v226, a50
    v_accvgpr_read_b32 v227, a51
    v_mul_f32 v224, v224, v220
    v_mul_f32 v225, v225, v220
    v_mul_f32 v226, v226, v220
    v_mul_f32 v227, v227, v220
    v_accvgpr_write_b32 a48, v224
    v_accvgpr_write_b32 a49, v225
    v_accvgpr_write_b32 a50, v226
    v_accvgpr_write_b32 a51, v227
    v_accvgpr_read_b32 v224, a64
    v_accvgpr_read_b32 v225, a65
    v_accvgpr_read_b32 v226, a66
    v_accvgpr_read_b32 v227, a67
    v_mul_f32 v224, v224, v220
    v_mul_f32 v225, v225, v220
    v_mul_f32 v226, v226, v220
    v_mul_f32 v227, v227, v220
    v_accvgpr_write_b32 a64, v224
    v_accvgpr_write_b32 a65, v225
    v_accvgpr_write_b32 a66, v226
    v_accvgpr_write_b32 a67, v227
    v_accvgpr_read_b32 v224, a80
    v_accvgpr_read_b32 v225, a81
    v_accvgpr_read_b32 v226, a82
    v_accvgpr_read_b32 v227, a83
    v_mul_f32 v224, v224, v220
    v_mul_f32 v225, v225, v220
    v_mul_f32 v226, v226, v220
    v_mul_f32 v227, v227, v220
    v_accvgpr_write_b32 a80, v224
    v_accvgpr_write_b32 a81, v225
    v_accvgpr_write_b32 a82, v226
    v_accvgpr_write_b32 a83, v227
    v_accvgpr_read_b32 v224, a96
    v_accvgpr_read_b32 v225, a97
    v_accvgpr_read_b32 v226, a98
    v_accvgpr_read_b32 v227, a99
    v_mul_f32 v224, v224, v220
    v_mul_f32 v225, v225, v220
    v_mul_f32 v226, v226, v220
    v_mul_f32 v227, v227, v220
    v_accvgpr_write_b32 a96, v224
    v_accvgpr_write_b32 a97, v225
    v_accvgpr_write_b32 a98, v226
    v_accvgpr_write_b32 a99, v227
    v_accvgpr_read_b32 v224, a112
    v_accvgpr_read_b32 v225, a113
    v_accvgpr_read_b32 v226, a114
    v_accvgpr_read_b32 v227, a115
    v_mul_f32 v224, v224, v220
    v_mul_f32 v225, v225, v220
    v_mul_f32 v226, v226, v220
    v_mul_f32 v227, v227, v220
    v_accvgpr_write_b32 a112, v224
    v_accvgpr_write_b32 a113, v225
    v_accvgpr_write_b32 a114, v226
    v_accvgpr_write_b32 a115, v227
    v_add_f32 v216, v216, v116
    v_add_f32 v216, v216, v117
    v_add_f32 v216, v216, v118
    v_add_f32 v216, v216, v119
    v_add_f32 v216, v216, v132
    v_add_f32 v216, v216, v133
    v_add_f32 v216, v216, v134
    v_add_f32 v216, v216, v135
    v_cvt_pk_bf16_f32 v180, v116, v117
    v_cvt_pk_bf16_f32 v181, v118, v119
    v_cvt_pk_bf16_f32 v182, v132, v133
    v_cvt_pk_bf16_f32 v183, v134, v135
    s_nop 1
    v_mfma_f32_16x16x32_bf16 a[0:3], v[196:199], v[180:183], a[0:3]
    v_mfma_f32_16x16x32_bf16 a[16:19], v[200:203], v[180:183], a[16:19]
    v_mfma_f32_16x16x32_bf16 a[32:35], v[204:207], v[180:183], a[32:35]
    v_mfma_f32_16x16x32_bf16 a[48:51], v[208:211], v[180:183], a[48:51]
    v_mfma_f32_16x16x32_bf16 a[64:67], v[228:231], v[180:183], a[64:67]
    v_mfma_f32_16x16x32_bf16 a[80:83], v[232:235], v[180:183], a[80:83]
    v_mfma_f32_16x16x32_bf16 a[96:99], v[236:239], v[180:183], a[96:99]
    v_mfma_f32_16x16x32_bf16 a[112:115], v[240:243], v[180:183], a[112:115]
    v_max3_f32 v224, v120, v121, v122
    v_max3_f32 v224, v224, v123, v136
    v_max3_f32 v224, v224, v137, v138
    v_max3_f32 v224, v224, v139, v213
    v_mov_b32 v225, v224
    s_nop 1
    v_permlane32_swap_b32 v224, v225
    v_max_f32 v224, v224, v225
    v_mov_b32 v225, v224
    s_nop 1
    v_permlane16_swap_b32 v224, v225
    v_max_f32 v224, v224, v225
    v_sub_f32 v220, v213, v224
    v_exp_f32 v220, v220
    v_mov_b32 v213, v224
    v_sub_f32 v120, v120, v224
    v_sub_f32 v121, v121, v224
    v_sub_f32 v122, v122, v224
    v_sub_f32 v123, v123, v224
    v_sub_f32 v136, v136, v224
    v_sub_f32 v137, v137, v224
    v_sub_f32 v138, v138, v224
    v_sub_f32 v139, v139, v224
    v_mul_f32 v217, v217, v220
    v_exp_f32 v120, v120
    v_exp_f32 v121, v121
    v_exp_f32 v122, v122
    v_exp_f32 v123, v123
    v_exp_f32 v136, v136
    v_exp_f32 v137, v137
    v_exp_f32 v138, v138
    v_exp_f32 v139, v139
    v_accvgpr_read_b32 v224, a4
    v_accvgpr_read_b32 v225, a5
    v_accvgpr_read_b32 v226, a6
    v_accvgpr_read_b32 v227, a7
    v_mul_f32 v224, v224, v220
    v_mul_f32 v225, v225, v220
    v_mul_f32 v226, v226, v220
    v_mul_f32 v227, v227, v220
    v_accvgpr_write_b32 a4, v224
    v_accvgpr_write_b32 a5, v225
    v_accvgpr_write_b32 a6, v226
    v_accvgpr_write_b32 a7, v227
    v_accvgpr_read_b32 v224, a20
    v_accvgpr_read_b32 v225, a21
    v_accvgpr_read_b32 v226, a22
    v_accvgpr_read_b32 v227, a23
    v_mul_f32 v224, v224, v220
    v_mul_f32 v225, v225, v220
    v_mul_f32 v226, v226, v220
    v_mul_f32 v227, v227, v220
    v_accvgpr_write_b32 a20, v224
    v_accvgpr_write_b32 a21, v225
    v_accvgpr_write_b32 a22, v226
    v_accvgpr_write_b32 a23, v227
    v_accvgpr_read_b32 v224, a36
    v_accvgpr_read_b32 v225, a37
    v_accvgpr_read_b32 v226, a38
    v_accvgpr_read_b32 v227, a39
    v_mul_f32 v224, v224, v220
    v_mul_f32 v225, v225, v220
    v_mul_f32 v226, v226, v220
    v_mul_f32 v227, v227, v220
    v_accvgpr_write_b32 a36, v224
    v_accvgpr_write_b32 a37, v225
    v_accvgpr_write_b32 a38, v226
    v_accvgpr_write_b32 a39, v227
    v_accvgpr_read_b32 v224, a52
    v_accvgpr_read_b32 v225, a53
    v_accvgpr_read_b32 v226, a54
    v_accvgpr_read_b32 v227, a55
    v_mul_f32 v224, v224, v220
    v_mul_f32 v225, v225, v220
    v_mul_f32 v226, v226, v220
    v_mul_f32 v227, v227, v220
    v_accvgpr_write_b32 a52, v224
    v_accvgpr_write_b32 a53, v225
    v_accvgpr_write_b32 a54, v226
    v_accvgpr_write_b32 a55, v227
    v_accvgpr_read_b32 v224, a68
    v_accvgpr_read_b32 v225, a69
    v_accvgpr_read_b32 v226, a70
    v_accvgpr_read_b32 v227, a71
    v_mul_f32 v224, v224, v220
    v_mul_f32 v225, v225, v220
    v_mul_f32 v226, v226, v220
    v_mul_f32 v227, v227, v220
    v_accvgpr_write_b32 a68, v224
    v_accvgpr_write_b32 a69, v225
    v_accvgpr_write_b32 a70, v226
    v_accvgpr_write_b32 a71, v227
    v_accvgpr_read_b32 v224, a84
    v_accvgpr_read_b32 v225, a85
    v_accvgpr_read_b32 v226, a86
    v_accvgpr_read_b32 v227, a87
    v_mul_f32 v224, v224, v220
    v_mul_f32 v225, v225, v220
    v_mul_f32 v226, v226, v220
    v_mul_f32 v227, v227, v220
    v_accvgpr_write_b32 a84, v224
    v_accvgpr_write_b32 a85, v225
    v_accvgpr_write_b32 a86, v226
    v_accvgpr_write_b32 a87, v227
    v_accvgpr_read_b32 v224, a100
    v_accvgpr_read_b32 v225, a101
    v_accvgpr_read_b32 v226, a102
    v_accvgpr_read_b32 v227, a103
    v_mul_f32 v224, v224, v220
    v_mul_f32 v225, v225, v220
    v_mul_f32 v226, v226, v220
    v_mul_f32 v227, v227, v220
    v_accvgpr_write_b32 a100, v224
    v_accvgpr_write_b32 a101, v225
    v_accvgpr_write_b32 a102, v226
    v_accvgpr_write_b32 a103, v227
    v_accvgpr_read_b32 v224, a116
    v_accvgpr_read_b32 v225, a117
    v_accvgpr_read_b32 v226, a118
    v_accvgpr_read_b32 v227, a119
    v_mul_f32 v224, v224, v220
    v_mul_f32 v225, v225, v220
    v_mul_f32 v226, v226, v220
    v_mul_f32 v227, v227, v220
    v_accvgpr_write_b32 a116, v224
    v_accvgpr_write_b32 a117, v225
    v_accvgpr_write_b32 a118, v226
    v_accvgpr_write_b32 a119, v227
    v_add_f32 v217, v217, v120
    v_add_f32 v217, v217, v121
    v_add_f32 v217, v217, v122
    v_add_f32 v217, v217, v123
    v_add_f32 v217, v217, v136
    v_add_f32 v217, v217, v137
    v_add_f32 v217, v217, v138
    v_add_f32 v217, v217, v139
    v_cvt_pk_bf16_f32 v184, v120, v121
    v_cvt_pk_bf16_f32 v185, v122, v123
    v_cvt_pk_bf16_f32 v186, v136, v137
    v_cvt_pk_bf16_f32 v187, v138, v139
    s_nop 1
    v_mfma_f32_16x16x32_bf16 a[4:7], v[196:199], v[184:187], a[4:7]
    v_mfma_f32_16x16x32_bf16 a[20:23], v[200:203], v[184:187], a[20:23]
    v_mfma_f32_16x16x32_bf16 a[36:39], v[204:207], v[184:187], a[36:39]
    v_mfma_f32_16x16x32_bf16 a[52:55], v[208:211], v[184:187], a[52:55]
    v_mfma_f32_16x16x32_bf16 a[68:71], v[228:231], v[184:187], a[68:71]
    v_mfma_f32_16x16x32_bf16 a[84:87], v[232:235], v[184:187], a[84:87]
    v_mfma_f32_16x16x32_bf16 a[100:103], v[236:239], v[184:187], a[100:103]
    v_mfma_f32_16x16x32_bf16 a[116:119], v[240:243], v[184:187], a[116:119]
    v_max3_f32 v224, v124, v125, v126
    v_max3_f32 v224, v224, v127, v140
    v_max3_f32 v224, v224, v141, v142
    v_max3_f32 v224, v224, v143, v214
    v_mov_b32 v225, v224
    s_nop 1
    v_permlane32_swap_b32 v224, v225
    v_max_f32 v224, v224, v225
    v_mov_b32 v225, v224
    s_nop 1
    v_permlane16_swap_b32 v224, v225
    v_max_f32 v224, v224, v225
    v_sub_f32 v220, v214, v224
    v_exp_f32 v220, v220
    v_mov_b32 v214, v224
    v_sub_f32 v124, v124, v224
    v_sub_f32 v125, v125, v224
    v_sub_f32 v126, v126, v224
    v_sub_f32 v127, v127, v224
    v_sub_f32 v140, v140, v224
    v_sub_f32 v141, v141, v224
    v_sub_f32 v142, v142, v224
    v_sub_f32 v143, v143, v224
    v_mul_f32 v218, v218, v220
    v_exp_f32 v124, v124
    v_exp_f32 v125, v125
    v_exp_f32 v126, v126
    v_exp_f32 v127, v127
    v_exp_f32 v140, v140
    v_exp_f32 v141, v141
    v_exp_f32 v142, v142
    v_exp_f32 v143, v143
    v_accvgpr_read_b32 v224, a8
    v_accvgpr_read_b32 v225, a9
    v_accvgpr_read_b32 v226, a10
    v_accvgpr_read_b32 v227, a11
    v_mul_f32 v224, v224, v220
    v_mul_f32 v225, v225, v220
    v_mul_f32 v226, v226, v220
    v_mul_f32 v227, v227, v220
    v_accvgpr_write_b32 a8, v224
    v_accvgpr_write_b32 a9, v225
    v_accvgpr_write_b32 a10, v226
    v_accvgpr_write_b32 a11, v227
    v_accvgpr_read_b32 v224, a24
    v_accvgpr_read_b32 v225, a25
    v_accvgpr_read_b32 v226, a26
    v_accvgpr_read_b32 v227, a27
    v_mul_f32 v224, v224, v220
    v_mul_f32 v225, v225, v220
    v_mul_f32 v226, v226, v220
    v_mul_f32 v227, v227, v220
    v_accvgpr_write_b32 a24, v224
    v_accvgpr_write_b32 a25, v225
    v_accvgpr_write_b32 a26, v226
    v_accvgpr_write_b32 a27, v227
    v_accvgpr_read_b32 v224, a40
    v_accvgpr_read_b32 v225, a41
    v_accvgpr_read_b32 v226, a42
    v_accvgpr_read_b32 v227, a43
    v_mul_f32 v224, v224, v220
    v_mul_f32 v225, v225, v220
    v_mul_f32 v226, v226, v220
    v_mul_f32 v227, v227, v220
    v_accvgpr_write_b32 a40, v224
    v_accvgpr_write_b32 a41, v225
    v_accvgpr_write_b32 a42, v226
    v_accvgpr_write_b32 a43, v227
    v_accvgpr_read_b32 v224, a56
    v_accvgpr_read_b32 v225, a57
    v_accvgpr_read_b32 v226, a58
    v_accvgpr_read_b32 v227, a59
    v_mul_f32 v224, v224, v220
    v_mul_f32 v225, v225, v220
    v_mul_f32 v226, v226, v220
    v_mul_f32 v227, v227, v220
    v_accvgpr_write_b32 a56, v224
    v_accvgpr_write_b32 a57, v225
    v_accvgpr_write_b32 a58, v226
    v_accvgpr_write_b32 a59, v227
    v_accvgpr_read_b32 v224, a72
    v_accvgpr_read_b32 v225, a73
    v_accvgpr_read_b32 v226, a74
    v_accvgpr_read_b32 v227, a75
    v_mul_f32 v224, v224, v220
    v_mul_f32 v225, v225, v220
    v_mul_f32 v226, v226, v220
    v_mul_f32 v227, v227, v220
    v_accvgpr_write_b32 a72, v224
    v_accvgpr_write_b32 a73, v225
    v_accvgpr_write_b32 a74, v226
    v_accvgpr_write_b32 a75, v227
    v_accvgpr_read_b32 v224, a88
    v_accvgpr_read_b32 v225, a89
    v_accvgpr_read_b32 v226, a90
    v_accvgpr_read_b32 v227, a91
    v_mul_f32 v224, v224, v220
    v_mul_f32 v225, v225, v220
    v_mul_f32 v226, v226, v220
    v_mul_f32 v227, v227, v220
    v_accvgpr_write_b32 a88, v224
    v_accvgpr_write_b32 a89, v225
    v_accvgpr_write_b32 a90, v226
    v_accvgpr_write_b32 a91, v227
    v_accvgpr_read_b32 v224, a104
    v_accvgpr_read_b32 v225, a105
    v_accvgpr_read_b32 v226, a106
    v_accvgpr_read_b32 v227, a107
    v_mul_f32 v224, v224, v220
    v_mul_f32 v225, v225, v220
    v_mul_f32 v226, v226, v220
    v_mul_f32 v227, v227, v220
    v_accvgpr_write_b32 a104, v224
    v_accvgpr_write_b32 a105, v225
    v_accvgpr_write_b32 a106, v226
    v_accvgpr_write_b32 a107, v227
    v_accvgpr_read_b32 v224, a120
    v_accvgpr_read_b32 v225, a121
    v_accvgpr_read_b32 v226, a122
    v_accvgpr_read_b32 v227, a123
    v_mul_f32 v224, v224, v220
    v_mul_f32 v225, v225, v220
    v_mul_f32 v226, v226, v220
    v_mul_f32 v227, v227, v220
    v_accvgpr_write_b32 a120, v224
    v_accvgpr_write_b32 a121, v225
    v_accvgpr_write_b32 a122, v226
    v_accvgpr_write_b32 a123, v227
    v_add_f32 v218, v218, v124
    v_add_f32 v218, v218, v125
    v_add_f32 v218, v218, v126
    v_add_f32 v218, v218, v127
    v_add_f32 v218, v218, v140
    v_add_f32 v218, v218, v141
    v_add_f32 v218, v218, v142
    v_add_f32 v218, v218, v143
    v_cvt_pk_bf16_f32 v188, v124, v125
    v_cvt_pk_bf16_f32 v189, v126, v127
    v_cvt_pk_bf16_f32 v190, v140, v141
    v_cvt_pk_bf16_f32 v191, v142, v143
    s_nop 1
    v_mfma_f32_16x16x32_bf16 a[8:11], v[196:199], v[188:191], a[8:11]
    v_mfma_f32_16x16x32_bf16 a[24:27], v[200:203], v[188:191], a[24:27]
    v_mfma_f32_16x16x32_bf16 a[40:43], v[204:207], v[188:191], a[40:43]
    v_mfma_f32_16x16x32_bf16 a[56:59], v[208:211], v[188:191], a[56:59]
    v_mfma_f32_16x16x32_bf16 a[72:75], v[228:231], v[188:191], a[72:75]
    v_mfma_f32_16x16x32_bf16 a[88:91], v[232:235], v[188:191], a[88:91]
    v_mfma_f32_16x16x32_bf16 a[104:107], v[236:239], v[188:191], a[104:107]
    v_mfma_f32_16x16x32_bf16 a[120:123], v[240:243], v[188:191], a[120:123]
    v_max3_f32 v224, v128, v129, v130
    v_max3_f32 v224, v224, v131, v144
    v_max3_f32 v224, v224, v145, v146
    v_max3_f32 v224, v224, v147, v215
    v_mov_b32 v225, v224
    s_nop 1
    v_permlane32_swap_b32 v224, v225
    v_max_f32 v224, v224, v225
    v_mov_b32 v225, v224
    s_nop 1
    v_permlane16_swap_b32 v224, v225
    v_max_f32 v224, v224, v225
    v_sub_f32 v220, v215, v224
    v_exp_f32 v220, v220
    v_mov_b32 v215, v224
    v_sub_f32 v128, v128, v224
    v_sub_f32 v129, v129, v224
    v_sub_f32 v130, v130, v224
    v_sub_f32 v131, v131, v224
    v_sub_f32 v144, v144, v224
    v_sub_f32 v145, v145, v224
    v_sub_f32 v146, v146, v224
    v_sub_f32 v147, v147, v224
    v_mul_f32 v219, v219, v220
    v_exp_f32 v128, v128
    v_exp_f32 v129, v129
    v_exp_f32 v130, v130
    v_exp_f32 v131, v131
    v_exp_f32 v144, v144
    v_exp_f32 v145, v145
    v_exp_f32 v146, v146
    v_exp_f32 v147, v147
    v_accvgpr_read_b32 v224, a12
    v_accvgpr_read_b32 v225, a13
    v_accvgpr_read_b32 v226, a14
    v_accvgpr_read_b32 v227, a15
    v_mul_f32 v224, v224, v220
    v_mul_f32 v225, v225, v220
    v_mul_f32 v226, v226, v220
    v_mul_f32 v227, v227, v220
    v_accvgpr_write_b32 a12, v224
    v_accvgpr_write_b32 a13, v225
    v_accvgpr_write_b32 a14, v226
    v_accvgpr_write_b32 a15, v227
    v_accvgpr_read_b32 v224, a28
    v_accvgpr_read_b32 v225, a29
    v_accvgpr_read_b32 v226, a30
    v_accvgpr_read_b32 v227, a31
    v_mul_f32 v224, v224, v220
    v_mul_f32 v225, v225, v220
    v_mul_f32 v226, v226, v220
    v_mul_f32 v227, v227, v220
    v_accvgpr_write_b32 a28, v224
    v_accvgpr_write_b32 a29, v225
    v_accvgpr_write_b32 a30, v226
    v_accvgpr_write_b32 a31, v227
    v_accvgpr_read_b32 v224, a44
    v_accvgpr_read_b32 v225, a45
    v_accvgpr_read_b32 v226, a46
    v_accvgpr_read_b32 v227, a47
    v_mul_f32 v224, v224, v220
    v_mul_f32 v225, v225, v220
    v_mul_f32 v226, v226, v220
    v_mul_f32 v227, v227, v220
    v_accvgpr_write_b32 a44, v224
    v_accvgpr_write_b32 a45, v225
    v_accvgpr_write_b32 a46, v226
    v_accvgpr_write_b32 a47, v227
    v_accvgpr_read_b32 v224, a60
    v_accvgpr_read_b32 v225, a61
    v_accvgpr_read_b32 v226, a62
    v_accvgpr_read_b32 v227, a63
    v_mul_f32 v224, v224, v220
    v_mul_f32 v225, v225, v220
    v_mul_f32 v226, v226, v220
    v_mul_f32 v227, v227, v220
    v_accvgpr_write_b32 a60, v224
    v_accvgpr_write_b32 a61, v225
    v_accvgpr_write_b32 a62, v226
    v_accvgpr_write_b32 a63, v227
    v_accvgpr_read_b32 v224, a76
    v_accvgpr_read_b32 v225, a77
    v_accvgpr_read_b32 v226, a78
    v_accvgpr_read_b32 v227, a79
    v_mul_f32 v224, v224, v220
    v_mul_f32 v225, v225, v220
    v_mul_f32 v226, v226, v220
    v_mul_f32 v227, v227, v220
    v_accvgpr_write_b32 a76, v224
    v_accvgpr_write_b32 a77, v225
    v_accvgpr_write_b32 a78, v226
    v_accvgpr_write_b32 a79, v227
    v_accvgpr_read_b32 v224, a92
    v_accvgpr_read_b32 v225, a93
    v_accvgpr_read_b32 v226, a94
    v_accvgpr_read_b32 v227, a95
    v_mul_f32 v224, v224, v220
    v_mul_f32 v225, v225, v220
    v_mul_f32 v226, v226, v220
    v_mul_f32 v227, v227, v220
    v_accvgpr_write_b32 a92, v224
    v_accvgpr_write_b32 a93, v225
    v_accvgpr_write_b32 a94, v226
    v_accvgpr_write_b32 a95, v227
    v_accvgpr_read_b32 v224, a108
    v_accvgpr_read_b32 v225, a109
    v_accvgpr_read_b32 v226, a110
    v_accvgpr_read_b32 v227, a111
    v_mul_f32 v224, v224, v220
    v_mul_f32 v225, v225, v220
    v_mul_f32 v226, v226, v220
    v_mul_f32 v227, v227, v220
    v_accvgpr_write_b32 a108, v224
    v_accvgpr_write_b32 a109, v225
    v_accvgpr_write_b32 a110, v226
    v_accvgpr_write_b32 a111, v227
    v_accvgpr_read_b32 v224, a124
    v_accvgpr_read_b32 v225, a125
    v_accvgpr_read_b32 v226, a126
    v_accvgpr_read_b32 v227, a127
    v_mul_f32 v224, v224, v220
    v_mul_f32 v225, v225, v220
    v_mul_f32 v226, v226, v220
    v_mul_f32 v227, v227, v220
    v_accvgpr_write_b32 a124, v224
    v_accvgpr_write_b32 a125, v225
    v_accvgpr_write_b32 a126, v226
    v_accvgpr_write_b32 a127, v227
    v_add_f32 v219, v219, v128
    v_add_f32 v219, v219, v129
    v_add_f32 v219, v219, v130
    v_add_f32 v219, v219, v131
    v_add_f32 v219, v219, v144
    v_add_f32 v219, v219, v145
    v_add_f32 v219, v219, v146
    v_add_f32 v219, v219, v147
    v_cvt_pk_bf16_f32 v192, v128, v129
    v_cvt_pk_bf16_f32 v193, v130, v131
    v_cvt_pk_bf16_f32 v194, v144, v145
    v_cvt_pk_bf16_f32 v195, v146, v147
    s_nop 1
    v_mfma_f32_16x16x32_bf16 a[12:15], v[196:199], v[192:195], a[12:15]
    v_mfma_f32_16x16x32_bf16 a[28:31], v[200:203], v[192:195], a[28:31]
    v_mfma_f32_16x16x32_bf16 a[44:47], v[204:207], v[192:195], a[44:47]
    v_mfma_f32_16x16x32_bf16 a[60:63], v[208:211], v[192:195], a[60:63]
    v_mfma_f32_16x16x32_bf16 a[76:79], v[228:231], v[192:195], a[76:79]
    v_mfma_f32_16x16x32_bf16 a[92:95], v[232:235], v[192:195], a[92:95]
    v_mfma_f32_16x16x32_bf16 a[108:111], v[236:239], v[192:195], a[108:111]
    v_mfma_f32_16x16x32_bf16 a[124:127], v[240:243], v[192:195], a[124:127]
    s_add_u32 s28, s28, 8192
    s_cmp_lt_u32 s28, 524288
    s_cbranch_scc1 L_slow_loop
    v_mov_b32 v224, v216
    s_nop 1
    v_permlane32_swap_b32 v216, v224
    v_add_f32 v216, v216, v224
    v_mov_b32 v224, v216
    s_nop 1
    v_permlane16_swap_b32 v216, v224
    v_add_f32 v216, v216, v224
    v_rcp_f32 v100, v216
    v_mov_b32 v224, v217
    s_nop 1
    v_permlane32_swap_b32 v217, v224
    v_add_f32 v217, v217, v224
    v_mov_b32 v224, v217
    s_nop 1
    v_permlane16_swap_b32 v217, v224
    v_add_f32 v217, v217, v224
    v_rcp_f32 v101, v217
    v_mov_b32 v224, v218
    s_nop 1
    v_permlane32_swap_b32 v218, v224
    v_add_f32 v218, v218, v224
    v_mov_b32 v224, v218
    s_nop 1
    v_permlane16_swap_b32 v218, v224
    v_add_f32 v218, v218, v224
    v_rcp_f32 v102, v218
    v_mov_b32 v224, v219
    s_nop 1
    v_permlane32_swap_b32 v219, v224
    v_add_f32 v219, v219, v224
    v_mov_b32 v224, v219
    s_nop 1
    v_permlane16_swap_b32 v219, v224
    v_add_f32 v219, v219, v224
    v_rcp_f32 v103, v219
    s_mov_b32 s36, 0
    v_accvgpr_read_b32 v120, a0
    v_accvgpr_read_b32 v121, a1
    v_accvgpr_read_b32 v122, a2
    v_accvgpr_read_b32 v123, a3
    v_accvgpr_read_b32 v124, a16
    v_accvgpr_read_b32 v125, a17
    v_accvgpr_read_b32 v126, a18
    v_accvgpr_read_b32 v127, a19
    v_mul_f32 v120, v120, v100
    v_mul_f32 v121, v121, v100
    v_mul_f32 v122, v122, v100
    v_mul_f32 v123, v123, v100
    v_mul_f32 v124, v124, v100
    v_mul_f32 v125, v125, v100
    v_mul_f32 v126, v126, v100
    v_mul_f32 v127, v127, v100
    v_cvt_pk_bf16_f32 v152, v120, v121
    v_cvt_pk_bf16_f32 v153, v122, v123
    v_cvt_pk_bf16_f32 v154, v124, v125
    v_cvt_pk_bf16_f32 v155, v126, v127
    buffer_store_dwordx4 v[152:155], v110, s[24:27], s36 offen offset:0 sc1
    v_accvgpr_read_b32 v128, a4
    v_accvgpr_read_b32 v129, a5
    v_accvgpr_read_b32 v130, a6
    v_accvgpr_read_b32 v131, a7
    v_accvgpr_read_b32 v132, a20
    v_accvgpr_read_b32 v133, a21
    v_accvgpr_read_b32 v134, a22
    v_accvgpr_read_b32 v135, a23
    v_mul_f32 v128, v128, v101
    v_mul_f32 v129, v129, v101
    v_mul_f32 v130, v130, v101
    v_mul_f32 v131, v131, v101
    v_mul_f32 v132, v132, v101
    v_mul_f32 v133, v133, v101
    v_mul_f32 v134, v134, v101
    v_mul_f32 v135, v135, v101
    v_cvt_pk_bf16_f32 v156, v128, v129
    v_cvt_pk_bf16_f32 v157, v130, v131
    v_cvt_pk_bf16_f32 v158, v132, v133
    v_cvt_pk_bf16_f32 v159, v134, v135
    buffer_store_dwordx4 v[156:159], v110, s[24:27], s36 offen offset:1024 sc1
    v_accvgpr_read_b32 v136, a8
    v_accvgpr_read_b32 v137, a9
    v_accvgpr_read_b32 v138, a10
    v_accvgpr_read_b32 v139, a11
    v_accvgpr_read_b32 v140, a24
    v_accvgpr_read_b32 v141, a25
    v_accvgpr_read_b32 v142, a26
    v_accvgpr_read_b32 v143, a27
    v_mul_f32 v136, v136, v102
    v_mul_f32 v137, v137, v102
    v_mul_f32 v138, v138, v102
    v_mul_f32 v139, v139, v102
    v_mul_f32 v140, v140, v102
    v_mul_f32 v141, v141, v102
    v_mul_f32 v142, v142, v102
    v_mul_f32 v143, v143, v102
    v_cvt_pk_bf16_f32 v160, v136, v137
    v_cvt_pk_bf16_f32 v161, v138, v139
    v_cvt_pk_bf16_f32 v162, v140, v141
    v_cvt_pk_bf16_f32 v163, v142, v143
    buffer_store_dwordx4 v[160:163], v110, s[24:27], s36 offen offset:2048 sc1
    v_accvgpr_read_b32 v144, a12
    v_accvgpr_read_b32 v145, a13
    v_accvgpr_read_b32 v146, a14
    v_accvgpr_read_b32 v147, a15
    v_accvgpr_read_b32 v148, a28
    v_accvgpr_read_b32 v149, a29
    v_accvgpr_read_b32 v150, a30
    v_accvgpr_read_b32 v151, a31
    v_mul_f32 v144, v144, v103
    v_mul_f32 v145, v145, v103
    v_mul_f32 v146, v146, v103
    v_mul_f32 v147, v147, v103
    v_mul_f32 v148, v148, v103
    v_mul_f32 v149, v149, v103
    v_mul_f32 v150, v150, v103
    v_mul_f32 v151, v151, v103
    v_cvt_pk_bf16_f32 v164, v144, v145
    v_cvt_pk_bf16_f32 v165, v146, v147
    v_cvt_pk_bf16_f32 v166, v148, v149
    v_cvt_pk_bf16_f32 v167, v150, v151
    buffer_store_dwordx4 v[164:167], v110, s[24:27], s36 offen offset:3072 sc1
    s_mov_b32 s36, 4096
    v_accvgpr_read_b32 v120, a32
    v_accvgpr_read_b32 v121, a33
    v_accvgpr_read_b32 v122, a34
    v_accvgpr_read_b32 v123, a35
    v_accvgpr_read_b32 v124, a48
    v_accvgpr_read_b32 v125, a49
    v_accvgpr_read_b32 v126, a50
    v_accvgpr_read_b32 v127, a51
    v_mul_f32 v120, v120, v100
    v_mul_f32 v121, v121, v100
    v_mul_f32 v122, v122, v100
    v_mul_f32 v123, v123, v100
    v_mul_f32 v124, v124, v100
    v_mul_f32 v125, v125, v100
    v_mul_f32 v126, v126, v100
    v_mul_f32 v127, v127, v100
    v_cvt_pk_bf16_f32 v152, v120, v121
    v_cvt_pk_bf16_f32 v153, v122, v123
    v_cvt_pk_bf16_f32 v154, v124, v125
    v_cvt_pk_bf16_f32 v155, v126, v127
    buffer_store_dwordx4 v[152:155], v110, s[24:27], s36 offen offset:0 sc1
    v_accvgpr_read_b32 v128, a36
    v_accvgpr_read_b32 v129, a37
    v_accvgpr_read_b32 v130, a38
    v_accvgpr_read_b32 v131, a39
    v_accvgpr_read_b32 v132, a52
    v_accvgpr_read_b32 v133, a53
    v_accvgpr_read_b32 v134, a54
    v_accvgpr_read_b32 v135, a55
    v_mul_f32 v128, v128, v101
    v_mul_f32 v129, v129, v101
    v_mul_f32 v130, v130, v101
    v_mul_f32 v131, v131, v101
    v_mul_f32 v132, v132, v101
    v_mul_f32 v133, v133, v101
    v_mul_f32 v134, v134, v101
    v_mul_f32 v135, v135, v101
    v_cvt_pk_bf16_f32 v156, v128, v129
    v_cvt_pk_bf16_f32 v157, v130, v131
    v_cvt_pk_bf16_f32 v158, v132, v133
    v_cvt_pk_bf16_f32 v159, v134, v135
    buffer_store_dwordx4 v[156:159], v110, s[24:27], s36 offen offset:1024 sc1
    v_accvgpr_read_b32 v136, a40
    v_accvgpr_read_b32 v137, a41
    v_accvgpr_read_b32 v138, a42
    v_accvgpr_read_b32 v139, a43
    v_accvgpr_read_b32 v140, a56
    v_accvgpr_read_b32 v141, a57
    v_accvgpr_read_b32 v142, a58
    v_accvgpr_read_b32 v143, a59
    v_mul_f32 v136, v136, v102
    v_mul_f32 v137, v137, v102
    v_mul_f32 v138, v138, v102
    v_mul_f32 v139, v139, v102
    v_mul_f32 v140, v140, v102
    v_mul_f32 v141, v141, v102
    v_mul_f32 v142, v142, v102
    v_mul_f32 v143, v143, v102
    v_cvt_pk_bf16_f32 v160, v136, v137
    v_cvt_pk_bf16_f32 v161, v138, v139
    v_cvt_pk_bf16_f32 v162, v140, v141
    v_cvt_pk_bf16_f32 v163, v142, v143
    buffer_store_dwordx4 v[160:163], v110, s[24:27], s36 offen offset:2048 sc1
    v_accvgpr_read_b32 v144, a44
    v_accvgpr_read_b32 v145, a45
    v_accvgpr_read_b32 v146, a46
    v_accvgpr_read_b32 v147, a47
    v_accvgpr_read_b32 v148, a60
    v_accvgpr_read_b32 v149, a61
    v_accvgpr_read_b32 v150, a62
    v_accvgpr_read_b32 v151, a63
    v_mul_f32 v144, v144, v103
    v_mul_f32 v145, v145, v103
    v_mul_f32 v146, v146, v103
    v_mul_f32 v147, v147, v103
    v_mul_f32 v148, v148, v103
    v_mul_f32 v149, v149, v103
    v_mul_f32 v150, v150, v103
    v_mul_f32 v151, v151, v103
    v_cvt_pk_bf16_f32 v164, v144, v145
    v_cvt_pk_bf16_f32 v165, v146, v147
    v_cvt_pk_bf16_f32 v166, v148, v149
    v_cvt_pk_bf16_f32 v167, v150, v151
    buffer_store_dwordx4 v[164:167], v110, s[24:27], s36 offen offset:3072 sc1
    s_mov_b32 s36, 8192
    v_accvgpr_read_b32 v120, a64
    v_accvgpr_read_b32 v121, a65
    v_accvgpr_read_b32 v122, a66
    v_accvgpr_read_b32 v123, a67
    v_accvgpr_read_b32 v124, a80
    v_accvgpr_read_b32 v125, a81
    v_accvgpr_read_b32 v126, a82
    v_accvgpr_read_b32 v127, a83
    v_mul_f32 v120, v120, v100
    v_mul_f32 v121, v121, v100
    v_mul_f32 v122, v122, v100
    v_mul_f32 v123, v123, v100
    v_mul_f32 v124, v124, v100
    v_mul_f32 v125, v125, v100
    v_mul_f32 v126, v126, v100
    v_mul_f32 v127, v127, v100
    v_cvt_pk_bf16_f32 v152, v120, v121
    v_cvt_pk_bf16_f32 v153, v122, v123
    v_cvt_pk_bf16_f32 v154, v124, v125
    v_cvt_pk_bf16_f32 v155, v126, v127
    buffer_store_dwordx4 v[152:155], v110, s[24:27], s36 offen offset:0 sc1
    v_accvgpr_read_b32 v128, a68
    v_accvgpr_read_b32 v129, a69
    v_accvgpr_read_b32 v130, a70
    v_accvgpr_read_b32 v131, a71
    v_accvgpr_read_b32 v132, a84
    v_accvgpr_read_b32 v133, a85
    v_accvgpr_read_b32 v134, a86
    v_accvgpr_read_b32 v135, a87
    v_mul_f32 v128, v128, v101
    v_mul_f32 v129, v129, v101
    v_mul_f32 v130, v130, v101
    v_mul_f32 v131, v131, v101
    v_mul_f32 v132, v132, v101
    v_mul_f32 v133, v133, v101
    v_mul_f32 v134, v134, v101
    v_mul_f32 v135, v135, v101
    v_cvt_pk_bf16_f32 v156, v128, v129
    v_cvt_pk_bf16_f32 v157, v130, v131
    v_cvt_pk_bf16_f32 v158, v132, v133
    v_cvt_pk_bf16_f32 v159, v134, v135
    buffer_store_dwordx4 v[156:159], v110, s[24:27], s36 offen offset:1024 sc1
    v_accvgpr_read_b32 v136, a72
    v_accvgpr_read_b32 v137, a73
    v_accvgpr_read_b32 v138, a74
    v_accvgpr_read_b32 v139, a75
    v_accvgpr_read_b32 v140, a88
    v_accvgpr_read_b32 v141, a89
    v_accvgpr_read_b32 v142, a90
    v_accvgpr_read_b32 v143, a91
    v_mul_f32 v136, v136, v102
    v_mul_f32 v137, v137, v102
    v_mul_f32 v138, v138, v102
    v_mul_f32 v139, v139, v102
    v_mul_f32 v140, v140, v102
    v_mul_f32 v141, v141, v102
    v_mul_f32 v142, v142, v102
    v_mul_f32 v143, v143, v102
    v_cvt_pk_bf16_f32 v160, v136, v137
    v_cvt_pk_bf16_f32 v161, v138, v139
    v_cvt_pk_bf16_f32 v162, v140, v141
    v_cvt_pk_bf16_f32 v163, v142, v143
    buffer_store_dwordx4 v[160:163], v110, s[24:27], s36 offen offset:2048 sc1
    v_accvgpr_read_b32 v144, a76
    v_accvgpr_read_b32 v145, a77
    v_accvgpr_read_b32 v146, a78
    v_accvgpr_read_b32 v147, a79
    v_accvgpr_read_b32 v148, a92
    v_accvgpr_read_b32 v149, a93
    v_accvgpr_read_b32 v150, a94
    v_accvgpr_read_b32 v151, a95
    v_mul_f32 v144, v144, v103
    v_mul_f32 v145, v145, v103
    v_mul_f32 v146, v146, v103
    v_mul_f32 v147, v147, v103
    v_mul_f32 v148, v148, v103
    v_mul_f32 v149, v149, v103
    v_mul_f32 v150, v150, v103
    v_mul_f32 v151, v151, v103
    v_cvt_pk_bf16_f32 v164, v144, v145
    v_cvt_pk_bf16_f32 v165, v146, v147
    v_cvt_pk_bf16_f32 v166, v148, v149
    v_cvt_pk_bf16_f32 v167, v150, v151
    buffer_store_dwordx4 v[164:167], v110, s[24:27], s36 offen offset:3072 sc1
    s_mov_b32 s36, 12288
    v_accvgpr_read_b32 v120, a96
    v_accvgpr_read_b32 v121, a97
    v_accvgpr_read_b32 v122, a98
    v_accvgpr_read_b32 v123, a99
    v_accvgpr_read_b32 v124, a112
    v_accvgpr_read_b32 v125, a113
    v_accvgpr_read_b32 v126, a114
    v_accvgpr_read_b32 v127, a115
    v_mul_f32 v120, v120, v100
    v_mul_f32 v121, v121, v100
    v_mul_f32 v122, v122, v100
    v_mul_f32 v123, v123, v100
    v_mul_f32 v124, v124, v100
    v_mul_f32 v125, v125, v100
    v_mul_f32 v126, v126, v100
    v_mul_f32 v127, v127, v100
    v_cvt_pk_bf16_f32 v152, v120, v121
    v_cvt_pk_bf16_f32 v153, v122, v123
    v_cvt_pk_bf16_f32 v154, v124, v125
    v_cvt_pk_bf16_f32 v155, v126, v127
    buffer_store_dwordx4 v[152:155], v110, s[24:27], s36 offen offset:0 sc1
    v_accvgpr_read_b32 v128, a100
    v_accvgpr_read_b32 v129, a101
    v_accvgpr_read_b32 v130, a102
    v_accvgpr_read_b32 v131, a103
    v_accvgpr_read_b32 v132, a116
    v_accvgpr_read_b32 v133, a117
    v_accvgpr_read_b32 v134, a118
    v_accvgpr_read_b32 v135, a119
    v_mul_f32 v128, v128, v101
    v_mul_f32 v129, v129, v101
    v_mul_f32 v130, v130, v101
    v_mul_f32 v131, v131, v101
    v_mul_f32 v132, v132, v101
    v_mul_f32 v133, v133, v101
    v_mul_f32 v134, v134, v101
    v_mul_f32 v135, v135, v101
    v_cvt_pk_bf16_f32 v156, v128, v129
    v_cvt_pk_bf16_f32 v157, v130, v131
    v_cvt_pk_bf16_f32 v158, v132, v133
    v_cvt_pk_bf16_f32 v159, v134, v135
    buffer_store_dwordx4 v[156:159], v110, s[24:27], s36 offen offset:1024 sc1
    v_accvgpr_read_b32 v136, a104
    v_accvgpr_read_b32 v137, a105
    v_accvgpr_read_b32 v138, a106
    v_accvgpr_read_b32 v139, a107
    v_accvgpr_read_b32 v140, a120
    v_accvgpr_read_b32 v141, a121
    v_accvgpr_read_b32 v142, a122
    v_accvgpr_read_b32 v143, a123
    v_mul_f32 v136, v136, v102
    v_mul_f32 v137, v137, v102
    v_mul_f32 v138, v138, v102
    v_mul_f32 v139, v139, v102
    v_mul_f32 v140, v140, v102
    v_mul_f32 v141, v141, v102
    v_mul_f32 v142, v142, v102
    v_mul_f32 v143, v143, v102
    v_cvt_pk_bf16_f32 v160, v136, v137
    v_cvt_pk_bf16_f32 v161, v138, v139
    v_cvt_pk_bf16_f32 v162, v140, v141
    v_cvt_pk_bf16_f32 v163, v142, v143
    buffer_store_dwordx4 v[160:163], v110, s[24:27], s36 offen offset:2048 sc1
    v_accvgpr_read_b32 v144, a108
    v_accvgpr_read_b32 v145, a109
    v_accvgpr_read_b32 v146, a110
    v_accvgpr_read_b32 v147, a111
    v_accvgpr_read_b32 v148, a124
    v_accvgpr_read_b32 v149, a125
    v_accvgpr_read_b32 v150, a126
    v_accvgpr_read_b32 v151, a127
    v_mul_f32 v144, v144, v103
    v_mul_f32 v145, v145, v103
    v_mul_f32 v146, v146, v103
    v_mul_f32 v147, v147, v103
    v_mul_f32 v148, v148, v103
    v_mul_f32 v149, v149, v103
    v_mul_f32 v150, v150, v103
    v_mul_f32 v151, v151, v103
    v_cvt_pk_bf16_f32 v164, v144, v145
    v_cvt_pk_bf16_f32 v165, v146, v147
    v_cvt_pk_bf16_f32 v166, v148, v149
    v_cvt_pk_bf16_f32 v167, v150, v151
    buffer_store_dwordx4 v[164:167], v110, s[24:27], s36 offen offset:3072 sc1
    s_mov_b32 s45, 61440
    buffer_load_dwordx4 a[0:3], v114, s[20:23], s45 offen offset:1024 sc1
    s_mov_b32 s45, 61440
    buffer_load_dwordx4 a[4:7], v114, s[20:23], s45 offen offset:2048 sc1
    s_mov_b32 s45, 61440
    buffer_load_dwordx4 a[8:11], v114, s[20:23], s45 offen offset:3072 sc1
    s_mov_b32 s45, 61440
    buffer_load_dwordx4 a[12:15], v115, s[20:23], s45 offen offset:0 sc1
    s_mov_b32 s45, 81920
    buffer_load_dwordx4 a[16:19], v114, s[20:23], s45 offen offset:0 sc1
    s_mov_b32 s45, 81920
    buffer_load_dwordx4 a[20:23], v114, s[20:23], s45 offen offset:1024 sc1
    s_mov_b32 s45, 81920
    buffer_load_dwordx4 a[24:27], v114, s[20:23], s45 offen offset:2048 sc1
    s_mov_b32 s45, 81920
    buffer_load_dwordx4 a[28:31], v114, s[20:23], s45 offen offset:3072 sc1
    s_mov_b32 s45, 81920
    buffer_load_dwordx4 a[32:35], v115, s[20:23], s45 offen offset:0 sc1
    s_mov_b32 s45, 102400
    buffer_load_dwordx4 a[36:39], v114, s[20:23], s45 offen offset:0 sc1
    s_mov_b32 s45, 102400
    buffer_load_dwordx4 a[40:43], v114, s[20:23], s45 offen offset:1024 sc1
    s_mov_b32 s45, 102400
    buffer_load_dwordx4 a[44:47], v114, s[20:23], s45 offen offset:2048 sc1
    s_mov_b32 s45, 102400
    buffer_load_dwordx4 a[48:51], v114, s[20:23], s45 offen offset:3072 sc1
    s_mov_b32 s45, 102400
    buffer_load_dwordx4 a[52:55], v115, s[20:23], s45 offen offset:0 sc1
    s_mov_b32 s45, 122880
    buffer_load_dwordx4 a[56:59], v114, s[20:23], s45 offen offset:0 sc1
    s_mov_b32 s45, 122880
    buffer_load_dwordx4 a[60:63], v114, s[20:23], s45 offen offset:1024 sc1
    s_mov_b32 s45, 122880
    buffer_load_dwordx4 a[64:67], v114, s[20:23], s45 offen offset:2048 sc1
    s_mov_b32 s45, 122880
    buffer_load_dwordx4 a[68:71], v114, s[20:23], s45 offen offset:3072 sc1
    s_mov_b32 s45, 122880
    buffer_load_dwordx4 a[72:75], v115, s[20:23], s45 offen offset:0 sc1
    s_mov_b32 s45, 143360
    buffer_load_dwordx4 a[76:79], v114, s[20:23], s45 offen offset:0 sc1
    s_mov_b32 s45, 143360
    buffer_load_dwordx4 a[80:83], v114, s[20:23], s45 offen offset:1024 sc1
    s_mov_b32 s45, 143360
    buffer_load_dwordx4 a[84:87], v114, s[20:23], s45 offen offset:2048 sc1
    s_mov_b32 s45, 143360
    buffer_load_dwordx4 a[88:91], v114, s[20:23], s45 offen offset:3072 sc1
    s_mov_b32 s45, 143360
    buffer_load_dwordx4 a[92:95], v115, s[20:23], s45 offen offset:0 sc1
    s_waitcnt vmcnt(0)
    s_branch L_published
L_spin_rows:
    s_mov_b32 s7, 32768
L_retry_rows:
    s_sleep 2
    buffer_load_dword v252, off, s[92:95], s74 sc1
    s_waitcnt vmcnt(0)
    v_cmp_gt_u32 vcc, 32, v252
    s_and_b64 vcc, vcc, exec
    s_cbranch_scc0 L_back_rows
    s_sub_u32 s7, s7, 1
    s_cbranch_scc0 L_retry_rows
    s_branch L_back_rows
L_spin_all:
    s_mov_b32 s7, 32768
L_retry_all:
    s_sleep 2
    buffer_load_dword v252, v253, s[92:95], 0 offen sc1
    s_waitcnt vmcnt(0)
    v_cmp_gt_u32 vcc, 32, v252
    s_and_b64 vcc, vcc, exec
    s_cbranch_scc0 L_back_all
    s_sub_u32 s7, s7, 1
    s_cbranch_scc0 L_retry_all
    s_branch L_back_all
L_rt_keys:
    s_lshl_b32 s40, s5, 13
    s_add_u32 s40, s40, 0x280008
    v_lshlrev_b32 v253, 4, v19
    buffer_load_dword v28, v253, s[76:79], s40 offen offset:0 sc1
    buffer_load_dword v29, v253, s[76:79], s40 offen offset:1024 sc1
    buffer_load_dword v30, v253, s[76:79], s40 offen offset:2048 sc1
    buffer_load_dword v31, v253, s[76:79], s40 offen offset:3072 sc1
    s_add_u32 s40, s40, 4096
    buffer_load_dword v32, v253, s[76:79], s40 offen offset:0 sc1
    buffer_load_dword v33, v253, s[76:79], s40 offen offset:1024 sc1
    buffer_load_dword v34, v253, s[76:79], s40 offen offset:2048 sc1
    buffer_load_dword v35, v253, s[76:79], s40 offen offset:3072 sc1
    s_branch L_rt_back_keys
L_rt_local:
    s_waitcnt vmcnt(11)
    s_mov_b32 s42, -1
    v_sub_u32 v20, s42, v28
    v_sub_u32 v21, s42, v29
    v_sub_u32 v22, s42, v30
    v_min3_u32 v20, v20, v21, v22
    v_sub_u32 v21, s42, v31
    v_sub_u32 v22, s42, v32
    v_min3_u32 v20, v20, v21, v22
    v_sub_u32 v21, s42, v33
    v_sub_u32 v22, s42, v34
    v_min3_u32 v20, v20, v21, v22
    v_sub_u32 v21, s42, v35
    v_min_u32 v20, v20, v21
    s_nop 1
    v_min_u32_dpp v20, v20, v20 row_shr:1 row_mask:0xf bank_mask:0xf
    s_nop 1
    v_min_u32_dpp v20, v20, v20 row_shr:2 row_mask:0xf bank_mask:0xf
    s_nop 1
    v_min_u32_dpp v20, v20, v20 row_shr:4 row_mask:0xf bank_mask:0xf
    s_nop 1
    v_min_u32_dpp v20, v20, v20 row_shr:8 row_mask:0xf bank_mask:0xf
    s_nop 1
    v_min_u32_dpp v20, v20, v20 row_bcast:15 row_mask:0xa bank_mask:0xf
    s_nop 1
    v_min_u32_dpp v20, v20, v20 row_bcast:31 row_mask:0xc bank_mask:0xf
    s_nop 0
    v_readlane_b32 s50, v20, 63
    s_sub_u32 s50, s42, s50
    s_sub_u32 s42, s50, 1
    v_sub_u32 v20, s42, v28
    v_sub_u32 v21, s42, v29
    v_sub_u32 v22, s42, v30
    v_min3_u32 v20, v20, v21, v22
    v_sub_u32 v21, s42, v31
    v_sub_u32 v22, s42, v32
    v_min3_u32 v20, v20, v21, v22
    v_sub_u32 v21, s42, v33
    v_sub_u32 v22, s42, v34
    v_min3_u32 v20, v20, v21, v22
    v_sub_u32 v21, s42, v35
    v_min_u32 v20, v20, v21
    s_nop 1
    v_min_u32_dpp v20, v20, v20 row_shr:1 row_mask:0xf bank_mask:0xf
    s_nop 1
    v_min_u32_dpp v20, v20, v20 row_shr:2 row_mask:0xf bank_mask:0xf
    s_nop 1
    v_min_u32_dpp v20, v20, v20 row_shr:4 row_mask:0xf bank_mask:0xf
    s_nop 1
    v_min_u32_dpp v20, v20, v20 row_shr:8 row_mask:0xf bank_mask:0xf
    s_nop 1
    v_min_u32_dpp v20, v20, v20 row_bcast:15 row_mask:0xa bank_mask:0xf
    s_nop 1
    v_min_u32_dpp v20, v20, v20 row_bcast:31 row_mask:0xc bank_mask:0xf
    s_nop 0
    v_readlane_b32 s51, v20, 63
    s_sub_u32 s51, s42, s51
    s_sub_u32 s42, s51, 1
    v_sub_u32 v20, s42, v28
    v_sub_u32 v21, s42, v29
    v_sub_u32 v22, s42, v30
    v_min3_u32 v20, v20, v21, v22
    v_sub_u32 v21, s42, v31
    v_sub_u32 v22, s42, v32
    v_min3_u32 v20, v20, v21, v22
    v_sub_u32 v21, s42, v33
    v_sub_u32 v22, s42, v34
    v_min3_u32 v20, v20, v21, v22
    v_sub_u32 v21, s42, v35
    v_min_u32 v20, v20, v21
    s_nop 1
    v_min_u32_dpp v20, v20, v20 row_shr:1 row_mask:0xf bank_mask:0xf
    s_nop 1
    v_min_u32_dpp v20, v20, v20 row_shr:2 row_mask:0xf bank_mask:0xf
    s_nop 1
    v_min_u32_dpp v20, v20, v20 row_shr:4 row_mask:0xf bank_mask:0xf
    s_nop 1
    v_min_u32_dpp v20, v20, v20 row_shr:8 row_mask:0xf bank_mask:0xf
    s_nop 1
    v_min_u32_dpp v20, v20, v20 row_bcast:15 row_mask:0xa bank_mask:0xf
    s_nop 1
    v_min_u32_dpp v20, v20, v20 row_bcast:31 row_mask:0xc bank_mask:0xf
    s_nop 0
    v_readlane_b32 s52, v20, 63
    s_sub_u32 s52, s42, s52
    s_sub_u32 s42, s52, 1
    v_sub_u32 v20, s42, v28
    v_sub_u32 v21, s42, v29
    v_sub_u32 v22, s42, v30
    v_min3_u32 v20, v20, v21, v22
    v_sub_u32 v21, s42, v31
    v_sub_u32 v22, s42, v32
    v_min3_u32 v20, v20, v21, v22
    v_sub_u32 v21, s42, v33
    v_sub_u32 v22, s42, v34
    v_min3_u32 v20, v20, v21, v22
    v_sub_u32 v21, s42, v35
    v_min_u32 v20, v20, v21
    s_nop 1
    v_min_u32_dpp v20, v20, v20 row_shr:1 row_mask:0xf bank_mask:0xf
    s_nop 1
    v_min_u32_dpp v20, v20, v20 row_shr:2 row_mask:0xf bank_mask:0xf
    s_nop 1
    v_min_u32_dpp v20, v20, v20 row_shr:4 row_mask:0xf bank_mask:0xf
    s_nop 1
    v_min_u32_dpp v20, v20, v20 row_shr:8 row_mask:0xf bank_mask:0xf
    s_nop 1
    v_min_u32_dpp v20, v20, v20 row_bcast:15 row_mask:0xa bank_mask:0xf
    s_nop 1
    v_min_u32_dpp v20, v20, v20 row_bcast:31 row_mask:0xc bank_mask:0xf
    s_nop 0
    v_readlane_b32 s53, v20, 63
    s_sub_u32 s53, s42, s53
    s_sub_u32 s42, s53, 1
    v_sub_u32 v20, s42, v28
    v_sub_u32 v21, s42, v29
    v_sub_u32 v22, s42, v30
    v_min3_u32 v20, v20, v21, v22
    v_sub_u32 v21, s42, v31
    v_sub_u32 v22, s42, v32
    v_min3_u32 v20, v20, v21, v22
    v_sub_u32 v21, s42, v33
    v_sub_u32 v22, s42, v34
    v_min3_u32 v20, v20, v21, v22
    v_sub_u32 v21, s42, v35
    v_min_u32 v20, v20, v21
    s_nop 1
    v_min_u32_dpp v20, v20, v20 row_shr:1 row_mask:0xf bank_mask:0xf
    s_nop 1
    v_min_u32_dpp v20, v20, v20 row_shr:2 row_mask:0xf bank_mask:0xf
    s_nop 1
    v_min_u32_dpp v20, v20, v20 row_shr:4 row_mask:0xf bank_mask:0xf
    s_nop 1
    v_min_u32_dpp v20, v20, v20 row_shr:8 row_mask:0xf bank_mask:0xf
    s_nop 1
    v_min_u32_dpp v20, v20, v20 row_bcast:15 row_mask:0xa bank_mask:0xf
    s_nop 1
    v_min_u32_dpp v20, v20, v20 row_bcast:31 row_mask:0xc bank_mask:0xf
    s_nop 0
    v_readlane_b32 s54, v20, 63
    s_sub_u32 s54, s42, s54
    s_sub_u32 s42, s54, 1
    v_sub_u32 v20, s42, v28
    v_sub_u32 v21, s42, v29
    v_sub_u32 v22, s42, v30
    v_min3_u32 v20, v20, v21, v22
    v_sub_u32 v21, s42, v31
    v_sub_u32 v22, s42, v32
    v_min3_u32 v20, v20, v21, v22
    v_sub_u32 v21, s42, v33
    v_sub_u32 v22, s42, v34
    v_min3_u32 v20, v20, v21, v22
    v_sub_u32 v21, s42, v35
    v_min_u32 v20, v20, v21
    s_nop 1
    v_min_u32_dpp v20, v20, v20 row_shr:1 row_mask:0xf bank_mask:0xf
    s_nop 1
    v_min_u32_dpp v20, v20, v20 row_shr:2 row_mask:0xf bank_mask:0xf
    s_nop 1
    v_min_u32_dpp v20, v20, v20 row_shr:4 row_mask:0xf bank_mask:0xf
    s_nop 1
    v_min_u32_dpp v20, v20, v20 row_shr:8 row_mask:0xf bank_mask:0xf
    s_nop 1
    v_min_u32_dpp v20, v20, v20 row_bcast:15 row_mask:0xa bank_mask:0xf
    s_nop 1
    v_min_u32_dpp v20, v20, v20 row_bcast:31 row_mask:0xc bank_mask:0xf
    s_nop 0
    v_readlane_b32 s55, v20, 63
    s_sub_u32 s55, s42, s55
    s_sub_u32 s42, s55, 1
    v_sub_u32 v20, s42, v28
    v_sub_u32 v21, s42, v29
    v_sub_u32 v22, s42, v30
    v_min3_u32 v20, v20, v21, v22
    v_sub_u32 v21, s42, v31
    v_sub_u32 v22, s42, v32
    v_min3_u32 v20, v20, v21, v22
    v_sub_u32 v21, s42, v33
    v_sub_u32 v22, s42, v34
    v_min3_u32 v20, v20, v21, v22
    v_sub_u32 v21, s42, v35
    v_min_u32 v20, v20, v21
    s_nop 1
    v_min_u32_dpp v20, v20, v20 row_shr:1 row_mask:0xf bank_mask:0xf
    s_nop 1
    v_min_u32_dpp v20, v20, v20 row_shr:2 row_mask:0xf bank_mask:0xf
    s_nop 1
    v_min_u32_dpp v20, v20, v20 row_shr:4 row_mask:0xf bank_mask:0xf
    s_nop 1
    v_min_u32_dpp v20, v20, v20 row_shr:8 row_mask:0xf bank_mask:0xf
    s_nop 1
    v_min_u32_dpp v20, v20, v20 row_bcast:15 row_mask:0xa bank_mask:0xf
    s_nop 1
    v_min_u32_dpp v20, v20, v20 row_bcast:31 row_mask:0xc bank_mask:0xf
    s_nop 0
    v_readlane_b32 s56, v20, 63
    s_sub_u32 s56, s42, s56
    s_sub_u32 s42, s56, 1
    v_sub_u32 v20, s42, v28
    v_sub_u32 v21, s42, v29
    v_sub_u32 v22, s42, v30
    v_min3_u32 v20, v20, v21, v22
    v_sub_u32 v21, s42, v31
    v_sub_u32 v22, s42, v32
    v_min3_u32 v20, v20, v21, v22
    v_sub_u32 v21, s42, v33
    v_sub_u32 v22, s42, v34
    v_min3_u32 v20, v20, v21, v22
    v_sub_u32 v21, s42, v35
    v_min_u32 v20, v20, v21
    s_nop 1
    v_min_u32_dpp v20, v20, v20 row_shr:1 row_mask:0xf bank_mask:0xf
    s_nop 1
    v_min_u32_dpp v20, v20, v20 row_shr:2 row_mask:0xf bank_mask:0xf
    s_nop 1
    v_min_u32_dpp v20, v20, v20 row_shr:4 row_mask:0xf bank_mask:0xf
    s_nop 1
    v_min_u32_dpp v20, v20, v20 row_shr:8 row_mask:0xf bank_mask:0xf
    s_nop 1
    v_min_u32_dpp v20, v20, v20 row_bcast:15 row_mask:0xa bank_mask:0xf
    s_nop 1
    v_min_u32_dpp v20, v20, v20 row_bcast:31 row_mask:0xc bank_mask:0xf
    s_nop 0
    v_readlane_b32 s57, v20, 63
    s_sub_u32 s57, s42, s57
    s_sub_u32 s42, s57, 1
    v_mov_b32 v20, s50
    v_writelane_b32 v20, s51, 1
    v_writelane_b32 v20, s52, 2
    v_writelane_b32 v20, s53, 3
    v_writelane_b32 v20, s54, 4
    v_writelane_b32 v20, s55, 5
    v_writelane_b32 v20, s56, 6
    v_writelane_b32 v20, s57, 7
    s_lshl_b32 s42, s5, 8
    s_add_u32 s42, s42, 86016
    v_lshl_add_u32 v21, v19, 2, s42
    ds_write_b32 v21, v20
    s_waitcnt lgkmcnt(0)
    s_branch L_rt_back_local
L_rt_merge:
    v_bfe_u32 v21, v19, 3, 2
    v_lshlrev_b32 v21, 8, v21
    v_and_b32 v20, 7, v19
    v_lshl_add_u32 v21, v20, 2, v21
    v_add_u32 v21, 86016, v21
    ds_read_b32 v20, v21
    s_waitcnt lgkmcnt(0)
    s_mov_b32 s42, -1
    v_sub_u32 v21, s42, v20
    s_nop 1
    v_min_u32_dpp v21, v21, v21 row_shr:1 row_mask:0xf bank_mask:0xf
    s_nop 1
    v_min_u32_dpp v21, v21, v21 row_shr:2 row_mask:0xf bank_mask:0xf
    s_nop 1
    v_min_u32_dpp v21, v21, v21 row_shr:4 row_mask:0xf bank_mask:0xf
    s_nop 1
    v_min_u32_dpp v21, v21, v21 row_shr:8 row_mask:0xf bank_mask:0xf
    s_nop 1
    v_min_u32_dpp v21, v21, v21 row_bcast:15 row_mask:0xa bank_mask:0xf
    s_nop 1
    v_min_u32_dpp v21, v21, v21 row_bcast:31 row_mask:0xc bank_mask:0xf
    s_nop 0
    v_readlane_b32 s50, v21, 63
    s_sub_u32 s50, s42, s50
    s_sub_u32 s42, s50, 1
    v_sub_u32 v21, s42, v20
    s_nop 1
    v_min_u32_dpp v21, v21, v21 row_shr:1 row_mask:0xf bank_mask:0xf
    s_nop 1
    v_min_u32_dpp v21, v21, v21 row_shr:2 row_mask:0xf bank_mask:0xf
    s_nop 1
    v_min_u32_dpp v21, v21, v21 row_shr:4 row_mask:0xf bank_mask:0xf
    s_nop 1
    v_min_u32_dpp v21, v21, v21 row_shr:8 row_mask:0xf bank_mask:0xf
    s_nop 1
    v_min_u32_dpp v21, v21, v21 row_bcast:15 row_mask:0xa bank_mask:0xf
    s_nop 1
    v_min_u32_dpp v21, v21, v21 row_bcast:31 row_mask:0xc bank_mask:0xf
    s_nop 0
    v_readlane_b32 s51, v21, 63
    s_sub_u32 s51, s42, s51
    s_sub_u32 s42, s51, 1
    v_sub_u32 v21, s42, v20
    s_nop 1
    v_min_u32_dpp v21, v21, v21 row_shr:1 row_mask:0xf bank_mask:0xf
    s_nop 1
    v_min_u32_dpp v21, v21, v21 row_shr:2 row_mask:0xf bank_mask:0xf
    s_nop 1
    v_min_u32_dpp v21, v21, v21 row_shr:4 row_mask:0xf bank_mask:0xf
    s_nop 1
    v_min_u32_dpp v21, v21, v21 row_shr:8 row_mask:0xf bank_mask:0xf
    s_nop 1
    v_min_u32_dpp v21, v21, v21 row_bcast:15 row_mask:0xa bank_mask:0xf
    s_nop 1
    v_min_u32_dpp v21, v21, v21 row_bcast:31 row_mask:0xc bank_mask:0xf
    s_nop 0
    v_readlane_b32 s52, v21, 63
    s_sub_u32 s52, s42, s52
    s_sub_u32 s42, s52, 1
    v_sub_u32 v21, s42, v20
    s_nop 1
    v_min_u32_dpp v21, v21, v21 row_shr:1 row_mask:0xf bank_mask:0xf
    s_nop 1
    v_min_u32_dpp v21, v21, v21 row_shr:2 row_mask:0xf bank_mask:0xf
    s_nop 1
    v_min_u32_dpp v21, v21, v21 row_shr:4 row_mask:0xf bank_mask:0xf
    s_nop 1
    v_min_u32_dpp v21, v21, v21 row_shr:8 row_mask:0xf bank_mask:0xf
    s_nop 1
    v_min_u32_dpp v21, v21, v21 row_bcast:15 row_mask:0xa bank_mask:0xf
    s_nop 1
    v_min_u32_dpp v21, v21, v21 row_bcast:31 row_mask:0xc bank_mask:0xf
    s_nop 0
    v_readlane_b32 s53, v21, 63
    s_sub_u32 s53, s42, s53
    s_sub_u32 s42, s53, 1
    v_sub_u32 v21, s42, v20
    s_nop 1
    v_min_u32_dpp v21, v21, v21 row_shr:1 row_mask:0xf bank_mask:0xf
    s_nop 1
    v_min_u32_dpp v21, v21, v21 row_shr:2 row_mask:0xf bank_mask:0xf
    s_nop 1
    v_min_u32_dpp v21, v21, v21 row_shr:4 row_mask:0xf bank_mask:0xf
    s_nop 1
    v_min_u32_dpp v21, v21, v21 row_shr:8 row_mask:0xf bank_mask:0xf
    s_nop 1
    v_min_u32_dpp v21, v21, v21 row_bcast:15 row_mask:0xa bank_mask:0xf
    s_nop 1
    v_min_u32_dpp v21, v21, v21 row_bcast:31 row_mask:0xc bank_mask:0xf
    s_nop 0
    v_readlane_b32 s54, v21, 63
    s_sub_u32 s54, s42, s54
    s_sub_u32 s42, s54, 1
    v_sub_u32 v21, s42, v20
    s_nop 1
    v_min_u32_dpp v21, v21, v21 row_shr:1 row_mask:0xf bank_mask:0xf
    s_nop 1
    v_min_u32_dpp v21, v21, v21 row_shr:2 row_mask:0xf bank_mask:0xf
    s_nop 1
    v_min_u32_dpp v21, v21, v21 row_shr:4 row_mask:0xf bank_mask:0xf
    s_nop 1
    v_min_u32_dpp v21, v21, v21 row_shr:8 row_mask:0xf bank_mask:0xf
    s_nop 1
    v_min_u32_dpp v21, v21, v21 row_bcast:15 row_mask:0xa bank_mask:0xf
    s_nop 1
    v_min_u32_dpp v21, v21, v21 row_bcast:31 row_mask:0xc bank_mask:0xf
    s_nop 0
    v_readlane_b32 s55, v21, 63
    s_sub_u32 s55, s42, s55
    s_sub_u32 s42, s55, 1
    v_sub_u32 v21, s42, v20
    s_nop 1
    v_min_u32_dpp v21, v21, v21 row_shr:1 row_mask:0xf bank_mask:0xf
    s_nop 1
    v_min_u32_dpp v21, v21, v21 row_shr:2 row_mask:0xf bank_mask:0xf
    s_nop 1
    v_min_u32_dpp v21, v21, v21 row_shr:4 row_mask:0xf bank_mask:0xf
    s_nop 1
    v_min_u32_dpp v21, v21, v21 row_shr:8 row_mask:0xf bank_mask:0xf
    s_nop 1
    v_min_u32_dpp v21, v21, v21 row_bcast:15 row_mask:0xa bank_mask:0xf
    s_nop 1
    v_min_u32_dpp v21, v21, v21 row_bcast:31 row_mask:0xc bank_mask:0xf
    s_nop 0
    v_readlane_b32 s56, v21, 63
    s_sub_u32 s56, s42, s56
    s_sub_u32 s42, s56, 1
    v_sub_u32 v21, s42, v20
    s_nop 1
    v_min_u32_dpp v21, v21, v21 row_shr:1 row_mask:0xf bank_mask:0xf
    s_nop 1
    v_min_u32_dpp v21, v21, v21 row_shr:2 row_mask:0xf bank_mask:0xf
    s_nop 1
    v_min_u32_dpp v21, v21, v21 row_shr:4 row_mask:0xf bank_mask:0xf
    s_nop 1
    v_min_u32_dpp v21, v21, v21 row_shr:8 row_mask:0xf bank_mask:0xf
    s_nop 1
    v_min_u32_dpp v21, v21, v21 row_bcast:15 row_mask:0xa bank_mask:0xf
    s_nop 1
    v_min_u32_dpp v21, v21, v21 row_bcast:31 row_mask:0xc bank_mask:0xf
    s_nop 0
    v_readlane_b32 s57, v21, 63
    s_sub_u32 s57, s42, s57
    s_sub_u32 s42, s57, 1
    v_mov_b32 v20, s50
    v_writelane_b32 v20, s51, 1
    v_writelane_b32 v20, s52, 2
    v_writelane_b32 v20, s53, 3
    v_writelane_b32 v20, s54, 4
    v_writelane_b32 v20, s55, 5
    v_writelane_b32 v20, s56, 6
    v_writelane_b32 v20, s57, 7
    v_lshlrev_b32 v21, 2, v19
    s_mov_b32 s42, 0x29b000
    s_mov_b64 exec, 0xff
    buffer_store_dword v20, v21, s[76:79], s42 offen sc1
    s_mov_b64 exec, -1
    s_branch L_rt_back_merge
L_site0:
    s_mov_b32 s43, m0
    s_mov_b32 m0, s38
    s_add_u32 s38, s38, 1024
    buffer_load_dwordx4 v24, s[16:19], s37 offen lds
    s_mov_b32 m0, s43
    s_add_u32 s37, s37, 221184
    s_cmp_eq_u32 s35, 9
    s_cselect_b32 s36, 4, s36
    s_branch L_site_back0
L_site1:
    s_mov_b32 s43, m0
    s_mov_b32 m0, s38
    s_add_u32 s38, s38, 1024
    buffer_load_dwordx4 v24, s[16:19], s37 offen lds
    s_mov_b32 m0, s43
    s_add_u32 s37, s37, 221184
    s_cmp_eq_u32 s35, 9
    s_cselect_b32 s36, 4, s36
    s_branch L_site_back1
L_once_pack:
    s_mov_b64 exec, 1
    buffer_store_dword v27, off, s[76:79], s75 sc1
    s_mov_b64 exec, -1
    s_branch L_once_back_pack
L_site2:
    s_mov_b32 s43, m0
    s_mov_b32 m0, s38
    s_add_u32 s38, s38, 1024
    buffer_load_dwordx4 v24, s[16:19], s37 offen lds
    s_mov_b32 m0, s43
    s_add_u32 s37, s37, 221184
    s_cmp_eq_u32 s35, 9
    s_cselect_b32 s36, 4, s36
    s_branch L_site_back2
L_site3:
    s_mov_b32 s43, m0
    s_mov_b32 m0, s38
    s_add_u32 s38, s38, 1024
    buffer_load_dwordx4 v24, s[16:19], s37 offen lds
    s_mov_b32 m0, s43
    s_add_u32 s37, s37, 221184
    s_cmp_eq_u32 s35, 9
    s_cselect_b32 s36, 4, s36
    s_branch L_site_back3
L_spin_pack:
    s_mov_b32 s7, 32768
L_retry_pack:
    s_sleep 2
    buffer_load_dwordx4 v[28:31], v32, s[76:79], 0 offen sc1
    s_waitcnt vmcnt(0)
    v_min3_u32 v28, v28, v29, v30
    v_min_u32 v28, v28, v31
    v_cmp_gt_u32 vcc, 1, v28
    s_and_b64 vcc, vcc, exec
    s_cbranch_scc0 L_back_pack
    s_sub_u32 s7, s7, 1
    s_cbranch_scc0 L_retry_pack
    s_branch L_back_pack
L_spin_sel:
    s_mov_b32 s7, 32768
L_retry_sel:
    s_sleep 2
    buffer_load_dword v249, v21, s[76:79], 0 offen sc1
    s_waitcnt vmcnt(0)
    v_cmp_eq_u32 vcc, 0, v249
    s_and_b64 vcc, vcc, exec
    s_cbranch_scc0 L_back_sel
    s_sub_u32 s7, s7, 1
    s_cbranch_scc0 L_retry_sel
    s_branch L_back_sel
L_spin_ffn:
    s_mov_b32 s7, 32768
L_retry_ffn:
    s_sleep 2
    buffer_load_dwordx4 v[252:255], v20, s[76:79], 0 offen sc1
    s_waitcnt vmcnt(0)
    v_min3_u32 v252, v252, v253, v254
    v_min_u32 v252, v252, v255
    v_cmp_gt_u32 vcc, 2, v252
    s_and_b64 vcc, vcc, exec
    s_cbranch_scc0 L_back_ffn
    s_sub_u32 s7, s7, 1
    s_cbranch_scc0 L_retry_ffn
    s_branch L_back_ffn
L_spin_o:
    s_mov_b32 s7, 32768
L_retry_o:
    s_sleep 2
    buffer_load_dwordx4 v[252:255], v1, s[76:79], 0 offen sc1
    s_waitcnt vmcnt(0)
    v_min3_u32 v252, v252, v253, v254
    v_min_u32 v252, v252, v255
    v_cmp_gt_u32 vcc, 1, v252
    s_and_b64 vcc, vcc, exec
    s_cbranch_scc0 L_back_o
    s_sub_u32 s7, s7, 1
    s_cbranch_scc0 L_retry_o
    s_branch L_back_o
L_spin_upd:
    s_mov_b32 s7, 32768
L_retry_upd:
    s_sleep 2
    buffer_load_dwordx2 v[20:21], v11, s[76:79], 0 offen offset:0 sc1
    buffer_load_dwordx2 v[246:247], v11, s[76:79], 0 offen offset:32 sc1
    buffer_load_dwordx2 v[248:249], v11, s[76:79], 0 offen offset:64 sc1
    buffer_load_dwordx2 v[252:253], v11, s[76:79], 0 offen offset:96 sc1
    buffer_load_dwordx2 v[254:255], v11, s[76:79], 0 offen offset:128 sc1
    s_waitcnt vmcnt(0)
    v_max3_u32 v1, v20, v21, v246
    v_max3_u32 v1, v1, v247, v248
    v_max3_u32 v1, v1, v249, v252
    v_max3_u32 v1, v1, v253, v254
    v_max_u32 v1, v1, v255
    v_cmp_eq_u32 vcc, -1, v1
    s_and_b64 vcc, vcc, exec
    s_cbranch_scc0 L_back_upd
    s_sub_u32 s7, s7, 1
    s_cbranch_scc0 L_retry_upd
    s_branch L_back_upd
L_spin_half:
    s_mov_b32 s7, 32768
L_retry_half:
    s_sleep 2
    buffer_load_dword v1, off, s[76:79], s37 sc1
    s_waitcnt vmcnt(0)
    v_cmp_ne_u32 vcc, 3, v1
    s_and_b64 vcc, vcc, exec
    s_cbranch_scc0 L_back_half
    s_sub_u32 s7, s7, 1
    s_cbranch_scc0 L_retry_half
    s_branch L_back_half
L_code_end:
    s_endpgm

.section .rodata,"a"
.p2align 6
.amdhsa_kernel recurrent_scan__mha_block_cached__moe_arch_mod__prompt_kernel
  .amdhsa_next_free_vgpr 512
  .amdhsa_next_free_sgpr 102
  .amdhsa_accum_offset 256
  .amdhsa_group_segment_fixed_size 0
  .amdhsa_kernarg_size 104
  .amdhsa_user_sgpr_count 2
  .amdhsa_user_sgpr_kernarg_segment_ptr 1
  .amdhsa_system_sgpr_workgroup_id_x 1
  .amdhsa_float_denorm_mode_32 3
.end_amdhsa_kernel
```

```asm
; @launch grid=(256,1,1) block=(256,1,1) lds=163840
.amdgcn_target "amdgcn-amd-amdhsa--gfx950"
.text
.globl recurrent_scan__mha_block_cached__moe_arch_mod__prompt_kernel
.p2align 8
.type recurrent_scan__mha_block_cached__moe_arch_mod__prompt_kernel,@function
recurrent_scan__mha_block_cached__moe_arch_mod__prompt_kernel:
    s_cmp_ge_u32 s2, 256
    s_cbranch_scc1 L_end
    s_load_dwordx16 s[48:63], s[0:1], 0
    s_load_dwordx8 s[64:71], s[0:1], 64
    s_load_dwordx2 s[72:73], s[0:1], 96
    s_getpc_b64 s[40:41]
L_touch:
    s_bfe_u32 s42, s2, 0x20003
    s_lshl_b32 s42, s42, 8
    v_add_u32 v252, s42, v0
    v_min_u32 v252, (L_code_end - L_touch) / 128, v252
    v_lshlrev_b32 v252, 7, v252
    global_load_dword a120, v252, s[40:41]
    v_lshrrev_b32 v116, 6, v0
    v_and_b32 v19, 63, v0
    s_and_b32 s40, s2, 7
    v_readfirstlane_b32 s5, v116
    s_lshl_b32 s40, s40, 2
    s_bfe_u32 s41, s2, 0x20003
    s_add_u32 s3, s40, s41
    s_lshr_b32 s4, s2, 5
    s_lshl_b32 s74, s4, 5
    s_add_u32 s6, s74, s3
    v_lshrrev_b32 v118, 4, v19
    v_and_b32 v117, 15, v19
    v_lshlrev_b32 v119, 1, v118
    v_xor_b32 v119, v117, v119
    s_lshl_b32 s42, s5, 4
    v_add_u32 v120, s42, v118
    v_lshlrev_b32 v121, 4, v119
    v_xor_b32 v122, 0x80, v121
    v_lshl_add_u32 v123, v120, 13, v121
    v_lshl_add_u32 v116, v120, 13, v122
    v_add_u32 v44, 0, v123
    v_add_u32 v45, 31744, v123
    v_add_u32 v46, 63488, v116
    v_add_u32 v47, 95232, v116
    v_lshl_add_u32 v17, v120, 8, v121
    v_lshl_add_u32 v18, v120, 8, v122
    v_xor_b32 v117, v117, v118
    v_xor_b32 v121, 0, v117
    v_lshlrev_b32 v121, 4, v121
    v_lshl_add_u32 v13, v120, 8, v121
    v_xor_b32 v121, 4, v117
    v_lshlrev_b32 v121, 4, v121
    v_lshl_add_u32 v14, v120, 8, v121
    v_xor_b32 v121, 8, v117
    v_lshlrev_b32 v121, 4, v121
    v_lshl_add_u32 v15, v120, 8, v121
    v_xor_b32 v121, 12, v117
    v_lshlrev_b32 v121, 4, v121
    v_lshl_add_u32 v16, v120, 8, v121
    v_lshrrev_b32 v116, 3, v19
    v_and_b32 v117, 7, v19
    v_xor_b32 v117, v117, v118
    v_mul_u32_u24 v116, 1280, v116
    s_mul_i32 s42, s5, 81920
    v_lshl_add_u32 v119, v117, 4, v116
    v_xor_b32 v117, 4, v117
    v_lshl_add_u32 v120, v117, 4, v116
    v_add_u32 v119, s42, v119
    v_add_u32 v120, s42, v120
    v_add_u32 v36, 0, v119
    v_add_u32 v37, 9216, v120
    v_add_u32 v38, 18432, v119
    v_add_u32 v39, 27648, v120
    v_add_u32 v40, 40960, v119
    v_add_u32 v41, 50176, v120
    v_add_u32 v42, 59392, v119
    v_add_u32 v43, 68608, v120
    s_lshl_b32 s43, s6, 2
    s_add_u32 s43, s43, s5
    s_lshl_b32 s43, s43, 1
    s_mul_i32 s38, s5, 24576
    s_lshl_b32 s40, s5, 12
    s_add_u32 s39, s40, 98304
    s_mov_b32 s34, s39
    s_mov_b32 s28, 0
    s_mov_b32 s29, 0
    s_and_b32 s40, s3, 31
    s_mul_i32 s40, s40, 10
    s_lshr_b32 s40, s40, 5
    s_lshl_b32 s36, s40, 7
    s_waitcnt lgkmcnt(0)
    s_mov_b32 s88, s48
    s_mov_b32 s89, s49
    s_mov_b32 s90, 0x280000
    s_mov_b32 s91, 0x20000
    s_mov_b32 s92, s60
    s_mov_b32 s93, s61
    s_mov_b32 s94, 0x500
    s_mov_b32 s95, 0x20000
    s_lshl_b32 s40, s3, 8
    s_add_u32 s20, s54, s40
    s_addc_u32 s21, s55, 0
    s_mov_b32 s22, 0x4fe100
    s_mov_b32 s23, 0x20000
    s_mul_i32 s40, s4, 327680
    s_add_u32 s16, s48, s40
    s_addc_u32 s17, s49, 0
    s_mov_b32 s18, 0x50000
    s_mov_b32 s19, 0x20000
    s_add_u32 m0, s39, 0
    s_mov_b32 s37, 0
    buffer_load_dwordx4 v44, s[20:23], s37 offen offset:0 lds
    buffer_load_dwordx4 v45, s[20:23], s37 offen offset:1024 lds
    buffer_load_dwordx4 v46, s[20:23], s37 offen offset:2048 lds
    buffer_load_dwordx4 v47, s[20:23], s37 offen offset:3072 lds
    s_add_u32 m0, s38, 0
    s_mov_b32 s36, 0
    buffer_load_dwordx4 v36, s[16:19], s36 offen offset:0 lds
    buffer_load_dwordx4 v37, s[16:19], s36 offen offset:1024 lds
    buffer_load_dwordx4 v38, s[16:19], s36 offen offset:2048 lds
    buffer_load_dwordx4 v39, s[16:19], s36 offen offset:3072 lds
    s_add_u32 m0, s38, 4096
    s_nop 0
    buffer_load_dwordx4 v40, s[16:19], s36 offen offset:0 lds
    buffer_load_dwordx4 v41, s[16:19], s36 offen offset:1024 lds
    buffer_load_dwordx4 v42, s[16:19], s36 offen offset:2048 lds
    buffer_load_dwordx4 v43, s[16:19], s36 offen offset:3072 lds
    v_lshrrev_b32 v108, 5, v19
    v_add_u32 v108, s43, v108
    v_and_b32 v110, 31, v19
    v_lshlrev_b32 v110, 3, v110
    v_mul_u32_u24 v109, 1280, v108
    v_add_u32 v109, v109, v110
    buffer_load_dwordx2 v[60:61], v109, s[88:91], 0 offen offset:0
    buffer_load_dwordx2 v[62:63], v109, s[88:91], 0 offen offset:256
    buffer_load_dwordx2 v[64:65], v109, s[88:91], 0 offen offset:512
    buffer_load_dwordx2 v[66:67], v109, s[88:91], 0 offen offset:768
    buffer_load_dwordx2 v[68:69], v109, s[88:91], 0 offen offset:1024
    buffer_load_dwordx2 v[70:71], v110, s[92:95], 0 offen offset:0
    buffer_load_dwordx2 v[72:73], v110, s[92:95], 0 offen offset:256
    buffer_load_dwordx2 v[74:75], v110, s[92:95], 0 offen offset:512
    buffer_load_dwordx2 v[76:77], v110, s[92:95], 0 offen offset:768
    buffer_load_dwordx2 v[78:79], v110, s[92:95], 0 offen offset:1024
    s_lshl_b32 s40, s3, 19
    s_add_u32 s8, s50, s40
    s_addc_u32 s9, s51, 0
    s_mov_b32 s10, 0x80000
    s_mov_b32 s11, 0x20000
    s_add_u32 s12, s52, s40
    s_addc_u32 s13, s53, 0
    s_mov_b32 s14, 0x80000
    s_mov_b32 s15, 0x20000
    s_and_b32 s40, s5, 1
    s_lshl_b32 s40, s40, 12
    s_cmp_ge_u32 s5, 2
    s_cselect_b32 s30, 32, 8
    s_cselect_b32 s31, 40, 16
    s_cselect_b32 s32, 0, 56
    s_cselect_b32 s33, 48, 24
    s_lshl_b32 s30, s30, 10
    s_add_u32 s30, s30, s40
    s_lshl_b32 s31, s31, 10
    s_add_u32 s31, s31, s40
    s_lshl_b32 s32, s32, 10
    s_add_u32 s32, s32, s40
    s_lshl_b32 s33, s33, 10
    s_add_u32 s33, s33, s40
    s_mov_b32 s44, 0x3e0293ee
    s_mov_b32 s45, 4096
    s_mov_b32 s76, s72
    s_mov_b32 s77, s73
    s_mov_b32 s78, 0x2500000
    s_mov_b32 s79, 0x20000
    s_mov_b32 s92, s70
    s_mov_b32 s93, s71
    s_mov_b32 s94, 0x100
    s_mov_b32 s95, 0x20000
    s_lshl_b32 s41, s4, 2
    s_add_u32 s41, s41, s5
    s_lshl_b32 s40, s41, 5
    s_add_u32 s40, s40, s3
    s_lshl_b32 s40, s40, 14
    s_add_u32 s40, s40, 0x400000
    s_add_u32 s24, s72, s40
    s_addc_u32 s25, s73, 0
    s_mov_b32 s26, 0x4000
    s_mov_b32 s27, 0x20000
    s_and_b32 s42, s3, 3
    s_lshl_b32 s42, s42, 2
    s_lshr_b32 s40, s6, 2
    s_lshl_b32 s40, s40, 7
    s_add_u32 s40, s40, s42
    s_add_u32 s75, s40, 0x290000
    s_lshr_b32 s40, s3, 2
    s_lshl_b32 s40, s40, 7
    s_add_u32 s40, s40, s42
    s_lshl_b32 s42, s41, 10
    s_add_u32 s40, s40, s42
    s_add_u32 s58, s40, 0x292000
    s_cmp_eq_u32 s5, 0
    s_cselect_b32 s59, 5, 8
    s_lshl_b32 s41, s41, 10
    s_add_u32 s46, s41, 0x280000
    v_lshrrev_b32 v116, 4, v19
    v_and_b32 v117, 15, v19
    v_lshlrev_b32 v59, 4, v117
    v_xor_b32 v118, v116, v117
    v_lshlrev_b32 v119, 8, v117
    v_add_u32 v119, 98304, v119
    s_add_u32 s41, s5, 0
    s_and_b32 s41, s41, 3
    s_lshl_b32 s41, s41, 2
    v_xor_b32 v120, s41, v118
    v_lshl_add_u32 v1, v120, 4, v119
    s_add_u32 s41, s5, 1
    s_and_b32 s41, s41, 3
    s_lshl_b32 s41, s41, 2
    v_xor_b32 v120, s41, v118
    v_lshl_add_u32 v2, v120, 4, v119
    s_add_u32 s41, s5, 2
    s_and_b32 s41, s41, 3
    s_lshl_b32 s41, s41, 2
    v_xor_b32 v120, s41, v118
    v_lshl_add_u32 v3, v120, 4, v119
    s_add_u32 s41, s5, 3
    s_and_b32 s41, s41, 3
    s_lshl_b32 s41, s41, 2
    v_xor_b32 v120, s41, v118
    v_lshl_add_u32 v4, v120, 4, v119
    v_lshrrev_b32 v118, 1, v117
    v_xor_b32 v118, v116, v118
    v_lshlrev_b32 v119, 7, v117
    v_add_u32 v119, s38, v119
    v_xor_b32 v120, 0, v118
    v_lshl_add_u32 v48, v120, 4, v119
    v_xor_b32 v120, 4, v118
    v_lshl_add_u32 v49, v120, 4, v119
    v_bfe_u32 v118, v19, 2, 2
    v_bfe_u32 v119, v19, 2, 3
    v_and_b32 v120, 3, v19
    v_lshlrev_b32 v120, 3, v120
    v_lshl_add_u32 v121, v116, 2, v118
    v_lshl_add_u32 v121, v121, 8, v120
    v_lshl_add_u32 v122, v116, 3, v118
    v_lshl_add_u32 v122, v122, 8, v120
    v_add_u32 v122, 98304, v122
    v_xor_b32 v123, 0, v119
    v_lshl_add_u32 v5, v123, 5, v121
    v_xor_b32 v123, 1, v119
    v_lshl_add_u32 v6, v123, 5, v121
    v_xor_b32 v123, 2, v119
    v_lshl_add_u32 v7, v123, 5, v121
    v_xor_b32 v123, 3, v119
    v_lshl_add_u32 v8, v123, 5, v121
    v_xor_b32 v123, 4, v119
    v_lshl_add_u32 v9, v123, 5, v121
    v_xor_b32 v123, 5, v119
    v_lshl_add_u32 v10, v123, 5, v121
    v_xor_b32 v123, 6, v119
    v_lshl_add_u32 v11, v123, 5, v121
    v_xor_b32 v123, 7, v119
    v_lshl_add_u32 v12, v123, 5, v121
    s_lshl_b32 s42, s5, 1
    s_add_u32 s41, s42, 0
    s_and_b32 s41, s41, 7
    v_xor_b32 v123, s41, v119
    v_lshl_add_u32 v50, v123, 5, v122
    s_add_u32 s41, s42, 1
    s_and_b32 s41, s41, 7
    v_xor_b32 v123, s41, v119
    v_lshl_add_u32 v51, v123, 5, v122
    s_add_u32 s41, s42, 2
    s_and_b32 s41, s41, 7
    v_xor_b32 v123, s41, v119
    v_lshl_add_u32 v52, v123, 5, v122
    s_add_u32 s41, s42, 3
    s_and_b32 s41, s41, 7
    v_xor_b32 v123, s41, v119
    v_lshl_add_u32 v53, v123, 5, v122
    s_add_u32 s41, s42, 4
    s_and_b32 s41, s41, 7
    v_xor_b32 v123, s41, v119
    v_lshl_add_u32 v54, v123, 5, v122
    s_add_u32 s41, s42, 5
    s_and_b32 s41, s41, 7
    v_xor_b32 v123, s41, v119
    v_lshl_add_u32 v55, v123, 5, v122
    s_add_u32 s41, s42, 6
    s_and_b32 s41, s41, 7
    v_xor_b32 v123, s41, v119
    v_lshl_add_u32 v56, v123, 5, v122
    s_add_u32 s41, s42, 7
    s_and_b32 s41, s41, 7
    v_xor_b32 v123, s41, v119
    v_lshl_add_u32 v57, v123, 5, v122
    s_lshl_b32 s41, s5, 7
    s_add_u32 s41, s41, 86016
    v_lshl_add_u32 v58, v116, 4, s41
    v_mov_b32 v32, 0x3f803f80
    v_mov_b32 v33, 0x3f803f80
    v_mov_b32 v34, 0x3f803f80
    v_mov_b32 v35, 0x3f803f80
    v_and_b32 v120, 1, v19
    v_cmp_eq_u32 vcc, 0, v120
    v_mov_b32 v121, 0x44444444
    v_mov_b32 v122, 0xeeeeeeee
    v_cndmask_b32 v248, v122, v121, vcc
    v_and_b32 v120, 2, v19
    v_cmp_eq_u32 vcc, 0, v120
    v_mov_b32 v27, 1
    v_mov_b32 v28, 0
    v_cndmask_b32 v244, 0, v32, vcc
    v_cndmask_b32 v245, 0, v32, vcc
    v_cndmask_b32 v246, 0, v32, vcc
    v_cndmask_b32 v247, 0, v32, vcc
    v_accvgpr_write_b32 a224, 0
    v_accvgpr_write_b32 a225, 0
    v_accvgpr_write_b32 a226, 0
    v_accvgpr_write_b32 a227, 0
    v_accvgpr_write_b32 a228, 0
    v_accvgpr_write_b32 a229, 0
    v_accvgpr_write_b32 a230, 0
    v_accvgpr_write_b32 a231, 0
    v_accvgpr_write_b32 a232, 0
    v_accvgpr_write_b32 a233, 0
    v_accvgpr_write_b32 a234, 0
    v_accvgpr_write_b32 a235, 0
    v_accvgpr_write_b32 a236, 0
    v_accvgpr_write_b32 a237, 0
    v_accvgpr_write_b32 a238, 0
    v_accvgpr_write_b32 a239, 0
    s_mul_i32 s47, s5, 5120
    s_mov_b32 s96, s56
    s_mov_b32 s97, s57
    s_mov_b32 s98, 0x500000
    s_mov_b32 s99, 0x20000
    s_lshr_b32 s40, s6, 1
    s_and_b32 s41, s6, 1
    s_lshl_b32 s41, s41, 2
    s_add_u32 s41, s41, s5
    s_add_u32 s47, s47, 65536
    s_mul_i32 s42, s40, 40960
    s_mul_i32 s43, s41, 160
    s_add_u32 s42, s42, s43
    v_add_u32 v25, 0, v19
    v_mul_u32_u24 v26, 6554, v25
    v_lshrrev_b32 v26, 16, v26
    v_mul_u32_u24 v20, 1120, v26
    v_lshl_add_u32 v20, v25, 4, v20
    v_add_u32 v20, s42, v20
    v_add_u32 v25, 64, v19
    v_mul_u32_u24 v26, 6554, v25
    v_lshrrev_b32 v26, 16, v26
    v_mul_u32_u24 v21, 1120, v26
    v_lshl_add_u32 v21, v25, 4, v21
    v_add_u32 v21, s42, v21
    v_add_u32 v25, 128, v19
    v_mul_u32_u24 v26, 6554, v25
    v_lshrrev_b32 v26, 16, v26
    v_mul_u32_u24 v22, 1120, v26
    v_lshl_add_u32 v22, v25, 4, v22
    v_add_u32 v22, s42, v22
    v_add_u32 v25, 192, v19
    v_mul_u32_u24 v26, 6554, v25
    v_lshrrev_b32 v26, 16, v26
    v_mul_u32_u24 v23, 1120, v26
    v_lshl_add_u32 v23, v25, 4, v23
    v_add_u32 v23, s42, v23
    v_add_u32 v25, 256, v19
    v_mul_u32_u24 v26, 6554, v25
    v_lshrrev_b32 v26, 16, v26
    v_mul_u32_u24 v24, 1120, v26
    v_lshl_add_u32 v24, v25, 4, v24
    v_add_u32 v24, s42, v24
    v_lshrrev_b32 v25, 2, v19
    v_mul_u32_u24 v25, 160, v25
    v_and_b32 v26, 3, v19
    v_lshl_add_u32 v25, v26, 3, v25
    v_add_u32 v25, s47, v25
    s_lshl_b32 s42, s41, 7
    s_add_u32 s42, s42, s40
    s_mul_i32 s42, s42, 5120
    s_add_u32 s42, s42, 0x1400000
    v_lshlrev_b32 v26, 4, v19
    v_add_u32 v26, s42, v26
    s_add_u32 m0, s39, 16384
    s_mov_b32 s37, 524288
    buffer_load_dwordx4 v44, s[20:23], s37 offen offset:0 lds
    buffer_load_dwordx4 v45, s[20:23], s37 offen offset:1024 lds
    buffer_load_dwordx4 v46, s[20:23], s37 offen offset:2048 lds
    buffer_load_dwordx4 v47, s[20:23], s37 offen offset:3072 lds
    s_add_u32 m0, s38, 8192
    s_mov_b32 s36, 128
    buffer_load_dwordx4 v36, s[16:19], s36 offen offset:0 lds
    buffer_load_dwordx4 v37, s[16:19], s36 offen offset:1024 lds
    buffer_load_dwordx4 v38, s[16:19], s36 offen offset:2048 lds
    buffer_load_dwordx4 v39, s[16:19], s36 offen offset:3072 lds
    s_add_u32 m0, s38, 12288
    s_nop 0
    buffer_load_dwordx4 v40, s[16:19], s36 offen offset:0 lds
    buffer_load_dwordx4 v41, s[16:19], s36 offen offset:1024 lds
    buffer_load_dwordx4 v42, s[16:19], s36 offen offset:2048 lds
    buffer_load_dwordx4 v43, s[16:19], s36 offen offset:3072 lds
    s_add_u32 m0, s39, 32768
    s_mov_b32 s37, 1048576
    buffer_load_dwordx4 v44, s[20:23], s37 offen offset:0 lds
    buffer_load_dwordx4 v45, s[20:23], s37 offen offset:1024 lds
    buffer_load_dwordx4 v46, s[20:23], s37 offen offset:2048 lds
    buffer_load_dwordx4 v47, s[20:23], s37 offen offset:3072 lds
    s_waitcnt vmcnt(26)
    s_barrier
    ds_read_b64_tr_b16 a[0:1], v50 offset:0
    ds_read_b64_tr_b16 a[2:3], v50 offset:1024
    ds_read_b128 a[32:35], v48 offset:0
    ds_read_b128 a[36:39], v48 offset:2048
    ds_read_b128 a[40:43], v48 offset:4096
    ds_read_b128 a[44:47], v48 offset:6144
    ds_read_b64_tr_b16 a[4:5], v51 offset:0
    ds_read_b64_tr_b16 a[6:7], v51 offset:1024
    ds_read_b64_tr_b16 a[8:9], v52 offset:0
    ds_read_b64_tr_b16 a[10:11], v52 offset:1024
    ds_read_b64_tr_b16 a[12:13], v53 offset:0
    ds_read_b64_tr_b16 a[14:15], v53 offset:1024
    ds_read_b64_tr_b16 a[16:17], v54 offset:0
    ds_read_b64_tr_b16 a[18:19], v54 offset:1024
    ds_read_b64_tr_b16 a[20:21], v55 offset:0
    ds_read_b64_tr_b16 a[22:23], v55 offset:1024
    ds_read_b64_tr_b16 a[24:25], v56 offset:0
    ds_read_b64_tr_b16 a[26:27], v56 offset:1024
    ds_read_b64_tr_b16 a[28:29], v57 offset:0
    ds_read_b64_tr_b16 a[30:31], v57 offset:1024
    s_waitcnt lgkmcnt(0)
    v_mfma_f32_16x16x32_bf16 v[100:103], a[0:3], v[32:35], 0
    s_waitcnt vmcnt(16)
    ds_read_b64_tr_b16 a[48:49], v50 offset:8192
    v_mfma_f32_16x16x32_bf16 v[104:107], a[4:7], v[32:35], 0
    s_add_u32 m0, s38, 16384
    s_mov_b32 s36, 256
    ds_read_b64_tr_b16 a[50:51], v50 offset:9216
    v_mfma_f32_16x16x32_bf16 v[116:119], a[0:3], a[32:35], 0
    s_lshl_b32 s40, s6, 7
    buffer_load_dwordx4 v36, s[16:19], s36 offen offset:0 lds
    v_mfma_f32_16x16x32_bf16 v[148:151], a[0:3], a[36:39], 0
    s_add_u32 s41, s40, 0x292000
    ds_read_b128 a[80:83], v49 offset:0
    v_mfma_f32_16x16x32_bf16 v[180:183], a[0:3], a[40:43], 0
    s_add_u32 s40, s40, 0x290000
    ds_read_b128 a[84:87], v49 offset:2048
    v_mfma_f32_16x16x32_bf16 v[212:215], a[0:3], a[44:47], 0
    s_cmp_lt_u32 s6, 64
    s_cselect_b32 s40, s40, 0x2500000
    buffer_load_dwordx4 v37, s[16:19], s36 offen offset:1024 lds
    v_mfma_f32_16x16x32_bf16 v[216:219], a[4:7], a[44:47], 0
    s_cmp_eq_u32 s5, 1
    s_cselect_b32 s40, s40, 0x2500000
    ds_read_b128 a[88:91], v49 offset:4096
    v_mfma_f32_16x16x32_bf16 v[184:187], a[4:7], a[40:43], 0
    s_cmp_eq_u32 s5, 0
    s_cselect_b32 s40, s41, s40
    ds_read_b128 a[92:95], v49 offset:6144
    v_mfma_f32_16x16x32_bf16 v[152:155], a[4:7], a[36:39], 0
    s_add_u32 s41, s41, 0xe000
    ds_read_b64_tr_b16 a[52:53], v51 offset:8192
    v_mfma_f32_16x16x32_bf16 v[120:123], a[4:7], a[32:35], 0
    s_cmp_eq_u32 s5, 3
    s_cselect_b32 s40, s41, s40
    buffer_load_dwordx4 v38, s[16:19], s36 offen offset:2048 lds
    v_mfma_f32_16x16x32_bf16 v[124:127], a[8:11], a[32:35], 0
    s_lshl_b32 s41, s6, 2
    ds_read_b64_tr_b16 a[54:55], v51 offset:9216
    v_mfma_f32_16x16x32_bf16 v[156:159], a[8:11], a[36:39], 0
    s_add_u32 s41, s41, s5
    ds_read_b64_tr_b16 a[56:57], v52 offset:8192
    v_mfma_f32_16x16x32_bf16 v[188:191], a[8:11], a[40:43], 0
    s_cmp_eq_u32 s41, 1022
    s_cselect_b32 s40, 0x29b000, s40
    ds_read_b64_tr_b16 a[58:59], v52 offset:9216
    v_mfma_f32_16x16x32_bf16 v[220:223], a[8:11], a[44:47], 0
    s_lshl_b32 s41, s6, 7
    buffer_load_dwordx4 v39, s[16:19], s36 offen offset:3072 lds
    v_mfma_f32_16x16x32_bf16 v[224:227], a[12:15], a[44:47], 0
    s_add_u32 s41, s41, 0x29c000
    ds_read_b64_tr_b16 a[60:61], v53 offset:8192
    v_mfma_f32_16x16x32_bf16 v[192:195], a[12:15], a[40:43], 0
    s_xor_b32 s42, s5, 2
    ds_read_b64_tr_b16 a[62:63], v53 offset:9216
    v_mfma_f32_16x16x32_bf16 v[160:163], a[12:15], a[36:39], 0
    s_add_u32 m0, s38, 20480
    ds_read_b64_tr_b16 a[64:65], v54 offset:8192
    v_mfma_f32_16x16x32_bf16 v[128:131], a[12:15], a[32:35], 0
    s_lshl_b32 s42, s42, 8
    buffer_load_dwordx4 v40, s[16:19], s36 offen offset:0 lds
    v_mfma_f32_16x16x32_bf16 v[132:135], a[16:19], a[32:35], 0
    s_add_u32 s42, s42, s6
    ds_read_b64_tr_b16 a[66:67], v54 offset:9216
    v_mfma_f32_16x16x32_bf16 v[164:167], a[16:19], a[36:39], 0
    s_cmp_lt_u32 s42, 80
    s_cselect_b32 s40, s41, s40
    s_cselect_b32 s41, -1, 0
    ds_read_b64_tr_b16 a[68:69], v55 offset:8192
    v_mov_b32 v28, s41
    v_lshlrev_b32 v29, 2, v19
    v_mfma_f32_16x16x32_bf16 v[196:199], a[16:19], a[40:43], 0
    buffer_load_dwordx4 v41, s[16:19], s36 offen offset:1024 lds
    s_mov_b32 exec_hi, 0
    buffer_store_dword v28, v29, s[76:79], s40 offen sc1
    s_mov_b32 exec_hi, -1
    v_lshlrev_b32 v80, 16, v60
    v_and_b32 v81, 0xffff0000, v60
    v_lshlrev_b32 v82, 16, v61
    v_and_b32 v83, 0xffff0000, v61
    v_lshlrev_b32 v84, 16, v62
    v_and_b32 v85, 0xffff0000, v62
    v_mfma_f32_16x16x32_bf16 v[228:231], a[16:19], a[44:47], 0
    ds_read_b64_tr_b16 a[70:71], v55 offset:9216
    v_lshlrev_b32 v86, 16, v63
    v_mfma_f32_16x16x32_bf16 v[232:235], a[20:23], a[44:47], 0
    ds_read_b64_tr_b16 a[72:73], v56 offset:8192
    v_and_b32 v87, 0xffff0000, v63
    v_lshlrev_b32 v88, 16, v64
    v_mfma_f32_16x16x32_bf16 v[200:203], a[20:23], a[40:43], 0
    ds_read_b64_tr_b16 a[74:75], v56 offset:9216
    v_and_b32 v89, 0xffff0000, v64
    v_mfma_f32_16x16x32_bf16 v[168:171], a[20:23], a[36:39], 0
    buffer_load_dwordx4 v42, s[16:19], s36 offen offset:2048 lds
    v_lshlrev_b32 v90, 16, v65
    v_mfma_f32_16x16x32_bf16 v[136:139], a[20:23], a[32:35], 0
    ds_read_b64_tr_b16 a[76:77], v57 offset:8192
    v_and_b32 v91, 0xffff0000, v65
    v_lshlrev_b32 v92, 16, v66
    v_mfma_f32_16x16x32_bf16 v[140:143], a[24:27], a[32:35], 0
    ds_read_b64_tr_b16 a[78:79], v57 offset:9216
    v_and_b32 v93, 0xffff0000, v66
    v_mfma_f32_16x16x32_bf16 v[172:175], a[24:27], a[36:39], 0
    v_lshlrev_b32 v94, 16, v67
    v_and_b32 v95, 0xffff0000, v67
    v_mfma_f32_16x16x32_bf16 v[204:207], a[24:27], a[40:43], 0
    buffer_load_dwordx4 v43, s[16:19], s36 offen offset:3072 lds
    v_lshlrev_b32 v96, 16, v68
    v_mfma_f32_16x16x32_bf16 v[236:239], a[24:27], a[44:47], 0
    v_and_b32 v97, 0xffff0000, v68
    v_lshlrev_b32 v98, 16, v69
    v_mfma_f32_16x16x32_bf16 v[240:243], a[28:31], a[44:47], 0
    v_and_b32 v99, 0xffff0000, v69
    v_add_f32 v109, v80, v81
    v_mfma_f32_16x16x32_bf16 v[208:211], a[28:31], a[40:43], 0
    v_add_f32 v110, v82, v83
    v_add_f32 v109, v109, v84
    v_mfma_f32_16x16x32_bf16 v[176:179], a[28:31], a[36:39], 0
    v_add_f32 v110, v110, v85
    v_add_f32 v109, v109, v86
    v_mfma_f32_16x16x32_bf16 v[144:147], a[28:31], a[32:35], 0
    v_add_f32 v110, v110, v87
    v_add_f32 v109, v109, v88
    s_waitcnt vmcnt(13) lgkmcnt(0)
    s_barrier
    v_mfma_f32_16x16x32_bf16 v[100:103], a[48:51], v[32:35], v[100:103]
    ds_read_b64_tr_b16 a[0:1], v50 offset:16384
    v_add_f32 v110, v110, v89
    v_mfma_f32_16x16x32_bf16 v[104:107], a[52:55], v[32:35], v[104:107]
    s_add_u32 m0, s39, 0
    s_mov_b32 s37, 1572864
    ds_read_b64_tr_b16 a[2:3], v50 offset:17408
    v_add_f32 v109, v109, v90
    v_mfma_f32_16x16x32_bf16 v[116:119], a[48:51], a[80:83], v[116:119]
    buffer_load_dwordx4 v44, s[20:23], s37 offen offset:0 lds
    v_mfma_f32_16x16x32_bf16 v[148:151], a[48:51], a[84:87], v[148:151]
    ds_read_b128 a[32:35], v48 offset:8192
    v_add_f32 v110, v110, v91
    v_mfma_f32_16x16x32_bf16 v[180:183], a[48:51], a[88:91], v[180:183]
    ds_read_b128 a[36:39], v48 offset:10240
    v_add_f32 v109, v109, v92
    v_mfma_f32_16x16x32_bf16 v[212:215], a[48:51], a[92:95], v[212:215]
    ds_read_b128 a[40:43], v48 offset:12288
    v_add_f32 v110, v110, v93
    v_mfma_f32_16x16x32_bf16 v[216:219], a[52:55], a[92:95], v[216:219]
    ds_read_b128 a[44:47], v48 offset:14336
    v_add_f32 v109, v109, v94
    v_mfma_f32_16x16x32_bf16 v[184:187], a[52:55], a[88:91], v[184:187]
    buffer_load_dwordx4 v45, s[20:23], s37 offen offset:1024 lds
    v_add_f32 v110, v110, v95
    v_mfma_f32_16x16x32_bf16 v[152:155], a[52:55], a[84:87], v[152:155]
    ds_read_b64_tr_b16 a[4:5], v51 offset:16384
    v_add_f32 v109, v109, v96
    v_add_f32 v110, v110, v97
    v_mfma_f32_16x16x32_bf16 v[120:123], a[52:55], a[80:83], v[120:123]
    ds_read_b64_tr_b16 a[6:7], v51 offset:17408
    v_add_f32 v109, v109, v98
    v_mfma_f32_16x16x32_bf16 v[124:127], a[56:59], a[80:83], v[124:127]
    ds_read_b64_tr_b16 a[8:9], v52 offset:16384
    v_add_f32 v110, v110, v99
    v_mfma_f32_16x16x32_bf16 v[156:159], a[56:59], a[84:87], v[156:159]
    ds_read_b64_tr_b16 a[10:11], v52 offset:17408
    v_add_f32 v109, v109, v110
    v_mfma_f32_16x16x32_bf16 v[188:191], a[56:59], a[88:91], v[188:191]
    buffer_load_dwordx4 v46, s[20:23], s37 offen offset:2048 lds
    v_add_f32_dpp v109, v109, v109 quad_perm:[1,0,3,2] row_mask:0xf bank_mask:0xf
    v_mfma_f32_16x16x32_bf16 v[220:223], a[56:59], a[92:95], v[220:223]
    ds_read_b64_tr_b16 a[12:13], v53 offset:16384
    v_add_f32_dpp v109, v109, v109 quad_perm:[2,3,0,1] row_mask:0xf bank_mask:0xf
    v_mfma_f32_16x16x32_bf16 v[224:227], a[60:63], a[92:95], v[224:227]
    ds_read_b64_tr_b16 a[14:15], v53 offset:17408
    v_add_f32_dpp v109, v109, v109 row_half_mirror row_mask:0xf bank_mask:0xf
    v_mfma_f32_16x16x32_bf16 v[192:195], a[60:63], a[88:91], v[192:195]
    ds_read_b64_tr_b16 a[16:17], v54 offset:16384
    v_add_f32_dpp v109, v109, v109 row_mirror row_mask:0xf bank_mask:0xf
    v_mov_b32 v110, v109
    v_mfma_f32_16x16x32_bf16 v[160:163], a[60:63], a[84:87], v[160:163]
    ds_read_b64_tr_b16 a[18:19], v54 offset:17408
    v_permlane16_swap_b32 v109, v110
    v_add_f32 v109, v109, v110
    v_mul_f32 v111, 0x3acccccd, v109
    v_mfma_f32_16x16x32_bf16 v[128:131], a[60:63], a[80:83], v[128:131]
    buffer_load_dwordx4 v47, s[20:23], s37 offen offset:3072 lds
    v_sub_f32 v60, v80, v111
    v_mfma_f32_16x16x32_bf16 v[132:135], a[64:67], a[80:83], v[132:135]
    ds_read_b64_tr_b16 a[20:21], v55 offset:16384
    v_mul_f32 v109, v60, v60
    v_mfma_f32_16x16x32_bf16 v[164:167], a[64:67], a[84:87], v[164:167]
    ds_read_b64_tr_b16 a[22:23], v55 offset:17408
    v_sub_f32 v61, v81, v111
    v_mul_f32 v112, v61, v61
    v_mfma_f32_16x16x32_bf16 v[196:199], a[64:67], a[88:91], v[196:199]
    ds_read_b64_tr_b16 a[24:25], v56 offset:16384
    v_sub_f32 v60, v82, v111
    v_mfma_f32_16x16x32_bf16 v[228:231], a[64:67], a[92:95], v[228:231]
    s_add_u32 m0, s38, 0
    s_mov_b32 s36, 384
    ds_read_b64_tr_b16 a[26:27], v56 offset:17408
    v_fmac_f32 v109, v60, v60
    v_mfma_f32_16x16x32_bf16 v[232:235], a[68:71], a[92:95], v[232:235]
    buffer_load_dwordx4 v36, s[16:19], s36 offen offset:0 lds
    v_sub_f32 v61, v83, v111
    v_fmac_f32 v112, v61, v61
    v_mfma_f32_16x16x32_bf16 v[200:203], a[68:71], a[88:91], v[200:203]
    ds_read_b64_tr_b16 a[28:29], v57 offset:16384
    v_sub_f32 v60, v84, v111
    v_mfma_f32_16x16x32_bf16 v[168:171], a[68:71], a[84:87], v[168:171]
    ds_read_b64_tr_b16 a[30:31], v57 offset:17408
    v_fmac_f32 v109, v60, v60
    v_mfma_f32_16x16x32_bf16 v[136:139], a[68:71], a[80:83], v[136:139]
    v_sub_f32 v61, v85, v111
    v_fmac_f32 v112, v61, v61
    v_mfma_f32_16x16x32_bf16 v[140:143], a[72:75], a[80:83], v[140:143]
    v_sub_f32 v60, v86, v111
    v_fmac_f32 v109, v60, v60
    v_mfma_f32_16x16x32_bf16 v[172:175], a[72:75], a[84:87], v[172:175]
    buffer_load_dwordx4 v37, s[16:19], s36 offen offset:1024 lds
    v_sub_f32 v61, v87, v111
    v_mfma_f32_16x16x32_bf16 v[204:207], a[72:75], a[88:91], v[204:207]
    v_fmac_f32 v112, v61, v61
    v_sub_f32 v60, v88, v111
    v_mfma_f32_16x16x32_bf16 v[236:239], a[72:75], a[92:95], v[236:239]
    v_fmac_f32 v109, v60, v60
    v_sub_f32 v61, v89, v111
    v_mfma_f32_16x16x32_bf16 v[240:243], a[76:79], a[92:95], v[240:243]
    v_fmac_f32 v112, v61, v61
    v_sub_f32 v60, v90, v111
    v_mfma_f32_16x16x32_bf16 v[208:211], a[76:79], a[88:91], v[208:211]
    v_fmac_f32 v109, v60, v60
    v_sub_f32 v61, v91, v111
    v_mfma_f32_16x16x32_bf16 v[176:179], a[76:79], a[84:87], v[176:179]
    v_fmac_f32 v112, v61, v61
    v_sub_f32 v60, v92, v111
    v_mfma_f32_16x16x32_bf16 v[144:147], a[76:79], a[80:83], v[144:147]
    v_fmac_f32 v109, v60, v60
    v_sub_f32 v61, v93, v111
    s_waitcnt lgkmcnt(0)
    v_mfma_f32_16x16x32_bf16 v[100:103], a[0:3], v[32:35], v[100:103]
    ds_read_b64_tr_b16 a[48:49], v50 offset:24576
    v_fmac_f32 v112, v61, v61
    v_mfma_f32_16x16x32_bf16 v[104:107], a[4:7], v[32:35], v[104:107]
    ds_read_b64_tr_b16 a[50:51], v50 offset:25600
    v_sub_f32 v60, v94, v111
    v_mfma_f32_16x16x32_bf16 v[116:119], a[0:3], a[32:35], v[116:119]
    buffer_load_dwordx4 v38, s[16:19], s36 offen offset:2048 lds
    v_mfma_f32_16x16x32_bf16 v[148:151], a[0:3], a[36:39], v[148:151]
    ds_read_b128 a[80:83], v49 offset:8192
    v_fmac_f32 v109, v60, v60
    v_mfma_f32_16x16x32_bf16 v[180:183], a[0:3], a[40:43], v[180:183]
    ds_read_b128 a[84:87], v49 offset:10240
    v_sub_f32 v61, v95, v111
    v_mfma_f32_16x16x32_bf16 v[212:215], a[0:3], a[44:47], v[212:215]
    ds_read_b128 a[88:91], v49 offset:12288
    v_fmac_f32 v112, v61, v61
    v_mfma_f32_16x16x32_bf16 v[216:219], a[4:7], a[44:47], v[216:219]
    ds_read_b128 a[92:95], v49 offset:14336
    v_sub_f32 v60, v96, v111
    v_mfma_f32_16x16x32_bf16 v[184:187], a[4:7], a[40:43], v[184:187]
    buffer_load_dwordx4 v39, s[16:19], s36 offen offset:3072 lds
    v_fmac_f32 v109, v60, v60
    v_mfma_f32_16x16x32_bf16 v[152:155], a[4:7], a[36:39], v[152:155]
    ds_read_b64_tr_b16 a[52:53], v51 offset:24576
    v_sub_f32 v61, v97, v111
    v_mfma_f32_16x16x32_bf16 v[120:123], a[4:7], a[32:35], v[120:123]
    ds_read_b64_tr_b16 a[54:55], v51 offset:25600
    v_fmac_f32 v112, v61, v61
    v_mfma_f32_16x16x32_bf16 v[124:127], a[8:11], a[32:35], v[124:127]
    ds_read_b64_tr_b16 a[56:57], v52 offset:24576
    v_sub_f32 v60, v98, v111
    v_mfma_f32_16x16x32_bf16 v[156:159], a[8:11], a[36:39], v[156:159]
    s_add_u32 m0, s38, 4096
    ds_read_b64_tr_b16 a[58:59], v52 offset:25600
    v_fmac_f32 v109, v60, v60
    v_sub_f32 v61, v99, v111
    v_mfma_f32_16x16x32_bf16 v[188:191], a[8:11], a[40:43], v[188:191]
    buffer_load_dwordx4 v40, s[16:19], s36 offen offset:0 lds
    v_fmac_f32 v112, v61, v61
    v_mfma_f32_16x16x32_bf16 v[220:223], a[8:11], a[44:47], v[220:223]
    ds_read_b64_tr_b16 a[60:61], v53 offset:24576
    v_add_f32 v109, v109, v112
    v_mfma_f32_16x16x32_bf16 v[224:227], a[12:15], a[44:47], v[224:227]
    ds_read_b64_tr_b16 a[62:63], v53 offset:25600
    v_add_f32_dpp v109, v109, v109 quad_perm:[1,0,3,2] row_mask:0xf bank_mask:0xf
    v_mfma_f32_16x16x32_bf16 v[192:195], a[12:15], a[40:43], v[192:195]
    ds_read_b64_tr_b16 a[64:65], v54 offset:24576
    v_add_f32_dpp v109, v109, v109 quad_perm:[2,3,0,1] row_mask:0xf bank_mask:0xf
    v_mfma_f32_16x16x32_bf16 v[160:163], a[12:15], a[36:39], v[160:163]
    ds_read_b64_tr_b16 a[66:67], v54 offset:25600
    v_add_f32_dpp v109, v109, v109 row_half_mirror row_mask:0xf bank_mask:0xf
    v_mfma_f32_16x16x32_bf16 v[128:131], a[12:15], a[32:35], v[128:131]
    buffer_load_dwordx4 v41, s[16:19], s36 offen offset:1024 lds
    v_add_f32_dpp v109, v109, v109 row_mirror row_mask:0xf bank_mask:0xf
    v_mov_b32 v110, v109
    v_mfma_f32_16x16x32_bf16 v[132:135], a[16:19], a[32:35], v[132:135]
    ds_read_b64_tr_b16 a[68:69], v55 offset:24576
    v_permlane16_swap_b32 v109, v110
    v_add_f32 v109, v109, v110
    v_mfma_f32_16x16x32_bf16 v[164:167], a[16:19], a[36:39], v[164:167]
    ds_read_b64_tr_b16 a[70:71], v55 offset:25600
    v_mul_f32 v109, 0x3acccccd, v109
    v_cvt_pk_bf16_f32 v110, v111, v109
    v_mfma_f32_16x16x32_bf16 v[196:199], a[16:19], a[40:43], v[196:199]
    ds_read_b64_tr_b16 a[72:73], v56 offset:24576
    v_lshlrev_b32 v111, 16, v110
    v_mfma_f32_16x16x32_bf16 v[228:231], a[16:19], a[44:47], v[228:231]
    ds_read_b64_tr_b16 a[74:75], v56 offset:25600
    v_and_b32 v109, 0xffff0000, v110
    v_mfma_f32_16x16x32_bf16 v[232:235], a[20:23], a[44:47], v[232:235]
    buffer_load_dwordx4 v42, s[16:19], s36 offen offset:2048 lds
    v_add_f32 v109, 0x3727c5ac, v109
    v_cvt_pk_bf16_f32 v109, v109, v109
    v_mfma_f32_16x16x32_bf16 v[200:203], a[20:23], a[40:43], v[200:203]
    ds_read_b64_tr_b16 a[76:77], v57 offset:24576
    v_lshlrev_b32 v109, 16, v109
    v_mfma_f32_16x16x32_bf16 v[168:171], a[20:23], a[36:39], v[168:171]
    ds_read_b64_tr_b16 a[78:79], v57 offset:25600
    v_sqrt_f32 v109, v109
    v_mfma_f32_16x16x32_bf16 v[136:139], a[20:23], a[32:35], v[136:139]
    v_sub_f32 v80, v80, v111
    v_sub_f32 v81, v81, v111
    v_mfma_f32_16x16x32_bf16 v[140:143], a[24:27], a[32:35], v[140:143]
    v_sub_f32 v82, v82, v111
    v_sub_f32 v83, v83, v111
    v_mfma_f32_16x16x32_bf16 v[172:175], a[24:27], a[36:39], v[172:175]
    buffer_load_dwordx4 v43, s[16:19], s36 offen offset:3072 lds
    v_sub_f32 v84, v84, v111
    v_mfma_f32_16x16x32_bf16 v[204:207], a[24:27], a[40:43], v[204:207]
    v_sub_f32 v85, v85, v111
    v_sub_f32 v86, v86, v111
    v_mfma_f32_16x16x32_bf16 v[236:239], a[24:27], a[44:47], v[236:239]
    v_sub_f32 v87, v87, v111
    v_sub_f32 v88, v88, v111
    v_mfma_f32_16x16x32_bf16 v[240:243], a[28:31], a[44:47], v[240:243]
    v_sub_f32 v89, v89, v111
    v_sub_f32 v90, v90, v111
    v_mfma_f32_16x16x32_bf16 v[208:211], a[28:31], a[40:43], v[208:211]
    v_sub_f32 v91, v91, v111
    v_sub_f32 v92, v92, v111
    v_mfma_f32_16x16x32_bf16 v[176:179], a[28:31], a[36:39], v[176:179]
    v_sub_f32 v93, v93, v111
    v_sub_f32 v94, v94, v111
    v_mfma_f32_16x16x32_bf16 v[144:147], a[28:31], a[32:35], v[144:147]
    v_sub_f32 v95, v95, v111
    v_sub_f32 v96, v96, v111
    s_waitcnt vmcnt(12) lgkmcnt(0)
    s_barrier
    v_mfma_f32_16x16x32_bf16 v[100:103], a[48:51], v[32:35], v[100:103]
    ds_read_b64_tr_b16 a[0:1], v50 offset:32768
    v_sub_f32 v97, v97, v111
    v_mfma_f32_16x16x32_bf16 v[104:107], a[52:55], v[32:35], v[104:107]
    s_add_u32 m0, s39, 16384
    s_mov_b32 s37, 2097152
    ds_read_b64_tr_b16 a[2:3], v50 offset:33792
    v_sub_f32 v98, v98, v111
    v_mfma_f32_16x16x32_bf16 v[116:119], a[48:51], a[80:83], v[116:119]
    buffer_load_dwordx4 v44, s[20:23], s37 offen offset:0 lds
    v_mfma_f32_16x16x32_bf16 v[148:151], a[48:51], a[84:87], v[148:151]
    ds_read_b128 a[32:35], v48 offset:16384
    v_sub_f32 v99, v99, v111
    v_mfma_f32_16x16x32_bf16 v[180:183], a[48:51], a[88:91], v[180:183]
    ds_read_b128 a[36:39], v48 offset:18432
    v_cvt_pk_bf16_f32 v109, v109, v109
    v_mfma_f32_16x16x32_bf16 v[212:215], a[48:51], a[92:95], v[212:215]
    ds_read_b128 a[40:43], v48 offset:20480
    v_lshlrev_b32 v109, 16, v109
    v_mfma_f32_16x16x32_bf16 v[216:219], a[52:55], a[92:95], v[216:219]
    ds_read_b128 a[44:47], v48 offset:22528
    v_rcp_f32 v112, v109
    v_mfma_f32_16x16x32_bf16 v[184:187], a[52:55], a[88:91], v[184:187]
    buffer_load_dwordx4 v45, s[20:23], s37 offen offset:1024 lds
    v_cvt_pk_bf16_f32 v60, v80, v81
    v_mfma_f32_16x16x32_bf16 v[152:155], a[52:55], a[84:87], v[152:155]
    ds_read_b64_tr_b16 a[4:5], v51 offset:32768
    v_cvt_pk_bf16_f32 v61, v82, v83
    v_mfma_f32_16x16x32_bf16 v[120:123], a[52:55], a[80:83], v[120:123]
    ds_read_b64_tr_b16 a[6:7], v51 offset:33792
    v_cvt_pk_bf16_f32 v62, v84, v85
    v_mfma_f32_16x16x32_bf16 v[124:127], a[56:59], a[80:83], v[124:127]
    ds_read_b64_tr_b16 a[8:9], v52 offset:32768
    v_cvt_pk_bf16_f32 v63, v86, v87
    v_mfma_f32_16x16x32_bf16 v[156:159], a[56:59], a[84:87], v[156:159]
    ds_read_b64_tr_b16 a[10:11], v52 offset:33792
    v_cvt_pk_bf16_f32 v64, v88, v89
    v_cvt_pk_bf16_f32 v65, v90, v91
    v_mfma_f32_16x16x32_bf16 v[188:191], a[56:59], a[88:91], v[188:191]
    buffer_load_dwordx4 v46, s[20:23], s37 offen offset:2048 lds
    v_cvt_pk_bf16_f32 v66, v92, v93
    v_mfma_f32_16x16x32_bf16 v[220:223], a[56:59], a[92:95], v[220:223]
    ds_read_b64_tr_b16 a[12:13], v53 offset:32768
    v_cvt_pk_bf16_f32 v67, v94, v95
    v_mfma_f32_16x16x32_bf16 v[224:227], a[60:63], a[92:95], v[224:227]
    ds_read_b64_tr_b16 a[14:15], v53 offset:33792
    v_cvt_pk_bf16_f32 v68, v96, v97
    v_cvt_pk_bf16_f32 v69, v98, v99
    v_mfma_f32_16x16x32_bf16 v[192:195], a[60:63], a[88:91], v[192:195]
    ds_read_b64_tr_b16 a[16:17], v54 offset:32768
    v_lshlrev_b32 v80, 16, v60
    v_mfma_f32_16x16x32_bf16 v[160:163], a[60:63], a[84:87], v[160:163]
    ds_read_b64_tr_b16 a[18:19], v54 offset:33792
    v_and_b32 v81, 0xffff0000, v60
    v_lshlrev_b32 v82, 16, v61
    v_mfma_f32_16x16x32_bf16 v[128:131], a[60:63], a[80:83], v[128:131]
    buffer_load_dwordx4 v47, s[20:23], s37 offen offset:3072 lds
    v_and_b32 v83, 0xffff0000, v61
    v_mfma_f32_16x16x32_bf16 v[132:135], a[64:67], a[80:83], v[132:135]
    ds_read_b64_tr_b16 a[20:21], v55 offset:32768
    v_lshlrev_b32 v84, 16, v62
    v_mfma_f32_16x16x32_bf16 v[164:167], a[64:67], a[84:87], v[164:167]
    ds_read_b64_tr_b16 a[22:23], v55 offset:33792
    v_and_b32 v85, 0xffff0000, v62
    v_lshlrev_b32 v86, 16, v63
    v_mfma_f32_16x16x32_bf16 v[196:199], a[64:67], a[88:91], v[196:199]
    ds_read_b64_tr_b16 a[24:25], v56 offset:32768
    v_and_b32 v87, 0xffff0000, v63
    v_mfma_f32_16x16x32_bf16 v[228:231], a[64:67], a[92:95], v[228:231]
    s_add_u32 m0, s38, 8192
    s_mov_b32 s36, 512
    ds_read_b64_tr_b16 a[26:27], v56 offset:33792
    v_lshlrev_b32 v88, 16, v64
    v_mfma_f32_16x16x32_bf16 v[232:235], a[68:71], a[92:95], v[232:235]
    buffer_load_dwordx4 v36, s[16:19], s36 offen offset:0 lds
    v_and_b32 v89, 0xffff0000, v64
    v_lshlrev_b32 v90, 16, v65
    v_mfma_f32_16x16x32_bf16 v[200:203], a[68:71], a[88:91], v[200:203]
    ds_read_b64_tr_b16 a[28:29], v57 offset:32768
    v_and_b32 v91, 0xffff0000, v65
    v_mfma_f32_16x16x32_bf16 v[168:171], a[68:71], a[84:87], v[168:171]
    ds_read_b64_tr_b16 a[30:31], v57 offset:33792
    v_lshlrev_b32 v92, 16, v66
    v_mfma_f32_16x16x32_bf16 v[136:139], a[68:71], a[80:83], v[136:139]
    v_and_b32 v93, 0xffff0000, v66
    v_lshlrev_b32 v94, 16, v67
    v_mfma_f32_16x16x32_bf16 v[140:143], a[72:75], a[80:83], v[140:143]
    v_and_b32 v95, 0xffff0000, v67
    v_lshlrev_b32 v96, 16, v68
    v_mfma_f32_16x16x32_bf16 v[172:175], a[72:75], a[84:87], v[172:175]
    buffer_load_dwordx4 v37, s[16:19], s36 offen offset:1024 lds
    v_and_b32 v97, 0xffff0000, v68
    v_mfma_f32_16x16x32_bf16 v[204:207], a[72:75], a[88:91], v[204:207]
    v_lshlrev_b32 v98, 16, v69
    v_and_b32 v99, 0xffff0000, v69
    v_mfma_f32_16x16x32_bf16 v[236:239], a[72:75], a[92:95], v[236:239]
    v_mul_f32 v80, v80, v112
    v_mul_f32 v81, v81, v112
    v_mfma_f32_16x16x32_bf16 v[240:243], a[76:79], a[92:95], v[240:243]
    v_mul_f32 v82, v82, v112
    v_mul_f32 v83, v83, v112
    v_mfma_f32_16x16x32_bf16 v[208:211], a[76:79], a[88:91], v[208:211]
    v_mul_f32 v84, v84, v112
    v_mul_f32 v85, v85, v112
    v_mfma_f32_16x16x32_bf16 v[176:179], a[76:79], a[84:87], v[176:179]
    v_mul_f32 v86, v86, v112
    v_mul_f32 v87, v87, v112
    v_mfma_f32_16x16x32_bf16 v[144:147], a[76:79], a[80:83], v[144:147]
    v_mul_f32 v88, v88, v112
    v_mul_f32 v89, v89, v112
    s_waitcnt lgkmcnt(0)
    v_mfma_f32_16x16x32_bf16 v[100:103], a[0:3], v[32:35], v[100:103]
    ds_read_b64_tr_b16 a[48:49], v50 offset:40960
    v_mul_f32 v90, v90, v112
    v_mfma_f32_16x16x32_bf16 v[104:107], a[4:7], v[32:35], v[104:107]
    ds_read_b64_tr_b16 a[50:51], v50 offset:41984
    v_mul_f32 v91, v91, v112
    v_mfma_f32_16x16x32_bf16 v[116:119], a[0:3], a[32:35], v[116:119]
    buffer_load_dwordx4 v38, s[16:19], s36 offen offset:2048 lds
    v_mfma_f32_16x16x32_bf16 v[148:151], a[0:3], a[36:39], v[148:151]
    ds_read_b128 a[80:83], v49 offset:16384
    v_mul_f32 v92, v92, v112
    v_mfma_f32_16x16x32_bf16 v[180:183], a[0:3], a[40:43], v[180:183]
    ds_read_b128 a[84:87], v49 offset:18432
    v_mul_f32 v93, v93, v112
    v_mfma_f32_16x16x32_bf16 v[212:215], a[0:3], a[44:47], v[212:215]
    ds_read_b128 a[88:91], v49 offset:20480
    v_mul_f32 v94, v94, v112
    v_mfma_f32_16x16x32_bf16 v[216:219], a[4:7], a[44:47], v[216:219]
    ds_read_b128 a[92:95], v49 offset:22528
    v_mul_f32 v95, v95, v112
    v_mfma_f32_16x16x32_bf16 v[184:187], a[4:7], a[40:43], v[184:187]
    buffer_load_dwordx4 v39, s[16:19], s36 offen offset:3072 lds
    v_mul_f32 v96, v96, v112
    v_mfma_f32_16x16x32_bf16 v[152:155], a[4:7], a[36:39], v[152:155]
    ds_read_b64_tr_b16 a[52:53], v51 offset:40960
    v_mul_f32 v97, v97, v112
    v_mfma_f32_16x16x32_bf16 v[120:123], a[4:7], a[32:35], v[120:123]
    ds_read_b64_tr_b16 a[54:55], v51 offset:41984
    v_mul_f32 v98, v98, v112
    v_mfma_f32_16x16x32_bf16 v[124:127], a[8:11], a[32:35], v[124:127]
    ds_read_b64_tr_b16 a[56:57], v52 offset:40960
    v_mul_f32 v99, v99, v112
    v_mfma_f32_16x16x32_bf16 v[156:159], a[8:11], a[36:39], v[156:159]
    s_add_u32 m0, s38, 12288
    ds_read_b64_tr_b16 a[58:59], v52 offset:41984
    v_cvt_pk_bf16_f32 v60, v80, v81
    v_cvt_pk_bf16_f32 v61, v82, v83
    v_mfma_f32_16x16x32_bf16 v[188:191], a[8:11], a[40:43], v[188:191]
    buffer_load_dwordx4 v40, s[16:19], s36 offen offset:0 lds
    v_cvt_pk_bf16_f32 v62, v84, v85
    v_mfma_f32_16x16x32_bf16 v[220:223], a[8:11], a[44:47], v[220:223]
    ds_read_b64_tr_b16 a[60:61], v53 offset:40960
    v_cvt_pk_bf16_f32 v63, v86, v87
    v_mfma_f32_16x16x32_bf16 v[224:227], a[12:15], a[44:47], v[224:227]
    ds_read_b64_tr_b16 a[62:63], v53 offset:41984
    v_cvt_pk_bf16_f32 v64, v88, v89
    v_cvt_pk_bf16_f32 v65, v90, v91
    v_mfma_f32_16x16x32_bf16 v[192:195], a[12:15], a[40:43], v[192:195]
    ds_read_b64_tr_b16 a[64:65], v54 offset:40960
    v_cvt_pk_bf16_f32 v66, v92, v93
    v_mfma_f32_16x16x32_bf16 v[160:163], a[12:15], a[36:39], v[160:163]
    ds_read_b64_tr_b16 a[66:67], v54 offset:41984
    v_cvt_pk_bf16_f32 v67, v94, v95
    v_cvt_pk_bf16_f32 v68, v96, v97
    v_mfma_f32_16x16x32_bf16 v[128:131], a[12:15], a[32:35], v[128:131]
    buffer_load_dwordx4 v41, s[16:19], s36 offen offset:1024 lds
    v_cvt_pk_bf16_f32 v69, v98, v99
    v_mfma_f32_16x16x32_bf16 v[132:135], a[16:19], a[32:35], v[132:135]
    ds_read_b64_tr_b16 a[68:69], v55 offset:40960
    v_mov_b32 v109, 0
    v_mfma_f32_16x16x32_bf16 v[164:167], a[16:19], a[36:39], v[164:167]
    ds_read_b64_tr_b16 a[70:71], v55 offset:41984
    v_dot2c_f32_bf16 v109, v60, v70
    v_dot2c_f32_bf16 v109, v61, v71
    v_dot2c_f32_bf16 v109, v62, v72
    v_dot2c_f32_bf16 v109, v63, v73
    v_dot2c_f32_bf16 v109, v64, v74
    v_dot2c_f32_bf16 v109, v65, v75
    v_dot2c_f32_bf16 v109, v66, v76
    v_dot2c_f32_bf16 v109, v67, v77
    v_dot2c_f32_bf16 v109, v68, v78
    v_dot2c_f32_bf16 v109, v69, v79
    s_nop 2
    v_mfma_f32_16x16x32_bf16 v[196:199], a[16:19], a[40:43], v[196:199]
    ds_read_b64_tr_b16 a[72:73], v56 offset:40960
    v_add_f32_dpp v109, v109, v109 quad_perm:[1,0,3,2] row_mask:0xf bank_mask:0xf
    v_mfma_f32_16x16x32_bf16 v[228:231], a[16:19], a[44:47], v[228:231]
    ds_read_b64_tr_b16 a[74:75], v56 offset:41984
    v_add_f32_dpp v109, v109, v109 quad_perm:[2,3,0,1] row_mask:0xf bank_mask:0xf
    v_mfma_f32_16x16x32_bf16 v[232:235], a[20:23], a[44:47], v[232:235]
    buffer_load_dwordx4 v42, s[16:19], s36 offen offset:2048 lds
    v_add_f32_dpp v109, v109, v109 row_half_mirror row_mask:0xf bank_mask:0xf
    v_mfma_f32_16x16x32_bf16 v[200:203], a[20:23], a[40:43], v[200:203]
    ds_read_b64_tr_b16 a[76:77], v57 offset:40960
    v_add_f32_dpp v109, v109, v109 row_mirror row_mask:0xf bank_mask:0xf
    v_mov_b32 v110, v109
    v_mfma_f32_16x16x32_bf16 v[168:171], a[20:23], a[36:39], v[168:171]
    ds_read_b64_tr_b16 a[78:79], v57 offset:41984
    v_permlane16_swap_b32 v109, v110
    v_add_f32 v109, v109, v110
    v_mfma_f32_16x16x32_bf16 v[136:139], a[20:23], a[32:35], v[136:139]
    v_cvt_pk_bf16_f32 v109, v109, v109
    v_lshlrev_b32 v109, 16, v109
    v_mfma_f32_16x16x32_bf16 v[140:143], a[24:27], a[32:35], v[140:143]
    v_ashrrev_i32 v110, 31, v109
    v_or_b32 v110, 0x80000000, v110
    v_mfma_f32_16x16x32_bf16 v[172:175], a[24:27], a[36:39], v[172:175]
    buffer_load_dwordx4 v43, s[16:19], s36 offen offset:3072 lds
    v_xor_b32 v109, v109, v110
    v_mfma_f32_16x16x32_bf16 v[204:207], a[24:27], a[40:43], v[204:207]
    v_and_b32 v109, 0xffff0000, v109
    v_sub_u32 v110, 0xffff, v108
    v_mfma_f32_16x16x32_bf16 v[236:239], a[24:27], a[44:47], v[236:239]
    v_or_b32 v62, v109, v110
    v_mov_b32 v60, v111
    v_mfma_f32_16x16x32_bf16 v[240:243], a[28:31], a[44:47], v[240:243]
    v_mov_b32 v61, v112
    v_mov_b32 v63, 0
    v_mfma_f32_16x16x32_bf16 v[208:211], a[28:31], a[40:43], v[208:211]
    v_lshlrev_b32 v110, 4, v108
    v_mfma_f32_16x16x32_bf16 v[176:179], a[28:31], a[36:39], v[176:179]
    s_mov_b32 s40, 0x280000
    s_mov_b32 exec_lo, 1
    s_mov_b32 exec_hi, 1
    buffer_store_dwordx4 v[60:63], v110, s[76:79], s40 offen sc1
    s_mov_b64 exec, -1
    v_mfma_f32_16x16x32_bf16 v[144:147], a[28:31], a[32:35], v[144:147]
    s_waitcnt vmcnt(13) lgkmcnt(0)
    s_barrier
    v_mfma_f32_16x16x32_bf16 v[100:103], a[48:51], v[32:35], v[100:103]
    ds_read_b64_tr_b16 a[0:1], v50 offset:0
    v_mfma_f32_16x16x32_bf16 v[104:107], a[52:55], v[32:35], v[104:107]
    s_add_u32 m0, s39, 32768
    s_mov_b32 s37, 2621440
    ds_read_b64_tr_b16 a[2:3], v50 offset:1024
    v_mfma_f32_16x16x32_bf16 v[116:119], a[48:51], a[80:83], v[116:119]
    buffer_load_dwordx4 v44, s[20:23], s37 offen offset:0 lds
    v_mfma_f32_16x16x32_bf16 v[148:151], a[48:51], a[84:87], v[148:151]
    ds_read_b128 a[32:35], v48 offset:0
    v_mfma_f32_16x16x32_bf16 v[180:183], a[48:51], a[88:91], v[180:183]
    ds_read_b128 a[36:39], v48 offset:2048
    v_mfma_f32_16x16x32_bf16 v[212:215], a[48:51], a[92:95], v[212:215]
    ds_read_b128 a[40:43], v48 offset:4096
    v_mfma_f32_16x16x32_bf16 v[216:219], a[52:55], a[92:95], v[216:219]
    ds_read_b128 a[44:47], v48 offset:6144
    v_mfma_f32_16x16x32_bf16 v[184:187], a[52:55], a[88:91], v[184:187]
    buffer_load_dwordx4 v45, s[20:23], s37 offen offset:1024 lds
    v_mfma_f32_16x16x32_bf16 v[152:155], a[52:55], a[84:87], v[152:155]
    ds_read_b64_tr_b16 a[4:5], v51 offset:0
    v_mfma_f32_16x16x32_bf16 v[120:123], a[52:55], a[80:83], v[120:123]
    ds_read_b64_tr_b16 a[6:7], v51 offset:1024
    v_mfma_f32_16x16x32_bf16 v[124:127], a[56:59], a[80:83], v[124:127]
    ds_read_b64_tr_b16 a[8:9], v52 offset:0
    v_mfma_f32_16x16x32_bf16 v[156:159], a[56:59], a[84:87], v[156:159]
    ds_read_b64_tr_b16 a[10:11], v52 offset:1024
    v_mfma_f32_16x16x32_bf16 v[188:191], a[56:59], a[88:91], v[188:191]
    buffer_load_dwordx4 v46, s[20:23], s37 offen offset:2048 lds
    v_mfma_f32_16x16x32_bf16 v[220:223], a[56:59], a[92:95], v[220:223]
    ds_read_b64_tr_b16 a[12:13], v53 offset:0
    v_mfma_f32_16x16x32_bf16 v[224:227], a[60:63], a[92:95], v[224:227]
    ds_read_b64_tr_b16 a[14:15], v53 offset:1024
    v_mfma_f32_16x16x32_bf16 v[192:195], a[60:63], a[88:91], v[192:195]
    ds_read_b64_tr_b16 a[16:17], v54 offset:0
    v_mfma_f32_16x16x32_bf16 v[160:163], a[60:63], a[84:87], v[160:163]
    ds_read_b64_tr_b16 a[18:19], v54 offset:1024
    v_mfma_f32_16x16x32_bf16 v[128:131], a[60:63], a[80:83], v[128:131]
    buffer_load_dwordx4 v47, s[20:23], s37 offen offset:3072 lds
    v_mfma_f32_16x16x32_bf16 v[132:135], a[64:67], a[80:83], v[132:135]
    ds_read_b64_tr_b16 a[20:21], v55 offset:0
    v_mfma_f32_16x16x32_bf16 v[164:167], a[64:67], a[84:87], v[164:167]
    ds_read_b64_tr_b16 a[22:23], v55 offset:1024
    v_mfma_f32_16x16x32_bf16 v[196:199], a[64:67], a[88:91], v[196:199]
    ds_read_b64_tr_b16 a[24:25], v56 offset:0
    v_mfma_f32_16x16x32_bf16 v[228:231], a[64:67], a[92:95], v[228:231]
    s_add_u32 m0, s38, 16384
    s_mov_b32 s36, 640
    ds_read_b64_tr_b16 a[26:27], v56 offset:1024
    v_mfma_f32_16x16x32_bf16 v[232:235], a[68:71], a[92:95], v[232:235]
    buffer_load_dwordx4 v36, s[16:19], s36 offen offset:0 lds
    v_mfma_f32_16x16x32_bf16 v[200:203], a[68:71], a[88:91], v[200:203]
    ds_read_b64_tr_b16 a[28:29], v57 offset:0
    v_mfma_f32_16x16x32_bf16 v[168:171], a[68:71], a[84:87], v[168:171]
    ds_read_b64_tr_b16 a[30:31], v57 offset:1024
    v_mfma_f32_16x16x32_bf16 v[136:139], a[68:71], a[80:83], v[136:139]
    v_mfma_f32_16x16x32_bf16 v[140:143], a[72:75], a[80:83], v[140:143]
    v_mfma_f32_16x16x32_bf16 v[172:175], a[72:75], a[84:87], v[172:175]
    buffer_load_dwordx4 v37, s[16:19], s36 offen offset:1024 lds
    v_mfma_f32_16x16x32_bf16 v[204:207], a[72:75], a[88:91], v[204:207]
    v_mfma_f32_16x16x32_bf16 v[236:239], a[72:75], a[92:95], v[236:239]
    v_mfma_f32_16x16x32_bf16 v[240:243], a[76:79], a[92:95], v[240:243]
    v_mfma_f32_16x16x32_bf16 v[208:211], a[76:79], a[88:91], v[208:211]
    v_mfma_f32_16x16x32_bf16 v[176:179], a[76:79], a[84:87], v[176:179]
    v_mfma_f32_16x16x32_bf16 v[144:147], a[76:79], a[80:83], v[144:147]
    s_waitcnt lgkmcnt(0)
    v_mfma_f32_16x16x32_bf16 v[100:103], a[0:3], v[32:35], v[100:103]
    ds_read_b64_tr_b16 a[48:49], v50 offset:8192
    v_mfma_f32_16x16x32_bf16 v[104:107], a[4:7], v[32:35], v[104:107]
    ds_read_b64_tr_b16 a[50:51], v50 offset:9216
    v_mfma_f32_16x16x32_bf16 v[116:119], a[0:3], a[32:35], v[116:119]
    buffer_load_dwordx4 v38, s[16:19], s36 offen offset:2048 lds
    v_mfma_f32_16x16x32_bf16 v[148:151], a[0:3], a[36:39], v[148:151]
    ds_read_b128 a[80:83], v49 offset:0
    v_mfma_f32_16x16x32_bf16 v[180:183], a[0:3], a[40:43], v[180:183]
    ds_read_b128 a[84:87], v49 offset:2048
    v_mfma_f32_16x16x32_bf16 v[212:215], a[0:3], a[44:47], v[212:215]
    ds_read_b128 a[88:91], v49 offset:4096
    v_mfma_f32_16x16x32_bf16 v[216:219], a[4:7], a[44:47], v[216:219]
    ds_read_b128 a[92:95], v49 offset:6144
    v_mfma_f32_16x16x32_bf16 v[184:187], a[4:7], a[40:43], v[184:187]
    buffer_load_dwordx4 v39, s[16:19], s36 offen offset:3072 lds
    v_mfma_f32_16x16x32_bf16 v[152:155], a[4:7], a[36:39], v[152:155]
    ds_read_b64_tr_b16 a[52:53], v51 offset:8192
    v_mfma_f32_16x16x32_bf16 v[120:123], a[4:7], a[32:35], v[120:123]
    ds_read_b64_tr_b16 a[54:55], v51 offset:9216
    v_mfma_f32_16x16x32_bf16 v[124:127], a[8:11], a[32:35], v[124:127]
    ds_read_b64_tr_b16 a[56:57], v52 offset:8192
    v_mfma_f32_16x16x32_bf16 v[156:159], a[8:11], a[36:39], v[156:159]
    s_add_u32 m0, s38, 20480
    ds_read_b64_tr_b16 a[58:59], v52 offset:9216
    v_mfma_f32_16x16x32_bf16 v[188:191], a[8:11], a[40:43], v[188:191]
    buffer_load_dwordx4 v40, s[16:19], s36 offen offset:0 lds
    v_mfma_f32_16x16x32_bf16 v[220:223], a[8:11], a[44:47], v[220:223]
    ds_read_b64_tr_b16 a[60:61], v53 offset:8192
    v_mfma_f32_16x16x32_bf16 v[224:227], a[12:15], a[44:47], v[224:227]
    ds_read_b64_tr_b16 a[62:63], v53 offset:9216
    v_mfma_f32_16x16x32_bf16 v[192:195], a[12:15], a[40:43], v[192:195]
    ds_read_b64_tr_b16 a[64:65], v54 offset:8192
    v_mfma_f32_16x16x32_bf16 v[160:163], a[12:15], a[36:39], v[160:163]
    ds_read_b64_tr_b16 a[66:67], v54 offset:9216
    v_mfma_f32_16x16x32_bf16 v[128:131], a[12:15], a[32:35], v[128:131]
    buffer_load_dwordx4 v41, s[16:19], s36 offen offset:1024 lds
    v_mfma_f32_16x16x32_bf16 v[132:135], a[16:19], a[32:35], v[132:135]
    ds_read_b64_tr_b16 a[68:69], v55 offset:8192
    v_mfma_f32_16x16x32_bf16 v[164:167], a[16:19], a[36:39], v[164:167]
    ds_read_b64_tr_b16 a[70:71], v55 offset:9216
    v_mfma_f32_16x16x32_bf16 v[196:199], a[16:19], a[40:43], v[196:199]
    ds_read_b64_tr_b16 a[72:73], v56 offset:8192
    v_mfma_f32_16x16x32_bf16 v[228:231], a[16:19], a[44:47], v[228:231]
    ds_read_b64_tr_b16 a[74:75], v56 offset:9216
    v_mfma_f32_16x16x32_bf16 v[232:235], a[20:23], a[44:47], v[232:235]
    buffer_load_dwordx4 v42, s[16:19], s36 offen offset:2048 lds
    v_mfma_f32_16x16x32_bf16 v[200:203], a[20:23], a[40:43], v[200:203]
    ds_read_b64_tr_b16 a[76:77], v57 offset:8192
    v_mfma_f32_16x16x32_bf16 v[168:171], a[20:23], a[36:39], v[168:171]
    ds_read_b64_tr_b16 a[78:79], v57 offset:9216
    v_mfma_f32_16x16x32_bf16 v[136:139], a[20:23], a[32:35], v[136:139]
    v_mfma_f32_16x16x32_bf16 v[140:143], a[24:27], a[32:35], v[140:143]
    v_mfma_f32_16x16x32_bf16 v[172:175], a[24:27], a[36:39], v[172:175]
    buffer_load_dwordx4 v43, s[16:19], s36 offen offset:3072 lds
    v_mfma_f32_16x16x32_bf16 v[204:207], a[24:27], a[40:43], v[204:207]
    v_mfma_f32_16x16x32_bf16 v[236:239], a[24:27], a[44:47], v[236:239]
    v_mfma_f32_16x16x32_bf16 v[240:243], a[28:31], a[44:47], v[240:243]
    v_mfma_f32_16x16x32_bf16 v[208:211], a[28:31], a[40:43], v[208:211]
    v_mfma_f32_16x16x32_bf16 v[176:179], a[28:31], a[36:39], v[176:179]
    v_mfma_f32_16x16x32_bf16 v[144:147], a[28:31], a[32:35], v[144:147]
    s_waitcnt vmcnt(13) lgkmcnt(0)
    s_barrier
    v_mfma_f32_16x16x32_bf16 v[100:103], a[48:51], v[32:35], v[100:103]
    ds_read_b64_tr_b16 a[0:1], v50 offset:16384
    v_mfma_f32_16x16x32_bf16 v[104:107], a[52:55], v[32:35], v[104:107]
    s_add_u32 m0, s39, 0
    s_mov_b32 s37, 3145728
    ds_read_b64_tr_b16 a[2:3], v50 offset:17408
    v_mfma_f32_16x16x32_bf16 v[116:119], a[48:51], a[80:83], v[116:119]
    buffer_load_dwordx4 v44, s[20:23], s37 offen offset:0 lds
    v_mfma_f32_16x16x32_bf16 v[148:151], a[48:51], a[84:87], v[148:151]
    ds_read_b128 a[32:35], v48 offset:8192
    v_mfma_f32_16x16x32_bf16 v[180:183], a[48:51], a[88:91], v[180:183]
    ds_read_b128 a[36:39], v48 offset:10240
    v_mfma_f32_16x16x32_bf16 v[212:215], a[48:51], a[92:95], v[212:215]
    ds_read_b128 a[40:43], v48 offset:12288
    v_mfma_f32_16x16x32_bf16 v[216:219], a[52:55], a[92:95], v[216:219]
    ds_read_b128 a[44:47], v48 offset:14336
    v_mfma_f32_16x16x32_bf16 v[184:187], a[52:55], a[88:91], v[184:187]
    buffer_load_dwordx4 v45, s[20:23], s37 offen offset:1024 lds
    v_mfma_f32_16x16x32_bf16 v[152:155], a[52:55], a[84:87], v[152:155]
    ds_read_b64_tr_b16 a[4:5], v51 offset:16384
    v_mfma_f32_16x16x32_bf16 v[120:123], a[52:55], a[80:83], v[120:123]
    ds_read_b64_tr_b16 a[6:7], v51 offset:17408
    v_mfma_f32_16x16x32_bf16 v[124:127], a[56:59], a[80:83], v[124:127]
    ds_read_b64_tr_b16 a[8:9], v52 offset:16384
    v_mfma_f32_16x16x32_bf16 v[156:159], a[56:59], a[84:87], v[156:159]
    ds_read_b64_tr_b16 a[10:11], v52 offset:17408
    v_mfma_f32_16x16x32_bf16 v[188:191], a[56:59], a[88:91], v[188:191]
    buffer_load_dwordx4 v46, s[20:23], s37 offen offset:2048 lds
    v_mfma_f32_16x16x32_bf16 v[220:223], a[56:59], a[92:95], v[220:223]
    ds_read_b64_tr_b16 a[12:13], v53 offset:16384
    v_mfma_f32_16x16x32_bf16 v[224:227], a[60:63], a[92:95], v[224:227]
    ds_read_b64_tr_b16 a[14:15], v53 offset:17408
    v_mfma_f32_16x16x32_bf16 v[192:195], a[60:63], a[88:91], v[192:195]
    ds_read_b64_tr_b16 a[16:17], v54 offset:16384
    v_mfma_f32_16x16x32_bf16 v[160:163], a[60:63], a[84:87], v[160:163]
    ds_read_b64_tr_b16 a[18:19], v54 offset:17408
    v_mfma_f32_16x16x32_bf16 v[128:131], a[60:63], a[80:83], v[128:131]
    buffer_load_dwordx4 v47, s[20:23], s37 offen offset:3072 lds
    v_mfma_f32_16x16x32_bf16 v[132:135], a[64:67], a[80:83], v[132:135]
    ds_read_b64_tr_b16 a[20:21], v55 offset:16384
    v_mfma_f32_16x16x32_bf16 v[164:167], a[64:67], a[84:87], v[164:167]
    ds_read_b64_tr_b16 a[22:23], v55 offset:17408
    v_mfma_f32_16x16x32_bf16 v[196:199], a[64:67], a[88:91], v[196:199]
    ds_read_b64_tr_b16 a[24:25], v56 offset:16384
    v_mfma_f32_16x16x32_bf16 v[228:231], a[64:67], a[92:95], v[228:231]
    s_add_u32 m0, s38, 0
    s_mov_b32 s36, 768
    ds_read_b64_tr_b16 a[26:27], v56 offset:17408
    v_mfma_f32_16x16x32_bf16 v[232:235], a[68:71], a[92:95], v[232:235]
    buffer_load_dwordx4 v36, s[16:19], s36 offen offset:0 lds
    v_mfma_f32_16x16x32_bf16 v[200:203], a[68:71], a[88:91], v[200:203]
    ds_read_b64_tr_b16 a[28:29], v57 offset:16384
    v_mfma_f32_16x16x32_bf16 v[168:171], a[68:71], a[84:87], v[168:171]
    ds_read_b64_tr_b16 a[30:31], v57 offset:17408
    v_mfma_f32_16x16x32_bf16 v[136:139], a[68:71], a[80:83], v[136:139]
    v_mfma_f32_16x16x32_bf16 v[140:143], a[72:75], a[80:83], v[140:143]
    v_mfma_f32_16x16x32_bf16 v[172:175], a[72:75], a[84:87], v[172:175]
    buffer_load_dwordx4 v37, s[16:19], s36 offen offset:1024 lds
    v_mfma_f32_16x16x32_bf16 v[204:207], a[72:75], a[88:91], v[204:207]
    v_mfma_f32_16x16x32_bf16 v[236:239], a[72:75], a[92:95], v[236:239]
    v_mfma_f32_16x16x32_bf16 v[240:243], a[76:79], a[92:95], v[240:243]
    v_mfma_f32_16x16x32_bf16 v[208:211], a[76:79], a[88:91], v[208:211]
    v_mfma_f32_16x16x32_bf16 v[176:179], a[76:79], a[84:87], v[176:179]
    v_mfma_f32_16x16x32_bf16 v[144:147], a[76:79], a[80:83], v[144:147]
    s_waitcnt lgkmcnt(0)
    v_mfma_f32_16x16x32_bf16 v[100:103], a[0:3], v[32:35], v[100:103]
    ds_read_b64_tr_b16 a[48:49], v50 offset:24576
    v_mfma_f32_16x16x32_bf16 v[104:107], a[4:7], v[32:35], v[104:107]
    ds_read_b64_tr_b16 a[50:51], v50 offset:25600
    v_mfma_f32_16x16x32_bf16 v[116:119], a[0:3], a[32:35], v[116:119]
    buffer_load_dwordx4 v38, s[16:19], s36 offen offset:2048 lds
    v_mfma_f32_16x16x32_bf16 v[148:151], a[0:3], a[36:39], v[148:151]
    ds_read_b128 a[80:83], v49 offset:8192
    v_mfma_f32_16x16x32_bf16 v[180:183], a[0:3], a[40:43], v[180:183]
    ds_read_b128 a[84:87], v49 offset:10240
    v_mfma_f32_16x16x32_bf16 v[212:215], a[0:3], a[44:47], v[212:215]
    ds_read_b128 a[88:91], v49 offset:12288
    v_mfma_f32_16x16x32_bf16 v[216:219], a[4:7], a[44:47], v[216:219]
    ds_read_b128 a[92:95], v49 offset:14336
    v_mfma_f32_16x16x32_bf16 v[184:187], a[4:7], a[40:43], v[184:187]
    buffer_load_dwordx4 v39, s[16:19], s36 offen offset:3072 lds
    v_mfma_f32_16x16x32_bf16 v[152:155], a[4:7], a[36:39], v[152:155]
    ds_read_b64_tr_b16 a[52:53], v51 offset:24576
    v_mfma_f32_16x16x32_bf16 v[120:123], a[4:7], a[32:35], v[120:123]
    ds_read_b64_tr_b16 a[54:55], v51 offset:25600
    v_mfma_f32_16x16x32_bf16 v[124:127], a[8:11], a[32:35], v[124:127]
    ds_read_b64_tr_b16 a[56:57], v52 offset:24576
    v_mfma_f32_16x16x32_bf16 v[156:159], a[8:11], a[36:39], v[156:159]
    s_add_u32 m0, s38, 4096
    ds_read_b64_tr_b16 a[58:59], v52 offset:25600
    v_mfma_f32_16x16x32_bf16 v[188:191], a[8:11], a[40:43], v[188:191]
    buffer_load_dwordx4 v40, s[16:19], s36 offen offset:0 lds
    v_mfma_f32_16x16x32_bf16 v[220:223], a[8:11], a[44:47], v[220:223]
    ds_read_b64_tr_b16 a[60:61], v53 offset:24576
    v_mfma_f32_16x16x32_bf16 v[224:227], a[12:15], a[44:47], v[224:227]
    ds_read_b64_tr_b16 a[62:63], v53 offset:25600
    v_mfma_f32_16x16x32_bf16 v[192:195], a[12:15], a[40:43], v[192:195]
    ds_read_b64_tr_b16 a[64:65], v54 offset:24576
    v_mfma_f32_16x16x32_bf16 v[160:163], a[12:15], a[36:39], v[160:163]
    ds_read_b64_tr_b16 a[66:67], v54 offset:25600
    v_mfma_f32_16x16x32_bf16 v[128:131], a[12:15], a[32:35], v[128:131]
    buffer_load_dwordx4 v41, s[16:19], s36 offen offset:1024 lds
    v_mfma_f32_16x16x32_bf16 v[132:135], a[16:19], a[32:35], v[132:135]
    ds_read_b64_tr_b16 a[68:69], v55 offset:24576
    v_mfma_f32_16x16x32_bf16 v[164:167], a[16:19], a[36:39], v[164:167]
    ds_read_b64_tr_b16 a[70:71], v55 offset:25600
    v_mfma_f32_16x16x32_bf16 v[196:199], a[16:19], a[40:43], v[196:199]
    ds_read_b64_tr_b16 a[72:73], v56 offset:24576
    v_mfma_f32_16x16x32_bf16 v[228:231], a[16:19], a[44:47], v[228:231]
    ds_read_b64_tr_b16 a[74:75], v56 offset:25600
    v_mfma_f32_16x16x32_bf16 v[232:235], a[20:23], a[44:47], v[232:235]
    buffer_load_dwordx4 v42, s[16:19], s36 offen offset:2048 lds
    v_mfma_f32_16x16x32_bf16 v[200:203], a[20:23], a[40:43], v[200:203]
    ds_read_b64_tr_b16 a[76:77], v57 offset:24576
    v_mfma_f32_16x16x32_bf16 v[168:171], a[20:23], a[36:39], v[168:171]
    ds_read_b64_tr_b16 a[78:79], v57 offset:25600
    v_mfma_f32_16x16x32_bf16 v[136:139], a[20:23], a[32:35], v[136:139]
    v_mfma_f32_16x16x32_bf16 v[140:143], a[24:27], a[32:35], v[140:143]
    v_mfma_f32_16x16x32_bf16 v[172:175], a[24:27], a[36:39], v[172:175]
    buffer_load_dwordx4 v43, s[16:19], s36 offen offset:3072 lds
    v_mfma_f32_16x16x32_bf16 v[204:207], a[24:27], a[40:43], v[204:207]
    v_mfma_f32_16x16x32_bf16 v[236:239], a[24:27], a[44:47], v[236:239]
    v_mfma_f32_16x16x32_bf16 v[240:243], a[28:31], a[44:47], v[240:243]
    v_mfma_f32_16x16x32_bf16 v[208:211], a[28:31], a[40:43], v[208:211]
    v_mfma_f32_16x16x32_bf16 v[176:179], a[28:31], a[36:39], v[176:179]
    v_mfma_f32_16x16x32_bf16 v[144:147], a[28:31], a[32:35], v[144:147]
    s_waitcnt vmcnt(12) lgkmcnt(0)
    s_barrier
    s_cmp_lg_u32 s5, 0
    s_cbranch_scc1 L_signalled
    s_mov_b64 exec, 1
    buffer_atomic_add v27, off, s[92:95], s74 sc1
    s_mov_b64 exec, -1
L_signalled:
    v_mfma_f32_16x16x32_bf16 v[100:103], a[48:51], v[32:35], v[100:103]
    ds_read_b64_tr_b16 a[0:1], v50 offset:32768
    v_mfma_f32_16x16x32_bf16 v[104:107], a[52:55], v[32:35], v[104:107]
    s_add_u32 m0, s39, 16384
    s_mov_b32 s37, 3670016
    ds_read_b64_tr_b16 a[2:3], v50 offset:33792
    v_mfma_f32_16x16x32_bf16 v[116:119], a[48:51], a[80:83], v[116:119]
    buffer_load_dwordx4 v44, s[20:23], s37 offen offset:0 lds
    v_mfma_f32_16x16x32_bf16 v[148:151], a[48:51], a[84:87], v[148:151]
    ds_read_b128 a[32:35], v48 offset:16384
    v_mfma_f32_16x16x32_bf16 v[180:183], a[48:51], a[88:91], v[180:183]
    ds_read_b128 a[36:39], v48 offset:18432
    v_mfma_f32_16x16x32_bf16 v[212:215], a[48:51], a[92:95], v[212:215]
    buffer_load_dwordx4 v45, s[20:23], s37 offen offset:1024 lds
    v_mfma_f32_16x16x32_bf16 v[216:219], a[52:55], a[92:95], v[216:219]
    ds_read_b128 a[40:43], v48 offset:20480
    v_mfma_f32_16x16x32_bf16 v[184:187], a[52:55], a[88:91], v[184:187]
    ds_read_b128 a[44:47], v48 offset:22528
    v_mfma_f32_16x16x32_bf16 v[152:155], a[52:55], a[84:87], v[152:155]
    ds_read_b64_tr_b16 a[4:5], v51 offset:32768
    v_mfma_f32_16x16x32_bf16 v[120:123], a[52:55], a[80:83], v[120:123]
    buffer_load_dwordx4 v46, s[20:23], s37 offen offset:2048 lds
    v_mfma_f32_16x16x32_bf16 v[124:127], a[56:59], a[80:83], v[124:127]
    ds_read_b64_tr_b16 a[6:7], v51 offset:33792
    v_mfma_f32_16x16x32_bf16 v[156:159], a[56:59], a[84:87], v[156:159]
    ds_read_b64_tr_b16 a[8:9], v52 offset:32768
    v_mfma_f32_16x16x32_bf16 v[188:191], a[56:59], a[88:91], v[188:191]
    ds_read_b64_tr_b16 a[10:11], v52 offset:33792
    v_mfma_f32_16x16x32_bf16 v[220:223], a[56:59], a[92:95], v[220:223]
    buffer_load_dwordx4 v47, s[20:23], s37 offen offset:3072 lds
    v_mfma_f32_16x16x32_bf16 v[224:227], a[60:63], a[92:95], v[224:227]
    ds_read_b64_tr_b16 a[12:13], v53 offset:32768
    v_mfma_f32_16x16x32_bf16 v[192:195], a[60:63], a[88:91], v[192:195]
    ds_read_b64_tr_b16 a[14:15], v53 offset:33792
    v_mfma_f32_16x16x32_bf16 v[160:163], a[60:63], a[84:87], v[160:163]
    s_add_u32 m0, s38, 8192
    s_mov_b32 s36, 896
    ds_read_b64_tr_b16 a[16:17], v54 offset:32768
    v_mfma_f32_16x16x32_bf16 v[128:131], a[60:63], a[80:83], v[128:131]
    buffer_load_dwordx4 v36, s[16:19], s36 offen offset:0 lds
    v_mfma_f32_16x16x32_bf16 v[132:135], a[64:67], a[80:83], v[132:135]
    ds_read_b64_tr_b16 a[18:19], v54 offset:33792
    v_mfma_f32_16x16x32_bf16 v[164:167], a[64:67], a[84:87], v[164:167]
    ds_read_b64_tr_b16 a[20:21], v55 offset:32768
    v_mfma_f32_16x16x32_bf16 v[196:199], a[64:67], a[88:91], v[196:199]
    buffer_load_dwordx4 v37, s[16:19], s36 offen offset:1024 lds
    v_mfma_f32_16x16x32_bf16 v[228:231], a[64:67], a[92:95], v[228:231]
    ds_read_b64_tr_b16 a[22:23], v55 offset:33792
    v_mfma_f32_16x16x32_bf16 v[232:235], a[68:71], a[92:95], v[232:235]
    ds_read_b64_tr_b16 a[24:25], v56 offset:32768
    v_mfma_f32_16x16x32_bf16 v[200:203], a[68:71], a[88:91], v[200:203]
    ds_read_b64_tr_b16 a[26:27], v56 offset:33792
    v_mfma_f32_16x16x32_bf16 v[168:171], a[68:71], a[84:87], v[168:171]
    buffer_load_dwordx4 v38, s[16:19], s36 offen offset:2048 lds
    v_mfma_f32_16x16x32_bf16 v[136:139], a[68:71], a[80:83], v[136:139]
    ds_read_b64_tr_b16 a[28:29], v57 offset:32768
    v_mfma_f32_16x16x32_bf16 v[140:143], a[72:75], a[80:83], v[140:143]
    ds_read_b64_tr_b16 a[30:31], v57 offset:33792
    v_mfma_f32_16x16x32_bf16 v[172:175], a[72:75], a[84:87], v[172:175]
    v_mfma_f32_16x16x32_bf16 v[204:207], a[72:75], a[88:91], v[204:207]
    buffer_load_dwordx4 v39, s[16:19], s36 offen offset:3072 lds
    v_mfma_f32_16x16x32_bf16 v[236:239], a[72:75], a[92:95], v[236:239]
    v_mfma_f32_16x16x32_bf16 v[240:243], a[76:79], a[92:95], v[240:243]
    v_mfma_f32_16x16x32_bf16 v[208:211], a[76:79], a[88:91], v[208:211]
    v_mfma_f32_16x16x32_bf16 v[176:179], a[76:79], a[84:87], v[176:179]
    v_mfma_f32_16x16x32_bf16 v[144:147], a[76:79], a[80:83], v[144:147]
    s_waitcnt lgkmcnt(0)
    v_mfma_f32_16x16x32_bf16 v[100:103], a[0:3], v[32:35], v[100:103]
    ds_read_b64_tr_b16 a[48:49], v50 offset:40960
    v_mfma_f32_16x16x32_bf16 v[104:107], a[4:7], v[32:35], v[104:107]
    s_add_u32 m0, s38, 12288
    ds_read_b64_tr_b16 a[50:51], v50 offset:41984
    v_mfma_f32_16x16x32_bf16 v[116:119], a[0:3], a[32:35], v[116:119]
    buffer_load_dwordx4 v40, s[16:19], s36 offen offset:0 lds
    v_mfma_f32_16x16x32_bf16 v[148:151], a[0:3], a[36:39], v[148:151]
    ds_read_b128 a[80:83], v49 offset:16384
    v_mfma_f32_16x16x32_bf16 v[180:183], a[0:3], a[40:43], v[180:183]
    ds_read_b128 a[84:87], v49 offset:18432
    v_mfma_f32_16x16x32_bf16 v[212:215], a[0:3], a[44:47], v[212:215]
    buffer_load_dwordx4 v41, s[16:19], s36 offen offset:1024 lds
    v_mfma_f32_16x16x32_bf16 v[216:219], a[4:7], a[44:47], v[216:219]
    ds_read_b128 a[88:91], v49 offset:20480
    v_mfma_f32_16x16x32_bf16 v[184:187], a[4:7], a[40:43], v[184:187]
    ds_read_b128 a[92:95], v49 offset:22528
    v_mfma_f32_16x16x32_bf16 v[152:155], a[4:7], a[36:39], v[152:155]
    ds_read_b64_tr_b16 a[52:53], v51 offset:40960
    v_mfma_f32_16x16x32_bf16 v[120:123], a[4:7], a[32:35], v[120:123]
    buffer_load_dwordx4 v42, s[16:19], s36 offen offset:2048 lds
    v_mfma_f32_16x16x32_bf16 v[124:127], a[8:11], a[32:35], v[124:127]
    ds_read_b64_tr_b16 a[54:55], v51 offset:41984
    v_mfma_f32_16x16x32_bf16 v[156:159], a[8:11], a[36:39], v[156:159]
    ds_read_b64_tr_b16 a[56:57], v52 offset:40960
    v_mfma_f32_16x16x32_bf16 v[188:191], a[8:11], a[40:43], v[188:191]
    ds_read_b64_tr_b16 a[58:59], v52 offset:41984
    v_mfma_f32_16x16x32_bf16 v[220:223], a[8:11], a[44:47], v[220:223]
    buffer_load_dwordx4 v43, s[16:19], s36 offen offset:3072 lds
    v_mfma_f32_16x16x32_bf16 v[224:227], a[12:15], a[44:47], v[224:227]
    ds_read_b64_tr_b16 a[60:61], v53 offset:40960
    v_mfma_f32_16x16x32_bf16 v[192:195], a[12:15], a[40:43], v[192:195]
    ds_read_b64_tr_b16 a[62:63], v53 offset:41984
    v_mfma_f32_16x16x32_bf16 v[160:163], a[12:15], a[36:39], v[160:163]
    s_add_u32 m0, s34, 49152
    ds_read_b64_tr_b16 a[64:65], v54 offset:40960
    v_mfma_f32_16x16x32_bf16 v[128:131], a[12:15], a[32:35], v[128:131]
    buffer_load_dwordx4 v13, s[8:11], s28 offen offset:0 lds
    v_mfma_f32_16x16x32_bf16 v[132:135], a[16:19], a[32:35], v[132:135]
    ds_read_b64_tr_b16 a[66:67], v54 offset:41984
    v_mfma_f32_16x16x32_bf16 v[164:167], a[16:19], a[36:39], v[164:167]
    ds_read_b64_tr_b16 a[68:69], v55 offset:40960
    v_mfma_f32_16x16x32_bf16 v[196:199], a[16:19], a[40:43], v[196:199]
    buffer_load_dwordx4 v14, s[8:11], s28 offen offset:1024 lds
    v_mfma_f32_16x16x32_bf16 v[228:231], a[16:19], a[44:47], v[228:231]
    ds_read_b64_tr_b16 a[70:71], v55 offset:41984
    v_mfma_f32_16x16x32_bf16 v[232:235], a[20:23], a[44:47], v[232:235]
    ds_read_b64_tr_b16 a[72:73], v56 offset:40960
    v_mfma_f32_16x16x32_bf16 v[200:203], a[20:23], a[40:43], v[200:203]
    ds_read_b64_tr_b16 a[74:75], v56 offset:41984
    v_mfma_f32_16x16x32_bf16 v[168:171], a[20:23], a[36:39], v[168:171]
    buffer_load_dwordx4 v15, s[8:11], s28 offen offset:2048 lds
    v_mfma_f32_16x16x32_bf16 v[136:139], a[20:23], a[32:35], v[136:139]
    ds_read_b64_tr_b16 a[76:77], v57 offset:40960
    v_mfma_f32_16x16x32_bf16 v[140:143], a[24:27], a[32:35], v[140:143]
    ds_read_b64_tr_b16 a[78:79], v57 offset:41984
    v_mfma_f32_16x16x32_bf16 v[172:175], a[24:27], a[36:39], v[172:175]
    v_mfma_f32_16x16x32_bf16 v[204:207], a[24:27], a[40:43], v[204:207]
    buffer_load_dwordx4 v16, s[8:11], s28 offen offset:3072 lds
    v_mfma_f32_16x16x32_bf16 v[236:239], a[24:27], a[44:47], v[236:239]
    v_mfma_f32_16x16x32_bf16 v[240:243], a[28:31], a[44:47], v[240:243]
    v_mfma_f32_16x16x32_bf16 v[208:211], a[28:31], a[40:43], v[208:211]
    v_mfma_f32_16x16x32_bf16 v[176:179], a[28:31], a[36:39], v[176:179]
    v_mfma_f32_16x16x32_bf16 v[144:147], a[28:31], a[32:35], v[144:147]
    s_add_u32 s28, s28, 16384
    s_waitcnt vmcnt(16) lgkmcnt(0)
    s_barrier
    v_mfma_f32_16x16x32_bf16 v[100:103], a[48:51], v[32:35], v[100:103]
    ds_read_b64_tr_b16 a[0:1], v50 offset:0
    v_mfma_f32_16x16x32_bf16 v[104:107], a[52:55], v[32:35], v[104:107]
    s_add_u32 m0, s39, 32768
    s_mov_b32 s37, 4194304
    ds_read_b64_tr_b16 a[2:3], v50 offset:1024
    v_mfma_f32_16x16x32_bf16 v[116:119], a[48:51], a[80:83], v[116:119]
    buffer_load_dwordx4 v44, s[20:23], s37 offen offset:0 lds
    v_mfma_f32_16x16x32_bf16 v[148:151], a[48:51], a[84:87], v[148:151]
    ds_read_b128 a[32:35], v48 offset:0
    v_mfma_f32_16x16x32_bf16 v[180:183], a[48:51], a[88:91], v[180:183]
    ds_read_b128 a[36:39], v48 offset:2048
    v_mfma_f32_16x16x32_bf16 v[212:215], a[48:51], a[92:95], v[212:215]
    ds_read_b128 a[40:43], v48 offset:4096
    v_mfma_f32_16x16x32_bf16 v[216:219], a[52:55], a[92:95], v[216:219]
    ds_read_b128 a[44:47], v48 offset:6144
    v_mfma_f32_16x16x32_bf16 v[184:187], a[52:55], a[88:91], v[184:187]
    buffer_load_dwordx4 v45, s[20:23], s37 offen offset:1024 lds
    v_mfma_f32_16x16x32_bf16 v[152:155], a[52:55], a[84:87], v[152:155]
    ds_read_b64_tr_b16 a[4:5], v51 offset:0
    v_mfma_f32_16x16x32_bf16 v[120:123], a[52:55], a[80:83], v[120:123]
    ds_read_b64_tr_b16 a[6:7], v51 offset:1024
    v_mfma_f32_16x16x32_bf16 v[124:127], a[56:59], a[80:83], v[124:127]
    ds_read_b64_tr_b16 a[8:9], v52 offset:0
    v_mfma_f32_16x16x32_bf16 v[156:159], a[56:59], a[84:87], v[156:159]
    ds_read_b64_tr_b16 a[10:11], v52 offset:1024
    v_mfma_f32_16x16x32_bf16 v[188:191], a[56:59], a[88:91], v[188:191]
    buffer_load_dwordx4 v46, s[20:23], s37 offen offset:2048 lds
    v_mfma_f32_16x16x32_bf16 v[220:223], a[56:59], a[92:95], v[220:223]
    ds_read_b64_tr_b16 a[12:13], v53 offset:0
    v_mfma_f32_16x16x32_bf16 v[224:227], a[60:63], a[92:95], v[224:227]
    ds_read_b64_tr_b16 a[14:15], v53 offset:1024
    v_mfma_f32_16x16x32_bf16 v[192:195], a[60:63], a[88:91], v[192:195]
    ds_read_b64_tr_b16 a[16:17], v54 offset:0
    v_mfma_f32_16x16x32_bf16 v[160:163], a[60:63], a[84:87], v[160:163]
    ds_read_b64_tr_b16 a[18:19], v54 offset:1024
    v_mfma_f32_16x16x32_bf16 v[128:131], a[60:63], a[80:83], v[128:131]
    buffer_load_dwordx4 v47, s[20:23], s37 offen offset:3072 lds
    v_mfma_f32_16x16x32_bf16 v[132:135], a[64:67], a[80:83], v[132:135]
    ds_read_b64_tr_b16 a[20:21], v55 offset:0
    v_mfma_f32_16x16x32_bf16 v[164:167], a[64:67], a[84:87], v[164:167]
    ds_read_b64_tr_b16 a[22:23], v55 offset:1024
    v_mfma_f32_16x16x32_bf16 v[196:199], a[64:67], a[88:91], v[196:199]
    ds_read_b64_tr_b16 a[24:25], v56 offset:0
    v_mfma_f32_16x16x32_bf16 v[228:231], a[64:67], a[92:95], v[228:231]
    s_add_u32 m0, s38, 16384
    s_mov_b32 s36, 1024
    ds_read_b64_tr_b16 a[26:27], v56 offset:1024
    v_mfma_f32_16x16x32_bf16 v[232:235], a[68:71], a[92:95], v[232:235]
    buffer_load_dwordx4 v36, s[16:19], s36 offen offset:0 lds
    v_mfma_f32_16x16x32_bf16 v[200:203], a[68:71], a[88:91], v[200:203]
    ds_read_b64_tr_b16 a[28:29], v57 offset:0
    v_mfma_f32_16x16x32_bf16 v[168:171], a[68:71], a[84:87], v[168:171]
    ds_read_b64_tr_b16 a[30:31], v57 offset:1024
    v_mfma_f32_16x16x32_bf16 v[136:139], a[68:71], a[80:83], v[136:139]
    v_mfma_f32_16x16x32_bf16 v[140:143], a[72:75], a[80:83], v[140:143]
    v_mfma_f32_16x16x32_bf16 v[172:175], a[72:75], a[84:87], v[172:175]
    buffer_load_dwordx4 v37, s[16:19], s36 offen offset:1024 lds
    v_mfma_f32_16x16x32_bf16 v[204:207], a[72:75], a[88:91], v[204:207]
    v_mfma_f32_16x16x32_bf16 v[236:239], a[72:75], a[92:95], v[236:239]
    v_mfma_f32_16x16x32_bf16 v[240:243], a[76:79], a[92:95], v[240:243]
    v_mfma_f32_16x16x32_bf16 v[208:211], a[76:79], a[88:91], v[208:211]
    v_mfma_f32_16x16x32_bf16 v[176:179], a[76:79], a[84:87], v[176:179]
    v_mfma_f32_16x16x32_bf16 v[144:147], a[76:79], a[80:83], v[144:147]
    s_waitcnt lgkmcnt(0)
    v_mfma_f32_16x16x32_bf16 v[100:103], a[0:3], v[32:35], v[100:103]
    ds_read_b64_tr_b16 a[48:49], v50 offset:8192
    v_mfma_f32_16x16x32_bf16 v[104:107], a[4:7], v[32:35], v[104:107]
    ds_read_b64_tr_b16 a[50:51], v50 offset:9216
    v_mfma_f32_16x16x32_bf16 v[116:119], a[0:3], a[32:35], v[116:119]
    buffer_load_dwordx4 v38, s[16:19], s36 offen offset:2048 lds
    v_mfma_f32_16x16x32_bf16 v[148:151], a[0:3], a[36:39], v[148:151]
    ds_read_b128 a[80:83], v49 offset:0
    v_mfma_f32_16x16x32_bf16 v[180:183], a[0:3], a[40:43], v[180:183]
    ds_read_b128 a[84:87], v49 offset:2048
    v_mfma_f32_16x16x32_bf16 v[212:215], a[0:3], a[44:47], v[212:215]
    ds_read_b128 a[88:91], v49 offset:4096
    v_mfma_f32_16x16x32_bf16 v[216:219], a[4:7], a[44:47], v[216:219]
    ds_read_b128 a[92:95], v49 offset:6144
    v_mfma_f32_16x16x32_bf16 v[184:187], a[4:7], a[40:43], v[184:187]
    buffer_load_dwordx4 v39, s[16:19], s36 offen offset:3072 lds
    v_mfma_f32_16x16x32_bf16 v[152:155], a[4:7], a[36:39], v[152:155]
    ds_read_b64_tr_b16 a[52:53], v51 offset:8192
    v_mfma_f32_16x16x32_bf16 v[120:123], a[4:7], a[32:35], v[120:123]
    ds_read_b64_tr_b16 a[54:55], v51 offset:9216
    v_mfma_f32_16x16x32_bf16 v[124:127], a[8:11], a[32:35], v[124:127]
    ds_read_b64_tr_b16 a[56:57], v52 offset:8192
    v_mfma_f32_16x16x32_bf16 v[156:159], a[8:11], a[36:39], v[156:159]
    s_add_u32 m0, s38, 20480
    ds_read_b64_tr_b16 a[58:59], v52 offset:9216
    v_mfma_f32_16x16x32_bf16 v[188:191], a[8:11], a[40:43], v[188:191]
    buffer_load_dwordx4 v40, s[16:19], s36 offen offset:0 lds
    v_mfma_f32_16x16x32_bf16 v[220:223], a[8:11], a[44:47], v[220:223]
    ds_read_b64_tr_b16 a[60:61], v53 offset:8192
    v_mfma_f32_16x16x32_bf16 v[224:227], a[12:15], a[44:47], v[224:227]
    ds_read_b64_tr_b16 a[62:63], v53 offset:9216
    v_mfma_f32_16x16x32_bf16 v[192:195], a[12:15], a[40:43], v[192:195]
    ds_read_b64_tr_b16 a[64:65], v54 offset:8192
    v_mfma_f32_16x16x32_bf16 v[160:163], a[12:15], a[36:39], v[160:163]
    ds_read_b64_tr_b16 a[66:67], v54 offset:9216
    v_mfma_f32_16x16x32_bf16 v[128:131], a[12:15], a[32:35], v[128:131]
    buffer_load_dwordx4 v41, s[16:19], s36 offen offset:1024 lds
    v_mfma_f32_16x16x32_bf16 v[132:135], a[16:19], a[32:35], v[132:135]
    ds_read_b64_tr_b16 a[68:69], v55 offset:8192
    v_mfma_f32_16x16x32_bf16 v[164:167], a[16:19], a[36:39], v[164:167]
    ds_read_b64_tr_b16 a[70:71], v55 offset:9216
    v_mfma_f32_16x16x32_bf16 v[196:199], a[16:19], a[40:43], v[196:199]
    ds_read_b64_tr_b16 a[72:73], v56 offset:8192
    v_mfma_f32_16x16x32_bf16 v[228:231], a[16:19], a[44:47], v[228:231]
    ds_read_b64_tr_b16 a[74:75], v56 offset:9216
    v_mfma_f32_16x16x32_bf16 v[232:235], a[20:23], a[44:47], v[232:235]
    buffer_load_dwordx4 v42, s[16:19], s36 offen offset:2048 lds
    v_mfma_f32_16x16x32_bf16 v[200:203], a[20:23], a[40:43], v[200:203]
    ds_read_b64_tr_b16 a[76:77], v57 offset:8192
    v_mfma_f32_16x16x32_bf16 v[168:171], a[20:23], a[36:39], v[168:171]
    ds_read_b64_tr_b16 a[78:79], v57 offset:9216
    v_mfma_f32_16x16x32_bf16 v[136:139], a[20:23], a[32:35], v[136:139]
    v_mfma_f32_16x16x32_bf16 v[140:143], a[24:27], a[32:35], v[140:143]
    v_mfma_f32_16x16x32_bf16 v[172:175], a[24:27], a[36:39], v[172:175]
    buffer_load_dwordx4 v43, s[16:19], s36 offen offset:3072 lds
    v_mfma_f32_16x16x32_bf16 v[204:207], a[24:27], a[40:43], v[204:207]
    v_mfma_f32_16x16x32_bf16 v[236:239], a[24:27], a[44:47], v[236:239]
    v_mfma_f32_16x16x32_bf16 v[240:243], a[28:31], a[44:47], v[240:243]
    v_mfma_f32_16x16x32_bf16 v[208:211], a[28:31], a[40:43], v[208:211]
    v_mfma_f32_16x16x32_bf16 v[176:179], a[28:31], a[36:39], v[176:179]
    v_mfma_f32_16x16x32_bf16 v[144:147], a[28:31], a[32:35], v[144:147]
    s_waitcnt vmcnt(16) lgkmcnt(0)
    s_barrier
    v_mfma_f32_16x16x32_bf16 v[100:103], a[48:51], v[32:35], v[100:103]
    ds_read_b64_tr_b16 a[0:1], v50 offset:16384
    v_mfma_f32_16x16x32_bf16 v[104:107], a[52:55], v[32:35], v[104:107]
    s_add_u32 m0, s39, 0
    s_mov_b32 s37, 4718592
    ds_read_b64_tr_b16 a[2:3], v50 offset:17408
    v_mfma_f32_16x16x32_bf16 v[116:119], a[48:51], a[80:83], v[116:119]
    buffer_load_dwordx4 v44, s[20:23], s37 offen offset:0 lds
    v_mfma_f32_16x16x32_bf16 v[148:151], a[48:51], a[84:87], v[148:151]
    ds_read_b128 a[32:35], v48 offset:8192
    v_mfma_f32_16x16x32_bf16 v[180:183], a[48:51], a[88:91], v[180:183]
    ds_read_b128 a[36:39], v48 offset:10240
    v_mfma_f32_16x16x32_bf16 v[212:215], a[48:51], a[92:95], v[212:215]
    ds_read_b128 a[40:43], v48 offset:12288
    v_mfma_f32_16x16x32_bf16 v[216:219], a[52:55], a[92:95], v[216:219]
    ds_read_b128 a[44:47], v48 offset:14336
    v_mfma_f32_16x16x32_bf16 v[184:187], a[52:55], a[88:91], v[184:187]
    buffer_load_dwordx4 v45, s[20:23], s37 offen offset:1024 lds
    v_mfma_f32_16x16x32_bf16 v[152:155], a[52:55], a[84:87], v[152:155]
    ds_read_b64_tr_b16 a[4:5], v51 offset:16384
    v_mfma_f32_16x16x32_bf16 v[120:123], a[52:55], a[80:83], v[120:123]
    ds_read_b64_tr_b16 a[6:7], v51 offset:17408
    v_mfma_f32_16x16x32_bf16 v[124:127], a[56:59], a[80:83], v[124:127]
    ds_read_b64_tr_b16 a[8:9], v52 offset:16384
    v_mfma_f32_16x16x32_bf16 v[156:159], a[56:59], a[84:87], v[156:159]
    ds_read_b64_tr_b16 a[10:11], v52 offset:17408
    v_mfma_f32_16x16x32_bf16 v[188:191], a[56:59], a[88:91], v[188:191]
    buffer_load_dwordx4 v46, s[20:23], s37 offen offset:2048 lds
    v_mfma_f32_16x16x32_bf16 v[220:223], a[56:59], a[92:95], v[220:223]
    ds_read_b64_tr_b16 a[12:13], v53 offset:16384
    v_mfma_f32_16x16x32_bf16 v[224:227], a[60:63], a[92:95], v[224:227]
    ds_read_b64_tr_b16 a[14:15], v53 offset:17408
    v_mfma_f32_16x16x32_bf16 v[192:195], a[60:63], a[88:91], v[192:195]
    ds_read_b64_tr_b16 a[16:17], v54 offset:16384
    v_mfma_f32_16x16x32_bf16 v[160:163], a[60:63], a[84:87], v[160:163]
    ds_read_b64_tr_b16 a[18:19], v54 offset:17408
    v_mfma_f32_16x16x32_bf16 v[128:131], a[60:63], a[80:83], v[128:131]
    buffer_load_dwordx4 v47, s[20:23], s37 offen offset:3072 lds
    v_mfma_f32_16x16x32_bf16 v[132:135], a[64:67], a[80:83], v[132:135]
    ds_read_b64_tr_b16 a[20:21], v55 offset:16384
    v_mfma_f32_16x16x32_bf16 v[164:167], a[64:67], a[84:87], v[164:167]
    ds_read_b64_tr_b16 a[22:23], v55 offset:17408
    v_mfma_f32_16x16x32_bf16 v[196:199], a[64:67], a[88:91], v[196:199]
    ds_read_b64_tr_b16 a[24:25], v56 offset:16384
    v_mfma_f32_16x16x32_bf16 v[228:231], a[64:67], a[92:95], v[228:231]
    s_add_u32 m0, s38, 0
    s_mov_b32 s36, 1152
    ds_read_b64_tr_b16 a[26:27], v56 offset:17408
    v_mfma_f32_16x16x32_bf16 v[232:235], a[68:71], a[92:95], v[232:235]
    buffer_load_dword v252, off, s[92:95], s74 sc1
    buffer_load_dwordx4 v36, s[16:19], s36 offen offset:0 lds
    v_mfma_f32_16x16x32_bf16 v[200:203], a[68:71], a[88:91], v[200:203]
    ds_read_b64_tr_b16 a[28:29], v57 offset:16384
    v_mfma_f32_16x16x32_bf16 v[168:171], a[68:71], a[84:87], v[168:171]
    ds_read_b64_tr_b16 a[30:31], v57 offset:17408
    v_mfma_f32_16x16x32_bf16 v[136:139], a[68:71], a[80:83], v[136:139]
    v_mfma_f32_16x16x32_bf16 v[140:143], a[72:75], a[80:83], v[140:143]
    v_mfma_f32_16x16x32_bf16 v[172:175], a[72:75], a[84:87], v[172:175]
    buffer_load_dwordx4 v37, s[16:19], s36 offen offset:1024 lds
    v_mfma_f32_16x16x32_bf16 v[204:207], a[72:75], a[88:91], v[204:207]
    v_mfma_f32_16x16x32_bf16 v[236:239], a[72:75], a[92:95], v[236:239]
    v_mfma_f32_16x16x32_bf16 v[240:243], a[76:79], a[92:95], v[240:243]
    v_mfma_f32_16x16x32_bf16 v[208:211], a[76:79], a[88:91], v[208:211]
    v_mfma_f32_16x16x32_bf16 v[176:179], a[76:79], a[84:87], v[176:179]
    v_mfma_f32_16x16x32_bf16 v[144:147], a[76:79], a[80:83], v[144:147]
    s_waitcnt lgkmcnt(0)
    v_mfma_f32_16x16x32_bf16 v[100:103], a[0:3], v[32:35], v[100:103]
    ds_read_b64_tr_b16 a[48:49], v50 offset:24576
    v_mfma_f32_16x16x32_bf16 v[104:107], a[4:7], v[32:35], v[104:107]
    ds_read_b64_tr_b16 a[50:51], v50 offset:25600
    v_mfma_f32_16x16x32_bf16 v[116:119], a[0:3], a[32:35], v[116:119]
    buffer_load_dwordx4 v38, s[16:19], s36 offen offset:2048 lds
    v_mfma_f32_16x16x32_bf16 v[148:151], a[0:3], a[36:39], v[148:151]
    ds_read_b128 a[80:83], v49 offset:8192
    v_mfma_f32_16x16x32_bf16 v[180:183], a[0:3], a[40:43], v[180:183]
    ds_read_b128 a[84:87], v49 offset:10240
    v_mfma_f32_16x16x32_bf16 v[212:215], a[0:3], a[44:47], v[212:215]
    ds_read_b128 a[88:91], v49 offset:12288
    v_mfma_f32_16x16x32_bf16 v[216:219], a[4:7], a[44:47], v[216:219]
    ds_read_b128 a[92:95], v49 offset:14336
    v_mfma_f32_16x16x32_bf16 v[184:187], a[4:7], a[40:43], v[184:187]
    buffer_load_dwordx4 v39, s[16:19], s36 offen offset:3072 lds
    v_mfma_f32_16x16x32_bf16 v[152:155], a[4:7], a[36:39], v[152:155]
    ds_read_b64_tr_b16 a[52:53], v51 offset:24576
    v_mfma_f32_16x16x32_bf16 v[120:123], a[4:7], a[32:35], v[120:123]
    ds_read_b64_tr_b16 a[54:55], v51 offset:25600
    v_mfma_f32_16x16x32_bf16 v[124:127], a[8:11], a[32:35], v[124:127]
    ds_read_b64_tr_b16 a[56:57], v52 offset:24576
    v_mfma_f32_16x16x32_bf16 v[156:159], a[8:11], a[36:39], v[156:159]
    s_add_u32 m0, s38, 4096
    ds_read_b64_tr_b16 a[58:59], v52 offset:25600
    v_mfma_f32_16x16x32_bf16 v[188:191], a[8:11], a[40:43], v[188:191]
    buffer_load_dwordx4 v40, s[16:19], s36 offen offset:0 lds
    v_mfma_f32_16x16x32_bf16 v[220:223], a[8:11], a[44:47], v[220:223]
    ds_read_b64_tr_b16 a[60:61], v53 offset:24576
    v_mfma_f32_16x16x32_bf16 v[224:227], a[12:15], a[44:47], v[224:227]
    ds_read_b64_tr_b16 a[62:63], v53 offset:25600
    v_mfma_f32_16x16x32_bf16 v[192:195], a[12:15], a[40:43], v[192:195]
    ds_read_b64_tr_b16 a[64:65], v54 offset:24576
    v_mfma_f32_16x16x32_bf16 v[160:163], a[12:15], a[36:39], v[160:163]
    ds_read_b64_tr_b16 a[66:67], v54 offset:25600
    v_mfma_f32_16x16x32_bf16 v[128:131], a[12:15], a[32:35], v[128:131]
    buffer_load_dwordx4 v41, s[16:19], s36 offen offset:1024 lds
    v_mfma_f32_16x16x32_bf16 v[132:135], a[16:19], a[32:35], v[132:135]
    ds_read_b64_tr_b16 a[68:69], v55 offset:24576
    v_mfma_f32_16x16x32_bf16 v[164:167], a[16:19], a[36:39], v[164:167]
    ds_read_b64_tr_b16 a[70:71], v55 offset:25600
    v_mfma_f32_16x16x32_bf16 v[196:199], a[16:19], a[40:43], v[196:199]
    ds_read_b64_tr_b16 a[72:73], v56 offset:24576
    v_mfma_f32_16x16x32_bf16 v[228:231], a[16:19], a[44:47], v[228:231]
    ds_read_b64_tr_b16 a[74:75], v56 offset:25600
    v_mfma_f32_16x16x32_bf16 v[232:235], a[20:23], a[44:47], v[232:235]
    buffer_load_dwordx4 v42, s[16:19], s36 offen offset:2048 lds
    v_mfma_f32_16x16x32_bf16 v[200:203], a[20:23], a[40:43], v[200:203]
    ds_read_b64_tr_b16 a[76:77], v57 offset:24576
    v_mfma_f32_16x16x32_bf16 v[168:171], a[20:23], a[36:39], v[168:171]
    ds_read_b64_tr_b16 a[78:79], v57 offset:25600
    v_mfma_f32_16x16x32_bf16 v[136:139], a[20:23], a[32:35], v[136:139]
    v_mfma_f32_16x16x32_bf16 v[140:143], a[24:27], a[32:35], v[140:143]
    v_mfma_f32_16x16x32_bf16 v[172:175], a[24:27], a[36:39], v[172:175]
    buffer_load_dwordx4 v43, s[16:19], s36 offen offset:3072 lds
    v_mfma_f32_16x16x32_bf16 v[204:207], a[24:27], a[40:43], v[204:207]
    v_mfma_f32_16x16x32_bf16 v[236:239], a[24:27], a[44:47], v[236:239]
    v_mfma_f32_16x16x32_bf16 v[240:243], a[28:31], a[44:47], v[240:243]
    v_mfma_f32_16x16x32_bf16 v[208:211], a[28:31], a[40:43], v[208:211]
    v_mfma_f32_16x16x32_bf16 v[176:179], a[28:31], a[36:39], v[176:179]
    v_mfma_f32_16x16x32_bf16 v[144:147], a[28:31], a[32:35], v[144:147]
    s_waitcnt vmcnt(13) lgkmcnt(0)
    s_barrier
    v_mfma_f32_16x16x32_bf16 v[100:103], a[48:51], v[32:35], v[100:103]
    ds_read_b64_tr_b16 a[0:1], v50 offset:32768
    v_mfma_f32_16x16x32_bf16 v[104:107], a[52:55], v[32:35], v[104:107]
    s_add_u32 m0, s34, 16384
    ds_read_b64_tr_b16 a[2:3], v50 offset:33792
    v_mfma_f32_16x16x32_bf16 v[116:119], a[48:51], a[80:83], v[116:119]
    buffer_load_dwordx4 v13, s[8:11], s28 offen offset:0 lds
    v_mfma_f32_16x16x32_bf16 v[148:151], a[48:51], a[84:87], v[148:151]
    ds_read_b128 a[32:35], v48 offset:16384
    v_mfma_f32_16x16x32_bf16 v[180:183], a[48:51], a[88:91], v[180:183]
    ds_read_b128 a[36:39], v48 offset:18432
    v_mfma_f32_16x16x32_bf16 v[212:215], a[48:51], a[92:95], v[212:215]
    ds_read_b128 a[40:43], v48 offset:20480
    v_mfma_f32_16x16x32_bf16 v[216:219], a[52:55], a[92:95], v[216:219]
    ds_read_b128 a[44:47], v48 offset:22528
    v_mfma_f32_16x16x32_bf16 v[184:187], a[52:55], a[88:91], v[184:187]
    ds_read_b64_tr_b16 a[4:5], v51 offset:32768
    v_mfma_f32_16x16x32_bf16 v[152:155], a[52:55], a[84:87], v[152:155]
    ds_read_b64_tr_b16 a[6:7], v51 offset:33792
    v_mfma_f32_16x16x32_bf16 v[120:123], a[52:55], a[80:83], v[120:123]
    ds_read_b64_tr_b16 a[8:9], v52 offset:32768
    v_mfma_f32_16x16x32_bf16 v[124:127], a[56:59], a[80:83], v[124:127]
    ds_read_b64_tr_b16 a[10:11], v52 offset:33792
    v_mfma_f32_16x16x32_bf16 v[156:159], a[56:59], a[84:87], v[156:159]
    ds_read_b64_tr_b16 a[12:13], v53 offset:32768
    v_mfma_f32_16x16x32_bf16 v[188:191], a[56:59], a[88:91], v[188:191]
    ds_read_b64_tr_b16 a[14:15], v53 offset:33792
    v_mfma_f32_16x16x32_bf16 v[220:223], a[56:59], a[92:95], v[220:223]
    ds_read_b64_tr_b16 a[16:17], v54 offset:32768
    v_mfma_f32_16x16x32_bf16 v[224:227], a[60:63], a[92:95], v[224:227]
    ds_read_b64_tr_b16 a[18:19], v54 offset:33792
    v_mfma_f32_16x16x32_bf16 v[192:195], a[60:63], a[88:91], v[192:195]
    ds_read_b64_tr_b16 a[20:21], v55 offset:32768
    v_mfma_f32_16x16x32_bf16 v[160:163], a[60:63], a[84:87], v[160:163]
    ds_read_b64_tr_b16 a[22:23], v55 offset:33792
    v_mfma_f32_16x16x32_bf16 v[128:131], a[60:63], a[80:83], v[128:131]
    buffer_load_dwordx4 v14, s[8:11], s28 offen offset:1024 lds
    v_mfma_f32_16x16x32_bf16 v[132:135], a[64:67], a[80:83], v[132:135]
    ds_read_b64_tr_b16 a[24:25], v56 offset:32768
    v_mfma_f32_16x16x32_bf16 v[164:167], a[64:67], a[84:87], v[164:167]
    ds_read_b64_tr_b16 a[26:27], v56 offset:33792
    v_mfma_f32_16x16x32_bf16 v[196:199], a[64:67], a[88:91], v[196:199]
    ds_read_b64_tr_b16 a[28:29], v57 offset:32768
    v_mfma_f32_16x16x32_bf16 v[228:231], a[64:67], a[92:95], v[228:231]
    s_waitcnt vmcnt(10)
    v_cmp_gt_u32 vcc, 32, v252
    s_and_b64 vcc, vcc, exec
    s_cbranch_scc1 L_spin_rows
L_back_rows:
    buffer_load_dwordx2 v[108:109], v59, s[76:79], s46 offen offset:0 sc1
    buffer_load_dwordx2 v[110:111], v59, s[76:79], s46 offen offset:256 sc1
    buffer_load_dwordx2 v[112:113], v59, s[76:79], s46 offen offset:512 sc1
    buffer_load_dwordx2 v[114:115], v59, s[76:79], s46 offen offset:768 sc1
    ds_read_b64_tr_b16 a[30:31], v57 offset:33792
    v_mfma_f32_16x16x32_bf16 v[232:235], a[68:71], a[92:95], v[232:235]
    v_mfma_f32_16x16x32_bf16 v[200:203], a[68:71], a[88:91], v[200:203]
    v_mfma_f32_16x16x32_bf16 v[168:171], a[68:71], a[84:87], v[168:171]
    v_mfma_f32_16x16x32_bf16 v[136:139], a[68:71], a[80:83], v[136:139]
    v_mfma_f32_16x16x32_bf16 v[140:143], a[72:75], a[80:83], v[140:143]
    v_mfma_f32_16x16x32_bf16 v[172:175], a[72:75], a[84:87], v[172:175]
    v_mfma_f32_16x16x32_bf16 v[204:207], a[72:75], a[88:91], v[204:207]
    v_mfma_f32_16x16x32_bf16 v[236:239], a[72:75], a[92:95], v[236:239]
    v_mfma_f32_16x16x32_bf16 v[240:243], a[76:79], a[92:95], v[240:243]
    v_mfma_f32_16x16x32_bf16 v[208:211], a[76:79], a[88:91], v[208:211]
    v_mfma_f32_16x16x32_bf16 v[176:179], a[76:79], a[84:87], v[176:179]
    v_mfma_f32_16x16x32_bf16 v[144:147], a[76:79], a[80:83], v[144:147]
    s_waitcnt lgkmcnt(0)
    v_mfma_f32_16x16x32_bf16 v[100:103], a[0:3], v[32:35], v[100:103]
    ds_read_b64_tr_b16 a[48:49], v50 offset:40960
    v_mfma_f32_16x16x32_bf16 v[104:107], a[4:7], v[32:35], v[104:107]
    ds_read_b64_tr_b16 a[50:51], v50 offset:41984
    v_mfma_f32_16x16x32_bf16 v[116:119], a[0:3], a[32:35], v[116:119]
    buffer_load_dwordx4 v15, s[8:11], s28 offen offset:2048 lds
    v_mfma_f32_16x16x32_bf16 v[148:151], a[0:3], a[36:39], v[148:151]
    ds_read_b128 a[80:83], v49 offset:16384
    v_mfma_f32_16x16x32_bf16 v[180:183], a[0:3], a[40:43], v[180:183]
    ds_read_b128 a[84:87], v49 offset:18432
    v_mfma_f32_16x16x32_bf16 v[212:215], a[0:3], a[44:47], v[212:215]
    ds_read_b128 a[88:91], v49 offset:20480
    v_mfma_f32_16x16x32_bf16 v[216:219], a[4:7], a[44:47], v[216:219]
    ds_read_b128 a[92:95], v49 offset:22528
    v_mfma_f32_16x16x32_bf16 v[184:187], a[4:7], a[40:43], v[184:187]
    ds_read_b64_tr_b16 a[52:53], v51 offset:40960
    v_mfma_f32_16x16x32_bf16 v[152:155], a[4:7], a[36:39], v[152:155]
    ds_read_b64_tr_b16 a[54:55], v51 offset:41984
    v_mfma_f32_16x16x32_bf16 v[120:123], a[4:7], a[32:35], v[120:123]
    ds_read_b64_tr_b16 a[56:57], v52 offset:40960
    v_mfma_f32_16x16x32_bf16 v[124:127], a[8:11], a[32:35], v[124:127]
    ds_read_b64_tr_b16 a[58:59], v52 offset:41984
    v_mfma_f32_16x16x32_bf16 v[156:159], a[8:11], a[36:39], v[156:159]
    ds_read_b64_tr_b16 a[60:61], v53 offset:40960
    v_mfma_f32_16x16x32_bf16 v[188:191], a[8:11], a[40:43], v[188:191]
    ds_read_b64_tr_b16 a[62:63], v53 offset:41984
    v_mfma_f32_16x16x32_bf16 v[220:223], a[8:11], a[44:47], v[220:223]
    ds_read_b64_tr_b16 a[64:65], v54 offset:40960
    v_mfma_f32_16x16x32_bf16 v[224:227], a[12:15], a[44:47], v[224:227]
    ds_read_b64_tr_b16 a[66:67], v54 offset:41984
    v_mfma_f32_16x16x32_bf16 v[192:195], a[12:15], a[40:43], v[192:195]
    ds_read_b64_tr_b16 a[68:69], v55 offset:40960
    v_mfma_f32_16x16x32_bf16 v[160:163], a[12:15], a[36:39], v[160:163]
    ds_read_b64_tr_b16 a[70:71], v55 offset:41984
    v_mfma_f32_16x16x32_bf16 v[128:131], a[12:15], a[32:35], v[128:131]
    buffer_load_dwordx4 v16, s[8:11], s28 offen offset:3072 lds
    v_mfma_f32_16x16x32_bf16 v[132:135], a[16:19], a[32:35], v[132:135]
    ds_read_b64_tr_b16 a[72:73], v56 offset:40960
    v_mfma_f32_16x16x32_bf16 v[164:167], a[16:19], a[36:39], v[164:167]
    ds_read_b64_tr_b16 a[74:75], v56 offset:41984
    v_mfma_f32_16x16x32_bf16 v[196:199], a[16:19], a[40:43], v[196:199]
    ds_read_b64_tr_b16 a[76:77], v57 offset:40960
    v_mfma_f32_16x16x32_bf16 v[228:231], a[16:19], a[44:47], v[228:231]
    ds_read_b64_tr_b16 a[78:79], v57 offset:41984
    v_mfma_f32_16x16x32_bf16 v[232:235], a[20:23], a[44:47], v[232:235]
    v_mfma_f32_16x16x32_bf16 v[200:203], a[20:23], a[40:43], v[200:203]
    v_mfma_f32_16x16x32_bf16 v[168:171], a[20:23], a[36:39], v[168:171]
    v_mfma_f32_16x16x32_bf16 v[136:139], a[20:23], a[32:35], v[136:139]
    v_mfma_f32_16x16x32_bf16 v[140:143], a[24:27], a[32:35], v[140:143]
    v_mfma_f32_16x16x32_bf16 v[172:175], a[24:27], a[36:39], v[172:175]
    v_mfma_f32_16x16x32_bf16 v[204:207], a[24:27], a[40:43], v[204:207]
    v_mfma_f32_16x16x32_bf16 v[236:239], a[24:27], a[44:47], v[236:239]
    v_mfma_f32_16x16x32_bf16 v[240:243], a[28:31], a[44:47], v[240:243]
    v_mfma_f32_16x16x32_bf16 v[208:211], a[28:31], a[40:43], v[208:211]
    v_mfma_f32_16x16x32_bf16 v[176:179], a[28:31], a[36:39], v[176:179]
    v_mfma_f32_16x16x32_bf16 v[144:147], a[28:31], a[32:35], v[144:147]
    s_add_u32 s28, s28, 16384
    s_waitcnt vmcnt(8) lgkmcnt(0)
    s_barrier
    v_mfma_f32_16x16x32_bf16 v[100:103], a[48:51], v[32:35], v[100:103]
    ds_read_b64_tr_b16 a[0:1], v50 offset:0
    v_mfma_f32_16x16x32_bf16 v[104:107], a[52:55], v[32:35], v[104:107]
    s_add_u32 m0, s34, 32768
    ds_read_b64_tr_b16 a[2:3], v50 offset:1024
    v_mfma_f32_16x16x32_bf16 v[116:119], a[48:51], a[80:83], v[116:119]
    buffer_load_dwordx4 v13, s[8:11], s28 offen offset:0 lds
    v_mfma_f32_16x16x32_bf16 v[148:151], a[48:51], a[84:87], v[148:151]
    ds_read_b128 a[32:35], v48 offset:0
    v_mfma_f32_16x16x32_bf16 v[180:183], a[48:51], a[88:91], v[180:183]
    ds_read_b128 a[36:39], v48 offset:2048
    v_mfma_f32_16x16x32_bf16 v[212:215], a[48:51], a[92:95], v[212:215]
    ds_read_b128 a[40:43], v48 offset:4096
    v_mfma_f32_16x16x32_bf16 v[216:219], a[52:55], a[92:95], v[216:219]
    ds_read_b128 a[44:47], v48 offset:6144
    v_mfma_f32_16x16x32_bf16 v[184:187], a[52:55], a[88:91], v[184:187]
    ds_read_b64_tr_b16 a[4:5], v51 offset:0
    v_mfma_f32_16x16x32_bf16 v[152:155], a[52:55], a[84:87], v[152:155]
    ds_read_b64_tr_b16 a[6:7], v51 offset:1024
    v_mfma_f32_16x16x32_bf16 v[120:123], a[52:55], a[80:83], v[120:123]
    buffer_load_dwordx4 v14, s[8:11], s28 offen offset:1024 lds
    v_mfma_f32_16x16x32_bf16 v[124:127], a[56:59], a[80:83], v[124:127]
    ds_read_b64_tr_b16 a[8:9], v52 offset:0
    v_mfma_f32_16x16x32_bf16 v[156:159], a[56:59], a[84:87], v[156:159]
    ds_read_b64_tr_b16 a[10:11], v52 offset:1024
    v_mfma_f32_16x16x32_bf16 v[188:191], a[56:59], a[88:91], v[188:191]
    ds_read_b64_tr_b16 a[12:13], v53 offset:0
    v_mfma_f32_16x16x32_bf16 v[220:223], a[56:59], a[92:95], v[220:223]
    ds_read_b64_tr_b16 a[14:15], v53 offset:1024
    v_mfma_f32_16x16x32_bf16 v[224:227], a[60:63], a[92:95], v[224:227]
    ds_read_b64_tr_b16 a[16:17], v54 offset:0
    v_mfma_f32_16x16x32_bf16 v[192:195], a[60:63], a[88:91], v[192:195]
    ds_read_b64_tr_b16 a[18:19], v54 offset:1024
    v_mfma_f32_16x16x32_bf16 v[160:163], a[60:63], a[84:87], v[160:163]
    ds_read_b64_tr_b16 a[20:21], v55 offset:0
    v_mfma_f32_16x16x32_bf16 v[128:131], a[60:63], a[80:83], v[128:131]
    buffer_load_dwordx4 v15, s[8:11], s28 offen offset:2048 lds
    v_mfma_f32_16x16x32_bf16 v[132:135], a[64:67], a[80:83], v[132:135]
    ds_read_b64_tr_b16 a[22:23], v55 offset:1024
    v_mfma_f32_16x16x32_bf16 v[164:167], a[64:67], a[84:87], v[164:167]
    ds_read_b64_tr_b16 a[24:25], v56 offset:0
    v_mfma_f32_16x16x32_bf16 v[196:199], a[64:67], a[88:91], v[196:199]
    ds_read_b64_tr_b16 a[26:27], v56 offset:1024
    v_mfma_f32_16x16x32_bf16 v[228:231], a[64:67], a[92:95], v[228:231]
    ds_read_b64_tr_b16 a[28:29], v57 offset:0
    v_mfma_f32_16x16x32_bf16 v[232:235], a[68:71], a[92:95], v[232:235]
    ds_read_b64_tr_b16 a[30:31], v57 offset:1024
    v_mfma_f32_16x16x32_bf16 v[200:203], a[68:71], a[88:91], v[200:203]
    v_mfma_f32_16x16x32_bf16 v[168:171], a[68:71], a[84:87], v[168:171]
    buffer_load_dwordx4 v16, s[8:11], s28 offen offset:3072 lds
    v_mfma_f32_16x16x32_bf16 v[136:139], a[68:71], a[80:83], v[136:139]
    v_mfma_f32_16x16x32_bf16 v[140:143], a[72:75], a[80:83], v[140:143]
    v_mfma_f32_16x16x32_bf16 v[172:175], a[72:75], a[84:87], v[172:175]
    v_mfma_f32_16x16x32_bf16 v[204:207], a[72:75], a[88:91], v[204:207]
    v_mfma_f32_16x16x32_bf16 v[236:239], a[72:75], a[92:95], v[236:239]
    v_mfma_f32_16x16x32_bf16 v[240:243], a[76:79], a[92:95], v[240:243]
    v_mfma_f32_16x16x32_bf16 v[208:211], a[76:79], a[88:91], v[208:211]
    v_mfma_f32_16x16x32_bf16 v[176:179], a[76:79], a[84:87], v[176:179]
    v_mfma_f32_16x16x32_bf16 v[144:147], a[76:79], a[80:83], v[144:147]
    s_waitcnt lgkmcnt(0)
    v_mfma_f32_16x16x32_bf16 v[100:103], a[0:3], v[32:35], v[100:103]
    ds_read_b64_tr_b16 a[48:49], v50 offset:8192
    v_mfma_f32_16x16x32_bf16 v[104:107], a[4:7], v[32:35], v[104:107]
    s_add_u32 s28, s28, 16384
    s_mov_b32 m0, s30
    ds_read_b64_tr_b16 a[50:51], v50 offset:9216
    v_mfma_f32_16x16x32_bf16 v[116:119], a[0:3], a[32:35], v[116:119]
    buffer_load_dwordx4 v17, s[12:15], s29 offen offset:0 lds
    v_mfma_f32_16x16x32_bf16 v[148:151], a[0:3], a[36:39], v[148:151]
    ds_read_b64_tr_b16 a[52:53], v51 offset:8192
    v_mfma_f32_16x16x32_bf16 v[180:183], a[0:3], a[40:43], v[180:183]
    ds_read_b64_tr_b16 a[54:55], v51 offset:9216
    v_mfma_f32_16x16x32_bf16 v[212:215], a[0:3], a[44:47], v[212:215]
    ds_read_b128 a[80:83], v49 offset:0
    v_mfma_f32_16x16x32_bf16 v[216:219], a[4:7], a[44:47], v[216:219]
    ds_read_b128 a[84:87], v49 offset:2048
    v_mfma_f32_16x16x32_bf16 v[184:187], a[4:7], a[40:43], v[184:187]
    ds_read_b128 a[88:91], v49 offset:4096
    v_mfma_f32_16x16x32_bf16 v[152:155], a[4:7], a[36:39], v[152:155]
    ds_read_b128 a[92:95], v49 offset:6144
    v_mfma_f32_16x16x32_bf16 v[120:123], a[4:7], a[32:35], v[120:123]
    buffer_load_dwordx4 v18, s[12:15], s29 offen offset:1024 lds
    v_mfma_f32_16x16x32_bf16 v[124:127], a[8:11], a[32:35], v[124:127]
    ds_read_b64_tr_b16 a[56:57], v52 offset:8192
    v_mfma_f32_16x16x32_bf16 v[156:159], a[8:11], a[36:39], v[156:159]
    ds_read_b64_tr_b16 a[58:59], v52 offset:9216
    v_mfma_f32_16x16x32_bf16 v[188:191], a[8:11], a[40:43], v[188:191]
    ds_read_b64_tr_b16 a[60:61], v53 offset:8192
    v_mfma_f32_16x16x32_bf16 v[220:223], a[8:11], a[44:47], v[220:223]
    ds_read_b64_tr_b16 a[62:63], v53 offset:9216
    v_mfma_f32_16x16x32_bf16 v[224:227], a[12:15], a[44:47], v[224:227]
    ds_read_b64_tr_b16 a[64:65], v54 offset:8192
    v_mfma_f32_16x16x32_bf16 v[192:195], a[12:15], a[40:43], v[192:195]
    s_waitcnt lgkmcnt(9)
    ds_read_b64_tr_b16 a[66:67], v54 offset:9216
    v_mfma_f32_16x16x32_bf16 v[100:103], a[48:51], v[32:35], v[100:103]
    ds_read_b64_tr_b16 a[68:69], v55 offset:8192
    v_mfma_f32_16x16x32_bf16 v[104:107], a[52:55], v[32:35], v[104:107]
    buffer_load_dwordx4 v17, s[12:15], s29 offen offset:2048 lds
    v_mfma_f32_16x16x32_bf16 v[160:163], a[12:15], a[36:39], v[160:163]
    ds_read_b64_tr_b16 a[70:71], v55 offset:9216
    v_mfma_f32_16x16x32_bf16 v[128:131], a[12:15], a[32:35], v[128:131]
    ds_read_b64_tr_b16 a[72:73], v56 offset:8192
    v_mfma_f32_16x16x32_bf16 v[132:135], a[16:19], a[32:35], v[132:135]
    ds_read_b64_tr_b16 a[74:75], v56 offset:9216
    v_mfma_f32_16x16x32_bf16 v[164:167], a[16:19], a[36:39], v[164:167]
    ds_read_b64_tr_b16 a[76:77], v57 offset:8192
    v_mfma_f32_16x16x32_bf16 v[196:199], a[16:19], a[40:43], v[196:199]
    ds_read_b64_tr_b16 a[78:79], v57 offset:9216
    v_mfma_f32_16x16x32_bf16 v[228:231], a[16:19], a[44:47], v[228:231]
    ds_write_b128 v58, v[100:103] offset:0
    v_mfma_f32_16x16x32_bf16 v[232:235], a[20:23], a[44:47], v[232:235]
    buffer_load_dwordx4 v18, s[12:15], s29 offen offset:3072 lds
    v_mfma_f32_16x16x32_bf16 v[200:203], a[20:23], a[40:43], v[200:203]
    ds_write_b128 v58, v[104:107] offset:64
    v_mfma_f32_16x16x32_bf16 v[168:171], a[20:23], a[36:39], v[168:171]
    ds_write_b128 v58, v[100:103] offset:512
    v_mfma_f32_16x16x32_bf16 v[136:139], a[20:23], a[32:35], v[136:139]
    ds_write_b128 v58, v[104:107] offset:576
    v_mfma_f32_16x16x32_bf16 v[140:143], a[24:27], a[32:35], v[140:143]
    v_mfma_f32_16x16x32_bf16 v[172:175], a[24:27], a[36:39], v[172:175]
    v_mfma_f32_16x16x32_bf16 v[204:207], a[24:27], a[40:43], v[204:207]
    v_mfma_f32_16x16x32_bf16 v[236:239], a[24:27], a[44:47], v[236:239]
    v_mfma_f32_16x16x32_bf16 v[240:243], a[28:31], a[44:47], v[240:243]
    v_mfma_f32_16x16x32_bf16 v[208:211], a[28:31], a[40:43], v[208:211]
    v_mfma_f32_16x16x32_bf16 v[176:179], a[28:31], a[36:39], v[176:179]
    v_mfma_f32_16x16x32_bf16 v[144:147], a[28:31], a[32:35], v[144:147]
    s_add_u32 s29, s29, 16384
    s_waitcnt vmcnt(10) lgkmcnt(0)
    s_barrier
    v_mfma_f32_16x16x32_bf16 v[116:119], a[48:51], a[80:83], v[116:119]
    ds_read_b128 v[68:71], v58 offset:0
    v_mfma_f32_16x16x32_bf16 v[120:123], a[52:55], a[80:83], v[120:123]
    ds_read_b128 v[72:75], v58 offset:64
    v_mul_f32 v109, s44, v109
    v_mfma_f32_16x16x32_bf16 v[124:127], a[56:59], a[80:83], v[124:127]
    ds_read_b128 v[76:79], v58 offset:128
    v_mul_f32 v111, s44, v111
    v_mfma_f32_16x16x32_bf16 v[128:131], a[60:63], a[80:83], v[128:131]
    ds_read_b128 v[80:83], v58 offset:192
    v_mul_f32 v113, s44, v113
    v_mfma_f32_16x16x32_bf16 v[132:135], a[64:67], a[80:83], v[132:135]
    ds_read_b128 v[84:87], v58 offset:256
    v_mfma_f32_16x16x32_bf16 v[136:139], a[68:71], a[80:83], v[136:139]
    ds_read_b128 v[88:91], v58 offset:320
    v_mul_f32 v115, s44, v115
    v_mfma_f32_16x16x32_bf16 v[140:143], a[72:75], a[80:83], v[140:143]
    ds_read_b128 v[92:95], v58 offset:384
    v_and_b32 v253, 7, v19
    v_mfma_f32_16x16x32_bf16 v[144:147], a[76:79], a[80:83], v[144:147]
    ds_read_b128 v[96:99], v58 offset:448
    v_lshlrev_b32 v253, 5, v253
    v_mfma_f32_16x16x32_bf16 v[148:151], a[48:51], a[84:87], v[148:151]
    ds_read_b128 a[128:131], v1 offset:49152
    v_mfma_f32_16x16x32_bf16 v[152:155], a[52:55], a[84:87], v[152:155]
    ds_read_b128 a[132:135], v2 offset:49152
    v_mfma_f32_16x16x32_bf16 v[156:159], a[56:59], a[84:87], v[156:159]
    ds_read_b128 a[136:139], v3 offset:49152
    v_mfma_f32_16x16x32_bf16 v[160:163], a[60:63], a[84:87], v[160:163]
    ds_read_b128 a[140:143], v4 offset:49152
    v_mfma_f32_16x16x32_bf16 v[164:167], a[64:67], a[84:87], v[164:167]
    ds_read_b128 a[144:147], v1 offset:53248
    v_mfma_f32_16x16x32_bf16 v[168:171], a[68:71], a[84:87], v[168:171]
    ds_read_b128 a[148:151], v2 offset:53248
    v_mfma_f32_16x16x32_bf16 v[172:175], a[72:75], a[84:87], v[172:175]
    ds_read_b128 a[152:155], v3 offset:53248
    v_mfma_f32_16x16x32_bf16 v[176:179], a[76:79], a[84:87], v[176:179]
    ds_read_b128 a[156:159], v4 offset:53248
    buffer_load_dword v252, v253, s[92:95], 0 offen sc1
    s_waitcnt lgkmcnt(8)
    v_pk_fma_f32 v[116:117], v[108:109], v[68:69], v[116:117] op_sel_hi:[0,1,1] neg_lo:[1,0,0] neg_hi:[1,0,0]
    v_pk_fma_f32 v[118:119], v[108:109], v[70:71], v[118:119] op_sel_hi:[0,1,1] neg_lo:[1,0,0] neg_hi:[1,0,0]
    v_pk_fma_f32 v[120:121], v[108:109], v[72:73], v[120:121] op_sel_hi:[0,1,1] neg_lo:[1,0,0] neg_hi:[1,0,0]
    v_pk_fma_f32 v[122:123], v[108:109], v[74:75], v[122:123] op_sel_hi:[0,1,1] neg_lo:[1,0,0] neg_hi:[1,0,0]
    v_pk_fma_f32 v[124:125], v[108:109], v[76:77], v[124:125] op_sel_hi:[0,1,1] neg_lo:[1,0,0] neg_hi:[1,0,0]
    v_pk_fma_f32 v[126:127], v[108:109], v[78:79], v[126:127] op_sel_hi:[0,1,1] neg_lo:[1,0,0] neg_hi:[1,0,0]
    v_pk_fma_f32 v[128:129], v[108:109], v[80:81], v[128:129] op_sel_hi:[0,1,1] neg_lo:[1,0,0] neg_hi:[1,0,0]
    v_pk_fma_f32 v[130:131], v[108:109], v[82:83], v[130:131] op_sel_hi:[0,1,1] neg_lo:[1,0,0] neg_hi:[1,0,0]
    v_pk_fma_f32 v[132:133], v[108:109], v[84:85], v[132:133] op_sel_hi:[0,1,1] neg_lo:[1,0,0] neg_hi:[1,0,0]
    v_pk_fma_f32 v[134:135], v[108:109], v[86:87], v[134:135] op_sel_hi:[0,1,1] neg_lo:[1,0,0] neg_hi:[1,0,0]
    v_pk_fma_f32 v[136:137], v[108:109], v[88:89], v[136:137] op_sel_hi:[0,1,1] neg_lo:[1,0,0] neg_hi:[1,0,0]
    v_pk_fma_f32 v[138:139], v[108:109], v[90:91], v[138:139] op_sel_hi:[0,1,1] neg_lo:[1,0,0] neg_hi:[1,0,0]
    v_pk_fma_f32 v[140:141], v[108:109], v[92:93], v[140:141] op_sel_hi:[0,1,1] neg_lo:[1,0,0] neg_hi:[1,0,0]
    v_pk_fma_f32 v[142:143], v[108:109], v[94:95], v[142:143] op_sel_hi:[0,1,1] neg_lo:[1,0,0] neg_hi:[1,0,0]
    v_pk_fma_f32 v[144:145], v[108:109], v[96:97], v[144:145] op_sel_hi:[0,1,1] neg_lo:[1,0,0] neg_hi:[1,0,0]
    v_pk_fma_f32 v[146:147], v[108:109], v[98:99], v[146:147] op_sel_hi:[0,1,1] neg_lo:[1,0,0] neg_hi:[1,0,0]
    v_pk_mul_f32 v[116:117], v[116:117], v[108:109] op_sel:[0,1] op_sel_hi:[1,1]
    v_pk_mul_f32 v[118:119], v[118:119], v[108:109] op_sel:[0,1] op_sel_hi:[1,1]
    v_pk_mul_f32 v[120:121], v[120:121], v[108:109] op_sel:[0,1] op_sel_hi:[1,1]
    v_pk_mul_f32 v[122:123], v[122:123], v[108:109] op_sel:[0,1] op_sel_hi:[1,1]
    v_pk_mul_f32 v[124:125], v[124:125], v[108:109] op_sel:[0,1] op_sel_hi:[1,1]
    v_pk_mul_f32 v[126:127], v[126:127], v[108:109] op_sel:[0,1] op_sel_hi:[1,1]
    v_pk_mul_f32 v[128:129], v[128:129], v[108:109] op_sel:[0,1] op_sel_hi:[1,1]
    v_pk_mul_f32 v[130:131], v[130:131], v[108:109] op_sel:[0,1] op_sel_hi:[1,1]
    v_pk_mul_f32 v[132:133], v[132:133], v[108:109] op_sel:[0,1] op_sel_hi:[1,1]
    v_pk_mul_f32 v[134:135], v[134:135], v[108:109] op_sel:[0,1] op_sel_hi:[1,1]
    v_pk_mul_f32 v[136:137], v[136:137], v[108:109] op_sel:[0,1] op_sel_hi:[1,1]
    v_pk_mul_f32 v[138:139], v[138:139], v[108:109] op_sel:[0,1] op_sel_hi:[1,1]
    v_pk_mul_f32 v[140:141], v[140:141], v[108:109] op_sel:[0,1] op_sel_hi:[1,1]
    v_pk_mul_f32 v[142:143], v[142:143], v[108:109] op_sel:[0,1] op_sel_hi:[1,1]
    v_pk_mul_f32 v[144:145], v[144:145], v[108:109] op_sel:[0,1] op_sel_hi:[1,1]
    v_pk_mul_f32 v[146:147], v[146:147], v[108:109] op_sel:[0,1] op_sel_hi:[1,1]
    v_mfma_f32_16x16x32_bf16 v[180:183], a[48:51], a[88:91], v[180:183]
    ds_read_b128 a[160:163], v1 offset:57344
    v_cvt_pk_bf16_f32 v36, v116, v117
    v_cvt_pk_bf16_f32 v37, v118, v119
    v_cvt_pk_bf16_f32 v38, v120, v121
    v_cvt_pk_bf16_f32 v39, v122, v123
    v_mfma_f32_16x16x32_bf16 v[184:187], a[52:55], a[88:91], v[184:187]
    ds_read_b128 a[164:167], v2 offset:57344
    v_cvt_pk_bf16_f32 v40, v124, v125
    v_cvt_pk_bf16_f32 v41, v126, v127
    v_cvt_pk_bf16_f32 v42, v128, v129
    v_cvt_pk_bf16_f32 v43, v130, v131
    v_mfma_f32_16x16x32_bf16 v[188:191], a[56:59], a[88:91], v[188:191]
    ds_read_b128 a[168:171], v3 offset:57344
    v_cvt_pk_bf16_f32 v44, v132, v133
    v_cvt_pk_bf16_f32 v45, v134, v135
    v_cvt_pk_bf16_f32 v46, v136, v137
    v_cvt_pk_bf16_f32 v47, v138, v139
    v_mfma_f32_16x16x32_bf16 v[192:195], a[60:63], a[88:91], v[192:195]
    ds_read_b128 a[172:175], v4 offset:57344
    v_cvt_pk_bf16_f32 v48, v140, v141
    v_cvt_pk_bf16_f32 v49, v142, v143
    v_cvt_pk_bf16_f32 v50, v144, v145
    v_cvt_pk_bf16_f32 v51, v146, v147
    v_mfma_f32_16x16x32_bf16 v[196:199], a[64:67], a[88:91], v[196:199]
    ds_read_b128 a[176:179], v1 offset:61440
    v_permlane32_swap_b32 v36, v38
    v_permlane32_swap_b32 v37, v39
    v_permlane32_swap_b32 v40, v42
    v_permlane32_swap_b32 v41, v43
    v_mfma_f32_16x16x32_bf16 v[200:203], a[68:71], a[88:91], v[200:203]
    ds_read_b128 a[180:183], v2 offset:61440
    v_permlane32_swap_b32 v44, v46
    v_permlane32_swap_b32 v45, v47
    v_permlane32_swap_b32 v48, v50
    v_permlane32_swap_b32 v49, v51
    v_mfma_f32_16x16x32_bf16 v[204:207], a[72:75], a[88:91], v[204:207]
    ds_read_b128 a[184:187], v3 offset:61440
    v_permlane16_swap_b32 v36, v38
    v_permlane16_swap_b32 v37, v39
    v_permlane16_swap_b32 v40, v42
    v_permlane16_swap_b32 v41, v43
    v_mfma_f32_16x16x32_bf16 v[208:211], a[76:79], a[88:91], v[208:211]
    ds_read_b128 a[188:191], v4 offset:61440
    v_permlane16_swap_b32 v44, v46
    v_permlane16_swap_b32 v45, v47
    v_permlane16_swap_b32 v48, v50
    v_permlane16_swap_b32 v49, v51
    v_pk_fma_f32 v[148:149], v[110:111], v[68:69], v[148:149] op_sel_hi:[0,1,1] neg_lo:[1,0,0] neg_hi:[1,0,0]
    v_pk_fma_f32 v[150:151], v[110:111], v[70:71], v[150:151] op_sel_hi:[0,1,1] neg_lo:[1,0,0] neg_hi:[1,0,0]
    v_pk_fma_f32 v[152:153], v[110:111], v[72:73], v[152:153] op_sel_hi:[0,1,1] neg_lo:[1,0,0] neg_hi:[1,0,0]
    v_pk_fma_f32 v[154:155], v[110:111], v[74:75], v[154:155] op_sel_hi:[0,1,1] neg_lo:[1,0,0] neg_hi:[1,0,0]
    v_pk_fma_f32 v[156:157], v[110:111], v[76:77], v[156:157] op_sel_hi:[0,1,1] neg_lo:[1,0,0] neg_hi:[1,0,0]
    v_pk_fma_f32 v[158:159], v[110:111], v[78:79], v[158:159] op_sel_hi:[0,1,1] neg_lo:[1,0,0] neg_hi:[1,0,0]
    v_pk_fma_f32 v[160:161], v[110:111], v[80:81], v[160:161] op_sel_hi:[0,1,1] neg_lo:[1,0,0] neg_hi:[1,0,0]
    v_pk_fma_f32 v[162:163], v[110:111], v[82:83], v[162:163] op_sel_hi:[0,1,1] neg_lo:[1,0,0] neg_hi:[1,0,0]
    v_pk_fma_f32 v[164:165], v[110:111], v[84:85], v[164:165] op_sel_hi:[0,1,1] neg_lo:[1,0,0] neg_hi:[1,0,0]
    v_pk_fma_f32 v[166:167], v[110:111], v[86:87], v[166:167] op_sel_hi:[0,1,1] neg_lo:[1,0,0] neg_hi:[1,0,0]
    v_pk_fma_f32 v[168:169], v[110:111], v[88:89], v[168:169] op_sel_hi:[0,1,1] neg_lo:[1,0,0] neg_hi:[1,0,0]
    v_pk_fma_f32 v[170:171], v[110:111], v[90:91], v[170:171] op_sel_hi:[0,1,1] neg_lo:[1,0,0] neg_hi:[1,0,0]
    v_pk_fma_f32 v[172:173], v[110:111], v[92:93], v[172:173] op_sel_hi:[0,1,1] neg_lo:[1,0,0] neg_hi:[1,0,0]
    v_pk_fma_f32 v[174:175], v[110:111], v[94:95], v[174:175] op_sel_hi:[0,1,1] neg_lo:[1,0,0] neg_hi:[1,0,0]
    v_pk_fma_f32 v[176:177], v[110:111], v[96:97], v[176:177] op_sel_hi:[0,1,1] neg_lo:[1,0,0] neg_hi:[1,0,0]
    v_pk_fma_f32 v[178:179], v[110:111], v[98:99], v[178:179] op_sel_hi:[0,1,1] neg_lo:[1,0,0] neg_hi:[1,0,0]
    v_pk_mul_f32 v[148:149], v[148:149], v[110:111] op_sel:[0,1] op_sel_hi:[1,1]
    v_pk_mul_f32 v[150:151], v[150:151], v[110:111] op_sel:[0,1] op_sel_hi:[1,1]
    v_pk_mul_f32 v[152:153], v[152:153], v[110:111] op_sel:[0,1] op_sel_hi:[1,1]
    v_pk_mul_f32 v[154:155], v[154:155], v[110:111] op_sel:[0,1] op_sel_hi:[1,1]
    v_pk_mul_f32 v[156:157], v[156:157], v[110:111] op_sel:[0,1] op_sel_hi:[1,1]
    v_pk_mul_f32 v[158:159], v[158:159], v[110:111] op_sel:[0,1] op_sel_hi:[1,1]
    v_pk_mul_f32 v[160:161], v[160:161], v[110:111] op_sel:[0,1] op_sel_hi:[1,1]
    v_pk_mul_f32 v[162:163], v[162:163], v[110:111] op_sel:[0,1] op_sel_hi:[1,1]
    v_pk_mul_f32 v[164:165], v[164:165], v[110:111] op_sel:[0,1] op_sel_hi:[1,1]
    v_pk_mul_f32 v[166:167], v[166:167], v[110:111] op_sel:[0,1] op_sel_hi:[1,1]
    v_pk_mul_f32 v[168:169], v[168:169], v[110:111] op_sel:[0,1] op_sel_hi:[1,1]
    v_pk_mul_f32 v[170:171], v[170:171], v[110:111] op_sel:[0,1] op_sel_hi:[1,1]
    v_pk_mul_f32 v[172:173], v[172:173], v[110:111] op_sel:[0,1] op_sel_hi:[1,1]
    v_pk_mul_f32 v[174:175], v[174:175], v[110:111] op_sel:[0,1] op_sel_hi:[1,1]
    v_pk_mul_f32 v[176:177], v[176:177], v[110:111] op_sel:[0,1] op_sel_hi:[1,1]
    v_pk_mul_f32 v[178:179], v[178:179], v[110:111] op_sel:[0,1] op_sel_hi:[1,1]
    v_mfma_f32_16x16x32_bf16 v[212:215], a[48:51], a[92:95], v[212:215]
    s_add_u32 m0, s47, 0
    s_nop 0
    buffer_load_dwordx4 v20, s[96:99], 0 offen lds
    v_cvt_pk_bf16_f32 v52, v148, v149
    v_cvt_pk_bf16_f32 v53, v150, v151
    v_cvt_pk_bf16_f32 v54, v152, v153
    v_cvt_pk_bf16_f32 v55, v154, v155
    v_mfma_f32_16x16x32_bf16 v[216:219], a[52:55], a[92:95], v[216:219]
    s_add_u32 m0, s47, 1024
    s_nop 0
    buffer_load_dwordx4 v21, s[96:99], 0 offen lds
    v_cvt_pk_bf16_f32 v56, v156, v157
    v_cvt_pk_bf16_f32 v57, v158, v159
    v_cvt_pk_bf16_f32 v58, v160, v161
    v_cvt_pk_bf16_f32 v59, v162, v163
    v_mfma_f32_16x16x32_bf16 v[220:223], a[56:59], a[92:95], v[220:223]
    s_add_u32 m0, s47, 2048
    s_nop 0
    buffer_load_dwordx4 v22, s[96:99], 0 offen lds
    v_cvt_pk_bf16_f32 v60, v164, v165
    v_cvt_pk_bf16_f32 v61, v166, v167
    v_cvt_pk_bf16_f32 v62, v168, v169
    v_cvt_pk_bf16_f32 v63, v170, v171
    v_mfma_f32_16x16x32_bf16 v[224:227], a[60:63], a[92:95], v[224:227]
    s_add_u32 m0, s47, 3072
    s_nop 0
    buffer_load_dwordx4 v23, s[96:99], 0 offen lds
    v_cvt_pk_bf16_f32 v64, v172, v173
    v_cvt_pk_bf16_f32 v65, v174, v175
    v_cvt_pk_bf16_f32 v66, v176, v177
    v_cvt_pk_bf16_f32 v67, v178, v179
    v_mfma_f32_16x16x32_bf16 v[228:231], a[64:67], a[92:95], v[228:231]
    s_add_u32 m0, s47, 4096
    s_nop 0
    buffer_load_dwordx4 v24, s[96:99], 0 offen lds
    v_permlane32_swap_b32 v52, v54
    v_permlane32_swap_b32 v53, v55
    v_permlane32_swap_b32 v56, v58
    v_permlane32_swap_b32 v57, v59
    v_mfma_f32_16x16x32_bf16 v[232:235], a[68:71], a[92:95], v[232:235]
    v_permlane32_swap_b32 v60, v62
    v_permlane32_swap_b32 v61, v63
    v_permlane32_swap_b32 v64, v66
    v_permlane32_swap_b32 v65, v67
    v_mfma_f32_16x16x32_bf16 v[236:239], a[72:75], a[92:95], v[236:239]
    v_permlane16_swap_b32 v52, v54
    v_permlane16_swap_b32 v53, v55
    v_permlane16_swap_b32 v56, v58
    v_permlane16_swap_b32 v57, v59
    v_mfma_f32_16x16x32_bf16 v[240:243], a[76:79], a[92:95], v[240:243]
    v_permlane16_swap_b32 v60, v62
    v_permlane16_swap_b32 v61, v63
    v_permlane16_swap_b32 v64, v66
    v_permlane16_swap_b32 v65, v67
    v_pk_fma_f32 v[180:181], v[112:113], v[68:69], v[180:181] op_sel_hi:[0,1,1] neg_lo:[1,0,0] neg_hi:[1,0,0]
    v_pk_fma_f32 v[182:183], v[112:113], v[70:71], v[182:183] op_sel_hi:[0,1,1] neg_lo:[1,0,0] neg_hi:[1,0,0]
    v_pk_fma_f32 v[184:185], v[112:113], v[72:73], v[184:185] op_sel_hi:[0,1,1] neg_lo:[1,0,0] neg_hi:[1,0,0]
    v_pk_fma_f32 v[186:187], v[112:113], v[74:75], v[186:187] op_sel_hi:[0,1,1] neg_lo:[1,0,0] neg_hi:[1,0,0]
    v_pk_fma_f32 v[188:189], v[112:113], v[76:77], v[188:189] op_sel_hi:[0,1,1] neg_lo:[1,0,0] neg_hi:[1,0,0]
    v_pk_fma_f32 v[190:191], v[112:113], v[78:79], v[190:191] op_sel_hi:[0,1,1] neg_lo:[1,0,0] neg_hi:[1,0,0]
    v_pk_fma_f32 v[192:193], v[112:113], v[80:81], v[192:193] op_sel_hi:[0,1,1] neg_lo:[1,0,0] neg_hi:[1,0,0]
    v_pk_fma_f32 v[194:195], v[112:113], v[82:83], v[194:195] op_sel_hi:[0,1,1] neg_lo:[1,0,0] neg_hi:[1,0,0]
    v_pk_fma_f32 v[196:197], v[112:113], v[84:85], v[196:197] op_sel_hi:[0,1,1] neg_lo:[1,0,0] neg_hi:[1,0,0]
    v_pk_fma_f32 v[198:199], v[112:113], v[86:87], v[198:199] op_sel_hi:[0,1,1] neg_lo:[1,0,0] neg_hi:[1,0,0]
    v_pk_fma_f32 v[200:201], v[112:113], v[88:89], v[200:201] op_sel_hi:[0,1,1] neg_lo:[1,0,0] neg_hi:[1,0,0]
    v_pk_fma_f32 v[202:203], v[112:113], v[90:91], v[202:203] op_sel_hi:[0,1,1] neg_lo:[1,0,0] neg_hi:[1,0,0]
    v_pk_fma_f32 v[204:205], v[112:113], v[92:93], v[204:205] op_sel_hi:[0,1,1] neg_lo:[1,0,0] neg_hi:[1,0,0]
    v_pk_fma_f32 v[206:207], v[112:113], v[94:95], v[206:207] op_sel_hi:[0,1,1] neg_lo:[1,0,0] neg_hi:[1,0,0]
    v_pk_fma_f32 v[208:209], v[112:113], v[96:97], v[208:209] op_sel_hi:[0,1,1] neg_lo:[1,0,0] neg_hi:[1,0,0]
    v_pk_fma_f32 v[210:211], v[112:113], v[98:99], v[210:211] op_sel_hi:[0,1,1] neg_lo:[1,0,0] neg_hi:[1,0,0]
    v_pk_mul_f32 v[180:181], v[180:181], v[112:113] op_sel:[0,1] op_sel_hi:[1,1]
    v_pk_mul_f32 v[182:183], v[182:183], v[112:113] op_sel:[0,1] op_sel_hi:[1,1]
    v_pk_mul_f32 v[184:185], v[184:185], v[112:113] op_sel:[0,1] op_sel_hi:[1,1]
    v_pk_mul_f32 v[186:187], v[186:187], v[112:113] op_sel:[0,1] op_sel_hi:[1,1]
    v_pk_mul_f32 v[188:189], v[188:189], v[112:113] op_sel:[0,1] op_sel_hi:[1,1]
    v_pk_mul_f32 v[190:191], v[190:191], v[112:113] op_sel:[0,1] op_sel_hi:[1,1]
    v_pk_mul_f32 v[192:193], v[192:193], v[112:113] op_sel:[0,1] op_sel_hi:[1,1]
    v_pk_mul_f32 v[194:195], v[194:195], v[112:113] op_sel:[0,1] op_sel_hi:[1,1]
    v_pk_mul_f32 v[196:197], v[196:197], v[112:113] op_sel:[0,1] op_sel_hi:[1,1]
    v_pk_mul_f32 v[198:199], v[198:199], v[112:113] op_sel:[0,1] op_sel_hi:[1,1]
    v_pk_mul_f32 v[200:201], v[200:201], v[112:113] op_sel:[0,1] op_sel_hi:[1,1]
    v_pk_mul_f32 v[202:203], v[202:203], v[112:113] op_sel:[0,1] op_sel_hi:[1,1]
    v_pk_mul_f32 v[204:205], v[204:205], v[112:113] op_sel:[0,1] op_sel_hi:[1,1]
    v_pk_mul_f32 v[206:207], v[206:207], v[112:113] op_sel:[0,1] op_sel_hi:[1,1]
    v_pk_mul_f32 v[208:209], v[208:209], v[112:113] op_sel:[0,1] op_sel_hi:[1,1]
    v_pk_mul_f32 v[210:211], v[210:211], v[112:113] op_sel:[0,1] op_sel_hi:[1,1]
    v_pk_fma_f32 v[212:213], v[114:115], v[68:69], v[212:213] op_sel_hi:[0,1,1] neg_lo:[1,0,0] neg_hi:[1,0,0]
    v_pk_fma_f32 v[214:215], v[114:115], v[70:71], v[214:215] op_sel_hi:[0,1,1] neg_lo:[1,0,0] neg_hi:[1,0,0]
    v_pk_fma_f32 v[216:217], v[114:115], v[72:73], v[216:217] op_sel_hi:[0,1,1] neg_lo:[1,0,0] neg_hi:[1,0,0]
    v_pk_fma_f32 v[218:219], v[114:115], v[74:75], v[218:219] op_sel_hi:[0,1,1] neg_lo:[1,0,0] neg_hi:[1,0,0]
    v_pk_fma_f32 v[220:221], v[114:115], v[76:77], v[220:221] op_sel_hi:[0,1,1] neg_lo:[1,0,0] neg_hi:[1,0,0]
    v_pk_fma_f32 v[222:223], v[114:115], v[78:79], v[222:223] op_sel_hi:[0,1,1] neg_lo:[1,0,0] neg_hi:[1,0,0]
    v_pk_fma_f32 v[224:225], v[114:115], v[80:81], v[224:225] op_sel_hi:[0,1,1] neg_lo:[1,0,0] neg_hi:[1,0,0]
    v_pk_fma_f32 v[226:227], v[114:115], v[82:83], v[226:227] op_sel_hi:[0,1,1] neg_lo:[1,0,0] neg_hi:[1,0,0]
    v_pk_fma_f32 v[228:229], v[114:115], v[84:85], v[228:229] op_sel_hi:[0,1,1] neg_lo:[1,0,0] neg_hi:[1,0,0]
    v_pk_fma_f32 v[230:231], v[114:115], v[86:87], v[230:231] op_sel_hi:[0,1,1] neg_lo:[1,0,0] neg_hi:[1,0,0]
    v_pk_fma_f32 v[232:233], v[114:115], v[88:89], v[232:233] op_sel_hi:[0,1,1] neg_lo:[1,0,0] neg_hi:[1,0,0]
    v_pk_fma_f32 v[234:235], v[114:115], v[90:91], v[234:235] op_sel_hi:[0,1,1] neg_lo:[1,0,0] neg_hi:[1,0,0]
    v_pk_fma_f32 v[236:237], v[114:115], v[92:93], v[236:237] op_sel_hi:[0,1,1] neg_lo:[1,0,0] neg_hi:[1,0,0]
    v_pk_fma_f32 v[238:239], v[114:115], v[94:95], v[238:239] op_sel_hi:[0,1,1] neg_lo:[1,0,0] neg_hi:[1,0,0]
    v_pk_fma_f32 v[240:241], v[114:115], v[96:97], v[240:241] op_sel_hi:[0,1,1] neg_lo:[1,0,0] neg_hi:[1,0,0]
    v_pk_fma_f32 v[242:243], v[114:115], v[98:99], v[242:243] op_sel_hi:[0,1,1] neg_lo:[1,0,0] neg_hi:[1,0,0]
    s_waitcnt lgkmcnt(0)
    v_mfma_f32_16x16x32_bf16 v[116:119], a[128:131], v[36:39], 0
    v_cvt_pk_bf16_f32 v68, v180, v181
    v_cvt_pk_bf16_f32 v69, v182, v183
    v_cvt_pk_bf16_f32 v70, v184, v185
    v_cvt_pk_bf16_f32 v71, v186, v187
    v_mfma_f32_16x16x32_bf16 v[116:119], a[132:135], v[40:43], v[116:119]
    v_cvt_pk_bf16_f32 v72, v188, v189
    v_cvt_pk_bf16_f32 v73, v190, v191
    v_cvt_pk_bf16_f32 v74, v192, v193
    v_cvt_pk_bf16_f32 v75, v194, v195
    v_mfma_f32_16x16x32_bf16 v[116:119], a[136:139], v[44:47], v[116:119]
    v_cvt_pk_bf16_f32 v76, v196, v197
    v_cvt_pk_bf16_f32 v77, v198, v199
    v_cvt_pk_bf16_f32 v78, v200, v201
    v_cvt_pk_bf16_f32 v79, v202, v203
    v_mfma_f32_16x16x32_bf16 v[116:119], a[140:143], v[48:51], v[116:119]
    v_cvt_pk_bf16_f32 v80, v204, v205
    v_cvt_pk_bf16_f32 v81, v206, v207
    v_cvt_pk_bf16_f32 v82, v208, v209
    v_cvt_pk_bf16_f32 v83, v210, v211
    v_mfma_f32_16x16x32_bf16 v[132:135], a[144:147], v[36:39], 0
    v_permlane32_swap_b32 v68, v70
    v_permlane32_swap_b32 v69, v71
    v_permlane32_swap_b32 v72, v74
    v_permlane32_swap_b32 v73, v75
    v_mfma_f32_16x16x32_bf16 v[132:135], a[148:151], v[40:43], v[132:135]
    v_permlane32_swap_b32 v76, v78
    v_permlane32_swap_b32 v77, v79
    v_permlane32_swap_b32 v80, v82
    v_permlane32_swap_b32 v81, v83
    v_mfma_f32_16x16x32_bf16 v[132:135], a[152:155], v[44:47], v[132:135]
    v_permlane16_swap_b32 v68, v70
    v_permlane16_swap_b32 v69, v71
    v_permlane16_swap_b32 v72, v74
    v_permlane16_swap_b32 v73, v75
    v_mfma_f32_16x16x32_bf16 v[132:135], a[156:159], v[48:51], v[132:135]
    v_permlane16_swap_b32 v76, v78
    v_permlane16_swap_b32 v77, v79
    v_permlane16_swap_b32 v80, v82
    v_permlane16_swap_b32 v81, v83
    v_pk_mul_f32 v[212:213], v[212:213], v[114:115] op_sel:[0,1] op_sel_hi:[1,1]
    v_pk_mul_f32 v[214:215], v[214:215], v[114:115] op_sel:[0,1] op_sel_hi:[1,1]
    v_pk_mul_f32 v[216:217], v[216:217], v[114:115] op_sel:[0,1] op_sel_hi:[1,1]
    v_pk_mul_f32 v[218:219], v[218:219], v[114:115] op_sel:[0,1] op_sel_hi:[1,1]
    v_pk_mul_f32 v[220:221], v[220:221], v[114:115] op_sel:[0,1] op_sel_hi:[1,1]
    v_pk_mul_f32 v[222:223], v[222:223], v[114:115] op_sel:[0,1] op_sel_hi:[1,1]
    v_pk_mul_f32 v[224:225], v[224:225], v[114:115] op_sel:[0,1] op_sel_hi:[1,1]
    v_pk_mul_f32 v[226:227], v[226:227], v[114:115] op_sel:[0,1] op_sel_hi:[1,1]
    v_pk_mul_f32 v[228:229], v[228:229], v[114:115] op_sel:[0,1] op_sel_hi:[1,1]
    v_pk_mul_f32 v[230:231], v[230:231], v[114:115] op_sel:[0,1] op_sel_hi:[1,1]
    v_pk_mul_f32 v[232:233], v[232:233], v[114:115] op_sel:[0,1] op_sel_hi:[1,1]
    v_pk_mul_f32 v[234:235], v[234:235], v[114:115] op_sel:[0,1] op_sel_hi:[1,1]
    v_pk_mul_f32 v[236:237], v[236:237], v[114:115] op_sel:[0,1] op_sel_hi:[1,1]
    v_pk_mul_f32 v[238:239], v[238:239], v[114:115] op_sel:[0,1] op_sel_hi:[1,1]
    v_pk_mul_f32 v[240:241], v[240:241], v[114:115] op_sel:[0,1] op_sel_hi:[1,1]
    v_pk_mul_f32 v[242:243], v[242:243], v[114:115] op_sel:[0,1] op_sel_hi:[1,1]
    v_mfma_f32_16x16x32_bf16 v[120:123], a[140:143], v[64:67], 0
    v_cvt_pk_bf16_f32 v84, v212, v213
    v_cvt_pk_bf16_f32 v85, v214, v215
    v_cvt_pk_bf16_f32 v86, v216, v217
    v_cvt_pk_bf16_f32 v87, v218, v219
    v_mfma_f32_16x16x32_bf16 v[120:123], a[136:139], v[60:63], v[120:123]
    v_cvt_pk_bf16_f32 v88, v220, v221
    v_cvt_pk_bf16_f32 v89, v222, v223
    v_cvt_pk_bf16_f32 v90, v224, v225
    v_cvt_pk_bf16_f32 v91, v226, v227
    v_mfma_f32_16x16x32_bf16 v[120:123], a[132:135], v[56:59], v[120:123]
    v_cvt_pk_bf16_f32 v92, v228, v229
    v_cvt_pk_bf16_f32 v93, v230, v231
    v_cvt_pk_bf16_f32 v94, v232, v233
    v_cvt_pk_bf16_f32 v95, v234, v235
    v_mfma_f32_16x16x32_bf16 v[120:123], a[128:131], v[52:55], v[120:123]
    v_cvt_pk_bf16_f32 v96, v236, v237
    v_cvt_pk_bf16_f32 v97, v238, v239
    v_cvt_pk_bf16_f32 v98, v240, v241
    v_cvt_pk_bf16_f32 v99, v242, v243
    v_mfma_f32_16x16x32_bf16 v[136:139], a[156:159], v[64:67], 0
    v_permlane32_swap_b32 v84, v86
    v_permlane32_swap_b32 v85, v87
    v_permlane32_swap_b32 v88, v90
    v_permlane32_swap_b32 v89, v91
    v_mfma_f32_16x16x32_bf16 v[136:139], a[152:155], v[60:63], v[136:139]
    v_permlane32_swap_b32 v92, v94
    v_permlane32_swap_b32 v93, v95
    v_permlane32_swap_b32 v96, v98
    v_permlane32_swap_b32 v97, v99
    v_mfma_f32_16x16x32_bf16 v[136:139], a[148:151], v[56:59], v[136:139]
    v_permlane16_swap_b32 v84, v86
    v_permlane16_swap_b32 v85, v87
    v_permlane16_swap_b32 v88, v90
    v_permlane16_swap_b32 v89, v91
    v_mfma_f32_16x16x32_bf16 v[136:139], a[144:147], v[52:55], v[136:139]
    v_permlane16_swap_b32 v92, v94
    v_permlane16_swap_b32 v93, v95
    v_permlane16_swap_b32 v96, v98
    v_permlane16_swap_b32 v97, v99
    v_mfma_f32_16x16x32_bf16 v[124:127], a[128:131], v[68:71], 0
    v_max3_f32 v28, v116, v117, v118
    v_max3_f32 v30, v120, v121, v122
    v_mfma_f32_16x16x32_bf16 v[124:127], a[132:135], v[72:75], v[124:127]
    v_max3_f32 v29, v119, v132, v133
    v_max3_f32 v31, v123, v136, v137
    v_max3_f32 v28, v28, v134, v135
    v_mfma_f32_16x16x32_bf16 v[124:127], a[136:139], v[76:79], v[124:127]
    v_max3_f32 v30, v30, v138, v139
    v_max_f32 v28, v28, v29
    v_max_f32 v30, v30, v31
    v_mfma_f32_16x16x32_bf16 v[124:127], a[140:143], v[80:83], v[124:127]
    v_mov_b32 v29, v28
    v_mov_b32 v31, v30
    s_nop 0
    v_permlane32_swap_b32 v28, v29
    v_mfma_f32_16x16x32_bf16 v[140:143], a[144:147], v[68:71], 0
    v_permlane32_swap_b32 v30, v31
    v_max_f32 v28, v28, v29
    v_mfma_f32_16x16x32_bf16 v[140:143], a[148:151], v[72:75], v[140:143]
    v_max_f32 v30, v30, v31
    v_mov_b32 v29, v28
    v_mov_b32 v31, v30
    v_mfma_f32_16x16x32_bf16 v[140:143], a[152:155], v[76:79], v[140:143]
    v_permlane16_swap_b32 v28, v29
    v_permlane16_swap_b32 v30, v31
    v_max_f32 v28, v28, v29
    v_mfma_f32_16x16x32_bf16 v[140:143], a[156:159], v[80:83], v[140:143]
    v_max_f32 v30, v30, v31
    v_sub_f32 v100, 0, v28
    v_sub_f32 v104, 0, v30
    v_mfma_f32_16x16x32_bf16 v[128:131], a[140:143], v[96:99], 0
    v_sub_f32 v101, 0, v28
    v_sub_f32 v105, 0, v30
    v_mfma_f32_16x16x32_bf16 v[128:131], a[136:139], v[92:95], v[128:131]
    v_sub_f32 v102, 0, v28
    v_sub_f32 v106, 0, v30
    v_sub_f32 v103, 0, v28
    v_mfma_f32_16x16x32_bf16 v[128:131], a[132:135], v[88:91], v[128:131]
    v_sub_f32 v107, 0, v30
    v_sub_f32 v116, v116, v28
    v_sub_f32 v120, v120, v30
    v_mfma_f32_16x16x32_bf16 v[128:131], a[128:131], v[84:87], v[128:131]
    v_sub_f32 v117, v117, v28
    v_sub_f32 v121, v121, v30
    v_sub_f32 v118, v118, v28
    v_mfma_f32_16x16x32_bf16 v[144:147], a[156:159], v[96:99], 0
    v_sub_f32 v122, v122, v30
    v_sub_f32 v119, v119, v28
    v_mfma_f32_16x16x32_bf16 v[144:147], a[152:155], v[92:95], v[144:147]
    v_sub_f32 v123, v123, v30
    v_sub_f32 v132, v132, v28
    v_sub_f32 v136, v136, v30
    v_mfma_f32_16x16x32_bf16 v[144:147], a[148:151], v[88:91], v[144:147]
    v_sub_f32 v133, v133, v28
    v_sub_f32 v137, v137, v30
    v_sub_f32 v134, v134, v28
    v_mfma_f32_16x16x32_bf16 v[144:147], a[144:147], v[84:87], v[144:147]
    v_sub_f32 v138, v138, v30
    v_sub_f32 v135, v135, v28
    v_sub_f32 v139, v139, v30
    s_waitcnt vmcnt(14)
    s_barrier
    v_mfma_f32_16x16x32_bf16 v[148:151], a[160:163], v[36:39], v[100:103]
    s_add_u32 m0, s34, 0
    s_nop 0
    s_nop 0
    s_nop 0
    v_mfma_f32_16x16x32_bf16 v[148:151], a[164:167], v[40:43], v[148:151]
    ds_read_b128 a[128:131], v1 offset:16384
    s_nop 0
    v_max3_f32 v32, v124, v125, v126
    v_max3_f32 v34, v128, v129, v130
    v_mfma_f32_16x16x32_bf16 v[148:151], a[168:171], v[44:47], v[148:151]
    ds_read_b128 a[132:135], v2 offset:16384
    v_max3_f32 v33, v127, v140, v141
    v_max3_f32 v35, v131, v144, v145
    v_max3_f32 v32, v32, v142, v143
    v_mfma_f32_16x16x32_bf16 v[148:151], a[172:175], v[48:51], v[148:151]
    buffer_load_dwordx4 v13, s[8:11], s28 offen offset:0 lds
    v_max3_f32 v34, v34, v146, v147
    v_max_f32 v32, v32, v33
    v_max_f32 v34, v34, v35
    v_mfma_f32_16x16x32_bf16 v[152:155], a[172:175], v[64:67], v[104:107]
    v_mov_b32 v33, v32
    v_mov_b32 v35, v34
    s_nop 0
    v_permlane32_swap_b32 v32, v33
    v_mfma_f32_16x16x32_bf16 v[152:155], a[168:171], v[60:63], v[152:155]
    v_permlane32_swap_b32 v34, v35
    v_max_f32 v32, v32, v33
    v_max_f32 v34, v34, v35
    v_mfma_f32_16x16x32_bf16 v[152:155], a[164:167], v[56:59], v[152:155]
    v_mov_b32 v33, v32
    v_mov_b32 v35, v34
    s_nop 0
    v_permlane16_swap_b32 v32, v33
    v_mfma_f32_16x16x32_bf16 v[152:155], a[160:163], v[52:55], v[152:155]
    v_permlane16_swap_b32 v34, v35
    v_max_f32 v32, v32, v33
    v_max_f32 v34, v34, v35
    v_mfma_f32_16x16x32_bf16 v[164:167], a[176:179], v[36:39], v[100:103]
    v_sub_f32 v108, 0, v32
    v_sub_f32 v112, 0, v34
    v_sub_f32 v109, 0, v32
    v_mfma_f32_16x16x32_bf16 v[164:167], a[180:183], v[40:43], v[164:167]
    v_sub_f32 v113, 0, v34
    v_sub_f32 v110, 0, v32
    v_sub_f32 v114, 0, v34
    v_mfma_f32_16x16x32_bf16 v[164:167], a[184:187], v[44:47], v[164:167]
    v_sub_f32 v111, 0, v32
    v_sub_f32 v115, 0, v34
    v_sub_f32 v124, v124, v32
    v_mfma_f32_16x16x32_bf16 v[164:167], a[188:191], v[48:51], v[164:167]
    v_sub_f32 v128, v128, v34
    v_sub_f32 v125, v125, v32
    v_sub_f32 v129, v129, v34
    v_mfma_f32_16x16x32_bf16 v[168:171], a[188:191], v[64:67], v[104:107]
    v_sub_f32 v126, v126, v32
    v_sub_f32 v130, v130, v34
    v_sub_f32 v127, v127, v32
    v_mfma_f32_16x16x32_bf16 v[168:171], a[184:187], v[60:63], v[168:171]
    v_sub_f32 v131, v131, v34
    v_sub_f32 v140, v140, v32
    v_sub_f32 v144, v144, v34
    v_mfma_f32_16x16x32_bf16 v[168:171], a[180:183], v[56:59], v[168:171]
    v_sub_f32 v141, v141, v32
    v_sub_f32 v145, v145, v34
    v_sub_f32 v142, v142, v32
    v_mfma_f32_16x16x32_bf16 v[168:171], a[176:179], v[52:55], v[168:171]
    v_sub_f32 v146, v146, v34
    v_sub_f32 v143, v143, v32
    v_sub_f32 v147, v147, v34
    s_nop 0
    v_mfma_f32_16x16x32_bf16 v[156:159], a[160:163], v[68:71], v[108:111]
    ds_read_b128 a[136:139], v3 offset:16384
    v_mfma_f32_16x16x32_bf16 v[156:159], a[164:167], v[72:75], v[156:159]
    ds_read_b128 a[140:143], v4 offset:16384
    v_mfma_f32_16x16x32_bf16 v[156:159], a[168:171], v[76:79], v[156:159]
    buffer_load_dwordx4 v14, s[8:11], s28 offen offset:1024 lds
    v_mfma_f32_16x16x32_bf16 v[156:159], a[172:175], v[80:83], v[156:159]
    v_mfma_f32_16x16x32_bf16 v[160:163], a[172:175], v[96:99], v[112:115]
    v_mfma_f32_16x16x32_bf16 v[160:163], a[168:171], v[92:95], v[160:163]
    v_mfma_f32_16x16x32_bf16 v[160:163], a[164:167], v[88:91], v[160:163]
    v_mfma_f32_16x16x32_bf16 v[160:163], a[160:163], v[84:87], v[160:163]
    s_waitcnt lgkmcnt(2)
    v_mfma_f32_16x16x32_bf16 v[172:175], a[176:179], v[68:71], v[108:111]
    s_waitcnt vmcnt(7)
    ds_read_b128 a[144:147], v1 offset:20480
    v_exp_f32 v116, v116
    v_mfma_f32_16x16x32_bf16 v[172:175], a[180:183], v[72:75], v[172:175]
    ds_read_b128 a[148:151], v2 offset:20480
    v_exp_f32 v117, v117
    v_mfma_f32_16x16x32_bf16 v[172:175], a[184:187], v[76:79], v[172:175]
    v_cvt_pk_bf16_f32 v180, v116, v117
    v_exp_f32 v118, v118
    v_mfma_f32_16x16x32_bf16 v[172:175], a[188:191], v[80:83], v[172:175]
    v_exp_f32 v119, v119
    v_mfma_f32_16x16x32_bf16 v[176:179], a[188:191], v[96:99], v[112:115]
    v_cvt_pk_bf16_f32 v181, v118, v119
    v_exp_f32 v120, v120
    v_mfma_f32_16x16x32_bf16 v[176:179], a[184:187], v[92:95], v[176:179]
    v_exp_f32 v121, v121
    v_mfma_f32_16x16x32_bf16 v[176:179], a[180:183], v[88:91], v[176:179]
    buffer_load_dwordx4 v15, s[8:11], s28 offen offset:2048 lds
    v_cvt_pk_bf16_f32 v188, v120, v121
    v_exp_f32 v122, v122
    v_mfma_f32_16x16x32_bf16 v[176:179], a[176:179], v[84:87], v[176:179]
    s_waitcnt lgkmcnt(2)
    v_exp_f32 v123, v123
    v_mfma_f32_16x16x32_bf16 v[116:119], a[128:131], v[36:39], v[100:103]
    ds_read_b128 a[152:155], v3 offset:20480
    v_cvt_pk_bf16_f32 v189, v122, v123
    v_exp_f32 v124, v124
    v_mfma_f32_16x16x32_bf16 v[116:119], a[132:135], v[40:43], v[116:119]
    ds_read_b128 a[156:159], v4 offset:20480
    v_exp_f32 v125, v125
    v_mfma_f32_16x16x32_bf16 v[116:119], a[136:139], v[44:47], v[116:119]
    v_cvt_pk_bf16_f32 v196, v124, v125
    v_exp_f32 v126, v126
    v_cmp_gt_u32 vcc, 32, v252
    s_and_b64 vcc, vcc, exec
    s_cbranch_scc1 L_spin_all
L_back_all:
    v_mfma_f32_16x16x32_bf16 v[116:119], a[140:143], v[48:51], v[116:119]
    s_cmp_eq_u32 s6, 255
    s_cbranch_scc1 L_rt_keys
L_rt_back_keys:
    v_exp_f32 v127, v127
    v_mfma_f32_16x16x32_bf16 v[120:123], a[140:143], v[64:67], v[104:107]
    v_cvt_pk_bf16_f32 v197, v126, v127
    v_exp_f32 v128, v128
    v_mfma_f32_16x16x32_bf16 v[120:123], a[136:139], v[60:63], v[120:123]
    v_exp_f32 v129, v129
    v_mfma_f32_16x16x32_bf16 v[120:123], a[132:135], v[56:59], v[120:123]
    buffer_load_dwordx4 v16, s[8:11], s28 offen offset:3072 lds
    v_cvt_pk_bf16_f32 v204, v128, v129
    v_exp_f32 v130, v130
    v_mfma_f32_16x16x32_bf16 v[120:123], a[128:131], v[52:55], v[120:123]
    s_waitcnt lgkmcnt(2)
    v_exp_f32 v131, v131
    v_mfma_f32_16x16x32_bf16 v[124:127], a[128:131], v[68:71], v[108:111]
    ds_read_b128 a[160:163], v1 offset:24576
    v_cvt_pk_bf16_f32 v205, v130, v131
    v_exp_f32 v132, v132
    v_mfma_f32_16x16x32_bf16 v[124:127], a[132:135], v[72:75], v[124:127]
    ds_read_b128 a[164:167], v2 offset:24576
    v_exp_f32 v133, v133
    v_mfma_f32_16x16x32_bf16 v[124:127], a[136:139], v[76:79], v[124:127]
    v_cvt_pk_bf16_f32 v182, v132, v133
    v_exp_f32 v134, v134
    v_mfma_f32_16x16x32_bf16 v[124:127], a[140:143], v[80:83], v[124:127]
    v_exp_f32 v135, v135
    v_mfma_f32_16x16x32_bf16 v[128:131], a[140:143], v[96:99], v[112:115]
    v_cvt_pk_bf16_f32 v183, v134, v135
    v_exp_f32 v136, v136
    v_mfma_f32_16x16x32_bf16 v[128:131], a[136:139], v[92:95], v[128:131]
    s_add_u32 s28, s28, 16384
    s_mov_b32 m0, s31
    v_exp_f32 v137, v137
    v_mfma_f32_16x16x32_bf16 v[128:131], a[132:135], v[88:91], v[128:131]
    buffer_load_dwordx4 v17, s[12:15], s29 offen offset:0 lds
    v_cvt_pk_bf16_f32 v190, v136, v137
    v_exp_f32 v138, v138
    v_mfma_f32_16x16x32_bf16 v[128:131], a[128:131], v[84:87], v[128:131]
    s_waitcnt lgkmcnt(2)
    v_exp_f32 v139, v139
    v_mfma_f32_16x16x32_bf16 v[132:135], a[144:147], v[36:39], v[100:103]
    ds_read_b128 a[168:171], v3 offset:24576
    v_cvt_pk_bf16_f32 v191, v138, v139
    v_exp_f32 v140, v140
    v_mfma_f32_16x16x32_bf16 v[132:135], a[148:151], v[40:43], v[132:135]
    ds_read_b128 a[172:175], v4 offset:24576
    v_exp_f32 v141, v141
    v_mfma_f32_16x16x32_bf16 v[132:135], a[152:155], v[44:47], v[132:135]
    v_cvt_pk_bf16_f32 v198, v140, v141
    v_exp_f32 v142, v142
    v_mfma_f32_16x16x32_bf16 v[132:135], a[156:159], v[48:51], v[132:135]
    v_exp_f32 v143, v143
    v_mfma_f32_16x16x32_bf16 v[136:139], a[156:159], v[64:67], v[104:107]
    v_cvt_pk_bf16_f32 v199, v142, v143
    v_exp_f32 v144, v144
    v_mfma_f32_16x16x32_bf16 v[136:139], a[152:155], v[60:63], v[136:139]
    v_exp_f32 v145, v145
    v_mfma_f32_16x16x32_bf16 v[136:139], a[148:151], v[56:59], v[136:139]
    buffer_load_dwordx4 v18, s[12:15], s29 offen offset:1024 lds
    v_cvt_pk_bf16_f32 v206, v144, v145
    v_exp_f32 v146, v146
    v_mfma_f32_16x16x32_bf16 v[136:139], a[144:147], v[52:55], v[136:139]
    s_waitcnt lgkmcnt(2)
    v_exp_f32 v147, v147
    v_mfma_f32_16x16x32_bf16 v[140:143], a[144:147], v[68:71], v[108:111]
    ds_read_b128 a[176:179], v1 offset:28672
    v_cvt_pk_bf16_f32 v207, v146, v147
    v_exp_f32 v148, v148
    v_mfma_f32_16x16x32_bf16 v[140:143], a[148:151], v[72:75], v[140:143]
    ds_read_b128 a[180:183], v2 offset:28672
    v_exp_f32 v149, v149
    v_mfma_f32_16x16x32_bf16 v[140:143], a[152:155], v[76:79], v[140:143]
    v_cvt_pk_bf16_f32 v184, v148, v149
    v_exp_f32 v150, v150
    v_mfma_f32_16x16x32_bf16 v[140:143], a[156:159], v[80:83], v[140:143]
    v_exp_f32 v151, v151
    v_mfma_f32_16x16x32_bf16 v[144:147], a[156:159], v[96:99], v[112:115]
    v_cvt_pk_bf16_f32 v185, v150, v151
    v_exp_f32 v152, v152
    v_mfma_f32_16x16x32_bf16 v[144:147], a[152:155], v[92:95], v[144:147]
    v_exp_f32 v153, v153
    v_mfma_f32_16x16x32_bf16 v[144:147], a[148:151], v[88:91], v[144:147]
    buffer_load_dwordx4 v17, s[12:15], s29 offen offset:2048 lds
    v_cvt_pk_bf16_f32 v192, v152, v153
    v_exp_f32 v154, v154
    v_mfma_f32_16x16x32_bf16 v[144:147], a[144:147], v[84:87], v[144:147]
    s_waitcnt lgkmcnt(2)
    v_exp_f32 v155, v155
    v_mfma_f32_16x16x32_bf16 v[148:151], a[160:163], v[36:39], v[100:103]
    ds_read_b128 a[184:187], v3 offset:28672
    v_cvt_pk_bf16_f32 v193, v154, v155
    v_exp_f32 v156, v156
    v_mfma_f32_16x16x32_bf16 v[148:151], a[164:167], v[40:43], v[148:151]
    ds_read_b128 a[188:191], v4 offset:28672
    v_exp_f32 v157, v157
    v_mfma_f32_16x16x32_bf16 v[148:151], a[168:171], v[44:47], v[148:151]
    v_cvt_pk_bf16_f32 v200, v156, v157
    v_exp_f32 v158, v158
    v_mfma_f32_16x16x32_bf16 v[148:151], a[172:175], v[48:51], v[148:151]
    v_exp_f32 v159, v159
    v_mfma_f32_16x16x32_bf16 v[152:155], a[172:175], v[64:67], v[104:107]
    v_cvt_pk_bf16_f32 v201, v158, v159
    v_exp_f32 v160, v160
    v_mfma_f32_16x16x32_bf16 v[152:155], a[168:171], v[60:63], v[152:155]
    v_exp_f32 v161, v161
    v_mfma_f32_16x16x32_bf16 v[152:155], a[164:167], v[56:59], v[152:155]
    buffer_load_dwordx4 v18, s[12:15], s29 offen offset:3072 lds
    v_cvt_pk_bf16_f32 v208, v160, v161
    v_exp_f32 v162, v162
    v_mfma_f32_16x16x32_bf16 v[152:155], a[160:163], v[52:55], v[152:155]
    s_waitcnt vmcnt(14) lgkmcnt(2)
    s_barrier
    s_add_u32 s29, s29, 16384
    v_exp_f32 v163, v163
    v_mfma_f32_16x16x32_bf16 v[156:159], a[160:163], v[68:71], v[108:111]
    s_waitcnt vmcnt(8)
    ds_read_b64_tr_b16 a[192:193], v5 offset:8192
    v_cvt_pk_bf16_f32 v209, v162, v163
    v_exp_f32 v164, v164
    v_mfma_f32_16x16x32_bf16 v[156:159], a[164:167], v[72:75], v[156:159]
    ds_read_b64_tr_b16 a[194:195], v5 offset:12288
    v_exp_f32 v165, v165
    v_mfma_f32_16x16x32_bf16 v[156:159], a[168:171], v[76:79], v[156:159]
    ds_read_b128 a[128:131], v1 offset:32768
    ds_read_b64_tr_b16 a[240:241], v25 offset:0
    v_cvt_pk_bf16_f32 v186, v164, v165
    v_exp_f32 v166, v166
    v_mfma_f32_16x16x32_bf16 v[156:159], a[172:175], v[80:83], v[156:159]
    ds_read_b64_tr_b16 a[196:197], v5 offset:32768
    v_exp_f32 v167, v167
    v_mfma_f32_16x16x32_bf16 v[160:163], a[172:175], v[96:99], v[112:115]
    ds_read_b64_tr_b16 a[198:199], v5 offset:36864
    ds_read_b64_tr_b16 a[242:243], v25 offset:2560
    v_cvt_pk_bf16_f32 v187, v166, v167
    v_exp_f32 v168, v168
    v_mfma_f32_16x16x32_bf16 v[160:163], a[168:171], v[92:95], v[160:163]
    s_add_u32 m0, s34, 49152
    ds_read_b128 a[132:135], v2 offset:32768
    ds_read_b64_tr_b16 a[244:245], v25 offset:32
    v_exp_f32 v169, v169
    v_mfma_f32_16x16x32_bf16 v[160:163], a[164:167], v[88:91], v[160:163]
    buffer_load_dwordx4 v13, s[8:11], s28 offen offset:0 lds
    v_cvt_pk_bf16_f32 v194, v168, v169
    v_exp_f32 v170, v170
    v_mfma_f32_16x16x32_bf16 v[160:163], a[160:163], v[84:87], v[160:163]
    s_waitcnt lgkmcnt(6)
    ds_read_b64_tr_b16 a[246:247], v25 offset:2592
    v_exp_f32 v171, v171
    v_mfma_f32_16x16x32_bf16 v[164:167], a[176:179], v[36:39], v[100:103]
    ds_read_b64_tr_b16 a[200:201], v6 offset:8192
    ds_read_b64_tr_b16 a[248:249], v25 offset:64
    v_cvt_pk_bf16_f32 v195, v170, v171
    v_exp_f32 v172, v172
    v_mfma_f32_16x16x32_bf16 v[164:167], a[180:183], v[40:43], v[164:167]
    ds_read_b64_tr_b16 a[202:203], v6 offset:12288
    v_exp_f32 v173, v173
    v_mfma_f32_16x16x32_bf16 v[164:167], a[184:187], v[44:47], v[164:167]
    ds_read_b128 a[136:139], v3 offset:32768
    ds_read_b64_tr_b16 a[250:251], v25 offset:2624
    v_cvt_pk_bf16_f32 v202, v172, v173
    v_exp_f32 v174, v174
    v_mfma_f32_16x16x32_bf16 v[164:167], a[188:191], v[48:51], v[164:167]
    ds_read_b64_tr_b16 a[204:205], v6 offset:32768
    ds_read_b64_tr_b16 a[252:253], v25 offset:96
    v_exp_f32 v175, v175
    v_mfma_f32_16x16x32_bf16 v[168:171], a[188:191], v[64:67], v[104:107]
    ds_read_b64_tr_b16 a[206:207], v6 offset:36864
    v_cvt_pk_bf16_f32 v203, v174, v175
    v_exp_f32 v176, v176
    v_mfma_f32_16x16x32_bf16 v[168:171], a[184:187], v[60:63], v[168:171]
    ds_read_b128 a[140:143], v4 offset:32768
    ds_read_b64_tr_b16 a[254:255], v25 offset:2656
    v_exp_f32 v177, v177
    v_mfma_f32_16x16x32_bf16 v[168:171], a[180:183], v[56:59], v[168:171]
    buffer_load_dwordx4 v14, s[8:11], s28 offen offset:1024 lds
    ds_read_b64_tr_b16 v[252:253], v25 offset:128
    v_cvt_pk_bf16_f32 v210, v176, v177
    v_exp_f32 v178, v178
    v_mfma_f32_16x16x32_bf16 v[168:171], a[176:179], v[52:55], v[168:171]
    s_waitcnt lgkmcnt(6)
    ds_read_b64_tr_b16 v[254:255], v25 offset:2688
    v_exp_f32 v179, v179
    v_mfma_f32_16x16x32_bf16 v[172:175], a[176:179], v[68:71], v[108:111]
    s_mov_b32 s16, s62
    v_exp_f32 v116, v116
    v_mfma_f32_16x16x32_bf16 v[172:175], a[180:183], v[72:75], v[172:175]
    s_mov_b32 s17, s63
    ds_read_b64_tr_b16 a[208:209], v7 offset:8192
    v_cvt_pk_bf16_f32 v211, v178, v179
    v_mfma_f32_16x16x32_bf16 v[172:175], a[184:187], v[76:79], v[172:175]
    s_mov_b32 s18, 0x21c000
    v_exp_f32 v117, v117
    v_mfma_f32_16x16x32_bf16 v[172:175], a[188:191], v[80:83], v[172:175]
    s_mov_b32 s19, 0x20000
    ds_read_b64_tr_b16 a[210:211], v7 offset:12288
    v_mfma_f32_16x16x32_bf16 v[176:179], a[188:191], v[96:99], v[112:115]
    s_mov_b32 s20, s64
    v_exp_f32 v118, v118
    v_mfma_f32_16x16x32_bf16 v[176:179], a[184:187], v[92:95], v[176:179]
    s_mov_b32 s21, s65
    ds_read_b128 a[144:147], v1 offset:36864
    v_cvt_pk_bf16_f32 v212, v116, v117
    v_mfma_f32_16x16x32_bf16 v[176:179], a[180:183], v[88:91], v[176:179]
    s_mov_b32 s22, 0x21c000
    v_exp_f32 v119, v119
    v_mfma_f32_16x16x32_bf16 v[176:179], a[176:179], v[84:87], v[176:179]
    s_mov_b32 s23, 0x20000
    ds_read_b64_tr_b16 a[212:213], v7 offset:32768
    v_mfma_f32_16x16x32_bf16 a[0:3], a[192:195], v[180:183], 0
    s_mov_b32 s96, s66
    v_exp_f32 v120, v120
    v_mfma_f32_16x16x32_bf16 a[0:3], a[196:199], v[184:187], a[0:3]
    s_mov_b32 s97, s67
    ds_read_b64_tr_b16 a[214:215], v7 offset:36864
    v_cvt_pk_bf16_f32 v213, v118, v119
    v_mfma_f32_16x16x32_bf16 a[4:7], a[196:199], v[192:195], 0
    s_mov_b32 s98, 0x21c000
    v_exp_f32 v121, v121
    v_mfma_f32_16x16x32_bf16 a[4:7], a[192:195], v[188:191], a[4:7]
    s_mov_b32 s99, 0x20000
    ds_read_b128 a[148:151], v2 offset:36864
    v_cvt_pk_bf16_f32 v220, v120, v121
    v_mfma_f32_16x16x32_bf16 a[8:11], a[192:195], v[196:199], 0
    v_exp_f32 v122, v122
    v_mfma_f32_16x16x32_bf16 a[8:11], a[196:199], v[200:203], a[8:11]
    buffer_load_dwordx4 v15, s[8:11], s28 offen offset:2048 lds
    v_mfma_f32_16x16x32_bf16 a[12:15], a[196:199], v[208:211], 0
    v_exp_f32 v123, v123
    v_mfma_f32_16x16x32_bf16 a[12:15], a[192:195], v[204:207], a[12:15]
    s_waitcnt lgkmcnt(6)
    v_mul_u32_u24 v24, 3456, v19
    v_mfma_f32_16x16x32_bf16 v[116:119], a[128:131], v[36:39], v[100:103]
    s_lshl_b32 s40, s6, 4
    v_exp_f32 v124, v124
    v_mfma_f32_16x16x32_bf16 v[116:119], a[132:135], v[40:43], v[116:119]
    ds_read_b64_tr_b16 a[216:217], v8 offset:8192
    v_cvt_pk_bf16_f32 v221, v122, v123
    v_mfma_f32_16x16x32_bf16 v[116:119], a[136:139], v[44:47], v[116:119]
    v_exp_f32 v125, v125
    v_mfma_f32_16x16x32_bf16 v[116:119], a[140:143], v[48:51], v[116:119]
    ds_read_b64_tr_b16 a[218:219], v8 offset:12288
    v_add_u32 v24, s40, v24
    v_mfma_f32_16x16x32_bf16 v[120:123], a[140:143], v[64:67], v[104:107]
    s_cmp_ge_u32 s5, 2
    s_cselect_b32 s16, s20, s16
    s_cselect_b32 s17, s21, s17
    v_exp_f32 v126, v126
    v_mfma_f32_16x16x32_bf16 v[120:123], a[136:139], v[60:63], v[120:123]
    s_cmp_ge_u32 s6, 216
    s_cselect_b32 s18, 0, s18
    ds_read_b128 a[152:155], v3 offset:36864
    v_cvt_pk_bf16_f32 v228, v124, v125
    v_mfma_f32_16x16x32_bf16 v[120:123], a[132:135], v[56:59], v[120:123]
    s_and_b32 s40, s5, 1
    v_exp_f32 v127, v127
    v_mfma_f32_16x16x32_bf16 v[120:123], a[128:131], v[52:55], v[120:123]
    s_mul_i32 s37, s40, 1105920
    ds_read_b64_tr_b16 a[220:221], v8 offset:32768
    v_mfma_f32_16x16x32_bf16 a[16:19], a[200:203], v[180:183], 0
    s_mul_i32 s38, s5, 5120
    v_exp_f32 v128, v128
    v_mfma_f32_16x16x32_bf16 a[16:19], a[204:207], v[184:187], a[16:19]
    s_add_u32 s38, s38, 65536
    ds_read_b64_tr_b16 a[222:223], v8 offset:36864
    v_cvt_pk_bf16_f32 v229, v126, v127
    v_mfma_f32_16x16x32_bf16 a[20:23], a[204:207], v[192:195], 0
    s_mov_b32 s36, 4
    buffer_store_dwordx4 a[240:243], v26, s[76:79], 0 offen offset:0 sc1
    v_exp_f32 v129, v129
    v_mfma_f32_16x16x32_bf16 a[20:23], a[200:203], v[188:191], a[20:23]
    ds_read_b128 a[156:159], v4 offset:36864
    v_mfma_f32_16x16x32_bf16 a[24:27], a[200:203], v[196:199], 0
    v_exp_f32 v130, v130
    v_mfma_f32_16x16x32_bf16 a[24:27], a[204:207], v[200:203], a[24:27]
    v_cvt_pk_bf16_f32 v236, v128, v129
    v_mfma_f32_16x16x32_bf16 a[28:31], a[204:207], v[208:211], 0
    v_exp_f32 v131, v131
    v_mfma_f32_16x16x32_bf16 a[28:31], a[200:203], v[204:207], a[28:31]
    buffer_load_dwordx4 v16, s[8:11], s28 offen offset:3072 lds
    v_smfmac_f32_16x16x64_bf16 a[224:227], v[244:247], v[180:187], v248
    s_waitcnt lgkmcnt(6)
    buffer_store_dwordx4 a[244:247], v26, s[76:79], 0 offen offset:1024 sc1
    v_mfma_f32_16x16x32_bf16 v[124:127], a[128:131], v[68:71], v[108:111]
    v_exp_f32 v132, v132
    v_mfma_f32_16x16x32_bf16 v[124:127], a[132:135], v[72:75], v[124:127]
    ds_read_b64_tr_b16 a[192:193], v9 offset:8192
    v_cvt_pk_bf16_f32 v237, v130, v131
    v_mfma_f32_16x16x32_bf16 v[124:127], a[136:139], v[76:79], v[124:127]
    v_exp_f32 v133, v133
    v_mfma_f32_16x16x32_bf16 v[124:127], a[140:143], v[80:83], v[124:127]
    ds_read_b64_tr_b16 a[194:195], v9 offset:12288
    v_mfma_f32_16x16x32_bf16 v[128:131], a[140:143], v[96:99], v[112:115]
    v_exp_f32 v134, v134
    v_mfma_f32_16x16x32_bf16 v[128:131], a[136:139], v[92:95], v[128:131]
    ds_read_b128 a[160:163], v1 offset:40960
    v_cvt_pk_bf16_f32 v214, v132, v133
    v_mfma_f32_16x16x32_bf16 v[128:131], a[132:135], v[88:91], v[128:131]
    v_exp_f32 v135, v135
    v_mfma_f32_16x16x32_bf16 v[128:131], a[128:131], v[84:87], v[128:131]
    ds_read_b64_tr_b16 a[196:197], v9 offset:32768
    v_mfma_f32_16x16x32_bf16 a[32:35], a[208:211], v[180:183], 0
    v_exp_f32 v136, v136
    v_mfma_f32_16x16x32_bf16 a[32:35], a[212:215], v[184:187], a[32:35]
    ds_read_b64_tr_b16 a[198:199], v9 offset:36864
    v_cvt_pk_bf16_f32 v215, v134, v135
    v_mfma_f32_16x16x32_bf16 a[36:39], a[212:215], v[192:195], 0
    v_exp_f32 v137, v137
    v_mfma_f32_16x16x32_bf16 a[36:39], a[208:211], v[188:191], a[36:39]
    ds_read_b128 a[164:167], v2 offset:40960
    v_cvt_pk_bf16_f32 v222, v136, v137
    v_mfma_f32_16x16x32_bf16 a[40:43], a[208:211], v[196:199], 0
    s_add_u32 s28, s28, 16384
    s_mov_b32 m0, s32
    buffer_store_dwordx4 a[248:251], v26, s[76:79], 0 offen offset:2048 sc1
    v_exp_f32 v138, v138
    v_mfma_f32_16x16x32_bf16 a[40:43], a[212:215], v[200:203], a[40:43]
    buffer_load_dwordx4 v17, s[12:15], s29 offen offset:0 lds
    v_mfma_f32_16x16x32_bf16 a[44:47], a[212:215], v[208:211], 0
    v_exp_f32 v139, v139
    v_mfma_f32_16x16x32_bf16 a[44:47], a[208:211], v[204:207], a[44:47]
    s_waitcnt lgkmcnt(6)
    buffer_store_dwordx4 a[252:255], v26, s[76:79], 0 offen offset:3072 sc1
    v_mfma_f32_16x16x32_bf16 v[132:135], a[144:147], v[36:39], v[100:103]
    v_exp_f32 v140, v140
    v_mfma_f32_16x16x32_bf16 v[132:135], a[148:151], v[40:43], v[132:135]
    ds_read_b64_tr_b16 a[200:201], v10 offset:8192
    v_cvt_pk_bf16_f32 v223, v138, v139
    v_mfma_f32_16x16x32_bf16 v[132:135], a[152:155], v[44:47], v[132:135]
    v_exp_f32 v141, v141
    v_mfma_f32_16x16x32_bf16 v[132:135], a[156:159], v[48:51], v[132:135]
    ds_read_b64_tr_b16 a[202:203], v10 offset:12288
    v_mfma_f32_16x16x32_bf16 v[136:139], a[156:159], v[64:67], v[104:107]
    v_exp_f32 v142, v142
    v_mfma_f32_16x16x32_bf16 v[136:139], a[152:155], v[60:63], v[136:139]
    ds_read_b128 a[168:171], v3 offset:40960
    v_cvt_pk_bf16_f32 v230, v140, v141
    v_mfma_f32_16x16x32_bf16 v[136:139], a[148:151], v[56:59], v[136:139]
    v_exp_f32 v143, v143
    v_mfma_f32_16x16x32_bf16 v[136:139], a[144:147], v[52:55], v[136:139]
    ds_read_b64_tr_b16 a[204:205], v10 offset:32768
    v_mfma_f32_16x16x32_bf16 a[48:51], a[216:219], v[180:183], 0
    v_exp_f32 v144, v144
    v_mfma_f32_16x16x32_bf16 a[48:51], a[220:223], v[184:187], a[48:51]
    ds_read_b64_tr_b16 a[206:207], v10 offset:36864
    v_cvt_pk_bf16_f32 v231, v142, v143
    v_mfma_f32_16x16x32_bf16 a[52:55], a[220:223], v[192:195], 0
    v_exp_f32 v145, v145
    v_mfma_f32_16x16x32_bf16 a[52:55], a[216:219], v[188:191], a[52:55]
    ds_read_b128 a[172:175], v4 offset:40960
    v_mfma_f32_16x16x32_bf16 a[56:59], a[216:219], v[196:199], 0
    v_exp_f32 v146, v146
    v_mfma_f32_16x16x32_bf16 a[56:59], a[220:223], v[200:203], a[56:59]
    v_cvt_pk_bf16_f32 v238, v144, v145
    v_mfma_f32_16x16x32_bf16 a[60:63], a[220:223], v[208:211], 0
    v_exp_f32 v147, v147
    v_mfma_f32_16x16x32_bf16 a[60:63], a[216:219], v[204:207], a[60:63]
    buffer_load_dwordx4 v18, s[12:15], s29 offen offset:1024 lds
    v_smfmac_f32_16x16x64_bf16 a[228:231], v[244:247], v[188:195], v248
    s_waitcnt lgkmcnt(6)
    buffer_store_dwordx4 v[252:255], v26, s[76:79], s45 offen offset:0 sc1
    v_mfma_f32_16x16x32_bf16 v[140:143], a[144:147], v[68:71], v[108:111]
    s_cmp_eq_u32 s6, 255
    s_cbranch_scc1 L_rt_local
L_rt_back_local:
    v_exp_f32 v148, v148
    v_mfma_f32_16x16x32_bf16 v[140:143], a[148:151], v[72:75], v[140:143]
    ds_read_b64_tr_b16 a[208:209], v11 offset:8192
    v_cvt_pk_bf16_f32 v239, v146, v147
    v_mfma_f32_16x16x32_bf16 v[140:143], a[152:155], v[76:79], v[140:143]
    v_exp_f32 v149, v149
    v_mfma_f32_16x16x32_bf16 v[140:143], a[156:159], v[80:83], v[140:143]
    ds_read_b64_tr_b16 a[210:211], v11 offset:12288
    v_mfma_f32_16x16x32_bf16 v[144:147], a[156:159], v[96:99], v[112:115]
    v_exp_f32 v150, v150
    v_mfma_f32_16x16x32_bf16 v[144:147], a[152:155], v[92:95], v[144:147]
    ds_read_b128 a[176:179], v1 offset:45056
    v_cvt_pk_bf16_f32 v216, v148, v149
    v_mfma_f32_16x16x32_bf16 v[144:147], a[148:151], v[88:91], v[144:147]
    v_exp_f32 v151, v151
    v_mfma_f32_16x16x32_bf16 v[144:147], a[144:147], v[84:87], v[144:147]
    ds_read_b64_tr_b16 a[212:213], v11 offset:32768
    v_mfma_f32_16x16x32_bf16 a[64:67], a[192:195], v[180:183], 0
    v_exp_f32 v152, v152
    v_mfma_f32_16x16x32_bf16 a[64:67], a[196:199], v[184:187], a[64:67]
    ds_read_b64_tr_b16 a[214:215], v11 offset:36864
    v_cvt_pk_bf16_f32 v217, v150, v151
    v_mfma_f32_16x16x32_bf16 a[68:71], a[196:199], v[192:195], 0
    v_exp_f32 v153, v153
    v_mfma_f32_16x16x32_bf16 a[68:71], a[192:195], v[188:191], a[68:71]
    ds_read_b128 a[180:183], v2 offset:45056
    v_cvt_pk_bf16_f32 v224, v152, v153
    v_mfma_f32_16x16x32_bf16 a[72:75], a[192:195], v[196:199], 0
    v_exp_f32 v154, v154
    v_mfma_f32_16x16x32_bf16 a[72:75], a[196:199], v[200:203], a[72:75]
    buffer_load_dwordx4 v17, s[12:15], s29 offen offset:2048 lds
    v_mfma_f32_16x16x32_bf16 a[76:79], a[196:199], v[208:211], 0
    v_exp_f32 v155, v155
    v_mfma_f32_16x16x32_bf16 a[76:79], a[192:195], v[204:207], a[76:79]
    s_waitcnt lgkmcnt(6)
    v_mfma_f32_16x16x32_bf16 v[148:151], a[160:163], v[36:39], v[100:103]
    v_exp_f32 v156, v156
    v_mfma_f32_16x16x32_bf16 v[148:151], a[164:167], v[40:43], v[148:151]
    ds_read_b64_tr_b16 a[216:217], v12 offset:8192
    v_cvt_pk_bf16_f32 v225, v154, v155
    v_mfma_f32_16x16x32_bf16 v[148:151], a[168:171], v[44:47], v[148:151]
    v_exp_f32 v157, v157
    v_mfma_f32_16x16x32_bf16 v[148:151], a[172:175], v[48:51], v[148:151]
    ds_read_b64_tr_b16 a[218:219], v12 offset:12288
    v_mfma_f32_16x16x32_bf16 v[152:155], a[172:175], v[64:67], v[104:107]
    v_exp_f32 v158, v158
    v_mfma_f32_16x16x32_bf16 v[152:155], a[168:171], v[60:63], v[152:155]
    ds_read_b128 a[184:187], v3 offset:45056
    v_cvt_pk_bf16_f32 v232, v156, v157
    v_mfma_f32_16x16x32_bf16 v[152:155], a[164:167], v[56:59], v[152:155]
    v_exp_f32 v159, v159
    v_mfma_f32_16x16x32_bf16 v[152:155], a[160:163], v[52:55], v[152:155]
    ds_read_b64_tr_b16 a[220:221], v12 offset:32768
    v_mfma_f32_16x16x32_bf16 a[80:83], a[200:203], v[180:183], 0
    v_exp_f32 v160, v160
    v_mfma_f32_16x16x32_bf16 a[80:83], a[204:207], v[184:187], a[80:83]
    ds_read_b64_tr_b16 a[222:223], v12 offset:36864
    v_cvt_pk_bf16_f32 v233, v158, v159
    v_mfma_f32_16x16x32_bf16 a[84:87], a[204:207], v[192:195], 0
    v_exp_f32 v161, v161
    v_mfma_f32_16x16x32_bf16 a[84:87], a[200:203], v[188:191], a[84:87]
    ds_read_b128 a[188:191], v4 offset:45056
    v_mfma_f32_16x16x32_bf16 a[88:91], a[200:203], v[196:199], 0
    v_exp_f32 v162, v162
    v_mfma_f32_16x16x32_bf16 a[88:91], a[204:207], v[200:203], a[88:91]
    v_cvt_pk_bf16_f32 v240, v160, v161
    v_mfma_f32_16x16x32_bf16 a[92:95], a[204:207], v[208:211], 0
    v_exp_f32 v163, v163
    v_mfma_f32_16x16x32_bf16 a[92:95], a[200:203], v[204:207], a[92:95]
    buffer_load_dwordx4 v18, s[12:15], s29 offen offset:3072 lds
    v_smfmac_f32_16x16x64_bf16 a[232:235], v[244:247], v[196:203], v248
    s_waitcnt vmcnt(13) lgkmcnt(6)
    s_barrier
    s_add_u32 s29, s29, 16384
    v_mfma_f32_16x16x32_bf16 v[156:159], a[160:163], v[68:71], v[108:111]
    v_exp_f32 v164, v164
    v_mfma_f32_16x16x32_bf16 v[156:159], a[164:167], v[72:75], v[156:159]
    ds_read_b64_tr_b16 a[192:193], v5 offset:16384
    v_cvt_pk_bf16_f32 v241, v162, v163
    v_mfma_f32_16x16x32_bf16 v[156:159], a[168:171], v[76:79], v[156:159]
    v_exp_f32 v165, v165
    v_mfma_f32_16x16x32_bf16 v[156:159], a[172:175], v[80:83], v[156:159]
    ds_read_b64_tr_b16 a[194:195], v5 offset:20480
    v_mfma_f32_16x16x32_bf16 v[160:163], a[172:175], v[96:99], v[112:115]
    v_exp_f32 v166, v166
    v_mfma_f32_16x16x32_bf16 v[160:163], a[168:171], v[92:95], v[160:163]
    ds_read_b128 a[128:131], v1 offset:0
    v_cvt_pk_bf16_f32 v218, v164, v165
    v_mfma_f32_16x16x32_bf16 v[160:163], a[164:167], v[88:91], v[160:163]
    v_exp_f32 v167, v167
    v_mfma_f32_16x16x32_bf16 v[160:163], a[160:163], v[84:87], v[160:163]
    ds_read_b64_tr_b16 a[196:197], v5 offset:40960
    v_mfma_f32_16x16x32_bf16 a[96:99], a[208:211], v[180:183], 0
    v_exp_f32 v168, v168
    v_mfma_f32_16x16x32_bf16 a[96:99], a[212:215], v[184:187], a[96:99]
    ds_read_b64_tr_b16 a[198:199], v5 offset:45056
    v_cvt_pk_bf16_f32 v219, v166, v167
    v_mfma_f32_16x16x32_bf16 a[100:103], a[212:215], v[192:195], 0
    v_exp_f32 v169, v169
    v_mfma_f32_16x16x32_bf16 a[100:103], a[208:211], v[188:191], a[100:103]
    ds_read_b128 a[132:135], v2 offset:0
    v_cvt_pk_bf16_f32 v226, v168, v169
    v_mfma_f32_16x16x32_bf16 a[104:107], a[208:211], v[196:199], 0
    s_add_u32 m0, s34, 16384
    v_exp_f32 v170, v170
    v_mfma_f32_16x16x32_bf16 a[104:107], a[212:215], v[200:203], a[104:107]
    buffer_load_dwordx4 v13, s[8:11], s28 offen offset:0 lds
    v_mfma_f32_16x16x32_bf16 a[108:111], a[212:215], v[208:211], 0
    v_exp_f32 v171, v171
    v_mfma_f32_16x16x32_bf16 a[108:111], a[208:211], v[204:207], a[108:111]
    s_waitcnt lgkmcnt(6)
    v_mfma_f32_16x16x32_bf16 v[164:167], a[176:179], v[36:39], v[100:103]
    s_cmp_eq_u32 s6, 255
    s_cbranch_scc1 L_rt_merge
L_rt_back_merge:
    v_exp_f32 v172, v172
    v_mfma_f32_16x16x32_bf16 v[164:167], a[180:183], v[40:43], v[164:167]
    ds_read_b64_tr_b16 a[200:201], v6 offset:16384
    v_cvt_pk_bf16_f32 v227, v170, v171
    v_mfma_f32_16x16x32_bf16 v[164:167], a[184:187], v[44:47], v[164:167]
    v_exp_f32 v173, v173
    v_mfma_f32_16x16x32_bf16 v[164:167], a[188:191], v[48:51], v[164:167]
    ds_read_b64_tr_b16 a[202:203], v6 offset:20480
    v_mfma_f32_16x16x32_bf16 v[168:171], a[188:191], v[64:67], v[104:107]
    v_exp_f32 v174, v174
    v_mfma_f32_16x16x32_bf16 v[168:171], a[184:187], v[60:63], v[168:171]
    ds_read_b128 a[136:139], v3 offset:0
    v_cvt_pk_bf16_f32 v234, v172, v173
    v_mfma_f32_16x16x32_bf16 v[168:171], a[180:183], v[56:59], v[168:171]
    v_exp_f32 v175, v175
    v_mfma_f32_16x16x32_bf16 v[168:171], a[176:179], v[52:55], v[168:171]
    ds_read_b64_tr_b16 a[204:205], v6 offset:40960
    v_mfma_f32_16x16x32_bf16 a[112:115], a[216:219], v[180:183], 0
    v_exp_f32 v176, v176
    v_mfma_f32_16x16x32_bf16 a[112:115], a[220:223], v[184:187], a[112:115]
    ds_read_b64_tr_b16 a[206:207], v6 offset:45056
    v_cvt_pk_bf16_f32 v235, v174, v175
    v_mfma_f32_16x16x32_bf16 a[116:119], a[220:223], v[192:195], 0
    v_exp_f32 v177, v177
    v_mfma_f32_16x16x32_bf16 a[116:119], a[216:219], v[188:191], a[116:119]
    ds_read_b128 a[140:143], v4 offset:0
    v_mfma_f32_16x16x32_bf16 a[120:123], a[216:219], v[196:199], 0
    v_exp_f32 v178, v178
    v_mfma_f32_16x16x32_bf16 a[120:123], a[220:223], v[200:203], a[120:123]
    v_cvt_pk_bf16_f32 v242, v176, v177
    v_mfma_f32_16x16x32_bf16 a[124:127], a[220:223], v[208:211], 0
    v_exp_f32 v179, v179
    v_mfma_f32_16x16x32_bf16 a[124:127], a[216:219], v[204:207], a[124:127]
    buffer_load_dwordx4 v14, s[8:11], s28 offen offset:1024 lds
    v_smfmac_f32_16x16x64_bf16 a[236:239], v[244:247], v[204:211], v248
    s_waitcnt lgkmcnt(6)
    s_mov_b32 s35, 5
.p2align 6
L_attn_loop:
    v_mfma_f32_16x16x32_bf16 v[172:175], a[176:179], v[68:71], v[108:111]
    v_exp_f32 v116, v116
    v_mfma_f32_16x16x32_bf16 v[172:175], a[180:183], v[72:75], v[172:175]
    ds_read_b64_tr_b16 a[208:209], v7 offset:16384
    v_cvt_pk_bf16_f32 v243, v178, v179
    v_mfma_f32_16x16x32_bf16 v[172:175], a[184:187], v[76:79], v[172:175]
    v_exp_f32 v117, v117
    v_mfma_f32_16x16x32_bf16 v[172:175], a[188:191], v[80:83], v[172:175]
    ds_read_b64_tr_b16 a[210:211], v7 offset:20480
    v_mfma_f32_16x16x32_bf16 v[176:179], a[188:191], v[96:99], v[112:115]
    v_exp_f32 v118, v118
    v_mfma_f32_16x16x32_bf16 v[176:179], a[184:187], v[92:95], v[176:179]
    ds_read_b128 a[144:147], v1 offset:4096
    v_cvt_pk_bf16_f32 v180, v116, v117
    v_mfma_f32_16x16x32_bf16 v[176:179], a[180:183], v[88:91], v[176:179]
    v_exp_f32 v119, v119
    v_mfma_f32_16x16x32_bf16 v[176:179], a[176:179], v[84:87], v[176:179]
    ds_read_b64_tr_b16 a[212:213], v7 offset:40960
    v_mfma_f32_16x16x32_bf16 a[0:3], a[192:195], v[212:215], a[0:3]
    v_exp_f32 v120, v120
    v_mfma_f32_16x16x32_bf16 a[0:3], a[196:199], v[216:219], a[0:3]
    ds_read_b64_tr_b16 a[214:215], v7 offset:45056
    v_cvt_pk_bf16_f32 v181, v118, v119
    v_mfma_f32_16x16x32_bf16 a[4:7], a[196:199], v[224:227], a[4:7]
    v_exp_f32 v121, v121
    v_mfma_f32_16x16x32_bf16 a[4:7], a[192:195], v[220:223], a[4:7]
    ds_read_b128 a[148:151], v2 offset:4096
    v_cvt_pk_bf16_f32 v188, v120, v121
    v_mfma_f32_16x16x32_bf16 a[8:11], a[192:195], v[228:231], a[8:11]
    v_exp_f32 v122, v122
    v_mfma_f32_16x16x32_bf16 a[8:11], a[196:199], v[232:235], a[8:11]
    buffer_load_dwordx4 v15, s[8:11], s28 offen offset:2048 lds
    v_mfma_f32_16x16x32_bf16 a[12:15], a[196:199], v[240:243], a[12:15]
    v_exp_f32 v123, v123
    v_mfma_f32_16x16x32_bf16 a[12:15], a[192:195], v[236:239], a[12:15]
    s_waitcnt lgkmcnt(6)
    v_mfma_f32_16x16x32_bf16 v[116:119], a[128:131], v[36:39], v[100:103]
    v_exp_f32 v124, v124
    v_mfma_f32_16x16x32_bf16 v[116:119], a[132:135], v[40:43], v[116:119]
    ds_read_b64_tr_b16 a[216:217], v8 offset:16384
    v_cvt_pk_bf16_f32 v189, v122, v123
    v_mfma_f32_16x16x32_bf16 v[116:119], a[136:139], v[44:47], v[116:119]
    v_exp_f32 v125, v125
    v_mfma_f32_16x16x32_bf16 v[116:119], a[140:143], v[48:51], v[116:119]
    ds_read_b64_tr_b16 a[218:219], v8 offset:20480
    v_mfma_f32_16x16x32_bf16 v[120:123], a[140:143], v[64:67], v[104:107]
    v_exp_f32 v126, v126
    v_mfma_f32_16x16x32_bf16 v[120:123], a[136:139], v[60:63], v[120:123]
    ds_read_b128 a[152:155], v3 offset:4096
    v_cvt_pk_bf16_f32 v196, v124, v125
    v_mfma_f32_16x16x32_bf16 v[120:123], a[132:135], v[56:59], v[120:123]
    v_exp_f32 v127, v127
    v_mfma_f32_16x16x32_bf16 v[120:123], a[128:131], v[52:55], v[120:123]
    ds_read_b64_tr_b16 a[220:221], v8 offset:40960
    v_mfma_f32_16x16x32_bf16 a[16:19], a[200:203], v[212:215], a[16:19]
    v_exp_f32 v128, v128
    v_mfma_f32_16x16x32_bf16 a[16:19], a[204:207], v[216:219], a[16:19]
    ds_read_b64_tr_b16 a[222:223], v8 offset:45056
    v_cvt_pk_bf16_f32 v197, v126, v127
    v_mfma_f32_16x16x32_bf16 a[20:23], a[204:207], v[224:227], a[20:23]
    v_exp_f32 v129, v129
    v_mfma_f32_16x16x32_bf16 a[20:23], a[200:203], v[220:223], a[20:23]
    ds_read_b128 a[156:159], v4 offset:4096
    v_mfma_f32_16x16x32_bf16 a[24:27], a[200:203], v[228:231], a[24:27]
    v_exp_f32 v130, v130
    v_mfma_f32_16x16x32_bf16 a[24:27], a[204:207], v[232:235], a[24:27]
    v_cvt_pk_bf16_f32 v204, v128, v129
    v_mfma_f32_16x16x32_bf16 a[28:31], a[204:207], v[240:243], a[28:31]
    v_exp_f32 v131, v131
    v_mfma_f32_16x16x32_bf16 a[28:31], a[200:203], v[236:239], a[28:31]
    buffer_load_dwordx4 v16, s[8:11], s28 offen offset:3072 lds
    v_smfmac_f32_16x16x64_bf16 a[224:227], v[244:247], v[212:219], v248
    s_waitcnt lgkmcnt(6)
    v_mfma_f32_16x16x32_bf16 v[124:127], a[128:131], v[68:71], v[108:111]
    s_cmp_eq_u32 s36, 0
    s_cbranch_scc1 L_site0
L_site_back0:
    v_exp_f32 v132, v132
    v_mfma_f32_16x16x32_bf16 v[124:127], a[132:135], v[72:75], v[124:127]
    ds_read_b64_tr_b16 a[192:193], v9 offset:16384
    v_cvt_pk_bf16_f32 v205, v130, v131
    v_mfma_f32_16x16x32_bf16 v[124:127], a[136:139], v[76:79], v[124:127]
    v_exp_f32 v133, v133
    v_mfma_f32_16x16x32_bf16 v[124:127], a[140:143], v[80:83], v[124:127]
    ds_read_b64_tr_b16 a[194:195], v9 offset:20480
    v_mfma_f32_16x16x32_bf16 v[128:131], a[140:143], v[96:99], v[112:115]
    v_exp_f32 v134, v134
    v_mfma_f32_16x16x32_bf16 v[128:131], a[136:139], v[92:95], v[128:131]
    ds_read_b128 a[160:163], v1 offset:8192
    v_cvt_pk_bf16_f32 v182, v132, v133
    v_mfma_f32_16x16x32_bf16 v[128:131], a[132:135], v[88:91], v[128:131]
    v_exp_f32 v135, v135
    v_mfma_f32_16x16x32_bf16 v[128:131], a[128:131], v[84:87], v[128:131]
    ds_read_b64_tr_b16 a[196:197], v9 offset:40960
    v_mfma_f32_16x16x32_bf16 a[32:35], a[208:211], v[212:215], a[32:35]
    v_exp_f32 v136, v136
    v_mfma_f32_16x16x32_bf16 a[32:35], a[212:215], v[216:219], a[32:35]
    ds_read_b64_tr_b16 a[198:199], v9 offset:45056
    v_cvt_pk_bf16_f32 v183, v134, v135
    v_mfma_f32_16x16x32_bf16 a[36:39], a[212:215], v[224:227], a[36:39]
    v_exp_f32 v137, v137
    v_mfma_f32_16x16x32_bf16 a[36:39], a[208:211], v[220:223], a[36:39]
    ds_read_b128 a[164:167], v2 offset:8192
    v_cvt_pk_bf16_f32 v190, v136, v137
    v_mfma_f32_16x16x32_bf16 a[40:43], a[208:211], v[228:231], a[40:43]
    s_add_u32 s28, s28, 16384
    s_mov_b32 m0, s33
    v_exp_f32 v138, v138
    v_mfma_f32_16x16x32_bf16 a[40:43], a[212:215], v[232:235], a[40:43]
    buffer_load_dwordx4 v17, s[12:15], s29 offen offset:0 lds
    v_mfma_f32_16x16x32_bf16 a[44:47], a[212:215], v[240:243], a[44:47]
    v_exp_f32 v139, v139
    v_mfma_f32_16x16x32_bf16 a[44:47], a[208:211], v[236:239], a[44:47]
    s_waitcnt lgkmcnt(6)
    v_mfma_f32_16x16x32_bf16 v[132:135], a[144:147], v[36:39], v[100:103]
    v_exp_f32 v140, v140
    v_mfma_f32_16x16x32_bf16 v[132:135], a[148:151], v[40:43], v[132:135]
    ds_read_b64_tr_b16 a[200:201], v10 offset:16384
    v_cvt_pk_bf16_f32 v191, v138, v139
    v_mfma_f32_16x16x32_bf16 v[132:135], a[152:155], v[44:47], v[132:135]
    v_exp_f32 v141, v141
    v_mfma_f32_16x16x32_bf16 v[132:135], a[156:159], v[48:51], v[132:135]
    ds_read_b64_tr_b16 a[202:203], v10 offset:20480
    v_mfma_f32_16x16x32_bf16 v[136:139], a[156:159], v[64:67], v[104:107]
    v_exp_f32 v142, v142
    v_mfma_f32_16x16x32_bf16 v[136:139], a[152:155], v[60:63], v[136:139]
    ds_read_b128 a[168:171], v3 offset:8192
    v_cvt_pk_bf16_f32 v198, v140, v141
    v_mfma_f32_16x16x32_bf16 v[136:139], a[148:151], v[56:59], v[136:139]
    v_exp_f32 v143, v143
    v_mfma_f32_16x16x32_bf16 v[136:139], a[144:147], v[52:55], v[136:139]
    ds_read_b64_tr_b16 a[204:205], v10 offset:40960
    v_mfma_f32_16x16x32_bf16 a[48:51], a[216:219], v[212:215], a[48:51]
    v_exp_f32 v144, v144
    v_mfma_f32_16x16x32_bf16 a[48:51], a[220:223], v[216:219], a[48:51]
    ds_read_b64_tr_b16 a[206:207], v10 offset:45056
    v_cvt_pk_bf16_f32 v199, v142, v143
    v_mfma_f32_16x16x32_bf16 a[52:55], a[220:223], v[224:227], a[52:55]
    v_exp_f32 v145, v145
    v_mfma_f32_16x16x32_bf16 a[52:55], a[216:219], v[220:223], a[52:55]
    ds_read_b128 a[172:175], v4 offset:8192
    v_mfma_f32_16x16x32_bf16 a[56:59], a[216:219], v[228:231], a[56:59]
    v_exp_f32 v146, v146
    v_mfma_f32_16x16x32_bf16 a[56:59], a[220:223], v[232:235], a[56:59]
    v_cvt_pk_bf16_f32 v206, v144, v145
    v_mfma_f32_16x16x32_bf16 a[60:63], a[220:223], v[240:243], a[60:63]
    v_exp_f32 v147, v147
    v_mfma_f32_16x16x32_bf16 a[60:63], a[216:219], v[236:239], a[60:63]
    buffer_load_dwordx4 v18, s[12:15], s29 offen offset:1024 lds
    v_smfmac_f32_16x16x64_bf16 a[228:231], v[244:247], v[220:227], v248
    s_waitcnt lgkmcnt(6)
    v_mfma_f32_16x16x32_bf16 v[140:143], a[144:147], v[68:71], v[108:111]
    v_exp_f32 v148, v148
    v_mfma_f32_16x16x32_bf16 v[140:143], a[148:151], v[72:75], v[140:143]
    ds_read_b64_tr_b16 a[208:209], v11 offset:16384
    v_cvt_pk_bf16_f32 v207, v146, v147
    v_mfma_f32_16x16x32_bf16 v[140:143], a[152:155], v[76:79], v[140:143]
    v_exp_f32 v149, v149
    v_mfma_f32_16x16x32_bf16 v[140:143], a[156:159], v[80:83], v[140:143]
    ds_read_b64_tr_b16 a[210:211], v11 offset:20480
    v_mfma_f32_16x16x32_bf16 v[144:147], a[156:159], v[96:99], v[112:115]
    v_exp_f32 v150, v150
    v_mfma_f32_16x16x32_bf16 v[144:147], a[152:155], v[92:95], v[144:147]
    ds_read_b128 a[176:179], v1 offset:12288
    v_cvt_pk_bf16_f32 v184, v148, v149
    v_mfma_f32_16x16x32_bf16 v[144:147], a[148:151], v[88:91], v[144:147]
    v_exp_f32 v151, v151
    v_mfma_f32_16x16x32_bf16 v[144:147], a[144:147], v[84:87], v[144:147]
    ds_read_b64_tr_b16 a[212:213], v11 offset:40960
    v_mfma_f32_16x16x32_bf16 a[64:67], a[192:195], v[212:215], a[64:67]
    v_exp_f32 v152, v152
    v_mfma_f32_16x16x32_bf16 a[64:67], a[196:199], v[216:219], a[64:67]
    ds_read_b64_tr_b16 a[214:215], v11 offset:45056
    v_cvt_pk_bf16_f32 v185, v150, v151
    v_mfma_f32_16x16x32_bf16 a[68:71], a[196:199], v[224:227], a[68:71]
    v_exp_f32 v153, v153
    v_mfma_f32_16x16x32_bf16 a[68:71], a[192:195], v[220:223], a[68:71]
    ds_read_b128 a[180:183], v2 offset:12288
    v_cvt_pk_bf16_f32 v192, v152, v153
    v_mfma_f32_16x16x32_bf16 a[72:75], a[192:195], v[228:231], a[72:75]
    v_exp_f32 v154, v154
    v_mfma_f32_16x16x32_bf16 a[72:75], a[196:199], v[232:235], a[72:75]
    buffer_load_dwordx4 v17, s[12:15], s29 offen offset:2048 lds
    v_mfma_f32_16x16x32_bf16 a[76:79], a[196:199], v[240:243], a[76:79]
    v_exp_f32 v155, v155
    v_mfma_f32_16x16x32_bf16 a[76:79], a[192:195], v[236:239], a[76:79]
    s_waitcnt lgkmcnt(6)
    v_mfma_f32_16x16x32_bf16 v[148:151], a[160:163], v[36:39], v[100:103]
    v_exp_f32 v156, v156
    v_mfma_f32_16x16x32_bf16 v[148:151], a[164:167], v[40:43], v[148:151]
    ds_read_b64_tr_b16 a[216:217], v12 offset:16384
    v_cvt_pk_bf16_f32 v193, v154, v155
    v_mfma_f32_16x16x32_bf16 v[148:151], a[168:171], v[44:47], v[148:151]
    v_exp_f32 v157, v157
    v_mfma_f32_16x16x32_bf16 v[148:151], a[172:175], v[48:51], v[148:151]
    ds_read_b64_tr_b16 a[218:219], v12 offset:20480
    v_mfma_f32_16x16x32_bf16 v[152:155], a[172:175], v[64:67], v[104:107]
    v_exp_f32 v158, v158
    v_mfma_f32_16x16x32_bf16 v[152:155], a[168:171], v[60:63], v[152:155]
    ds_read_b128 a[184:187], v3 offset:12288
    v_cvt_pk_bf16_f32 v200, v156, v157
    v_mfma_f32_16x16x32_bf16 v[152:155], a[164:167], v[56:59], v[152:155]
    v_exp_f32 v159, v159
    v_mfma_f32_16x16x32_bf16 v[152:155], a[160:163], v[52:55], v[152:155]
    ds_read_b64_tr_b16 a[220:221], v12 offset:40960
    v_mfma_f32_16x16x32_bf16 a[80:83], a[200:203], v[212:215], a[80:83]
    v_exp_f32 v160, v160
    v_mfma_f32_16x16x32_bf16 a[80:83], a[204:207], v[216:219], a[80:83]
    ds_read_b64_tr_b16 a[222:223], v12 offset:45056
    v_cvt_pk_bf16_f32 v201, v158, v159
    v_mfma_f32_16x16x32_bf16 a[84:87], a[204:207], v[224:227], a[84:87]
    v_exp_f32 v161, v161
    v_mfma_f32_16x16x32_bf16 a[84:87], a[200:203], v[220:223], a[84:87]
    ds_read_b128 a[188:191], v4 offset:12288
    v_mfma_f32_16x16x32_bf16 a[88:91], a[200:203], v[228:231], a[88:91]
    v_exp_f32 v162, v162
    v_mfma_f32_16x16x32_bf16 a[88:91], a[204:207], v[232:235], a[88:91]
    v_cvt_pk_bf16_f32 v208, v160, v161
    v_mfma_f32_16x16x32_bf16 a[92:95], a[204:207], v[240:243], a[92:95]
    v_exp_f32 v163, v163
    v_mfma_f32_16x16x32_bf16 a[92:95], a[200:203], v[236:239], a[92:95]
    buffer_load_dwordx4 v18, s[12:15], s29 offen offset:3072 lds
    v_smfmac_f32_16x16x64_bf16 a[232:235], v[244:247], v[228:235], v248
    s_waitcnt vmcnt(8) lgkmcnt(6)
    s_barrier
    s_add_u32 s29, s29, 16384
    v_mfma_f32_16x16x32_bf16 v[156:159], a[160:163], v[68:71], v[108:111]
    v_exp_f32 v164, v164
    v_mfma_f32_16x16x32_bf16 v[156:159], a[164:167], v[72:75], v[156:159]
    ds_read_b64_tr_b16 a[192:193], v5 offset:57344
    v_cvt_pk_bf16_f32 v209, v162, v163
    v_mfma_f32_16x16x32_bf16 v[156:159], a[168:171], v[76:79], v[156:159]
    v_exp_f32 v165, v165
    v_mfma_f32_16x16x32_bf16 v[156:159], a[172:175], v[80:83], v[156:159]
    ds_read_b64_tr_b16 a[194:195], v5 offset:61440
    v_mfma_f32_16x16x32_bf16 v[160:163], a[172:175], v[96:99], v[112:115]
    v_exp_f32 v166, v166
    v_mfma_f32_16x16x32_bf16 v[160:163], a[168:171], v[92:95], v[160:163]
    ds_read_b128 a[128:131], v1 offset:49152
    v_cvt_pk_bf16_f32 v186, v164, v165
    v_mfma_f32_16x16x32_bf16 v[160:163], a[164:167], v[88:91], v[160:163]
    v_exp_f32 v167, v167
    v_mfma_f32_16x16x32_bf16 v[160:163], a[160:163], v[84:87], v[160:163]
    ds_read_b64_tr_b16 a[196:197], v5 offset:0
    v_mfma_f32_16x16x32_bf16 a[96:99], a[208:211], v[212:215], a[96:99]
    v_exp_f32 v168, v168
    v_mfma_f32_16x16x32_bf16 a[96:99], a[212:215], v[216:219], a[96:99]
    ds_read_b64_tr_b16 a[198:199], v5 offset:4096
    v_cvt_pk_bf16_f32 v187, v166, v167
    v_mfma_f32_16x16x32_bf16 a[100:103], a[212:215], v[224:227], a[100:103]
    v_exp_f32 v169, v169
    v_mfma_f32_16x16x32_bf16 a[100:103], a[208:211], v[220:223], a[100:103]
    ds_read_b128 a[132:135], v2 offset:49152
    v_cvt_pk_bf16_f32 v194, v168, v169
    v_mfma_f32_16x16x32_bf16 a[104:107], a[208:211], v[228:231], a[104:107]
    s_add_u32 m0, s34, 32768
    v_exp_f32 v170, v170
    v_mfma_f32_16x16x32_bf16 a[104:107], a[212:215], v[232:235], a[104:107]
    buffer_load_dwordx4 v13, s[8:11], s28 offen offset:0 lds
    v_mfma_f32_16x16x32_bf16 a[108:111], a[212:215], v[240:243], a[108:111]
    v_exp_f32 v171, v171
    v_mfma_f32_16x16x32_bf16 a[108:111], a[208:211], v[236:239], a[108:111]
    s_waitcnt lgkmcnt(6)
    v_mfma_f32_16x16x32_bf16 v[164:167], a[176:179], v[36:39], v[100:103]
    v_exp_f32 v172, v172
    v_mfma_f32_16x16x32_bf16 v[164:167], a[180:183], v[40:43], v[164:167]
    ds_read_b64_tr_b16 a[200:201], v6 offset:57344
    v_cvt_pk_bf16_f32 v195, v170, v171
    v_mfma_f32_16x16x32_bf16 v[164:167], a[184:187], v[44:47], v[164:167]
    v_exp_f32 v173, v173
    v_mfma_f32_16x16x32_bf16 v[164:167], a[188:191], v[48:51], v[164:167]
    ds_read_b64_tr_b16 a[202:203], v6 offset:61440
    v_mfma_f32_16x16x32_bf16 v[168:171], a[188:191], v[64:67], v[104:107]
    v_exp_f32 v174, v174
    v_mfma_f32_16x16x32_bf16 v[168:171], a[184:187], v[60:63], v[168:171]
    ds_read_b128 a[136:139], v3 offset:49152
    v_cvt_pk_bf16_f32 v202, v172, v173
    v_mfma_f32_16x16x32_bf16 v[168:171], a[180:183], v[56:59], v[168:171]
    v_exp_f32 v175, v175
    v_mfma_f32_16x16x32_bf16 v[168:171], a[176:179], v[52:55], v[168:171]
    ds_read_b64_tr_b16 a[204:205], v6 offset:0
    v_mfma_f32_16x16x32_bf16 a[112:115], a[216:219], v[212:215], a[112:115]
    v_exp_f32 v176, v176
    v_mfma_f32_16x16x32_bf16 a[112:115], a[220:223], v[216:219], a[112:115]
    ds_read_b64_tr_b16 a[206:207], v6 offset:4096
    v_cvt_pk_bf16_f32 v203, v174, v175
    v_mfma_f32_16x16x32_bf16 a[116:119], a[220:223], v[224:227], a[116:119]
    v_exp_f32 v177, v177
    v_mfma_f32_16x16x32_bf16 a[116:119], a[216:219], v[220:223], a[116:119]
    ds_read_b128 a[140:143], v4 offset:49152
    v_mfma_f32_16x16x32_bf16 a[120:123], a[216:219], v[228:231], a[120:123]
    v_exp_f32 v178, v178
    v_mfma_f32_16x16x32_bf16 a[120:123], a[220:223], v[232:235], a[120:123]
    v_cvt_pk_bf16_f32 v210, v176, v177
    v_mfma_f32_16x16x32_bf16 a[124:127], a[220:223], v[240:243], a[124:127]
    v_exp_f32 v179, v179
    v_mfma_f32_16x16x32_bf16 a[124:127], a[216:219], v[236:239], a[124:127]
    buffer_load_dwordx4 v14, s[8:11], s28 offen offset:1024 lds
    v_smfmac_f32_16x16x64_bf16 a[236:239], v[244:247], v[236:243], v248
    s_waitcnt lgkmcnt(6)
    v_mfma_f32_16x16x32_bf16 v[172:175], a[176:179], v[68:71], v[108:111]
    v_exp_f32 v116, v116
    v_mfma_f32_16x16x32_bf16 v[172:175], a[180:183], v[72:75], v[172:175]
    ds_read_b64_tr_b16 a[208:209], v7 offset:57344
    v_cvt_pk_bf16_f32 v211, v178, v179
    v_mfma_f32_16x16x32_bf16 v[172:175], a[184:187], v[76:79], v[172:175]
    v_exp_f32 v117, v117
    v_mfma_f32_16x16x32_bf16 v[172:175], a[188:191], v[80:83], v[172:175]
    ds_read_b64_tr_b16 a[210:211], v7 offset:61440
    v_mfma_f32_16x16x32_bf16 v[176:179], a[188:191], v[96:99], v[112:115]
    v_exp_f32 v118, v118
    v_mfma_f32_16x16x32_bf16 v[176:179], a[184:187], v[92:95], v[176:179]
    ds_read_b128 a[144:147], v1 offset:53248
    v_cvt_pk_bf16_f32 v212, v116, v117
    v_mfma_f32_16x16x32_bf16 v[176:179], a[180:183], v[88:91], v[176:179]
    v_exp_f32 v119, v119
    v_mfma_f32_16x16x32_bf16 v[176:179], a[176:179], v[84:87], v[176:179]
    ds_read_b64_tr_b16 a[212:213], v7 offset:0
    v_mfma_f32_16x16x32_bf16 a[0:3], a[192:195], v[180:183], a[0:3]
    v_exp_f32 v120, v120
    v_mfma_f32_16x16x32_bf16 a[0:3], a[196:199], v[184:187], a[0:3]
    ds_read_b64_tr_b16 a[214:215], v7 offset:4096
    v_cvt_pk_bf16_f32 v213, v118, v119
    v_mfma_f32_16x16x32_bf16 a[4:7], a[196:199], v[192:195], a[4:7]
    v_exp_f32 v121, v121
    v_mfma_f32_16x16x32_bf16 a[4:7], a[192:195], v[188:191], a[4:7]
    ds_read_b128 a[148:151], v2 offset:53248
    v_cvt_pk_bf16_f32 v220, v120, v121
    v_mfma_f32_16x16x32_bf16 a[8:11], a[192:195], v[196:199], a[8:11]
    v_exp_f32 v122, v122
    v_mfma_f32_16x16x32_bf16 a[8:11], a[196:199], v[200:203], a[8:11]
    buffer_load_dwordx4 v15, s[8:11], s28 offen offset:2048 lds
    v_mfma_f32_16x16x32_bf16 a[12:15], a[196:199], v[208:211], a[12:15]
    v_exp_f32 v123, v123
    v_mfma_f32_16x16x32_bf16 a[12:15], a[192:195], v[204:207], a[12:15]
    s_waitcnt lgkmcnt(6)
    v_mfma_f32_16x16x32_bf16 v[116:119], a[128:131], v[36:39], v[100:103]
    v_exp_f32 v124, v124
    v_mfma_f32_16x16x32_bf16 v[116:119], a[132:135], v[40:43], v[116:119]
    ds_read_b64_tr_b16 a[216:217], v8 offset:57344
    v_cvt_pk_bf16_f32 v221, v122, v123
    v_mfma_f32_16x16x32_bf16 v[116:119], a[136:139], v[44:47], v[116:119]
    v_exp_f32 v125, v125
    v_mfma_f32_16x16x32_bf16 v[116:119], a[140:143], v[48:51], v[116:119]
    ds_read_b64_tr_b16 a[218:219], v8 offset:61440
    v_mfma_f32_16x16x32_bf16 v[120:123], a[140:143], v[64:67], v[104:107]
    v_exp_f32 v126, v126
    v_mfma_f32_16x16x32_bf16 v[120:123], a[136:139], v[60:63], v[120:123]
    ds_read_b128 a[152:155], v3 offset:53248
    v_cvt_pk_bf16_f32 v228, v124, v125
    v_mfma_f32_16x16x32_bf16 v[120:123], a[132:135], v[56:59], v[120:123]
    v_exp_f32 v127, v127
    v_mfma_f32_16x16x32_bf16 v[120:123], a[128:131], v[52:55], v[120:123]
    ds_read_b64_tr_b16 a[220:221], v8 offset:0
    v_mfma_f32_16x16x32_bf16 a[16:19], a[200:203], v[180:183], a[16:19]
    v_exp_f32 v128, v128
    v_mfma_f32_16x16x32_bf16 a[16:19], a[204:207], v[184:187], a[16:19]
    ds_read_b64_tr_b16 a[222:223], v8 offset:4096
    v_cvt_pk_bf16_f32 v229, v126, v127
    v_mfma_f32_16x16x32_bf16 a[20:23], a[204:207], v[192:195], a[20:23]
    v_exp_f32 v129, v129
    v_mfma_f32_16x16x32_bf16 a[20:23], a[200:203], v[188:191], a[20:23]
    ds_read_b128 a[156:159], v4 offset:53248
    v_mfma_f32_16x16x32_bf16 a[24:27], a[200:203], v[196:199], a[24:27]
    v_exp_f32 v130, v130
    v_mfma_f32_16x16x32_bf16 a[24:27], a[204:207], v[200:203], a[24:27]
    v_cvt_pk_bf16_f32 v236, v128, v129
    v_mfma_f32_16x16x32_bf16 a[28:31], a[204:207], v[208:211], a[28:31]
    v_exp_f32 v131, v131
    v_mfma_f32_16x16x32_bf16 a[28:31], a[200:203], v[204:207], a[28:31]
    buffer_load_dwordx4 v16, s[8:11], s28 offen offset:3072 lds
    v_smfmac_f32_16x16x64_bf16 a[224:227], v[244:247], v[180:187], v248
    s_waitcnt lgkmcnt(6)
    v_mfma_f32_16x16x32_bf16 v[124:127], a[128:131], v[68:71], v[108:111]
    s_cmp_eq_u32 s36, 1
    s_cbranch_scc1 L_site1
L_site_back1:
    v_exp_f32 v132, v132
    v_mfma_f32_16x16x32_bf16 v[124:127], a[132:135], v[72:75], v[124:127]
    ds_read_b64_tr_b16 a[192:193], v9 offset:57344
    v_cvt_pk_bf16_f32 v237, v130, v131
    v_mfma_f32_16x16x32_bf16 v[124:127], a[136:139], v[76:79], v[124:127]
    v_exp_f32 v133, v133
    v_mfma_f32_16x16x32_bf16 v[124:127], a[140:143], v[80:83], v[124:127]
    ds_read_b64_tr_b16 a[194:195], v9 offset:61440
    v_mfma_f32_16x16x32_bf16 v[128:131], a[140:143], v[96:99], v[112:115]
    v_exp_f32 v134, v134
    v_mfma_f32_16x16x32_bf16 v[128:131], a[136:139], v[92:95], v[128:131]
    ds_read_b128 a[160:163], v1 offset:57344
    v_cvt_pk_bf16_f32 v214, v132, v133
    v_mfma_f32_16x16x32_bf16 v[128:131], a[132:135], v[88:91], v[128:131]
    v_exp_f32 v135, v135
    v_mfma_f32_16x16x32_bf16 v[128:131], a[128:131], v[84:87], v[128:131]
    ds_read_b64_tr_b16 a[196:197], v9 offset:0
    v_mfma_f32_16x16x32_bf16 a[32:35], a[208:211], v[180:183], a[32:35]
    v_exp_f32 v136, v136
    v_mfma_f32_16x16x32_bf16 a[32:35], a[212:215], v[184:187], a[32:35]
    ds_read_b64_tr_b16 a[198:199], v9 offset:4096
    v_cvt_pk_bf16_f32 v215, v134, v135
    v_mfma_f32_16x16x32_bf16 a[36:39], a[212:215], v[192:195], a[36:39]
    v_exp_f32 v137, v137
    v_mfma_f32_16x16x32_bf16 a[36:39], a[208:211], v[188:191], a[36:39]
    ds_read_b128 a[164:167], v2 offset:57344
    v_cvt_pk_bf16_f32 v222, v136, v137
    v_mfma_f32_16x16x32_bf16 a[40:43], a[208:211], v[196:199], a[40:43]
    s_add_u32 s28, s28, 16384
    s_mov_b32 m0, s30
    v_exp_f32 v138, v138
    v_mfma_f32_16x16x32_bf16 a[40:43], a[212:215], v[200:203], a[40:43]
    buffer_load_dwordx4 v17, s[12:15], s29 offen offset:0 lds
    v_mfma_f32_16x16x32_bf16 a[44:47], a[212:215], v[208:211], a[44:47]
    v_exp_f32 v139, v139
    v_mfma_f32_16x16x32_bf16 a[44:47], a[208:211], v[204:207], a[44:47]
    s_waitcnt lgkmcnt(6)
    v_mfma_f32_16x16x32_bf16 v[132:135], a[144:147], v[36:39], v[100:103]
    v_exp_f32 v140, v140
    v_mfma_f32_16x16x32_bf16 v[132:135], a[148:151], v[40:43], v[132:135]
    ds_read_b64_tr_b16 a[200:201], v10 offset:57344
    v_cvt_pk_bf16_f32 v223, v138, v139
    v_mfma_f32_16x16x32_bf16 v[132:135], a[152:155], v[44:47], v[132:135]
    v_exp_f32 v141, v141
    v_mfma_f32_16x16x32_bf16 v[132:135], a[156:159], v[48:51], v[132:135]
    ds_read_b64_tr_b16 a[202:203], v10 offset:61440
    v_mfma_f32_16x16x32_bf16 v[136:139], a[156:159], v[64:67], v[104:107]
    v_exp_f32 v142, v142
    v_mfma_f32_16x16x32_bf16 v[136:139], a[152:155], v[60:63], v[136:139]
    ds_read_b128 a[168:171], v3 offset:57344
    v_cvt_pk_bf16_f32 v230, v140, v141
    v_mfma_f32_16x16x32_bf16 v[136:139], a[148:151], v[56:59], v[136:139]
    v_exp_f32 v143, v143
    v_mfma_f32_16x16x32_bf16 v[136:139], a[144:147], v[52:55], v[136:139]
    ds_read_b64_tr_b16 a[204:205], v10 offset:0
    v_mfma_f32_16x16x32_bf16 a[48:51], a[216:219], v[180:183], a[48:51]
    v_exp_f32 v144, v144
    v_mfma_f32_16x16x32_bf16 a[48:51], a[220:223], v[184:187], a[48:51]
    ds_read_b64_tr_b16 a[206:207], v10 offset:4096
    v_cvt_pk_bf16_f32 v231, v142, v143
    v_mfma_f32_16x16x32_bf16 a[52:55], a[220:223], v[192:195], a[52:55]
    v_exp_f32 v145, v145
    v_mfma_f32_16x16x32_bf16 a[52:55], a[216:219], v[188:191], a[52:55]
    ds_read_b128 a[172:175], v4 offset:57344
    v_mfma_f32_16x16x32_bf16 a[56:59], a[216:219], v[196:199], a[56:59]
    v_exp_f32 v146, v146
    v_mfma_f32_16x16x32_bf16 a[56:59], a[220:223], v[200:203], a[56:59]
    v_cvt_pk_bf16_f32 v238, v144, v145
    v_mfma_f32_16x16x32_bf16 a[60:63], a[220:223], v[208:211], a[60:63]
    v_exp_f32 v147, v147
    v_mfma_f32_16x16x32_bf16 a[60:63], a[216:219], v[204:207], a[60:63]
    buffer_load_dwordx4 v18, s[12:15], s29 offen offset:1024 lds
    v_smfmac_f32_16x16x64_bf16 a[228:231], v[244:247], v[188:195], v248
    s_waitcnt lgkmcnt(6)
    v_mfma_f32_16x16x32_bf16 v[140:143], a[144:147], v[68:71], v[108:111]
    v_exp_f32 v148, v148
    v_mfma_f32_16x16x32_bf16 v[140:143], a[148:151], v[72:75], v[140:143]
    ds_read_b64_tr_b16 a[208:209], v11 offset:57344
    v_cvt_pk_bf16_f32 v239, v146, v147
    v_mfma_f32_16x16x32_bf16 v[140:143], a[152:155], v[76:79], v[140:143]
    v_exp_f32 v149, v149
    v_mfma_f32_16x16x32_bf16 v[140:143], a[156:159], v[80:83], v[140:143]
    ds_read_b64_tr_b16 a[210:211], v11 offset:61440
    v_mfma_f32_16x16x32_bf16 v[144:147], a[156:159], v[96:99], v[112:115]
    v_exp_f32 v150, v150
    v_mfma_f32_16x16x32_bf16 v[144:147], a[152:155], v[92:95], v[144:147]
    ds_read_b128 a[176:179], v1 offset:61440
    v_cvt_pk_bf16_f32 v216, v148, v149
    v_mfma_f32_16x16x32_bf16 v[144:147], a[148:151], v[88:91], v[144:147]
    v_exp_f32 v151, v151
    v_mfma_f32_16x16x32_bf16 v[144:147], a[144:147], v[84:87], v[144:147]
    ds_read_b64_tr_b16 a[212:213], v11 offset:0
    v_mfma_f32_16x16x32_bf16 a[64:67], a[192:195], v[180:183], a[64:67]
    v_exp_f32 v152, v152
    v_mfma_f32_16x16x32_bf16 a[64:67], a[196:199], v[184:187], a[64:67]
    ds_read_b64_tr_b16 a[214:215], v11 offset:4096
    v_cvt_pk_bf16_f32 v217, v150, v151
    v_mfma_f32_16x16x32_bf16 a[68:71], a[196:199], v[192:195], a[68:71]
    v_exp_f32 v153, v153
    v_mfma_f32_16x16x32_bf16 a[68:71], a[192:195], v[188:191], a[68:71]
    ds_read_b128 a[180:183], v2 offset:61440
    v_cvt_pk_bf16_f32 v224, v152, v153
    v_mfma_f32_16x16x32_bf16 a[72:75], a[192:195], v[196:199], a[72:75]
    v_exp_f32 v154, v154
    v_mfma_f32_16x16x32_bf16 a[72:75], a[196:199], v[200:203], a[72:75]
    buffer_load_dwordx4 v17, s[12:15], s29 offen offset:2048 lds
    v_mfma_f32_16x16x32_bf16 a[76:79], a[196:199], v[208:211], a[76:79]
    v_exp_f32 v155, v155
    v_mfma_f32_16x16x32_bf16 a[76:79], a[192:195], v[204:207], a[76:79]
    s_waitcnt lgkmcnt(6)
    v_mfma_f32_16x16x32_bf16 v[148:151], a[160:163], v[36:39], v[100:103]
    v_exp_f32 v156, v156
    v_mfma_f32_16x16x32_bf16 v[148:151], a[164:167], v[40:43], v[148:151]
    ds_read_b64_tr_b16 a[216:217], v12 offset:57344
    v_cvt_pk_bf16_f32 v225, v154, v155
    v_mfma_f32_16x16x32_bf16 v[148:151], a[168:171], v[44:47], v[148:151]
    v_exp_f32 v157, v157
    v_mfma_f32_16x16x32_bf16 v[148:151], a[172:175], v[48:51], v[148:151]
    ds_read_b64_tr_b16 a[218:219], v12 offset:61440
    v_mfma_f32_16x16x32_bf16 v[152:155], a[172:175], v[64:67], v[104:107]
    v_exp_f32 v158, v158
    v_mfma_f32_16x16x32_bf16 v[152:155], a[168:171], v[60:63], v[152:155]
    ds_read_b128 a[184:187], v3 offset:61440
    v_cvt_pk_bf16_f32 v232, v156, v157
    v_mfma_f32_16x16x32_bf16 v[152:155], a[164:167], v[56:59], v[152:155]
    v_exp_f32 v159, v159
    v_mfma_f32_16x16x32_bf16 v[152:155], a[160:163], v[52:55], v[152:155]
    ds_read_b64_tr_b16 a[220:221], v12 offset:0
    v_mfma_f32_16x16x32_bf16 a[80:83], a[200:203], v[180:183], a[80:83]
    v_exp_f32 v160, v160
    v_mfma_f32_16x16x32_bf16 a[80:83], a[204:207], v[184:187], a[80:83]
    ds_read_b64_tr_b16 a[222:223], v12 offset:4096
    v_cvt_pk_bf16_f32 v233, v158, v159
    v_mfma_f32_16x16x32_bf16 a[84:87], a[204:207], v[192:195], a[84:87]
    v_exp_f32 v161, v161
    v_mfma_f32_16x16x32_bf16 a[84:87], a[200:203], v[188:191], a[84:87]
    ds_read_b128 a[188:191], v4 offset:61440
    v_mfma_f32_16x16x32_bf16 a[88:91], a[200:203], v[196:199], a[88:91]
    v_exp_f32 v162, v162
    v_mfma_f32_16x16x32_bf16 a[88:91], a[204:207], v[200:203], a[88:91]
    v_cvt_pk_bf16_f32 v240, v160, v161
    v_mfma_f32_16x16x32_bf16 a[92:95], a[204:207], v[208:211], a[92:95]
    v_exp_f32 v163, v163
    v_mfma_f32_16x16x32_bf16 a[92:95], a[200:203], v[204:207], a[92:95]
    buffer_load_dwordx4 v18, s[12:15], s29 offen offset:3072 lds
    v_smfmac_f32_16x16x64_bf16 a[232:235], v[244:247], v[196:203], v248
    s_waitcnt vmcnt(8) lgkmcnt(6)
    s_barrier
    s_add_u32 s29, s29, 16384
    v_mfma_f32_16x16x32_bf16 v[156:159], a[160:163], v[68:71], v[108:111]
    v_exp_f32 v164, v164
    v_mfma_f32_16x16x32_bf16 v[156:159], a[164:167], v[72:75], v[156:159]
    ds_read_b64_tr_b16 a[192:193], v5 offset:24576
    v_cvt_pk_bf16_f32 v241, v162, v163
    v_mfma_f32_16x16x32_bf16 v[156:159], a[168:171], v[76:79], v[156:159]
    v_exp_f32 v165, v165
    v_mfma_f32_16x16x32_bf16 v[156:159], a[172:175], v[80:83], v[156:159]
    ds_read_b64_tr_b16 a[194:195], v5 offset:28672
    v_mfma_f32_16x16x32_bf16 v[160:163], a[172:175], v[96:99], v[112:115]
    v_exp_f32 v166, v166
    v_mfma_f32_16x16x32_bf16 v[160:163], a[168:171], v[92:95], v[160:163]
    ds_read_b128 a[128:131], v1 offset:16384
    v_cvt_pk_bf16_f32 v218, v164, v165
    v_mfma_f32_16x16x32_bf16 v[160:163], a[164:167], v[88:91], v[160:163]
    v_exp_f32 v167, v167
    v_mfma_f32_16x16x32_bf16 v[160:163], a[160:163], v[84:87], v[160:163]
    ds_read_b64_tr_b16 a[196:197], v5 offset:49152
    v_mfma_f32_16x16x32_bf16 a[96:99], a[208:211], v[180:183], a[96:99]
    v_exp_f32 v168, v168
    v_mfma_f32_16x16x32_bf16 a[96:99], a[212:215], v[184:187], a[96:99]
    ds_read_b64_tr_b16 a[198:199], v5 offset:53248
    v_cvt_pk_bf16_f32 v219, v166, v167
    v_mfma_f32_16x16x32_bf16 a[100:103], a[212:215], v[192:195], a[100:103]
    v_exp_f32 v169, v169
    v_mfma_f32_16x16x32_bf16 a[100:103], a[208:211], v[188:191], a[100:103]
    ds_read_b128 a[132:135], v2 offset:16384
    v_cvt_pk_bf16_f32 v226, v168, v169
    v_mfma_f32_16x16x32_bf16 a[104:107], a[208:211], v[196:199], a[104:107]
    s_add_u32 m0, s34, 0
    v_exp_f32 v170, v170
    v_mfma_f32_16x16x32_bf16 a[104:107], a[212:215], v[200:203], a[104:107]
    buffer_load_dwordx4 v13, s[8:11], s28 offen offset:0 lds
    v_mfma_f32_16x16x32_bf16 a[108:111], a[212:215], v[208:211], a[108:111]
    v_exp_f32 v171, v171
    v_mfma_f32_16x16x32_bf16 a[108:111], a[208:211], v[204:207], a[108:111]
    s_waitcnt lgkmcnt(6)
    v_mfma_f32_16x16x32_bf16 v[164:167], a[176:179], v[36:39], v[100:103]
    s_cmp_eq_u32 s59, s35
    s_cbranch_scc1 L_once_pack
L_once_back_pack:
    v_exp_f32 v172, v172
    v_mfma_f32_16x16x32_bf16 v[164:167], a[180:183], v[40:43], v[164:167]
    ds_read_b64_tr_b16 a[200:201], v6 offset:24576
    v_cvt_pk_bf16_f32 v227, v170, v171
    v_mfma_f32_16x16x32_bf16 v[164:167], a[184:187], v[44:47], v[164:167]
    v_exp_f32 v173, v173
    v_mfma_f32_16x16x32_bf16 v[164:167], a[188:191], v[48:51], v[164:167]
    ds_read_b64_tr_b16 a[202:203], v6 offset:28672
    v_mfma_f32_16x16x32_bf16 v[168:171], a[188:191], v[64:67], v[104:107]
    v_exp_f32 v174, v174
    v_mfma_f32_16x16x32_bf16 v[168:171], a[184:187], v[60:63], v[168:171]
    ds_read_b128 a[136:139], v3 offset:16384
    v_cvt_pk_bf16_f32 v234, v172, v173
    v_mfma_f32_16x16x32_bf16 v[168:171], a[180:183], v[56:59], v[168:171]
    v_exp_f32 v175, v175
    v_mfma_f32_16x16x32_bf16 v[168:171], a[176:179], v[52:55], v[168:171]
    ds_read_b64_tr_b16 a[204:205], v6 offset:49152
    v_mfma_f32_16x16x32_bf16 a[112:115], a[216:219], v[180:183], a[112:115]
    v_exp_f32 v176, v176
    v_mfma_f32_16x16x32_bf16 a[112:115], a[220:223], v[184:187], a[112:115]
    ds_read_b64_tr_b16 a[206:207], v6 offset:53248
    v_cvt_pk_bf16_f32 v235, v174, v175
    v_mfma_f32_16x16x32_bf16 a[116:119], a[220:223], v[192:195], a[116:119]
    v_exp_f32 v177, v177
    v_mfma_f32_16x16x32_bf16 a[116:119], a[216:219], v[188:191], a[116:119]
    ds_read_b128 a[140:143], v4 offset:16384
    v_mfma_f32_16x16x32_bf16 a[120:123], a[216:219], v[196:199], a[120:123]
    v_exp_f32 v178, v178
    v_mfma_f32_16x16x32_bf16 a[120:123], a[220:223], v[200:203], a[120:123]
    v_cvt_pk_bf16_f32 v242, v176, v177
    v_mfma_f32_16x16x32_bf16 a[124:127], a[220:223], v[208:211], a[124:127]
    v_exp_f32 v179, v179
    v_mfma_f32_16x16x32_bf16 a[124:127], a[216:219], v[204:207], a[124:127]
    buffer_load_dwordx4 v14, s[8:11], s28 offen offset:1024 lds
    v_smfmac_f32_16x16x64_bf16 a[236:239], v[244:247], v[204:211], v248
    s_waitcnt lgkmcnt(6)
    v_mfma_f32_16x16x32_bf16 v[172:175], a[176:179], v[68:71], v[108:111]
    v_exp_f32 v116, v116
    v_mfma_f32_16x16x32_bf16 v[172:175], a[180:183], v[72:75], v[172:175]
    ds_read_b64_tr_b16 a[208:209], v7 offset:24576
    v_cvt_pk_bf16_f32 v243, v178, v179
    v_mfma_f32_16x16x32_bf16 v[172:175], a[184:187], v[76:79], v[172:175]
    v_exp_f32 v117, v117
    v_mfma_f32_16x16x32_bf16 v[172:175], a[188:191], v[80:83], v[172:175]
    ds_read_b64_tr_b16 a[210:211], v7 offset:28672
    v_mfma_f32_16x16x32_bf16 v[176:179], a[188:191], v[96:99], v[112:115]
    v_exp_f32 v118, v118
    v_mfma_f32_16x16x32_bf16 v[176:179], a[184:187], v[92:95], v[176:179]
    ds_read_b128 a[144:147], v1 offset:20480
    v_cvt_pk_bf16_f32 v180, v116, v117
    v_mfma_f32_16x16x32_bf16 v[176:179], a[180:183], v[88:91], v[176:179]
    v_exp_f32 v119, v119
    v_mfma_f32_16x16x32_bf16 v[176:179], a[176:179], v[84:87], v[176:179]
    ds_read_b64_tr_b16 a[212:213], v7 offset:49152
    v_mfma_f32_16x16x32_bf16 a[0:3], a[192:195], v[212:215], a[0:3]
    v_exp_f32 v120, v120
    v_mfma_f32_16x16x32_bf16 a[0:3], a[196:199], v[216:219], a[0:3]
    ds_read_b64_tr_b16 a[214:215], v7 offset:53248
    v_cvt_pk_bf16_f32 v181, v118, v119
    v_mfma_f32_16x16x32_bf16 a[4:7], a[196:199], v[224:227], a[4:7]
    v_exp_f32 v121, v121
    v_mfma_f32_16x16x32_bf16 a[4:7], a[192:195], v[220:223], a[4:7]
    ds_read_b128 a[148:151], v2 offset:20480
    v_cvt_pk_bf16_f32 v188, v120, v121
    v_mfma_f32_16x16x32_bf16 a[8:11], a[192:195], v[228:231], a[8:11]
    v_exp_f32 v122, v122
    v_mfma_f32_16x16x32_bf16 a[8:11], a[196:199], v[232:235], a[8:11]
    buffer_load_dwordx4 v15, s[8:11], s28 offen offset:2048 lds
    v_mfma_f32_16x16x32_bf16 a[12:15], a[196:199], v[240:243], a[12:15]
    v_exp_f32 v123, v123
    v_mfma_f32_16x16x32_bf16 a[12:15], a[192:195], v[236:239], a[12:15]
    s_waitcnt lgkmcnt(6)
    v_mfma_f32_16x16x32_bf16 v[116:119], a[128:131], v[36:39], v[100:103]
    v_exp_f32 v124, v124
    v_mfma_f32_16x16x32_bf16 v[116:119], a[132:135], v[40:43], v[116:119]
    ds_read_b64_tr_b16 a[216:217], v8 offset:24576
    v_cvt_pk_bf16_f32 v189, v122, v123
    v_mfma_f32_16x16x32_bf16 v[116:119], a[136:139], v[44:47], v[116:119]
    v_exp_f32 v125, v125
    v_mfma_f32_16x16x32_bf16 v[116:119], a[140:143], v[48:51], v[116:119]
    ds_read_b64_tr_b16 a[218:219], v8 offset:28672
    v_mfma_f32_16x16x32_bf16 v[120:123], a[140:143], v[64:67], v[104:107]
    v_exp_f32 v126, v126
    v_mfma_f32_16x16x32_bf16 v[120:123], a[136:139], v[60:63], v[120:123]
    ds_read_b128 a[152:155], v3 offset:20480
    v_cvt_pk_bf16_f32 v196, v124, v125
    v_mfma_f32_16x16x32_bf16 v[120:123], a[132:135], v[56:59], v[120:123]
    v_exp_f32 v127, v127
    v_mfma_f32_16x16x32_bf16 v[120:123], a[128:131], v[52:55], v[120:123]
    ds_read_b64_tr_b16 a[220:221], v8 offset:49152
    v_mfma_f32_16x16x32_bf16 a[16:19], a[200:203], v[212:215], a[16:19]
    v_exp_f32 v128, v128
    v_mfma_f32_16x16x32_bf16 a[16:19], a[204:207], v[216:219], a[16:19]
    ds_read_b64_tr_b16 a[222:223], v8 offset:53248
    v_cvt_pk_bf16_f32 v197, v126, v127
    v_mfma_f32_16x16x32_bf16 a[20:23], a[204:207], v[224:227], a[20:23]
    v_exp_f32 v129, v129
    v_mfma_f32_16x16x32_bf16 a[20:23], a[200:203], v[220:223], a[20:23]
    ds_read_b128 a[156:159], v4 offset:20480
    v_mfma_f32_16x16x32_bf16 a[24:27], a[200:203], v[228:231], a[24:27]
    v_exp_f32 v130, v130
    v_mfma_f32_16x16x32_bf16 a[24:27], a[204:207], v[232:235], a[24:27]
    v_cvt_pk_bf16_f32 v204, v128, v129
    v_mfma_f32_16x16x32_bf16 a[28:31], a[204:207], v[240:243], a[28:31]
    v_exp_f32 v131, v131
    v_mfma_f32_16x16x32_bf16 a[28:31], a[200:203], v[236:239], a[28:31]
    buffer_load_dwordx4 v16, s[8:11], s28 offen offset:3072 lds
    v_smfmac_f32_16x16x64_bf16 a[224:227], v[244:247], v[212:219], v248
    s_waitcnt lgkmcnt(6)
    v_mfma_f32_16x16x32_bf16 v[124:127], a[128:131], v[68:71], v[108:111]
    s_cmp_eq_u32 s36, 2
    s_cbranch_scc1 L_site2
L_site_back2:
    v_exp_f32 v132, v132
    v_mfma_f32_16x16x32_bf16 v[124:127], a[132:135], v[72:75], v[124:127]
    ds_read_b64_tr_b16 a[192:193], v9 offset:24576
    v_cvt_pk_bf16_f32 v205, v130, v131
    v_mfma_f32_16x16x32_bf16 v[124:127], a[136:139], v[76:79], v[124:127]
    v_exp_f32 v133, v133
    v_mfma_f32_16x16x32_bf16 v[124:127], a[140:143], v[80:83], v[124:127]
    ds_read_b64_tr_b16 a[194:195], v9 offset:28672
    v_mfma_f32_16x16x32_bf16 v[128:131], a[140:143], v[96:99], v[112:115]
    v_exp_f32 v134, v134
    v_mfma_f32_16x16x32_bf16 v[128:131], a[136:139], v[92:95], v[128:131]
    ds_read_b128 a[160:163], v1 offset:24576
    v_cvt_pk_bf16_f32 v182, v132, v133
    v_mfma_f32_16x16x32_bf16 v[128:131], a[132:135], v[88:91], v[128:131]
    v_exp_f32 v135, v135
    v_mfma_f32_16x16x32_bf16 v[128:131], a[128:131], v[84:87], v[128:131]
    ds_read_b64_tr_b16 a[196:197], v9 offset:49152
    v_mfma_f32_16x16x32_bf16 a[32:35], a[208:211], v[212:215], a[32:35]
    v_exp_f32 v136, v136
    v_mfma_f32_16x16x32_bf16 a[32:35], a[212:215], v[216:219], a[32:35]
    ds_read_b64_tr_b16 a[198:199], v9 offset:53248
    v_cvt_pk_bf16_f32 v183, v134, v135
    v_mfma_f32_16x16x32_bf16 a[36:39], a[212:215], v[224:227], a[36:39]
    v_exp_f32 v137, v137
    v_mfma_f32_16x16x32_bf16 a[36:39], a[208:211], v[220:223], a[36:39]
    ds_read_b128 a[164:167], v2 offset:24576
    v_cvt_pk_bf16_f32 v190, v136, v137
    v_mfma_f32_16x16x32_bf16 a[40:43], a[208:211], v[228:231], a[40:43]
    s_add_u32 s28, s28, 16384
    s_mov_b32 m0, s31
    v_exp_f32 v138, v138
    v_mfma_f32_16x16x32_bf16 a[40:43], a[212:215], v[232:235], a[40:43]
    buffer_load_dwordx4 v17, s[12:15], s29 offen offset:0 lds
    v_mfma_f32_16x16x32_bf16 a[44:47], a[212:215], v[240:243], a[44:47]
    v_exp_f32 v139, v139
    v_mfma_f32_16x16x32_bf16 a[44:47], a[208:211], v[236:239], a[44:47]
    s_waitcnt lgkmcnt(6)
    v_mfma_f32_16x16x32_bf16 v[132:135], a[144:147], v[36:39], v[100:103]
    v_exp_f32 v140, v140
    v_mfma_f32_16x16x32_bf16 v[132:135], a[148:151], v[40:43], v[132:135]
    ds_read_b64_tr_b16 a[200:201], v10 offset:24576
    v_cvt_pk_bf16_f32 v191, v138, v139
    v_mfma_f32_16x16x32_bf16 v[132:135], a[152:155], v[44:47], v[132:135]
    v_exp_f32 v141, v141
    v_mfma_f32_16x16x32_bf16 v[132:135], a[156:159], v[48:51], v[132:135]
    ds_read_b64_tr_b16 a[202:203], v10 offset:28672
    v_mfma_f32_16x16x32_bf16 v[136:139], a[156:159], v[64:67], v[104:107]
    v_exp_f32 v142, v142
    v_mfma_f32_16x16x32_bf16 v[136:139], a[152:155], v[60:63], v[136:139]
    ds_read_b128 a[168:171], v3 offset:24576
    v_cvt_pk_bf16_f32 v198, v140, v141
    v_mfma_f32_16x16x32_bf16 v[136:139], a[148:151], v[56:59], v[136:139]
    v_exp_f32 v143, v143
    v_mfma_f32_16x16x32_bf16 v[136:139], a[144:147], v[52:55], v[136:139]
    ds_read_b64_tr_b16 a[204:205], v10 offset:49152
    v_mfma_f32_16x16x32_bf16 a[48:51], a[216:219], v[212:215], a[48:51]
    v_exp_f32 v144, v144
    v_mfma_f32_16x16x32_bf16 a[48:51], a[220:223], v[216:219], a[48:51]
    ds_read_b64_tr_b16 a[206:207], v10 offset:53248
    v_cvt_pk_bf16_f32 v199, v142, v143
    v_mfma_f32_16x16x32_bf16 a[52:55], a[220:223], v[224:227], a[52:55]
    v_exp_f32 v145, v145
    v_mfma_f32_16x16x32_bf16 a[52:55], a[216:219], v[220:223], a[52:55]
    ds_read_b128 a[172:175], v4 offset:24576
    v_mfma_f32_16x16x32_bf16 a[56:59], a[216:219], v[228:231], a[56:59]
    v_exp_f32 v146, v146
    v_mfma_f32_16x16x32_bf16 a[56:59], a[220:223], v[232:235], a[56:59]
    v_cvt_pk_bf16_f32 v206, v144, v145
    v_mfma_f32_16x16x32_bf16 a[60:63], a[220:223], v[240:243], a[60:63]
    v_exp_f32 v147, v147
    v_mfma_f32_16x16x32_bf16 a[60:63], a[216:219], v[236:239], a[60:63]
    buffer_load_dwordx4 v18, s[12:15], s29 offen offset:1024 lds
    v_smfmac_f32_16x16x64_bf16 a[228:231], v[244:247], v[220:227], v248
    s_waitcnt lgkmcnt(6)
    v_mfma_f32_16x16x32_bf16 v[140:143], a[144:147], v[68:71], v[108:111]
    v_exp_f32 v148, v148
    v_mfma_f32_16x16x32_bf16 v[140:143], a[148:151], v[72:75], v[140:143]
    ds_read_b64_tr_b16 a[208:209], v11 offset:24576
    v_cvt_pk_bf16_f32 v207, v146, v147
    v_mfma_f32_16x16x32_bf16 v[140:143], a[152:155], v[76:79], v[140:143]
    v_exp_f32 v149, v149
    v_mfma_f32_16x16x32_bf16 v[140:143], a[156:159], v[80:83], v[140:143]
    ds_read_b64_tr_b16 a[210:211], v11 offset:28672
    v_mfma_f32_16x16x32_bf16 v[144:147], a[156:159], v[96:99], v[112:115]
    v_exp_f32 v150, v150
    v_mfma_f32_16x16x32_bf16 v[144:147], a[152:155], v[92:95], v[144:147]
    ds_read_b128 a[176:179], v1 offset:28672
    v_cvt_pk_bf16_f32 v184, v148, v149
    v_mfma_f32_16x16x32_bf16 v[144:147], a[148:151], v[88:91], v[144:147]
    v_exp_f32 v151, v151
    v_mfma_f32_16x16x32_bf16 v[144:147], a[144:147], v[84:87], v[144:147]
    ds_read_b64_tr_b16 a[212:213], v11 offset:49152
    v_mfma_f32_16x16x32_bf16 a[64:67], a[192:195], v[212:215], a[64:67]
    v_exp_f32 v152, v152
    v_mfma_f32_16x16x32_bf16 a[64:67], a[196:199], v[216:219], a[64:67]
    ds_read_b64_tr_b16 a[214:215], v11 offset:53248
    v_cvt_pk_bf16_f32 v185, v150, v151
    v_mfma_f32_16x16x32_bf16 a[68:71], a[196:199], v[224:227], a[68:71]
    v_exp_f32 v153, v153
    v_mfma_f32_16x16x32_bf16 a[68:71], a[192:195], v[220:223], a[68:71]
    ds_read_b128 a[180:183], v2 offset:28672
    v_cvt_pk_bf16_f32 v192, v152, v153
    v_mfma_f32_16x16x32_bf16 a[72:75], a[192:195], v[228:231], a[72:75]
    v_exp_f32 v154, v154
    v_mfma_f32_16x16x32_bf16 a[72:75], a[196:199], v[232:235], a[72:75]
    buffer_load_dwordx4 v17, s[12:15], s29 offen offset:2048 lds
    v_mfma_f32_16x16x32_bf16 a[76:79], a[196:199], v[240:243], a[76:79]
    v_exp_f32 v155, v155
    v_mfma_f32_16x16x32_bf16 a[76:79], a[192:195], v[236:239], a[76:79]
    s_waitcnt lgkmcnt(6)
    v_mfma_f32_16x16x32_bf16 v[148:151], a[160:163], v[36:39], v[100:103]
    v_exp_f32 v156, v156
    v_mfma_f32_16x16x32_bf16 v[148:151], a[164:167], v[40:43], v[148:151]
    ds_read_b64_tr_b16 a[216:217], v12 offset:24576
    v_cvt_pk_bf16_f32 v193, v154, v155
    v_mfma_f32_16x16x32_bf16 v[148:151], a[168:171], v[44:47], v[148:151]
    v_exp_f32 v157, v157
    v_mfma_f32_16x16x32_bf16 v[148:151], a[172:175], v[48:51], v[148:151]
    ds_read_b64_tr_b16 a[218:219], v12 offset:28672
    v_mfma_f32_16x16x32_bf16 v[152:155], a[172:175], v[64:67], v[104:107]
    v_exp_f32 v158, v158
    v_mfma_f32_16x16x32_bf16 v[152:155], a[168:171], v[60:63], v[152:155]
    ds_read_b128 a[184:187], v3 offset:28672
    v_cvt_pk_bf16_f32 v200, v156, v157
    v_mfma_f32_16x16x32_bf16 v[152:155], a[164:167], v[56:59], v[152:155]
    v_exp_f32 v159, v159
    v_mfma_f32_16x16x32_bf16 v[152:155], a[160:163], v[52:55], v[152:155]
    ds_read_b64_tr_b16 a[220:221], v12 offset:49152
    v_mfma_f32_16x16x32_bf16 a[80:83], a[200:203], v[212:215], a[80:83]
    v_exp_f32 v160, v160
    v_mfma_f32_16x16x32_bf16 a[80:83], a[204:207], v[216:219], a[80:83]
    ds_read_b64_tr_b16 a[222:223], v12 offset:53248
    v_cvt_pk_bf16_f32 v201, v158, v159
    v_mfma_f32_16x16x32_bf16 a[84:87], a[204:207], v[224:227], a[84:87]
    v_exp_f32 v161, v161
    v_mfma_f32_16x16x32_bf16 a[84:87], a[200:203], v[220:223], a[84:87]
    ds_read_b128 a[188:191], v4 offset:28672
    v_mfma_f32_16x16x32_bf16 a[88:91], a[200:203], v[228:231], a[88:91]
    v_exp_f32 v162, v162
    v_mfma_f32_16x16x32_bf16 a[88:91], a[204:207], v[232:235], a[88:91]
    v_cvt_pk_bf16_f32 v208, v160, v161
    v_mfma_f32_16x16x32_bf16 a[92:95], a[204:207], v[240:243], a[92:95]
    v_exp_f32 v163, v163
    v_mfma_f32_16x16x32_bf16 a[92:95], a[200:203], v[236:239], a[92:95]
    buffer_load_dwordx4 v18, s[12:15], s29 offen offset:3072 lds
    v_smfmac_f32_16x16x64_bf16 a[232:235], v[244:247], v[228:235], v248
    s_waitcnt vmcnt(8) lgkmcnt(6)
    s_barrier
    s_add_u32 s29, s29, 16384
    v_mfma_f32_16x16x32_bf16 v[156:159], a[160:163], v[68:71], v[108:111]
    v_exp_f32 v164, v164
    v_mfma_f32_16x16x32_bf16 v[156:159], a[164:167], v[72:75], v[156:159]
    ds_read_b64_tr_b16 a[192:193], v5 offset:8192
    v_cvt_pk_bf16_f32 v209, v162, v163
    v_mfma_f32_16x16x32_bf16 v[156:159], a[168:171], v[76:79], v[156:159]
    v_exp_f32 v165, v165
    v_mfma_f32_16x16x32_bf16 v[156:159], a[172:175], v[80:83], v[156:159]
    ds_read_b64_tr_b16 a[194:195], v5 offset:12288
    v_mfma_f32_16x16x32_bf16 v[160:163], a[172:175], v[96:99], v[112:115]
    v_exp_f32 v166, v166
    v_mfma_f32_16x16x32_bf16 v[160:163], a[168:171], v[92:95], v[160:163]
    ds_read_b128 a[128:131], v1 offset:32768
    v_cvt_pk_bf16_f32 v186, v164, v165
    v_mfma_f32_16x16x32_bf16 v[160:163], a[164:167], v[88:91], v[160:163]
    v_exp_f32 v167, v167
    v_mfma_f32_16x16x32_bf16 v[160:163], a[160:163], v[84:87], v[160:163]
    ds_read_b64_tr_b16 a[196:197], v5 offset:32768
    v_mfma_f32_16x16x32_bf16 a[96:99], a[208:211], v[212:215], a[96:99]
    v_exp_f32 v168, v168
    v_mfma_f32_16x16x32_bf16 a[96:99], a[212:215], v[216:219], a[96:99]
    ds_read_b64_tr_b16 a[198:199], v5 offset:36864
    v_cvt_pk_bf16_f32 v187, v166, v167
    v_mfma_f32_16x16x32_bf16 a[100:103], a[212:215], v[224:227], a[100:103]
    v_exp_f32 v169, v169
    v_mfma_f32_16x16x32_bf16 a[100:103], a[208:211], v[220:223], a[100:103]
    ds_read_b128 a[132:135], v2 offset:32768
    v_cvt_pk_bf16_f32 v194, v168, v169
    v_mfma_f32_16x16x32_bf16 a[104:107], a[208:211], v[228:231], a[104:107]
    s_add_u32 m0, s34, 49152
    v_exp_f32 v170, v170
    v_mfma_f32_16x16x32_bf16 a[104:107], a[212:215], v[232:235], a[104:107]
    buffer_load_dwordx4 v13, s[8:11], s28 offen offset:0 lds
    v_mfma_f32_16x16x32_bf16 a[108:111], a[212:215], v[240:243], a[108:111]
    v_exp_f32 v171, v171
    v_mfma_f32_16x16x32_bf16 a[108:111], a[208:211], v[236:239], a[108:111]
    s_waitcnt lgkmcnt(6)
    v_mfma_f32_16x16x32_bf16 v[164:167], a[176:179], v[36:39], v[100:103]
    v_exp_f32 v172, v172
    v_mfma_f32_16x16x32_bf16 v[164:167], a[180:183], v[40:43], v[164:167]
    ds_read_b64_tr_b16 a[200:201], v6 offset:8192
    v_cvt_pk_bf16_f32 v195, v170, v171
    v_mfma_f32_16x16x32_bf16 v[164:167], a[184:187], v[44:47], v[164:167]
    v_exp_f32 v173, v173
    v_mfma_f32_16x16x32_bf16 v[164:167], a[188:191], v[48:51], v[164:167]
    ds_read_b64_tr_b16 a[202:203], v6 offset:12288
    v_mfma_f32_16x16x32_bf16 v[168:171], a[188:191], v[64:67], v[104:107]
    v_exp_f32 v174, v174
    v_mfma_f32_16x16x32_bf16 v[168:171], a[184:187], v[60:63], v[168:171]
    ds_read_b128 a[136:139], v3 offset:32768
    v_cvt_pk_bf16_f32 v202, v172, v173
    v_mfma_f32_16x16x32_bf16 v[168:171], a[180:183], v[56:59], v[168:171]
    v_exp_f32 v175, v175
    v_mfma_f32_16x16x32_bf16 v[168:171], a[176:179], v[52:55], v[168:171]
    ds_read_b64_tr_b16 a[204:205], v6 offset:32768
    v_mfma_f32_16x16x32_bf16 a[112:115], a[216:219], v[212:215], a[112:115]
    v_exp_f32 v176, v176
    v_mfma_f32_16x16x32_bf16 a[112:115], a[220:223], v[216:219], a[112:115]
    ds_read_b64_tr_b16 a[206:207], v6 offset:36864
    v_cvt_pk_bf16_f32 v203, v174, v175
    v_mfma_f32_16x16x32_bf16 a[116:119], a[220:223], v[224:227], a[116:119]
    v_exp_f32 v177, v177
    v_mfma_f32_16x16x32_bf16 a[116:119], a[216:219], v[220:223], a[116:119]
    ds_read_b128 a[140:143], v4 offset:32768
    v_mfma_f32_16x16x32_bf16 a[120:123], a[216:219], v[228:231], a[120:123]
    v_exp_f32 v178, v178
    v_mfma_f32_16x16x32_bf16 a[120:123], a[220:223], v[232:235], a[120:123]
    v_cvt_pk_bf16_f32 v210, v176, v177
    v_mfma_f32_16x16x32_bf16 a[124:127], a[220:223], v[240:243], a[124:127]
    v_exp_f32 v179, v179
    v_mfma_f32_16x16x32_bf16 a[124:127], a[216:219], v[236:239], a[124:127]
    buffer_load_dwordx4 v14, s[8:11], s28 offen offset:1024 lds
    v_smfmac_f32_16x16x64_bf16 a[236:239], v[244:247], v[236:243], v248
    s_waitcnt lgkmcnt(6)
    v_mfma_f32_16x16x32_bf16 v[172:175], a[176:179], v[68:71], v[108:111]
    v_exp_f32 v116, v116
    v_mfma_f32_16x16x32_bf16 v[172:175], a[180:183], v[72:75], v[172:175]
    ds_read_b64_tr_b16 a[208:209], v7 offset:8192
    v_cvt_pk_bf16_f32 v211, v178, v179
    v_mfma_f32_16x16x32_bf16 v[172:175], a[184:187], v[76:79], v[172:175]
    v_exp_f32 v117, v117
    v_mfma_f32_16x16x32_bf16 v[172:175], a[188:191], v[80:83], v[172:175]
    ds_read_b64_tr_b16 a[210:211], v7 offset:12288
    v_mfma_f32_16x16x32_bf16 v[176:179], a[188:191], v[96:99], v[112:115]
    v_exp_f32 v118, v118
    v_mfma_f32_16x16x32_bf16 v[176:179], a[184:187], v[92:95], v[176:179]
    ds_read_b128 a[144:147], v1 offset:36864
    v_cvt_pk_bf16_f32 v212, v116, v117
    v_mfma_f32_16x16x32_bf16 v[176:179], a[180:183], v[88:91], v[176:179]
    v_exp_f32 v119, v119
    v_mfma_f32_16x16x32_bf16 v[176:179], a[176:179], v[84:87], v[176:179]
    ds_read_b64_tr_b16 a[212:213], v7 offset:32768
    v_mfma_f32_16x16x32_bf16 a[0:3], a[192:195], v[180:183], a[0:3]
    v_exp_f32 v120, v120
    v_mfma_f32_16x16x32_bf16 a[0:3], a[196:199], v[184:187], a[0:3]
    ds_read_b64_tr_b16 a[214:215], v7 offset:36864
    v_cvt_pk_bf16_f32 v213, v118, v119
    v_mfma_f32_16x16x32_bf16 a[4:7], a[196:199], v[192:195], a[4:7]
    v_exp_f32 v121, v121
    v_mfma_f32_16x16x32_bf16 a[4:7], a[192:195], v[188:191], a[4:7]
    ds_read_b128 a[148:151], v2 offset:36864
    v_cvt_pk_bf16_f32 v220, v120, v121
    v_mfma_f32_16x16x32_bf16 a[8:11], a[192:195], v[196:199], a[8:11]
    v_exp_f32 v122, v122
    v_mfma_f32_16x16x32_bf16 a[8:11], a[196:199], v[200:203], a[8:11]
    buffer_load_dwordx4 v15, s[8:11], s28 offen offset:2048 lds
    v_mfma_f32_16x16x32_bf16 a[12:15], a[196:199], v[208:211], a[12:15]
    v_exp_f32 v123, v123
    v_mfma_f32_16x16x32_bf16 a[12:15], a[192:195], v[204:207], a[12:15]
    s_waitcnt lgkmcnt(6)
    v_mfma_f32_16x16x32_bf16 v[116:119], a[128:131], v[36:39], v[100:103]
    v_exp_f32 v124, v124
    v_mfma_f32_16x16x32_bf16 v[116:119], a[132:135], v[40:43], v[116:119]
    ds_read_b64_tr_b16 a[216:217], v8 offset:8192
    v_cvt_pk_bf16_f32 v221, v122, v123
    v_mfma_f32_16x16x32_bf16 v[116:119], a[136:139], v[44:47], v[116:119]
    v_exp_f32 v125, v125
    v_mfma_f32_16x16x32_bf16 v[116:119], a[140:143], v[48:51], v[116:119]
    ds_read_b64_tr_b16 a[218:219], v8 offset:12288
    v_mfma_f32_16x16x32_bf16 v[120:123], a[140:143], v[64:67], v[104:107]
    v_exp_f32 v126, v126
    v_mfma_f32_16x16x32_bf16 v[120:123], a[136:139], v[60:63], v[120:123]
    ds_read_b128 a[152:155], v3 offset:36864
    v_cvt_pk_bf16_f32 v228, v124, v125
    v_mfma_f32_16x16x32_bf16 v[120:123], a[132:135], v[56:59], v[120:123]
    v_exp_f32 v127, v127
    v_mfma_f32_16x16x32_bf16 v[120:123], a[128:131], v[52:55], v[120:123]
    ds_read_b64_tr_b16 a[220:221], v8 offset:32768
    v_mfma_f32_16x16x32_bf16 a[16:19], a[200:203], v[180:183], a[16:19]
    v_exp_f32 v128, v128
    v_mfma_f32_16x16x32_bf16 a[16:19], a[204:207], v[184:187], a[16:19]
    ds_read_b64_tr_b16 a[222:223], v8 offset:36864
    v_cvt_pk_bf16_f32 v229, v126, v127
    v_mfma_f32_16x16x32_bf16 a[20:23], a[204:207], v[192:195], a[20:23]
    v_exp_f32 v129, v129
    v_mfma_f32_16x16x32_bf16 a[20:23], a[200:203], v[188:191], a[20:23]
    ds_read_b128 a[156:159], v4 offset:36864
    v_mfma_f32_16x16x32_bf16 a[24:27], a[200:203], v[196:199], a[24:27]
    v_exp_f32 v130, v130
    v_mfma_f32_16x16x32_bf16 a[24:27], a[204:207], v[200:203], a[24:27]
    v_cvt_pk_bf16_f32 v236, v128, v129
    v_mfma_f32_16x16x32_bf16 a[28:31], a[204:207], v[208:211], a[28:31]
    v_exp_f32 v131, v131
    v_mfma_f32_16x16x32_bf16 a[28:31], a[200:203], v[204:207], a[28:31]
    buffer_load_dwordx4 v16, s[8:11], s28 offen offset:3072 lds
    v_smfmac_f32_16x16x64_bf16 a[224:227], v[244:247], v[180:187], v248
    s_waitcnt lgkmcnt(6)
    v_mfma_f32_16x16x32_bf16 v[124:127], a[128:131], v[68:71], v[108:111]
    s_cmp_eq_u32 s36, 3
    s_cbranch_scc1 L_site3
L_site_back3:
    v_exp_f32 v132, v132
    v_mfma_f32_16x16x32_bf16 v[124:127], a[132:135], v[72:75], v[124:127]
    ds_read_b64_tr_b16 a[192:193], v9 offset:8192
    v_cvt_pk_bf16_f32 v237, v130, v131
    v_mfma_f32_16x16x32_bf16 v[124:127], a[136:139], v[76:79], v[124:127]
    v_exp_f32 v133, v133
    v_mfma_f32_16x16x32_bf16 v[124:127], a[140:143], v[80:83], v[124:127]
    ds_read_b64_tr_b16 a[194:195], v9 offset:12288
    v_mfma_f32_16x16x32_bf16 v[128:131], a[140:143], v[96:99], v[112:115]
    v_exp_f32 v134, v134
    v_mfma_f32_16x16x32_bf16 v[128:131], a[136:139], v[92:95], v[128:131]
    ds_read_b128 a[160:163], v1 offset:40960
    v_cvt_pk_bf16_f32 v214, v132, v133
    v_mfma_f32_16x16x32_bf16 v[128:131], a[132:135], v[88:91], v[128:131]
    v_exp_f32 v135, v135
    v_mfma_f32_16x16x32_bf16 v[128:131], a[128:131], v[84:87], v[128:131]
    ds_read_b64_tr_b16 a[196:197], v9 offset:32768
    v_mfma_f32_16x16x32_bf16 a[32:35], a[208:211], v[180:183], a[32:35]
    v_exp_f32 v136, v136
    v_mfma_f32_16x16x32_bf16 a[32:35], a[212:215], v[184:187], a[32:35]
    ds_read_b64_tr_b16 a[198:199], v9 offset:36864
    v_cvt_pk_bf16_f32 v215, v134, v135
    v_mfma_f32_16x16x32_bf16 a[36:39], a[212:215], v[192:195], a[36:39]
    v_exp_f32 v137, v137
    v_mfma_f32_16x16x32_bf16 a[36:39], a[208:211], v[188:191], a[36:39]
    ds_read_b128 a[164:167], v2 offset:40960
    v_cvt_pk_bf16_f32 v222, v136, v137
    v_mfma_f32_16x16x32_bf16 a[40:43], a[208:211], v[196:199], a[40:43]
    s_add_u32 s28, s28, 16384
    s_mov_b32 m0, s32
    v_exp_f32 v138, v138
    v_mfma_f32_16x16x32_bf16 a[40:43], a[212:215], v[200:203], a[40:43]
    buffer_load_dwordx4 v17, s[12:15], s29 offen offset:0 lds
    v_mfma_f32_16x16x32_bf16 a[44:47], a[212:215], v[208:211], a[44:47]
    v_exp_f32 v139, v139
    v_mfma_f32_16x16x32_bf16 a[44:47], a[208:211], v[204:207], a[44:47]
    s_waitcnt lgkmcnt(6)
    v_mfma_f32_16x16x32_bf16 v[132:135], a[144:147], v[36:39], v[100:103]
    v_exp_f32 v140, v140
    v_mfma_f32_16x16x32_bf16 v[132:135], a[148:151], v[40:43], v[132:135]
    ds_read_b64_tr_b16 a[200:201], v10 offset:8192
    v_cvt_pk_bf16_f32 v223, v138, v139
    v_mfma_f32_16x16x32_bf16 v[132:135], a[152:155], v[44:47], v[132:135]
    v_exp_f32 v141, v141
    v_mfma_f32_16x16x32_bf16 v[132:135], a[156:159], v[48:51], v[132:135]
    ds_read_b64_tr_b16 a[202:203], v10 offset:12288
    v_mfma_f32_16x16x32_bf16 v[136:139], a[156:159], v[64:67], v[104:107]
    v_exp_f32 v142, v142
    v_mfma_f32_16x16x32_bf16 v[136:139], a[152:155], v[60:63], v[136:139]
    ds_read_b128 a[168:171], v3 offset:40960
    v_cvt_pk_bf16_f32 v230, v140, v141
    v_mfma_f32_16x16x32_bf16 v[136:139], a[148:151], v[56:59], v[136:139]
    v_exp_f32 v143, v143
    v_mfma_f32_16x16x32_bf16 v[136:139], a[144:147], v[52:55], v[136:139]
    ds_read_b64_tr_b16 a[204:205], v10 offset:32768
    v_mfma_f32_16x16x32_bf16 a[48:51], a[216:219], v[180:183], a[48:51]
    v_exp_f32 v144, v144
    v_mfma_f32_16x16x32_bf16 a[48:51], a[220:223], v[184:187], a[48:51]
    ds_read_b64_tr_b16 a[206:207], v10 offset:36864
    v_cvt_pk_bf16_f32 v231, v142, v143
    v_mfma_f32_16x16x32_bf16 a[52:55], a[220:223], v[192:195], a[52:55]
    v_exp_f32 v145, v145
    v_mfma_f32_16x16x32_bf16 a[52:55], a[216:219], v[188:191], a[52:55]
    ds_read_b128 a[172:175], v4 offset:40960
    v_mfma_f32_16x16x32_bf16 a[56:59], a[216:219], v[196:199], a[56:59]
    v_exp_f32 v146, v146
    v_mfma_f32_16x16x32_bf16 a[56:59], a[220:223], v[200:203], a[56:59]
    v_cvt_pk_bf16_f32 v238, v144, v145
    v_mfma_f32_16x16x32_bf16 a[60:63], a[220:223], v[208:211], a[60:63]
    v_exp_f32 v147, v147
    v_mfma_f32_16x16x32_bf16 a[60:63], a[216:219], v[204:207], a[60:63]
    buffer_load_dwordx4 v18, s[12:15], s29 offen offset:1024 lds
    v_smfmac_f32_16x16x64_bf16 a[228:231], v[244:247], v[188:195], v248
    s_waitcnt lgkmcnt(6)
    v_mfma_f32_16x16x32_bf16 v[140:143], a[144:147], v[68:71], v[108:111]
    v_exp_f32 v148, v148
    v_mfma_f32_16x16x32_bf16 v[140:143], a[148:151], v[72:75], v[140:143]
    ds_read_b64_tr_b16 a[208:209], v11 offset:8192
    v_cvt_pk_bf16_f32 v239, v146, v147
    v_mfma_f32_16x16x32_bf16 v[140:143], a[152:155], v[76:79], v[140:143]
    v_exp_f32 v149, v149
    v_mfma_f32_16x16x32_bf16 v[140:143], a[156:159], v[80:83], v[140:143]
    ds_read_b64_tr_b16 a[210:211], v11 offset:12288
    v_mfma_f32_16x16x32_bf16 v[144:147], a[156:159], v[96:99], v[112:115]
    v_exp_f32 v150, v150
    v_mfma_f32_16x16x32_bf16 v[144:147], a[152:155], v[92:95], v[144:147]
    ds_read_b128 a[176:179], v1 offset:45056
    v_cvt_pk_bf16_f32 v216, v148, v149
    v_mfma_f32_16x16x32_bf16 v[144:147], a[148:151], v[88:91], v[144:147]
    v_exp_f32 v151, v151
    v_mfma_f32_16x16x32_bf16 v[144:147], a[144:147], v[84:87], v[144:147]
    ds_read_b64_tr_b16 a[212:213], v11 offset:32768
    v_mfma_f32_16x16x32_bf16 a[64:67], a[192:195], v[180:183], a[64:67]
    v_exp_f32 v152, v152
    v_mfma_f32_16x16x32_bf16 a[64:67], a[196:199], v[184:187], a[64:67]
    ds_read_b64_tr_b16 a[214:215], v11 offset:36864
    v_cvt_pk_bf16_f32 v217, v150, v151
    v_mfma_f32_16x16x32_bf16 a[68:71], a[196:199], v[192:195], a[68:71]
    v_exp_f32 v153, v153
    v_mfma_f32_16x16x32_bf16 a[68:71], a[192:195], v[188:191], a[68:71]
    ds_read_b128 a[180:183], v2 offset:45056
    v_cvt_pk_bf16_f32 v224, v152, v153
    v_mfma_f32_16x16x32_bf16 a[72:75], a[192:195], v[196:199], a[72:75]
    v_exp_f32 v154, v154
    v_mfma_f32_16x16x32_bf16 a[72:75], a[196:199], v[200:203], a[72:75]
    buffer_load_dwordx4 v17, s[12:15], s29 offen offset:2048 lds
    v_mfma_f32_16x16x32_bf16 a[76:79], a[196:199], v[208:211], a[76:79]
    v_exp_f32 v155, v155
    v_mfma_f32_16x16x32_bf16 a[76:79], a[192:195], v[204:207], a[76:79]
    s_waitcnt lgkmcnt(6)
    v_mfma_f32_16x16x32_bf16 v[148:151], a[160:163], v[36:39], v[100:103]
    v_exp_f32 v156, v156
    v_mfma_f32_16x16x32_bf16 v[148:151], a[164:167], v[40:43], v[148:151]
    ds_read_b64_tr_b16 a[216:217], v12 offset:8192
    v_cvt_pk_bf16_f32 v225, v154, v155
    v_mfma_f32_16x16x32_bf16 v[148:151], a[168:171], v[44:47], v[148:151]
    v_exp_f32 v157, v157
    v_mfma_f32_16x16x32_bf16 v[148:151], a[172:175], v[48:51], v[148:151]
    ds_read_b64_tr_b16 a[218:219], v12 offset:12288
    v_mfma_f32_16x16x32_bf16 v[152:155], a[172:175], v[64:67], v[104:107]
    v_exp_f32 v158, v158
    v_mfma_f32_16x16x32_bf16 v[152:155], a[168:171], v[60:63], v[152:155]
    ds_read_b128 a[184:187], v3 offset:45056
    v_cvt_pk_bf16_f32 v232, v156, v157
    v_mfma_f32_16x16x32_bf16 v[152:155], a[164:167], v[56:59], v[152:155]
    v_exp_f32 v159, v159
    v_mfma_f32_16x16x32_bf16 v[152:155], a[160:163], v[52:55], v[152:155]
    ds_read_b64_tr_b16 a[220:221], v12 offset:32768
    v_mfma_f32_16x16x32_bf16 a[80:83], a[200:203], v[180:183], a[80:83]
    v_exp_f32 v160, v160
    v_mfma_f32_16x16x32_bf16 a[80:83], a[204:207], v[184:187], a[80:83]
    ds_read_b64_tr_b16 a[222:223], v12 offset:36864
    v_cvt_pk_bf16_f32 v233, v158, v159
    v_mfma_f32_16x16x32_bf16 a[84:87], a[204:207], v[192:195], a[84:87]
    v_exp_f32 v161, v161
    v_mfma_f32_16x16x32_bf16 a[84:87], a[200:203], v[188:191], a[84:87]
    ds_read_b128 a[188:191], v4 offset:45056
    v_mfma_f32_16x16x32_bf16 a[88:91], a[200:203], v[196:199], a[88:91]
    v_exp_f32 v162, v162
    v_mfma_f32_16x16x32_bf16 a[88:91], a[204:207], v[200:203], a[88:91]
    v_cvt_pk_bf16_f32 v240, v160, v161
    v_mfma_f32_16x16x32_bf16 a[92:95], a[204:207], v[208:211], a[92:95]
    v_exp_f32 v163, v163
    v_mfma_f32_16x16x32_bf16 a[92:95], a[200:203], v[204:207], a[92:95]
    buffer_load_dwordx4 v18, s[12:15], s29 offen offset:3072 lds
    v_smfmac_f32_16x16x64_bf16 a[232:235], v[244:247], v[196:203], v248
    s_waitcnt vmcnt(8) lgkmcnt(6)
    s_barrier
    s_add_u32 s29, s29, 16384
    v_mfma_f32_16x16x32_bf16 v[156:159], a[160:163], v[68:71], v[108:111]
    v_exp_f32 v164, v164
    v_mfma_f32_16x16x32_bf16 v[156:159], a[164:167], v[72:75], v[156:159]
    ds_read_b64_tr_b16 a[192:193], v5 offset:16384
    v_cvt_pk_bf16_f32 v241, v162, v163
    v_mfma_f32_16x16x32_bf16 v[156:159], a[168:171], v[76:79], v[156:159]
    v_exp_f32 v165, v165
    v_mfma_f32_16x16x32_bf16 v[156:159], a[172:175], v[80:83], v[156:159]
    ds_read_b64_tr_b16 a[194:195], v5 offset:20480
    v_mfma_f32_16x16x32_bf16 v[160:163], a[172:175], v[96:99], v[112:115]
    v_exp_f32 v166, v166
    v_mfma_f32_16x16x32_bf16 v[160:163], a[168:171], v[92:95], v[160:163]
    ds_read_b128 a[128:131], v1 offset:0
    v_cvt_pk_bf16_f32 v218, v164, v165
    v_mfma_f32_16x16x32_bf16 v[160:163], a[164:167], v[88:91], v[160:163]
    v_exp_f32 v167, v167
    v_mfma_f32_16x16x32_bf16 v[160:163], a[160:163], v[84:87], v[160:163]
    ds_read_b64_tr_b16 a[196:197], v5 offset:40960
    v_mfma_f32_16x16x32_bf16 a[96:99], a[208:211], v[180:183], a[96:99]
    v_exp_f32 v168, v168
    v_mfma_f32_16x16x32_bf16 a[96:99], a[212:215], v[184:187], a[96:99]
    ds_read_b64_tr_b16 a[198:199], v5 offset:45056
    v_cvt_pk_bf16_f32 v219, v166, v167
    v_mfma_f32_16x16x32_bf16 a[100:103], a[212:215], v[192:195], a[100:103]
    v_exp_f32 v169, v169
    v_mfma_f32_16x16x32_bf16 a[100:103], a[208:211], v[188:191], a[100:103]
    ds_read_b128 a[132:135], v2 offset:0
    v_cvt_pk_bf16_f32 v226, v168, v169
    v_mfma_f32_16x16x32_bf16 a[104:107], a[208:211], v[196:199], a[104:107]
    s_add_u32 m0, s34, 16384
    v_exp_f32 v170, v170
    v_mfma_f32_16x16x32_bf16 a[104:107], a[212:215], v[200:203], a[104:107]
    buffer_load_dwordx4 v13, s[8:11], s28 offen offset:0 lds
    v_mfma_f32_16x16x32_bf16 a[108:111], a[212:215], v[208:211], a[108:111]
    v_exp_f32 v171, v171
    v_mfma_f32_16x16x32_bf16 a[108:111], a[208:211], v[204:207], a[108:111]
    s_waitcnt lgkmcnt(6)
    v_mfma_f32_16x16x32_bf16 v[164:167], a[176:179], v[36:39], v[100:103]
    s_mov_b32 s36, s5
    v_exp_f32 v172, v172
    v_mfma_f32_16x16x32_bf16 v[164:167], a[180:183], v[40:43], v[164:167]
    ds_read_b64_tr_b16 a[200:201], v6 offset:16384
    v_cvt_pk_bf16_f32 v227, v170, v171
    v_mfma_f32_16x16x32_bf16 v[164:167], a[184:187], v[44:47], v[164:167]
    v_exp_f32 v173, v173
    v_mfma_f32_16x16x32_bf16 v[164:167], a[188:191], v[48:51], v[164:167]
    ds_read_b64_tr_b16 a[202:203], v6 offset:20480
    v_mfma_f32_16x16x32_bf16 v[168:171], a[188:191], v[64:67], v[104:107]
    v_exp_f32 v174, v174
    v_mfma_f32_16x16x32_bf16 v[168:171], a[184:187], v[60:63], v[168:171]
    ds_read_b128 a[136:139], v3 offset:0
    v_cvt_pk_bf16_f32 v234, v172, v173
    v_mfma_f32_16x16x32_bf16 v[168:171], a[180:183], v[56:59], v[168:171]
    v_exp_f32 v175, v175
    v_mfma_f32_16x16x32_bf16 v[168:171], a[176:179], v[52:55], v[168:171]
    ds_read_b64_tr_b16 a[204:205], v6 offset:40960
    v_mfma_f32_16x16x32_bf16 a[112:115], a[216:219], v[180:183], a[112:115]
    v_exp_f32 v176, v176
    v_mfma_f32_16x16x32_bf16 a[112:115], a[220:223], v[184:187], a[112:115]
    ds_read_b64_tr_b16 a[206:207], v6 offset:45056
    v_cvt_pk_bf16_f32 v235, v174, v175
    v_mfma_f32_16x16x32_bf16 a[116:119], a[220:223], v[192:195], a[116:119]
    v_exp_f32 v177, v177
    v_mfma_f32_16x16x32_bf16 a[116:119], a[216:219], v[188:191], a[116:119]
    ds_read_b128 a[140:143], v4 offset:0
    v_mfma_f32_16x16x32_bf16 a[120:123], a[216:219], v[196:199], a[120:123]
    v_exp_f32 v178, v178
    v_mfma_f32_16x16x32_bf16 a[120:123], a[220:223], v[200:203], a[120:123]
    v_cvt_pk_bf16_f32 v242, v176, v177
    v_mfma_f32_16x16x32_bf16 a[124:127], a[220:223], v[208:211], a[124:127]
    v_exp_f32 v179, v179
    v_mfma_f32_16x16x32_bf16 a[124:127], a[216:219], v[204:207], a[124:127]
    buffer_load_dwordx4 v14, s[8:11], s28 offen offset:1024 lds
    v_smfmac_f32_16x16x64_bf16 a[236:239], v[244:247], v[204:211], v248
    s_waitcnt lgkmcnt(6)
    s_sub_u32 s35, s35, 1
    s_cbranch_scc0 L_attn_loop
    v_mfma_f32_16x16x32_bf16 v[172:175], a[176:179], v[68:71], v[108:111]
    s_bfe_u32 s47, s2, 0x10003
    v_exp_f32 v116, v116
    v_mfma_f32_16x16x32_bf16 v[172:175], a[180:183], v[72:75], v[172:175]
    s_bfe_u32 s40, s2, 0x20001
    ds_read_b64_tr_b16 a[208:209], v7 offset:16384
    v_cvt_pk_bf16_f32 v243, v178, v179
    v_mfma_f32_16x16x32_bf16 v[172:175], a[184:187], v[76:79], v[172:175]
    s_lshl_b32 s40, s40, 3
    v_exp_f32 v117, v117
    v_mfma_f32_16x16x32_bf16 v[172:175], a[188:191], v[80:83], v[172:175]
    s_bfe_u32 s41, s2, 0x30003
    ds_read_b64_tr_b16 a[210:211], v7 offset:20480
    v_and_b32 v21, 7, v19
    v_mfma_f32_16x16x32_bf16 v[176:179], a[188:191], v[96:99], v[112:115]
    s_add_u32 s87, s40, s41
    v_exp_f32 v118, v118
    v_mfma_f32_16x16x32_bf16 v[176:179], a[184:187], v[92:95], v[176:179]
    s_and_b32 s40, s2, 1
    ds_read_b128 a[144:147], v1 offset:4096
    v_cvt_pk_bf16_f32 v180, v116, v117
    v_mfma_f32_16x16x32_bf16 v[176:179], a[180:183], v[88:91], v[176:179]
    s_lshl_b32 s40, s40, 2
    v_exp_f32 v119, v119
    v_mfma_f32_16x16x32_bf16 v[176:179], a[176:179], v[84:87], v[176:179]
    s_lshr_b32 s41, s2, 6
    ds_read_b64_tr_b16 a[212:213], v7 offset:40960
    v_lshlrev_b32 v21, 2, v21
    v_mfma_f32_16x16x32_bf16 a[0:3], a[192:195], v[212:215], a[0:3]
    s_add_u32 s100, s40, s41
    v_exp_f32 v120, v120
    v_mfma_f32_16x16x32_bf16 a[0:3], a[196:199], v[216:219], a[0:3]
    s_add_u32 s16, s72, 0x1a00000
    s_addc_u32 s17, s73, 0
    ds_read_b64_tr_b16 a[214:215], v7 offset:45056
    v_cvt_pk_bf16_f32 v181, v118, v119
    v_mfma_f32_16x16x32_bf16 a[4:7], a[196:199], v[224:227], a[4:7]
    s_mov_b32 s18, 0x438000
    v_exp_f32 v121, v121
    v_mfma_f32_16x16x32_bf16 a[4:7], a[192:195], v[220:223], a[4:7]
    s_mov_b32 s19, 0x20000
    ds_read_b128 a[148:151], v2 offset:4096
    v_cvt_pk_bf16_f32 v188, v120, v121
    v_mfma_f32_16x16x32_bf16 a[8:11], a[192:195], v[228:231], a[8:11]
    v_exp_f32 v122, v122
    v_mfma_f32_16x16x32_bf16 a[8:11], a[196:199], v[232:235], a[8:11]
    buffer_load_dwordx4 v15, s[8:11], s28 offen offset:2048 lds
    v_add_u32 v21, 0x29b000, v21
    v_mfma_f32_16x16x32_bf16 a[12:15], a[196:199], v[240:243], a[12:15]
    v_exp_f32 v123, v123
    v_mfma_f32_16x16x32_bf16 a[12:15], a[192:195], v[236:239], a[12:15]
    s_waitcnt lgkmcnt(6)
    buffer_load_dword v249, v21, s[76:79], 0 offen sc1
    v_mfma_f32_16x16x32_bf16 v[116:119], a[128:131], v[36:39], v[100:103]
    v_exp_f32 v124, v124
    v_mfma_f32_16x16x32_bf16 v[116:119], a[132:135], v[40:43], v[116:119]
    ds_read_b64_tr_b16 a[216:217], v8 offset:16384
    v_cvt_pk_bf16_f32 v189, v122, v123
    v_mfma_f32_16x16x32_bf16 v[116:119], a[136:139], v[44:47], v[116:119]
    v_exp_f32 v125, v125
    v_mfma_f32_16x16x32_bf16 v[116:119], a[140:143], v[48:51], v[116:119]
    ds_read_b64_tr_b16 a[218:219], v8 offset:20480
    v_lshlrev_b32 v32, 7, v19
    v_mfma_f32_16x16x32_bf16 v[120:123], a[140:143], v[64:67], v[104:107]
    v_exp_f32 v126, v126
    v_mfma_f32_16x16x32_bf16 v[120:123], a[136:139], v[60:63], v[120:123]
    ds_read_b128 a[152:155], v3 offset:4096
    v_cvt_pk_bf16_f32 v196, v124, v125
    v_mfma_f32_16x16x32_bf16 v[120:123], a[132:135], v[56:59], v[120:123]
    v_exp_f32 v127, v127
    v_mfma_f32_16x16x32_bf16 v[120:123], a[128:131], v[52:55], v[120:123]
    ds_read_b64_tr_b16 a[220:221], v8 offset:40960
    v_add_u32 v32, 0x290000, v32
    v_mfma_f32_16x16x32_bf16 a[16:19], a[200:203], v[212:215], a[16:19]
    v_exp_f32 v128, v128
    v_mfma_f32_16x16x32_bf16 a[16:19], a[204:207], v[216:219], a[16:19]
    ds_read_b64_tr_b16 a[222:223], v8 offset:45056
    v_cvt_pk_bf16_f32 v197, v126, v127
    v_mfma_f32_16x16x32_bf16 a[20:23], a[204:207], v[224:227], a[20:23]
    v_exp_f32 v129, v129
    v_mfma_f32_16x16x32_bf16 a[20:23], a[200:203], v[220:223], a[20:23]
    ds_read_b128 a[156:159], v4 offset:4096
    v_mfma_f32_16x16x32_bf16 a[24:27], a[200:203], v[228:231], a[24:27]
    v_exp_f32 v130, v130
    v_mfma_f32_16x16x32_bf16 a[24:27], a[204:207], v[232:235], a[24:27]
    v_cvt_pk_bf16_f32 v204, v128, v129
    v_mfma_f32_16x16x32_bf16 a[28:31], a[204:207], v[240:243], a[28:31]
    v_exp_f32 v131, v131
    v_mfma_f32_16x16x32_bf16 a[28:31], a[200:203], v[236:239], a[28:31]
    buffer_load_dwordx4 v16, s[8:11], s28 offen offset:3072 lds
    v_smfmac_f32_16x16x64_bf16 a[224:227], v[244:247], v[212:219], v248
    s_waitcnt lgkmcnt(6)
    buffer_load_dwordx4 v[28:31], v32, s[76:79], 0 offen sc1
    v_mfma_f32_16x16x32_bf16 v[124:127], a[128:131], v[68:71], v[108:111]
    v_exp_f32 v132, v132
    v_mfma_f32_16x16x32_bf16 v[124:127], a[132:135], v[72:75], v[124:127]
    ds_read_b64_tr_b16 a[192:193], v9 offset:16384
    v_cvt_pk_bf16_f32 v205, v130, v131
    v_mfma_f32_16x16x32_bf16 v[124:127], a[136:139], v[76:79], v[124:127]
    v_exp_f32 v133, v133
    v_mfma_f32_16x16x32_bf16 v[124:127], a[140:143], v[80:83], v[124:127]
    ds_read_b64_tr_b16 a[194:195], v9 offset:20480
    v_mov_b32 v24, 0x3f803f80
    v_mfma_f32_16x16x32_bf16 v[128:131], a[140:143], v[96:99], v[112:115]
    v_exp_f32 v134, v134
    v_mfma_f32_16x16x32_bf16 v[128:131], a[136:139], v[92:95], v[128:131]
    ds_read_b128 a[160:163], v1 offset:8192
    v_cvt_pk_bf16_f32 v182, v132, v133
    v_mfma_f32_16x16x32_bf16 v[128:131], a[132:135], v[88:91], v[128:131]
    v_exp_f32 v135, v135
    v_accvgpr_write_b32 a240, v24
    v_mfma_f32_16x16x32_bf16 v[128:131], a[128:131], v[84:87], v[128:131]
    ds_read_b64_tr_b16 a[196:197], v9 offset:40960
    v_accvgpr_write_b32 a241, v24
    v_mfma_f32_16x16x32_bf16 a[32:35], a[208:211], v[212:215], a[32:35]
    v_exp_f32 v136, v136
    v_mfma_f32_16x16x32_bf16 a[32:35], a[212:215], v[216:219], a[32:35]
    ds_read_b64_tr_b16 a[198:199], v9 offset:45056
    v_cvt_pk_bf16_f32 v183, v134, v135
    v_lshlrev_b32 v25, 4, v19
    v_mfma_f32_16x16x32_bf16 a[36:39], a[212:215], v[224:227], a[36:39]
    s_mul_i32 s40, s5, 3072
    v_exp_f32 v137, v137
    v_mfma_f32_16x16x32_bf16 a[36:39], a[208:211], v[220:223], a[36:39]
    s_mul_i32 s41, s6, 10240
    ds_read_b128 a[164:167], v2 offset:8192
    v_cvt_pk_bf16_f32 v190, v136, v137
    v_mfma_f32_16x16x32_bf16 a[40:43], a[208:211], v[228:231], a[40:43]
    s_add_u32 s28, s28, 16384
    s_mov_b32 m0, s33
    v_exp_f32 v138, v138
    v_accvgpr_write_b32 a242, v24
    v_mfma_f32_16x16x32_bf16 a[40:43], a[212:215], v[232:235], a[40:43]
    s_add_u32 s41, s41, s40
    buffer_load_dwordx4 v17, s[12:15], s29 offen offset:0 lds
    v_mfma_f32_16x16x32_bf16 a[44:47], a[212:215], v[240:243], a[44:47]
    v_exp_f32 v139, v139
    v_mfma_f32_16x16x32_bf16 a[44:47], a[208:211], v[236:239], a[44:47]
    s_waitcnt lgkmcnt(6)
    v_accvgpr_write_b32 a243, v24
    v_accvgpr_write_b32 a244, v24
    v_mfma_f32_16x16x32_bf16 v[132:135], a[144:147], v[36:39], v[100:103]
    v_exp_f32 v140, v140
    v_mfma_f32_16x16x32_bf16 v[132:135], a[148:151], v[40:43], v[132:135]
    ds_read_b64_tr_b16 a[200:201], v10 offset:16384
    v_cvt_pk_bf16_f32 v191, v138, v139
    v_mfma_f32_16x16x32_bf16 v[132:135], a[152:155], v[44:47], v[132:135]
    v_exp_f32 v141, v141
    v_mfma_f32_16x16x32_bf16 v[132:135], a[156:159], v[48:51], v[132:135]
    ds_read_b64_tr_b16 a[202:203], v10 offset:20480
    v_accvgpr_write_b32 a245, v24
    v_mfma_f32_16x16x32_bf16 v[136:139], a[156:159], v[64:67], v[104:107]
    v_exp_f32 v142, v142
    v_mfma_f32_16x16x32_bf16 v[136:139], a[152:155], v[60:63], v[136:139]
    ds_read_b128 a[168:171], v3 offset:8192
    v_cvt_pk_bf16_f32 v198, v140, v141
    v_mfma_f32_16x16x32_bf16 v[136:139], a[148:151], v[56:59], v[136:139]
    v_exp_f32 v143, v143
    v_mfma_f32_16x16x32_bf16 v[136:139], a[144:147], v[52:55], v[136:139]
    ds_read_b64_tr_b16 a[204:205], v10 offset:40960
    v_accvgpr_write_b32 a246, v24
    v_mfma_f32_16x16x32_bf16 a[48:51], a[216:219], v[212:215], a[48:51]
    v_exp_f32 v144, v144
    v_mfma_f32_16x16x32_bf16 a[48:51], a[220:223], v[216:219], a[48:51]
    ds_read_b64_tr_b16 a[206:207], v10 offset:45056
    v_cvt_pk_bf16_f32 v199, v142, v143
    v_mfma_f32_16x16x32_bf16 a[52:55], a[220:223], v[224:227], a[52:55]
    v_exp_f32 v145, v145
    v_mfma_f32_16x16x32_bf16 a[52:55], a[216:219], v[220:223], a[52:55]
    ds_read_b128 a[172:175], v4 offset:8192
    v_accvgpr_write_b32 a247, v24
    v_mfma_f32_16x16x32_bf16 a[56:59], a[216:219], v[228:231], a[56:59]
    v_exp_f32 v146, v146
    v_mfma_f32_16x16x32_bf16 a[56:59], a[220:223], v[232:235], a[56:59]
    v_cvt_pk_bf16_f32 v206, v144, v145
    v_accvgpr_write_b32 a248, v24
    v_mfma_f32_16x16x32_bf16 a[60:63], a[220:223], v[240:243], a[60:63]
    v_exp_f32 v147, v147
    v_mfma_f32_16x16x32_bf16 a[60:63], a[216:219], v[236:239], a[60:63]
    buffer_load_dwordx4 v18, s[12:15], s29 offen offset:1024 lds
    v_smfmac_f32_16x16x64_bf16 a[228:231], v[244:247], v[220:227], v248
    s_waitcnt lgkmcnt(6)
    v_accvgpr_write_b32 a249, v24
    v_accvgpr_write_b32 a250, v24
    v_mfma_f32_16x16x32_bf16 v[140:143], a[144:147], v[68:71], v[108:111]
    v_exp_f32 v148, v148
    v_mfma_f32_16x16x32_bf16 v[140:143], a[148:151], v[72:75], v[140:143]
    ds_read_b64_tr_b16 a[208:209], v11 offset:16384
    v_cvt_pk_bf16_f32 v207, v146, v147
    v_mfma_f32_16x16x32_bf16 v[140:143], a[152:155], v[76:79], v[140:143]
    v_exp_f32 v149, v149
    v_mfma_f32_16x16x32_bf16 v[140:143], a[156:159], v[80:83], v[140:143]
    ds_read_b64_tr_b16 a[210:211], v11 offset:20480
    v_accvgpr_write_b32 a251, v24
    v_mfma_f32_16x16x32_bf16 v[144:147], a[156:159], v[96:99], v[112:115]
    v_exp_f32 v150, v150
    v_mfma_f32_16x16x32_bf16 v[144:147], a[152:155], v[92:95], v[144:147]
    ds_read_b128 a[176:179], v1 offset:12288
    v_cvt_pk_bf16_f32 v184, v148, v149
    v_mfma_f32_16x16x32_bf16 v[144:147], a[148:151], v[88:91], v[144:147]
    v_exp_f32 v151, v151
    v_mfma_f32_16x16x32_bf16 v[144:147], a[144:147], v[84:87], v[144:147]
    ds_read_b64_tr_b16 a[212:213], v11 offset:40960
    v_accvgpr_write_b32 a252, v24
    v_mfma_f32_16x16x32_bf16 a[64:67], a[192:195], v[212:215], a[64:67]
    v_exp_f32 v152, v152
    v_mfma_f32_16x16x32_bf16 a[64:67], a[196:199], v[216:219], a[64:67]
    ds_read_b64_tr_b16 a[214:215], v11 offset:45056
    v_cvt_pk_bf16_f32 v185, v150, v151
    v_mfma_f32_16x16x32_bf16 a[68:71], a[196:199], v[224:227], a[68:71]
    v_exp_f32 v153, v153
    v_mfma_f32_16x16x32_bf16 a[68:71], a[192:195], v[220:223], a[68:71]
    ds_read_b128 a[180:183], v2 offset:12288
    v_cvt_pk_bf16_f32 v192, v152, v153
    v_mfma_f32_16x16x32_bf16 a[72:75], a[192:195], v[228:231], a[72:75]
    v_exp_f32 v154, v154
    v_mfma_f32_16x16x32_bf16 a[72:75], a[196:199], v[232:235], a[72:75]
    buffer_load_dwordx4 v17, s[12:15], s29 offen offset:2048 lds
    s_mov_b32 s43, m0
    s_add_u32 m0, s40, 86016
    s_nop 0
    buffer_load_dwordx4 v25, s[96:99], s41 offen offset:0 lds
    s_mov_b32 m0, s43
    v_accvgpr_write_b32 a253, v24
    v_mfma_f32_16x16x32_bf16 a[76:79], a[196:199], v[240:243], a[76:79]
    v_exp_f32 v155, v155
    v_mfma_f32_16x16x32_bf16 a[76:79], a[192:195], v[236:239], a[76:79]
    s_waitcnt lgkmcnt(6)
    v_accvgpr_write_b32 a254, v24
    v_accvgpr_write_b32 a255, v24
    v_mfma_f32_16x16x32_bf16 v[148:151], a[160:163], v[36:39], v[100:103]
    v_exp_f32 v156, v156
    v_mfma_f32_16x16x32_bf16 v[148:151], a[164:167], v[40:43], v[148:151]
    ds_read_b64_tr_b16 a[216:217], v12 offset:16384
    v_cvt_pk_bf16_f32 v193, v154, v155
    v_mfma_f32_16x16x32_bf16 v[148:151], a[168:171], v[44:47], v[148:151]
    v_exp_f32 v157, v157
    v_mfma_f32_16x16x32_bf16 v[148:151], a[172:175], v[48:51], v[148:151]
    ds_read_b64_tr_b16 a[218:219], v12 offset:20480
    v_mov_b32 v252, v24
    v_mfma_f32_16x16x32_bf16 v[152:155], a[172:175], v[64:67], v[104:107]
    v_exp_f32 v158, v158
    v_mfma_f32_16x16x32_bf16 v[152:155], a[168:171], v[60:63], v[152:155]
    ds_read_b128 a[184:187], v3 offset:12288
    v_cvt_pk_bf16_f32 v200, v156, v157
    v_mfma_f32_16x16x32_bf16 v[152:155], a[164:167], v[56:59], v[152:155]
    v_exp_f32 v159, v159
    v_mfma_f32_16x16x32_bf16 v[152:155], a[160:163], v[52:55], v[152:155]
    ds_read_b64_tr_b16 a[220:221], v12 offset:40960
    s_mov_b32 s43, m0
    s_add_u32 m0, s40, 86016
    s_nop 0
    buffer_load_dwordx4 v25, s[96:99], s41 offen offset:1024 lds
    s_mov_b32 m0, s43
    v_mov_b32 v253, v24
    v_mfma_f32_16x16x32_bf16 a[80:83], a[200:203], v[212:215], a[80:83]
    v_exp_f32 v160, v160
    v_mfma_f32_16x16x32_bf16 a[80:83], a[204:207], v[216:219], a[80:83]
    ds_read_b64_tr_b16 a[222:223], v12 offset:45056
    v_cvt_pk_bf16_f32 v201, v158, v159
    v_mfma_f32_16x16x32_bf16 a[84:87], a[204:207], v[224:227], a[84:87]
    v_exp_f32 v161, v161
    v_mfma_f32_16x16x32_bf16 a[84:87], a[200:203], v[220:223], a[84:87]
    ds_read_b128 a[188:191], v4 offset:12288
    v_mov_b32 v254, v24
    v_mfma_f32_16x16x32_bf16 a[88:91], a[200:203], v[228:231], a[88:91]
    v_exp_f32 v162, v162
    v_mfma_f32_16x16x32_bf16 a[88:91], a[204:207], v[232:235], a[88:91]
    v_cvt_pk_bf16_f32 v208, v160, v161
    v_mov_b32 v255, v24
    v_mfma_f32_16x16x32_bf16 a[92:95], a[204:207], v[240:243], a[92:95]
    v_exp_f32 v163, v163
    v_mfma_f32_16x16x32_bf16 a[92:95], a[200:203], v[236:239], a[92:95]
    buffer_load_dwordx4 v18, s[12:15], s29 offen offset:3072 lds
    v_smfmac_f32_16x16x64_bf16 a[232:235], v[244:247], v[228:235], v248
    s_waitcnt vmcnt(12) lgkmcnt(6)
    s_barrier
    s_add_u32 s29, s29, 16384
    s_mov_b32 s43, m0
    s_add_u32 m0, s40, 86016
    s_nop 0
    buffer_load_dwordx4 v25, s[96:99], s41 offen offset:2048 lds
    s_mov_b32 m0, s43
    v_mfma_f32_16x16x32_bf16 v[156:159], a[160:163], v[68:71], v[108:111]
    s_waitcnt vmcnt(7)
    v_exp_f32 v164, v164
    v_mfma_f32_16x16x32_bf16 v[156:159], a[164:167], v[72:75], v[156:159]
    ds_read_b64_tr_b16 a[192:193], v5 offset:57344
    v_cvt_pk_bf16_f32 v209, v162, v163
    v_mfma_f32_16x16x32_bf16 v[156:159], a[168:171], v[76:79], v[156:159]
    v_exp_f32 v165, v165
    v_mfma_f32_16x16x32_bf16 v[156:159], a[172:175], v[80:83], v[156:159]
    ds_read_b64_tr_b16 a[194:195], v5 offset:61440
    v_cmp_eq_u32 vcc, 0, v249
    s_and_b64 vcc, vcc, exec
    s_cbranch_scc1 L_spin_sel
L_back_sel:
    v_mfma_f32_16x16x32_bf16 v[160:163], a[172:175], v[96:99], v[112:115]
    v_exp_f32 v166, v166
    v_mfma_f32_16x16x32_bf16 v[160:163], a[168:171], v[92:95], v[160:163]
    ds_read_b128 a[128:131], v1 offset:49152
    v_cvt_pk_bf16_f32 v186, v164, v165
    v_mfma_f32_16x16x32_bf16 v[160:163], a[164:167], v[88:91], v[160:163]
    v_exp_f32 v167, v167
    v_mfma_f32_16x16x32_bf16 v[160:163], a[160:163], v[84:87], v[160:163]
    ds_read_b64_tr_b16 a[196:197], v5 offset:0
    v_min3_u32 v28, v28, v29, v30
    v_mfma_f32_16x16x32_bf16 a[96:99], a[208:211], v[212:215], a[96:99]
    v_exp_f32 v168, v168
    v_mfma_f32_16x16x32_bf16 a[96:99], a[212:215], v[216:219], a[96:99]
    ds_read_b64_tr_b16 a[198:199], v5 offset:4096
    v_cvt_pk_bf16_f32 v187, v166, v167
    v_mfma_f32_16x16x32_bf16 a[100:103], a[212:215], v[224:227], a[100:103]
    v_exp_f32 v169, v169
    v_mfma_f32_16x16x32_bf16 a[100:103], a[208:211], v[220:223], a[100:103]
    ds_read_b128 a[132:135], v2 offset:49152
    v_cvt_pk_bf16_f32 v194, v168, v169
    v_mfma_f32_16x16x32_bf16 a[104:107], a[208:211], v[228:231], a[104:107]
    s_add_u32 m0, s34, 32768
    v_exp_f32 v170, v170
    v_mfma_f32_16x16x32_bf16 a[104:107], a[212:215], v[232:235], a[104:107]
    buffer_load_dwordx4 v13, s[8:11], s28 offen offset:0 lds
    v_mfma_f32_16x16x32_bf16 a[108:111], a[212:215], v[240:243], a[108:111]
    v_exp_f32 v171, v171
    v_mfma_f32_16x16x32_bf16 a[108:111], a[208:211], v[236:239], a[108:111]
    s_waitcnt lgkmcnt(6)
    v_min_u32 v28, v28, v31
    v_cmp_gt_u32 vcc, 1, v28
    s_and_b64 vcc, vcc, exec
    s_cbranch_scc1 L_spin_pack
L_back_pack:
    v_mfma_f32_16x16x32_bf16 v[164:167], a[176:179], v[36:39], v[100:103]
    v_exp_f32 v172, v172
    v_mfma_f32_16x16x32_bf16 v[164:167], a[180:183], v[40:43], v[164:167]
    ds_read_b64_tr_b16 a[200:201], v6 offset:57344
    v_cvt_pk_bf16_f32 v195, v170, v171
    v_mfma_f32_16x16x32_bf16 v[164:167], a[184:187], v[44:47], v[164:167]
    v_exp_f32 v173, v173
    v_mfma_f32_16x16x32_bf16 v[164:167], a[188:191], v[48:51], v[164:167]
    ds_read_b64_tr_b16 a[202:203], v6 offset:61440
    v_mfma_f32_16x16x32_bf16 v[168:171], a[188:191], v[64:67], v[104:107]
    v_exp_f32 v174, v174
    v_mfma_f32_16x16x32_bf16 v[168:171], a[184:187], v[60:63], v[168:171]
    ds_read_b128 a[136:139], v3 offset:49152
    v_cvt_pk_bf16_f32 v202, v172, v173
    v_mfma_f32_16x16x32_bf16 v[168:171], a[180:183], v[56:59], v[168:171]
    v_exp_f32 v175, v175
    v_mfma_f32_16x16x32_bf16 v[168:171], a[176:179], v[52:55], v[168:171]
    ds_read_b64_tr_b16 a[204:205], v6 offset:0
    v_mfma_f32_16x16x32_bf16 a[112:115], a[216:219], v[212:215], a[112:115]
    v_exp_f32 v176, v176
    v_mfma_f32_16x16x32_bf16 a[112:115], a[220:223], v[216:219], a[112:115]
    ds_read_b64_tr_b16 a[206:207], v6 offset:4096
    v_cvt_pk_bf16_f32 v203, v174, v175
    v_mfma_f32_16x16x32_bf16 a[116:119], a[220:223], v[224:227], a[116:119]
    v_exp_f32 v177, v177
    v_mfma_f32_16x16x32_bf16 a[116:119], a[216:219], v[220:223], a[116:119]
    ds_read_b128 a[140:143], v4 offset:49152
    v_mfma_f32_16x16x32_bf16 a[120:123], a[216:219], v[228:231], a[120:123]
    v_exp_f32 v178, v178
    v_mfma_f32_16x16x32_bf16 a[120:123], a[220:223], v[232:235], a[120:123]
    v_cvt_pk_bf16_f32 v210, v176, v177
    v_mfma_f32_16x16x32_bf16 a[124:127], a[220:223], v[240:243], a[124:127]
    v_exp_f32 v179, v179
    v_mfma_f32_16x16x32_bf16 a[124:127], a[216:219], v[236:239], a[124:127]
    buffer_load_dwordx4 v14, s[8:11], s28 offen offset:1024 lds
    v_smfmac_f32_16x16x64_bf16 a[236:239], v[244:247], v[236:243], v248
    s_waitcnt lgkmcnt(6)
    v_mfma_f32_16x16x32_bf16 v[172:175], a[176:179], v[68:71], v[108:111]
    v_exp_f32 v116, v116
    v_mfma_f32_16x16x32_bf16 v[172:175], a[180:183], v[72:75], v[172:175]
    ds_read_b64_tr_b16 a[208:209], v7 offset:57344
    v_cvt_pk_bf16_f32 v211, v178, v179
    v_mfma_f32_16x16x32_bf16 v[172:175], a[184:187], v[76:79], v[172:175]
    v_exp_f32 v117, v117
    v_mfma_f32_16x16x32_bf16 v[172:175], a[188:191], v[80:83], v[172:175]
    ds_read_b64_tr_b16 a[210:211], v7 offset:61440
    v_mov_b32 v22, v249
    v_mfma_f32_16x16x32_bf16 v[176:179], a[188:191], v[96:99], v[112:115]
    v_exp_f32 v118, v118
    v_mfma_f32_16x16x32_bf16 v[176:179], a[184:187], v[92:95], v[176:179]
    ds_read_b128 a[144:147], v1 offset:53248
    v_cvt_pk_bf16_f32 v212, v116, v117
    v_mfma_f32_16x16x32_bf16 v[176:179], a[180:183], v[88:91], v[176:179]
    v_exp_f32 v119, v119
    v_mfma_f32_16x16x32_bf16 v[176:179], a[176:179], v[84:87], v[176:179]
    ds_read_b64_tr_b16 a[212:213], v7 offset:0
    v_not_b32 v22, v22
    v_mfma_f32_16x16x32_bf16 a[0:3], a[192:195], v[180:183], a[0:3]
    v_exp_f32 v120, v120
    v_mfma_f32_16x16x32_bf16 a[0:3], a[196:199], v[184:187], a[0:3]
    ds_read_b64_tr_b16 a[214:215], v7 offset:4096
    v_cvt_pk_bf16_f32 v213, v118, v119
    v_mfma_f32_16x16x32_bf16 a[4:7], a[196:199], v[192:195], a[4:7]
    v_exp_f32 v121, v121
    v_mfma_f32_16x16x32_bf16 a[4:7], a[192:195], v[188:191], a[4:7]
    ds_read_b128 a[148:151], v2 offset:53248
    v_cvt_pk_bf16_f32 v220, v120, v121
    v_mfma_f32_16x16x32_bf16 a[8:11], a[192:195], v[196:199], a[8:11]
    v_exp_f32 v122, v122
    v_and_b32 v22, 0x7ff, v22
    v_mfma_f32_16x16x32_bf16 a[8:11], a[196:199], v[200:203], a[8:11]
    buffer_load_dwordx4 v15, s[8:11], s28 offen offset:2048 lds
    v_mfma_f32_16x16x32_bf16 a[12:15], a[196:199], v[208:211], a[12:15]
    v_exp_f32 v123, v123
    v_mfma_f32_16x16x32_bf16 a[12:15], a[192:195], v[204:207], a[12:15]
    s_waitcnt lgkmcnt(6)
    v_lshrrev_b32 v24, 4, v19
    v_lshlrev_b32 v23, 4, v22
    v_mfma_f32_16x16x32_bf16 v[116:119], a[128:131], v[36:39], v[100:103]
    v_exp_f32 v124, v124
    v_mfma_f32_16x16x32_bf16 v[116:119], a[132:135], v[40:43], v[116:119]
    ds_read_b64_tr_b16 a[216:217], v8 offset:57344
    v_cvt_pk_bf16_f32 v221, v122, v123
    v_mfma_f32_16x16x32_bf16 v[116:119], a[136:139], v[44:47], v[116:119]
    v_exp_f32 v125, v125
    v_mfma_f32_16x16x32_bf16 v[116:119], a[140:143], v[48:51], v[116:119]
    ds_read_b64_tr_b16 a[218:219], v8 offset:61440
    v_mul_u32_u24 v22, 1280, v22
    v_mfma_f32_16x16x32_bf16 v[120:123], a[140:143], v[64:67], v[104:107]
    v_exp_f32 v126, v126
    v_mfma_f32_16x16x32_bf16 v[120:123], a[136:139], v[60:63], v[120:123]
    ds_read_b128 a[152:155], v3 offset:53248
    v_cvt_pk_bf16_f32 v228, v124, v125
    v_mfma_f32_16x16x32_bf16 v[120:123], a[132:135], v[56:59], v[120:123]
    v_exp_f32 v127, v127
    v_mfma_f32_16x16x32_bf16 v[120:123], a[128:131], v[52:55], v[120:123]
    ds_read_b64_tr_b16 a[220:221], v8 offset:0
    v_lshl_add_u32 v22, v24, 4, v22
    v_mfma_f32_16x16x32_bf16 a[16:19], a[200:203], v[180:183], a[16:19]
    s_mul_i32 s40, s5, 320
    v_exp_f32 v128, v128
    v_mfma_f32_16x16x32_bf16 a[16:19], a[204:207], v[184:187], a[16:19]
    s_mov_b32 s41, 0x280000
    ds_read_b64_tr_b16 a[222:223], v8 offset:4096
    v_cvt_pk_bf16_f32 v229, v126, v127
    v_mfma_f32_16x16x32_bf16 a[20:23], a[204:207], v[192:195], a[20:23]
    v_exp_f32 v129, v129
    v_mfma_f32_16x16x32_bf16 a[20:23], a[200:203], v[188:191], a[20:23]
    ds_read_b128 a[156:159], v4 offset:53248
    v_mfma_f32_16x16x32_bf16 a[24:27], a[200:203], v[196:199], a[24:27]
    v_exp_f32 v130, v130
    v_mfma_f32_16x16x32_bf16 a[24:27], a[204:207], v[200:203], a[24:27]
    v_cvt_pk_bf16_f32 v236, v128, v129
    v_mfma_f32_16x16x32_bf16 a[28:31], a[204:207], v[208:211], a[28:31]
    v_exp_f32 v131, v131
    v_mfma_f32_16x16x32_bf16 a[28:31], a[200:203], v[204:207], a[28:31]
    buffer_load_dwordx4 v16, s[8:11], s28 offen offset:3072 lds
    v_smfmac_f32_16x16x64_bf16 a[224:227], v[244:247], v[180:187], v248
    s_waitcnt lgkmcnt(6)
    buffer_load_dwordx2 v[20:21], v23, s[76:79], s41 offen sc1
    v_mfma_f32_16x16x32_bf16 v[124:127], a[128:131], v[68:71], v[108:111]
    v_exp_f32 v132, v132
    v_mfma_f32_16x16x32_bf16 v[124:127], a[132:135], v[72:75], v[124:127]
    ds_read_b64_tr_b16 a[192:193], v9 offset:57344
    v_cvt_pk_bf16_f32 v237, v130, v131
    v_mfma_f32_16x16x32_bf16 v[124:127], a[136:139], v[76:79], v[124:127]
    v_exp_f32 v133, v133
    v_mfma_f32_16x16x32_bf16 v[124:127], a[140:143], v[80:83], v[124:127]
    ds_read_b64_tr_b16 a[194:195], v9 offset:61440
    v_mfma_f32_16x16x32_bf16 v[128:131], a[140:143], v[96:99], v[112:115]
    v_exp_f32 v134, v134
    v_mfma_f32_16x16x32_bf16 v[128:131], a[136:139], v[92:95], v[128:131]
    ds_read_b128 a[160:163], v1 offset:57344
    v_cvt_pk_bf16_f32 v214, v132, v133
    v_mfma_f32_16x16x32_bf16 v[128:131], a[132:135], v[88:91], v[128:131]
    v_exp_f32 v135, v135
    v_mfma_f32_16x16x32_bf16 v[128:131], a[128:131], v[84:87], v[128:131]
    ds_read_b64_tr_b16 a[196:197], v9 offset:0
    v_mfma_f32_16x16x32_bf16 a[32:35], a[208:211], v[180:183], a[32:35]
    v_exp_f32 v136, v136
    v_mfma_f32_16x16x32_bf16 a[32:35], a[212:215], v[184:187], a[32:35]
    ds_read_b64_tr_b16 a[198:199], v9 offset:4096
    v_cvt_pk_bf16_f32 v215, v134, v135
    v_mfma_f32_16x16x32_bf16 a[36:39], a[212:215], v[192:195], a[36:39]
    v_exp_f32 v137, v137
    v_mfma_f32_16x16x32_bf16 a[36:39], a[208:211], v[188:191], a[36:39]
    ds_read_b128 a[164:167], v2 offset:57344
    v_cvt_pk_bf16_f32 v222, v136, v137
    v_mfma_f32_16x16x32_bf16 a[40:43], a[208:211], v[196:199], a[40:43]
    s_add_u32 s28, s28, 16384
    s_mov_b32 m0, s30
    v_exp_f32 v138, v138
    v_mfma_f32_16x16x32_bf16 a[40:43], a[212:215], v[200:203], a[40:43]
    buffer_load_dwordx4 v17, s[12:15], s29 offen offset:0 lds
    v_mfma_f32_16x16x32_bf16 a[44:47], a[212:215], v[208:211], a[44:47]
    s_mov_b32 exec_lo, 0x00ff00ff
    s_mov_b32 exec_hi, 0x00ff00ff
    buffer_load_dwordx4 a[240:243], v22, s[88:91], s40 offen offset:0
    s_mov_b64 exec, -1
    v_exp_f32 v139, v139
    v_mfma_f32_16x16x32_bf16 a[44:47], a[208:211], v[204:207], a[44:47]
    s_waitcnt lgkmcnt(6)
    s_mov_b32 exec_lo, 0x00ff00ff
    s_mov_b32 exec_hi, 0x00ff00ff
    buffer_load_dwordx4 a[244:247], v22, s[88:91], s40 offen offset:64
    s_mov_b64 exec, -1
    v_mfma_f32_16x16x32_bf16 v[132:135], a[144:147], v[36:39], v[100:103]
    v_exp_f32 v140, v140
    v_mfma_f32_16x16x32_bf16 v[132:135], a[148:151], v[40:43], v[132:135]
    ds_read_b64_tr_b16 a[200:201], v10 offset:57344
    v_cvt_pk_bf16_f32 v223, v138, v139
    v_mfma_f32_16x16x32_bf16 v[132:135], a[152:155], v[44:47], v[132:135]
    v_exp_f32 v141, v141
    v_mfma_f32_16x16x32_bf16 v[132:135], a[156:159], v[48:51], v[132:135]
    ds_read_b64_tr_b16 a[202:203], v10 offset:61440
    v_mfma_f32_16x16x32_bf16 v[136:139], a[156:159], v[64:67], v[104:107]
    v_exp_f32 v142, v142
    v_mfma_f32_16x16x32_bf16 v[136:139], a[152:155], v[60:63], v[136:139]
    ds_read_b128 a[168:171], v3 offset:57344
    v_cvt_pk_bf16_f32 v230, v140, v141
    v_mfma_f32_16x16x32_bf16 v[136:139], a[148:151], v[56:59], v[136:139]
    v_exp_f32 v143, v143
    v_mfma_f32_16x16x32_bf16 v[136:139], a[144:147], v[52:55], v[136:139]
    ds_read_b64_tr_b16 a[204:205], v10 offset:0
    s_mov_b32 exec_lo, 0x00ff00ff
    s_mov_b32 exec_hi, 0x00ff00ff
    buffer_load_dwordx4 a[248:251], v22, s[88:91], s40 offen offset:128
    s_mov_b64 exec, -1
    v_mfma_f32_16x16x32_bf16 a[48:51], a[216:219], v[180:183], a[48:51]
    v_exp_f32 v144, v144
    v_mfma_f32_16x16x32_bf16 a[48:51], a[220:223], v[184:187], a[48:51]
    ds_read_b64_tr_b16 a[206:207], v10 offset:4096
    v_cvt_pk_bf16_f32 v231, v142, v143
    v_mfma_f32_16x16x32_bf16 a[52:55], a[220:223], v[192:195], a[52:55]
    v_exp_f32 v145, v145
    v_mfma_f32_16x16x32_bf16 a[52:55], a[216:219], v[188:191], a[52:55]
    ds_read_b128 a[172:175], v4 offset:57344
    v_mfma_f32_16x16x32_bf16 a[56:59], a[216:219], v[196:199], a[56:59]
    s_mov_b32 exec_lo, 0x00ff00ff
    s_mov_b32 exec_hi, 0x00ff00ff
    buffer_load_dwordx4 a[252:255], v22, s[88:91], s40 offen offset:192
    s_mov_b64 exec, -1
    v_exp_f32 v146, v146
    v_mfma_f32_16x16x32_bf16 a[56:59], a[220:223], v[200:203], a[56:59]
    v_cvt_pk_bf16_f32 v238, v144, v145
    v_mfma_f32_16x16x32_bf16 a[60:63], a[220:223], v[208:211], a[60:63]
    v_exp_f32 v147, v147
    v_mfma_f32_16x16x32_bf16 a[60:63], a[216:219], v[204:207], a[60:63]
    buffer_load_dwordx4 v18, s[12:15], s29 offen offset:1024 lds
    v_smfmac_f32_16x16x64_bf16 a[228:231], v[244:247], v[188:195], v248
    s_waitcnt lgkmcnt(6)
    s_mov_b32 exec_lo, 0x00ff00ff
    s_mov_b32 exec_hi, 0x00ff00ff
    buffer_load_dwordx4 v[252:255], v22, s[88:91], s40 offen offset:256
    s_mov_b64 exec, -1
    v_mfma_f32_16x16x32_bf16 v[140:143], a[144:147], v[68:71], v[108:111]
    v_exp_f32 v148, v148
    v_mfma_f32_16x16x32_bf16 v[140:143], a[148:151], v[72:75], v[140:143]
    ds_read_b64_tr_b16 a[208:209], v11 offset:57344
    v_cvt_pk_bf16_f32 v239, v146, v147
    v_mfma_f32_16x16x32_bf16 v[140:143], a[152:155], v[76:79], v[140:143]
    v_exp_f32 v149, v149
    v_lshrrev_b32 v22, 4, v19
    v_mfma_f32_16x16x32_bf16 v[140:143], a[156:159], v[80:83], v[140:143]
    ds_read_b64_tr_b16 a[210:211], v11 offset:61440
    v_bfe_u32 v24, v19, 2, 2
    v_mfma_f32_16x16x32_bf16 v[144:147], a[156:159], v[96:99], v[112:115]
    v_exp_f32 v150, v150
    v_mfma_f32_16x16x32_bf16 v[144:147], a[152:155], v[92:95], v[144:147]
    ds_read_b128 a[176:179], v1 offset:61440
    v_cvt_pk_bf16_f32 v216, v148, v149
    v_mfma_f32_16x16x32_bf16 v[144:147], a[148:151], v[88:91], v[144:147]
    v_exp_f32 v151, v151
    v_lshl_add_u32 v22, v22, 3, v24
    v_mfma_f32_16x16x32_bf16 v[144:147], a[144:147], v[84:87], v[144:147]
    ds_read_b64_tr_b16 a[212:213], v11 offset:0
    v_and_b32 v24, 1, v19
    v_mfma_f32_16x16x32_bf16 a[64:67], a[192:195], v[180:183], a[64:67]
    v_exp_f32 v152, v152
    v_mfma_f32_16x16x32_bf16 a[64:67], a[196:199], v[184:187], a[64:67]
    ds_read_b64_tr_b16 a[214:215], v11 offset:4096
    v_cvt_pk_bf16_f32 v217, v150, v151
    v_mfma_f32_16x16x32_bf16 a[68:71], a[196:199], v[192:195], a[68:71]
    v_exp_f32 v153, v153
    v_mfma_f32_16x16x32_bf16 a[68:71], a[192:195], v[188:191], a[68:71]
    ds_read_b128 a[180:183], v2 offset:61440
    v_cvt_pk_bf16_f32 v224, v152, v153
    v_lshl_add_u32 v22, v22, 1, v24
    v_mfma_f32_16x16x32_bf16 a[72:75], a[192:195], v[196:199], a[72:75]
    v_exp_f32 v154, v154
    v_mfma_f32_16x16x32_bf16 a[72:75], a[196:199], v[200:203], a[72:75]
    buffer_load_dwordx4 v17, s[12:15], s29 offen offset:2048 lds
    v_bfe_u32 v24, v19, 1, 1
    v_mfma_f32_16x16x32_bf16 a[76:79], a[196:199], v[208:211], a[76:79]
    v_exp_f32 v155, v155
    v_mfma_f32_16x16x32_bf16 a[76:79], a[192:195], v[204:207], a[76:79]
    s_waitcnt lgkmcnt(6)
    v_mul_u32_u24 v24, 10240, v24
    v_lshl_add_u32 v22, v22, 3, v24
    v_mfma_f32_16x16x32_bf16 v[148:151], a[160:163], v[36:39], v[100:103]
    s_mul_i32 s42, s5, 2560
    v_exp_f32 v156, v156
    v_mfma_f32_16x16x32_bf16 v[148:151], a[164:167], v[40:43], v[148:151]
    s_add_u32 s42, s42, 65536
    ds_read_b64_tr_b16 a[216:217], v12 offset:57344
    v_cvt_pk_bf16_f32 v225, v154, v155
    v_mfma_f32_16x16x32_bf16 v[148:151], a[168:171], v[44:47], v[148:151]
    v_exp_f32 v157, v157
    v_mfma_f32_16x16x32_bf16 v[148:151], a[172:175], v[48:51], v[148:151]
    ds_read_b64_tr_b16 a[218:219], v12 offset:61440
    v_add_u32 v22, s42, v22
    v_mfma_f32_16x16x32_bf16 v[152:155], a[172:175], v[64:67], v[104:107]
    s_mov_b32 s42, 65536
    v_exp_f32 v158, v158
    v_mfma_f32_16x16x32_bf16 v[152:155], a[168:171], v[60:63], v[152:155]
    ds_read_b128 a[184:187], v3 offset:61440
    v_cvt_pk_bf16_f32 v232, v156, v157
    v_mfma_f32_16x16x32_bf16 v[152:155], a[164:167], v[56:59], v[152:155]
    v_exp_f32 v159, v159
    v_mfma_f32_16x16x32_bf16 v[152:155], a[160:163], v[52:55], v[152:155]
    ds_read_b64_tr_b16 a[220:221], v12 offset:0
    v_lshl_add_u32 v23, v19, 4, s42
    v_mfma_f32_16x16x32_bf16 a[80:83], a[200:203], v[180:183], a[80:83]
    v_exp_f32 v160, v160
    v_mfma_f32_16x16x32_bf16 a[80:83], a[204:207], v[184:187], a[80:83]
    ds_read_b64_tr_b16 a[222:223], v12 offset:4096
    v_cvt_pk_bf16_f32 v233, v158, v159
    v_mfma_f32_16x16x32_bf16 a[84:87], a[204:207], v[192:195], a[84:87]
    v_exp_f32 v161, v161
    v_mfma_f32_16x16x32_bf16 a[84:87], a[200:203], v[188:191], a[84:87]
    ds_read_b128 a[188:191], v4 offset:61440
    v_readlane_b32 s50, v249, 0
    v_mfma_f32_16x16x32_bf16 a[88:91], a[200:203], v[196:199], a[88:91]
    v_exp_f32 v162, v162
    v_mfma_f32_16x16x32_bf16 a[88:91], a[204:207], v[200:203], a[88:91]
    v_cvt_pk_bf16_f32 v240, v160, v161
    v_readlane_b32 s51, v249, 1
    v_mfma_f32_16x16x32_bf16 a[92:95], a[204:207], v[208:211], a[92:95]
    v_exp_f32 v163, v163
    v_mfma_f32_16x16x32_bf16 a[92:95], a[200:203], v[204:207], a[92:95]
    buffer_load_dwordx4 v18, s[12:15], s29 offen offset:3072 lds
    v_smfmac_f32_16x16x64_bf16 a[232:235], v[244:247], v[196:203], v248
    s_waitcnt vmcnt(15) lgkmcnt(6)
    s_barrier
    s_add_u32 s29, s29, 16384
    v_readlane_b32 s52, v249, 2
    v_mfma_f32_16x16x32_bf16 v[156:159], a[160:163], v[68:71], v[108:111]
    v_exp_f32 v164, v164
    v_mfma_f32_16x16x32_bf16 v[156:159], a[164:167], v[72:75], v[156:159]
    ds_read_b64_tr_b16 a[192:193], v5 offset:24576
    v_cvt_pk_bf16_f32 v241, v162, v163
    v_mfma_f32_16x16x32_bf16 v[156:159], a[168:171], v[76:79], v[156:159]
    v_exp_f32 v165, v165
    v_mfma_f32_16x16x32_bf16 v[156:159], a[172:175], v[80:83], v[156:159]
    ds_read_b64_tr_b16 a[194:195], v5 offset:28672
    v_readlane_b32 s53, v249, 3
    v_mfma_f32_16x16x32_bf16 v[160:163], a[172:175], v[96:99], v[112:115]
    v_exp_f32 v166, v166
    v_mfma_f32_16x16x32_bf16 v[160:163], a[168:171], v[92:95], v[160:163]
    ds_read_b128 a[128:131], v1 offset:16384
    v_cvt_pk_bf16_f32 v218, v164, v165
    v_mfma_f32_16x16x32_bf16 v[160:163], a[164:167], v[88:91], v[160:163]
    v_exp_f32 v167, v167
    v_mfma_f32_16x16x32_bf16 v[160:163], a[160:163], v[84:87], v[160:163]
    ds_read_b64_tr_b16 a[196:197], v5 offset:49152
    v_readlane_b32 s54, v249, 4
    v_mfma_f32_16x16x32_bf16 a[96:99], a[208:211], v[180:183], a[96:99]
    v_exp_f32 v168, v168
    v_mfma_f32_16x16x32_bf16 a[96:99], a[212:215], v[184:187], a[96:99]
    ds_read_b64_tr_b16 a[198:199], v5 offset:53248
    v_cvt_pk_bf16_f32 v219, v166, v167
    v_mfma_f32_16x16x32_bf16 a[100:103], a[212:215], v[192:195], a[100:103]
    v_exp_f32 v169, v169
    v_mfma_f32_16x16x32_bf16 a[100:103], a[208:211], v[188:191], a[100:103]
    ds_read_b128 a[132:135], v2 offset:16384
    v_cvt_pk_bf16_f32 v226, v168, v169
    v_readlane_b32 s55, v249, 5
    v_mfma_f32_16x16x32_bf16 a[104:107], a[208:211], v[196:199], a[104:107]
    s_add_u32 m0, s34, 0
    v_exp_f32 v170, v170
    v_mfma_f32_16x16x32_bf16 a[104:107], a[212:215], v[200:203], a[104:107]
    buffer_load_dwordx4 v13, s[8:11], s28 offen offset:0 lds
    v_readlane_b32 s56, v249, 6
    v_mfma_f32_16x16x32_bf16 a[108:111], a[212:215], v[208:211], a[108:111]
    v_exp_f32 v171, v171
    v_mfma_f32_16x16x32_bf16 a[108:111], a[208:211], v[204:207], a[108:111]
    s_waitcnt lgkmcnt(6)
    v_readlane_b32 s57, v249, 7
    v_mfma_f32_16x16x32_bf16 v[164:167], a[176:179], v[36:39], v[100:103]
    v_exp_f32 v172, v172
    v_mfma_f32_16x16x32_bf16 v[164:167], a[180:183], v[40:43], v[164:167]
    ds_read_b64_tr_b16 a[200:201], v6 offset:24576
    v_cvt_pk_bf16_f32 v227, v170, v171
    v_mfma_f32_16x16x32_bf16 v[164:167], a[184:187], v[44:47], v[164:167]
    v_exp_f32 v173, v173
    v_mfma_f32_16x16x32_bf16 v[164:167], a[188:191], v[48:51], v[164:167]
    ds_read_b64_tr_b16 a[202:203], v6 offset:28672
    v_mfma_f32_16x16x32_bf16 v[168:171], a[188:191], v[64:67], v[104:107]
    v_exp_f32 v174, v174
    v_mfma_f32_16x16x32_bf16 v[168:171], a[184:187], v[60:63], v[168:171]
    ds_read_b128 a[136:139], v3 offset:16384
    v_cvt_pk_bf16_f32 v234, v172, v173
    v_mfma_f32_16x16x32_bf16 v[168:171], a[180:183], v[56:59], v[168:171]
    v_exp_f32 v175, v175
    v_mfma_f32_16x16x32_bf16 v[168:171], a[176:179], v[52:55], v[168:171]
    ds_read_b64_tr_b16 a[204:205], v6 offset:49152
    ds_read_b64_tr_b16 v[24:25], v22 offset:0
    v_mfma_f32_16x16x32_bf16 a[112:115], a[216:219], v[180:183], a[112:115]
    v_exp_f32 v176, v176
    v_mfma_f32_16x16x32_bf16 a[112:115], a[220:223], v[184:187], a[112:115]
    ds_read_b64_tr_b16 a[206:207], v6 offset:53248
    v_cvt_pk_bf16_f32 v235, v174, v175
    v_mfma_f32_16x16x32_bf16 a[116:119], a[220:223], v[192:195], a[116:119]
    v_exp_f32 v177, v177
    v_mfma_f32_16x16x32_bf16 a[116:119], a[216:219], v[188:191], a[116:119]
    ds_read_b128 a[140:143], v4 offset:16384
    ds_read_b64_tr_b16 v[26:27], v22 offset:64
    v_mfma_f32_16x16x32_bf16 a[120:123], a[216:219], v[196:199], a[120:123]
    v_exp_f32 v178, v178
    v_mfma_f32_16x16x32_bf16 a[120:123], a[220:223], v[200:203], a[120:123]
    ds_read_b64_tr_b16 v[28:29], v22 offset:512
    v_cvt_pk_bf16_f32 v242, v176, v177
    v_mfma_f32_16x16x32_bf16 a[124:127], a[220:223], v[208:211], a[124:127]
    v_exp_f32 v179, v179
    v_mfma_f32_16x16x32_bf16 a[124:127], a[216:219], v[204:207], a[124:127]
    buffer_load_dwordx4 v14, s[8:11], s28 offen offset:1024 lds
    v_smfmac_f32_16x16x64_bf16 a[236:239], v[244:247], v[204:211], v248
    s_waitcnt lgkmcnt(6)
    ds_read_b64_tr_b16 v[30:31], v22 offset:576
    v_mfma_f32_16x16x32_bf16 v[172:175], a[176:179], v[68:71], v[108:111]
    v_exp_f32 v116, v116
    v_mfma_f32_16x16x32_bf16 v[172:175], a[180:183], v[72:75], v[172:175]
    ds_read_b64_tr_b16 a[208:209], v7 offset:24576
    v_cvt_pk_bf16_f32 v243, v178, v179
    v_mfma_f32_16x16x32_bf16 v[172:175], a[184:187], v[76:79], v[172:175]
    v_exp_f32 v117, v117
    v_mfma_f32_16x16x32_bf16 v[172:175], a[188:191], v[80:83], v[172:175]
    ds_read_b64_tr_b16 a[210:211], v7 offset:28672
    v_mfma_f32_16x16x32_bf16 v[176:179], a[188:191], v[96:99], v[112:115]
    v_exp_f32 v118, v118
    v_mfma_f32_16x16x32_bf16 v[176:179], a[184:187], v[92:95], v[176:179]
    ds_read_b128 a[144:147], v1 offset:20480
    v_cvt_pk_bf16_f32 v180, v116, v117
    v_mfma_f32_16x16x32_bf16 v[176:179], a[180:183], v[88:91], v[176:179]
    v_exp_f32 v119, v119
    v_mfma_f32_16x16x32_bf16 v[176:179], a[176:179], v[84:87], v[176:179]
    ds_read_b64_tr_b16 a[212:213], v7 offset:49152
    v_mfma_f32_16x16x32_bf16 a[0:3], a[192:195], v[212:215], a[0:3]
    v_exp_f32 v120, v120
    v_mfma_f32_16x16x32_bf16 a[0:3], a[196:199], v[216:219], a[0:3]
    ds_read_b64_tr_b16 a[214:215], v7 offset:53248
    v_cvt_pk_bf16_f32 v181, v118, v119
    v_mfma_f32_16x16x32_bf16 a[4:7], a[196:199], v[224:227], a[4:7]
    v_exp_f32 v121, v121
    v_mfma_f32_16x16x32_bf16 a[4:7], a[192:195], v[220:223], a[4:7]
    ds_read_b128 a[148:151], v2 offset:20480
    v_cvt_pk_bf16_f32 v188, v120, v121
    v_mfma_f32_16x16x32_bf16 a[8:11], a[192:195], v[228:231], a[8:11]
    v_exp_f32 v122, v122
    v_mfma_f32_16x16x32_bf16 a[8:11], a[196:199], v[232:235], a[8:11]
    buffer_load_dwordx4 v15, s[8:11], s28 offen offset:2048 lds
    v_mfma_f32_16x16x32_bf16 a[12:15], a[196:199], v[240:243], a[12:15]
    v_exp_f32 v123, v123
    v_mfma_f32_16x16x32_bf16 a[12:15], a[192:195], v[236:239], a[12:15]
    s_waitcnt lgkmcnt(6)
    v_mfma_f32_16x16x32_bf16 v[116:119], a[128:131], v[36:39], v[100:103]
    s_waitcnt vmcnt(5)
    v_exp_f32 v124, v124
    v_mfma_f32_16x16x32_bf16 v[32:35], v[24:27], a[240:243], 0
    v_mfma_f32_16x16x32_bf16 v[32:35], v[28:31], a[244:247], v[32:35]
    ds_read_b64_tr_b16 v[24:25], v22 offset:1024
    v_mfma_f32_16x16x32_bf16 v[116:119], a[132:135], v[40:43], v[116:119]
    ds_read_b64_tr_b16 a[216:217], v8 offset:24576
    v_cvt_pk_bf16_f32 v189, v122, v123
    v_mfma_f32_16x16x32_bf16 v[116:119], a[136:139], v[44:47], v[116:119]
    v_exp_f32 v125, v125
    v_mfma_f32_16x16x32_bf16 v[116:119], a[140:143], v[48:51], v[116:119]
    ds_read_b64_tr_b16 a[218:219], v8 offset:28672
    v_mfma_f32_16x16x32_bf16 v[120:123], a[140:143], v[64:67], v[104:107]
    v_exp_f32 v126, v126
    v_mfma_f32_16x16x32_bf16 v[120:123], a[136:139], v[60:63], v[120:123]
    ds_read_b128 a[152:155], v3 offset:20480
    v_cvt_pk_bf16_f32 v196, v124, v125
    v_mfma_f32_16x16x32_bf16 v[120:123], a[132:135], v[56:59], v[120:123]
    v_exp_f32 v127, v127
    v_mfma_f32_16x16x32_bf16 v[120:123], a[128:131], v[52:55], v[120:123]
    ds_read_b64_tr_b16 a[220:221], v8 offset:49152
    v_mfma_f32_16x16x32_bf16 a[16:19], a[200:203], v[212:215], a[16:19]
    v_exp_f32 v128, v128
    v_mfma_f32_16x16x32_bf16 a[16:19], a[204:207], v[216:219], a[16:19]
    ds_read_b64_tr_b16 a[222:223], v8 offset:53248
    v_cvt_pk_bf16_f32 v197, v126, v127
    v_mfma_f32_16x16x32_bf16 a[20:23], a[204:207], v[224:227], a[20:23]
    v_exp_f32 v129, v129
    v_mfma_f32_16x16x32_bf16 a[20:23], a[200:203], v[220:223], a[20:23]
    ds_read_b128 a[156:159], v4 offset:20480
    v_mfma_f32_16x16x32_bf16 a[24:27], a[200:203], v[228:231], a[24:27]
    v_exp_f32 v130, v130
    v_mfma_f32_16x16x32_bf16 a[24:27], a[204:207], v[232:235], a[24:27]
    ds_read_b64_tr_b16 v[26:27], v22 offset:1088
    v_cvt_pk_bf16_f32 v204, v128, v129
    v_mfma_f32_16x16x32_bf16 a[28:31], a[204:207], v[240:243], a[28:31]
    v_exp_f32 v131, v131
    v_mfma_f32_16x16x32_bf16 a[28:31], a[200:203], v[236:239], a[28:31]
    buffer_load_dwordx4 v16, s[8:11], s28 offen offset:3072 lds
    v_smfmac_f32_16x16x64_bf16 a[224:227], v[244:247], v[212:219], v248
    s_waitcnt lgkmcnt(6)
    ds_read_b64_tr_b16 v[28:29], v22 offset:1536
    ds_read_b64_tr_b16 v[30:31], v22 offset:1600
    v_mfma_f32_16x16x32_bf16 v[124:127], a[128:131], v[68:71], v[108:111]
    s_mul_i32 s40, s5, 2560
    v_exp_f32 v132, v132
    v_mfma_f32_16x16x32_bf16 v[124:127], a[132:135], v[72:75], v[124:127]
    ds_read_b64_tr_b16 a[192:193], v9 offset:24576
    v_cvt_pk_bf16_f32 v205, v130, v131
    v_mfma_f32_16x16x32_bf16 v[124:127], a[136:139], v[76:79], v[124:127]
    v_exp_f32 v133, v133
    v_add_u32 v0, s40, v23
    v_mfma_f32_16x16x32_bf16 v[124:127], a[140:143], v[80:83], v[124:127]
    s_nop 0
    ds_read_b64_tr_b16 a[194:195], v9 offset:28672
    v_mfma_f32_16x16x32_bf16 v[128:131], a[140:143], v[96:99], v[112:115]
    s_nop 0
    v_exp_f32 v134, v134
    v_mfma_f32_16x16x32_bf16 v[128:131], a[136:139], v[92:95], v[128:131]
    s_nop 0
    ds_read_b128 a[160:163], v1 offset:24576
    v_cvt_pk_bf16_f32 v182, v132, v133
    v_mfma_f32_16x16x32_bf16 v[128:131], a[132:135], v[88:91], v[128:131]
    s_nop 0
    v_exp_f32 v135, v135
    v_mfma_f32_16x16x32_bf16 v[128:131], a[128:131], v[84:87], v[128:131]
    s_nop 0
    ds_read_b64_tr_b16 a[196:197], v9 offset:49152
    v_mfma_f32_16x16x32_bf16 a[32:35], a[208:211], v[212:215], a[32:35]
    s_nop 0
    v_exp_f32 v136, v136
    v_mfma_f32_16x16x32_bf16 a[32:35], a[212:215], v[216:219], a[32:35]
    s_waitcnt lgkmcnt(4)
    ds_read_b64_tr_b16 a[198:199], v9 offset:53248
    v_cvt_pk_bf16_f32 v183, v134, v135
    v_mfma_f32_16x16x32_bf16 v[32:35], v[24:27], a[248:251], v[32:35]
    v_mfma_f32_16x16x32_bf16 v[32:35], v[28:31], a[252:255], v[32:35]
    ds_read_b64_tr_b16 v[24:25], v22 offset:2048
    v_mfma_f32_16x16x32_bf16 a[36:39], a[212:215], v[224:227], a[36:39]
    v_exp_f32 v137, v137
    v_mfma_f32_16x16x32_bf16 a[36:39], a[208:211], v[220:223], a[36:39]
    ds_read_b128 a[164:167], v2 offset:24576
    v_cvt_pk_bf16_f32 v190, v136, v137
    v_mfma_f32_16x16x32_bf16 a[40:43], a[208:211], v[228:231], a[40:43]
    s_add_u32 s28, s28, 16384
    s_mov_b32 m0, s31
    v_exp_f32 v138, v138
    v_mfma_f32_16x16x32_bf16 a[40:43], a[212:215], v[232:235], a[40:43]
    buffer_load_dwordx4 v17, s[12:15], s29 offen offset:0 lds
    v_mfma_f32_16x16x32_bf16 a[44:47], a[212:215], v[240:243], a[44:47]
    v_exp_f32 v139, v139
    v_mfma_f32_16x16x32_bf16 a[44:47], a[208:211], v[236:239], a[44:47]
    s_waitcnt lgkmcnt(6)
    ds_read_b64_tr_b16 v[26:27], v22 offset:2112
    v_mfma_f32_16x16x32_bf16 v[132:135], a[144:147], v[36:39], v[100:103]
    s_nop 0
    v_exp_f32 v140, v140
    v_mfma_f32_16x16x32_bf16 v[132:135], a[148:151], v[40:43], v[132:135]
    s_nop 0
    ds_read_b64_tr_b16 a[200:201], v10 offset:24576
    v_cvt_pk_bf16_f32 v191, v138, v139
    v_mfma_f32_16x16x32_bf16 v[132:135], a[152:155], v[44:47], v[132:135]
    s_nop 0
    v_exp_f32 v141, v141
    v_mfma_f32_16x16x32_bf16 v[132:135], a[156:159], v[48:51], v[132:135]
    s_nop 0
    ds_read_b64_tr_b16 a[202:203], v10 offset:28672
    v_mfma_f32_16x16x32_bf16 v[136:139], a[156:159], v[64:67], v[104:107]
    s_nop 0
    v_exp_f32 v142, v142
    v_mfma_f32_16x16x32_bf16 v[136:139], a[152:155], v[60:63], v[136:139]
    s_nop 0
    ds_read_b128 a[168:171], v3 offset:24576
    v_cvt_pk_bf16_f32 v198, v140, v141
    v_mfma_f32_16x16x32_bf16 v[136:139], a[148:151], v[56:59], v[136:139]
    s_nop 0
    v_exp_f32 v143, v143
    v_mfma_f32_16x16x32_bf16 v[136:139], a[144:147], v[52:55], v[136:139]
    s_nop 0
    ds_read_b64_tr_b16 a[204:205], v10 offset:49152
    v_mfma_f32_16x16x32_bf16 a[48:51], a[216:219], v[212:215], a[48:51]
    s_waitcnt lgkmcnt(4)
    v_exp_f32 v144, v144
    v_mfma_f32_16x16x32_bf16 v[32:35], v[24:27], v[252:255], v[32:35]
    v_mfma_f32_16x16x32_bf16 a[48:51], a[220:223], v[216:219], a[48:51]
    ds_read_b64_tr_b16 a[206:207], v10 offset:53248
    v_cvt_pk_bf16_f32 v199, v142, v143
    v_mfma_f32_16x16x32_bf16 a[52:55], a[220:223], v[224:227], a[52:55]
    v_exp_f32 v145, v145
    v_mfma_f32_16x16x32_bf16 a[52:55], a[216:219], v[220:223], a[52:55]
    ds_read_b128 a[172:175], v4 offset:24576
    v_mfma_f32_16x16x32_bf16 a[56:59], a[216:219], v[228:231], a[56:59]
    v_exp_f32 v146, v146
    v_mfma_f32_16x16x32_bf16 a[56:59], a[220:223], v[232:235], a[56:59]
    v_cvt_pk_bf16_f32 v206, v144, v145
    v_mfma_f32_16x16x32_bf16 a[60:63], a[220:223], v[240:243], a[60:63]
    v_exp_f32 v147, v147
    v_mfma_f32_16x16x32_bf16 a[60:63], a[216:219], v[236:239], a[60:63]
    buffer_load_dwordx4 v18, s[12:15], s29 offen offset:1024 lds
    v_smfmac_f32_16x16x64_bf16 a[228:231], v[244:247], v[220:227], v248
    s_waitcnt lgkmcnt(6)
    v_mfma_f32_16x16x32_bf16 v[140:143], a[144:147], v[68:71], v[108:111]
    s_nop 0
    v_exp_f32 v148, v148
    v_mfma_f32_16x16x32_bf16 v[140:143], a[148:151], v[72:75], v[140:143]
    s_nop 0
    ds_read_b64_tr_b16 a[208:209], v11 offset:24576
    v_cvt_pk_bf16_f32 v207, v146, v147
    v_mfma_f32_16x16x32_bf16 v[140:143], a[152:155], v[76:79], v[140:143]
    s_nop 0
    v_exp_f32 v149, v149
    v_mfma_f32_16x16x32_bf16 v[140:143], a[156:159], v[80:83], v[140:143]
    ds_read_b64_tr_b16 a[210:211], v11 offset:28672
    v_mfma_f32_16x16x32_bf16 v[144:147], a[156:159], v[96:99], v[112:115]
    v_exp_f32 v150, v150
    v_mfma_f32_16x16x32_bf16 v[144:147], a[152:155], v[92:95], v[144:147]
    ds_read_b128 a[176:179], v1 offset:28672
    v_cvt_pk_bf16_f32 v184, v148, v149
    v_mfma_f32_16x16x32_bf16 v[144:147], a[148:151], v[88:91], v[144:147]
    v_exp_f32 v151, v151
    v_mfma_f32_16x16x32_bf16 v[144:147], a[144:147], v[84:87], v[144:147]
    ds_read_b64_tr_b16 a[212:213], v11 offset:49152
    ds_write_b128 v0, v[32:35]
    v_bfe_u32 v22, v19, 2, 3
    v_mfma_f32_16x16x32_bf16 a[64:67], a[192:195], v[212:215], a[64:67]
    v_exp_f32 v152, v152
    v_mul_u32_u24 v22, 160, v22
    v_mfma_f32_16x16x32_bf16 a[64:67], a[196:199], v[216:219], a[64:67]
    ds_read_b64_tr_b16 a[214:215], v11 offset:53248
    v_cvt_pk_bf16_f32 v185, v150, v151
    v_mfma_f32_16x16x32_bf16 a[68:71], a[196:199], v[224:227], a[68:71]
    v_exp_f32 v153, v153
    v_and_b32 v28, 3, v19
    v_mfma_f32_16x16x32_bf16 a[68:71], a[192:195], v[220:223], a[68:71]
    ds_read_b128 a[180:183], v2 offset:28672
    v_cvt_pk_bf16_f32 v192, v152, v153
    v_add_u32 v22, v22, v28
    v_mfma_f32_16x16x32_bf16 a[72:75], a[192:195], v[228:231], a[72:75]
    s_mul_i32 s42, s5, 320
    v_exp_f32 v154, v154
    v_mfma_f32_16x16x32_bf16 a[72:75], a[196:199], v[232:235], a[72:75]
    s_add_u32 s42, s42, 86016
    buffer_load_dwordx4 v17, s[12:15], s29 offen offset:2048 lds
    v_mfma_f32_16x16x32_bf16 a[76:79], a[196:199], v[240:243], a[76:79]
    v_exp_f32 v155, v155
    v_mfma_f32_16x16x32_bf16 a[76:79], a[192:195], v[236:239], a[76:79]
    s_waitcnt lgkmcnt(6)
    v_lshl_add_u32 v22, v22, 3, s42
    v_mfma_f32_16x16x32_bf16 v[148:151], a[160:163], v[36:39], v[100:103]
    v_exp_f32 v156, v156
    v_mfma_f32_16x16x32_bf16 v[148:151], a[164:167], v[40:43], v[148:151]
    ds_read_b64_tr_b16 a[216:217], v12 offset:24576
    v_cvt_pk_bf16_f32 v193, v154, v155
    v_mfma_f32_16x16x32_bf16 v[148:151], a[168:171], v[44:47], v[148:151]
    v_exp_f32 v157, v157
    v_mfma_f32_16x16x32_bf16 v[148:151], a[172:175], v[48:51], v[148:151]
    ds_read_b64_tr_b16 a[218:219], v12 offset:28672
    v_mfma_f32_16x16x32_bf16 v[152:155], a[172:175], v[64:67], v[104:107]
    v_exp_f32 v158, v158
    v_mfma_f32_16x16x32_bf16 v[152:155], a[168:171], v[60:63], v[152:155]
    ds_read_b128 a[184:187], v3 offset:28672
    v_cvt_pk_bf16_f32 v200, v156, v157
    v_mfma_f32_16x16x32_bf16 v[152:155], a[164:167], v[56:59], v[152:155]
    v_exp_f32 v159, v159
    v_mfma_f32_16x16x32_bf16 v[152:155], a[160:163], v[52:55], v[152:155]
    ds_read_b64_tr_b16 a[220:221], v12 offset:49152
    v_mfma_f32_16x16x32_bf16 a[80:83], a[200:203], v[212:215], a[80:83]
    v_exp_f32 v160, v160
    v_mfma_f32_16x16x32_bf16 a[80:83], a[204:207], v[216:219], a[80:83]
    ds_read_b64_tr_b16 a[222:223], v12 offset:53248
    v_cvt_pk_bf16_f32 v201, v158, v159
    v_mfma_f32_16x16x32_bf16 a[84:87], a[204:207], v[224:227], a[84:87]
    v_exp_f32 v161, v161
    v_mfma_f32_16x16x32_bf16 a[84:87], a[200:203], v[220:223], a[84:87]
    ds_read_b128 a[188:191], v4 offset:28672
    v_mfma_f32_16x16x32_bf16 a[88:91], a[200:203], v[228:231], a[88:91]
    v_exp_f32 v162, v162
    v_mfma_f32_16x16x32_bf16 a[88:91], a[204:207], v[232:235], a[88:91]
    v_cvt_pk_bf16_f32 v208, v160, v161
    v_mfma_f32_16x16x32_bf16 a[92:95], a[204:207], v[240:243], a[92:95]
    v_exp_f32 v163, v163
    v_mfma_f32_16x16x32_bf16 a[92:95], a[200:203], v[236:239], a[92:95]
    buffer_load_dwordx4 v18, s[12:15], s29 offen offset:3072 lds
    v_smfmac_f32_16x16x64_bf16 a[232:235], v[244:247], v[228:235], v248
    s_waitcnt vmcnt(8) lgkmcnt(6)
    s_barrier
    s_add_u32 s29, s29, 16384
    v_mfma_f32_16x16x32_bf16 v[156:159], a[160:163], v[68:71], v[108:111]
    v_exp_f32 v164, v164
    v_mfma_f32_16x16x32_bf16 v[156:159], a[164:167], v[72:75], v[156:159]
    ds_read_b64_tr_b16 a[192:193], v5 offset:8192
    v_cvt_pk_bf16_f32 v209, v162, v163
    v_mfma_f32_16x16x32_bf16 v[156:159], a[168:171], v[76:79], v[156:159]
    v_exp_f32 v165, v165
    v_mfma_f32_16x16x32_bf16 v[156:159], a[172:175], v[80:83], v[156:159]
    ds_read_b64_tr_b16 a[194:195], v5 offset:12288
    ds_read_b128 v[24:27], v23 offset:0
    v_mfma_f32_16x16x32_bf16 v[160:163], a[172:175], v[96:99], v[112:115]
    v_exp_f32 v166, v166
    v_mfma_f32_16x16x32_bf16 v[160:163], a[168:171], v[92:95], v[160:163]
    ds_read_b128 a[128:131], v1 offset:32768
    v_cvt_pk_bf16_f32 v186, v164, v165
    v_mfma_f32_16x16x32_bf16 v[160:163], a[164:167], v[88:91], v[160:163]
    v_exp_f32 v167, v167
    v_mfma_f32_16x16x32_bf16 v[160:163], a[160:163], v[84:87], v[160:163]
    ds_read_b64_tr_b16 a[196:197], v5 offset:32768
    ds_read_b128 v[28:31], v23 offset:2560
    v_mfma_f32_16x16x32_bf16 a[96:99], a[208:211], v[212:215], a[96:99]
    v_exp_f32 v168, v168
    v_mfma_f32_16x16x32_bf16 a[96:99], a[212:215], v[216:219], a[96:99]
    ds_read_b64_tr_b16 a[198:199], v5 offset:36864
    v_cvt_pk_bf16_f32 v187, v166, v167
    v_mfma_f32_16x16x32_bf16 a[100:103], a[212:215], v[224:227], a[100:103]
    v_exp_f32 v169, v169
    v_mfma_f32_16x16x32_bf16 a[100:103], a[208:211], v[220:223], a[100:103]
    ds_read_b128 a[132:135], v2 offset:32768
    v_cvt_pk_bf16_f32 v194, v168, v169
    v_mfma_f32_16x16x32_bf16 a[104:107], a[208:211], v[228:231], a[104:107]
    s_mov_b32 m0, s32
    v_exp_f32 v170, v170
    v_mfma_f32_16x16x32_bf16 a[104:107], a[212:215], v[232:235], a[104:107]
    buffer_load_dwordx4 v17, s[12:15], s29 offen offset:0 lds
    v_mfma_f32_16x16x32_bf16 a[108:111], a[212:215], v[240:243], a[108:111]
    v_exp_f32 v171, v171
    v_mfma_f32_16x16x32_bf16 a[108:111], a[208:211], v[236:239], a[108:111]
    s_waitcnt lgkmcnt(6)
    ds_read_b128 v[32:35], v23 offset:5120
    ds_read_b128 v[252:255], v23 offset:7680
    v_mfma_f32_16x16x32_bf16 v[164:167], a[176:179], v[36:39], v[100:103]
    v_exp_f32 v172, v172
    v_mfma_f32_16x16x32_bf16 v[164:167], a[180:183], v[40:43], v[164:167]
    ds_read_b64_tr_b16 a[200:201], v6 offset:8192
    v_cvt_pk_bf16_f32 v195, v170, v171
    v_mfma_f32_16x16x32_bf16 v[164:167], a[184:187], v[44:47], v[164:167]
    v_exp_f32 v173, v173
    v_mfma_f32_16x16x32_bf16 v[164:167], a[188:191], v[48:51], v[164:167]
    ds_read_b64_tr_b16 a[202:203], v6 offset:12288
    v_mfma_f32_16x16x32_bf16 v[168:171], a[188:191], v[64:67], v[104:107]
    v_exp_f32 v174, v174
    v_mfma_f32_16x16x32_bf16 v[168:171], a[184:187], v[60:63], v[168:171]
    ds_read_b128 a[136:139], v3 offset:32768
    v_cvt_pk_bf16_f32 v202, v172, v173
    v_mfma_f32_16x16x32_bf16 v[168:171], a[180:183], v[56:59], v[168:171]
    v_exp_f32 v175, v175
    v_mfma_f32_16x16x32_bf16 v[168:171], a[176:179], v[52:55], v[168:171]
    ds_read_b64_tr_b16 a[204:205], v6 offset:32768
    ds_read_b64_tr_b16 a[240:241], v22 offset:0
    v_mfma_f32_16x16x32_bf16 a[112:115], a[216:219], v[212:215], a[112:115]
    v_exp_f32 v176, v176
    v_mfma_f32_16x16x32_bf16 a[112:115], a[220:223], v[216:219], a[112:115]
    ds_read_b64_tr_b16 a[206:207], v6 offset:36864
    v_cvt_pk_bf16_f32 v203, v174, v175
    v_mfma_f32_16x16x32_bf16 a[116:119], a[220:223], v[224:227], a[116:119]
    v_exp_f32 v177, v177
    v_mfma_f32_16x16x32_bf16 a[116:119], a[216:219], v[220:223], a[116:119]
    ds_read_b128 a[140:143], v4 offset:32768
    ds_read_b64_tr_b16 a[242:243], v22 offset:32
    v_mfma_f32_16x16x32_bf16 a[120:123], a[216:219], v[228:231], a[120:123]
    v_exp_f32 v178, v178
    v_mfma_f32_16x16x32_bf16 a[120:123], a[220:223], v[232:235], a[120:123]
    ds_read_b64_tr_b16 a[244:245], v22 offset:64
    v_cvt_pk_bf16_f32 v210, v176, v177
    v_mfma_f32_16x16x32_bf16 a[124:127], a[220:223], v[240:243], a[124:127]
    v_exp_f32 v179, v179
    v_mfma_f32_16x16x32_bf16 a[124:127], a[216:219], v[236:239], a[124:127]
    buffer_load_dwordx4 v18, s[12:15], s29 offen offset:1024 lds
    v_smfmac_f32_16x16x64_bf16 a[236:239], v[244:247], v[236:243], v248
    s_waitcnt lgkmcnt(6)
    ds_read_b64_tr_b16 a[246:247], v22 offset:96
    v_mfma_f32_16x16x32_bf16 v[172:175], a[176:179], v[68:71], v[108:111]
    v_exp_f32 v116, v116
    v_mfma_f32_16x16x32_bf16 v[172:175], a[180:183], v[72:75], v[172:175]
    ds_read_b64_tr_b16 a[208:209], v7 offset:8192
    v_cvt_pk_bf16_f32 v211, v178, v179
    v_add_f32 v24, v24, v28
    v_mfma_f32_16x16x32_bf16 v[172:175], a[184:187], v[76:79], v[172:175]
    v_exp_f32 v117, v117
    v_add_f32 v25, v25, v29
    v_mfma_f32_16x16x32_bf16 v[172:175], a[188:191], v[80:83], v[172:175]
    ds_read_b64_tr_b16 a[210:211], v7 offset:12288
    v_add_f32 v26, v26, v30
    v_mfma_f32_16x16x32_bf16 v[176:179], a[188:191], v[96:99], v[112:115]
    v_exp_f32 v118, v118
    v_mfma_f32_16x16x32_bf16 v[176:179], a[184:187], v[92:95], v[176:179]
    ds_read_b128 a[144:147], v1 offset:36864
    v_cvt_pk_bf16_f32 v212, v116, v117
    v_add_f32 v27, v27, v31
    v_mfma_f32_16x16x32_bf16 v[176:179], a[180:183], v[88:91], v[176:179]
    v_exp_f32 v119, v119
    v_add_f32 v24, v24, v32
    v_mfma_f32_16x16x32_bf16 v[176:179], a[176:179], v[84:87], v[176:179]
    ds_read_b64_tr_b16 a[212:213], v7 offset:32768
    v_add_f32 v25, v25, v33
    v_mfma_f32_16x16x32_bf16 a[0:3], a[192:195], v[180:183], a[0:3]
    v_exp_f32 v120, v120
    v_mfma_f32_16x16x32_bf16 a[0:3], a[196:199], v[184:187], a[0:3]
    ds_read_b64_tr_b16 a[214:215], v7 offset:36864
    v_cvt_pk_bf16_f32 v213, v118, v119
    v_add_f32 v26, v26, v34
    v_mfma_f32_16x16x32_bf16 a[4:7], a[196:199], v[192:195], a[4:7]
    v_exp_f32 v121, v121
    v_add_f32 v27, v27, v35
    v_mfma_f32_16x16x32_bf16 a[4:7], a[192:195], v[188:191], a[4:7]
    ds_read_b128 a[148:151], v2 offset:36864
    v_cvt_pk_bf16_f32 v220, v120, v121
    v_add_f32 v24, v24, v252
    v_mfma_f32_16x16x32_bf16 a[8:11], a[192:195], v[196:199], a[8:11]
    v_exp_f32 v122, v122
    v_mfma_f32_16x16x32_bf16 a[8:11], a[196:199], v[200:203], a[8:11]
    buffer_load_dwordx4 v17, s[12:15], s29 offen offset:2048 lds
    v_add_f32 v25, v25, v253
    v_mfma_f32_16x16x32_bf16 a[12:15], a[196:199], v[208:211], a[12:15]
    v_exp_f32 v123, v123
    v_add_f32 v26, v26, v254
    v_mfma_f32_16x16x32_bf16 a[12:15], a[192:195], v[204:207], a[12:15]
    s_waitcnt lgkmcnt(6)
    ds_read_b64_tr_b16 a[248:249], v22 offset:128
    v_add_f32 v27, v27, v255
    v_mfma_f32_16x16x32_bf16 v[116:119], a[128:131], v[36:39], v[100:103]
    v_exp_f32 v124, v124
    v_mfma_f32_16x16x32_bf16 v[116:119], a[132:135], v[40:43], v[116:119]
    ds_read_b64_tr_b16 a[216:217], v8 offset:8192
    v_cvt_pk_bf16_f32 v221, v122, v123
    v_mov_b32_dpp v28, v24 row_newbcast:8 row_mask:0xf bank_mask:0xf
    v_mfma_f32_16x16x32_bf16 v[116:119], a[136:139], v[44:47], v[116:119]
    v_exp_f32 v125, v125
    v_mov_b32_dpp v29, v25 row_newbcast:8 row_mask:0xf bank_mask:0xf
    v_mfma_f32_16x16x32_bf16 v[116:119], a[140:143], v[48:51], v[116:119]
    ds_read_b64_tr_b16 a[218:219], v8 offset:12288
    v_mov_b32_dpp v30, v26 row_newbcast:8 row_mask:0xf bank_mask:0xf
    v_mfma_f32_16x16x32_bf16 v[120:123], a[140:143], v[64:67], v[104:107]
    v_exp_f32 v126, v126
    v_mfma_f32_16x16x32_bf16 v[120:123], a[136:139], v[60:63], v[120:123]
    ds_read_b128 a[152:155], v3 offset:36864
    v_cvt_pk_bf16_f32 v228, v124, v125
    v_mov_b32_dpp v31, v27 row_newbcast:8 row_mask:0xf bank_mask:0xf
    v_mfma_f32_16x16x32_bf16 v[120:123], a[132:135], v[56:59], v[120:123]
    v_exp_f32 v127, v127
    v_mfma_f32_16x16x32_bf16 v[120:123], a[128:131], v[52:55], v[120:123]
    ds_read_b64_tr_b16 a[220:221], v8 offset:32768
    v_fma_f32 v24, -v20, v28, v24
    v_mfma_f32_16x16x32_bf16 a[16:19], a[200:203], v[180:183], a[16:19]
    v_exp_f32 v128, v128
    v_fma_f32 v25, -v20, v29, v25
    v_mfma_f32_16x16x32_bf16 a[16:19], a[204:207], v[184:187], a[16:19]
    ds_read_b64_tr_b16 a[222:223], v8 offset:36864
    v_cvt_pk_bf16_f32 v229, v126, v127
    v_fma_f32 v26, -v20, v30, v26
    v_mfma_f32_16x16x32_bf16 a[20:23], a[204:207], v[192:195], a[20:23]
    v_exp_f32 v129, v129
    v_mfma_f32_16x16x32_bf16 a[20:23], a[200:203], v[188:191], a[20:23]
    ds_read_b128 a[156:159], v4 offset:36864
    v_fma_f32 v27, -v20, v31, v27
    v_mfma_f32_16x16x32_bf16 a[24:27], a[200:203], v[196:199], a[24:27]
    v_exp_f32 v130, v130
    v_mul_f32 v24, v24, v21
    v_mfma_f32_16x16x32_bf16 a[24:27], a[204:207], v[200:203], a[24:27]
    v_cvt_pk_bf16_f32 v236, v128, v129
    v_mul_f32 v25, v25, v21
    v_mfma_f32_16x16x32_bf16 a[28:31], a[204:207], v[208:211], a[28:31]
    v_exp_f32 v131, v131
    v_mfma_f32_16x16x32_bf16 a[28:31], a[200:203], v[204:207], a[28:31]
    buffer_load_dwordx4 v18, s[12:15], s29 offen offset:3072 lds
    v_mul_f32 v26, v26, v21
    v_smfmac_f32_16x16x64_bf16 a[224:227], v[244:247], v[180:187], v248
    s_waitcnt lgkmcnt(6)
    s_add_u32 s29, s29, 16384
    ds_read_b64_tr_b16 a[250:251], v22 offset:160
    ds_read_b64_tr_b16 a[252:253], v22 offset:192
    ds_read_b64_tr_b16 a[254:255], v22 offset:224
    v_mul_f32 v27, v27, v21
    v_cvt_pk_bf16_f32 v28, v24, v25
    v_mfma_f32_16x16x32_bf16 v[124:127], a[128:131], v[68:71], v[108:111]
    v_exp_f32 v132, v132
    v_mfma_f32_16x16x32_bf16 v[124:127], a[132:135], v[72:75], v[124:127]
    ds_read_b64_tr_b16 a[192:193], v9 offset:8192
    v_cvt_pk_bf16_f32 v237, v130, v131
    v_mfma_f32_16x16x32_bf16 v[124:127], a[136:139], v[76:79], v[124:127]
    v_exp_f32 v133, v133
    v_cvt_pk_bf16_f32 v29, v26, v27
    v_mfma_f32_16x16x32_bf16 v[124:127], a[140:143], v[80:83], v[124:127]
    ds_read_b64_tr_b16 a[194:195], v9 offset:12288
    v_lshlrev_b32 v24, 16, v28
    v_mfma_f32_16x16x32_bf16 v[128:131], a[140:143], v[96:99], v[112:115]
    v_exp_f32 v134, v134
    v_mfma_f32_16x16x32_bf16 v[128:131], a[136:139], v[92:95], v[128:131]
    ds_read_b128 a[160:163], v1 offset:40960
    v_cvt_pk_bf16_f32 v214, v132, v133
    v_and_b32 v25, 0xffff0000, v28
    v_mfma_f32_16x16x32_bf16 v[128:131], a[132:135], v[88:91], v[128:131]
    v_exp_f32 v135, v135
    v_lshlrev_b32 v26, 16, v29
    v_mfma_f32_16x16x32_bf16 v[128:131], a[128:131], v[84:87], v[128:131]
    ds_read_b64_tr_b16 a[196:197], v9 offset:32768
    v_and_b32 v27, 0xffff0000, v29
    v_mfma_f32_16x16x32_bf16 a[32:35], a[208:211], v[180:183], a[32:35]
    v_exp_f32 v136, v136
    v_mfma_f32_16x16x32_bf16 a[32:35], a[212:215], v[184:187], a[32:35]
    ds_read_b64_tr_b16 a[198:199], v9 offset:36864
    v_cvt_pk_bf16_f32 v215, v134, v135
    v_mov_b32 v32, v24
    v_mfma_f32_16x16x32_bf16 a[36:39], a[212:215], v[192:195], a[36:39]
    v_exp_f32 v137, v137
    v_mov_b32 v33, v25
    v_mfma_f32_16x16x32_bf16 a[36:39], a[208:211], v[188:191], a[36:39]
    ds_read_b128 a[164:167], v2 offset:40960
    v_mov_b32 v34, v26
    v_mfma_f32_16x16x32_bf16 a[40:43], a[208:211], v[196:199], a[40:43]
    v_exp_f32 v138, v138
    v_mfma_f32_16x16x32_bf16 a[40:43], a[212:215], v[200:203], a[40:43]
    v_cvt_pk_bf16_f32 v222, v136, v137
    v_mov_b32 v35, v27
    v_mfma_f32_16x16x32_bf16 a[44:47], a[212:215], v[208:211], a[44:47]
    v_exp_f32 v139, v139
    v_permlane32_swap_b32 v24, v32
    v_mfma_f32_16x16x32_bf16 a[44:47], a[208:211], v[204:207], a[44:47]
    s_waitcnt lgkmcnt(6)
    v_permlane32_swap_b32 v25, v33
    v_mfma_f32_16x16x32_bf16 v[132:135], a[144:147], v[36:39], v[100:103]
    s_mul_i32 s46, s5, 10240
    v_exp_f32 v140, v140
    v_mfma_f32_16x16x32_bf16 v[132:135], a[148:151], v[40:43], v[132:135]
    s_lshl_b32 s40, s100, 1
    ds_read_b64_tr_b16 a[200:201], v10 offset:8192
    v_cvt_pk_bf16_f32 v223, v138, v139
    v_permlane32_swap_b32 v26, v34
    v_mfma_f32_16x16x32_bf16 v[132:135], a[152:155], v[44:47], v[132:135]
    s_add_u32 s40, s40, s47
    v_exp_f32 v141, v141
    v_permlane32_swap_b32 v27, v35
    v_mfma_f32_16x16x32_bf16 v[132:135], a[156:159], v[48:51], v[132:135]
    s_mul_i32 s40, s40, 327680
    ds_read_b64_tr_b16 a[202:203], v10 offset:12288
    v_mul_f32 v28, 0xbfb8aa3b, v24
    v_mfma_f32_16x16x32_bf16 v[136:139], a[156:159], v[64:67], v[104:107]
    s_add_u32 s40, s40, 0x1400000
    v_exp_f32 v142, v142
    v_mfma_f32_16x16x32_bf16 v[136:139], a[152:155], v[60:63], v[136:139]
    s_add_u32 s20, s72, s40
    s_addc_u32 s21, s73, 0
    ds_read_b128 a[168:171], v3 offset:40960
    v_cvt_pk_bf16_f32 v230, v140, v141
    v_mul_f32 v29, 0xbfb8aa3b, v25
    v_mfma_f32_16x16x32_bf16 v[136:139], a[148:151], v[56:59], v[136:139]
    s_mov_b32 s22, 0x50000
    v_exp_f32 v143, v143
    v_mfma_f32_16x16x32_bf16 v[136:139], a[144:147], v[52:55], v[136:139]
    s_mov_b32 s23, 0x20000
    ds_read_b64_tr_b16 a[204:205], v10 offset:32768
    v_mul_f32 v30, 0xbfb8aa3b, v26
    v_mfma_f32_16x16x32_bf16 a[48:51], a[216:219], v[180:183], a[48:51]
    s_mul_i32 s40, s5, 5120
    v_exp_f32 v144, v144
    v_mul_f32 v31, 0xbfb8aa3b, v27
    v_mfma_f32_16x16x32_bf16 a[48:51], a[220:223], v[184:187], a[48:51]
    ds_read_b64_tr_b16 a[206:207], v10 offset:36864
    v_cvt_pk_bf16_f32 v231, v142, v143
    v_exp_f32 v28, v28
    v_mfma_f32_16x16x32_bf16 a[52:55], a[220:223], v[192:195], a[52:55]
    v_exp_f32 v145, v145
    v_mfma_f32_16x16x32_bf16 a[52:55], a[216:219], v[188:191], a[52:55]
    ds_read_b128 a[172:175], v4 offset:40960
    v_exp_f32 v29, v29
    v_mfma_f32_16x16x32_bf16 a[56:59], a[216:219], v[196:199], a[56:59]
    v_exp_f32 v146, v146
    v_exp_f32 v30, v30
    v_mfma_f32_16x16x32_bf16 a[56:59], a[220:223], v[200:203], a[56:59]
    v_cvt_pk_bf16_f32 v238, v144, v145
    v_lshl_add_u32 v254, v19, 4, s40
    v_mfma_f32_16x16x32_bf16 a[60:63], a[220:223], v[208:211], a[60:63]
    v_exp_f32 v147, v147
    v_exp_f32 v31, v31
    v_mfma_f32_16x16x32_bf16 a[60:63], a[216:219], v[204:207], a[60:63]
    v_add_f32 v28, 1.0, v28
    v_add_f32 v29, 1.0, v29
    v_smfmac_f32_16x16x64_bf16 a[228:231], v[244:247], v[188:195], v248
    s_waitcnt lgkmcnt(6)
    v_add_f32 v30, 1.0, v30
    v_add_f32 v31, 1.0, v31
    v_mfma_f32_16x16x32_bf16 v[140:143], a[144:147], v[68:71], v[108:111]
    v_exp_f32 v148, v148
    v_mfma_f32_16x16x32_bf16 v[140:143], a[148:151], v[72:75], v[140:143]
    ds_read_b64_tr_b16 a[208:209], v11 offset:8192
    v_cvt_pk_bf16_f32 v239, v146, v147
    v_mfma_f32_16x16x32_bf16 v[140:143], a[152:155], v[76:79], v[140:143]
    v_exp_f32 v149, v149
    v_mfma_f32_16x16x32_bf16 v[140:143], a[156:159], v[80:83], v[140:143]
    ds_read_b64_tr_b16 a[210:211], v11 offset:12288
    v_rcp_f32 v28, v28
    v_mfma_f32_16x16x32_bf16 v[144:147], a[156:159], v[96:99], v[112:115]
    v_exp_f32 v150, v150
    v_mfma_f32_16x16x32_bf16 v[144:147], a[152:155], v[92:95], v[144:147]
    ds_read_b128 a[176:179], v1 offset:45056
    v_cvt_pk_bf16_f32 v216, v148, v149
    v_rcp_f32 v29, v29
    v_mfma_f32_16x16x32_bf16 v[144:147], a[148:151], v[88:91], v[144:147]
    v_exp_f32 v151, v151
    v_rcp_f32 v30, v30
    v_mfma_f32_16x16x32_bf16 v[144:147], a[144:147], v[84:87], v[144:147]
    ds_read_b64_tr_b16 a[212:213], v11 offset:32768
    v_rcp_f32 v31, v31
    v_mfma_f32_16x16x32_bf16 a[64:67], a[192:195], v[180:183], a[64:67]
    v_exp_f32 v152, v152
    v_mfma_f32_16x16x32_bf16 a[64:67], a[196:199], v[184:187], a[64:67]
    ds_read_b64_tr_b16 a[214:215], v11 offset:36864
    v_cvt_pk_bf16_f32 v217, v150, v151
    v_mul_f32 v24, v24, v28
    v_mfma_f32_16x16x32_bf16 a[68:71], a[196:199], v[192:195], a[68:71]
    v_exp_f32 v153, v153
    v_mul_f32 v25, v25, v29
    v_mfma_f32_16x16x32_bf16 a[68:71], a[192:195], v[188:191], a[68:71]
    ds_read_b128 a[180:183], v2 offset:45056
    v_mul_f32 v26, v26, v30
    v_mfma_f32_16x16x32_bf16 a[72:75], a[192:195], v[196:199], a[72:75]
    v_exp_f32 v154, v154
    v_mfma_f32_16x16x32_bf16 a[72:75], a[196:199], v[200:203], a[72:75]
    v_cvt_pk_bf16_f32 v224, v152, v153
    v_mul_f32 v27, v27, v31
    v_mfma_f32_16x16x32_bf16 a[76:79], a[196:199], v[208:211], a[76:79]
    v_exp_f32 v155, v155
    v_cvt_pk_bf16_f32 v28, v24, v25
    v_mfma_f32_16x16x32_bf16 a[76:79], a[192:195], v[204:207], a[76:79]
    s_waitcnt lgkmcnt(6)
    v_cvt_pk_bf16_f32 v29, v26, v27
    v_lshlrev_b32 v24, 16, v28
    v_mfma_f32_16x16x32_bf16 v[148:151], a[160:163], v[36:39], v[100:103]
    v_exp_f32 v156, v156
    v_mfma_f32_16x16x32_bf16 v[148:151], a[164:167], v[40:43], v[148:151]
    ds_read_b64_tr_b16 a[216:217], v12 offset:8192
    v_cvt_pk_bf16_f32 v225, v154, v155
    v_mfma_f32_16x16x32_bf16 v[148:151], a[168:171], v[44:47], v[148:151]
    v_exp_f32 v157, v157
    v_and_b32 v25, 0xffff0000, v28
    v_mfma_f32_16x16x32_bf16 v[148:151], a[172:175], v[48:51], v[148:151]
    ds_read_b64_tr_b16 a[218:219], v12 offset:12288
    v_lshlrev_b32 v26, 16, v29
    v_mfma_f32_16x16x32_bf16 v[152:155], a[172:175], v[64:67], v[104:107]
    v_exp_f32 v158, v158
    v_mfma_f32_16x16x32_bf16 v[152:155], a[168:171], v[60:63], v[152:155]
    ds_read_b128 a[184:187], v3 offset:45056
    v_cvt_pk_bf16_f32 v232, v156, v157
    v_and_b32 v27, 0xffff0000, v29
    v_mfma_f32_16x16x32_bf16 v[152:155], a[164:167], v[56:59], v[152:155]
    v_exp_f32 v159, v159
    v_mfma_f32_16x16x32_bf16 v[152:155], a[160:163], v[52:55], v[152:155]
    ds_read_b64_tr_b16 a[220:221], v12 offset:32768
    v_mul_f32 v24, v24, v32
    v_mfma_f32_16x16x32_bf16 a[80:83], a[200:203], v[180:183], a[80:83]
    v_exp_f32 v160, v160
    v_mul_f32 v25, v25, v33
    v_mfma_f32_16x16x32_bf16 a[80:83], a[204:207], v[184:187], a[80:83]
    ds_read_b64_tr_b16 a[222:223], v12 offset:36864
    v_cvt_pk_bf16_f32 v233, v158, v159
    v_mul_f32 v26, v26, v34
    v_mfma_f32_16x16x32_bf16 a[84:87], a[204:207], v[192:195], a[84:87]
    v_exp_f32 v161, v161
    v_mfma_f32_16x16x32_bf16 a[84:87], a[200:203], v[188:191], a[84:87]
    ds_read_b128 a[188:191], v4 offset:45056
    v_mul_f32 v27, v27, v35
    v_mfma_f32_16x16x32_bf16 a[88:91], a[200:203], v[196:199], a[88:91]
    v_exp_f32 v162, v162
    v_cmp_gt_u32 vcc, 32, v19
    v_mfma_f32_16x16x32_bf16 a[88:91], a[204:207], v[200:203], a[88:91]
    v_cvt_pk_bf16_f32 v240, v160, v161
    v_cvt_pk_bf16_f32 v252, v24, v25
    v_mfma_f32_16x16x32_bf16 a[92:95], a[204:207], v[208:211], a[92:95]
    v_exp_f32 v163, v163
    v_mfma_f32_16x16x32_bf16 a[92:95], a[200:203], v[204:207], a[92:95]
    v_cvt_pk_bf16_f32 v253, v26, v27
    v_cndmask_b32 v252, 0, v252, vcc
    v_smfmac_f32_16x16x64_bf16 a[232:235], v[244:247], v[196:203], v248
    s_waitcnt vmcnt(4) lgkmcnt(0)
    s_barrier
    v_cndmask_b32 v253, 0, v253, vcc
    v_and_b32 v23, 7, v19
    v_mfma_f32_16x16x32_bf16 v[156:159], a[160:163], v[68:71], v[108:111]
    v_exp_f32 v164, v164
    v_mfma_f32_16x16x32_bf16 v[156:159], a[164:167], v[72:75], v[156:159]
    ds_read_b64_tr_b16 a[192:193], v5 offset:16384
    v_cvt_pk_bf16_f32 v241, v162, v163
    v_mfma_f32_16x16x32_bf16 v[156:159], a[168:171], v[76:79], v[156:159]
    v_exp_f32 v165, v165
    v_mfma_f32_16x16x32_bf16 v[156:159], a[172:175], v[80:83], v[156:159]
    ds_read_b64_tr_b16 a[194:195], v5 offset:20480
    v_mul_u32_u24 v23, 34560, v23
    v_mfma_f32_16x16x32_bf16 v[160:163], a[172:175], v[96:99], v[112:115]
    v_exp_f32 v166, v166
    v_mfma_f32_16x16x32_bf16 v[160:163], a[168:171], v[92:95], v[160:163]
    ds_read_b128 a[128:131], v1 offset:0
    v_cvt_pk_bf16_f32 v218, v164, v165
    v_lshrrev_b32 v0, 4, v19
    v_mfma_f32_16x16x32_bf16 v[160:163], a[164:167], v[88:91], v[160:163]
    v_exp_f32 v167, v167
    v_add_u32 v23, v23, v0
    v_mfma_f32_16x16x32_bf16 v[160:163], a[160:163], v[84:87], v[160:163]
    ds_read_b64_tr_b16 a[196:197], v5 offset:40960
    v_and_b32 v0, 8, v19
    v_mfma_f32_16x16x32_bf16 a[96:99], a[208:211], v[180:183], a[96:99]
    v_exp_f32 v168, v168
    v_mfma_f32_16x16x32_bf16 a[96:99], a[212:215], v[184:187], a[96:99]
    ds_read_b64_tr_b16 a[198:199], v5 offset:45056
    v_cvt_pk_bf16_f32 v219, v166, v167
    v_lshrrev_b32 v0, 1, v0
    v_mfma_f32_16x16x32_bf16 a[100:103], a[212:215], v[192:195], a[100:103]
    v_exp_f32 v169, v169
    v_add_lshl_u32 v23, v23, v0, 4
    v_mfma_f32_16x16x32_bf16 a[100:103], a[208:211], v[188:191], a[100:103]
    s_mul_i32 s42, s5, 1080
    ds_read_b128 a[132:135], v2 offset:0
    v_cvt_pk_bf16_f32 v226, v168, v169
    v_mfma_f32_16x16x32_bf16 a[104:107], a[208:211], v[196:199], a[104:107]
    s_add_u32 s42, s42, s6
    v_exp_f32 v170, v170
    v_mfma_f32_16x16x32_bf16 a[104:107], a[212:215], v[200:203], a[104:107]
    s_lshl_b32 s42, s42, 7
    s_mov_b32 m0, s33
    s_nop 0
    buffer_load_dwordx4 v17, s[12:15], s29 offen offset:0 lds
    v_mfma_f32_16x16x32_bf16 a[108:111], a[212:215], v[208:211], a[108:111]
    s_cmp_lt_u32 s6, 216
    s_cselect_b32 s42, s42, 0x438000
    v_exp_f32 v171, v171
    v_mfma_f32_16x16x32_bf16 a[108:111], a[208:211], v[204:207], a[108:111]
    s_waitcnt lgkmcnt(6)
    s_add_u32 m0, s46, 122880
    s_mov_b32 s45, 245760
    buffer_load_dwordx4 v254, s[20:23], s45 offen sc1 lds
    v_mfma_f32_16x16x32_bf16 v[164:167], a[176:179], v[36:39], v[100:103]
    v_exp_f32 v172, v172
    v_mfma_f32_16x16x16_bf16 v[24:27], a[240:241], v[252:253], 0
    v_mfma_f32_16x16x16_bf16 v[28:31], a[242:243], v[252:253], 0
    s_nop 0
    s_add_u32 m0, s46, 123904
    s_mov_b32 s45, 246784
    buffer_load_dwordx4 v254, s[20:23], s45 offen sc1 lds
    v_mfma_f32_16x16x32_bf16 v[164:167], a[180:183], v[40:43], v[164:167]
    s_nop 0
    ds_read_b64_tr_b16 a[200:201], v6 offset:16384
    v_cvt_pk_bf16_f32 v227, v170, v171
    v_mfma_f32_16x16x32_bf16 v[164:167], a[184:187], v[44:47], v[164:167]
    s_nop 0
    v_exp_f32 v173, v173
    v_mfma_f32_16x16x32_bf16 v[164:167], a[188:191], v[48:51], v[164:167]
    s_nop 0
    ds_read_b64_tr_b16 a[202:203], v6 offset:20480
    v_mov_b32_dpp v24, v28 row_shr:8 row_mask:0xf bank_mask:0xc
    v_mfma_f32_16x16x32_bf16 v[168:171], a[188:191], v[64:67], v[104:107]
    v_exp_f32 v174, v174
    v_mfma_f32_16x16x32_bf16 v[168:171], a[184:187], v[60:63], v[168:171]
    ds_read_b128 a[136:139], v3 offset:0
    v_cvt_pk_bf16_f32 v234, v172, v173
    v_mfma_f32_16x16x32_bf16 v[168:171], a[180:183], v[56:59], v[168:171]
    v_exp_f32 v175, v175
    v_mfma_f32_16x16x32_bf16 v[168:171], a[176:179], v[52:55], v[168:171]
    ds_read_b64_tr_b16 a[204:205], v6 offset:40960
    v_mov_b32_dpp v25, v29 row_shr:8 row_mask:0xf bank_mask:0xc
    v_mfma_f32_16x16x32_bf16 a[112:115], a[216:219], v[180:183], a[112:115]
    v_exp_f32 v176, v176
    v_mfma_f32_16x16x32_bf16 a[112:115], a[220:223], v[184:187], a[112:115]
    ds_read_b64_tr_b16 a[206:207], v6 offset:45056
    v_cvt_pk_bf16_f32 v235, v174, v175
    v_mfma_f32_16x16x32_bf16 a[116:119], a[220:223], v[192:195], a[116:119]
    v_exp_f32 v177, v177
    v_mov_b32_dpp v26, v30 row_shr:8 row_mask:0xf bank_mask:0xc
    v_mfma_f32_16x16x32_bf16 a[116:119], a[216:219], v[188:191], a[116:119]
    ds_read_b128 a[140:143], v4 offset:0
    v_mov_b32_dpp v27, v31 row_shr:8 row_mask:0xf bank_mask:0xc
    v_mfma_f32_16x16x32_bf16 a[120:123], a[216:219], v[196:199], a[120:123]
    v_exp_f32 v178, v178
    v_mfma_f32_16x16x32_bf16 a[120:123], a[220:223], v[200:203], a[120:123]
    buffer_store_dwordx4 v[24:27], v23, s[16:19], s42 offen sc1
    v_cvt_pk_bf16_f32 v242, v176, v177
    v_mfma_f32_16x16x32_bf16 a[124:127], a[220:223], v[208:211], a[124:127]
    s_add_u32 s42, s42, 27648
    v_exp_f32 v179, v179
    v_mfma_f32_16x16x32_bf16 a[124:127], a[216:219], v[204:207], a[124:127]
    s_mov_b32 m0, s33
    s_nop 0
    buffer_load_dwordx4 v18, s[12:15], s29 offen offset:1024 lds
    v_smfmac_f32_16x16x64_bf16 a[236:239], v[244:247], v[204:211], v248
    s_waitcnt lgkmcnt(6)
    ds_read_b64_tr_b16 a[240:241], v22 offset:256
    ds_read_b64_tr_b16 a[242:243], v22 offset:288
    v_mfma_f32_16x16x32_bf16 v[172:175], a[176:179], v[68:71], v[108:111]
    v_exp_f32 v116, v116
    v_mfma_f32_16x16x16_bf16 v[32:35], a[244:245], v[252:253], 0
    v_mfma_f32_16x16x16_bf16 v[28:31], a[246:247], v[252:253], 0
    s_nop 0
    s_add_u32 m0, s46, 124928
    s_mov_b32 s45, 247808
    buffer_load_dwordx4 v254, s[20:23], s45 offen sc1 lds
    v_mfma_f32_16x16x32_bf16 v[172:175], a[180:183], v[72:75], v[172:175]
    s_nop 0
    ds_read_b64_tr_b16 a[208:209], v7 offset:16384
    v_cvt_pk_bf16_f32 v243, v178, v179
    v_mfma_f32_16x16x32_bf16 v[172:175], a[184:187], v[76:79], v[172:175]
    s_nop 0
    v_exp_f32 v117, v117
    v_mfma_f32_16x16x32_bf16 v[172:175], a[188:191], v[80:83], v[172:175]
    s_nop 0
    ds_read_b64_tr_b16 a[210:211], v7 offset:20480
    v_mov_b32_dpp v32, v28 row_shr:8 row_mask:0xf bank_mask:0xc
    v_mfma_f32_16x16x32_bf16 v[176:179], a[188:191], v[96:99], v[112:115]
    v_exp_f32 v118, v118
    v_mfma_f32_16x16x32_bf16 v[176:179], a[184:187], v[92:95], v[176:179]
    ds_read_b128 a[144:147], v1 offset:4096
    v_cvt_pk_bf16_f32 v180, v116, v117
    v_mfma_f32_16x16x32_bf16 v[176:179], a[180:183], v[88:91], v[176:179]
    v_exp_f32 v119, v119
    v_mfma_f32_16x16x32_bf16 v[176:179], a[176:179], v[84:87], v[176:179]
    ds_read_b64_tr_b16 a[212:213], v7 offset:40960
    v_mov_b32_dpp v33, v29 row_shr:8 row_mask:0xf bank_mask:0xc
    v_mfma_f32_16x16x32_bf16 a[0:3], a[192:195], v[212:215], a[0:3]
    v_exp_f32 v120, v120
    v_mfma_f32_16x16x32_bf16 a[0:3], a[196:199], v[216:219], a[0:3]
    ds_read_b64_tr_b16 a[214:215], v7 offset:45056
    v_cvt_pk_bf16_f32 v181, v118, v119
    v_mfma_f32_16x16x32_bf16 a[4:7], a[196:199], v[224:227], a[4:7]
    v_exp_f32 v121, v121
    v_mfma_f32_16x16x32_bf16 a[4:7], a[192:195], v[220:223], a[4:7]
    ds_read_b128 a[148:151], v2 offset:4096
    v_cvt_pk_bf16_f32 v188, v120, v121
    v_mov_b32_dpp v34, v30 row_shr:8 row_mask:0xf bank_mask:0xc
    v_mfma_f32_16x16x32_bf16 a[8:11], a[192:195], v[228:231], a[8:11]
    v_exp_f32 v122, v122
    v_mfma_f32_16x16x32_bf16 a[8:11], a[196:199], v[232:235], a[8:11]
    s_mov_b32 m0, s33
    s_nop 0
    buffer_load_dwordx4 v17, s[12:15], s29 offen offset:2048 lds
    v_mov_b32_dpp v35, v31 row_shr:8 row_mask:0xf bank_mask:0xc
    v_mfma_f32_16x16x32_bf16 a[12:15], a[196:199], v[240:243], a[12:15]
    buffer_store_dwordx4 v[32:35], v23, s[16:19], s42 offen sc1
    v_exp_f32 v123, v123
    v_mfma_f32_16x16x32_bf16 a[12:15], a[192:195], v[236:239], a[12:15]
    s_waitcnt lgkmcnt(6)
    s_add_u32 s42, s42, 27648
    s_add_u32 m0, s46, 125952
    s_mov_b32 s45, 248832
    buffer_load_dwordx4 v254, s[20:23], s45 offen sc1 lds
    v_mfma_f32_16x16x32_bf16 v[116:119], a[128:131], v[36:39], v[100:103]
    v_exp_f32 v124, v124
    v_mfma_f32_16x16x16_bf16 v[24:27], a[248:249], v[252:253], 0
    v_mfma_f32_16x16x16_bf16 v[28:31], a[250:251], v[252:253], 0
    s_nop 0
    s_add_u32 m0, s46, 126976
    s_mov_b32 s45, 249856
    buffer_load_dwordx4 v254, s[20:23], s45 offen sc1 lds
    v_mfma_f32_16x16x32_bf16 v[116:119], a[132:135], v[40:43], v[116:119]
    s_nop 0
    ds_read_b64_tr_b16 a[216:217], v8 offset:16384
    v_cvt_pk_bf16_f32 v189, v122, v123
    v_mfma_f32_16x16x32_bf16 v[116:119], a[136:139], v[44:47], v[116:119]
    s_nop 0
    v_exp_f32 v125, v125
    v_mfma_f32_16x16x32_bf16 v[116:119], a[140:143], v[48:51], v[116:119]
    s_nop 0
    ds_read_b64_tr_b16 a[218:219], v8 offset:20480
    v_mov_b32_dpp v24, v28 row_shr:8 row_mask:0xf bank_mask:0xc
    v_mfma_f32_16x16x32_bf16 v[120:123], a[140:143], v[64:67], v[104:107]
    v_exp_f32 v126, v126
    v_mfma_f32_16x16x32_bf16 v[120:123], a[136:139], v[60:63], v[120:123]
    ds_read_b128 a[152:155], v3 offset:4096
    v_cvt_pk_bf16_f32 v196, v124, v125
    v_mfma_f32_16x16x32_bf16 v[120:123], a[132:135], v[56:59], v[120:123]
    v_exp_f32 v127, v127
    v_mfma_f32_16x16x32_bf16 v[120:123], a[128:131], v[52:55], v[120:123]
    ds_read_b64_tr_b16 a[220:221], v8 offset:40960
    v_mov_b32_dpp v25, v29 row_shr:8 row_mask:0xf bank_mask:0xc
    v_mfma_f32_16x16x32_bf16 a[16:19], a[200:203], v[212:215], a[16:19]
    v_exp_f32 v128, v128
    v_mfma_f32_16x16x32_bf16 a[16:19], a[204:207], v[216:219], a[16:19]
    ds_read_b64_tr_b16 a[222:223], v8 offset:45056
    v_cvt_pk_bf16_f32 v197, v126, v127
    v_mfma_f32_16x16x32_bf16 a[20:23], a[204:207], v[224:227], a[20:23]
    v_exp_f32 v129, v129
    v_mfma_f32_16x16x32_bf16 a[20:23], a[200:203], v[220:223], a[20:23]
    ds_read_b128 a[156:159], v4 offset:4096
    v_mov_b32_dpp v26, v30 row_shr:8 row_mask:0xf bank_mask:0xc
    v_mfma_f32_16x16x32_bf16 a[24:27], a[200:203], v[228:231], a[24:27]
    v_exp_f32 v130, v130
    v_mfma_f32_16x16x32_bf16 a[24:27], a[204:207], v[232:235], a[24:27]
    v_cvt_pk_bf16_f32 v204, v128, v129
    v_mov_b32_dpp v27, v31 row_shr:8 row_mask:0xf bank_mask:0xc
    v_mfma_f32_16x16x32_bf16 a[28:31], a[204:207], v[240:243], a[28:31]
    v_exp_f32 v131, v131
    v_mfma_f32_16x16x32_bf16 a[28:31], a[200:203], v[236:239], a[28:31]
    s_mov_b32 m0, s33
    s_nop 0
    buffer_load_dwordx4 v18, s[12:15], s29 offen offset:3072 lds
    buffer_store_dwordx4 v[24:27], v23, s[16:19], s42 offen sc1
    v_smfmac_f32_16x16x64_bf16 a[224:227], v[244:247], v[212:219], v248
    s_waitcnt lgkmcnt(6)
    s_add_u32 s29, s29, 16384
    s_add_u32 s42, s42, 27648
    s_add_u32 m0, s46, 128000
    s_mov_b32 s45, 266240
    buffer_load_dwordx4 v254, s[20:23], s45 offen sc1 lds
    v_mfma_f32_16x16x32_bf16 v[124:127], a[128:131], v[68:71], v[108:111]
    v_exp_f32 v132, v132
    v_mfma_f32_16x16x16_bf16 v[32:35], a[252:253], v[252:253], 0
    v_mfma_f32_16x16x16_bf16 v[28:31], a[254:255], v[252:253], 0
    s_nop 0
    s_add_u32 m0, s46, 129024
    s_mov_b32 s45, 267264
    buffer_load_dwordx4 v254, s[20:23], s45 offen sc1 lds
    v_mfma_f32_16x16x32_bf16 v[124:127], a[132:135], v[72:75], v[124:127]
    s_nop 0
    ds_read_b64_tr_b16 a[192:193], v9 offset:16384
    v_cvt_pk_bf16_f32 v205, v130, v131
    v_mfma_f32_16x16x32_bf16 v[124:127], a[136:139], v[76:79], v[124:127]
    s_nop 0
    v_exp_f32 v133, v133
    v_mfma_f32_16x16x32_bf16 v[124:127], a[140:143], v[80:83], v[124:127]
    s_nop 0
    ds_read_b64_tr_b16 a[194:195], v9 offset:20480
    v_mov_b32_dpp v32, v28 row_shr:8 row_mask:0xf bank_mask:0xc
    v_mfma_f32_16x16x32_bf16 v[128:131], a[140:143], v[96:99], v[112:115]
    v_exp_f32 v134, v134
    v_mfma_f32_16x16x32_bf16 v[128:131], a[136:139], v[92:95], v[128:131]
    ds_read_b128 a[160:163], v1 offset:8192
    v_cvt_pk_bf16_f32 v182, v132, v133
    v_mfma_f32_16x16x32_bf16 v[128:131], a[132:135], v[88:91], v[128:131]
    v_exp_f32 v135, v135
    v_mfma_f32_16x16x32_bf16 v[128:131], a[128:131], v[84:87], v[128:131]
    ds_read_b64_tr_b16 a[196:197], v9 offset:40960
    v_mov_b32_dpp v33, v29 row_shr:8 row_mask:0xf bank_mask:0xc
    v_mfma_f32_16x16x32_bf16 a[32:35], a[208:211], v[212:215], a[32:35]
    v_exp_f32 v136, v136
    v_mfma_f32_16x16x32_bf16 a[32:35], a[212:215], v[216:219], a[32:35]
    ds_read_b64_tr_b16 a[198:199], v9 offset:45056
    v_cvt_pk_bf16_f32 v183, v134, v135
    v_mfma_f32_16x16x32_bf16 a[36:39], a[212:215], v[224:227], a[36:39]
    v_exp_f32 v137, v137
    v_mfma_f32_16x16x32_bf16 a[36:39], a[208:211], v[220:223], a[36:39]
    ds_read_b128 a[164:167], v2 offset:8192
    v_mov_b32_dpp v34, v30 row_shr:8 row_mask:0xf bank_mask:0xc
    v_mfma_f32_16x16x32_bf16 a[40:43], a[208:211], v[228:231], a[40:43]
    v_exp_f32 v138, v138
    v_mfma_f32_16x16x32_bf16 a[40:43], a[212:215], v[232:235], a[40:43]
    v_cvt_pk_bf16_f32 v190, v136, v137
    v_mov_b32_dpp v35, v31 row_shr:8 row_mask:0xf bank_mask:0xc
    v_mfma_f32_16x16x32_bf16 a[44:47], a[212:215], v[240:243], a[44:47]
    buffer_store_dwordx4 v[32:35], v23, s[16:19], s42 offen sc1
    v_exp_f32 v139, v139
    v_mfma_f32_16x16x32_bf16 a[44:47], a[208:211], v[236:239], a[44:47]
    s_waitcnt lgkmcnt(6)
    s_add_u32 s42, s42, 27648
    s_add_u32 m0, s46, 130048
    s_mov_b32 s45, 268288
    buffer_load_dwordx4 v254, s[20:23], s45 offen sc1 lds
    v_mfma_f32_16x16x32_bf16 v[132:135], a[144:147], v[36:39], v[100:103]
    v_exp_f32 v140, v140
    v_mfma_f32_16x16x16_bf16 v[24:27], a[240:241], v[252:253], 0
    v_mfma_f32_16x16x16_bf16 v[28:31], a[242:243], v[252:253], 0
    s_nop 0
    s_add_u32 m0, s46, 131072
    s_mov_b32 s45, 269312
    buffer_load_dwordx4 v254, s[20:23], s45 offen sc1 lds
    v_mfma_f32_16x16x32_bf16 v[132:135], a[148:151], v[40:43], v[132:135]
    s_nop 0
    ds_read_b64_tr_b16 a[200:201], v10 offset:16384
    v_cvt_pk_bf16_f32 v191, v138, v139
    v_mfma_f32_16x16x32_bf16 v[132:135], a[152:155], v[44:47], v[132:135]
    s_nop 0
    v_exp_f32 v141, v141
    v_mfma_f32_16x16x32_bf16 v[132:135], a[156:159], v[48:51], v[132:135]
    s_nop 0
    ds_read_b64_tr_b16 a[202:203], v10 offset:20480
    v_mov_b32_dpp v24, v28 row_shr:8 row_mask:0xf bank_mask:0xc
    v_mfma_f32_16x16x32_bf16 v[136:139], a[156:159], v[64:67], v[104:107]
    v_exp_f32 v142, v142
    v_mfma_f32_16x16x32_bf16 v[136:139], a[152:155], v[60:63], v[136:139]
    ds_read_b128 a[168:171], v3 offset:8192
    v_cvt_pk_bf16_f32 v198, v140, v141
    v_mfma_f32_16x16x32_bf16 v[136:139], a[148:151], v[56:59], v[136:139]
    v_exp_f32 v143, v143
    v_mfma_f32_16x16x32_bf16 v[136:139], a[144:147], v[52:55], v[136:139]
    ds_read_b64_tr_b16 a[204:205], v10 offset:40960
    v_mov_b32_dpp v25, v29 row_shr:8 row_mask:0xf bank_mask:0xc
    v_mfma_f32_16x16x32_bf16 a[48:51], a[216:219], v[212:215], a[48:51]
    v_exp_f32 v144, v144
    v_mfma_f32_16x16x32_bf16 a[48:51], a[220:223], v[216:219], a[48:51]
    ds_read_b64_tr_b16 a[206:207], v10 offset:45056
    v_cvt_pk_bf16_f32 v199, v142, v143
    v_mfma_f32_16x16x32_bf16 a[52:55], a[220:223], v[224:227], a[52:55]
    v_exp_f32 v145, v145
    v_mfma_f32_16x16x32_bf16 a[52:55], a[216:219], v[220:223], a[52:55]
    ds_read_b128 a[172:175], v4 offset:8192
    v_mov_b32_dpp v26, v30 row_shr:8 row_mask:0xf bank_mask:0xc
    v_mfma_f32_16x16x32_bf16 a[56:59], a[216:219], v[228:231], a[56:59]
    v_exp_f32 v146, v146
    v_mfma_f32_16x16x32_bf16 a[56:59], a[220:223], v[232:235], a[56:59]
    v_cvt_pk_bf16_f32 v206, v144, v145
    v_mov_b32_dpp v27, v31 row_shr:8 row_mask:0xf bank_mask:0xc
    v_mfma_f32_16x16x32_bf16 a[60:63], a[220:223], v[240:243], a[60:63]
    v_exp_f32 v147, v147
    v_mfma_f32_16x16x32_bf16 a[60:63], a[216:219], v[236:239], a[60:63]
    buffer_store_dwordx4 v[24:27], v23, s[16:19], s42 offen sc1
    v_smfmac_f32_16x16x64_bf16 a[228:231], v[244:247], v[220:227], v248
    s_waitcnt lgkmcnt(6)
    s_add_u32 s42, s42, 27648
    s_add_u32 m0, s46, 132096
    s_mov_b32 s45, 270336
    buffer_load_dwordx4 v254, s[20:23], s45 offen sc1 lds
    v_mfma_f32_16x16x32_bf16 v[140:143], a[144:147], v[68:71], v[108:111]
    v_exp_f32 v148, v148
    v_mfma_f32_16x16x32_bf16 v[140:143], a[148:151], v[72:75], v[140:143]
    ds_read_b64_tr_b16 a[208:209], v11 offset:16384
    v_cvt_pk_bf16_f32 v207, v146, v147
    v_mfma_f32_16x16x32_bf16 v[140:143], a[152:155], v[76:79], v[140:143]
    v_exp_f32 v149, v149
    v_mfma_f32_16x16x32_bf16 v[140:143], a[156:159], v[80:83], v[140:143]
    ds_read_b64_tr_b16 a[210:211], v11 offset:20480
    v_mfma_f32_16x16x32_bf16 v[144:147], a[156:159], v[96:99], v[112:115]
    v_exp_f32 v150, v150
    v_mfma_f32_16x16x32_bf16 v[144:147], a[152:155], v[92:95], v[144:147]
    ds_read_b128 a[176:179], v1 offset:12288
    v_cvt_pk_bf16_f32 v184, v148, v149
    v_mfma_f32_16x16x32_bf16 v[144:147], a[148:151], v[88:91], v[144:147]
    v_exp_f32 v151, v151
    v_mfma_f32_16x16x32_bf16 v[144:147], a[144:147], v[84:87], v[144:147]
    ds_read_b64_tr_b16 a[212:213], v11 offset:40960
    v_mfma_f32_16x16x32_bf16 a[64:67], a[192:195], v[212:215], a[64:67]
    v_exp_f32 v152, v152
    v_mfma_f32_16x16x32_bf16 a[64:67], a[196:199], v[216:219], a[64:67]
    ds_read_b64_tr_b16 a[214:215], v11 offset:45056
    v_cvt_pk_bf16_f32 v185, v150, v151
    v_mfma_f32_16x16x32_bf16 a[68:71], a[196:199], v[224:227], a[68:71]
    v_exp_f32 v153, v153
    v_mfma_f32_16x16x32_bf16 a[68:71], a[192:195], v[220:223], a[68:71]
    ds_read_b128 a[180:183], v2 offset:12288
    v_mfma_f32_16x16x32_bf16 a[72:75], a[192:195], v[228:231], a[72:75]
    v_exp_f32 v154, v154
    v_mfma_f32_16x16x32_bf16 a[72:75], a[196:199], v[232:235], a[72:75]
    v_cvt_pk_bf16_f32 v192, v152, v153
    v_mfma_f32_16x16x32_bf16 a[76:79], a[196:199], v[240:243], a[76:79]
    v_exp_f32 v155, v155
    v_mfma_f32_16x16x32_bf16 a[76:79], a[192:195], v[236:239], a[76:79]
    s_waitcnt lgkmcnt(6)
    v_mfma_f32_16x16x32_bf16 v[148:151], a[160:163], v[36:39], v[100:103]
    v_exp_f32 v156, v156
    v_mfma_f32_16x16x32_bf16 v[148:151], a[164:167], v[40:43], v[148:151]
    ds_read_b64_tr_b16 a[216:217], v12 offset:16384
    v_cvt_pk_bf16_f32 v193, v154, v155
    v_mfma_f32_16x16x32_bf16 v[148:151], a[168:171], v[44:47], v[148:151]
    v_exp_f32 v157, v157
    v_mfma_f32_16x16x32_bf16 v[148:151], a[172:175], v[48:51], v[148:151]
    ds_read_b64_tr_b16 a[218:219], v12 offset:20480
    v_mfma_f32_16x16x32_bf16 v[152:155], a[172:175], v[64:67], v[104:107]
    v_exp_f32 v158, v158
    v_mfma_f32_16x16x32_bf16 v[152:155], a[168:171], v[60:63], v[152:155]
    ds_read_b128 a[184:187], v3 offset:12288
    v_cvt_pk_bf16_f32 v200, v156, v157
    v_mfma_f32_16x16x32_bf16 v[152:155], a[164:167], v[56:59], v[152:155]
    v_exp_f32 v159, v159
    v_mfma_f32_16x16x32_bf16 v[152:155], a[160:163], v[52:55], v[152:155]
    ds_read_b64_tr_b16 a[220:221], v12 offset:40960
    v_mfma_f32_16x16x32_bf16 a[80:83], a[200:203], v[212:215], a[80:83]
    v_exp_f32 v160, v160
    v_mfma_f32_16x16x32_bf16 a[80:83], a[204:207], v[216:219], a[80:83]
    ds_read_b64_tr_b16 a[222:223], v12 offset:45056
    v_cvt_pk_bf16_f32 v201, v158, v159
    v_mfma_f32_16x16x32_bf16 a[84:87], a[204:207], v[224:227], a[84:87]
    v_exp_f32 v161, v161
    v_mfma_f32_16x16x32_bf16 a[84:87], a[200:203], v[220:223], a[84:87]
    ds_read_b128 a[188:191], v4 offset:12288
    v_mfma_f32_16x16x32_bf16 a[88:91], a[200:203], v[228:231], a[88:91]
    v_exp_f32 v162, v162
    v_mfma_f32_16x16x32_bf16 a[88:91], a[204:207], v[232:235], a[88:91]
    v_cvt_pk_bf16_f32 v208, v160, v161
    v_mfma_f32_16x16x32_bf16 a[92:95], a[204:207], v[240:243], a[92:95]
    v_exp_f32 v163, v163
    v_mfma_f32_16x16x32_bf16 a[92:95], a[200:203], v[236:239], a[92:95]
    v_smfmac_f32_16x16x64_bf16 a[232:235], v[244:247], v[228:235], v248
    s_waitcnt vmcnt(19) lgkmcnt(0)
    s_barrier
    v_mfma_f32_16x16x32_bf16 v[156:159], a[160:163], v[68:71], v[108:111]
    v_exp_f32 v164, v164
    v_mfma_f32_16x16x32_bf16 v[156:159], a[164:167], v[72:75], v[156:159]
    ds_read_b64_tr_b16 a[192:193], v5 offset:57344
    v_cvt_pk_bf16_f32 v209, v162, v163
    v_mfma_f32_16x16x32_bf16 v[156:159], a[168:171], v[76:79], v[156:159]
    v_exp_f32 v165, v165
    v_mfma_f32_16x16x32_bf16 v[156:159], a[172:175], v[80:83], v[156:159]
    ds_read_b64_tr_b16 a[194:195], v5 offset:61440
    v_mfma_f32_16x16x32_bf16 v[160:163], a[172:175], v[96:99], v[112:115]
    v_exp_f32 v166, v166
    v_mfma_f32_16x16x32_bf16 v[160:163], a[168:171], v[92:95], v[160:163]
    ds_read_b64_tr_b16 a[196:197], v5 offset:0
    v_cvt_pk_bf16_f32 v186, v164, v165
    v_mfma_f32_16x16x32_bf16 v[160:163], a[164:167], v[88:91], v[160:163]
    s_add_u32 m0, s46, 81920
    s_mov_b32 s45, 286720
    buffer_load_dwordx4 v254, s[20:23], s45 offen sc1 lds
    v_exp_f32 v167, v167
    v_mfma_f32_16x16x32_bf16 v[160:163], a[160:163], v[84:87], v[160:163]
    ds_read_b64_tr_b16 a[198:199], v5 offset:4096
    v_mfma_f32_16x16x32_bf16 a[96:99], a[208:211], v[212:215], a[96:99]
    v_exp_f32 v168, v168
    v_mfma_f32_16x16x32_bf16 a[96:99], a[212:215], v[216:219], a[96:99]
    v_cvt_pk_bf16_f32 v187, v166, v167
    v_mfma_f32_16x16x32_bf16 a[100:103], a[212:215], v[224:227], a[100:103]
    v_exp_f32 v169, v169
    v_mfma_f32_16x16x32_bf16 a[100:103], a[208:211], v[220:223], a[100:103]
    s_add_u32 m0, s46, 82944
    s_mov_b32 s45, 287744
    buffer_load_dwordx4 v254, s[20:23], s45 offen sc1 lds
    v_mfma_f32_16x16x32_bf16 a[104:107], a[208:211], v[228:231], a[104:107]
    v_exp_f32 v170, v170
    v_mfma_f32_16x16x32_bf16 a[104:107], a[212:215], v[232:235], a[104:107]
    v_cvt_pk_bf16_f32 v194, v168, v169
    v_mfma_f32_16x16x32_bf16 a[108:111], a[212:215], v[240:243], a[108:111]
    v_exp_f32 v171, v171
    v_mfma_f32_16x16x32_bf16 a[108:111], a[208:211], v[236:239], a[108:111]
    s_waitcnt lgkmcnt(4)
    s_add_u32 m0, s46, 83968
    s_mov_b32 s45, 288768
    buffer_load_dwordx4 v254, s[20:23], s45 offen sc1 lds
    v_mfma_f32_16x16x32_bf16 v[164:167], a[176:179], v[36:39], v[100:103]
    v_exp_f32 v172, v172
    v_mfma_f32_16x16x32_bf16 v[164:167], a[180:183], v[40:43], v[164:167]
    ds_read_b64_tr_b16 a[200:201], v6 offset:57344
    v_cvt_pk_bf16_f32 v195, v170, v171
    v_mfma_f32_16x16x32_bf16 v[164:167], a[184:187], v[44:47], v[164:167]
    v_exp_f32 v173, v173
    v_mfma_f32_16x16x32_bf16 v[164:167], a[188:191], v[48:51], v[164:167]
    ds_read_b64_tr_b16 a[202:203], v6 offset:61440
    v_mfma_f32_16x16x32_bf16 v[168:171], a[188:191], v[64:67], v[104:107]
    v_exp_f32 v174, v174
    v_mfma_f32_16x16x32_bf16 v[168:171], a[184:187], v[60:63], v[168:171]
    ds_read_b64_tr_b16 a[204:205], v6 offset:0
    v_cvt_pk_bf16_f32 v202, v172, v173
    v_mfma_f32_16x16x32_bf16 v[168:171], a[180:183], v[56:59], v[168:171]
    v_exp_f32 v175, v175
    v_mfma_f32_16x16x32_bf16 v[168:171], a[176:179], v[52:55], v[168:171]
    ds_read_b64_tr_b16 a[206:207], v6 offset:4096
    v_mfma_f32_16x16x32_bf16 a[112:115], a[216:219], v[212:215], a[112:115]
    v_exp_f32 v176, v176
    v_mfma_f32_16x16x32_bf16 a[112:115], a[220:223], v[216:219], a[112:115]
    v_cvt_pk_bf16_f32 v203, v174, v175
    v_mfma_f32_16x16x32_bf16 a[116:119], a[220:223], v[224:227], a[116:119]
    s_add_u32 m0, s46, 84992
    s_mov_b32 s45, 289792
    buffer_load_dwordx4 v254, s[20:23], s45 offen sc1 lds
    v_exp_f32 v177, v177
    v_mfma_f32_16x16x32_bf16 a[116:119], a[216:219], v[220:223], a[116:119]
    s_add_u32 m0, s46, 86016
    s_mov_b32 s45, 290816
    buffer_load_dwordx4 v254, s[20:23], s45 offen sc1 lds
    v_mfma_f32_16x16x32_bf16 a[120:123], a[216:219], v[228:231], a[120:123]
    v_exp_f32 v178, v178
    v_mfma_f32_16x16x32_bf16 a[120:123], a[220:223], v[232:235], a[120:123]
    v_cvt_pk_bf16_f32 v210, v176, v177
    v_mfma_f32_16x16x32_bf16 a[124:127], a[220:223], v[240:243], a[124:127]
    v_exp_f32 v179, v179
    v_mfma_f32_16x16x32_bf16 a[124:127], a[216:219], v[236:239], a[124:127]
    v_smfmac_f32_16x16x64_bf16 a[236:239], v[244:247], v[236:243], v248
    s_waitcnt lgkmcnt(4)
    v_mfma_f32_16x16x32_bf16 v[172:175], a[176:179], v[68:71], v[108:111]
    v_exp_f32 v116, v116
    v_mfma_f32_16x16x32_bf16 v[172:175], a[180:183], v[72:75], v[172:175]
    ds_read_b64_tr_b16 a[208:209], v7 offset:57344
    v_cvt_pk_bf16_f32 v211, v178, v179
    v_mfma_f32_16x16x32_bf16 v[172:175], a[184:187], v[76:79], v[172:175]
    v_exp_f32 v117, v117
    v_mfma_f32_16x16x32_bf16 v[172:175], a[188:191], v[80:83], v[172:175]
    ds_read_b64_tr_b16 a[210:211], v7 offset:61440
    v_mfma_f32_16x16x32_bf16 v[176:179], a[188:191], v[96:99], v[112:115]
    v_exp_f32 v118, v118
    v_mfma_f32_16x16x32_bf16 v[176:179], a[184:187], v[92:95], v[176:179]
    ds_read_b64_tr_b16 a[212:213], v7 offset:0
    v_cvt_pk_bf16_f32 v212, v116, v117
    v_mfma_f32_16x16x32_bf16 v[176:179], a[180:183], v[88:91], v[176:179]
    v_exp_f32 v119, v119
    v_mfma_f32_16x16x32_bf16 v[176:179], a[176:179], v[84:87], v[176:179]
    ds_read_b64_tr_b16 a[214:215], v7 offset:4096
    v_mfma_f32_16x16x32_bf16 a[0:3], a[192:195], v[180:183], a[0:3]
    v_exp_f32 v120, v120
    v_mfma_f32_16x16x32_bf16 a[0:3], a[196:199], v[184:187], a[0:3]
    s_add_u32 m0, s46, 87040
    s_mov_b32 s45, 307200
    buffer_load_dwordx4 v254, s[20:23], s45 offen sc1 lds
    v_cvt_pk_bf16_f32 v213, v118, v119
    v_mfma_f32_16x16x32_bf16 a[4:7], a[196:199], v[192:195], a[4:7]
    v_exp_f32 v121, v121
    v_mfma_f32_16x16x32_bf16 a[4:7], a[192:195], v[188:191], a[4:7]
    s_add_u32 m0, s46, 88064
    s_mov_b32 s45, 308224
    buffer_load_dwordx4 v254, s[20:23], s45 offen sc1 lds
    v_mfma_f32_16x16x32_bf16 a[8:11], a[192:195], v[196:199], a[8:11]
    v_exp_f32 v122, v122
    v_mfma_f32_16x16x32_bf16 a[8:11], a[196:199], v[200:203], a[8:11]
    v_cvt_pk_bf16_f32 v220, v120, v121
    v_mfma_f32_16x16x32_bf16 a[12:15], a[196:199], v[208:211], a[12:15]
    v_exp_f32 v123, v123
    v_mfma_f32_16x16x32_bf16 a[12:15], a[192:195], v[204:207], a[12:15]
    s_waitcnt lgkmcnt(4)
    s_add_u32 m0, s46, 89088
    s_mov_b32 s45, 309248
    buffer_load_dwordx4 v254, s[20:23], s45 offen sc1 lds
    v_mfma_f32_16x16x32_bf16 a[16:19], a[200:203], v[180:183], a[16:19]
    ds_read_b64_tr_b16 a[216:217], v8 offset:57344
    v_cvt_pk_bf16_f32 v221, v122, v123
    v_exp_f32 v124, v124
    v_mfma_f32_16x16x32_bf16 a[16:19], a[204:207], v[184:187], a[16:19]
    ds_read_b64_tr_b16 a[218:219], v8 offset:61440
    v_exp_f32 v125, v125
    v_mfma_f32_16x16x32_bf16 a[20:23], a[204:207], v[192:195], a[20:23]
    ds_read_b64_tr_b16 a[220:221], v8 offset:0
    v_cvt_pk_bf16_f32 v228, v124, v125
    v_exp_f32 v126, v126
    v_mov_b32 v114, v254
    v_mfma_f32_16x16x32_bf16 a[20:23], a[200:203], v[188:191], a[20:23]
    ds_read_b64_tr_b16 a[222:223], v8 offset:4096
    v_exp_f32 v127, v127
    v_mfma_f32_16x16x32_bf16 a[24:27], a[200:203], v[196:199], a[24:27]
    v_cvt_pk_bf16_f32 v229, v126, v127
    v_exp_f32 v128, v128
    v_mfma_f32_16x16x32_bf16 a[24:27], a[204:207], v[200:203], a[24:27]
    v_exp_f32 v129, v129
    v_add_u32 v115, 4096, v254
    v_mfma_f32_16x16x32_bf16 a[28:31], a[204:207], v[208:211], a[28:31]
    v_cvt_pk_bf16_f32 v236, v128, v129
    v_exp_f32 v130, v130
    v_mfma_f32_16x16x32_bf16 a[28:31], a[200:203], v[204:207], a[28:31]
    v_exp_f32 v131, v131
    v_smfmac_f32_16x16x64_bf16 a[224:227], v[244:247], v[180:187], v248
    s_waitcnt lgkmcnt(4)
    s_add_u32 m0, s46, 90112
    s_mov_b32 s45, 310272
    buffer_load_dwordx4 v254, s[20:23], s45 offen sc1 lds
    v_mov_b32 v0, 2
    v_mfma_f32_16x16x32_bf16 a[32:35], a[208:211], v[180:183], a[32:35]
    ds_read_b64_tr_b16 a[192:193], v9 offset:57344
    v_cvt_pk_bf16_f32 v237, v130, v131
    v_exp_f32 v132, v132
    v_mfma_f32_16x16x32_bf16 a[32:35], a[212:215], v[184:187], a[32:35]
    ds_read_b64_tr_b16 a[194:195], v9 offset:61440
    v_exp_f32 v133, v133
    v_mfma_f32_16x16x32_bf16 a[36:39], a[212:215], v[192:195], a[36:39]
    ds_read_b64_tr_b16 a[196:197], v9 offset:0
    v_cvt_pk_bf16_f32 v214, v132, v133
    v_exp_f32 v134, v134
    v_mfma_f32_16x16x32_bf16 a[36:39], a[208:211], v[188:191], a[36:39]
    ds_read_b64_tr_b16 a[198:199], v9 offset:4096
    v_exp_f32 v135, v135
    v_mfma_f32_16x16x32_bf16 a[40:43], a[208:211], v[196:199], a[40:43]
    v_cvt_pk_bf16_f32 v215, v134, v135
    v_exp_f32 v136, v136
    v_mfma_f32_16x16x32_bf16 a[40:43], a[212:215], v[200:203], a[40:43]
    v_exp_f32 v137, v137
    v_mfma_f32_16x16x32_bf16 a[44:47], a[212:215], v[208:211], a[44:47]
    v_cvt_pk_bf16_f32 v222, v136, v137
    v_exp_f32 v138, v138
    v_mfma_f32_16x16x32_bf16 a[44:47], a[208:211], v[204:207], a[44:47]
    s_waitcnt lgkmcnt(4)
    s_add_u32 m0, s46, 91136
    s_mov_b32 s45, 311296
    buffer_load_dwordx4 v254, s[20:23], s45 offen sc1 lds
    v_exp_f32 v139, v139
    v_mfma_f32_16x16x32_bf16 a[48:51], a[216:219], v[180:183], a[48:51]
    s_mov_b32 s45, 0
    ds_read_b64_tr_b16 a[200:201], v10 offset:57344
    v_cvt_pk_bf16_f32 v223, v138, v139
    v_exp_f32 v140, v140
    v_mfma_f32_16x16x32_bf16 a[48:51], a[220:223], v[184:187], a[48:51]
    ds_read_b64_tr_b16 a[202:203], v10 offset:61440
    v_exp_f32 v141, v141
    v_mfma_f32_16x16x32_bf16 a[52:55], a[220:223], v[192:195], a[52:55]
    ds_read_b64_tr_b16 a[204:205], v10 offset:0
    buffer_load_dwordx4 a[128:131], v114, s[20:23], s45 offen offset:0 sc1
    v_cvt_pk_bf16_f32 v230, v140, v141
    v_exp_f32 v142, v142
    v_mfma_f32_16x16x32_bf16 a[52:55], a[216:219], v[188:191], a[52:55]
    s_mov_b32 s45, 0
    ds_read_b64_tr_b16 a[206:207], v10 offset:4096
    v_exp_f32 v143, v143
    v_mfma_f32_16x16x32_bf16 a[56:59], a[216:219], v[196:199], a[56:59]
    v_cvt_pk_bf16_f32 v231, v142, v143
    v_exp_f32 v144, v144
    v_mfma_f32_16x16x32_bf16 a[56:59], a[220:223], v[200:203], a[56:59]
    buffer_load_dwordx4 a[132:135], v114, s[20:23], s45 offen offset:1024 sc1
    v_exp_f32 v145, v145
    v_mfma_f32_16x16x32_bf16 a[60:63], a[220:223], v[208:211], a[60:63]
    s_mov_b32 s45, 0
    v_cvt_pk_bf16_f32 v238, v144, v145
    v_exp_f32 v146, v146
    v_mfma_f32_16x16x32_bf16 a[60:63], a[216:219], v[204:207], a[60:63]
    v_exp_f32 v147, v147
    v_smfmac_f32_16x16x64_bf16 a[228:231], v[244:247], v[188:195], v248
    s_waitcnt lgkmcnt(4)
    buffer_load_dwordx4 a[136:139], v114, s[20:23], s45 offen offset:2048 sc1
    v_mfma_f32_16x16x32_bf16 a[64:67], a[192:195], v[180:183], a[64:67]
    s_mov_b32 s45, 0
    ds_read_b64_tr_b16 a[208:209], v11 offset:57344
    v_cvt_pk_bf16_f32 v239, v146, v147
    v_exp_f32 v148, v148
    v_mfma_f32_16x16x32_bf16 a[64:67], a[196:199], v[184:187], a[64:67]
    ds_read_b64_tr_b16 a[210:211], v11 offset:61440
    buffer_load_dwordx4 a[140:143], v114, s[20:23], s45 offen offset:3072 sc1
    v_exp_f32 v149, v149
    v_mfma_f32_16x16x32_bf16 a[68:71], a[196:199], v[192:195], a[68:71]
    s_mov_b32 s45, 0
    ds_read_b64_tr_b16 a[212:213], v11 offset:0
    v_cvt_pk_bf16_f32 v216, v148, v149
    v_exp_f32 v150, v150
    v_mfma_f32_16x16x32_bf16 a[68:71], a[192:195], v[188:191], a[68:71]
    ds_read_b64_tr_b16 a[214:215], v11 offset:4096
    v_exp_f32 v151, v151
    v_mfma_f32_16x16x32_bf16 a[72:75], a[192:195], v[196:199], a[72:75]
    buffer_load_dwordx4 a[144:147], v115, s[20:23], s45 offen offset:0 sc1
    v_cvt_pk_bf16_f32 v217, v150, v151
    v_exp_f32 v152, v152
    v_mfma_f32_16x16x32_bf16 a[72:75], a[196:199], v[200:203], a[72:75]
    s_mov_b32 s45, 20480
    v_exp_f32 v153, v153
    v_mfma_f32_16x16x32_bf16 a[76:79], a[196:199], v[208:211], a[76:79]
    buffer_load_dwordx4 a[148:151], v114, s[20:23], s45 offen offset:0 sc1
    v_cvt_pk_bf16_f32 v224, v152, v153
    v_exp_f32 v154, v154
    v_mfma_f32_16x16x32_bf16 a[76:79], a[192:195], v[204:207], a[76:79]
    s_waitcnt lgkmcnt(4)
    v_exp_f32 v155, v155
    v_mfma_f32_16x16x32_bf16 a[80:83], a[200:203], v[180:183], a[80:83]
    s_mov_b32 s45, 20480
    ds_read_b64_tr_b16 a[216:217], v12 offset:57344
    v_cvt_pk_bf16_f32 v225, v154, v155
    v_exp_f32 v156, v156
    v_mfma_f32_16x16x32_bf16 a[80:83], a[204:207], v[184:187], a[80:83]
    ds_read_b64_tr_b16 a[218:219], v12 offset:61440
    buffer_load_dwordx4 a[152:155], v114, s[20:23], s45 offen offset:1024 sc1
    v_exp_f32 v157, v157
    v_mfma_f32_16x16x32_bf16 a[84:87], a[204:207], v[192:195], a[84:87]
    s_mov_b32 s45, 20480
    ds_read_b64_tr_b16 a[220:221], v12 offset:0
    v_cvt_pk_bf16_f32 v232, v156, v157
    v_exp_f32 v158, v158
    v_mfma_f32_16x16x32_bf16 a[84:87], a[200:203], v[188:191], a[84:87]
    ds_read_b64_tr_b16 a[222:223], v12 offset:4096
    v_exp_f32 v159, v159
    v_mfma_f32_16x16x32_bf16 a[88:91], a[200:203], v[196:199], a[88:91]
    buffer_load_dwordx4 a[156:159], v114, s[20:23], s45 offen offset:2048 sc1
    v_cvt_pk_bf16_f32 v233, v158, v159
    v_exp_f32 v160, v160
    v_mfma_f32_16x16x32_bf16 a[88:91], a[204:207], v[200:203], a[88:91]
    s_mov_b32 s45, 20480
    v_exp_f32 v161, v161
    v_mfma_f32_16x16x32_bf16 a[92:95], a[204:207], v[208:211], a[92:95]
    v_cvt_pk_bf16_f32 v240, v160, v161
    v_exp_f32 v162, v162
    v_mfma_f32_16x16x32_bf16 a[92:95], a[200:203], v[204:207], a[92:95]
    buffer_load_dwordx4 a[160:163], v114, s[20:23], s45 offen offset:3072 sc1
    v_exp_f32 v163, v163
    v_smfmac_f32_16x16x64_bf16 a[232:235], v[244:247], v[196:203], v248
    s_waitcnt vmcnt(20) lgkmcnt(0)
    s_barrier
    v_mfma_f32_16x16x32_bf16 a[96:99], a[208:211], v[180:183], a[96:99]
    s_mov_b32 s45, 20480
    ds_read_b64_tr_b16 a[192:193], v5 offset:24576
    buffer_load_dwordx4 a[164:167], v115, s[20:23], s45 offen offset:0 sc1
    v_cvt_pk_bf16_f32 v241, v162, v163
    v_exp_f32 v164, v164
    v_mfma_f32_16x16x32_bf16 a[96:99], a[212:215], v[184:187], a[96:99]
    s_mov_b32 s45, 40960
    ds_read_b64_tr_b16 a[194:195], v5 offset:28672
    v_exp_f32 v165, v165
    v_mfma_f32_16x16x32_bf16 a[100:103], a[212:215], v[192:195], a[100:103]
    ds_read_b64_tr_b16 a[196:197], v5 offset:49152
    v_cvt_pk_bf16_f32 v218, v164, v165
    v_exp_f32 v166, v166
    v_mfma_f32_16x16x32_bf16 a[100:103], a[208:211], v[188:191], a[100:103]
    ds_read_b64_tr_b16 a[198:199], v5 offset:53248
    buffer_load_dwordx4 a[168:171], v114, s[20:23], s45 offen offset:0 sc1
    v_exp_f32 v167, v167
    v_mfma_f32_16x16x32_bf16 a[104:107], a[208:211], v[196:199], a[104:107]
    s_mov_b32 s45, 40960
    v_cvt_pk_bf16_f32 v219, v166, v167
    v_exp_f32 v168, v168
    v_mfma_f32_16x16x32_bf16 a[104:107], a[212:215], v[200:203], a[104:107]
    buffer_load_dwordx4 a[172:175], v114, s[20:23], s45 offen offset:1024 sc1
    v_exp_f32 v169, v169
    v_mfma_f32_16x16x32_bf16 a[108:111], a[212:215], v[208:211], a[108:111]
    s_mov_b32 s45, 40960
    v_cvt_pk_bf16_f32 v226, v168, v169
    v_exp_f32 v170, v170
    v_mfma_f32_16x16x32_bf16 a[108:111], a[208:211], v[204:207], a[108:111]
    s_waitcnt lgkmcnt(4)
    s_cmp_lg_u32 s5, 0
    s_cbranch_scc1 L_ffn_flagged
    s_mov_b64 exec, 1
    buffer_store_dword v0, off, s[76:79], s75 sc1
    s_mov_b64 exec, -1
L_ffn_flagged:
    v_exp_f32 v171, v171
    v_mfma_f32_16x16x32_bf16 a[112:115], a[216:219], v[180:183], a[112:115]
    ds_read_b64_tr_b16 a[200:201], v6 offset:24576
    buffer_load_dwordx4 a[176:179], v114, s[20:23], s45 offen offset:2048 sc1
    v_cvt_pk_bf16_f32 v227, v170, v171
    v_exp_f32 v172, v172
    v_mfma_f32_16x16x32_bf16 a[112:115], a[220:223], v[184:187], a[112:115]
    s_mov_b32 s45, 40960
    ds_read_b64_tr_b16 a[202:203], v6 offset:28672
    v_exp_f32 v173, v173
    v_mfma_f32_16x16x32_bf16 a[116:119], a[220:223], v[192:195], a[116:119]
    ds_read_b64_tr_b16 a[204:205], v6 offset:49152
    v_cvt_pk_bf16_f32 v234, v172, v173
    v_exp_f32 v174, v174
    v_mfma_f32_16x16x32_bf16 a[116:119], a[216:219], v[188:191], a[116:119]
    ds_read_b64_tr_b16 a[206:207], v6 offset:53248
    buffer_load_dwordx4 a[180:183], v114, s[20:23], s45 offen offset:3072 sc1
    v_exp_f32 v175, v175
    v_mfma_f32_16x16x32_bf16 a[120:123], a[216:219], v[196:199], a[120:123]
    s_mov_b32 s45, 40960
    v_cvt_pk_bf16_f32 v235, v174, v175
    v_exp_f32 v176, v176
    v_mfma_f32_16x16x32_bf16 a[120:123], a[220:223], v[200:203], a[120:123]
    v_exp_f32 v177, v177
    v_mfma_f32_16x16x32_bf16 a[124:127], a[220:223], v[208:211], a[124:127]
    buffer_load_dwordx4 a[184:187], v115, s[20:23], s45 offen offset:0 sc1
    v_cvt_pk_bf16_f32 v242, v176, v177
    v_exp_f32 v178, v178
    v_mfma_f32_16x16x32_bf16 a[124:127], a[216:219], v[204:207], a[124:127]
    s_mov_b32 s45, 61440
    v_exp_f32 v179, v179
    v_smfmac_f32_16x16x64_bf16 a[236:239], v[244:247], v[204:211], v248
    s_waitcnt lgkmcnt(4)
    buffer_load_dwordx4 a[188:191], v114, s[20:23], s45 offen offset:0 sc1
    v_mfma_f32_16x16x32_bf16 a[0:3], a[192:195], v[212:215], a[0:3]
    s_lshl_b32 s40, s87, 2
    ds_read_b64_tr_b16 a[208:209], v7 offset:24576
    v_cvt_pk_bf16_f32 v243, v178, v179
    v_mfma_f32_16x16x32_bf16 a[0:3], a[196:199], v[216:219], a[0:3]
    s_add_u32 s40, s40, s5
    ds_read_b64_tr_b16 a[210:211], v7 offset:28672
    v_smfmac_f32_16x16x64_bf16 a[224:227], v[244:247], v[212:219], v248
    s_lshl_b32 s40, s40, 4
    ds_read_b64_tr_b16 a[212:213], v7 offset:49152
    v_and_b32 v35, 15, v19
    v_smfmac_f32_16x16x64_bf16 a[228:231], v[244:247], v[220:227], v248
    ds_read_b64_tr_b16 a[214:215], v7 offset:53248
    v_add_u32 v35, s40, v35
    v_smfmac_f32_16x16x64_bf16 a[232:235], v[244:247], v[228:235], v248
    v_mul_u32_u24 v34, 1280, v35
    v_lshrrev_b32 v116, 4, v19
    v_smfmac_f32_16x16x64_bf16 a[236:239], v[244:247], v[236:243], v248
    v_lshl_add_u32 v34, v116, 3, v34
    v_mfma_f32_16x16x32_bf16 a[4:7], a[196:199], v[224:227], a[4:7]
    s_mul_i32 s40, s100, 160
    v_add_u32 v34, s40, v34
    v_lshlrev_b32 v116, 4, v35
    v_mfma_f32_16x16x32_bf16 a[4:7], a[192:195], v[220:223], a[4:7]
    s_mov_b32 s40, 0x280000
    buffer_load_dwordx2 v[32:33], v116, s[76:79], s40 offen sc1
    v_mfma_f32_16x16x32_bf16 a[8:11], a[192:195], v[228:231], a[8:11]
    buffer_load_dwordx2 v[22:23], v34, s[88:91], 0 offen offset:0
    v_mfma_f32_16x16x32_bf16 a[8:11], a[196:199], v[232:235], a[8:11]
    buffer_load_dwordx2 v[24:25], v34, s[88:91], 0 offen offset:32
    v_mfma_f32_16x16x32_bf16 a[12:15], a[196:199], v[240:243], a[12:15]
    buffer_load_dwordx2 v[26:27], v34, s[88:91], 0 offen offset:64
    v_mfma_f32_16x16x32_bf16 a[12:15], a[192:195], v[236:239], a[12:15]
    s_waitcnt lgkmcnt(4)
    buffer_load_dwordx2 v[28:29], v34, s[88:91], 0 offen offset:96
    v_mfma_f32_16x16x32_bf16 a[16:19], a[200:203], v[212:215], a[16:19]
    ds_read_b64_tr_b16 a[216:217], v8 offset:24576
    v_accvgpr_read_b32 v100, a224
    v_mfma_f32_16x16x32_bf16 a[16:19], a[204:207], v[216:219], a[16:19]
    ds_read_b64_tr_b16 a[218:219], v8 offset:28672
    v_accvgpr_read_b32 v104, a225
    v_accvgpr_read_b32 v101, a228
    v_accvgpr_read_b32 v105, a229
    v_mfma_f32_16x16x32_bf16 a[20:23], a[204:207], v[224:227], a[20:23]
    ds_read_b64_tr_b16 a[220:221], v8 offset:49152
    v_accvgpr_read_b32 v102, a232
    v_accvgpr_read_b32 v106, a233
    v_mfma_f32_16x16x32_bf16 a[20:23], a[200:203], v[220:223], a[20:23]
    ds_read_b64_tr_b16 a[222:223], v8 offset:53248
    v_accvgpr_read_b32 v103, a236
    v_accvgpr_read_b32 v107, a237
    v_add_f32 v100, v100, v104
    v_mfma_f32_16x16x32_bf16 a[24:27], a[200:203], v[228:231], a[24:27]
    buffer_load_dwordx2 v[30:31], v34, s[88:91], 0 offen offset:128
    v_add_f32 v101, v101, v105
    v_add_f32 v102, v102, v106
    v_add_f32 v103, v103, v107
    v_mfma_f32_16x16x32_bf16 a[24:27], a[204:207], v[232:235], a[24:27]
    v_lshlrev_b32 v20, 7, v19
    v_add_u32 v20, 0x290000, v20
    v_maximum3_f32 v108, v100, v101, v102
    v_maximum3_f32 v108, v108, v103, v103
    v_mfma_f32_16x16x32_bf16 a[28:31], a[204:207], v[240:243], a[28:31]
    buffer_load_dwordx4 v[252:255], v20, s[76:79], 0 offen sc1
    v_mul_f32 v108, 0x4d800000, v108
    v_mov_b32 v109, 0
    v_lshlrev_b32 v110, 4, v19
    v_mfma_f32_16x16x32_bf16 a[28:31], a[200:203], v[236:239], a[28:31]
    s_waitcnt lgkmcnt(4)
    v_rcp_f32 v100, v100
    v_rcp_f32 v101, v101
    v_rcp_f32 v102, v102
    v_rcp_f32 v103, v103
    v_mfma_f32_16x16x32_bf16 a[32:35], a[208:211], v[212:215], a[32:35]
    s_mov_b32 s36, 0
    ds_read_b64_tr_b16 a[192:193], v9 offset:24576
    v_accvgpr_read_b32 v120, a0
    v_accvgpr_read_b32 v121, a1
    v_accvgpr_read_b32 v122, a2
    v_accvgpr_read_b32 v123, a3
    v_mfma_f32_16x16x32_bf16 a[32:35], a[212:215], v[216:219], a[32:35]
    ds_read_b64_tr_b16 a[194:195], v9 offset:28672
    v_accvgpr_read_b32 v124, a16
    v_accvgpr_read_b32 v125, a17
    v_accvgpr_read_b32 v126, a18
    v_accvgpr_read_b32 v127, a19
    v_maximum3_f32 v108, v108, |v120|, |v121|
    v_maximum3_f32 v109, v109, |v122|, |v123|
    v_mfma_f32_16x16x32_bf16 a[36:39], a[212:215], v[224:227], a[36:39]
    ds_read_b64_tr_b16 a[196:197], v9 offset:49152
    v_maximum3_f32 v108, v108, |v124|, |v125|
    v_maximum3_f32 v109, v109, |v126|, |v127|
    v_mul_f32 v120, v120, v100
    v_mul_f32 v121, v121, v100
    v_mul_f32 v122, v122, v100
    v_mul_f32 v123, v123, v100
    v_mfma_f32_16x16x32_bf16 a[36:39], a[208:211], v[220:223], a[36:39]
    ds_read_b64_tr_b16 a[198:199], v9 offset:53248
    v_mul_f32 v124, v124, v100
    v_mul_f32 v125, v125, v100
    v_mul_f32 v126, v126, v100
    v_mul_f32 v127, v127, v100
    v_cvt_pk_bf16_f32 v152, v120, v121
    v_cvt_pk_bf16_f32 v153, v122, v123
    v_cvt_pk_bf16_f32 v154, v124, v125
    v_mfma_f32_16x16x32_bf16 a[40:43], a[208:211], v[228:231], a[40:43]
    v_cvt_pk_bf16_f32 v155, v126, v127
    v_mfma_f32_16x16x32_bf16 a[40:43], a[212:215], v[232:235], a[40:43]
    buffer_store_dwordx4 v[152:155], v110, s[24:27], s36 offen offset:0 sc1
    v_accvgpr_read_b32 v128, a4
    v_accvgpr_read_b32 v129, a5
    v_accvgpr_read_b32 v130, a6
    v_accvgpr_read_b32 v131, a7
    v_accvgpr_read_b32 v132, a20
    v_accvgpr_read_b32 v133, a21
    v_accvgpr_read_b32 v134, a22
    v_accvgpr_read_b32 v135, a23
    v_maximum3_f32 v108, v108, |v128|, |v129|
    v_maximum3_f32 v109, v109, |v130|, |v131|
    v_mfma_f32_16x16x32_bf16 a[44:47], a[212:215], v[240:243], a[44:47]
    v_maximum3_f32 v108, v108, |v132|, |v133|
    v_maximum3_f32 v109, v109, |v134|, |v135|
    v_mul_f32 v128, v128, v101
    v_mul_f32 v129, v129, v101
    v_mul_f32 v130, v130, v101
    v_mul_f32 v131, v131, v101
    v_mul_f32 v132, v132, v101
    v_mfma_f32_16x16x32_bf16 a[44:47], a[208:211], v[236:239], a[44:47]
    s_waitcnt lgkmcnt(4)
    v_mul_f32 v133, v133, v101
    v_mul_f32 v134, v134, v101
    v_mul_f32 v135, v135, v101
    v_cvt_pk_bf16_f32 v156, v128, v129
    v_cvt_pk_bf16_f32 v157, v130, v131
    v_cvt_pk_bf16_f32 v158, v132, v133
    v_mfma_f32_16x16x32_bf16 a[48:51], a[216:219], v[212:215], a[48:51]
    ds_read_b64_tr_b16 a[200:201], v10 offset:24576
    v_cvt_pk_bf16_f32 v159, v134, v135
    v_mfma_f32_16x16x32_bf16 a[48:51], a[220:223], v[216:219], a[48:51]
    ds_read_b64_tr_b16 a[202:203], v10 offset:28672
    buffer_store_dwordx4 v[156:159], v110, s[24:27], s36 offen offset:1024 sc1
    v_accvgpr_read_b32 v136, a8
    v_accvgpr_read_b32 v137, a9
    v_accvgpr_read_b32 v138, a10
    v_accvgpr_read_b32 v139, a11
    v_accvgpr_read_b32 v140, a24
    v_accvgpr_read_b32 v141, a25
    v_accvgpr_read_b32 v142, a26
    v_accvgpr_read_b32 v143, a27
    v_maximum3_f32 v108, v108, |v136|, |v137|
    v_maximum3_f32 v109, v109, |v138|, |v139|
    v_maximum3_f32 v108, v108, |v140|, |v141|
    v_mfma_f32_16x16x32_bf16 a[52:55], a[220:223], v[224:227], a[52:55]
    ds_read_b64_tr_b16 a[204:205], v10 offset:49152
    v_maximum3_f32 v109, v109, |v142|, |v143|
    v_mul_f32 v136, v136, v102
    v_mul_f32 v137, v137, v102
    v_mul_f32 v138, v138, v102
    v_mul_f32 v139, v139, v102
    v_mul_f32 v140, v140, v102
    v_mfma_f32_16x16x32_bf16 a[52:55], a[216:219], v[220:223], a[52:55]
    ds_read_b64_tr_b16 a[206:207], v10 offset:53248
    v_mul_f32 v141, v141, v102
    v_mul_f32 v142, v142, v102
    v_mul_f32 v143, v143, v102
    v_cvt_pk_bf16_f32 v160, v136, v137
    v_cvt_pk_bf16_f32 v161, v138, v139
    v_cvt_pk_bf16_f32 v162, v140, v141
    v_mfma_f32_16x16x32_bf16 a[56:59], a[216:219], v[228:231], a[56:59]
    v_cvt_pk_bf16_f32 v163, v142, v143
    v_mfma_f32_16x16x32_bf16 a[56:59], a[220:223], v[232:235], a[56:59]
    buffer_store_dwordx4 v[160:163], v110, s[24:27], s36 offen offset:2048 sc1
    v_accvgpr_read_b32 v144, a12
    v_accvgpr_read_b32 v145, a13
    v_accvgpr_read_b32 v146, a14
    v_accvgpr_read_b32 v147, a15
    v_accvgpr_read_b32 v148, a28
    v_accvgpr_read_b32 v149, a29
    v_accvgpr_read_b32 v150, a30
    v_accvgpr_read_b32 v151, a31
    v_maximum3_f32 v108, v108, |v144|, |v145|
    v_maximum3_f32 v109, v109, |v146|, |v147|
    v_maximum3_f32 v108, v108, |v148|, |v149|
    v_mfma_f32_16x16x32_bf16 a[60:63], a[220:223], v[240:243], a[60:63]
    v_maximum3_f32 v109, v109, |v150|, |v151|
    v_mul_f32 v144, v144, v103
    v_mul_f32 v145, v145, v103
    v_mul_f32 v146, v146, v103
    v_mul_f32 v147, v147, v103
    v_mul_f32 v148, v148, v103
    v_mfma_f32_16x16x32_bf16 a[60:63], a[216:219], v[236:239], a[60:63]
    s_waitcnt lgkmcnt(4)
    v_mul_f32 v149, v149, v103
    v_mul_f32 v150, v150, v103
    v_mul_f32 v151, v151, v103
    v_cvt_pk_bf16_f32 v164, v144, v145
    v_cvt_pk_bf16_f32 v165, v146, v147
    v_cvt_pk_bf16_f32 v166, v148, v149
    v_cvt_pk_bf16_f32 v167, v150, v151
    buffer_store_dwordx4 v[164:167], v110, s[24:27], s36 offen offset:3072 sc1
    v_mfma_f32_16x16x32_bf16 a[64:67], a[192:195], v[212:215], a[64:67]
    s_mov_b32 s36, 4096
    ds_read_b64_tr_b16 a[208:209], v11 offset:24576
    v_accvgpr_read_b32 v120, a32
    v_accvgpr_read_b32 v121, a33
    v_accvgpr_read_b32 v122, a34
    v_accvgpr_read_b32 v123, a35
    v_accvgpr_read_b32 v124, a48
    v_mfma_f32_16x16x32_bf16 a[64:67], a[196:199], v[216:219], a[64:67]
    ds_read_b64_tr_b16 a[210:211], v11 offset:28672
    v_accvgpr_read_b32 v125, a49
    v_accvgpr_read_b32 v126, a50
    v_accvgpr_read_b32 v127, a51
    v_maximum3_f32 v108, v108, |v120|, |v121|
    v_maximum3_f32 v109, v109, |v122|, |v123|
    v_maximum3_f32 v108, v108, |v124|, |v125|
    v_maximum3_f32 v109, v109, |v126|, |v127|
    v_mfma_f32_16x16x32_bf16 a[68:71], a[196:199], v[224:227], a[68:71]
    ds_read_b64_tr_b16 a[212:213], v11 offset:49152
    v_mul_f32 v120, v120, v100
    v_mul_f32 v121, v121, v100
    v_mul_f32 v122, v122, v100
    v_mul_f32 v123, v123, v100
    v_mul_f32 v124, v124, v100
    v_mul_f32 v125, v125, v100
    v_mul_f32 v126, v126, v100
    v_mfma_f32_16x16x32_bf16 a[68:71], a[192:195], v[220:223], a[68:71]
    ds_read_b64_tr_b16 a[214:215], v11 offset:53248
    v_mul_f32 v127, v127, v100
    v_cvt_pk_bf16_f32 v152, v120, v121
    v_cvt_pk_bf16_f32 v153, v122, v123
    v_cvt_pk_bf16_f32 v154, v124, v125
    v_cvt_pk_bf16_f32 v155, v126, v127
    v_mfma_f32_16x16x32_bf16 a[72:75], a[192:195], v[228:231], a[72:75]
    buffer_store_dwordx4 v[152:155], v110, s[24:27], s36 offen offset:0 sc1
    v_mfma_f32_16x16x32_bf16 a[72:75], a[196:199], v[232:235], a[72:75]
    s_mov_b32 s45, 61440
    buffer_load_dwordx4 a[0:3], v114, s[20:23], s45 offen offset:1024 sc1
    v_mfma_f32_16x16x32_bf16 a[76:79], a[196:199], v[240:243], a[76:79]
    s_mov_b32 s45, 61440
    buffer_load_dwordx4 a[4:7], v114, s[20:23], s45 offen offset:2048 sc1
    v_accvgpr_read_b32 v128, a36
    v_accvgpr_read_b32 v129, a37
    v_accvgpr_read_b32 v130, a38
    v_accvgpr_read_b32 v131, a39
    v_accvgpr_read_b32 v132, a52
    v_accvgpr_read_b32 v133, a53
    v_accvgpr_read_b32 v134, a54
    v_accvgpr_read_b32 v135, a55
    v_maximum3_f32 v108, v108, |v128|, |v129|
    v_maximum3_f32 v109, v109, |v130|, |v131|
    v_maximum3_f32 v108, v108, |v132|, |v133|
    v_maximum3_f32 v109, v109, |v134|, |v135|
    v_mul_f32 v128, v128, v101
    v_mul_f32 v129, v129, v101
    v_mul_f32 v130, v130, v101
    v_mul_f32 v131, v131, v101
    v_mul_f32 v132, v132, v101
    v_mul_f32 v133, v133, v101
    v_mul_f32 v134, v134, v101
    v_mul_f32 v135, v135, v101
    v_mfma_f32_16x16x32_bf16 a[76:79], a[192:195], v[236:239], a[76:79]
    s_waitcnt lgkmcnt(4)
    v_cvt_pk_bf16_f32 v156, v128, v129
    v_cvt_pk_bf16_f32 v157, v130, v131
    v_cvt_pk_bf16_f32 v158, v132, v133
    v_cvt_pk_bf16_f32 v159, v134, v135
    v_mfma_f32_16x16x32_bf16 a[80:83], a[200:203], v[212:215], a[80:83]
    ds_read_b64_tr_b16 a[216:217], v12 offset:24576
    buffer_store_dwordx4 v[156:159], v110, s[24:27], s36 offen offset:1024 sc1
    v_mfma_f32_16x16x32_bf16 a[80:83], a[204:207], v[216:219], a[80:83]
    s_mov_b32 s45, 61440
    ds_read_b64_tr_b16 a[218:219], v12 offset:28672
    buffer_load_dwordx4 a[8:11], v114, s[20:23], s45 offen offset:3072 sc1
    v_mfma_f32_16x16x32_bf16 a[84:87], a[204:207], v[224:227], a[84:87]
    s_mov_b32 s45, 61440
    ds_read_b64_tr_b16 a[220:221], v12 offset:49152
    buffer_load_dwordx4 a[12:15], v115, s[20:23], s45 offen offset:0 sc1
    v_accvgpr_read_b32 v136, a40
    v_accvgpr_read_b32 v137, a41
    v_accvgpr_read_b32 v138, a42
    v_accvgpr_read_b32 v139, a43
    v_accvgpr_read_b32 v140, a56
    v_accvgpr_read_b32 v141, a57
    v_accvgpr_read_b32 v142, a58
    v_accvgpr_read_b32 v143, a59
    v_maximum3_f32 v108, v108, |v136|, |v137|
    v_maximum3_f32 v109, v109, |v138|, |v139|
    v_maximum3_f32 v108, v108, |v140|, |v141|
    v_maximum3_f32 v109, v109, |v142|, |v143|
    v_mul_f32 v136, v136, v102
    v_mul_f32 v137, v137, v102
    v_mul_f32 v138, v138, v102
    v_mul_f32 v139, v139, v102
    v_mul_f32 v140, v140, v102
    v_mul_f32 v141, v141, v102
    v_mul_f32 v142, v142, v102
    v_mul_f32 v143, v143, v102
    v_mfma_f32_16x16x32_bf16 a[84:87], a[200:203], v[220:223], a[84:87]
    ds_read_b64_tr_b16 a[222:223], v12 offset:53248
    v_cvt_pk_bf16_f32 v160, v136, v137
    v_cvt_pk_bf16_f32 v161, v138, v139
    v_cvt_pk_bf16_f32 v162, v140, v141
    v_cvt_pk_bf16_f32 v163, v142, v143
    v_mfma_f32_16x16x32_bf16 a[88:91], a[200:203], v[228:231], a[88:91]
    buffer_store_dwordx4 v[160:163], v110, s[24:27], s36 offen offset:2048 sc1
    v_mfma_f32_16x16x32_bf16 a[88:91], a[204:207], v[232:235], a[88:91]
    s_mov_b32 s45, 81920
    buffer_load_dwordx4 a[16:19], v114, s[20:23], s45 offen offset:0 sc1
    v_mfma_f32_16x16x32_bf16 a[92:95], a[204:207], v[240:243], a[92:95]
    s_mov_b32 s45, 81920
    buffer_load_dwordx4 a[20:23], v114, s[20:23], s45 offen offset:1024 sc1
    v_accvgpr_read_b32 v144, a44
    v_accvgpr_read_b32 v145, a45
    v_accvgpr_read_b32 v146, a46
    v_accvgpr_read_b32 v147, a47
    v_accvgpr_read_b32 v148, a60
    v_accvgpr_read_b32 v149, a61
    v_accvgpr_read_b32 v150, a62
    v_accvgpr_read_b32 v151, a63
    v_maximum3_f32 v108, v108, |v144|, |v145|
    v_maximum3_f32 v109, v109, |v146|, |v147|
    v_maximum3_f32 v108, v108, |v148|, |v149|
    v_maximum3_f32 v109, v109, |v150|, |v151|
    v_mul_f32 v144, v144, v103
    v_mul_f32 v145, v145, v103
    v_mul_f32 v146, v146, v103
    v_mul_f32 v147, v147, v103
    v_mul_f32 v148, v148, v103
    v_mul_f32 v149, v149, v103
    v_mul_f32 v150, v150, v103
    v_mul_f32 v151, v151, v103
    v_mfma_f32_16x16x32_bf16 a[92:95], a[200:203], v[236:239], a[92:95]
    s_waitcnt lgkmcnt(4)
    v_cvt_pk_bf16_f32 v164, v144, v145
    v_cvt_pk_bf16_f32 v165, v146, v147
    v_cvt_pk_bf16_f32 v166, v148, v149
    v_cvt_pk_bf16_f32 v167, v150, v151
    buffer_store_dwordx4 v[164:167], v110, s[24:27], s36 offen offset:3072 sc1
    s_mov_b32 s45, 81920
    buffer_load_dwordx4 a[24:27], v114, s[20:23], s45 offen offset:2048 sc1
    s_mov_b32 s45, 81920
    buffer_load_dwordx4 a[28:31], v114, s[20:23], s45 offen offset:3072 sc1
    v_mfma_f32_16x16x32_bf16 a[96:99], a[208:211], v[212:215], a[96:99]
    s_mov_b32 s36, 8192
    v_accvgpr_read_b32 v120, a64
    v_accvgpr_read_b32 v121, a65
    v_accvgpr_read_b32 v122, a66
    v_accvgpr_read_b32 v123, a67
    v_accvgpr_read_b32 v124, a80
    v_mfma_f32_16x16x32_bf16 a[96:99], a[212:215], v[216:219], a[96:99]
    v_accvgpr_read_b32 v125, a81
    v_accvgpr_read_b32 v126, a82
    v_accvgpr_read_b32 v127, a83
    v_maximum3_f32 v108, v108, |v120|, |v121|
    v_maximum3_f32 v109, v109, |v122|, |v123|
    v_maximum3_f32 v108, v108, |v124|, |v125|
    v_maximum3_f32 v109, v109, |v126|, |v127|
    v_mfma_f32_16x16x32_bf16 a[100:103], a[212:215], v[224:227], a[100:103]
    v_mul_f32 v120, v120, v100
    v_mul_f32 v121, v121, v100
    v_mul_f32 v122, v122, v100
    v_mul_f32 v123, v123, v100
    v_mul_f32 v124, v124, v100
    v_mul_f32 v125, v125, v100
    v_mul_f32 v126, v126, v100
    v_mfma_f32_16x16x32_bf16 a[100:103], a[208:211], v[220:223], a[100:103]
    v_mul_f32 v127, v127, v100
    v_cvt_pk_bf16_f32 v152, v120, v121
    v_cvt_pk_bf16_f32 v153, v122, v123
    v_cvt_pk_bf16_f32 v154, v124, v125
    v_cvt_pk_bf16_f32 v155, v126, v127
    v_mfma_f32_16x16x32_bf16 a[104:107], a[208:211], v[228:231], a[104:107]
    buffer_store_dwordx4 v[152:155], v110, s[24:27], s36 offen offset:0 sc1
    v_mfma_f32_16x16x32_bf16 a[104:107], a[212:215], v[232:235], a[104:107]
    s_mov_b32 s45, 81920
    buffer_load_dwordx4 a[32:35], v115, s[20:23], s45 offen offset:0 sc1
    v_mfma_f32_16x16x32_bf16 a[108:111], a[212:215], v[240:243], a[108:111]
    s_mov_b32 s45, 102400
    buffer_load_dwordx4 a[36:39], v114, s[20:23], s45 offen offset:0 sc1
    v_accvgpr_read_b32 v128, a68
    v_accvgpr_read_b32 v129, a69
    v_accvgpr_read_b32 v130, a70
    v_accvgpr_read_b32 v131, a71
    v_accvgpr_read_b32 v132, a84
    v_accvgpr_read_b32 v133, a85
    v_accvgpr_read_b32 v134, a86
    v_accvgpr_read_b32 v135, a87
    v_maximum3_f32 v108, v108, |v128|, |v129|
    v_maximum3_f32 v109, v109, |v130|, |v131|
    v_maximum3_f32 v108, v108, |v132|, |v133|
    v_maximum3_f32 v109, v109, |v134|, |v135|
    v_mul_f32 v128, v128, v101
    v_mul_f32 v129, v129, v101
    v_mul_f32 v130, v130, v101
    v_mul_f32 v131, v131, v101
    v_mul_f32 v132, v132, v101
    v_mul_f32 v133, v133, v101
    v_mul_f32 v134, v134, v101
    v_mul_f32 v135, v135, v101
    v_mfma_f32_16x16x32_bf16 a[108:111], a[208:211], v[236:239], a[108:111]
    s_waitcnt lgkmcnt(0)
    v_cvt_pk_bf16_f32 v156, v128, v129
    v_cvt_pk_bf16_f32 v157, v130, v131
    v_cvt_pk_bf16_f32 v158, v132, v133
    v_cvt_pk_bf16_f32 v159, v134, v135
    v_mfma_f32_16x16x32_bf16 a[112:115], a[216:219], v[212:215], a[112:115]
    buffer_store_dwordx4 v[156:159], v110, s[24:27], s36 offen offset:1024 sc1
    v_mfma_f32_16x16x32_bf16 a[112:115], a[220:223], v[216:219], a[112:115]
    s_mov_b32 s45, 102400
    buffer_load_dwordx4 a[40:43], v114, s[20:23], s45 offen offset:1024 sc1
    v_mfma_f32_16x16x32_bf16 a[116:119], a[220:223], v[224:227], a[116:119]
    s_mov_b32 s45, 102400
    buffer_load_dwordx4 a[44:47], v114, s[20:23], s45 offen offset:2048 sc1
    v_accvgpr_read_b32 v136, a72
    v_accvgpr_read_b32 v137, a73
    v_accvgpr_read_b32 v138, a74
    v_accvgpr_read_b32 v139, a75
    v_accvgpr_read_b32 v140, a88
    v_accvgpr_read_b32 v141, a89
    v_accvgpr_read_b32 v142, a90
    v_accvgpr_read_b32 v143, a91
    v_maximum3_f32 v108, v108, |v136|, |v137|
    v_maximum3_f32 v109, v109, |v138|, |v139|
    v_maximum3_f32 v108, v108, |v140|, |v141|
    v_maximum3_f32 v109, v109, |v142|, |v143|
    v_mul_f32 v136, v136, v102
    v_mul_f32 v137, v137, v102
    v_mul_f32 v138, v138, v102
    v_mul_f32 v139, v139, v102
    v_mul_f32 v140, v140, v102
    v_mul_f32 v141, v141, v102
    v_mul_f32 v142, v142, v102
    v_mul_f32 v143, v143, v102
    v_mfma_f32_16x16x32_bf16 a[116:119], a[216:219], v[220:223], a[116:119]
    v_cvt_pk_bf16_f32 v160, v136, v137
    v_cvt_pk_bf16_f32 v161, v138, v139
    v_cvt_pk_bf16_f32 v162, v140, v141
    v_cvt_pk_bf16_f32 v163, v142, v143
    v_mfma_f32_16x16x32_bf16 a[120:123], a[216:219], v[228:231], a[120:123]
    buffer_store_dwordx4 v[160:163], v110, s[24:27], s36 offen offset:2048 sc1
    v_mfma_f32_16x16x32_bf16 a[120:123], a[220:223], v[232:235], a[120:123]
    s_mov_b32 s45, 102400
    buffer_load_dwordx4 a[48:51], v114, s[20:23], s45 offen offset:3072 sc1
    v_mfma_f32_16x16x32_bf16 a[124:127], a[220:223], v[240:243], a[124:127]
    s_mov_b32 s45, 102400
    buffer_load_dwordx4 a[52:55], v115, s[20:23], s45 offen offset:0 sc1
    v_accvgpr_read_b32 v144, a76
    v_accvgpr_read_b32 v145, a77
    v_accvgpr_read_b32 v146, a78
    v_accvgpr_read_b32 v147, a79
    v_accvgpr_read_b32 v148, a92
    v_accvgpr_read_b32 v149, a93
    v_accvgpr_read_b32 v150, a94
    v_accvgpr_read_b32 v151, a95
    v_maximum3_f32 v108, v108, |v144|, |v145|
    v_maximum3_f32 v109, v109, |v146|, |v147|
    v_maximum3_f32 v108, v108, |v148|, |v149|
    v_maximum3_f32 v109, v109, |v150|, |v151|
    v_mul_f32 v144, v144, v103
    v_mul_f32 v145, v145, v103
    v_mul_f32 v146, v146, v103
    v_mul_f32 v147, v147, v103
    v_mul_f32 v148, v148, v103
    v_mul_f32 v149, v149, v103
    v_mul_f32 v150, v150, v103
    v_mul_f32 v151, v151, v103
    v_mfma_f32_16x16x32_bf16 a[124:127], a[216:219], v[236:239], a[124:127]
    v_cvt_pk_bf16_f32 v164, v144, v145
    v_cvt_pk_bf16_f32 v165, v146, v147
    v_cvt_pk_bf16_f32 v166, v148, v149
    v_cvt_pk_bf16_f32 v167, v150, v151
    buffer_store_dwordx4 v[164:167], v110, s[24:27], s36 offen offset:3072 sc1
    s_mov_b32 s45, 122880
    buffer_load_dwordx4 a[56:59], v114, s[20:23], s45 offen offset:0 sc1
    s_mov_b32 s45, 122880
    buffer_load_dwordx4 a[60:63], v114, s[20:23], s45 offen offset:1024 sc1
    s_mov_b32 s36, 12288
    v_accvgpr_read_b32 v120, a96
    v_accvgpr_read_b32 v121, a97
    v_accvgpr_read_b32 v122, a98
    v_accvgpr_read_b32 v123, a99
    v_accvgpr_read_b32 v124, a112
    v_accvgpr_read_b32 v125, a113
    v_accvgpr_read_b32 v126, a114
    v_accvgpr_read_b32 v127, a115
    v_maximum3_f32 v108, v108, |v120|, |v121|
    v_maximum3_f32 v109, v109, |v122|, |v123|
    v_maximum3_f32 v108, v108, |v124|, |v125|
    v_maximum3_f32 v109, v109, |v126|, |v127|
    v_mul_f32 v120, v120, v100
    v_mul_f32 v121, v121, v100
    v_mul_f32 v122, v122, v100
    v_mul_f32 v123, v123, v100
    v_mul_f32 v124, v124, v100
    v_mul_f32 v125, v125, v100
    v_mul_f32 v126, v126, v100
    v_mul_f32 v127, v127, v100
    v_cvt_pk_bf16_f32 v152, v120, v121
    v_cvt_pk_bf16_f32 v153, v122, v123
    v_cvt_pk_bf16_f32 v154, v124, v125
    v_cvt_pk_bf16_f32 v155, v126, v127
    buffer_store_dwordx4 v[152:155], v110, s[24:27], s36 offen offset:0 sc1
    s_mov_b32 s45, 122880
    buffer_load_dwordx4 a[64:67], v114, s[20:23], s45 offen offset:2048 sc1
    s_mov_b32 s45, 122880
    buffer_load_dwordx4 a[68:71], v114, s[20:23], s45 offen offset:3072 sc1
    v_accvgpr_read_b32 v128, a100
    v_accvgpr_read_b32 v129, a101
    v_accvgpr_read_b32 v130, a102
    v_accvgpr_read_b32 v131, a103
    v_accvgpr_read_b32 v132, a116
    v_accvgpr_read_b32 v133, a117
    v_accvgpr_read_b32 v134, a118
    v_accvgpr_read_b32 v135, a119
    v_maximum3_f32 v108, v108, |v128|, |v129|
    v_maximum3_f32 v109, v109, |v130|, |v131|
    v_maximum3_f32 v108, v108, |v132|, |v133|
    v_maximum3_f32 v109, v109, |v134|, |v135|
    v_mul_f32 v128, v128, v101
    v_mul_f32 v129, v129, v101
    v_mul_f32 v130, v130, v101
    v_mul_f32 v131, v131, v101
    v_mul_f32 v132, v132, v101
    v_mul_f32 v133, v133, v101
    v_mul_f32 v134, v134, v101
    v_mul_f32 v135, v135, v101
    v_cvt_pk_bf16_f32 v156, v128, v129
    v_cvt_pk_bf16_f32 v157, v130, v131
    v_cvt_pk_bf16_f32 v158, v132, v133
    v_cvt_pk_bf16_f32 v159, v134, v135
    buffer_store_dwordx4 v[156:159], v110, s[24:27], s36 offen offset:1024 sc1
    s_mov_b32 s45, 122880
    buffer_load_dwordx4 a[72:75], v115, s[20:23], s45 offen offset:0 sc1
    s_mov_b32 s45, 143360
    buffer_load_dwordx4 a[76:79], v114, s[20:23], s45 offen offset:0 sc1
    v_accvgpr_read_b32 v136, a104
    v_accvgpr_read_b32 v137, a105
    v_accvgpr_read_b32 v138, a106
    v_accvgpr_read_b32 v139, a107
    v_accvgpr_read_b32 v140, a120
    v_accvgpr_read_b32 v141, a121
    v_accvgpr_read_b32 v142, a122
    v_accvgpr_read_b32 v143, a123
    v_maximum3_f32 v108, v108, |v136|, |v137|
    v_maximum3_f32 v109, v109, |v138|, |v139|
    v_maximum3_f32 v108, v108, |v140|, |v141|
    v_maximum3_f32 v109, v109, |v142|, |v143|
    v_mul_f32 v136, v136, v102
    v_mul_f32 v137, v137, v102
    v_mul_f32 v138, v138, v102
    v_mul_f32 v139, v139, v102
    v_mul_f32 v140, v140, v102
    v_mul_f32 v141, v141, v102
    v_mul_f32 v142, v142, v102
    v_mul_f32 v143, v143, v102
    v_cvt_pk_bf16_f32 v160, v136, v137
    v_cvt_pk_bf16_f32 v161, v138, v139
    v_cvt_pk_bf16_f32 v162, v140, v141
    v_cvt_pk_bf16_f32 v163, v142, v143
    buffer_store_dwordx4 v[160:163], v110, s[24:27], s36 offen offset:2048 sc1
    s_mov_b32 s45, 143360
    buffer_load_dwordx4 a[80:83], v114, s[20:23], s45 offen offset:1024 sc1
    s_mov_b32 s45, 143360
    buffer_load_dwordx4 a[84:87], v114, s[20:23], s45 offen offset:2048 sc1
    v_accvgpr_read_b32 v144, a108
    v_accvgpr_read_b32 v145, a109
    v_accvgpr_read_b32 v146, a110
    v_accvgpr_read_b32 v147, a111
    v_accvgpr_read_b32 v148, a124
    v_accvgpr_read_b32 v149, a125
    v_accvgpr_read_b32 v150, a126
    v_accvgpr_read_b32 v151, a127
    v_maximum3_f32 v108, v108, |v144|, |v145|
    v_maximum3_f32 v109, v109, |v146|, |v147|
    v_maximum3_f32 v108, v108, |v148|, |v149|
    v_maximum3_f32 v109, v109, |v150|, |v151|
    v_mul_f32 v144, v144, v103
    v_mul_f32 v145, v145, v103
    v_mul_f32 v146, v146, v103
    v_mul_f32 v147, v147, v103
    v_mul_f32 v148, v148, v103
    v_mul_f32 v149, v149, v103
    v_mul_f32 v150, v150, v103
    v_mul_f32 v151, v151, v103
    v_cvt_pk_bf16_f32 v164, v144, v145
    v_cvt_pk_bf16_f32 v165, v146, v147
    v_cvt_pk_bf16_f32 v166, v148, v149
    v_cvt_pk_bf16_f32 v167, v150, v151
    buffer_store_dwordx4 v[164:167], v110, s[24:27], s36 offen offset:3072 sc1
    s_mov_b32 s45, 143360
    buffer_load_dwordx4 a[88:91], v114, s[20:23], s45 offen offset:3072 sc1
    s_mov_b32 s45, 143360
    buffer_load_dwordx4 a[92:95], v115, s[20:23], s45 offen offset:0 sc1
    v_maximum3_f32 v108, v108, v109, v109
    v_cmp_ngt_f32 vcc, 0x7f800000, v108
    s_and_b64 vcc, vcc, exec
    s_cbranch_scc1 L_slow
L_published:
    v_mov_b32 v16, v114
    v_mov_b32 v17, v115
    v_mov_b32 v3, v249
    v_mov_b32 v2, 1
    s_waitcnt vmcnt(40)
    v_lshlrev_b32 v166, 16, v22
    v_and_b32 v167, 0xffff0000, v22
    v_lshlrev_b32 v168, 16, v23
    v_and_b32 v169, 0xffff0000, v23
    v_lshlrev_b32 v170, 16, v24
    v_and_b32 v171, 0xffff0000, v24
    v_lshlrev_b32 v172, 16, v25
    v_and_b32 v173, 0xffff0000, v25
    v_lshlrev_b32 v174, 16, v26
    v_and_b32 v175, 0xffff0000, v26
    v_lshlrev_b32 v176, 16, v27
    v_and_b32 v177, 0xffff0000, v27
    v_lshlrev_b32 v178, 16, v28
    v_and_b32 v179, 0xffff0000, v28
    v_lshlrev_b32 v180, 16, v29
    v_and_b32 v181, 0xffff0000, v29
    v_lshlrev_b32 v182, 16, v30
    v_and_b32 v183, 0xffff0000, v30
    v_lshlrev_b32 v184, 16, v31
    v_and_b32 v185, 0xffff0000, v31
    v_pk_add_f32 v[166:167], v[166:167], v[32:33] op_sel_hi:[1,0] neg_lo:[0,1] neg_hi:[0,1]
    v_pk_add_f32 v[168:169], v[168:169], v[32:33] op_sel_hi:[1,0] neg_lo:[0,1] neg_hi:[0,1]
    v_pk_add_f32 v[170:171], v[170:171], v[32:33] op_sel_hi:[1,0] neg_lo:[0,1] neg_hi:[0,1]
    v_pk_add_f32 v[172:173], v[172:173], v[32:33] op_sel_hi:[1,0] neg_lo:[0,1] neg_hi:[0,1]
    v_pk_add_f32 v[174:175], v[174:175], v[32:33] op_sel_hi:[1,0] neg_lo:[0,1] neg_hi:[0,1]
    v_pk_add_f32 v[176:177], v[176:177], v[32:33] op_sel_hi:[1,0] neg_lo:[0,1] neg_hi:[0,1]
    v_pk_add_f32 v[178:179], v[178:179], v[32:33] op_sel_hi:[1,0] neg_lo:[0,1] neg_hi:[0,1]
    v_pk_add_f32 v[180:181], v[180:181], v[32:33] op_sel_hi:[1,0] neg_lo:[0,1] neg_hi:[0,1]
    v_pk_add_f32 v[182:183], v[182:183], v[32:33] op_sel_hi:[1,0] neg_lo:[0,1] neg_hi:[0,1]
    v_pk_add_f32 v[184:185], v[184:185], v[32:33] op_sel_hi:[1,0] neg_lo:[0,1] neg_hi:[0,1]
    v_cvt_pk_bf16_f32 v36, v166, v167
    v_cvt_pk_bf16_f32 v37, v168, v169
    v_cvt_pk_bf16_f32 v38, v170, v171
    v_cvt_pk_bf16_f32 v39, v172, v173
    v_cvt_pk_bf16_f32 v40, v174, v175
    v_cvt_pk_bf16_f32 v41, v176, v177
    v_cvt_pk_bf16_f32 v42, v178, v179
    v_cvt_pk_bf16_f32 v43, v180, v181
    v_cvt_pk_bf16_f32 v44, v182, v183
    v_cvt_pk_bf16_f32 v45, v184, v185
    v_lshlrev_b32 v166, 16, v36
    v_and_b32 v167, 0xffff0000, v36
    v_lshlrev_b32 v168, 16, v37
    v_and_b32 v169, 0xffff0000, v37
    v_lshlrev_b32 v170, 16, v38
    v_and_b32 v171, 0xffff0000, v38
    v_lshlrev_b32 v172, 16, v39
    v_and_b32 v173, 0xffff0000, v39
    v_lshlrev_b32 v174, 16, v40
    v_and_b32 v175, 0xffff0000, v40
    v_lshlrev_b32 v176, 16, v41
    v_and_b32 v177, 0xffff0000, v41
    v_lshlrev_b32 v178, 16, v42
    v_and_b32 v179, 0xffff0000, v42
    v_lshlrev_b32 v180, 16, v43
    v_and_b32 v181, 0xffff0000, v43
    v_lshlrev_b32 v182, 16, v44
    v_and_b32 v183, 0xffff0000, v44
    v_lshlrev_b32 v184, 16, v45
    v_and_b32 v185, 0xffff0000, v45
    v_pk_mul_f32 v[166:167], v[166:167], v[32:33] op_sel:[0,1] op_sel_hi:[1,1]
    v_pk_mul_f32 v[168:169], v[168:169], v[32:33] op_sel:[0,1] op_sel_hi:[1,1]
    v_pk_mul_f32 v[170:171], v[170:171], v[32:33] op_sel:[0,1] op_sel_hi:[1,1]
    v_pk_mul_f32 v[172:173], v[172:173], v[32:33] op_sel:[0,1] op_sel_hi:[1,1]
    v_pk_mul_f32 v[174:175], v[174:175], v[32:33] op_sel:[0,1] op_sel_hi:[1,1]
    v_pk_mul_f32 v[176:177], v[176:177], v[32:33] op_sel:[0,1] op_sel_hi:[1,1]
    v_pk_mul_f32 v[178:179], v[178:179], v[32:33] op_sel:[0,1] op_sel_hi:[1,1]
    v_pk_mul_f32 v[180:181], v[180:181], v[32:33] op_sel:[0,1] op_sel_hi:[1,1]
    v_pk_mul_f32 v[182:183], v[182:183], v[32:33] op_sel:[0,1] op_sel_hi:[1,1]
    v_pk_mul_f32 v[184:185], v[184:185], v[32:33] op_sel:[0,1] op_sel_hi:[1,1]
    v_cvt_pk_bf16_f32 v36, v166, v167
    v_cvt_pk_bf16_f32 v37, v168, v169
    v_cvt_pk_bf16_f32 v38, v170, v171
    v_cvt_pk_bf16_f32 v39, v172, v173
    v_cvt_pk_bf16_f32 v40, v174, v175
    v_cvt_pk_bf16_f32 v41, v176, v177
    v_cvt_pk_bf16_f32 v42, v178, v179
    v_cvt_pk_bf16_f32 v43, v180, v181
    v_cvt_pk_bf16_f32 v44, v182, v183
    v_cvt_pk_bf16_f32 v45, v184, v185
    s_lshr_b32 s40, s87, 1
    s_lshl_b32 s40, s40, 2
    s_add_u32 s40, s40, s47
    s_lshl_b32 s40, s40, 18
    s_add_u32 s40, s40, 0x400000
    s_add_u32 s8, s72, s40
    s_addc_u32 s9, s73, 0
    s_mov_b32 s10, 0xc0000
    s_mov_b32 s11, 0x20000
    s_mov_b32 s12, s68
    s_mov_b32 s13, s69
    s_mov_b32 s14, 0x280000
    s_mov_b32 s15, 0x20000
    s_xor_b32 s40, s47, 1
    s_lshl_b32 s30, s40, 19
    s_lshl_b32 s31, s47, 19
    s_add_u32 s40, s5, 0
    s_and_b32 s40, s40, 3
    s_lshl_b32 s41, s5, 2
    s_add_u32 s41, s41, s40
    s_lshl_b32 s41, s41, 10
    v_lshl_add_u32 v4, v19, 4, s41
    s_add_u32 s40, s5, 1
    s_and_b32 s40, s40, 3
    s_lshl_b32 s41, s5, 2
    s_add_u32 s41, s41, s40
    s_lshl_b32 s41, s41, 10
    v_lshl_add_u32 v5, v19, 4, s41
    s_add_u32 s40, s5, 2
    s_and_b32 s40, s40, 3
    s_lshl_b32 s41, s5, 2
    s_add_u32 s41, s41, s40
    s_lshl_b32 s41, s41, 10
    v_lshl_add_u32 v6, v19, 4, s41
    s_add_u32 s40, s5, 3
    s_and_b32 s40, s40, 3
    s_lshl_b32 s41, s5, 2
    s_add_u32 s41, s41, s40
    s_lshl_b32 s41, s41, 10
    v_lshl_add_u32 v7, v19, 4, s41
    s_add_u32 s40, s46, 122880
    v_lshl_add_u32 v8, v19, 4, s40
    s_add_u32 s40, s46, 81920
    v_lshl_add_u32 v9, v19, 4, s40
    s_lshl_b32 s40, s46, 1
    v_lshl_add_u32 v10, v19, 4, s40
    s_waitcnt vmcnt(2)
    s_mov_b64 exec, 1
    buffer_store_dword v2, off, s[76:79], s58 sc1
    s_mov_b64 exec, -1
    v_min3_u32 v252, v252, v253, v254
    v_min_u32 v252, v252, v255
    v_cmp_gt_u32 vcc, 2, v252
    s_and_b64 vcc, vcc, exec
    s_cbranch_scc1 L_spin_ffn
L_back_ffn:
    s_and_b32 s40, s87, 30
    s_lshl_b32 s40, s40, 1
    s_add_u32 s40, s40, s47
    s_lshl_b32 s40, s40, 9
    s_mov_b32 s45, 163840
    buffer_load_dwordx4 v[46:49], v16, s[20:23], s45 offen offset:0 sc1
    s_add_u32 s40, s40, 0x292000
    v_bfe_u32 v1, v19, 2, 1
    v_lshlrev_b32 v1, 3, v1
    v_and_or_b32 v1, v19, 3, v1
    buffer_load_dwordx4 v[50:53], v16, s[20:23], s45 offen offset:1024 sc1
    v_lshl_add_u32 v1, v1, 7, s40
    v_mov_b32 v2, 3
    v_mov_b32 v11, 0x2500000
    s_not_b32 s40, s50
    buffer_load_dwordx4 v[54:57], v16, s[20:23], s45 offen offset:2048 sc1
    s_and_b32 s40, s40, 0x7ff
    v_cmp_eq_u32 vcc, s40, v35
    v_mov_b32 v12, 0x29c000
    s_nop 0
    buffer_load_dwordx4 v[58:61], v16, s[20:23], s45 offen offset:3072 sc1
    v_cndmask_b32 v11, v11, v12, vcc
    s_not_b32 s40, s51
    s_and_b32 s40, s40, 0x7ff
    v_cmp_eq_u32 vcc, s40, v35
    buffer_load_dwordx4 v[62:65], v17, s[20:23], s45 offen offset:0 sc1
    v_mov_b32 v12, 0x29c500
    s_nop 0
    v_cndmask_b32 v11, v11, v12, vcc
    s_not_b32 s40, s52
    s_mov_b32 s45, 184320
    buffer_load_dwordx4 v[66:69], v16, s[20:23], s45 offen offset:0 sc1
    s_and_b32 s40, s40, 0x7ff
    v_cmp_eq_u32 vcc, s40, v35
    v_mov_b32 v12, 0x29ca00
    s_nop 0
    buffer_load_dwordx4 v[70:73], v16, s[20:23], s45 offen offset:1024 sc1
    v_cndmask_b32 v11, v11, v12, vcc
    s_not_b32 s40, s53
    s_and_b32 s40, s40, 0x7ff
    v_cmp_eq_u32 vcc, s40, v35
    buffer_load_dwordx4 v[74:77], v16, s[20:23], s45 offen offset:2048 sc1
    v_mov_b32 v12, 0x29cf00
    s_nop 0
    v_cndmask_b32 v11, v11, v12, vcc
    s_not_b32 s40, s54
    buffer_load_dwordx4 v[78:81], v16, s[20:23], s45 offen offset:3072 sc1
    s_and_b32 s40, s40, 0x7ff
    v_cmp_eq_u32 vcc, s40, v35
    v_mov_b32 v12, 0x29d400
    s_nop 0
    buffer_load_dwordx4 v[82:85], v17, s[20:23], s45 offen offset:0 sc1
    v_cndmask_b32 v11, v11, v12, vcc
    s_not_b32 s40, s55
    s_and_b32 s40, s40, 0x7ff
    v_cmp_eq_u32 vcc, s40, v35
    s_mov_b32 s45, 204800
    buffer_load_dwordx4 v[86:89], v16, s[20:23], s45 offen offset:0 sc1
    v_mov_b32 v12, 0x29d900
    s_nop 0
    v_cndmask_b32 v11, v11, v12, vcc
    s_not_b32 s40, s56
    buffer_load_dwordx4 v[90:93], v16, s[20:23], s45 offen offset:1024 sc1
    s_and_b32 s40, s40, 0x7ff
    v_cmp_eq_u32 vcc, s40, v35
    v_mov_b32 v12, 0x29de00
    s_nop 0
    buffer_load_dwordx4 v[94:97], v16, s[20:23], s45 offen offset:2048 sc1
    v_cndmask_b32 v11, v11, v12, vcc
    s_not_b32 s40, s57
    s_and_b32 s40, s40, 0x7ff
    v_cmp_eq_u32 vcc, s40, v35
    buffer_load_dwordx4 v[98:101], v16, s[20:23], s45 offen offset:3072 sc1
    v_mov_b32 v12, 0x29e300
    s_nop 0
    v_cndmask_b32 v11, v11, v12, vcc
    v_mul_u32_u24 v12, 1280, v35
    buffer_load_dwordx4 v[102:105], v17, s[20:23], s45 offen offset:0 sc1
    v_sub_u32 v12, v34, v12
    v_add_u32 v11, v11, v12
    buffer_load_dwordx4 v[252:255], v1, s[76:79], 0 offen sc1
    s_mul_i32 s40, s6, 27648
    s_lshl_b32 s41, s5, 10
    s_add_u32 s40, s40, s41
    v_lshlrev_b32 v154, 4, v19
    buffer_load_dwordx4 v[126:129], v154, s[16:19], s40 offen sc1
    s_add_u32 s40, s40, 4096
    buffer_load_dwordx4 v[130:133], v154, s[16:19], s40 offen sc1
    s_add_u32 s40, s40, 4096
    buffer_load_dwordx4 v[134:137], v154, s[16:19], s40 offen sc1
    s_add_u32 s40, s40, 4096
    buffer_load_dwordx4 v[138:141], v154, s[16:19], s40 offen sc1
    s_add_u32 s40, s40, 4096
    buffer_load_dwordx4 v[142:145], v154, s[16:19], s40 offen sc1
    s_add_u32 s40, s40, 4096
    buffer_load_dwordx4 v[146:149], v154, s[16:19], s40 offen sc1
    s_add_u32 s40, s40, 4096
    s_cmp_eq_u32 s5, 3
    s_cselect_b32 s40, 0x438000, s40
    buffer_load_dwordx4 v[150:153], v154, s[16:19], s40 offen sc1
    s_mov_b32 s45, 225280
    buffer_load_dwordx4 v[106:109], v16, s[20:23], s45 offen offset:0 sc1
    buffer_load_dwordx4 v[110:113], v16, s[20:23], s45 offen offset:1024 sc1
    buffer_load_dwordx4 v[114:117], v16, s[20:23], s45 offen offset:2048 sc1
    buffer_load_dwordx4 v[118:121], v16, s[20:23], s45 offen offset:3072 sc1
    buffer_load_dwordx4 v[122:125], v17, s[20:23], s45 offen offset:0 sc1
    s_cmp_lg_u32 s5, 0
    s_cbranch_scc1 L_back_o
    s_waitcnt vmcnt(12)
    v_min3_u32 v252, v252, v253, v254
    v_min_u32 v252, v252, v255
    v_cmp_gt_u32 vcc, 1, v252
    s_and_b64 vcc, vcc, exec
    s_cbranch_scc1 L_spin_o
L_back_o:
    s_barrier
    s_add_u32 s44, s30, 0
    buffer_load_dwordx4 a[96:99], v4, s[8:11], s44 offen sc1
    buffer_load_dwordx4 a[100:103], v5, s[8:11], s44 offen sc1
    buffer_load_dwordx4 a[104:107], v6, s[8:11], s44 offen sc1
    buffer_load_dwordx4 a[108:111], v7, s[8:11], s44 offen sc1
    s_add_u32 s44, s30, 16384
    buffer_load_dwordx4 a[112:115], v4, s[8:11], s44 offen sc1
    buffer_load_dwordx4 a[116:119], v5, s[8:11], s44 offen sc1
    buffer_load_dwordx4 a[120:123], v6, s[8:11], s44 offen sc1
    buffer_load_dwordx4 a[124:127], v7, s[8:11], s44 offen sc1
    s_add_u32 s44, s30, 32768
    buffer_load_dwordx4 a[192:195], v4, s[8:11], s44 offen sc1
    buffer_load_dwordx4 a[196:199], v5, s[8:11], s44 offen sc1
    buffer_load_dwordx4 a[200:203], v6, s[8:11], s44 offen sc1
    buffer_load_dwordx4 a[204:207], v7, s[8:11], s44 offen sc1
    s_add_u32 s44, s30, 49152
    buffer_load_dwordx4 a[208:211], v4, s[8:11], s44 offen sc1
    buffer_load_dwordx4 a[212:215], v5, s[8:11], s44 offen sc1
    buffer_load_dwordx4 a[216:219], v6, s[8:11], s44 offen sc1
    buffer_load_dwordx4 a[220:223], v7, s[8:11], s44 offen sc1
    s_waitcnt vmcnt(8)
    v_mfma_f32_16x16x32_bf16 v[166:169], a[128:131], a[96:99], 0
    v_add_f32 v126, v126, v130
    v_mfma_f32_16x16x32_bf16 v[166:169], a[148:151], a[112:115], v[166:169]
    s_add_u32 s44, s30, 65536
    buffer_load_dwordx4 a[224:227], v4, s[8:11], s44 offen sc1
    v_add_f32 v127, v127, v131
    v_add_f32 v128, v128, v132
    v_mfma_f32_16x16x32_bf16 v[186:189], a[148:151], a[116:119], 0
    v_add_f32 v129, v129, v133
    v_mfma_f32_16x16x32_bf16 v[186:189], a[128:131], a[100:103], v[186:189]
    v_add_f32 v126, v126, v134
    v_add_f32 v127, v127, v135
    v_mfma_f32_16x16x32_bf16 v[206:209], a[128:131], a[104:107], 0
    buffer_load_dwordx4 a[228:231], v5, s[8:11], s44 offen sc1
    v_add_f32 v128, v128, v136
    v_add_f32 v129, v129, v137
    v_mfma_f32_16x16x32_bf16 v[206:209], a[148:151], a[120:123], v[206:209]
    v_add_f32 v126, v126, v138
    v_mfma_f32_16x16x32_bf16 v[226:229], a[148:151], a[124:127], 0
    v_add_f32 v127, v127, v139
    v_add_f32 v128, v128, v140
    v_mfma_f32_16x16x32_bf16 v[226:229], a[128:131], a[108:111], v[226:229]
    v_add_f32 v129, v129, v141
    v_mfma_f32_16x16x32_bf16 v[170:173], a[132:135], a[96:99], 0
    buffer_load_dwordx4 a[232:235], v6, s[8:11], s44 offen sc1
    v_add_f32 v126, v126, v142
    v_add_f32 v127, v127, v143
    v_mfma_f32_16x16x32_bf16 v[170:173], a[152:155], a[112:115], v[170:173]
    v_add_f32 v128, v128, v144
    v_add_f32 v129, v129, v145
    v_mfma_f32_16x16x32_bf16 v[190:193], a[152:155], a[116:119], 0
    v_add_f32 v126, v126, v146
    v_mfma_f32_16x16x32_bf16 v[190:193], a[132:135], a[100:103], v[190:193]
    v_add_f32 v127, v127, v147
    v_add_f32 v128, v128, v148
    v_mfma_f32_16x16x32_bf16 v[210:213], a[132:135], a[104:107], 0
    buffer_load_dwordx4 a[236:239], v7, s[8:11], s44 offen sc1
    v_add_f32 v129, v129, v149
    v_mfma_f32_16x16x32_bf16 v[210:213], a[152:155], a[120:123], v[210:213]
    v_add_f32 v126, v126, v150
    v_add_f32 v127, v127, v151
    v_mfma_f32_16x16x32_bf16 v[230:233], a[152:155], a[124:127], 0
    v_add_f32 v128, v128, v152
    v_add_f32 v129, v129, v153
    v_mfma_f32_16x16x32_bf16 v[230:233], a[132:135], a[108:111], v[230:233]
    v_add_f32_dpp v126, v126, v126 row_ror:8 row_mask:0xf bank_mask:0xf
    v_mfma_f32_16x16x32_bf16 v[174:177], a[136:139], a[96:99], 0
    s_add_u32 s44, s30, 81920
    buffer_load_dwordx4 a[240:243], v4, s[8:11], s44 offen sc1
    v_add_f32_dpp v127, v127, v127 row_ror:8 row_mask:0xf bank_mask:0xf
    v_add_f32_dpp v128, v128, v128 row_ror:8 row_mask:0xf bank_mask:0xf
    v_mfma_f32_16x16x32_bf16 v[174:177], a[156:159], a[112:115], v[174:177]
    v_add_f32_dpp v129, v129, v129 row_ror:8 row_mask:0xf bank_mask:0xf
    v_mov_b32 v130, v126
    v_mfma_f32_16x16x32_bf16 v[194:197], a[156:159], a[116:119], 0
    v_mov_b32 v131, v127
    v_mfma_f32_16x16x32_bf16 v[194:197], a[136:139], a[100:103], v[194:197]
    buffer_load_dwordx4 a[244:247], v5, s[8:11], s44 offen sc1
    v_mov_b32 v132, v128
    v_mov_b32 v133, v129
    v_mfma_f32_16x16x32_bf16 v[214:217], a[136:139], a[104:107], 0
    v_permlane16_swap_b32 v126, v130
    v_mfma_f32_16x16x32_bf16 v[214:217], a[156:159], a[120:123], v[214:217]
    v_permlane16_swap_b32 v127, v131
    v_permlane16_swap_b32 v128, v132
    v_mfma_f32_16x16x32_bf16 v[234:237], a[156:159], a[124:127], 0
    v_permlane16_swap_b32 v129, v133
    v_add_f32 v126, v126, v130
    v_mfma_f32_16x16x32_bf16 v[234:237], a[136:139], a[108:111], v[234:237]
    buffer_load_dwordx4 a[248:251], v6, s[8:11], s44 offen sc1
    v_add_f32 v127, v127, v131
    v_mfma_f32_16x16x32_bf16 v[178:181], a[140:143], a[96:99], 0
    v_add_f32 v128, v128, v132
    v_add_f32 v129, v129, v133
    v_mfma_f32_16x16x32_bf16 v[178:181], a[160:163], a[112:115], v[178:181]
    v_mov_b32 v130, v126
    v_mfma_f32_16x16x32_bf16 v[198:201], a[160:163], a[116:119], 0
    v_mov_b32 v131, v127
    v_mov_b32 v132, v128
    v_mfma_f32_16x16x32_bf16 v[198:201], a[140:143], a[100:103], v[198:201]
    buffer_load_dwordx4 a[252:255], v7, s[8:11], s44 offen sc1
    v_mov_b32 v133, v129
    v_permlane32_swap_b32 v126, v130
    v_mfma_f32_16x16x32_bf16 v[218:221], a[140:143], a[104:107], 0
    v_permlane32_swap_b32 v127, v131
    v_mfma_f32_16x16x32_bf16 v[218:221], a[160:163], a[120:123], v[218:221]
    v_permlane32_swap_b32 v128, v132
    v_permlane32_swap_b32 v129, v133
    v_mfma_f32_16x16x32_bf16 v[238:241], a[160:163], a[124:127], 0
    v_add_f32 v126, v126, v130
    v_mfma_f32_16x16x32_bf16 v[238:241], a[140:143], a[108:111], v[238:241]
    v_add_f32 v127, v127, v131
    v_add_f32 v128, v128, v132
    v_mfma_f32_16x16x32_bf16 v[182:185], a[144:147], a[96:99], 0
    v_add_f32 v129, v129, v133
    v_and_b32 v154, 7, v19
    v_mfma_f32_16x16x32_bf16 v[182:185], a[164:167], a[112:115], v[182:185]
    v_lshlrev_b32 v154, 4, v154
    v_mfma_f32_16x16x32_bf16 v[202:205], a[164:167], a[116:119], 0
    v_add_u32 v154, 0, v154
    s_lshl_b32 s40, s5, 7
    v_mfma_f32_16x16x32_bf16 v[202:205], a[144:147], a[100:103], v[202:205]
    v_add_u32 v155, s40, v154
    ds_write_b128 v155, v[126:129]
    v_mfma_f32_16x16x32_bf16 v[222:225], a[144:147], a[104:107], 0
    v_mfma_f32_16x16x32_bf16 v[222:225], a[164:167], a[120:123], v[222:225]
    v_mfma_f32_16x16x32_bf16 v[242:245], a[164:167], a[124:127], 0
    v_mfma_f32_16x16x32_bf16 v[242:245], a[144:147], a[108:111], v[242:245]
    s_waitcnt vmcnt(8)
    v_mfma_f32_16x16x32_bf16 v[166:169], a[168:171], a[192:195], v[166:169]
    s_waitcnt lgkmcnt(0)
    v_mfma_f32_16x16x32_bf16 v[166:169], a[188:191], a[208:211], v[166:169]
    s_add_u32 s44, s30, 196608
    buffer_load_dwordx4 a[96:99], v4, s[8:11], s44 offen sc1
    s_barrier
    v_mfma_f32_16x16x32_bf16 v[186:189], a[188:191], a[212:215], v[186:189]
    ds_read_b128 v[126:129], v154 offset:0
    ds_read_b128 v[130:133], v154 offset:128
    v_mfma_f32_16x16x32_bf16 v[186:189], a[168:171], a[196:199], v[186:189]
    ds_read_b128 v[134:137], v154 offset:256
    v_mfma_f32_16x16x32_bf16 v[206:209], a[168:171], a[200:203], v[206:209]
    buffer_load_dwordx4 a[100:103], v5, s[8:11], s44 offen sc1
    ds_read_b128 v[138:141], v154 offset:384
    s_mul_i32 s42, s6, 3277
    v_mfma_f32_16x16x32_bf16 v[206:209], a[188:191], a[216:219], v[206:209]
    s_lshr_b32 s42, s42, 16
    v_mfma_f32_16x16x32_bf16 v[226:229], a[188:191], a[220:223], v[226:229]
    s_min_u32 s42, s42, 7
    v_mfma_f32_16x16x32_bf16 v[226:229], a[168:171], a[204:207], v[226:229]
    v_readlane_b32 s40, v3, s42
    s_and_b32 s40, s40, 0xffff0000
    v_mfma_f32_16x16x32_bf16 v[170:173], a[172:175], a[192:195], v[170:173]
    buffer_load_dwordx4 a[104:107], v6, s[8:11], s44 offen sc1
    s_ashr_i32 s41, s40, 31
    v_mfma_f32_16x16x32_bf16 v[170:173], a[0:3], a[208:211], v[170:173]
    s_andn2_b32 s41, 0x7fff0000, s41
    s_or_b32 s41, s41, 0x80000000
    v_mfma_f32_16x16x32_bf16 v[190:193], a[0:3], a[212:215], v[190:193]
    s_xor_b32 s40, s40, s41
    v_mfma_f32_16x16x32_bf16 v[190:193], a[172:175], a[196:199], v[190:193]
    v_mov_b32 v142, 0xbfb8aa3b
    v_mfma_f32_16x16x32_bf16 v[210:213], a[172:175], a[200:203], v[210:213]
    buffer_load_dwordx4 a[108:111], v7, s[8:11], s44 offen sc1
    v_mul_f32 v142, s40, v142
    v_exp_f32 v142, v142
    v_mfma_f32_16x16x32_bf16 v[210:213], a[0:3], a[216:219], v[210:213]
    s_nop 0
    v_mfma_f32_16x16x32_bf16 v[230:233], a[0:3], a[220:223], v[230:233]
    v_add_f32 v142, 1.0, v142
    v_rcp_f32 v142, v142
    v_mfma_f32_16x16x32_bf16 v[230:233], a[172:175], a[204:207], v[230:233]
    s_nop 0
    v_mfma_f32_16x16x32_bf16 v[174:177], a[176:179], a[192:195], v[174:177]
    s_add_u32 s44, s30, 212992
    buffer_load_dwordx4 a[112:115], v4, s[8:11], s44 offen sc1
    v_cvt_pk_bf16_f32 v142, v142, v142
    v_mfma_f32_16x16x32_bf16 v[174:177], a[4:7], a[208:211], v[174:177]
    v_lshlrev_b32 v142, 16, v142
    s_lshl_b32 s40, s6, 6
    v_mfma_f32_16x16x32_bf16 v[194:197], a[4:7], a[212:215], v[194:197]
    s_add_u32 s40, s40, 0x29c000
    v_mfma_f32_16x16x32_bf16 v[194:197], a[176:179], a[196:199], v[194:197]
    buffer_load_dwordx4 a[116:119], v5, s[8:11], s44 offen sc1
    s_lshl_b32 s41, s5, 8
    s_add_u32 s41, s41, s6
    v_mfma_f32_16x16x32_bf16 v[214:217], a[176:179], a[200:203], v[214:217]
    s_cmp_lt_u32 s41, 160
    s_cselect_b32 s40, s40, 0x2500000
    v_mfma_f32_16x16x32_bf16 v[214:217], a[4:7], a[216:219], v[214:217]
    v_lshlrev_b32 v143, 3, v19
    v_mfma_f32_16x16x32_bf16 v[234:237], a[4:7], a[220:223], v[234:237]
    s_waitcnt lgkmcnt(0)
    v_add_f32 v126, v126, v130
    v_mfma_f32_16x16x32_bf16 v[234:237], a[176:179], a[204:207], v[234:237]
    buffer_load_dwordx4 a[120:123], v6, s[8:11], s44 offen sc1
    v_add_f32 v127, v127, v131
    v_mfma_f32_16x16x32_bf16 v[178:181], a[180:183], a[192:195], v[178:181]
    v_add_f32 v128, v128, v132
    v_add_f32 v129, v129, v133
    v_mfma_f32_16x16x32_bf16 v[178:181], a[8:11], a[208:211], v[178:181]
    v_add_f32 v126, v126, v134
    v_mfma_f32_16x16x32_bf16 v[198:201], a[8:11], a[212:215], v[198:201]
    v_add_f32 v127, v127, v135
    v_mfma_f32_16x16x32_bf16 v[198:201], a[180:183], a[196:199], v[198:201]
    buffer_load_dwordx4 a[124:127], v7, s[8:11], s44 offen sc1
    v_add_f32 v128, v128, v136
    v_add_f32 v129, v129, v137
    v_mfma_f32_16x16x32_bf16 v[218:221], a[180:183], a[200:203], v[218:221]
    v_add_f32 v126, v126, v138
    v_mfma_f32_16x16x32_bf16 v[218:221], a[8:11], a[216:219], v[218:221]
    v_add_f32 v127, v127, v139
    v_add_f32 v128, v128, v140
    v_mfma_f32_16x16x32_bf16 v[238:241], a[8:11], a[220:223], v[238:241]
    v_add_f32 v129, v129, v141
    v_mfma_f32_16x16x32_bf16 v[238:241], a[180:183], a[204:207], v[238:241]
    v_cvt_pk_bf16_f32 v130, v126, v127
    v_mfma_f32_16x16x32_bf16 v[182:185], a[184:187], a[192:195], v[182:185]
    v_cvt_pk_bf16_f32 v131, v128, v129
    v_lshlrev_b32 v126, 16, v130
    v_mfma_f32_16x16x32_bf16 v[182:185], a[12:15], a[208:211], v[182:185]
    v_and_b32 v127, 0xffff0000, v130
    v_mfma_f32_16x16x32_bf16 v[202:205], a[12:15], a[212:215], v[202:205]
    v_lshlrev_b32 v128, 16, v131
    v_and_b32 v129, 0xffff0000, v131
    v_mfma_f32_16x16x32_bf16 v[202:205], a[184:187], a[196:199], v[202:205]
    v_mul_f32 v126, v126, v142
    v_mfma_f32_16x16x32_bf16 v[222:225], a[184:187], a[200:203], v[222:225]
    v_mul_f32 v127, v127, v142
    v_mfma_f32_16x16x32_bf16 v[222:225], a[12:15], a[216:219], v[222:225]
    v_mul_f32 v128, v128, v142
    v_mul_f32 v129, v129, v142
    v_mfma_f32_16x16x32_bf16 v[242:245], a[12:15], a[220:223], v[242:245]
    v_cvt_pk_bf16_f32 v130, v126, v127
    v_mfma_f32_16x16x32_bf16 v[242:245], a[184:187], a[204:207], v[242:245]
    v_cvt_pk_bf16_f32 v131, v128, v129
    s_mov_b64 exec, 0xff
    buffer_store_dwordx2 v[130:131], v143, s[76:79], s40 offen sc1
    s_mov_b64 exec, -1
    s_waitcnt vmcnt(9)
    v_mfma_f32_16x16x32_bf16 v[166:169], a[16:19], a[224:227], v[166:169]
    v_mfma_f32_16x16x32_bf16 v[166:169], a[36:39], a[240:243], v[166:169]
    s_add_u32 s44, s30, 98304
    buffer_load_dwordx4 a[192:195], v4, s[8:11], s44 offen sc1
    v_mfma_f32_16x16x32_bf16 v[186:189], a[36:39], a[244:247], v[186:189]
    ds_read_b128 v[126:129], v8 offset:0
    v_mfma_f32_16x16x32_bf16 v[186:189], a[16:19], a[228:231], v[186:189]
    v_mfma_f32_16x16x32_bf16 v[206:209], a[16:19], a[232:235], v[206:209]
    buffer_load_dwordx4 a[196:199], v5, s[8:11], s44 offen sc1
    v_mfma_f32_16x16x32_bf16 v[206:209], a[36:39], a[248:251], v[206:209]
    ds_read_b128 v[130:133], v8 offset:1024
    v_mfma_f32_16x16x32_bf16 v[226:229], a[36:39], a[252:255], v[226:229]
    v_mfma_f32_16x16x32_bf16 v[226:229], a[16:19], a[236:239], v[226:229]
    ds_read_b128 v[134:137], v8 offset:2048
    v_mfma_f32_16x16x32_bf16 v[170:173], a[20:23], a[224:227], v[170:173]
    buffer_load_dwordx4 a[200:203], v6, s[8:11], s44 offen sc1
    v_mfma_f32_16x16x32_bf16 v[170:173], a[40:43], a[240:243], v[170:173]
    v_mfma_f32_16x16x32_bf16 v[190:193], a[40:43], a[244:247], v[190:193]
    ds_read_b128 v[138:141], v8 offset:3072
    v_mfma_f32_16x16x32_bf16 v[190:193], a[20:23], a[228:231], v[190:193]
    v_mfma_f32_16x16x32_bf16 v[210:213], a[20:23], a[232:235], v[210:213]
    buffer_load_dwordx4 a[204:207], v7, s[8:11], s44 offen sc1
    v_mfma_f32_16x16x32_bf16 v[210:213], a[40:43], a[248:251], v[210:213]
    ds_read_b128 v[142:145], v8 offset:4096
    v_mfma_f32_16x16x32_bf16 v[230:233], a[40:43], a[252:255], v[230:233]
    v_mfma_f32_16x16x32_bf16 v[230:233], a[20:23], a[236:239], v[230:233]
    ds_read_b128 v[146:149], v8 offset:5120
    v_mfma_f32_16x16x32_bf16 v[174:177], a[24:27], a[224:227], v[174:177]
    s_add_u32 s44, s30, 114688
    buffer_load_dwordx4 a[208:211], v4, s[8:11], s44 offen sc1
    v_mfma_f32_16x16x32_bf16 v[174:177], a[44:47], a[240:243], v[174:177]
    v_mfma_f32_16x16x32_bf16 v[194:197], a[44:47], a[244:247], v[194:197]
    ds_read_b128 v[150:153], v8 offset:6144
    v_mfma_f32_16x16x32_bf16 v[194:197], a[24:27], a[228:231], v[194:197]
    buffer_load_dwordx4 a[212:215], v5, s[8:11], s44 offen sc1
    v_mfma_f32_16x16x32_bf16 v[214:217], a[24:27], a[232:235], v[214:217]
    v_mfma_f32_16x16x32_bf16 v[214:217], a[44:47], a[248:251], v[214:217]
    ds_read_b128 v[154:157], v8 offset:7168
    v_mfma_f32_16x16x32_bf16 v[234:237], a[44:47], a[252:255], v[234:237]
    v_mfma_f32_16x16x32_bf16 v[234:237], a[24:27], a[236:239], v[234:237]
    buffer_load_dwordx4 a[216:219], v6, s[8:11], s44 offen sc1
    v_mfma_f32_16x16x32_bf16 v[178:181], a[28:31], a[224:227], v[178:181]
    ds_read_b128 v[158:161], v8 offset:8192
    v_mfma_f32_16x16x32_bf16 v[178:181], a[48:51], a[240:243], v[178:181]
    v_mfma_f32_16x16x32_bf16 v[198:201], a[48:51], a[244:247], v[198:201]
    ds_read_b128 v[162:165], v8 offset:9216
    v_mfma_f32_16x16x32_bf16 v[198:201], a[28:31], a[228:231], v[198:201]
    buffer_load_dwordx4 a[220:223], v7, s[8:11], s44 offen sc1
    v_mfma_f32_16x16x32_bf16 v[218:221], a[28:31], a[232:235], v[218:221]
    v_mfma_f32_16x16x32_bf16 v[218:221], a[48:51], a[248:251], v[218:221]
    v_mfma_f32_16x16x32_bf16 v[238:241], a[48:51], a[252:255], v[238:241]
    v_mfma_f32_16x16x32_bf16 v[238:241], a[28:31], a[236:239], v[238:241]
    v_mfma_f32_16x16x32_bf16 v[182:185], a[32:35], a[224:227], v[182:185]
    v_mfma_f32_16x16x32_bf16 v[182:185], a[52:55], a[240:243], v[182:185]
    v_mfma_f32_16x16x32_bf16 v[202:205], a[52:55], a[244:247], v[202:205]
    v_mfma_f32_16x16x32_bf16 v[202:205], a[32:35], a[228:231], v[202:205]
    v_mfma_f32_16x16x32_bf16 v[222:225], a[32:35], a[232:235], v[222:225]
    v_mfma_f32_16x16x32_bf16 v[222:225], a[52:55], a[248:251], v[222:225]
    v_mfma_f32_16x16x32_bf16 v[242:245], a[52:55], a[252:255], v[242:245]
    v_mfma_f32_16x16x32_bf16 v[242:245], a[32:35], a[236:239], v[242:245]
    s_waitcnt vmcnt(9) lgkmcnt(0)
    v_mfma_f32_16x16x32_bf16 v[166:169], v[126:129], a[96:99], v[166:169]
    v_mfma_f32_16x16x32_bf16 v[166:169], v[146:149], a[112:115], v[166:169]
    s_add_u32 s44, s30, 229376
    buffer_load_dwordx4 a[224:227], v4, s[8:11], s44 offen sc1
    v_mfma_f32_16x16x32_bf16 v[186:189], v[146:149], a[116:119], v[186:189]
    v_mfma_f32_16x16x32_bf16 v[186:189], v[126:129], a[100:103], v[186:189]
    v_mfma_f32_16x16x32_bf16 v[206:209], v[126:129], a[104:107], v[206:209]
    buffer_load_dwordx4 a[228:231], v5, s[8:11], s44 offen sc1
    v_mfma_f32_16x16x32_bf16 v[206:209], v[146:149], a[120:123], v[206:209]
    v_mfma_f32_16x16x32_bf16 v[226:229], v[146:149], a[124:127], v[226:229]
    v_mfma_f32_16x16x32_bf16 v[226:229], v[126:129], a[108:111], v[226:229]
    v_mfma_f32_16x16x32_bf16 v[170:173], v[130:133], a[96:99], v[170:173]
    buffer_load_dwordx4 a[232:235], v6, s[8:11], s44 offen sc1
    v_mfma_f32_16x16x32_bf16 v[170:173], v[150:153], a[112:115], v[170:173]
    v_mfma_f32_16x16x32_bf16 v[190:193], v[150:153], a[116:119], v[190:193]
    v_mfma_f32_16x16x32_bf16 v[190:193], v[130:133], a[100:103], v[190:193]
    v_mfma_f32_16x16x32_bf16 v[210:213], v[130:133], a[104:107], v[210:213]
    buffer_load_dwordx4 a[236:239], v7, s[8:11], s44 offen sc1
    v_mfma_f32_16x16x32_bf16 v[210:213], v[150:153], a[120:123], v[210:213]
    v_mfma_f32_16x16x32_bf16 v[230:233], v[150:153], a[124:127], v[230:233]
    v_mfma_f32_16x16x32_bf16 v[230:233], v[130:133], a[108:111], v[230:233]
    v_mfma_f32_16x16x32_bf16 v[174:177], v[134:137], a[96:99], v[174:177]
    s_add_u32 s44, s30, 245760
    buffer_load_dwordx4 a[240:243], v4, s[8:11], s44 offen sc1
    v_mfma_f32_16x16x32_bf16 v[174:177], v[154:157], a[112:115], v[174:177]
    v_mfma_f32_16x16x32_bf16 v[194:197], v[154:157], a[116:119], v[194:197]
    v_mfma_f32_16x16x32_bf16 v[194:197], v[134:137], a[100:103], v[194:197]
    buffer_load_dwordx4 a[244:247], v5, s[8:11], s44 offen sc1
    v_mfma_f32_16x16x32_bf16 v[214:217], v[134:137], a[104:107], v[214:217]
    v_mfma_f32_16x16x32_bf16 v[214:217], v[154:157], a[120:123], v[214:217]
    v_mfma_f32_16x16x32_bf16 v[234:237], v[154:157], a[124:127], v[234:237]
    v_mfma_f32_16x16x32_bf16 v[234:237], v[134:137], a[108:111], v[234:237]
    buffer_load_dwordx4 a[248:251], v6, s[8:11], s44 offen sc1
    v_mfma_f32_16x16x32_bf16 v[178:181], v[138:141], a[96:99], v[178:181]
    v_mfma_f32_16x16x32_bf16 v[178:181], v[158:161], a[112:115], v[178:181]
    v_mfma_f32_16x16x32_bf16 v[198:201], v[158:161], a[116:119], v[198:201]
    v_mfma_f32_16x16x32_bf16 v[198:201], v[138:141], a[100:103], v[198:201]
    buffer_load_dwordx4 a[252:255], v7, s[8:11], s44 offen sc1
    v_mfma_f32_16x16x32_bf16 v[218:221], v[138:141], a[104:107], v[218:221]
    v_mfma_f32_16x16x32_bf16 v[218:221], v[158:161], a[120:123], v[218:221]
    v_mfma_f32_16x16x32_bf16 v[238:241], v[158:161], a[124:127], v[238:241]
    v_mfma_f32_16x16x32_bf16 v[238:241], v[138:141], a[108:111], v[238:241]
    v_mfma_f32_16x16x32_bf16 v[182:185], v[142:145], a[96:99], v[182:185]
    v_mfma_f32_16x16x32_bf16 v[182:185], v[162:165], a[112:115], v[182:185]
    v_mfma_f32_16x16x32_bf16 v[202:205], v[162:165], a[116:119], v[202:205]
    v_mfma_f32_16x16x32_bf16 v[202:205], v[142:145], a[100:103], v[202:205]
    v_mfma_f32_16x16x32_bf16 v[222:225], v[142:145], a[104:107], v[222:225]
    v_mfma_f32_16x16x32_bf16 v[222:225], v[162:165], a[120:123], v[222:225]
    v_mfma_f32_16x16x32_bf16 v[242:245], v[162:165], a[124:127], v[242:245]
    v_mfma_f32_16x16x32_bf16 v[242:245], v[142:145], a[108:111], v[242:245]
    s_waitcnt vmcnt(8)
    v_mfma_f32_16x16x32_bf16 v[166:169], a[56:59], a[192:195], v[166:169]
    v_mfma_f32_16x16x32_bf16 v[166:169], a[76:79], a[208:211], v[166:169]
    s_add_u32 s44, s30, 131072
    buffer_load_dwordx4 a[96:99], v4, s[8:11], s44 offen sc1
    v_mfma_f32_16x16x32_bf16 v[186:189], a[76:79], a[212:215], v[186:189]
    ds_read_b128 v[126:129], v9 offset:0
    v_mfma_f32_16x16x32_bf16 v[186:189], a[56:59], a[196:199], v[186:189]
    v_mfma_f32_16x16x32_bf16 v[206:209], a[56:59], a[200:203], v[206:209]
    buffer_load_dwordx4 a[100:103], v5, s[8:11], s44 offen sc1
    v_mfma_f32_16x16x32_bf16 v[206:209], a[76:79], a[216:219], v[206:209]
    ds_read_b128 v[130:133], v9 offset:1024
    v_mfma_f32_16x16x32_bf16 v[226:229], a[76:79], a[220:223], v[226:229]
    v_mfma_f32_16x16x32_bf16 v[226:229], a[56:59], a[204:207], v[226:229]
    ds_read_b128 v[134:137], v9 offset:2048
    v_mfma_f32_16x16x32_bf16 v[170:173], a[60:63], a[192:195], v[170:173]
    buffer_load_dwordx4 a[104:107], v6, s[8:11], s44 offen sc1
    v_mfma_f32_16x16x32_bf16 v[170:173], a[80:83], a[208:211], v[170:173]
    v_mfma_f32_16x16x32_bf16 v[190:193], a[80:83], a[212:215], v[190:193]
    ds_read_b128 v[138:141], v9 offset:3072
    v_mfma_f32_16x16x32_bf16 v[190:193], a[60:63], a[196:199], v[190:193]
    v_mfma_f32_16x16x32_bf16 v[210:213], a[60:63], a[200:203], v[210:213]
    buffer_load_dwordx4 a[108:111], v7, s[8:11], s44 offen sc1
    v_mfma_f32_16x16x32_bf16 v[210:213], a[80:83], a[216:219], v[210:213]
    ds_read_b128 v[142:145], v9 offset:4096
    v_mfma_f32_16x16x32_bf16 v[230:233], a[80:83], a[220:223], v[230:233]
    v_mfma_f32_16x16x32_bf16 v[230:233], a[60:63], a[204:207], v[230:233]
    ds_read_b128 v[146:149], v9 offset:5120
    v_mfma_f32_16x16x32_bf16 v[174:177], a[64:67], a[192:195], v[174:177]
    s_add_u32 s44, s30, 147456
    buffer_load_dwordx4 a[112:115], v4, s[8:11], s44 offen sc1
    v_mfma_f32_16x16x32_bf16 v[174:177], a[84:87], a[208:211], v[174:177]
    v_mfma_f32_16x16x32_bf16 v[194:197], a[84:87], a[212:215], v[194:197]
    ds_read_b128 v[150:153], v9 offset:6144
    v_mfma_f32_16x16x32_bf16 v[194:197], a[64:67], a[196:199], v[194:197]
    buffer_load_dwordx4 a[116:119], v5, s[8:11], s44 offen sc1
    v_mfma_f32_16x16x32_bf16 v[214:217], a[64:67], a[200:203], v[214:217]
    v_mfma_f32_16x16x32_bf16 v[214:217], a[84:87], a[216:219], v[214:217]
    ds_read_b128 v[154:157], v9 offset:7168
    v_mfma_f32_16x16x32_bf16 v[234:237], a[84:87], a[220:223], v[234:237]
    v_mfma_f32_16x16x32_bf16 v[234:237], a[64:67], a[204:207], v[234:237]
    buffer_load_dwordx4 a[120:123], v6, s[8:11], s44 offen sc1
    v_mfma_f32_16x16x32_bf16 v[178:181], a[68:71], a[192:195], v[178:181]
    ds_read_b128 v[158:161], v9 offset:8192
    v_mfma_f32_16x16x32_bf16 v[178:181], a[88:91], a[208:211], v[178:181]
    v_mfma_f32_16x16x32_bf16 v[198:201], a[88:91], a[212:215], v[198:201]
    ds_read_b128 v[162:165], v9 offset:9216
    v_mfma_f32_16x16x32_bf16 v[198:201], a[68:71], a[196:199], v[198:201]
    buffer_load_dwordx4 a[124:127], v7, s[8:11], s44 offen sc1
    v_mfma_f32_16x16x32_bf16 v[218:221], a[68:71], a[200:203], v[218:221]
    v_mfma_f32_16x16x32_bf16 v[218:221], a[88:91], a[216:219], v[218:221]
    v_mfma_f32_16x16x32_bf16 v[238:241], a[88:91], a[220:223], v[238:241]
    v_mfma_f32_16x16x32_bf16 v[238:241], a[68:71], a[204:207], v[238:241]
    v_mfma_f32_16x16x32_bf16 v[182:185], a[72:75], a[192:195], v[182:185]
    v_mfma_f32_16x16x32_bf16 v[182:185], a[92:95], a[208:211], v[182:185]
    v_mfma_f32_16x16x32_bf16 v[202:205], a[92:95], a[212:215], v[202:205]
    v_mfma_f32_16x16x32_bf16 v[202:205], a[72:75], a[196:199], v[202:205]
    v_mfma_f32_16x16x32_bf16 v[222:225], a[72:75], a[200:203], v[222:225]
    v_mfma_f32_16x16x32_bf16 v[222:225], a[92:95], a[216:219], v[222:225]
    v_mfma_f32_16x16x32_bf16 v[242:245], a[92:95], a[220:223], v[242:245]
    v_mfma_f32_16x16x32_bf16 v[242:245], a[72:75], a[204:207], v[242:245]
    s_waitcnt vmcnt(8) lgkmcnt(0)
    v_mfma_f32_16x16x32_bf16 v[166:169], v[126:129], a[224:227], v[166:169]
    v_mfma_f32_16x16x32_bf16 v[166:169], v[146:149], a[240:243], v[166:169]
    s_add_u32 s44, s30, 163840
    buffer_load_dwordx4 a[192:195], v4, s[8:11], s44 offen sc1
    s_lshl_b32 s36, s2, 5
    v_mfma_f32_16x16x32_bf16 v[186:189], v[146:149], a[244:247], v[186:189]
    v_mfma_f32_16x16x32_bf16 v[186:189], v[126:129], a[228:231], v[186:189]
    s_add_u32 s36, s36, s5
    v_mfma_f32_16x16x32_bf16 v[206:209], v[126:129], a[232:235], v[206:209]
    buffer_load_dwordx4 a[196:199], v5, s[8:11], s44 offen sc1
    v_mfma_f32_16x16x32_bf16 v[206:209], v[146:149], a[248:251], v[206:209]
    s_lshl_b32 s36, s36, 2
    v_mfma_f32_16x16x32_bf16 v[226:229], v[146:149], a[252:255], v[226:229]
    s_add_u32 s36, s36, 0x2a0000
    v_mfma_f32_16x16x32_bf16 v[226:229], v[126:129], a[236:239], v[226:229]
    v_mfma_f32_16x16x32_bf16 v[170:173], v[130:133], a[224:227], v[170:173]
    buffer_load_dwordx4 a[200:203], v6, s[8:11], s44 offen sc1
    s_xor_b32 s37, s36, 1024
    v_mfma_f32_16x16x32_bf16 v[170:173], v[150:153], a[240:243], v[170:173]
    v_mfma_f32_16x16x32_bf16 v[190:193], v[150:153], a[244:247], v[190:193]
    s_sub_u32 s40, s5, 1
    v_mfma_f32_16x16x32_bf16 v[190:193], v[130:133], a[228:231], v[190:193]
    v_mfma_f32_16x16x32_bf16 v[210:213], v[130:133], a[232:235], v[210:213]
    buffer_load_dwordx4 a[204:207], v7, s[8:11], s44 offen sc1
    s_and_b32 s40, s40, 3
    v_mfma_f32_16x16x32_bf16 v[210:213], v[150:153], a[248:251], v[210:213]
    s_mul_i32 s40, s40, 20480
    v_mfma_f32_16x16x32_bf16 v[230:233], v[150:153], a[252:255], v[230:233]
    v_mfma_f32_16x16x32_bf16 v[230:233], v[130:133], a[236:239], v[230:233]
    v_lshl_add_u32 v13, v19, 4, s40
    v_mfma_f32_16x16x32_bf16 v[174:177], v[134:137], a[224:227], v[174:177]
    s_add_u32 s44, s30, 180224
    buffer_load_dwordx4 a[208:211], v4, s[8:11], s44 offen sc1
    v_mfma_f32_16x16x32_bf16 v[174:177], v[154:157], a[240:243], v[174:177]
    s_sub_u32 s40, s5, 2
    v_mfma_f32_16x16x32_bf16 v[194:197], v[154:157], a[244:247], v[194:197]
    v_mfma_f32_16x16x32_bf16 v[194:197], v[134:137], a[228:231], v[194:197]
    buffer_load_dwordx4 a[212:215], v5, s[8:11], s44 offen sc1
    s_and_b32 s40, s40, 3
    v_mfma_f32_16x16x32_bf16 v[214:217], v[134:137], a[232:235], v[214:217]
    s_mul_i32 s40, s40, 20480
    v_mfma_f32_16x16x32_bf16 v[214:217], v[154:157], a[248:251], v[214:217]
    v_mfma_f32_16x16x32_bf16 v[234:237], v[154:157], a[252:255], v[234:237]
    v_lshl_add_u32 v14, v19, 4, s40
    v_mfma_f32_16x16x32_bf16 v[234:237], v[134:137], a[236:239], v[234:237]
    buffer_load_dwordx4 a[216:219], v6, s[8:11], s44 offen sc1
    v_mfma_f32_16x16x32_bf16 v[178:181], v[138:141], a[224:227], v[178:181]
    s_sub_u32 s40, s5, 3
    v_mfma_f32_16x16x32_bf16 v[178:181], v[158:161], a[240:243], v[178:181]
    v_mfma_f32_16x16x32_bf16 v[198:201], v[158:161], a[244:247], v[198:201]
    s_and_b32 s40, s40, 3
    v_mfma_f32_16x16x32_bf16 v[198:201], v[138:141], a[228:231], v[198:201]
    buffer_load_dwordx4 a[220:223], v7, s[8:11], s44 offen sc1
    s_mul_i32 s40, s40, 20480
    v_mfma_f32_16x16x32_bf16 v[218:221], v[138:141], a[232:235], v[218:221]
    v_mfma_f32_16x16x32_bf16 v[218:221], v[158:161], a[248:251], v[218:221]
    v_lshl_add_u32 v15, v19, 4, s40
    v_mfma_f32_16x16x32_bf16 v[238:241], v[158:161], a[252:255], v[238:241]
    v_mfma_f32_16x16x32_bf16 v[238:241], v[138:141], a[236:239], v[238:241]
    s_lshl_b32 s40, s2, 2
    v_mfma_f32_16x16x32_bf16 v[182:185], v[142:145], a[224:227], v[182:185]
    v_mfma_f32_16x16x32_bf16 v[182:185], v[162:165], a[240:243], v[182:185]
    s_add_u32 s40, s40, s5
    v_mfma_f32_16x16x32_bf16 v[202:205], v[162:165], a[244:247], v[202:205]
    s_mul_i32 s40, s40, 5120
    v_mfma_f32_16x16x32_bf16 v[202:205], v[142:145], a[228:231], v[202:205]
    v_mfma_f32_16x16x32_bf16 v[222:225], v[142:145], a[232:235], v[222:225]
    s_add_u32 s40, s40, 0x2000000
    v_mfma_f32_16x16x32_bf16 v[222:225], v[162:165], a[248:251], v[222:225]
    v_mfma_f32_16x16x32_bf16 v[242:245], v[162:165], a[252:255], v[242:245]
    v_lshl_add_u32 v18, v19, 4, s40
    v_mfma_f32_16x16x32_bf16 v[242:245], v[142:145], a[236:239], v[242:245]
    s_mov_b32 s41, 4096
    s_waitcnt vmcnt(8)
    v_mfma_f32_16x16x32_bf16 v[166:169], v[46:49], a[96:99], v[166:169]
    v_mfma_f32_16x16x32_bf16 v[166:169], v[66:69], a[112:115], v[166:169]
    s_add_u32 s44, s31, 0
    buffer_load_dwordx4 a[224:227], v4, s[8:11], s44 offen sc1
    v_mfma_f32_16x16x32_bf16 v[186:189], v[66:69], a[116:119], v[186:189]
    v_mfma_f32_16x16x32_bf16 v[186:189], v[46:49], a[100:103], v[186:189]
    v_mfma_f32_16x16x32_bf16 v[206:209], v[46:49], a[104:107], v[206:209]
    buffer_load_dwordx4 a[228:231], v5, s[8:11], s44 offen sc1
    v_mfma_f32_16x16x32_bf16 v[206:209], v[66:69], a[120:123], v[206:209]
    v_mfma_f32_16x16x32_bf16 v[226:229], v[66:69], a[124:127], v[226:229]
    v_mfma_f32_16x16x32_bf16 v[226:229], v[46:49], a[108:111], v[226:229]
    v_mfma_f32_16x16x32_bf16 v[170:173], v[50:53], a[96:99], v[170:173]
    buffer_load_dwordx4 a[232:235], v6, s[8:11], s44 offen sc1
    v_mfma_f32_16x16x32_bf16 v[170:173], v[70:73], a[112:115], v[170:173]
    v_mfma_f32_16x16x32_bf16 v[190:193], v[70:73], a[116:119], v[190:193]
    v_mfma_f32_16x16x32_bf16 v[190:193], v[50:53], a[100:103], v[190:193]
    v_mfma_f32_16x16x32_bf16 v[210:213], v[50:53], a[104:107], v[210:213]
    buffer_load_dwordx4 a[236:239], v7, s[8:11], s44 offen sc1
    v_mfma_f32_16x16x32_bf16 v[210:213], v[70:73], a[120:123], v[210:213]
    v_mfma_f32_16x16x32_bf16 v[230:233], v[70:73], a[124:127], v[230:233]
    v_mfma_f32_16x16x32_bf16 v[230:233], v[50:53], a[108:111], v[230:233]
    v_mfma_f32_16x16x32_bf16 v[174:177], v[54:57], a[96:99], v[174:177]
    s_add_u32 s44, s31, 16384
    buffer_load_dwordx4 a[240:243], v4, s[8:11], s44 offen sc1
    v_mfma_f32_16x16x32_bf16 v[174:177], v[74:77], a[112:115], v[174:177]
    v_mfma_f32_16x16x32_bf16 v[194:197], v[74:77], a[116:119], v[194:197]
    v_mfma_f32_16x16x32_bf16 v[194:197], v[54:57], a[100:103], v[194:197]
    buffer_load_dwordx4 a[244:247], v5, s[8:11], s44 offen sc1
    v_mfma_f32_16x16x32_bf16 v[214:217], v[54:57], a[104:107], v[214:217]
    v_mfma_f32_16x16x32_bf16 v[214:217], v[74:77], a[120:123], v[214:217]
    v_mfma_f32_16x16x32_bf16 v[234:237], v[74:77], a[124:127], v[234:237]
    v_mfma_f32_16x16x32_bf16 v[234:237], v[54:57], a[108:111], v[234:237]
    buffer_load_dwordx4 a[248:251], v6, s[8:11], s44 offen sc1
    v_mfma_f32_16x16x32_bf16 v[178:181], v[58:61], a[96:99], v[178:181]
    v_mfma_f32_16x16x32_bf16 v[178:181], v[78:81], a[112:115], v[178:181]
    v_mfma_f32_16x16x32_bf16 v[198:201], v[78:81], a[116:119], v[198:201]
    v_mfma_f32_16x16x32_bf16 v[198:201], v[58:61], a[100:103], v[198:201]
    buffer_load_dwordx4 a[252:255], v7, s[8:11], s44 offen sc1
    v_mfma_f32_16x16x32_bf16 v[218:221], v[58:61], a[104:107], v[218:221]
    v_mfma_f32_16x16x32_bf16 v[218:221], v[78:81], a[120:123], v[218:221]
    v_mfma_f32_16x16x32_bf16 v[238:241], v[78:81], a[124:127], v[238:241]
    v_mfma_f32_16x16x32_bf16 v[238:241], v[58:61], a[108:111], v[238:241]
    v_mfma_f32_16x16x32_bf16 v[182:185], v[62:65], a[96:99], v[182:185]
    v_mfma_f32_16x16x32_bf16 v[182:185], v[82:85], a[112:115], v[182:185]
    v_mfma_f32_16x16x32_bf16 v[202:205], v[82:85], a[116:119], v[202:205]
    v_mfma_f32_16x16x32_bf16 v[202:205], v[62:65], a[100:103], v[202:205]
    v_mfma_f32_16x16x32_bf16 v[222:225], v[62:65], a[104:107], v[222:225]
    v_mfma_f32_16x16x32_bf16 v[222:225], v[82:85], a[120:123], v[222:225]
    v_mfma_f32_16x16x32_bf16 v[242:245], v[82:85], a[124:127], v[242:245]
    v_mfma_f32_16x16x32_bf16 v[242:245], v[62:65], a[108:111], v[242:245]
    s_waitcnt vmcnt(8)
    v_mfma_f32_16x16x32_bf16 v[186:189], v[86:89], a[196:199], v[186:189]
    v_mfma_f32_16x16x32_bf16 v[186:189], v[106:109], a[212:215], v[186:189]
    s_add_u32 s44, s31, 32768
    buffer_load_dwordx4 a[96:99], v4, s[8:11], s44 offen sc1
    v_mfma_f32_16x16x32_bf16 v[190:193], v[110:113], a[212:215], v[190:193]
    v_mfma_f32_16x16x32_bf16 v[190:193], v[90:93], a[196:199], v[190:193]
    v_mfma_f32_16x16x32_bf16 v[194:197], v[94:97], a[196:199], v[194:197]
    buffer_load_dwordx4 a[100:103], v5, s[8:11], s44 offen sc1
    v_mfma_f32_16x16x32_bf16 v[194:197], v[114:117], a[212:215], v[194:197]
    v_mfma_f32_16x16x32_bf16 v[198:201], v[118:121], a[212:215], v[198:201]
    v_mfma_f32_16x16x32_bf16 v[198:201], v[98:101], a[196:199], v[198:201]
    v_mfma_f32_16x16x32_bf16 v[202:205], v[102:105], a[196:199], v[202:205]
    buffer_load_dwordx4 a[104:107], v6, s[8:11], s44 offen sc1
    v_mfma_f32_16x16x32_bf16 v[202:205], v[122:125], a[212:215], v[202:205]
    ds_write_b128 v10, v[186:189] offset:0
    v_mfma_f32_16x16x32_bf16 v[206:209], v[106:109], a[216:219], v[206:209]
    v_mfma_f32_16x16x32_bf16 v[206:209], v[86:89], a[200:203], v[206:209]
    ds_write_b128 v10, v[190:193] offset:1024
    v_mfma_f32_16x16x32_bf16 v[210:213], v[90:93], a[200:203], v[210:213]
    buffer_load_dwordx4 a[108:111], v7, s[8:11], s44 offen sc1
    v_mfma_f32_16x16x32_bf16 v[210:213], v[110:113], a[216:219], v[210:213]
    ds_write_b128 v10, v[194:197] offset:2048
    v_mfma_f32_16x16x32_bf16 v[214:217], v[114:117], a[216:219], v[214:217]
    v_mfma_f32_16x16x32_bf16 v[214:217], v[94:97], a[200:203], v[214:217]
    ds_write_b128 v10, v[198:201] offset:3072
    v_mfma_f32_16x16x32_bf16 v[218:221], v[98:101], a[200:203], v[218:221]
    s_add_u32 s44, s31, 49152
    buffer_load_dwordx4 a[112:115], v4, s[8:11], s44 offen sc1
    v_mfma_f32_16x16x32_bf16 v[218:221], v[118:121], a[216:219], v[218:221]
    ds_write_b128 v10, v[202:205] offset:4096
    v_mfma_f32_16x16x32_bf16 v[222:225], v[122:125], a[216:219], v[222:225]
    v_mfma_f32_16x16x32_bf16 v[222:225], v[102:105], a[200:203], v[222:225]
    ds_write_b128 v10, v[206:209] offset:5120
    buffer_load_dwordx4 a[116:119], v5, s[8:11], s44 offen sc1
    v_mfma_f32_16x16x32_bf16 v[226:229], v[86:89], a[204:207], v[226:229]
    v_mfma_f32_16x16x32_bf16 v[226:229], v[106:109], a[220:223], v[226:229]
    ds_write_b128 v10, v[210:213] offset:6144
    v_mfma_f32_16x16x32_bf16 v[230:233], v[110:113], a[220:223], v[230:233]
    v_mfma_f32_16x16x32_bf16 v[230:233], v[90:93], a[204:207], v[230:233]
    ds_write_b128 v10, v[214:217] offset:7168
    buffer_load_dwordx4 a[120:123], v6, s[8:11], s44 offen sc1
    v_mfma_f32_16x16x32_bf16 v[234:237], v[94:97], a[204:207], v[234:237]
    v_mfma_f32_16x16x32_bf16 v[234:237], v[114:117], a[220:223], v[234:237]
    ds_write_b128 v10, v[218:221] offset:8192
    v_mfma_f32_16x16x32_bf16 v[238:241], v[118:121], a[220:223], v[238:241]
    v_mfma_f32_16x16x32_bf16 v[238:241], v[98:101], a[204:207], v[238:241]
    ds_write_b128 v10, v[222:225] offset:9216
    buffer_load_dwordx4 a[124:127], v7, s[8:11], s44 offen sc1
    v_mfma_f32_16x16x32_bf16 v[242:245], v[102:105], a[204:207], v[242:245]
    v_mfma_f32_16x16x32_bf16 v[242:245], v[122:125], a[220:223], v[242:245]
    ds_write_b128 v10, v[226:229] offset:10240
    v_mfma_f32_16x16x32_bf16 v[166:169], v[106:109], a[208:211], v[166:169]
    v_mfma_f32_16x16x32_bf16 v[166:169], v[86:89], a[192:195], v[166:169]
    ds_write_b128 v10, v[230:233] offset:11264
    v_mfma_f32_16x16x32_bf16 v[170:173], v[90:93], a[192:195], v[170:173]
    v_mfma_f32_16x16x32_bf16 v[170:173], v[110:113], a[208:211], v[170:173]
    ds_write_b128 v10, v[234:237] offset:12288
    v_mfma_f32_16x16x32_bf16 v[174:177], v[114:117], a[208:211], v[174:177]
    v_mfma_f32_16x16x32_bf16 v[174:177], v[94:97], a[192:195], v[174:177]
    ds_write_b128 v10, v[238:241] offset:13312
    v_mfma_f32_16x16x32_bf16 v[178:181], v[98:101], a[192:195], v[178:181]
    v_mfma_f32_16x16x32_bf16 v[178:181], v[118:121], a[208:211], v[178:181]
    ds_write_b128 v10, v[242:245] offset:14336
    v_mfma_f32_16x16x32_bf16 v[182:185], v[122:125], a[208:211], v[182:185]
    v_mfma_f32_16x16x32_bf16 v[182:185], v[102:105], a[192:195], v[182:185]
    s_waitcnt vmcnt(8)
    v_mfma_f32_16x16x32_bf16 v[186:189], a[128:131], a[228:231], 0
    s_nop 0
    v_mov_b32 v126, v166
    v_mfma_f32_16x16x32_bf16 v[186:189], a[148:151], a[244:247], v[186:189]
    s_add_u32 s44, s31, 65536
    buffer_load_dwordx4 a[192:195], v4, s[8:11], s44 offen sc1
    v_mov_b32 v127, v167
    v_mov_b32 v128, v168
    v_mov_b32 v129, v169
    v_mfma_f32_16x16x32_bf16 v[190:193], a[152:155], a[244:247], 0
    v_mov_b32 v130, v170
    v_mov_b32 v131, v171
    v_mov_b32 v132, v172
    v_mfma_f32_16x16x32_bf16 v[190:193], a[132:135], a[228:231], v[190:193]
    v_mov_b32 v133, v173
    s_waitcnt lgkmcnt(0)
    s_barrier
    v_mfma_f32_16x16x32_bf16 v[194:197], a[136:139], a[228:231], 0
    buffer_load_dwordx4 a[196:199], v5, s[8:11], s44 offen sc1
    ds_read_b128 v[146:149], v13 offset:0
    ds_read_b128 v[150:153], v13 offset:1024
    v_mfma_f32_16x16x32_bf16 v[194:197], a[156:159], a[244:247], v[194:197]
    ds_read_b128 v[154:157], v13 offset:2048
    ds_read_b128 v[158:161], v13 offset:3072
    ds_read_b128 v[162:165], v13 offset:4096
    v_mfma_f32_16x16x32_bf16 v[198:201], a[160:163], a[244:247], 0
    v_mov_b32 v134, v174
    v_mov_b32 v135, v175
    v_mov_b32 v136, v176
    v_mfma_f32_16x16x32_bf16 v[198:201], a[140:143], a[228:231], v[198:201]
    v_mov_b32 v137, v177
    v_mov_b32 v138, v178
    v_mov_b32 v139, v179
    v_mfma_f32_16x16x32_bf16 v[202:205], a[144:147], a[228:231], 0
    buffer_load_dwordx4 a[200:203], v6, s[8:11], s44 offen sc1
    v_mov_b32 v140, v180
    v_mov_b32 v141, v181
    v_mfma_f32_16x16x32_bf16 v[202:205], a[164:167], a[244:247], v[202:205]
    v_mov_b32 v142, v182
    v_mov_b32 v143, v183
    v_mov_b32 v144, v184
    v_mfma_f32_16x16x32_bf16 v[206:209], a[148:151], a[248:251], 0
    v_mov_b32 v145, v185
    s_waitcnt lgkmcnt(4)
    v_add_f32 v126, v126, v146
    v_mfma_f32_16x16x32_bf16 v[206:209], a[128:131], a[232:235], v[206:209]
    v_add_f32 v127, v127, v147
    v_add_f32 v128, v128, v148
    v_add_f32 v129, v129, v149
    v_mfma_f32_16x16x32_bf16 v[210:213], a[132:135], a[232:235], 0
    buffer_load_dwordx4 a[204:207], v7, s[8:11], s44 offen sc1
    ds_read_b128 v[146:149], v14 offset:5120
    s_waitcnt lgkmcnt(4)
    v_mfma_f32_16x16x32_bf16 v[210:213], a[152:155], a[248:251], v[210:213]
    v_add_f32 v130, v130, v150
    v_add_f32 v131, v131, v151
    v_add_f32 v132, v132, v152
    v_mfma_f32_16x16x32_bf16 v[214:217], a[156:159], a[248:251], 0
    v_add_f32 v133, v133, v153
    ds_read_b128 v[150:153], v14 offset:6144
    s_waitcnt lgkmcnt(4)
    v_mfma_f32_16x16x32_bf16 v[214:217], a[136:139], a[232:235], v[214:217]
    v_add_f32 v134, v134, v154
    v_add_f32 v135, v135, v155
    v_add_f32 v136, v136, v156
    v_mfma_f32_16x16x32_bf16 v[218:221], a[140:143], a[232:235], 0
    s_add_u32 s44, s31, 81920
    buffer_load_dwordx4 a[208:211], v4, s[8:11], s44 offen sc1
    v_add_f32 v137, v137, v157
    ds_read_b128 v[154:157], v14 offset:7168
    v_mfma_f32_16x16x32_bf16 v[218:221], a[160:163], a[248:251], v[218:221]
    s_waitcnt lgkmcnt(4)
    v_add_f32 v138, v138, v158
    v_add_f32 v139, v139, v159
    v_mfma_f32_16x16x32_bf16 v[222:225], a[164:167], a[248:251], 0
    v_add_f32 v140, v140, v160
    v_add_f32 v141, v141, v161
    ds_read_b128 v[158:161], v14 offset:8192
    v_mfma_f32_16x16x32_bf16 v[222:225], a[144:147], a[232:235], v[222:225]
    buffer_load_dwordx4 a[212:215], v5, s[8:11], s44 offen sc1
    s_waitcnt lgkmcnt(4)
    v_add_f32 v142, v142, v162
    v_add_f32 v143, v143, v163
    v_mfma_f32_16x16x32_bf16 v[226:229], a[128:131], a[236:239], 0
    v_add_f32 v144, v144, v164
    v_add_f32 v145, v145, v165
    v_mfma_f32_16x16x32_bf16 v[226:229], a[148:151], a[252:255], v[226:229]
    ds_read_b128 v[162:165], v14 offset:9216
    s_waitcnt lgkmcnt(4)
    v_add_f32 v126, v126, v146
    v_mfma_f32_16x16x32_bf16 v[230:233], a[152:155], a[252:255], 0
    v_add_f32 v127, v127, v147
    v_add_f32 v128, v128, v148
    v_add_f32 v129, v129, v149
    v_mfma_f32_16x16x32_bf16 v[230:233], a[132:135], a[236:239], v[230:233]
    buffer_load_dwordx4 a[216:219], v6, s[8:11], s44 offen sc1
    ds_read_b128 v[146:149], v15 offset:10240
    s_waitcnt lgkmcnt(4)
    v_add_f32 v130, v130, v150
    v_mfma_f32_16x16x32_bf16 v[234:237], a[136:139], a[236:239], 0
    v_add_f32 v131, v131, v151
    v_add_f32 v132, v132, v152
    v_mfma_f32_16x16x32_bf16 v[234:237], a[156:159], a[252:255], v[234:237]
    v_add_f32 v133, v133, v153
    ds_read_b128 v[150:153], v15 offset:11264
    s_waitcnt lgkmcnt(4)
    v_mfma_f32_16x16x32_bf16 v[238:241], a[160:163], a[252:255], 0
    v_add_f32 v134, v134, v154
    v_add_f32 v135, v135, v155
    v_add_f32 v136, v136, v156
    v_mfma_f32_16x16x32_bf16 v[238:241], a[140:143], a[236:239], v[238:241]
    buffer_load_dwordx4 a[220:223], v7, s[8:11], s44 offen sc1
    v_add_f32 v137, v137, v157
    ds_read_b128 v[154:157], v15 offset:12288
    s_waitcnt lgkmcnt(4)
    v_mfma_f32_16x16x32_bf16 v[242:245], a[144:147], a[236:239], 0
    v_add_f32 v138, v138, v158
    v_add_f32 v139, v139, v159
    v_mfma_f32_16x16x32_bf16 v[242:245], a[164:167], a[252:255], v[242:245]
    v_add_f32 v140, v140, v160
    v_add_f32 v141, v141, v161
    ds_read_b128 v[158:161], v15 offset:13312
    v_mfma_f32_16x16x32_bf16 v[166:169], a[148:151], a[240:243], 0
    s_waitcnt lgkmcnt(4)
    v_add_f32 v142, v142, v162
    v_add_f32 v143, v143, v163
    v_mfma_f32_16x16x32_bf16 v[166:169], a[128:131], a[224:227], v[166:169]
    v_add_f32 v144, v144, v164
    v_add_f32 v145, v145, v165
    ds_read_b128 v[162:165], v15 offset:14336
    v_mfma_f32_16x16x32_bf16 v[170:173], a[132:135], a[224:227], 0
    s_waitcnt lgkmcnt(4)
    v_add_f32 v126, v126, v146
    v_mfma_f32_16x16x32_bf16 v[170:173], a[152:155], a[240:243], v[170:173]
    v_add_f32 v127, v127, v147
    v_add_f32 v128, v128, v148
    v_add_f32 v129, v129, v149
    v_mfma_f32_16x16x32_bf16 v[174:177], a[156:159], a[240:243], 0
    s_waitcnt lgkmcnt(3)
    v_add_f32 v130, v130, v150
    v_add_f32 v131, v131, v151
    v_mfma_f32_16x16x32_bf16 v[174:177], a[136:139], a[224:227], v[174:177]
    v_add_f32 v132, v132, v152
    v_add_f32 v133, v133, v153
    s_waitcnt lgkmcnt(2)
    v_mfma_f32_16x16x32_bf16 v[178:181], a[140:143], a[224:227], 0
    v_add_f32 v134, v134, v154
    v_add_f32 v135, v135, v155
    v_mfma_f32_16x16x32_bf16 v[178:181], a[160:163], a[240:243], v[178:181]
    v_add_f32 v136, v136, v156
    v_add_f32 v137, v137, v157
    s_waitcnt lgkmcnt(1)
    v_mfma_f32_16x16x32_bf16 v[182:185], a[164:167], a[240:243], 0
    v_add_f32 v138, v138, v158
    v_add_f32 v139, v139, v159
    v_add_f32 v140, v140, v160
    v_mfma_f32_16x16x32_bf16 v[182:185], a[144:147], a[224:227], v[182:185]
    v_add_f32 v141, v141, v161
    s_waitcnt lgkmcnt(0)
    v_add_f32 v142, v142, v162
    s_waitcnt vmcnt(8)
    v_mfma_f32_16x16x32_bf16 v[166:169], a[168:171], a[96:99], v[166:169]
    v_mfma_f32_16x16x32_bf16 v[166:169], a[188:191], a[112:115], v[166:169]
    s_add_u32 s44, s31, 196608
    buffer_load_dwordx4 a[224:227], v4, s[8:11], s44 offen sc1
    v_mfma_f32_16x16x32_bf16 v[186:189], a[188:191], a[116:119], v[186:189]
    buffer_load_dwordx4 a[228:231], v5, s[8:11], s44 offen sc1
    v_mfma_f32_16x16x32_bf16 v[186:189], a[168:171], a[100:103], v[186:189]
    buffer_load_dwordx4 a[232:235], v6, s[8:11], s44 offen sc1
    v_add_f32 v143, v143, v163
    v_mfma_f32_16x16x32_bf16 v[206:209], a[168:171], a[104:107], v[206:209]
    buffer_load_dwordx4 a[236:239], v7, s[8:11], s44 offen sc1
    v_mfma_f32_16x16x32_bf16 v[206:209], a[188:191], a[120:123], v[206:209]
    v_mfma_f32_16x16x32_bf16 v[226:229], a[188:191], a[124:127], v[226:229]
    s_add_u32 s44, s31, 212992
    buffer_load_dwordx4 a[240:243], v4, s[8:11], s44 offen sc1
    v_add_f32 v144, v144, v164
    v_mfma_f32_16x16x32_bf16 v[226:229], a[168:171], a[108:111], v[226:229]
    buffer_load_dwordx4 a[244:247], v5, s[8:11], s44 offen sc1
    v_mfma_f32_16x16x32_bf16 v[170:173], a[172:175], a[96:99], v[170:173]
    buffer_load_dwordx4 a[248:251], v6, s[8:11], s44 offen sc1
    v_mfma_f32_16x16x32_bf16 v[170:173], a[0:3], a[112:115], v[170:173]
    buffer_load_dwordx4 a[252:255], v7, s[8:11], s44 offen sc1
    v_add_f32 v145, v145, v165
    v_mfma_f32_16x16x32_bf16 v[190:193], a[0:3], a[116:119], v[190:193]
    v_mfma_f32_16x16x32_bf16 v[190:193], a[172:175], a[100:103], v[190:193]
    v_mfma_f32_16x16x32_bf16 v[210:213], a[172:175], a[104:107], v[210:213]
    buffer_store_dwordx4 v[126:129], v18, s[76:79], 0 offen offset:0 sc1
    v_mfma_f32_16x16x32_bf16 v[210:213], a[0:3], a[120:123], v[210:213]
    v_mfma_f32_16x16x32_bf16 v[230:233], a[0:3], a[124:127], v[230:233]
    v_mfma_f32_16x16x32_bf16 v[230:233], a[172:175], a[108:111], v[230:233]
    v_mfma_f32_16x16x32_bf16 v[174:177], a[176:179], a[96:99], v[174:177]
    v_mfma_f32_16x16x32_bf16 v[174:177], a[4:7], a[112:115], v[174:177]
    v_mfma_f32_16x16x32_bf16 v[194:197], a[4:7], a[116:119], v[194:197]
    buffer_store_dwordx4 v[130:133], v18, s[76:79], 0 offen offset:1024 sc1
    v_mfma_f32_16x16x32_bf16 v[194:197], a[176:179], a[100:103], v[194:197]
    v_mfma_f32_16x16x32_bf16 v[214:217], a[176:179], a[104:107], v[214:217]
    v_mfma_f32_16x16x32_bf16 v[214:217], a[4:7], a[120:123], v[214:217]
    v_mfma_f32_16x16x32_bf16 v[234:237], a[4:7], a[124:127], v[234:237]
    v_mfma_f32_16x16x32_bf16 v[234:237], a[176:179], a[108:111], v[234:237]
    v_mfma_f32_16x16x32_bf16 v[178:181], a[180:183], a[96:99], v[178:181]
    buffer_store_dwordx4 v[134:137], v18, s[76:79], 0 offen offset:2048 sc1
    v_mfma_f32_16x16x32_bf16 v[178:181], a[8:11], a[112:115], v[178:181]
    v_mfma_f32_16x16x32_bf16 v[198:201], a[8:11], a[116:119], v[198:201]
    v_mfma_f32_16x16x32_bf16 v[198:201], a[180:183], a[100:103], v[198:201]
    v_mfma_f32_16x16x32_bf16 v[218:221], a[180:183], a[104:107], v[218:221]
    v_mfma_f32_16x16x32_bf16 v[218:221], a[8:11], a[120:123], v[218:221]
    v_mfma_f32_16x16x32_bf16 v[238:241], a[8:11], a[124:127], v[238:241]
    buffer_store_dwordx4 v[138:141], v18, s[76:79], 0 offen offset:3072 sc1
    v_mfma_f32_16x16x32_bf16 v[238:241], a[180:183], a[108:111], v[238:241]
    v_mfma_f32_16x16x32_bf16 v[182:185], a[184:187], a[96:99], v[182:185]
    v_mfma_f32_16x16x32_bf16 v[182:185], a[12:15], a[112:115], v[182:185]
    v_mfma_f32_16x16x32_bf16 v[202:205], a[12:15], a[116:119], v[202:205]
    v_mfma_f32_16x16x32_bf16 v[202:205], a[184:187], a[100:103], v[202:205]
    v_mfma_f32_16x16x32_bf16 v[222:225], a[184:187], a[104:107], v[222:225]
    buffer_store_dwordx4 v[142:145], v18, s[76:79], s41 offen offset:0 sc1
    v_mfma_f32_16x16x32_bf16 v[222:225], a[12:15], a[120:123], v[222:225]
    v_mfma_f32_16x16x32_bf16 v[242:245], a[12:15], a[124:127], v[242:245]
    v_mfma_f32_16x16x32_bf16 v[242:245], a[184:187], a[108:111], v[242:245]
    s_waitcnt vmcnt(13)
    v_mfma_f32_16x16x32_bf16 v[166:169], a[16:19], a[192:195], v[166:169]
    v_mfma_f32_16x16x32_bf16 v[166:169], a[36:39], a[208:211], v[166:169]
    s_add_u32 s44, s31, 98304
    buffer_load_dwordx4 a[96:99], v4, s[8:11], s44 offen sc1
    v_mfma_f32_16x16x32_bf16 v[186:189], a[36:39], a[212:215], v[186:189]
    v_mfma_f32_16x16x32_bf16 v[186:189], a[16:19], a[196:199], v[186:189]
    v_mfma_f32_16x16x32_bf16 v[206:209], a[16:19], a[200:203], v[206:209]
    buffer_load_dwordx4 a[100:103], v5, s[8:11], s44 offen sc1
    v_mfma_f32_16x16x32_bf16 v[206:209], a[36:39], a[216:219], v[206:209]
    v_mfma_f32_16x16x32_bf16 v[226:229], a[36:39], a[220:223], v[226:229]
    v_mfma_f32_16x16x32_bf16 v[226:229], a[16:19], a[204:207], v[226:229]
    v_mfma_f32_16x16x32_bf16 v[170:173], a[20:23], a[192:195], v[170:173]
    buffer_load_dwordx4 a[104:107], v6, s[8:11], s44 offen sc1
    v_mfma_f32_16x16x32_bf16 v[170:173], a[40:43], a[208:211], v[170:173]
    v_mfma_f32_16x16x32_bf16 v[190:193], a[40:43], a[212:215], v[190:193]
    v_mfma_f32_16x16x32_bf16 v[190:193], a[20:23], a[196:199], v[190:193]
    v_mfma_f32_16x16x32_bf16 v[210:213], a[20:23], a[200:203], v[210:213]
    buffer_load_dwordx4 a[108:111], v7, s[8:11], s44 offen sc1
    v_mfma_f32_16x16x32_bf16 v[210:213], a[40:43], a[216:219], v[210:213]
    v_mfma_f32_16x16x32_bf16 v[230:233], a[40:43], a[220:223], v[230:233]
    v_mfma_f32_16x16x32_bf16 v[230:233], a[20:23], a[204:207], v[230:233]
    ds_read_b128 v[126:129], v8 offset:0
    v_mfma_f32_16x16x32_bf16 v[174:177], a[24:27], a[192:195], v[174:177]
    s_add_u32 s44, s31, 114688
    buffer_load_dwordx4 a[112:115], v4, s[8:11], s44 offen sc1
    v_mfma_f32_16x16x32_bf16 v[174:177], a[44:47], a[208:211], v[174:177]
    v_mfma_f32_16x16x32_bf16 v[194:197], a[44:47], a[212:215], v[194:197]
    ds_read_b128 v[130:133], v8 offset:1024
    v_mfma_f32_16x16x32_bf16 v[194:197], a[24:27], a[196:199], v[194:197]
    buffer_load_dwordx4 a[116:119], v5, s[8:11], s44 offen sc1
    v_mfma_f32_16x16x32_bf16 v[214:217], a[24:27], a[200:203], v[214:217]
    v_mfma_f32_16x16x32_bf16 v[214:217], a[44:47], a[216:219], v[214:217]
    ds_read_b128 v[134:137], v8 offset:2048
    v_mfma_f32_16x16x32_bf16 v[234:237], a[44:47], a[220:223], v[234:237]
    v_mfma_f32_16x16x32_bf16 v[234:237], a[24:27], a[204:207], v[234:237]
    buffer_load_dwordx4 a[120:123], v6, s[8:11], s44 offen sc1
    v_mfma_f32_16x16x32_bf16 v[178:181], a[28:31], a[192:195], v[178:181]
    ds_read_b128 v[138:141], v8 offset:3072
    v_mfma_f32_16x16x32_bf16 v[178:181], a[48:51], a[208:211], v[178:181]
    v_mfma_f32_16x16x32_bf16 v[198:201], a[48:51], a[212:215], v[198:201]
    ds_read_b128 v[142:145], v8 offset:4096
    v_mfma_f32_16x16x32_bf16 v[198:201], a[28:31], a[196:199], v[198:201]
    buffer_load_dwordx4 a[124:127], v7, s[8:11], s44 offen sc1
    v_mfma_f32_16x16x32_bf16 v[218:221], a[28:31], a[200:203], v[218:221]
    v_mfma_f32_16x16x32_bf16 v[218:221], a[48:51], a[216:219], v[218:221]
    ds_read_b128 v[146:149], v8 offset:5120
    v_mfma_f32_16x16x32_bf16 v[238:241], a[48:51], a[220:223], v[238:241]
    v_mfma_f32_16x16x32_bf16 v[238:241], a[28:31], a[204:207], v[238:241]
    ds_read_b128 v[150:153], v8 offset:6144
    v_mfma_f32_16x16x32_bf16 v[182:185], a[32:35], a[192:195], v[182:185]
    v_mfma_f32_16x16x32_bf16 v[182:185], a[52:55], a[208:211], v[182:185]
    ds_read_b128 v[154:157], v8 offset:7168
    v_mfma_f32_16x16x32_bf16 v[202:205], a[52:55], a[212:215], v[202:205]
    v_mfma_f32_16x16x32_bf16 v[202:205], a[32:35], a[196:199], v[202:205]
    ds_read_b128 v[158:161], v8 offset:8192
    v_mfma_f32_16x16x32_bf16 v[222:225], a[32:35], a[200:203], v[222:225]
    v_mfma_f32_16x16x32_bf16 v[222:225], a[52:55], a[216:219], v[222:225]
    ds_read_b128 v[162:165], v8 offset:9216
    v_mfma_f32_16x16x32_bf16 v[242:245], a[52:55], a[220:223], v[242:245]
    buffer_load_dwordx2 v[20:21], v11, s[76:79], 0 offen offset:0 sc1
    buffer_load_dwordx2 v[246:247], v11, s[76:79], 0 offen offset:32 sc1
    buffer_load_dwordx2 v[248:249], v11, s[76:79], 0 offen offset:64 sc1
    buffer_load_dwordx2 v[252:253], v11, s[76:79], 0 offen offset:96 sc1
    buffer_load_dwordx2 v[254:255], v11, s[76:79], 0 offen offset:128 sc1
    v_mfma_f32_16x16x32_bf16 v[242:245], a[32:35], a[204:207], v[242:245]
    s_waitcnt vmcnt(18) lgkmcnt(0)
    v_mfma_f32_16x16x32_bf16 v[166:169], v[126:129], a[224:227], v[166:169]
    s_waitcnt vmcnt(13)
    s_mov_b64 exec, 1
    buffer_store_dword v2, off, s[76:79], s36 sc1
    s_mov_b64 exec, -1
    v_mfma_f32_16x16x32_bf16 v[166:169], v[146:149], a[240:243], v[166:169]
    s_add_u32 s44, s31, 229376
    buffer_load_dwordx4 a[192:195], v4, s[8:11], s44 offen sc1
    v_mfma_f32_16x16x32_bf16 v[186:189], v[146:149], a[244:247], v[186:189]
    v_mfma_f32_16x16x32_bf16 v[186:189], v[126:129], a[228:231], v[186:189]
    v_mfma_f32_16x16x32_bf16 v[206:209], v[126:129], a[232:235], v[206:209]
    buffer_load_dwordx4 a[196:199], v5, s[8:11], s44 offen sc1
    v_mfma_f32_16x16x32_bf16 v[206:209], v[146:149], a[248:251], v[206:209]
    v_mfma_f32_16x16x32_bf16 v[226:229], v[146:149], a[252:255], v[226:229]
    v_mfma_f32_16x16x32_bf16 v[226:229], v[126:129], a[236:239], v[226:229]
    v_mfma_f32_16x16x32_bf16 v[170:173], v[130:133], a[224:227], v[170:173]
    buffer_load_dwordx4 a[200:203], v6, s[8:11], s44 offen sc1
    v_mfma_f32_16x16x32_bf16 v[170:173], v[150:153], a[240:243], v[170:173]
    v_mfma_f32_16x16x32_bf16 v[190:193], v[150:153], a[244:247], v[190:193]
    v_mfma_f32_16x16x32_bf16 v[190:193], v[130:133], a[228:231], v[190:193]
    v_mfma_f32_16x16x32_bf16 v[210:213], v[130:133], a[232:235], v[210:213]
    buffer_load_dwordx4 a[204:207], v7, s[8:11], s44 offen sc1
    v_mfma_f32_16x16x32_bf16 v[210:213], v[150:153], a[248:251], v[210:213]
    v_mfma_f32_16x16x32_bf16 v[230:233], v[150:153], a[252:255], v[230:233]
    v_mfma_f32_16x16x32_bf16 v[230:233], v[130:133], a[236:239], v[230:233]
    v_mfma_f32_16x16x32_bf16 v[174:177], v[134:137], a[224:227], v[174:177]
    s_add_u32 s44, s31, 245760
    buffer_load_dwordx4 a[208:211], v4, s[8:11], s44 offen sc1
    v_mfma_f32_16x16x32_bf16 v[174:177], v[154:157], a[240:243], v[174:177]
    v_mfma_f32_16x16x32_bf16 v[194:197], v[154:157], a[244:247], v[194:197]
    v_mfma_f32_16x16x32_bf16 v[194:197], v[134:137], a[228:231], v[194:197]
    buffer_load_dwordx4 a[212:215], v5, s[8:11], s44 offen sc1
    v_mfma_f32_16x16x32_bf16 v[214:217], v[134:137], a[232:235], v[214:217]
    v_mfma_f32_16x16x32_bf16 v[214:217], v[154:157], a[248:251], v[214:217]
    v_mfma_f32_16x16x32_bf16 v[234:237], v[154:157], a[252:255], v[234:237]
    v_mfma_f32_16x16x32_bf16 v[234:237], v[134:137], a[236:239], v[234:237]
    buffer_load_dwordx4 a[216:219], v6, s[8:11], s44 offen sc1
    v_mfma_f32_16x16x32_bf16 v[178:181], v[138:141], a[224:227], v[178:181]
    v_mfma_f32_16x16x32_bf16 v[178:181], v[158:161], a[240:243], v[178:181]
    v_mfma_f32_16x16x32_bf16 v[198:201], v[158:161], a[244:247], v[198:201]
    v_mfma_f32_16x16x32_bf16 v[198:201], v[138:141], a[228:231], v[198:201]
    buffer_load_dwordx4 a[220:223], v7, s[8:11], s44 offen sc1
    v_mfma_f32_16x16x32_bf16 v[218:221], v[138:141], a[232:235], v[218:221]
    v_mfma_f32_16x16x32_bf16 v[218:221], v[158:161], a[248:251], v[218:221]
    v_mfma_f32_16x16x32_bf16 v[238:241], v[158:161], a[252:255], v[238:241]
    v_mfma_f32_16x16x32_bf16 v[238:241], v[138:141], a[236:239], v[238:241]
    v_mfma_f32_16x16x32_bf16 v[182:185], v[142:145], a[224:227], v[182:185]
    v_mfma_f32_16x16x32_bf16 v[182:185], v[162:165], a[240:243], v[182:185]
    v_mfma_f32_16x16x32_bf16 v[202:205], v[162:165], a[244:247], v[202:205]
    v_mfma_f32_16x16x32_bf16 v[202:205], v[142:145], a[228:231], v[202:205]
    v_mfma_f32_16x16x32_bf16 v[222:225], v[142:145], a[232:235], v[222:225]
    v_mfma_f32_16x16x32_bf16 v[222:225], v[162:165], a[248:251], v[222:225]
    v_mfma_f32_16x16x32_bf16 v[242:245], v[162:165], a[252:255], v[242:245]
    v_mfma_f32_16x16x32_bf16 v[242:245], v[142:145], a[236:239], v[242:245]
    s_waitcnt vmcnt(14)
    v_mfma_f32_16x16x32_bf16 v[166:169], a[56:59], a[96:99], v[166:169]
    v_mfma_f32_16x16x32_bf16 v[166:169], a[76:79], a[112:115], v[166:169]
    s_add_u32 s44, s31, 131072
    buffer_load_dwordx4 a[224:227], v4, s[8:11], s44 offen sc1
    v_mfma_f32_16x16x32_bf16 v[186:189], a[76:79], a[116:119], v[186:189]
    ds_read_b128 v[126:129], v9 offset:0
    v_mfma_f32_16x16x32_bf16 v[186:189], a[56:59], a[100:103], v[186:189]
    v_mfma_f32_16x16x32_bf16 v[206:209], a[56:59], a[104:107], v[206:209]
    buffer_load_dwordx4 a[228:231], v5, s[8:11], s44 offen sc1
    v_mfma_f32_16x16x32_bf16 v[206:209], a[76:79], a[120:123], v[206:209]
    ds_read_b128 v[130:133], v9 offset:1024
    v_mfma_f32_16x16x32_bf16 v[226:229], a[76:79], a[124:127], v[226:229]
    v_mfma_f32_16x16x32_bf16 v[226:229], a[56:59], a[108:111], v[226:229]
    ds_read_b128 v[134:137], v9 offset:2048
    v_mfma_f32_16x16x32_bf16 v[170:173], a[60:63], a[96:99], v[170:173]
    buffer_load_dwordx4 a[232:235], v6, s[8:11], s44 offen sc1
    v_mfma_f32_16x16x32_bf16 v[170:173], a[80:83], a[112:115], v[170:173]
    v_mfma_f32_16x16x32_bf16 v[190:193], a[80:83], a[116:119], v[190:193]
    ds_read_b128 v[138:141], v9 offset:3072
    v_mfma_f32_16x16x32_bf16 v[190:193], a[60:63], a[100:103], v[190:193]
    v_mfma_f32_16x16x32_bf16 v[210:213], a[60:63], a[104:107], v[210:213]
    buffer_load_dwordx4 a[236:239], v7, s[8:11], s44 offen sc1
    v_mfma_f32_16x16x32_bf16 v[210:213], a[80:83], a[120:123], v[210:213]
    ds_read_b128 v[142:145], v9 offset:4096
    v_mfma_f32_16x16x32_bf16 v[230:233], a[80:83], a[124:127], v[230:233]
    v_mfma_f32_16x16x32_bf16 v[230:233], a[60:63], a[108:111], v[230:233]
    ds_read_b128 v[146:149], v9 offset:5120
    v_mfma_f32_16x16x32_bf16 v[174:177], a[64:67], a[96:99], v[174:177]
    s_add_u32 s44, s31, 147456
    buffer_load_dwordx4 a[240:243], v4, s[8:11], s44 offen sc1
    v_mfma_f32_16x16x32_bf16 v[174:177], a[84:87], a[112:115], v[174:177]
    v_mfma_f32_16x16x32_bf16 v[194:197], a[84:87], a[116:119], v[194:197]
    ds_read_b128 v[150:153], v9 offset:6144
    v_mfma_f32_16x16x32_bf16 v[194:197], a[64:67], a[100:103], v[194:197]
    buffer_load_dwordx4 a[244:247], v5, s[8:11], s44 offen sc1
    v_mfma_f32_16x16x32_bf16 v[214:217], a[64:67], a[104:107], v[214:217]
    v_mfma_f32_16x16x32_bf16 v[214:217], a[84:87], a[120:123], v[214:217]
    ds_read_b128 v[154:157], v9 offset:7168
    v_mfma_f32_16x16x32_bf16 v[234:237], a[84:87], a[124:127], v[234:237]
    v_mfma_f32_16x16x32_bf16 v[234:237], a[64:67], a[108:111], v[234:237]
    buffer_load_dwordx4 a[248:251], v6, s[8:11], s44 offen sc1
    v_mfma_f32_16x16x32_bf16 v[178:181], a[68:71], a[96:99], v[178:181]
    ds_read_b128 v[158:161], v9 offset:8192
    v_mfma_f32_16x16x32_bf16 v[178:181], a[88:91], a[112:115], v[178:181]
    v_mfma_f32_16x16x32_bf16 v[198:201], a[88:91], a[116:119], v[198:201]
    ds_read_b128 v[162:165], v9 offset:9216
    v_mfma_f32_16x16x32_bf16 v[198:201], a[68:71], a[100:103], v[198:201]
    buffer_load_dwordx4 a[252:255], v7, s[8:11], s44 offen sc1
    v_mfma_f32_16x16x32_bf16 v[218:221], a[68:71], a[104:107], v[218:221]
    v_mfma_f32_16x16x32_bf16 v[218:221], a[88:91], a[120:123], v[218:221]
    v_mfma_f32_16x16x32_bf16 v[238:241], a[88:91], a[124:127], v[238:241]
    v_mfma_f32_16x16x32_bf16 v[238:241], a[68:71], a[108:111], v[238:241]
    v_mfma_f32_16x16x32_bf16 v[182:185], a[72:75], a[96:99], v[182:185]
    v_mfma_f32_16x16x32_bf16 v[182:185], a[92:95], a[112:115], v[182:185]
    v_mfma_f32_16x16x32_bf16 v[202:205], a[92:95], a[116:119], v[202:205]
    v_mfma_f32_16x16x32_bf16 v[202:205], a[72:75], a[100:103], v[202:205]
    v_mfma_f32_16x16x32_bf16 v[222:225], a[72:75], a[104:107], v[222:225]
    v_mfma_f32_16x16x32_bf16 v[222:225], a[92:95], a[120:123], v[222:225]
    v_mfma_f32_16x16x32_bf16 v[242:245], a[92:95], a[124:127], v[242:245]
    v_mfma_f32_16x16x32_bf16 v[242:245], a[72:75], a[108:111], v[242:245]
    s_waitcnt vmcnt(8) lgkmcnt(0)
    v_mfma_f32_16x16x32_bf16 v[166:169], v[126:129], a[192:195], v[166:169]
    v_max3_u32 v1, v20, v21, v246
    v_max3_u32 v1, v1, v247, v248
    v_max3_u32 v1, v1, v249, v252
    v_max3_u32 v1, v1, v253, v254
    v_max_u32 v1, v1, v255
    v_cmp_eq_u32 vcc, -1, v1
    s_and_b64 vcc, vcc, exec
    s_cbranch_scc1 L_spin_upd
L_back_upd:
    v_mfma_f32_16x16x32_bf16 v[166:169], v[146:149], a[208:211], v[166:169]
    s_add_u32 s44, s31, 163840
    buffer_load_dwordx4 a[96:99], v4, s[8:11], s44 offen sc1
    v_mfma_f32_16x16x32_bf16 v[186:189], v[146:149], a[212:215], v[186:189]
    v_mfma_f32_16x16x32_bf16 v[186:189], v[126:129], a[196:199], v[186:189]
    v_mfma_f32_16x16x32_bf16 v[206:209], v[126:129], a[200:203], v[206:209]
    buffer_load_dwordx4 a[100:103], v5, s[8:11], s44 offen sc1
    v_mfma_f32_16x16x32_bf16 v[206:209], v[146:149], a[216:219], v[206:209]
    v_mfma_f32_16x16x32_bf16 v[226:229], v[146:149], a[220:223], v[226:229]
    v_mfma_f32_16x16x32_bf16 v[226:229], v[126:129], a[204:207], v[226:229]
    v_mfma_f32_16x16x32_bf16 v[170:173], v[130:133], a[192:195], v[170:173]
    buffer_load_dwordx4 a[104:107], v6, s[8:11], s44 offen sc1
    v_mfma_f32_16x16x32_bf16 v[170:173], v[150:153], a[208:211], v[170:173]
    v_mfma_f32_16x16x32_bf16 v[190:193], v[150:153], a[212:215], v[190:193]
    v_mfma_f32_16x16x32_bf16 v[190:193], v[130:133], a[196:199], v[190:193]
    v_mfma_f32_16x16x32_bf16 v[210:213], v[130:133], a[200:203], v[210:213]
    buffer_load_dwordx4 a[108:111], v7, s[8:11], s44 offen sc1
    v_mfma_f32_16x16x32_bf16 v[210:213], v[150:153], a[216:219], v[210:213]
    v_mfma_f32_16x16x32_bf16 v[230:233], v[150:153], a[220:223], v[230:233]
    v_mfma_f32_16x16x32_bf16 v[230:233], v[130:133], a[204:207], v[230:233]
    v_mfma_f32_16x16x32_bf16 v[174:177], v[134:137], a[192:195], v[174:177]
    s_add_u32 s44, s31, 180224
    buffer_load_dwordx4 a[112:115], v4, s[8:11], s44 offen sc1
    v_mfma_f32_16x16x32_bf16 v[174:177], v[154:157], a[208:211], v[174:177]
    v_mfma_f32_16x16x32_bf16 v[194:197], v[154:157], a[212:215], v[194:197]
    v_mfma_f32_16x16x32_bf16 v[194:197], v[134:137], a[196:199], v[194:197]
    buffer_load_dwordx4 a[116:119], v5, s[8:11], s44 offen sc1
    v_mfma_f32_16x16x32_bf16 v[214:217], v[134:137], a[200:203], v[214:217]
    v_mfma_f32_16x16x32_bf16 v[214:217], v[154:157], a[216:219], v[214:217]
    v_mfma_f32_16x16x32_bf16 v[234:237], v[154:157], a[220:223], v[234:237]
    v_mfma_f32_16x16x32_bf16 v[234:237], v[134:137], a[204:207], v[234:237]
    buffer_load_dwordx4 a[120:123], v6, s[8:11], s44 offen sc1
    v_mfma_f32_16x16x32_bf16 v[178:181], v[138:141], a[192:195], v[178:181]
    v_mfma_f32_16x16x32_bf16 v[178:181], v[158:161], a[208:211], v[178:181]
    v_mfma_f32_16x16x32_bf16 v[198:201], v[158:161], a[212:215], v[198:201]
    v_mfma_f32_16x16x32_bf16 v[198:201], v[138:141], a[196:199], v[198:201]
    buffer_load_dwordx4 a[124:127], v7, s[8:11], s44 offen sc1
    v_mfma_f32_16x16x32_bf16 v[218:221], v[138:141], a[200:203], v[218:221]
    v_mfma_f32_16x16x32_bf16 v[218:221], v[158:161], a[216:219], v[218:221]
    v_mfma_f32_16x16x32_bf16 v[238:241], v[158:161], a[220:223], v[238:241]
    v_mfma_f32_16x16x32_bf16 v[238:241], v[138:141], a[204:207], v[238:241]
    v_mfma_f32_16x16x32_bf16 v[182:185], v[142:145], a[192:195], v[182:185]
    v_mfma_f32_16x16x32_bf16 v[182:185], v[162:165], a[208:211], v[182:185]
    v_mfma_f32_16x16x32_bf16 v[202:205], v[162:165], a[212:215], v[202:205]
    v_mfma_f32_16x16x32_bf16 v[202:205], v[142:145], a[196:199], v[202:205]
    v_mfma_f32_16x16x32_bf16 v[222:225], v[142:145], a[200:203], v[222:225]
    v_mfma_f32_16x16x32_bf16 v[222:225], v[162:165], a[216:219], v[222:225]
    v_mfma_f32_16x16x32_bf16 v[242:245], v[162:165], a[220:223], v[242:245]
    s_sub_u32 s40, s5, 1
    s_and_b32 s40, s40, 3
    s_mul_i32 s40, s40, 10240
    s_add_u32 s40, s40, 122880
    v_lshl_add_u32 v5, v19, 4, s40
    s_sub_u32 s40, s5, 2
    s_and_b32 s40, s40, 3
    s_mul_i32 s40, s40, 10240
    s_add_u32 s40, s40, 122880
    v_lshl_add_u32 v6, v19, 4, s40
    s_sub_u32 s40, s5, 3
    s_and_b32 s40, s40, 3
    s_mul_i32 s40, s40, 10240
    s_add_u32 s40, s40, 81920
    v_lshl_add_u32 v7, v19, 4, s40
    buffer_load_dword v1, off, s[76:79], s37 sc1
    v_mfma_f32_16x16x32_bf16 v[242:245], v[142:145], a[204:207], v[242:245]
    s_waitcnt vmcnt(9)
    v_mfma_f32_16x16x32_bf16 v[166:169], v[46:49], a[224:227], v[166:169]
    v_mfma_f32_16x16x32_bf16 v[166:169], v[66:69], a[240:243], v[166:169]
    v_lshlrev_b32 v126, 16, v36
    v_and_b32 v127, 0xffff0000, v36
    v_lshlrev_b32 v146, 16, v20
    v_and_b32 v147, 0xffff0000, v20
    v_mfma_f32_16x16x32_bf16 v[186:189], v[66:69], a[244:247], v[186:189]
    v_lshlrev_b32 v128, 16, v37
    v_and_b32 v129, 0xffff0000, v37
    v_lshlrev_b32 v148, 16, v21
    v_and_b32 v149, 0xffff0000, v21
    v_lshlrev_b32 v130, 16, v38
    v_mfma_f32_16x16x32_bf16 v[186:189], v[46:49], a[228:231], v[186:189]
    v_and_b32 v131, 0xffff0000, v38
    v_lshlrev_b32 v150, 16, v246
    v_and_b32 v151, 0xffff0000, v246
    v_lshlrev_b32 v132, 16, v39
    v_mfma_f32_16x16x32_bf16 v[206:209], v[46:49], a[232:235], v[206:209]
    v_and_b32 v133, 0xffff0000, v39
    v_lshlrev_b32 v152, 16, v247
    v_and_b32 v153, 0xffff0000, v247
    v_lshlrev_b32 v134, 16, v40
    v_and_b32 v135, 0xffff0000, v40
    v_mfma_f32_16x16x32_bf16 v[206:209], v[66:69], a[248:251], v[206:209]
    v_lshlrev_b32 v154, 16, v248
    v_and_b32 v155, 0xffff0000, v248
    v_lshlrev_b32 v136, 16, v41
    v_and_b32 v137, 0xffff0000, v41
    v_lshlrev_b32 v156, 16, v249
    v_mfma_f32_16x16x32_bf16 v[226:229], v[66:69], a[252:255], v[226:229]
    v_and_b32 v157, 0xffff0000, v249
    v_lshlrev_b32 v138, 16, v42
    v_and_b32 v139, 0xffff0000, v42
    v_lshlrev_b32 v158, 16, v252
    v_mfma_f32_16x16x32_bf16 v[226:229], v[46:49], a[236:239], v[226:229]
    v_and_b32 v159, 0xffff0000, v252
    v_lshlrev_b32 v140, 16, v43
    v_and_b32 v141, 0xffff0000, v43
    v_lshlrev_b32 v160, 16, v253
    v_and_b32 v161, 0xffff0000, v253
    v_mfma_f32_16x16x32_bf16 v[170:173], v[50:53], a[224:227], v[170:173]
    v_lshlrev_b32 v142, 16, v44
    v_and_b32 v143, 0xffff0000, v44
    v_lshlrev_b32 v162, 16, v254
    v_and_b32 v163, 0xffff0000, v254
    v_mfma_f32_16x16x32_bf16 v[170:173], v[70:73], a[240:243], v[170:173]
    v_lshlrev_b32 v144, 16, v45
    v_and_b32 v145, 0xffff0000, v45
    v_lshlrev_b32 v164, 16, v255
    v_and_b32 v165, 0xffff0000, v255
    v_add_f32 v126, v126, v146
    v_mfma_f32_16x16x32_bf16 v[190:193], v[70:73], a[244:247], v[190:193]
    v_add_f32 v127, v127, v147
    v_add_f32 v128, v128, v148
    v_add_f32 v129, v129, v149
    v_add_f32 v130, v130, v150
    v_add_f32 v131, v131, v151
    v_mfma_f32_16x16x32_bf16 v[190:193], v[50:53], a[228:231], v[190:193]
    v_add_f32 v132, v132, v152
    v_add_f32 v133, v133, v153
    v_add_f32 v134, v134, v154
    v_add_f32 v135, v135, v155
    v_mfma_f32_16x16x32_bf16 v[210:213], v[50:53], a[232:235], v[210:213]
    v_add_f32 v136, v136, v156
    v_add_f32 v137, v137, v157
    v_add_f32 v138, v138, v158
    v_add_f32 v139, v139, v159
    v_add_f32 v140, v140, v160
    v_mfma_f32_16x16x32_bf16 v[210:213], v[70:73], a[248:251], v[210:213]
    v_add_f32 v141, v141, v161
    v_add_f32 v142, v142, v162
    v_add_f32 v143, v143, v163
    v_add_f32 v144, v144, v164
    v_add_f32 v145, v145, v165
    v_mfma_f32_16x16x32_bf16 v[230:233], v[70:73], a[252:255], v[230:233]
    v_cvt_pk_bf16_f32 v146, v126, v127
    v_cvt_pk_bf16_f32 v147, v128, v129
    v_cvt_pk_bf16_f32 v148, v130, v131
    v_cvt_pk_bf16_f32 v149, v132, v133
    v_mfma_f32_16x16x32_bf16 v[230:233], v[50:53], a[236:239], v[230:233]
    v_cvt_pk_bf16_f32 v150, v134, v135
    v_cvt_pk_bf16_f32 v151, v136, v137
    v_cvt_pk_bf16_f32 v152, v138, v139
    v_cvt_pk_bf16_f32 v153, v140, v141
    v_cvt_pk_bf16_f32 v154, v142, v143
    v_mfma_f32_16x16x32_bf16 v[174:177], v[54:57], a[224:227], v[174:177]
    v_cvt_pk_bf16_f32 v155, v144, v145
    v_lshlrev_b32 v126, 16, v146
    v_and_b32 v127, 0xffff0000, v146
    v_lshlrev_b32 v128, 16, v147
    v_mfma_f32_16x16x32_bf16 v[174:177], v[74:77], a[240:243], v[174:177]
    v_and_b32 v129, 0xffff0000, v147
    v_lshlrev_b32 v130, 16, v148
    v_and_b32 v131, 0xffff0000, v148
    v_lshlrev_b32 v132, 16, v149
    v_and_b32 v133, 0xffff0000, v149
    v_mfma_f32_16x16x32_bf16 v[194:197], v[74:77], a[244:247], v[194:197]
    v_lshlrev_b32 v134, 16, v150
    v_and_b32 v135, 0xffff0000, v150
    v_lshlrev_b32 v136, 16, v151
    v_and_b32 v137, 0xffff0000, v151
    v_lshlrev_b32 v138, 16, v152
    v_mfma_f32_16x16x32_bf16 v[194:197], v[54:57], a[228:231], v[194:197]
    v_and_b32 v139, 0xffff0000, v152
    v_lshlrev_b32 v140, 16, v153
    v_and_b32 v141, 0xffff0000, v153
    v_lshlrev_b32 v142, 16, v154
    v_mfma_f32_16x16x32_bf16 v[214:217], v[54:57], a[232:235], v[214:217]
    v_and_b32 v143, 0xffff0000, v154
    v_lshlrev_b32 v144, 16, v155
    v_and_b32 v145, 0xffff0000, v155
    v_mul_f32 v146, 0xbfb8aa3b, v126
    v_mul_f32 v147, 0xbfb8aa3b, v127
    v_mfma_f32_16x16x32_bf16 v[214:217], v[74:77], a[248:251], v[214:217]
    v_mul_f32 v148, 0xbfb8aa3b, v128
    v_mul_f32 v149, 0xbfb8aa3b, v129
    v_mul_f32 v150, 0xbfb8aa3b, v130
    v_mul_f32 v151, 0xbfb8aa3b, v131
    v_mfma_f32_16x16x32_bf16 v[234:237], v[74:77], a[252:255], v[234:237]
    v_mul_f32 v152, 0xbfb8aa3b, v132
    v_mul_f32 v153, 0xbfb8aa3b, v133
    v_mul_f32 v154, 0xbfb8aa3b, v134
    v_mul_f32 v155, 0xbfb8aa3b, v135
    v_mul_f32 v156, 0xbfb8aa3b, v136
    v_mfma_f32_16x16x32_bf16 v[234:237], v[54:57], a[236:239], v[234:237]
    v_mul_f32 v157, 0xbfb8aa3b, v137
    v_mul_f32 v158, 0xbfb8aa3b, v138
    v_mul_f32 v159, 0xbfb8aa3b, v139
    v_mul_f32 v160, 0xbfb8aa3b, v140
    v_mul_f32 v161, 0xbfb8aa3b, v141
    v_mfma_f32_16x16x32_bf16 v[178:181], v[58:61], a[224:227], v[178:181]
    v_mul_f32 v162, 0xbfb8aa3b, v142
    v_mul_f32 v163, 0xbfb8aa3b, v143
    v_mul_f32 v164, 0xbfb8aa3b, v144
    v_mul_f32 v165, 0xbfb8aa3b, v145
    v_mfma_f32_16x16x32_bf16 v[178:181], v[78:81], a[240:243], v[178:181]
    v_exp_f32 v146, v146
    v_exp_f32 v147, v147
    v_exp_f32 v148, v148
    v_exp_f32 v149, v149
    v_exp_f32 v150, v150
    v_mfma_f32_16x16x32_bf16 v[198:201], v[78:81], a[244:247], v[198:201]
    v_exp_f32 v151, v151
    v_exp_f32 v152, v152
    v_exp_f32 v153, v153
    v_exp_f32 v154, v154
    v_exp_f32 v155, v155
    v_mfma_f32_16x16x32_bf16 v[198:201], v[58:61], a[228:231], v[198:201]
    v_exp_f32 v156, v156
    v_exp_f32 v157, v157
    v_exp_f32 v158, v158
    v_exp_f32 v159, v159
    v_mfma_f32_16x16x32_bf16 v[218:221], v[58:61], a[232:235], v[218:221]
    v_exp_f32 v160, v160
    v_exp_f32 v161, v161
    v_exp_f32 v162, v162
    v_exp_f32 v163, v163
    v_exp_f32 v164, v164
    v_mfma_f32_16x16x32_bf16 v[218:221], v[78:81], a[248:251], v[218:221]
    v_exp_f32 v165, v165
    v_add_f32 v146, 1.0, v146
    v_add_f32 v147, 1.0, v147
    v_add_f32 v148, 1.0, v148
    v_mfma_f32_16x16x32_bf16 v[238:241], v[78:81], a[252:255], v[238:241]
    v_add_f32 v149, 1.0, v149
    v_add_f32 v150, 1.0, v150
    v_add_f32 v151, 1.0, v151
    v_add_f32 v152, 1.0, v152
    v_add_f32 v153, 1.0, v153
    v_mfma_f32_16x16x32_bf16 v[238:241], v[58:61], a[236:239], v[238:241]
    v_add_f32 v154, 1.0, v154
    v_add_f32 v155, 1.0, v155
    v_add_f32 v156, 1.0, v156
    v_add_f32 v157, 1.0, v157
    v_add_f32 v158, 1.0, v158
    v_mfma_f32_16x16x32_bf16 v[182:185], v[62:65], a[224:227], v[182:185]
    v_add_f32 v159, 1.0, v159
    v_add_f32 v160, 1.0, v160
    v_add_f32 v161, 1.0, v161
    v_add_f32 v162, 1.0, v162
    v_mfma_f32_16x16x32_bf16 v[182:185], v[82:85], a[240:243], v[182:185]
    v_add_f32 v163, 1.0, v163
    v_add_f32 v164, 1.0, v164
    v_add_f32 v165, 1.0, v165
    v_rcp_f32 v146, v146
    v_rcp_f32 v147, v147
    v_mfma_f32_16x16x32_bf16 v[202:205], v[82:85], a[244:247], v[202:205]
    v_rcp_f32 v148, v148
    v_rcp_f32 v149, v149
    v_rcp_f32 v150, v150
    v_rcp_f32 v151, v151
    v_mfma_f32_16x16x32_bf16 v[202:205], v[62:65], a[228:231], v[202:205]
    v_rcp_f32 v152, v152
    v_rcp_f32 v153, v153
    v_rcp_f32 v154, v154
    v_rcp_f32 v155, v155
    v_rcp_f32 v156, v156
    v_mfma_f32_16x16x32_bf16 v[222:225], v[62:65], a[232:235], v[222:225]
    v_rcp_f32 v157, v157
    v_rcp_f32 v158, v158
    v_rcp_f32 v159, v159
    v_rcp_f32 v160, v160
    v_rcp_f32 v161, v161
    v_mfma_f32_16x16x32_bf16 v[222:225], v[82:85], a[248:251], v[222:225]
    v_rcp_f32 v162, v162
    v_rcp_f32 v163, v163
    v_rcp_f32 v164, v164
    v_rcp_f32 v165, v165
    v_mfma_f32_16x16x32_bf16 v[242:245], v[82:85], a[252:255], v[242:245]
    v_mul_f32 v126, v126, v146
    v_mul_f32 v127, v127, v147
    v_mul_f32 v128, v128, v148
    v_mul_f32 v129, v129, v149
    v_mul_f32 v130, v130, v150
    v_mfma_f32_16x16x32_bf16 v[242:245], v[62:65], a[236:239], v[242:245]
    v_mul_f32 v131, v131, v151
    v_mul_f32 v132, v132, v152
    v_mul_f32 v133, v133, v153
    v_mul_f32 v134, v134, v154
    v_mul_f32 v135, v135, v155
    s_waitcnt vmcnt(1)
    v_mfma_f32_16x16x32_bf16 v[186:189], v[86:89], a[100:103], v[186:189]
    s_waitcnt vmcnt(0)
    v_cmp_ne_u32 vcc, 3, v1
    s_and_b64 vcc, vcc, exec
    s_cbranch_scc1 L_spin_half
L_back_half:
    s_xor_b32 s40, s2, 8
    s_sub_u32 s40, s40, s2
    s_mul_i32 s40, s40, 20480
    v_add_u32 v18, s40, v18
    s_mov_b32 s41, 4096
    buffer_load_dwordx4 v[46:49], v18, s[76:79], 0 offen offset:0 sc1
    buffer_load_dwordx4 v[50:53], v18, s[76:79], 0 offen offset:1024 sc1
    buffer_load_dwordx4 v[54:57], v18, s[76:79], 0 offen offset:2048 sc1
    buffer_load_dwordx4 v[58:61], v18, s[76:79], 0 offen offset:3072 sc1
    buffer_load_dwordx4 v[62:65], v18, s[76:79], s41 offen offset:0 sc1
    v_mfma_f32_16x16x32_bf16 v[186:189], v[106:109], a[116:119], v[186:189]
    v_mul_f32 v136, v136, v156
    v_mfma_f32_16x16x32_bf16 v[190:193], v[110:113], a[116:119], v[190:193]
    v_mul_f32 v137, v137, v157
    v_mul_f32 v138, v138, v158
    v_mfma_f32_16x16x32_bf16 v[190:193], v[90:93], a[100:103], v[190:193]
    v_mul_f32 v139, v139, v159
    v_mfma_f32_16x16x32_bf16 v[194:197], v[94:97], a[100:103], v[194:197]
    v_mul_f32 v140, v140, v160
    v_mul_f32 v141, v141, v161
    v_mfma_f32_16x16x32_bf16 v[194:197], v[114:117], a[116:119], v[194:197]
    v_mul_f32 v142, v142, v162
    v_mfma_f32_16x16x32_bf16 v[198:201], v[118:121], a[116:119], v[198:201]
    v_mul_f32 v143, v143, v163
    v_mul_f32 v144, v144, v164
    v_mfma_f32_16x16x32_bf16 v[198:201], v[98:101], a[100:103], v[198:201]
    v_mul_f32 v145, v145, v165
    v_mfma_f32_16x16x32_bf16 v[202:205], v[102:105], a[100:103], v[202:205]
    v_cvt_pk_bf16_f32 v146, v126, v127
    v_cvt_pk_bf16_f32 v147, v128, v129
    v_mfma_f32_16x16x32_bf16 v[202:205], v[122:125], a[116:119], v[202:205]
    ds_write_b128 v8, v[186:189] offset:0
    v_cvt_pk_bf16_f32 v148, v130, v131
    v_mfma_f32_16x16x32_bf16 v[206:209], v[106:109], a[120:123], v[206:209]
    v_cvt_pk_bf16_f32 v149, v132, v133
    v_cvt_pk_bf16_f32 v150, v134, v135
    v_mfma_f32_16x16x32_bf16 v[206:209], v[86:89], a[104:107], v[206:209]
    ds_write_b128 v8, v[190:193] offset:1024
    v_cvt_pk_bf16_f32 v151, v136, v137
    v_mfma_f32_16x16x32_bf16 v[210:213], v[90:93], a[104:107], v[210:213]
    v_cvt_pk_bf16_f32 v152, v138, v139
    v_cvt_pk_bf16_f32 v153, v140, v141
    v_mfma_f32_16x16x32_bf16 v[210:213], v[110:113], a[120:123], v[210:213]
    ds_write_b128 v8, v[194:197] offset:2048
    v_cvt_pk_bf16_f32 v154, v142, v143
    v_cvt_pk_bf16_f32 v155, v144, v145
    v_mfma_f32_16x16x32_bf16 v[214:217], v[114:117], a[120:123], v[214:217]
    v_lshlrev_b32 v126, 16, v146
    v_mfma_f32_16x16x32_bf16 v[214:217], v[94:97], a[104:107], v[214:217]
    ds_write_b128 v8, v[198:201] offset:3072
    v_and_b32 v127, 0xffff0000, v146
    v_lshlrev_b32 v128, 16, v147
    v_mfma_f32_16x16x32_bf16 v[218:221], v[98:101], a[104:107], v[218:221]
    v_and_b32 v129, 0xffff0000, v147
    v_mfma_f32_16x16x32_bf16 v[218:221], v[118:121], a[120:123], v[218:221]
    ds_write_b128 v8, v[202:205] offset:4096
    v_lshlrev_b32 v130, 16, v148
    v_and_b32 v131, 0xffff0000, v148
    v_mfma_f32_16x16x32_bf16 v[222:225], v[122:125], a[120:123], v[222:225]
    v_lshlrev_b32 v132, 16, v149
    v_mfma_f32_16x16x32_bf16 v[222:225], v[102:105], a[104:107], v[222:225]
    ds_write_b128 v8, v[206:209] offset:5120
    v_and_b32 v133, 0xffff0000, v149
    v_lshlrev_b32 v134, 16, v150
    v_mfma_f32_16x16x32_bf16 v[226:229], v[86:89], a[108:111], v[226:229]
    v_and_b32 v135, 0xffff0000, v150
    v_mfma_f32_16x16x32_bf16 v[226:229], v[106:109], a[124:127], v[226:229]
    ds_write_b128 v8, v[210:213] offset:6144
    v_lshlrev_b32 v136, 16, v151
    v_and_b32 v137, 0xffff0000, v151
    v_mfma_f32_16x16x32_bf16 v[230:233], v[110:113], a[124:127], v[230:233]
    v_lshlrev_b32 v138, 16, v152
    v_mfma_f32_16x16x32_bf16 v[230:233], v[90:93], a[108:111], v[230:233]
    ds_write_b128 v8, v[214:217] offset:7168
    v_and_b32 v139, 0xffff0000, v152
    v_lshlrev_b32 v140, 16, v153
    v_mfma_f32_16x16x32_bf16 v[234:237], v[94:97], a[108:111], v[234:237]
    v_and_b32 v141, 0xffff0000, v153
    v_mfma_f32_16x16x32_bf16 v[234:237], v[114:117], a[124:127], v[234:237]
    ds_write_b128 v8, v[218:221] offset:8192
    v_lshlrev_b32 v142, 16, v154
    v_and_b32 v143, 0xffff0000, v154
    v_mfma_f32_16x16x32_bf16 v[238:241], v[118:121], a[124:127], v[238:241]
    v_lshlrev_b32 v144, 16, v155
    v_and_b32 v145, 0xffff0000, v155
    v_mfma_f32_16x16x32_bf16 v[238:241], v[98:101], a[108:111], v[238:241]
    ds_write_b128 v8, v[222:225] offset:9216
    v_lshlrev_b32 v146, 16, v22
    v_mfma_f32_16x16x32_bf16 v[242:245], v[102:105], a[108:111], v[242:245]
    v_and_b32 v147, 0xffff0000, v22
    v_lshlrev_b32 v148, 16, v23
    v_mfma_f32_16x16x32_bf16 v[242:245], v[122:125], a[124:127], v[242:245]
    ds_write_b128 v9, v[226:229] offset:0
    v_and_b32 v149, 0xffff0000, v23
    v_mfma_f32_16x16x32_bf16 v[166:169], v[106:109], a[112:115], v[166:169]
    v_lshlrev_b32 v150, 16, v24
    v_and_b32 v151, 0xffff0000, v24
    v_mfma_f32_16x16x32_bf16 v[166:169], v[86:89], a[96:99], v[166:169]
    ds_write_b128 v9, v[230:233] offset:1024
    v_lshlrev_b32 v152, 16, v25
    v_mfma_f32_16x16x32_bf16 v[170:173], v[90:93], a[96:99], v[170:173]
    v_and_b32 v153, 0xffff0000, v25
    v_lshlrev_b32 v154, 16, v26
    v_mfma_f32_16x16x32_bf16 v[170:173], v[110:113], a[112:115], v[170:173]
    ds_write_b128 v9, v[234:237] offset:2048
    v_and_b32 v155, 0xffff0000, v26
    v_mfma_f32_16x16x32_bf16 v[174:177], v[114:117], a[112:115], v[174:177]
    v_lshlrev_b32 v156, 16, v27
    v_and_b32 v157, 0xffff0000, v27
    v_mfma_f32_16x16x32_bf16 v[174:177], v[94:97], a[96:99], v[174:177]
    ds_write_b128 v9, v[238:241] offset:3072
    v_lshlrev_b32 v158, 16, v28
    v_mfma_f32_16x16x32_bf16 v[178:181], v[98:101], a[96:99], v[178:181]
    v_and_b32 v159, 0xffff0000, v28
    v_lshlrev_b32 v160, 16, v29
    v_mfma_f32_16x16x32_bf16 v[178:181], v[118:121], a[112:115], v[178:181]
    ds_write_b128 v9, v[242:245] offset:4096
    v_and_b32 v161, 0xffff0000, v29
    v_mfma_f32_16x16x32_bf16 v[182:185], v[122:125], a[112:115], v[182:185]
    v_lshlrev_b32 v162, 16, v30
    v_and_b32 v163, 0xffff0000, v30
    v_mfma_f32_16x16x32_bf16 v[182:185], v[102:105], a[96:99], v[182:185]
    v_lshlrev_b32 v164, 16, v31
    v_and_b32 v165, 0xffff0000, v31
    s_waitcnt lgkmcnt(0)
    s_barrier
    ds_read_b128 v[186:189], v5 offset:0
    ds_read_b128 v[190:193], v5 offset:1024
    ds_read_b128 v[194:197], v5 offset:2048
    ds_read_b128 v[198:201], v5 offset:3072
    ds_read_b128 v[202:205], v5 offset:4096
    ds_read_b128 v[206:209], v6 offset:5120
    ds_read_b128 v[210:213], v6 offset:6144
    ds_read_b128 v[214:217], v6 offset:7168
    ds_read_b128 v[218:221], v6 offset:8192
    ds_read_b128 v[222:225], v6 offset:9216
    ds_read_b128 v[226:229], v7 offset:0
    ds_read_b128 v[230:233], v7 offset:1024
    ds_read_b128 v[234:237], v7 offset:2048
    ds_read_b128 v[238:241], v7 offset:3072
    ds_read_b128 v[242:245], v7 offset:4096
    s_waitcnt lgkmcnt(10)
    v_pk_add_f32 v[166:167], v[166:167], v[186:187]
    v_pk_add_f32 v[168:169], v[168:169], v[188:189]
    v_pk_add_f32 v[170:171], v[170:171], v[190:191]
    v_pk_add_f32 v[172:173], v[172:173], v[192:193]
    v_pk_add_f32 v[174:175], v[174:175], v[194:195]
    v_pk_add_f32 v[176:177], v[176:177], v[196:197]
    v_pk_add_f32 v[178:179], v[178:179], v[198:199]
    v_pk_add_f32 v[180:181], v[180:181], v[200:201]
    v_pk_add_f32 v[182:183], v[182:183], v[202:203]
    v_pk_add_f32 v[184:185], v[184:185], v[204:205]
    s_waitcnt lgkmcnt(5)
    v_pk_add_f32 v[166:167], v[166:167], v[206:207]
    v_pk_add_f32 v[168:169], v[168:169], v[208:209]
    v_pk_add_f32 v[170:171], v[170:171], v[210:211]
    v_pk_add_f32 v[172:173], v[172:173], v[212:213]
    v_pk_add_f32 v[174:175], v[174:175], v[214:215]
    v_pk_add_f32 v[176:177], v[176:177], v[216:217]
    v_pk_add_f32 v[178:179], v[178:179], v[218:219]
    v_pk_add_f32 v[180:181], v[180:181], v[220:221]
    v_pk_add_f32 v[182:183], v[182:183], v[222:223]
    v_pk_add_f32 v[184:185], v[184:185], v[224:225]
    s_waitcnt lgkmcnt(0)
    v_pk_add_f32 v[166:167], v[166:167], v[226:227]
    v_pk_add_f32 v[168:169], v[168:169], v[228:229]
    v_pk_add_f32 v[170:171], v[170:171], v[230:231]
    v_pk_add_f32 v[172:173], v[172:173], v[232:233]
    v_pk_add_f32 v[174:175], v[174:175], v[234:235]
    v_pk_add_f32 v[176:177], v[176:177], v[236:237]
    v_pk_add_f32 v[178:179], v[178:179], v[238:239]
    v_pk_add_f32 v[180:181], v[180:181], v[240:241]
    v_pk_add_f32 v[182:183], v[182:183], v[242:243]
    v_pk_add_f32 v[184:185], v[184:185], v[244:245]
    s_waitcnt vmcnt(0)
    v_pk_add_f32 v[166:167], v[166:167], v[46:47]
    v_pk_add_f32 v[168:169], v[168:169], v[48:49]
    v_pk_add_f32 v[170:171], v[170:171], v[50:51]
    v_pk_add_f32 v[172:173], v[172:173], v[52:53]
    v_pk_add_f32 v[174:175], v[174:175], v[54:55]
    v_pk_add_f32 v[176:177], v[176:177], v[56:57]
    v_pk_add_f32 v[178:179], v[178:179], v[58:59]
    v_pk_add_f32 v[180:181], v[180:181], v[60:61]
    v_pk_add_f32 v[182:183], v[182:183], v[62:63]
    v_pk_add_f32 v[184:185], v[184:185], v[64:65]
    v_cvt_pk_bf16_f32 v66, v166, v167
    v_cvt_pk_bf16_f32 v67, v168, v169
    v_cvt_pk_bf16_f32 v68, v170, v171
    v_cvt_pk_bf16_f32 v69, v172, v173
    v_cvt_pk_bf16_f32 v70, v174, v175
    v_cvt_pk_bf16_f32 v71, v176, v177
    v_cvt_pk_bf16_f32 v72, v178, v179
    v_cvt_pk_bf16_f32 v73, v180, v181
    v_cvt_pk_bf16_f32 v74, v182, v183
    v_cvt_pk_bf16_f32 v75, v184, v185
    v_lshlrev_b32 v166, 16, v66
    v_and_b32 v167, 0xffff0000, v66
    v_lshlrev_b32 v168, 16, v67
    v_and_b32 v169, 0xffff0000, v67
    v_lshlrev_b32 v170, 16, v68
    v_and_b32 v171, 0xffff0000, v68
    v_lshlrev_b32 v172, 16, v69
    v_and_b32 v173, 0xffff0000, v69
    v_lshlrev_b32 v174, 16, v70
    v_and_b32 v175, 0xffff0000, v70
    v_lshlrev_b32 v176, 16, v71
    v_and_b32 v177, 0xffff0000, v71
    v_lshlrev_b32 v178, 16, v72
    v_and_b32 v179, 0xffff0000, v72
    v_lshlrev_b32 v180, 16, v73
    v_and_b32 v181, 0xffff0000, v73
    v_lshlrev_b32 v182, 16, v74
    v_and_b32 v183, 0xffff0000, v74
    v_lshlrev_b32 v184, 16, v75
    v_and_b32 v185, 0xffff0000, v75
    v_pk_mul_f32 v[166:167], v[166:167], v[126:127]
    v_pk_mul_f32 v[168:169], v[168:169], v[128:129]
    v_pk_mul_f32 v[170:171], v[170:171], v[130:131]
    v_pk_mul_f32 v[172:173], v[172:173], v[132:133]
    v_pk_mul_f32 v[174:175], v[174:175], v[134:135]
    v_pk_mul_f32 v[176:177], v[176:177], v[136:137]
    v_pk_mul_f32 v[178:179], v[178:179], v[138:139]
    v_pk_mul_f32 v[180:181], v[180:181], v[140:141]
    v_pk_mul_f32 v[182:183], v[182:183], v[142:143]
    v_pk_mul_f32 v[184:185], v[184:185], v[144:145]
    v_cvt_pk_bf16_f32 v66, v166, v167
    v_cvt_pk_bf16_f32 v67, v168, v169
    v_cvt_pk_bf16_f32 v68, v170, v171
    v_cvt_pk_bf16_f32 v69, v172, v173
    v_cvt_pk_bf16_f32 v70, v174, v175
    v_cvt_pk_bf16_f32 v71, v176, v177
    v_cvt_pk_bf16_f32 v72, v178, v179
    v_cvt_pk_bf16_f32 v73, v180, v181
    v_cvt_pk_bf16_f32 v74, v182, v183
    v_cvt_pk_bf16_f32 v75, v184, v185
    v_lshlrev_b32 v166, 16, v66
    v_and_b32 v167, 0xffff0000, v66
    v_lshlrev_b32 v168, 16, v67
    v_and_b32 v169, 0xffff0000, v67
    v_lshlrev_b32 v170, 16, v68
    v_and_b32 v171, 0xffff0000, v68
    v_lshlrev_b32 v172, 16, v69
    v_and_b32 v173, 0xffff0000, v69
    v_lshlrev_b32 v174, 16, v70
    v_and_b32 v175, 0xffff0000, v70
    v_lshlrev_b32 v176, 16, v71
    v_and_b32 v177, 0xffff0000, v71
    v_lshlrev_b32 v178, 16, v72
    v_and_b32 v179, 0xffff0000, v72
    v_lshlrev_b32 v180, 16, v73
    v_and_b32 v181, 0xffff0000, v73
    v_lshlrev_b32 v182, 16, v74
    v_and_b32 v183, 0xffff0000, v74
    v_lshlrev_b32 v184, 16, v75
    v_and_b32 v185, 0xffff0000, v75
    v_pk_add_f32 v[166:167], v[166:167], v[146:147]
    v_pk_add_f32 v[168:169], v[168:169], v[148:149]
    v_pk_add_f32 v[170:171], v[170:171], v[150:151]
    v_pk_add_f32 v[172:173], v[172:173], v[152:153]
    v_pk_add_f32 v[174:175], v[174:175], v[154:155]
    v_pk_add_f32 v[176:177], v[176:177], v[156:157]
    v_pk_add_f32 v[178:179], v[178:179], v[158:159]
    v_pk_add_f32 v[180:181], v[180:181], v[160:161]
    v_pk_add_f32 v[182:183], v[182:183], v[162:163]
    v_pk_add_f32 v[184:185], v[184:185], v[164:165]
    v_cvt_pk_bf16_f32 v66, v166, v167
    v_cvt_pk_bf16_f32 v67, v168, v169
    buffer_store_dwordx2 v[66:67], v34, s[12:15], 0 offen offset:0
    v_cvt_pk_bf16_f32 v68, v170, v171
    v_cvt_pk_bf16_f32 v69, v172, v173
    buffer_store_dwordx2 v[68:69], v34, s[12:15], 0 offen offset:32
    v_cvt_pk_bf16_f32 v70, v174, v175
    v_cvt_pk_bf16_f32 v71, v176, v177
    buffer_store_dwordx2 v[70:71], v34, s[12:15], 0 offen offset:64
    v_cvt_pk_bf16_f32 v72, v178, v179
    v_cvt_pk_bf16_f32 v73, v180, v181
    buffer_store_dwordx2 v[72:73], v34, s[12:15], 0 offen offset:96
    v_cvt_pk_bf16_f32 v74, v182, v183
    v_cvt_pk_bf16_f32 v75, v184, v185
    buffer_store_dwordx2 v[74:75], v34, s[12:15], 0 offen offset:128
L_end:
    s_endpgm
L_slow:
    s_lshl_b32 s40, s5, 12
    v_subrev_u32 v13, s40, v13
    v_subrev_u32 v14, s40, v14
    v_subrev_u32 v15, s40, v15
    v_subrev_u32 v16, s40, v16
    v_subrev_u32 v17, s40, v17
    v_subrev_u32 v18, s40, v18
    s_and_b32 s40, s5, 1
    s_lshr_b32 s41, s5, 1
    s_mul_i32 s41, s41, 3
    s_add_u32 s40, s40, s41
    s_add_u32 s40, s40, 1
    s_lshl_b32 s34, s40, 13
    s_sub_u32 s40, s34, 98304
    v_add_u32 v1, s40, v1
    v_add_u32 v2, s40, v2
    v_add_u32 v3, s40, v3
    v_add_u32 v4, s40, v4
    v_add_u32 v5, s34, v5
    v_add_u32 v6, s34, v6
    v_add_u32 v7, s34, v7
    v_add_u32 v8, s34, v8
    v_add_u32 v9, s34, v9
    v_add_u32 v10, s34, v10
    v_add_u32 v11, s34, v11
    v_add_u32 v12, s34, v12
    v_mov_b32 v212, 0xff800000
    v_mov_b32 v216, 0
    v_mov_b32 v213, 0xff800000
    v_mov_b32 v217, 0
    v_mov_b32 v214, 0xff800000
    v_mov_b32 v218, 0
    v_mov_b32 v215, 0xff800000
    v_mov_b32 v219, 0
    v_accvgpr_write_b32 a0, 0
    v_accvgpr_write_b32 a1, 0
    v_accvgpr_write_b32 a2, 0
    v_accvgpr_write_b32 a3, 0
    v_accvgpr_write_b32 a4, 0
    v_accvgpr_write_b32 a5, 0
    v_accvgpr_write_b32 a6, 0
    v_accvgpr_write_b32 a7, 0
    v_accvgpr_write_b32 a8, 0
    v_accvgpr_write_b32 a9, 0
    v_accvgpr_write_b32 a10, 0
    v_accvgpr_write_b32 a11, 0
    v_accvgpr_write_b32 a12, 0
    v_accvgpr_write_b32 a13, 0
    v_accvgpr_write_b32 a14, 0
    v_accvgpr_write_b32 a15, 0
    v_accvgpr_write_b32 a16, 0
    v_accvgpr_write_b32 a17, 0
    v_accvgpr_write_b32 a18, 0
    v_accvgpr_write_b32 a19, 0
    v_accvgpr_write_b32 a20, 0
    v_accvgpr_write_b32 a21, 0
    v_accvgpr_write_b32 a22, 0
    v_accvgpr_write_b32 a23, 0
    v_accvgpr_write_b32 a24, 0
    v_accvgpr_write_b32 a25, 0
    v_accvgpr_write_b32 a26, 0
    v_accvgpr_write_b32 a27, 0
    v_accvgpr_write_b32 a28, 0
    v_accvgpr_write_b32 a29, 0
    v_accvgpr_write_b32 a30, 0
    v_accvgpr_write_b32 a31, 0
    v_accvgpr_write_b32 a32, 0
    v_accvgpr_write_b32 a33, 0
    v_accvgpr_write_b32 a34, 0
    v_accvgpr_write_b32 a35, 0
    v_accvgpr_write_b32 a36, 0
    v_accvgpr_write_b32 a37, 0
    v_accvgpr_write_b32 a38, 0
    v_accvgpr_write_b32 a39, 0
    v_accvgpr_write_b32 a40, 0
    v_accvgpr_write_b32 a41, 0
    v_accvgpr_write_b32 a42, 0
    v_accvgpr_write_b32 a43, 0
    v_accvgpr_write_b32 a44, 0
    v_accvgpr_write_b32 a45, 0
    v_accvgpr_write_b32 a46, 0
    v_accvgpr_write_b32 a47, 0
    v_accvgpr_write_b32 a48, 0
    v_accvgpr_write_b32 a49, 0
    v_accvgpr_write_b32 a50, 0
    v_accvgpr_write_b32 a51, 0
    v_accvgpr_write_b32 a52, 0
    v_accvgpr_write_b32 a53, 0
    v_accvgpr_write_b32 a54, 0
    v_accvgpr_write_b32 a55, 0
    v_accvgpr_write_b32 a56, 0
    v_accvgpr_write_b32 a57, 0
    v_accvgpr_write_b32 a58, 0
    v_accvgpr_write_b32 a59, 0
    v_accvgpr_write_b32 a60, 0
    v_accvgpr_write_b32 a61, 0
    v_accvgpr_write_b32 a62, 0
    v_accvgpr_write_b32 a63, 0
    v_accvgpr_write_b32 a64, 0
    v_accvgpr_write_b32 a65, 0
    v_accvgpr_write_b32 a66, 0
    v_accvgpr_write_b32 a67, 0
    v_accvgpr_write_b32 a68, 0
    v_accvgpr_write_b32 a69, 0
    v_accvgpr_write_b32 a70, 0
    v_accvgpr_write_b32 a71, 0
    v_accvgpr_write_b32 a72, 0
    v_accvgpr_write_b32 a73, 0
    v_accvgpr_write_b32 a74, 0
    v_accvgpr_write_b32 a75, 0
    v_accvgpr_write_b32 a76, 0
    v_accvgpr_write_b32 a77, 0
    v_accvgpr_write_b32 a78, 0
    v_accvgpr_write_b32 a79, 0
    v_accvgpr_write_b32 a80, 0
    v_accvgpr_write_b32 a81, 0
    v_accvgpr_write_b32 a82, 0
    v_accvgpr_write_b32 a83, 0
    v_accvgpr_write_b32 a84, 0
    v_accvgpr_write_b32 a85, 0
    v_accvgpr_write_b32 a86, 0
    v_accvgpr_write_b32 a87, 0
    v_accvgpr_write_b32 a88, 0
    v_accvgpr_write_b32 a89, 0
    v_accvgpr_write_b32 a90, 0
    v_accvgpr_write_b32 a91, 0
    v_accvgpr_write_b32 a92, 0
    v_accvgpr_write_b32 a93, 0
    v_accvgpr_write_b32 a94, 0
    v_accvgpr_write_b32 a95, 0
    v_accvgpr_write_b32 a96, 0
    v_accvgpr_write_b32 a97, 0
    v_accvgpr_write_b32 a98, 0
    v_accvgpr_write_b32 a99, 0
    v_accvgpr_write_b32 a100, 0
    v_accvgpr_write_b32 a101, 0
    v_accvgpr_write_b32 a102, 0
    v_accvgpr_write_b32 a103, 0
    v_accvgpr_write_b32 a104, 0
    v_accvgpr_write_b32 a105, 0
    v_accvgpr_write_b32 a106, 0
    v_accvgpr_write_b32 a107, 0
    v_accvgpr_write_b32 a108, 0
    v_accvgpr_write_b32 a109, 0
    v_accvgpr_write_b32 a110, 0
    v_accvgpr_write_b32 a111, 0
    v_accvgpr_write_b32 a112, 0
    v_accvgpr_write_b32 a113, 0
    v_accvgpr_write_b32 a114, 0
    v_accvgpr_write_b32 a115, 0
    v_accvgpr_write_b32 a116, 0
    v_accvgpr_write_b32 a117, 0
    v_accvgpr_write_b32 a118, 0
    v_accvgpr_write_b32 a119, 0
    v_accvgpr_write_b32 a120, 0
    v_accvgpr_write_b32 a121, 0
    v_accvgpr_write_b32 a122, 0
    v_accvgpr_write_b32 a123, 0
    v_accvgpr_write_b32 a124, 0
    v_accvgpr_write_b32 a125, 0
    v_accvgpr_write_b32 a126, 0
    v_accvgpr_write_b32 a127, 0
    s_mov_b32 s28, 0
L_slow_loop:
    s_add_u32 m0, s34, 0
    s_add_u32 s40, s28, 0
    buffer_load_dwordx4 v13, s[8:11], s40 offen offset:0 lds
    buffer_load_dwordx4 v14, s[8:11], s40 offen offset:1024 lds
    buffer_load_dwordx4 v15, s[8:11], s40 offen offset:2048 lds
    buffer_load_dwordx4 v16, s[8:11], s40 offen offset:3072 lds
    s_add_u32 m0, s34, 4096
    s_add_u32 s40, s28, 4096
    buffer_load_dwordx4 v13, s[8:11], s40 offen offset:0 lds
    buffer_load_dwordx4 v14, s[8:11], s40 offen offset:1024 lds
    buffer_load_dwordx4 v15, s[8:11], s40 offen offset:2048 lds
    buffer_load_dwordx4 v16, s[8:11], s40 offen offset:3072 lds
    s_waitcnt vmcnt(0)
    ds_read_b128 v[148:151], v1 offset:0
    ds_read_b128 v[152:155], v2 offset:0
    ds_read_b128 v[156:159], v3 offset:0
    ds_read_b128 v[160:163], v4 offset:0
    ds_read_b128 v[164:167], v1 offset:4096
    ds_read_b128 v[168:171], v2 offset:4096
    ds_read_b128 v[172:175], v3 offset:4096
    ds_read_b128 v[176:179], v4 offset:4096
    s_waitcnt lgkmcnt(0)
    s_add_u32 m0, s34, 0
    s_add_u32 s40, s28, 0
    buffer_load_dwordx4 v17, s[12:15], s40 offen offset:0 lds
    buffer_load_dwordx4 v18, s[12:15], s40 offen offset:1024 lds
    buffer_load_dwordx4 v17, s[12:15], s40 offen offset:2048 lds
    buffer_load_dwordx4 v18, s[12:15], s40 offen offset:3072 lds
    s_add_u32 m0, s34, 4096
    s_add_u32 s40, s28, 4096
    buffer_load_dwordx4 v17, s[12:15], s40 offen offset:0 lds
    buffer_load_dwordx4 v18, s[12:15], s40 offen offset:1024 lds
    buffer_load_dwordx4 v17, s[12:15], s40 offen offset:2048 lds
    buffer_load_dwordx4 v18, s[12:15], s40 offen offset:3072 lds
    s_waitcnt vmcnt(0)
    ds_read_b64_tr_b16 v[196:197], v5 offset:0
    ds_read_b64_tr_b16 v[198:199], v5 offset:4096
    ds_read_b64_tr_b16 v[200:201], v6 offset:0
    ds_read_b64_tr_b16 v[202:203], v6 offset:4096
    ds_read_b64_tr_b16 v[204:205], v7 offset:0
    ds_read_b64_tr_b16 v[206:207], v7 offset:4096
    ds_read_b64_tr_b16 v[208:209], v8 offset:0
    ds_read_b64_tr_b16 v[210:211], v8 offset:4096
    ds_read_b64_tr_b16 v[228:229], v9 offset:0
    ds_read_b64_tr_b16 v[230:231], v9 offset:4096
    ds_read_b64_tr_b16 v[232:233], v10 offset:0
    ds_read_b64_tr_b16 v[234:235], v10 offset:4096
    ds_read_b64_tr_b16 v[236:237], v11 offset:0
    ds_read_b64_tr_b16 v[238:239], v11 offset:4096
    ds_read_b64_tr_b16 v[240:241], v12 offset:0
    ds_read_b64_tr_b16 v[242:243], v12 offset:4096
    v_mfma_f32_16x16x32_bf16 v[116:119], v[148:151], v[36:39], 0
    v_mfma_f32_16x16x32_bf16 v[116:119], v[152:155], v[40:43], v[116:119]
    v_mfma_f32_16x16x32_bf16 v[116:119], v[156:159], v[44:47], v[116:119]
    v_mfma_f32_16x16x32_bf16 v[116:119], v[160:163], v[48:51], v[116:119]
    v_mfma_f32_16x16x32_bf16 v[132:135], v[164:167], v[36:39], 0
    v_mfma_f32_16x16x32_bf16 v[132:135], v[168:171], v[40:43], v[132:135]
    v_mfma_f32_16x16x32_bf16 v[132:135], v[172:175], v[44:47], v[132:135]
    v_mfma_f32_16x16x32_bf16 v[132:135], v[176:179], v[48:51], v[132:135]
    v_mfma_f32_16x16x32_bf16 v[120:123], v[160:163], v[64:67], 0
    v_mfma_f32_16x16x32_bf16 v[120:123], v[156:159], v[60:63], v[120:123]
    v_mfma_f32_16x16x32_bf16 v[120:123], v[152:155], v[56:59], v[120:123]
    v_mfma_f32_16x16x32_bf16 v[120:123], v[148:151], v[52:55], v[120:123]
    v_mfma_f32_16x16x32_bf16 v[136:139], v[176:179], v[64:67], 0
    v_mfma_f32_16x16x32_bf16 v[136:139], v[172:175], v[60:63], v[136:139]
    v_mfma_f32_16x16x32_bf16 v[136:139], v[168:171], v[56:59], v[136:139]
    v_mfma_f32_16x16x32_bf16 v[136:139], v[164:167], v[52:55], v[136:139]
    v_mfma_f32_16x16x32_bf16 v[124:127], v[148:151], v[68:71], 0
    v_mfma_f32_16x16x32_bf16 v[124:127], v[152:155], v[72:75], v[124:127]
    v_mfma_f32_16x16x32_bf16 v[124:127], v[156:159], v[76:79], v[124:127]
    v_mfma_f32_16x16x32_bf16 v[124:127], v[160:163], v[80:83], v[124:127]
    v_mfma_f32_16x16x32_bf16 v[140:143], v[164:167], v[68:71], 0
    v_mfma_f32_16x16x32_bf16 v[140:143], v[168:171], v[72:75], v[140:143]
    v_mfma_f32_16x16x32_bf16 v[140:143], v[172:175], v[76:79], v[140:143]
    v_mfma_f32_16x16x32_bf16 v[140:143], v[176:179], v[80:83], v[140:143]
    v_mfma_f32_16x16x32_bf16 v[128:131], v[160:163], v[96:99], 0
    v_mfma_f32_16x16x32_bf16 v[128:131], v[156:159], v[92:95], v[128:131]
    v_mfma_f32_16x16x32_bf16 v[128:131], v[152:155], v[88:91], v[128:131]
    v_mfma_f32_16x16x32_bf16 v[128:131], v[148:151], v[84:87], v[128:131]
    v_mfma_f32_16x16x32_bf16 v[144:147], v[176:179], v[96:99], 0
    v_mfma_f32_16x16x32_bf16 v[144:147], v[172:175], v[92:95], v[144:147]
    v_mfma_f32_16x16x32_bf16 v[144:147], v[168:171], v[88:91], v[144:147]
    v_mfma_f32_16x16x32_bf16 v[144:147], v[164:167], v[84:87], v[144:147]
    s_waitcnt lgkmcnt(0)
    s_nop 7
    v_max3_f32 v224, v116, v117, v118
    v_max3_f32 v224, v224, v119, v132
    v_max3_f32 v224, v224, v133, v134
    v_max3_f32 v224, v224, v135, v212
    v_mov_b32 v225, v224
    s_nop 1
    v_permlane32_swap_b32 v224, v225
    v_max_f32 v224, v224, v225
    v_mov_b32 v225, v224
    s_nop 1
    v_permlane16_swap_b32 v224, v225
    v_max_f32 v224, v224, v225
    v_sub_f32 v220, v212, v224
    v_exp_f32 v220, v220
    v_mov_b32 v212, v224
    v_sub_f32 v116, v116, v224
    v_sub_f32 v117, v117, v224
    v_sub_f32 v118, v118, v224
    v_sub_f32 v119, v119, v224
    v_sub_f32 v132, v132, v224
    v_sub_f32 v133, v133, v224
    v_sub_f32 v134, v134, v224
    v_sub_f32 v135, v135, v224
    v_mul_f32 v216, v216, v220
    v_exp_f32 v116, v116
    v_exp_f32 v117, v117
    v_exp_f32 v118, v118
    v_exp_f32 v119, v119
    v_exp_f32 v132, v132
    v_exp_f32 v133, v133
    v_exp_f32 v134, v134
    v_exp_f32 v135, v135
    v_accvgpr_read_b32 v224, a0
    v_accvgpr_read_b32 v225, a1
    v_accvgpr_read_b32 v226, a2
    v_accvgpr_read_b32 v227, a3
    v_mul_f32 v224, v224, v220
    v_mul_f32 v225, v225, v220
    v_mul_f32 v226, v226, v220
    v_mul_f32 v227, v227, v220
    v_accvgpr_write_b32 a0, v224
    v_accvgpr_write_b32 a1, v225
    v_accvgpr_write_b32 a2, v226
    v_accvgpr_write_b32 a3, v227
    v_accvgpr_read_b32 v224, a16
    v_accvgpr_read_b32 v225, a17
    v_accvgpr_read_b32 v226, a18
    v_accvgpr_read_b32 v227, a19
    v_mul_f32 v224, v224, v220
    v_mul_f32 v225, v225, v220
    v_mul_f32 v226, v226, v220
    v_mul_f32 v227, v227, v220
    v_accvgpr_write_b32 a16, v224
    v_accvgpr_write_b32 a17, v225
    v_accvgpr_write_b32 a18, v226
    v_accvgpr_write_b32 a19, v227
    v_accvgpr_read_b32 v224, a32
    v_accvgpr_read_b32 v225, a33
    v_accvgpr_read_b32 v226, a34
    v_accvgpr_read_b32 v227, a35
    v_mul_f32 v224, v224, v220
    v_mul_f32 v225, v225, v220
    v_mul_f32 v226, v226, v220
    v_mul_f32 v227, v227, v220
    v_accvgpr_write_b32 a32, v224
    v_accvgpr_write_b32 a33, v225
    v_accvgpr_write_b32 a34, v226
    v_accvgpr_write_b32 a35, v227
    v_accvgpr_read_b32 v224, a48
    v_accvgpr_read_b32 v225, a49
    v_accvgpr_read_b32 v226, a50
    v_accvgpr_read_b32 v227, a51
    v_mul_f32 v224, v224, v220
    v_mul_f32 v225, v225, v220
    v_mul_f32 v226, v226, v220
    v_mul_f32 v227, v227, v220
    v_accvgpr_write_b32 a48, v224
    v_accvgpr_write_b32 a49, v225
    v_accvgpr_write_b32 a50, v226
    v_accvgpr_write_b32 a51, v227
    v_accvgpr_read_b32 v224, a64
    v_accvgpr_read_b32 v225, a65
    v_accvgpr_read_b32 v226, a66
    v_accvgpr_read_b32 v227, a67
    v_mul_f32 v224, v224, v220
    v_mul_f32 v225, v225, v220
    v_mul_f32 v226, v226, v220
    v_mul_f32 v227, v227, v220
    v_accvgpr_write_b32 a64, v224
    v_accvgpr_write_b32 a65, v225
    v_accvgpr_write_b32 a66, v226
    v_accvgpr_write_b32 a67, v227
    v_accvgpr_read_b32 v224, a80
    v_accvgpr_read_b32 v225, a81
    v_accvgpr_read_b32 v226, a82
    v_accvgpr_read_b32 v227, a83
    v_mul_f32 v224, v224, v220
    v_mul_f32 v225, v225, v220
    v_mul_f32 v226, v226, v220
    v_mul_f32 v227, v227, v220
    v_accvgpr_write_b32 a80, v224
    v_accvgpr_write_b32 a81, v225
    v_accvgpr_write_b32 a82, v226
    v_accvgpr_write_b32 a83, v227
    v_accvgpr_read_b32 v224, a96
    v_accvgpr_read_b32 v225, a97
    v_accvgpr_read_b32 v226, a98
    v_accvgpr_read_b32 v227, a99
    v_mul_f32 v224, v224, v220
    v_mul_f32 v225, v225, v220
    v_mul_f32 v226, v226, v220
    v_mul_f32 v227, v227, v220
    v_accvgpr_write_b32 a96, v224
    v_accvgpr_write_b32 a97, v225
    v_accvgpr_write_b32 a98, v226
    v_accvgpr_write_b32 a99, v227
    v_accvgpr_read_b32 v224, a112
    v_accvgpr_read_b32 v225, a113
    v_accvgpr_read_b32 v226, a114
    v_accvgpr_read_b32 v227, a115
    v_mul_f32 v224, v224, v220
    v_mul_f32 v225, v225, v220
    v_mul_f32 v226, v226, v220
    v_mul_f32 v227, v227, v220
    v_accvgpr_write_b32 a112, v224
    v_accvgpr_write_b32 a113, v225
    v_accvgpr_write_b32 a114, v226
    v_accvgpr_write_b32 a115, v227
    v_add_f32 v216, v216, v116
    v_add_f32 v216, v216, v117
    v_add_f32 v216, v216, v118
    v_add_f32 v216, v216, v119
    v_add_f32 v216, v216, v132
    v_add_f32 v216, v216, v133
    v_add_f32 v216, v216, v134
    v_add_f32 v216, v216, v135
    v_cvt_pk_bf16_f32 v180, v116, v117
    v_cvt_pk_bf16_f32 v181, v118, v119
    v_cvt_pk_bf16_f32 v182, v132, v133
    v_cvt_pk_bf16_f32 v183, v134, v135
    s_nop 1
    v_mfma_f32_16x16x32_bf16 a[0:3], v[196:199], v[180:183], a[0:3]
    v_mfma_f32_16x16x32_bf16 a[16:19], v[200:203], v[180:183], a[16:19]
    v_mfma_f32_16x16x32_bf16 a[32:35], v[204:207], v[180:183], a[32:35]
    v_mfma_f32_16x16x32_bf16 a[48:51], v[208:211], v[180:183], a[48:51]
    v_mfma_f32_16x16x32_bf16 a[64:67], v[228:231], v[180:183], a[64:67]
    v_mfma_f32_16x16x32_bf16 a[80:83], v[232:235], v[180:183], a[80:83]
    v_mfma_f32_16x16x32_bf16 a[96:99], v[236:239], v[180:183], a[96:99]
    v_mfma_f32_16x16x32_bf16 a[112:115], v[240:243], v[180:183], a[112:115]
    v_max3_f32 v224, v120, v121, v122
    v_max3_f32 v224, v224, v123, v136
    v_max3_f32 v224, v224, v137, v138
    v_max3_f32 v224, v224, v139, v213
    v_mov_b32 v225, v224
    s_nop 1
    v_permlane32_swap_b32 v224, v225
    v_max_f32 v224, v224, v225
    v_mov_b32 v225, v224
    s_nop 1
    v_permlane16_swap_b32 v224, v225
    v_max_f32 v224, v224, v225
    v_sub_f32 v220, v213, v224
    v_exp_f32 v220, v220
    v_mov_b32 v213, v224
    v_sub_f32 v120, v120, v224
    v_sub_f32 v121, v121, v224
    v_sub_f32 v122, v122, v224
    v_sub_f32 v123, v123, v224
    v_sub_f32 v136, v136, v224
    v_sub_f32 v137, v137, v224
    v_sub_f32 v138, v138, v224
    v_sub_f32 v139, v139, v224
    v_mul_f32 v217, v217, v220
    v_exp_f32 v120, v120
    v_exp_f32 v121, v121
    v_exp_f32 v122, v122
    v_exp_f32 v123, v123
    v_exp_f32 v136, v136
    v_exp_f32 v137, v137
    v_exp_f32 v138, v138
    v_exp_f32 v139, v139
    v_accvgpr_read_b32 v224, a4
    v_accvgpr_read_b32 v225, a5
    v_accvgpr_read_b32 v226, a6
    v_accvgpr_read_b32 v227, a7
    v_mul_f32 v224, v224, v220
    v_mul_f32 v225, v225, v220
    v_mul_f32 v226, v226, v220
    v_mul_f32 v227, v227, v220
    v_accvgpr_write_b32 a4, v224
    v_accvgpr_write_b32 a5, v225
    v_accvgpr_write_b32 a6, v226
    v_accvgpr_write_b32 a7, v227
    v_accvgpr_read_b32 v224, a20
    v_accvgpr_read_b32 v225, a21
    v_accvgpr_read_b32 v226, a22
    v_accvgpr_read_b32 v227, a23
    v_mul_f32 v224, v224, v220
    v_mul_f32 v225, v225, v220
    v_mul_f32 v226, v226, v220
    v_mul_f32 v227, v227, v220
    v_accvgpr_write_b32 a20, v224
    v_accvgpr_write_b32 a21, v225
    v_accvgpr_write_b32 a22, v226
    v_accvgpr_write_b32 a23, v227
    v_accvgpr_read_b32 v224, a36
    v_accvgpr_read_b32 v225, a37
    v_accvgpr_read_b32 v226, a38
    v_accvgpr_read_b32 v227, a39
    v_mul_f32 v224, v224, v220
    v_mul_f32 v225, v225, v220
    v_mul_f32 v226, v226, v220
    v_mul_f32 v227, v227, v220
    v_accvgpr_write_b32 a36, v224
    v_accvgpr_write_b32 a37, v225
    v_accvgpr_write_b32 a38, v226
    v_accvgpr_write_b32 a39, v227
    v_accvgpr_read_b32 v224, a52
    v_accvgpr_read_b32 v225, a53
    v_accvgpr_read_b32 v226, a54
    v_accvgpr_read_b32 v227, a55
    v_mul_f32 v224, v224, v220
    v_mul_f32 v225, v225, v220
    v_mul_f32 v226, v226, v220
    v_mul_f32 v227, v227, v220
    v_accvgpr_write_b32 a52, v224
    v_accvgpr_write_b32 a53, v225
    v_accvgpr_write_b32 a54, v226
    v_accvgpr_write_b32 a55, v227
    v_accvgpr_read_b32 v224, a68
    v_accvgpr_read_b32 v225, a69
    v_accvgpr_read_b32 v226, a70
    v_accvgpr_read_b32 v227, a71
    v_mul_f32 v224, v224, v220
    v_mul_f32 v225, v225, v220
    v_mul_f32 v226, v226, v220
    v_mul_f32 v227, v227, v220
    v_accvgpr_write_b32 a68, v224
    v_accvgpr_write_b32 a69, v225
    v_accvgpr_write_b32 a70, v226
    v_accvgpr_write_b32 a71, v227
    v_accvgpr_read_b32 v224, a84
    v_accvgpr_read_b32 v225, a85
    v_accvgpr_read_b32 v226, a86
    v_accvgpr_read_b32 v227, a87
    v_mul_f32 v224, v224, v220
    v_mul_f32 v225, v225, v220
    v_mul_f32 v226, v226, v220
    v_mul_f32 v227, v227, v220
    v_accvgpr_write_b32 a84, v224
    v_accvgpr_write_b32 a85, v225
    v_accvgpr_write_b32 a86, v226
    v_accvgpr_write_b32 a87, v227
    v_accvgpr_read_b32 v224, a100
    v_accvgpr_read_b32 v225, a101
    v_accvgpr_read_b32 v226, a102
    v_accvgpr_read_b32 v227, a103
    v_mul_f32 v224, v224, v220
    v_mul_f32 v225, v225, v220
    v_mul_f32 v226, v226, v220
    v_mul_f32 v227, v227, v220
    v_accvgpr_write_b32 a100, v224
    v_accvgpr_write_b32 a101, v225
    v_accvgpr_write_b32 a102, v226
    v_accvgpr_write_b32 a103, v227
    v_accvgpr_read_b32 v224, a116
    v_accvgpr_read_b32 v225, a117
    v_accvgpr_read_b32 v226, a118
    v_accvgpr_read_b32 v227, a119
    v_mul_f32 v224, v224, v220
    v_mul_f32 v225, v225, v220
    v_mul_f32 v226, v226, v220
    v_mul_f32 v227, v227, v220
    v_accvgpr_write_b32 a116, v224
    v_accvgpr_write_b32 a117, v225
    v_accvgpr_write_b32 a118, v226
    v_accvgpr_write_b32 a119, v227
    v_add_f32 v217, v217, v120
    v_add_f32 v217, v217, v121
    v_add_f32 v217, v217, v122
    v_add_f32 v217, v217, v123
    v_add_f32 v217, v217, v136
    v_add_f32 v217, v217, v137
    v_add_f32 v217, v217, v138
    v_add_f32 v217, v217, v139
    v_cvt_pk_bf16_f32 v184, v120, v121
    v_cvt_pk_bf16_f32 v185, v122, v123
    v_cvt_pk_bf16_f32 v186, v136, v137
    v_cvt_pk_bf16_f32 v187, v138, v139
    s_nop 1
    v_mfma_f32_16x16x32_bf16 a[4:7], v[196:199], v[184:187], a[4:7]
    v_mfma_f32_16x16x32_bf16 a[20:23], v[200:203], v[184:187], a[20:23]
    v_mfma_f32_16x16x32_bf16 a[36:39], v[204:207], v[184:187], a[36:39]
    v_mfma_f32_16x16x32_bf16 a[52:55], v[208:211], v[184:187], a[52:55]
    v_mfma_f32_16x16x32_bf16 a[68:71], v[228:231], v[184:187], a[68:71]
    v_mfma_f32_16x16x32_bf16 a[84:87], v[232:235], v[184:187], a[84:87]
    v_mfma_f32_16x16x32_bf16 a[100:103], v[236:239], v[184:187], a[100:103]
    v_mfma_f32_16x16x32_bf16 a[116:119], v[240:243], v[184:187], a[116:119]
    v_max3_f32 v224, v124, v125, v126
    v_max3_f32 v224, v224, v127, v140
    v_max3_f32 v224, v224, v141, v142
    v_max3_f32 v224, v224, v143, v214
    v_mov_b32 v225, v224
    s_nop 1
    v_permlane32_swap_b32 v224, v225
    v_max_f32 v224, v224, v225
    v_mov_b32 v225, v224
    s_nop 1
    v_permlane16_swap_b32 v224, v225
    v_max_f32 v224, v224, v225
    v_sub_f32 v220, v214, v224
    v_exp_f32 v220, v220
    v_mov_b32 v214, v224
    v_sub_f32 v124, v124, v224
    v_sub_f32 v125, v125, v224
    v_sub_f32 v126, v126, v224
    v_sub_f32 v127, v127, v224
    v_sub_f32 v140, v140, v224
    v_sub_f32 v141, v141, v224
    v_sub_f32 v142, v142, v224
    v_sub_f32 v143, v143, v224
    v_mul_f32 v218, v218, v220
    v_exp_f32 v124, v124
    v_exp_f32 v125, v125
    v_exp_f32 v126, v126
    v_exp_f32 v127, v127
    v_exp_f32 v140, v140
    v_exp_f32 v141, v141
    v_exp_f32 v142, v142
    v_exp_f32 v143, v143
    v_accvgpr_read_b32 v224, a8
    v_accvgpr_read_b32 v225, a9
    v_accvgpr_read_b32 v226, a10
    v_accvgpr_read_b32 v227, a11
    v_mul_f32 v224, v224, v220
    v_mul_f32 v225, v225, v220
    v_mul_f32 v226, v226, v220
    v_mul_f32 v227, v227, v220
    v_accvgpr_write_b32 a8, v224
    v_accvgpr_write_b32 a9, v225
    v_accvgpr_write_b32 a10, v226
    v_accvgpr_write_b32 a11, v227
    v_accvgpr_read_b32 v224, a24
    v_accvgpr_read_b32 v225, a25
    v_accvgpr_read_b32 v226, a26
    v_accvgpr_read_b32 v227, a27
    v_mul_f32 v224, v224, v220
    v_mul_f32 v225, v225, v220
    v_mul_f32 v226, v226, v220
    v_mul_f32 v227, v227, v220
    v_accvgpr_write_b32 a24, v224
    v_accvgpr_write_b32 a25, v225
    v_accvgpr_write_b32 a26, v226
    v_accvgpr_write_b32 a27, v227
    v_accvgpr_read_b32 v224, a40
    v_accvgpr_read_b32 v225, a41
    v_accvgpr_read_b32 v226, a42
    v_accvgpr_read_b32 v227, a43
    v_mul_f32 v224, v224, v220
    v_mul_f32 v225, v225, v220
    v_mul_f32 v226, v226, v220
    v_mul_f32 v227, v227, v220
    v_accvgpr_write_b32 a40, v224
    v_accvgpr_write_b32 a41, v225
    v_accvgpr_write_b32 a42, v226
    v_accvgpr_write_b32 a43, v227
    v_accvgpr_read_b32 v224, a56
    v_accvgpr_read_b32 v225, a57
    v_accvgpr_read_b32 v226, a58
    v_accvgpr_read_b32 v227, a59
    v_mul_f32 v224, v224, v220
    v_mul_f32 v225, v225, v220
    v_mul_f32 v226, v226, v220
    v_mul_f32 v227, v227, v220
    v_accvgpr_write_b32 a56, v224
    v_accvgpr_write_b32 a57, v225
    v_accvgpr_write_b32 a58, v226
    v_accvgpr_write_b32 a59, v227
    v_accvgpr_read_b32 v224, a72
    v_accvgpr_read_b32 v225, a73
    v_accvgpr_read_b32 v226, a74
    v_accvgpr_read_b32 v227, a75
    v_mul_f32 v224, v224, v220
    v_mul_f32 v225, v225, v220
    v_mul_f32 v226, v226, v220
    v_mul_f32 v227, v227, v220
    v_accvgpr_write_b32 a72, v224
    v_accvgpr_write_b32 a73, v225
    v_accvgpr_write_b32 a74, v226
    v_accvgpr_write_b32 a75, v227
    v_accvgpr_read_b32 v224, a88
    v_accvgpr_read_b32 v225, a89
    v_accvgpr_read_b32 v226, a90
    v_accvgpr_read_b32 v227, a91
    v_mul_f32 v224, v224, v220
    v_mul_f32 v225, v225, v220
    v_mul_f32 v226, v226, v220
    v_mul_f32 v227, v227, v220
    v_accvgpr_write_b32 a88, v224
    v_accvgpr_write_b32 a89, v225
    v_accvgpr_write_b32 a90, v226
    v_accvgpr_write_b32 a91, v227
    v_accvgpr_read_b32 v224, a104
    v_accvgpr_read_b32 v225, a105
    v_accvgpr_read_b32 v226, a106
    v_accvgpr_read_b32 v227, a107
    v_mul_f32 v224, v224, v220
    v_mul_f32 v225, v225, v220
    v_mul_f32 v226, v226, v220
    v_mul_f32 v227, v227, v220
    v_accvgpr_write_b32 a104, v224
    v_accvgpr_write_b32 a105, v225
    v_accvgpr_write_b32 a106, v226
    v_accvgpr_write_b32 a107, v227
    v_accvgpr_read_b32 v224, a120
    v_accvgpr_read_b32 v225, a121
    v_accvgpr_read_b32 v226, a122
    v_accvgpr_read_b32 v227, a123
    v_mul_f32 v224, v224, v220
    v_mul_f32 v225, v225, v220
    v_mul_f32 v226, v226, v220
    v_mul_f32 v227, v227, v220
    v_accvgpr_write_b32 a120, v224
    v_accvgpr_write_b32 a121, v225
    v_accvgpr_write_b32 a122, v226
    v_accvgpr_write_b32 a123, v227
    v_add_f32 v218, v218, v124
    v_add_f32 v218, v218, v125
    v_add_f32 v218, v218, v126
    v_add_f32 v218, v218, v127
    v_add_f32 v218, v218, v140
    v_add_f32 v218, v218, v141
    v_add_f32 v218, v218, v142
    v_add_f32 v218, v218, v143
    v_cvt_pk_bf16_f32 v188, v124, v125
    v_cvt_pk_bf16_f32 v189, v126, v127
    v_cvt_pk_bf16_f32 v190, v140, v141
    v_cvt_pk_bf16_f32 v191, v142, v143
    s_nop 1
    v_mfma_f32_16x16x32_bf16 a[8:11], v[196:199], v[188:191], a[8:11]
    v_mfma_f32_16x16x32_bf16 a[24:27], v[200:203], v[188:191], a[24:27]
    v_mfma_f32_16x16x32_bf16 a[40:43], v[204:207], v[188:191], a[40:43]
    v_mfma_f32_16x16x32_bf16 a[56:59], v[208:211], v[188:191], a[56:59]
    v_mfma_f32_16x16x32_bf16 a[72:75], v[228:231], v[188:191], a[72:75]
    v_mfma_f32_16x16x32_bf16 a[88:91], v[232:235], v[188:191], a[88:91]
    v_mfma_f32_16x16x32_bf16 a[104:107], v[236:239], v[188:191], a[104:107]
    v_mfma_f32_16x16x32_bf16 a[120:123], v[240:243], v[188:191], a[120:123]
    v_max3_f32 v224, v128, v129, v130
    v_max3_f32 v224, v224, v131, v144
    v_max3_f32 v224, v224, v145, v146
    v_max3_f32 v224, v224, v147, v215
    v_mov_b32 v225, v224
    s_nop 1
    v_permlane32_swap_b32 v224, v225
    v_max_f32 v224, v224, v225
    v_mov_b32 v225, v224
    s_nop 1
    v_permlane16_swap_b32 v224, v225
    v_max_f32 v224, v224, v225
    v_sub_f32 v220, v215, v224
    v_exp_f32 v220, v220
    v_mov_b32 v215, v224
    v_sub_f32 v128, v128, v224
    v_sub_f32 v129, v129, v224
    v_sub_f32 v130, v130, v224
    v_sub_f32 v131, v131, v224
    v_sub_f32 v144, v144, v224
    v_sub_f32 v145, v145, v224
    v_sub_f32 v146, v146, v224
    v_sub_f32 v147, v147, v224
    v_mul_f32 v219, v219, v220
    v_exp_f32 v128, v128
    v_exp_f32 v129, v129
    v_exp_f32 v130, v130
    v_exp_f32 v131, v131
    v_exp_f32 v144, v144
    v_exp_f32 v145, v145
    v_exp_f32 v146, v146
    v_exp_f32 v147, v147
    v_accvgpr_read_b32 v224, a12
    v_accvgpr_read_b32 v225, a13
    v_accvgpr_read_b32 v226, a14
    v_accvgpr_read_b32 v227, a15
    v_mul_f32 v224, v224, v220
    v_mul_f32 v225, v225, v220
    v_mul_f32 v226, v226, v220
    v_mul_f32 v227, v227, v220
    v_accvgpr_write_b32 a12, v224
    v_accvgpr_write_b32 a13, v225
    v_accvgpr_write_b32 a14, v226
    v_accvgpr_write_b32 a15, v227
    v_accvgpr_read_b32 v224, a28
    v_accvgpr_read_b32 v225, a29
    v_accvgpr_read_b32 v226, a30
    v_accvgpr_read_b32 v227, a31
    v_mul_f32 v224, v224, v220
    v_mul_f32 v225, v225, v220
    v_mul_f32 v226, v226, v220
    v_mul_f32 v227, v227, v220
    v_accvgpr_write_b32 a28, v224
    v_accvgpr_write_b32 a29, v225
    v_accvgpr_write_b32 a30, v226
    v_accvgpr_write_b32 a31, v227
    v_accvgpr_read_b32 v224, a44
    v_accvgpr_read_b32 v225, a45
    v_accvgpr_read_b32 v226, a46
    v_accvgpr_read_b32 v227, a47
    v_mul_f32 v224, v224, v220
    v_mul_f32 v225, v225, v220
    v_mul_f32 v226, v226, v220
    v_mul_f32 v227, v227, v220
    v_accvgpr_write_b32 a44, v224
    v_accvgpr_write_b32 a45, v225
    v_accvgpr_write_b32 a46, v226
    v_accvgpr_write_b32 a47, v227
    v_accvgpr_read_b32 v224, a60
    v_accvgpr_read_b32 v225, a61
    v_accvgpr_read_b32 v226, a62
    v_accvgpr_read_b32 v227, a63
    v_mul_f32 v224, v224, v220
    v_mul_f32 v225, v225, v220
    v_mul_f32 v226, v226, v220
    v_mul_f32 v227, v227, v220
    v_accvgpr_write_b32 a60, v224
    v_accvgpr_write_b32 a61, v225
    v_accvgpr_write_b32 a62, v226
    v_accvgpr_write_b32 a63, v227
    v_accvgpr_read_b32 v224, a76
    v_accvgpr_read_b32 v225, a77
    v_accvgpr_read_b32 v226, a78
    v_accvgpr_read_b32 v227, a79
    v_mul_f32 v224, v224, v220
    v_mul_f32 v225, v225, v220
    v_mul_f32 v226, v226, v220
    v_mul_f32 v227, v227, v220
    v_accvgpr_write_b32 a76, v224
    v_accvgpr_write_b32 a77, v225
    v_accvgpr_write_b32 a78, v226
    v_accvgpr_write_b32 a79, v227
    v_accvgpr_read_b32 v224, a92
    v_accvgpr_read_b32 v225, a93
    v_accvgpr_read_b32 v226, a94
    v_accvgpr_read_b32 v227, a95
    v_mul_f32 v224, v224, v220
    v_mul_f32 v225, v225, v220
    v_mul_f32 v226, v226, v220
    v_mul_f32 v227, v227, v220
    v_accvgpr_write_b32 a92, v224
    v_accvgpr_write_b32 a93, v225
    v_accvgpr_write_b32 a94, v226
    v_accvgpr_write_b32 a95, v227
    v_accvgpr_read_b32 v224, a108
    v_accvgpr_read_b32 v225, a109
    v_accvgpr_read_b32 v226, a110
    v_accvgpr_read_b32 v227, a111
    v_mul_f32 v224, v224, v220
    v_mul_f32 v225, v225, v220
    v_mul_f32 v226, v226, v220
    v_mul_f32 v227, v227, v220
    v_accvgpr_write_b32 a108, v224
    v_accvgpr_write_b32 a109, v225
    v_accvgpr_write_b32 a110, v226
    v_accvgpr_write_b32 a111, v227
    v_accvgpr_read_b32 v224, a124
    v_accvgpr_read_b32 v225, a125
    v_accvgpr_read_b32 v226, a126
    v_accvgpr_read_b32 v227, a127
    v_mul_f32 v224, v224, v220
    v_mul_f32 v225, v225, v220
    v_mul_f32 v226, v226, v220
    v_mul_f32 v227, v227, v220
    v_accvgpr_write_b32 a124, v224
    v_accvgpr_write_b32 a125, v225
    v_accvgpr_write_b32 a126, v226
    v_accvgpr_write_b32 a127, v227
    v_add_f32 v219, v219, v128
    v_add_f32 v219, v219, v129
    v_add_f32 v219, v219, v130
    v_add_f32 v219, v219, v131
    v_add_f32 v219, v219, v144
    v_add_f32 v219, v219, v145
    v_add_f32 v219, v219, v146
    v_add_f32 v219, v219, v147
    v_cvt_pk_bf16_f32 v192, v128, v129
    v_cvt_pk_bf16_f32 v193, v130, v131
    v_cvt_pk_bf16_f32 v194, v144, v145
    v_cvt_pk_bf16_f32 v195, v146, v147
    s_nop 1
    v_mfma_f32_16x16x32_bf16 a[12:15], v[196:199], v[192:195], a[12:15]
    v_mfma_f32_16x16x32_bf16 a[28:31], v[200:203], v[192:195], a[28:31]
    v_mfma_f32_16x16x32_bf16 a[44:47], v[204:207], v[192:195], a[44:47]
    v_mfma_f32_16x16x32_bf16 a[60:63], v[208:211], v[192:195], a[60:63]
    v_mfma_f32_16x16x32_bf16 a[76:79], v[228:231], v[192:195], a[76:79]
    v_mfma_f32_16x16x32_bf16 a[92:95], v[232:235], v[192:195], a[92:95]
    v_mfma_f32_16x16x32_bf16 a[108:111], v[236:239], v[192:195], a[108:111]
    v_mfma_f32_16x16x32_bf16 a[124:127], v[240:243], v[192:195], a[124:127]
    s_add_u32 s28, s28, 8192
    s_cmp_lt_u32 s28, 524288
    s_cbranch_scc1 L_slow_loop
    v_mov_b32 v224, v216
    s_nop 1
    v_permlane32_swap_b32 v216, v224
    v_add_f32 v216, v216, v224
    v_mov_b32 v224, v216
    s_nop 1
    v_permlane16_swap_b32 v216, v224
    v_add_f32 v216, v216, v224
    v_rcp_f32 v100, v216
    v_mov_b32 v224, v217
    s_nop 1
    v_permlane32_swap_b32 v217, v224
    v_add_f32 v217, v217, v224
    v_mov_b32 v224, v217
    s_nop 1
    v_permlane16_swap_b32 v217, v224
    v_add_f32 v217, v217, v224
    v_rcp_f32 v101, v217
    v_mov_b32 v224, v218
    s_nop 1
    v_permlane32_swap_b32 v218, v224
    v_add_f32 v218, v218, v224
    v_mov_b32 v224, v218
    s_nop 1
    v_permlane16_swap_b32 v218, v224
    v_add_f32 v218, v218, v224
    v_rcp_f32 v102, v218
    v_mov_b32 v224, v219
    s_nop 1
    v_permlane32_swap_b32 v219, v224
    v_add_f32 v219, v219, v224
    v_mov_b32 v224, v219
    s_nop 1
    v_permlane16_swap_b32 v219, v224
    v_add_f32 v219, v219, v224
    v_rcp_f32 v103, v219
    s_mov_b32 s36, 0
    v_accvgpr_read_b32 v120, a0
    v_accvgpr_read_b32 v121, a1
    v_accvgpr_read_b32 v122, a2
    v_accvgpr_read_b32 v123, a3
    v_accvgpr_read_b32 v124, a16
    v_accvgpr_read_b32 v125, a17
    v_accvgpr_read_b32 v126, a18
    v_accvgpr_read_b32 v127, a19
    v_mul_f32 v120, v120, v100
    v_mul_f32 v121, v121, v100
    v_mul_f32 v122, v122, v100
    v_mul_f32 v123, v123, v100
    v_mul_f32 v124, v124, v100
    v_mul_f32 v125, v125, v100
    v_mul_f32 v126, v126, v100
    v_mul_f32 v127, v127, v100
    v_cvt_pk_bf16_f32 v152, v120, v121
    v_cvt_pk_bf16_f32 v153, v122, v123
    v_cvt_pk_bf16_f32 v154, v124, v125
    v_cvt_pk_bf16_f32 v155, v126, v127
    buffer_store_dwordx4 v[152:155], v110, s[24:27], s36 offen offset:0 sc1
    v_accvgpr_read_b32 v128, a4
    v_accvgpr_read_b32 v129, a5
    v_accvgpr_read_b32 v130, a6
    v_accvgpr_read_b32 v131, a7
    v_accvgpr_read_b32 v132, a20
    v_accvgpr_read_b32 v133, a21
    v_accvgpr_read_b32 v134, a22
    v_accvgpr_read_b32 v135, a23
    v_mul_f32 v128, v128, v101
    v_mul_f32 v129, v129, v101
    v_mul_f32 v130, v130, v101
    v_mul_f32 v131, v131, v101
    v_mul_f32 v132, v132, v101
    v_mul_f32 v133, v133, v101
    v_mul_f32 v134, v134, v101
    v_mul_f32 v135, v135, v101
    v_cvt_pk_bf16_f32 v156, v128, v129
    v_cvt_pk_bf16_f32 v157, v130, v131
    v_cvt_pk_bf16_f32 v158, v132, v133
    v_cvt_pk_bf16_f32 v159, v134, v135
    buffer_store_dwordx4 v[156:159], v110, s[24:27], s36 offen offset:1024 sc1
    v_accvgpr_read_b32 v136, a8
    v_accvgpr_read_b32 v137, a9
    v_accvgpr_read_b32 v138, a10
    v_accvgpr_read_b32 v139, a11
    v_accvgpr_read_b32 v140, a24
    v_accvgpr_read_b32 v141, a25
    v_accvgpr_read_b32 v142, a26
    v_accvgpr_read_b32 v143, a27
    v_mul_f32 v136, v136, v102
    v_mul_f32 v137, v137, v102
    v_mul_f32 v138, v138, v102
    v_mul_f32 v139, v139, v102
    v_mul_f32 v140, v140, v102
    v_mul_f32 v141, v141, v102
    v_mul_f32 v142, v142, v102
    v_mul_f32 v143, v143, v102
    v_cvt_pk_bf16_f32 v160, v136, v137
    v_cvt_pk_bf16_f32 v161, v138, v139
    v_cvt_pk_bf16_f32 v162, v140, v141
    v_cvt_pk_bf16_f32 v163, v142, v143
    buffer_store_dwordx4 v[160:163], v110, s[24:27], s36 offen offset:2048 sc1
    v_accvgpr_read_b32 v144, a12
    v_accvgpr_read_b32 v145, a13
    v_accvgpr_read_b32 v146, a14
    v_accvgpr_read_b32 v147, a15
    v_accvgpr_read_b32 v148, a28
    v_accvgpr_read_b32 v149, a29
    v_accvgpr_read_b32 v150, a30
    v_accvgpr_read_b32 v151, a31
    v_mul_f32 v144, v144, v103
    v_mul_f32 v145, v145, v103
    v_mul_f32 v146, v146, v103
    v_mul_f32 v147, v147, v103
    v_mul_f32 v148, v148, v103
    v_mul_f32 v149, v149, v103
    v_mul_f32 v150, v150, v103
    v_mul_f32 v151, v151, v103
    v_cvt_pk_bf16_f32 v164, v144, v145
    v_cvt_pk_bf16_f32 v165, v146, v147
    v_cvt_pk_bf16_f32 v166, v148, v149
    v_cvt_pk_bf16_f32 v167, v150, v151
    buffer_store_dwordx4 v[164:167], v110, s[24:27], s36 offen offset:3072 sc1
    s_mov_b32 s36, 4096
    v_accvgpr_read_b32 v120, a32
    v_accvgpr_read_b32 v121, a33
    v_accvgpr_read_b32 v122, a34
    v_accvgpr_read_b32 v123, a35
    v_accvgpr_read_b32 v124, a48
    v_accvgpr_read_b32 v125, a49
    v_accvgpr_read_b32 v126, a50
    v_accvgpr_read_b32 v127, a51
    v_mul_f32 v120, v120, v100
    v_mul_f32 v121, v121, v100
    v_mul_f32 v122, v122, v100
    v_mul_f32 v123, v123, v100
    v_mul_f32 v124, v124, v100
    v_mul_f32 v125, v125, v100
    v_mul_f32 v126, v126, v100
    v_mul_f32 v127, v127, v100
    v_cvt_pk_bf16_f32 v152, v120, v121
    v_cvt_pk_bf16_f32 v153, v122, v123
    v_cvt_pk_bf16_f32 v154, v124, v125
    v_cvt_pk_bf16_f32 v155, v126, v127
    buffer_store_dwordx4 v[152:155], v110, s[24:27], s36 offen offset:0 sc1
    v_accvgpr_read_b32 v128, a36
    v_accvgpr_read_b32 v129, a37
    v_accvgpr_read_b32 v130, a38
    v_accvgpr_read_b32 v131, a39
    v_accvgpr_read_b32 v132, a52
    v_accvgpr_read_b32 v133, a53
    v_accvgpr_read_b32 v134, a54
    v_accvgpr_read_b32 v135, a55
    v_mul_f32 v128, v128, v101
    v_mul_f32 v129, v129, v101
    v_mul_f32 v130, v130, v101
    v_mul_f32 v131, v131, v101
    v_mul_f32 v132, v132, v101
    v_mul_f32 v133, v133, v101
    v_mul_f32 v134, v134, v101
    v_mul_f32 v135, v135, v101
    v_cvt_pk_bf16_f32 v156, v128, v129
    v_cvt_pk_bf16_f32 v157, v130, v131
    v_cvt_pk_bf16_f32 v158, v132, v133
    v_cvt_pk_bf16_f32 v159, v134, v135
    buffer_store_dwordx4 v[156:159], v110, s[24:27], s36 offen offset:1024 sc1
    v_accvgpr_read_b32 v136, a40
    v_accvgpr_read_b32 v137, a41
    v_accvgpr_read_b32 v138, a42
    v_accvgpr_read_b32 v139, a43
    v_accvgpr_read_b32 v140, a56
    v_accvgpr_read_b32 v141, a57
    v_accvgpr_read_b32 v142, a58
    v_accvgpr_read_b32 v143, a59
    v_mul_f32 v136, v136, v102
    v_mul_f32 v137, v137, v102
    v_mul_f32 v138, v138, v102
    v_mul_f32 v139, v139, v102
    v_mul_f32 v140, v140, v102
    v_mul_f32 v141, v141, v102
    v_mul_f32 v142, v142, v102
    v_mul_f32 v143, v143, v102
    v_cvt_pk_bf16_f32 v160, v136, v137
    v_cvt_pk_bf16_f32 v161, v138, v139
    v_cvt_pk_bf16_f32 v162, v140, v141
    v_cvt_pk_bf16_f32 v163, v142, v143
    buffer_store_dwordx4 v[160:163], v110, s[24:27], s36 offen offset:2048 sc1
    v_accvgpr_read_b32 v144, a44
    v_accvgpr_read_b32 v145, a45
    v_accvgpr_read_b32 v146, a46
    v_accvgpr_read_b32 v147, a47
    v_accvgpr_read_b32 v148, a60
    v_accvgpr_read_b32 v149, a61
    v_accvgpr_read_b32 v150, a62
    v_accvgpr_read_b32 v151, a63
    v_mul_f32 v144, v144, v103
    v_mul_f32 v145, v145, v103
    v_mul_f32 v146, v146, v103
    v_mul_f32 v147, v147, v103
    v_mul_f32 v148, v148, v103
    v_mul_f32 v149, v149, v103
    v_mul_f32 v150, v150, v103
    v_mul_f32 v151, v151, v103
    v_cvt_pk_bf16_f32 v164, v144, v145
    v_cvt_pk_bf16_f32 v165, v146, v147
    v_cvt_pk_bf16_f32 v166, v148, v149
    v_cvt_pk_bf16_f32 v167, v150, v151
    buffer_store_dwordx4 v[164:167], v110, s[24:27], s36 offen offset:3072 sc1
    s_mov_b32 s36, 8192
    v_accvgpr_read_b32 v120, a64
    v_accvgpr_read_b32 v121, a65
    v_accvgpr_read_b32 v122, a66
    v_accvgpr_read_b32 v123, a67
    v_accvgpr_read_b32 v124, a80
    v_accvgpr_read_b32 v125, a81
    v_accvgpr_read_b32 v126, a82
    v_accvgpr_read_b32 v127, a83
    v_mul_f32 v120, v120, v100
    v_mul_f32 v121, v121, v100
    v_mul_f32 v122, v122, v100
    v_mul_f32 v123, v123, v100
    v_mul_f32 v124, v124, v100
    v_mul_f32 v125, v125, v100
    v_mul_f32 v126, v126, v100
    v_mul_f32 v127, v127, v100
    v_cvt_pk_bf16_f32 v152, v120, v121
    v_cvt_pk_bf16_f32 v153, v122, v123
    v_cvt_pk_bf16_f32 v154, v124, v125
    v_cvt_pk_bf16_f32 v155, v126, v127
    buffer_store_dwordx4 v[152:155], v110, s[24:27], s36 offen offset:0 sc1
    v_accvgpr_read_b32 v128, a68
    v_accvgpr_read_b32 v129, a69
    v_accvgpr_read_b32 v130, a70
    v_accvgpr_read_b32 v131, a71
    v_accvgpr_read_b32 v132, a84
    v_accvgpr_read_b32 v133, a85
    v_accvgpr_read_b32 v134, a86
    v_accvgpr_read_b32 v135, a87
    v_mul_f32 v128, v128, v101
    v_mul_f32 v129, v129, v101
    v_mul_f32 v130, v130, v101
    v_mul_f32 v131, v131, v101
    v_mul_f32 v132, v132, v101
    v_mul_f32 v133, v133, v101
    v_mul_f32 v134, v134, v101
    v_mul_f32 v135, v135, v101
    v_cvt_pk_bf16_f32 v156, v128, v129
    v_cvt_pk_bf16_f32 v157, v130, v131
    v_cvt_pk_bf16_f32 v158, v132, v133
    v_cvt_pk_bf16_f32 v159, v134, v135
    buffer_store_dwordx4 v[156:159], v110, s[24:27], s36 offen offset:1024 sc1
    v_accvgpr_read_b32 v136, a72
    v_accvgpr_read_b32 v137, a73
    v_accvgpr_read_b32 v138, a74
    v_accvgpr_read_b32 v139, a75
    v_accvgpr_read_b32 v140, a88
    v_accvgpr_read_b32 v141, a89
    v_accvgpr_read_b32 v142, a90
    v_accvgpr_read_b32 v143, a91
    v_mul_f32 v136, v136, v102
    v_mul_f32 v137, v137, v102
    v_mul_f32 v138, v138, v102
    v_mul_f32 v139, v139, v102
    v_mul_f32 v140, v140, v102
    v_mul_f32 v141, v141, v102
    v_mul_f32 v142, v142, v102
    v_mul_f32 v143, v143, v102
    v_cvt_pk_bf16_f32 v160, v136, v137
    v_cvt_pk_bf16_f32 v161, v138, v139
    v_cvt_pk_bf16_f32 v162, v140, v141
    v_cvt_pk_bf16_f32 v163, v142, v143
    buffer_store_dwordx4 v[160:163], v110, s[24:27], s36 offen offset:2048 sc1
    v_accvgpr_read_b32 v144, a76
    v_accvgpr_read_b32 v145, a77
    v_accvgpr_read_b32 v146, a78
    v_accvgpr_read_b32 v147, a79
    v_accvgpr_read_b32 v148, a92
    v_accvgpr_read_b32 v149, a93
    v_accvgpr_read_b32 v150, a94
    v_accvgpr_read_b32 v151, a95
    v_mul_f32 v144, v144, v103
    v_mul_f32 v145, v145, v103
    v_mul_f32 v146, v146, v103
    v_mul_f32 v147, v147, v103
    v_mul_f32 v148, v148, v103
    v_mul_f32 v149, v149, v103
    v_mul_f32 v150, v150, v103
    v_mul_f32 v151, v151, v103
    v_cvt_pk_bf16_f32 v164, v144, v145
    v_cvt_pk_bf16_f32 v165, v146, v147
    v_cvt_pk_bf16_f32 v166, v148, v149
    v_cvt_pk_bf16_f32 v167, v150, v151
    buffer_store_dwordx4 v[164:167], v110, s[24:27], s36 offen offset:3072 sc1
    s_mov_b32 s36, 12288
    v_accvgpr_read_b32 v120, a96
    v_accvgpr_read_b32 v121, a97
    v_accvgpr_read_b32 v122, a98
    v_accvgpr_read_b32 v123, a99
    v_accvgpr_read_b32 v124, a112
    v_accvgpr_read_b32 v125, a113
    v_accvgpr_read_b32 v126, a114
    v_accvgpr_read_b32 v127, a115
    v_mul_f32 v120, v120, v100
    v_mul_f32 v121, v121, v100
    v_mul_f32 v122, v122, v100
    v_mul_f32 v123, v123, v100
    v_mul_f32 v124, v124, v100
    v_mul_f32 v125, v125, v100
    v_mul_f32 v126, v126, v100
    v_mul_f32 v127, v127, v100
    v_cvt_pk_bf16_f32 v152, v120, v121
    v_cvt_pk_bf16_f32 v153, v122, v123
    v_cvt_pk_bf16_f32 v154, v124, v125
    v_cvt_pk_bf16_f32 v155, v126, v127
    buffer_store_dwordx4 v[152:155], v110, s[24:27], s36 offen offset:0 sc1
    v_accvgpr_read_b32 v128, a100
    v_accvgpr_read_b32 v129, a101
    v_accvgpr_read_b32 v130, a102
    v_accvgpr_read_b32 v131, a103
    v_accvgpr_read_b32 v132, a116
    v_accvgpr_read_b32 v133, a117
    v_accvgpr_read_b32 v134, a118
    v_accvgpr_read_b32 v135, a119
    v_mul_f32 v128, v128, v101
    v_mul_f32 v129, v129, v101
    v_mul_f32 v130, v130, v101
    v_mul_f32 v131, v131, v101
    v_mul_f32 v132, v132, v101
    v_mul_f32 v133, v133, v101
    v_mul_f32 v134, v134, v101
    v_mul_f32 v135, v135, v101
    v_cvt_pk_bf16_f32 v156, v128, v129
    v_cvt_pk_bf16_f32 v157, v130, v131
    v_cvt_pk_bf16_f32 v158, v132, v133
    v_cvt_pk_bf16_f32 v159, v134, v135
    buffer_store_dwordx4 v[156:159], v110, s[24:27], s36 offen offset:1024 sc1
    v_accvgpr_read_b32 v136, a104
    v_accvgpr_read_b32 v137, a105
    v_accvgpr_read_b32 v138, a106
    v_accvgpr_read_b32 v139, a107
    v_accvgpr_read_b32 v140, a120
    v_accvgpr_read_b32 v141, a121
    v_accvgpr_read_b32 v142, a122
    v_accvgpr_read_b32 v143, a123
    v_mul_f32 v136, v136, v102
    v_mul_f32 v137, v137, v102
    v_mul_f32 v138, v138, v102
    v_mul_f32 v139, v139, v102
    v_mul_f32 v140, v140, v102
    v_mul_f32 v141, v141, v102
    v_mul_f32 v142, v142, v102
    v_mul_f32 v143, v143, v102
    v_cvt_pk_bf16_f32 v160, v136, v137
    v_cvt_pk_bf16_f32 v161, v138, v139
    v_cvt_pk_bf16_f32 v162, v140, v141
    v_cvt_pk_bf16_f32 v163, v142, v143
    buffer_store_dwordx4 v[160:163], v110, s[24:27], s36 offen offset:2048 sc1
    v_accvgpr_read_b32 v144, a108
    v_accvgpr_read_b32 v145, a109
    v_accvgpr_read_b32 v146, a110
    v_accvgpr_read_b32 v147, a111
    v_accvgpr_read_b32 v148, a124
    v_accvgpr_read_b32 v149, a125
    v_accvgpr_read_b32 v150, a126
    v_accvgpr_read_b32 v151, a127
    v_mul_f32 v144, v144, v103
    v_mul_f32 v145, v145, v103
    v_mul_f32 v146, v146, v103
    v_mul_f32 v147, v147, v103
    v_mul_f32 v148, v148, v103
    v_mul_f32 v149, v149, v103
    v_mul_f32 v150, v150, v103
    v_mul_f32 v151, v151, v103
    v_cvt_pk_bf16_f32 v164, v144, v145
    v_cvt_pk_bf16_f32 v165, v146, v147
    v_cvt_pk_bf16_f32 v166, v148, v149
    v_cvt_pk_bf16_f32 v167, v150, v151
    buffer_store_dwordx4 v[164:167], v110, s[24:27], s36 offen offset:3072 sc1
    s_mov_b32 s45, 61440
    buffer_load_dwordx4 a[0:3], v114, s[20:23], s45 offen offset:1024 sc1
    s_mov_b32 s45, 61440
    buffer_load_dwordx4 a[4:7], v114, s[20:23], s45 offen offset:2048 sc1
    s_mov_b32 s45, 61440
    buffer_load_dwordx4 a[8:11], v114, s[20:23], s45 offen offset:3072 sc1
    s_mov_b32 s45, 61440
    buffer_load_dwordx4 a[12:15], v115, s[20:23], s45 offen offset:0 sc1
    s_mov_b32 s45, 81920
    buffer_load_dwordx4 a[16:19], v114, s[20:23], s45 offen offset:0 sc1
    s_mov_b32 s45, 81920
    buffer_load_dwordx4 a[20:23], v114, s[20:23], s45 offen offset:1024 sc1
    s_mov_b32 s45, 81920
    buffer_load_dwordx4 a[24:27], v114, s[20:23], s45 offen offset:2048 sc1
    s_mov_b32 s45, 81920
    buffer_load_dwordx4 a[28:31], v114, s[20:23], s45 offen offset:3072 sc1
    s_mov_b32 s45, 81920
    buffer_load_dwordx4 a[32:35], v115, s[20:23], s45 offen offset:0 sc1
    s_mov_b32 s45, 102400
    buffer_load_dwordx4 a[36:39], v114, s[20:23], s45 offen offset:0 sc1
    s_mov_b32 s45, 102400
    buffer_load_dwordx4 a[40:43], v114, s[20:23], s45 offen offset:1024 sc1
    s_mov_b32 s45, 102400
    buffer_load_dwordx4 a[44:47], v114, s[20:23], s45 offen offset:2048 sc1
    s_mov_b32 s45, 102400
    buffer_load_dwordx4 a[48:51], v114, s[20:23], s45 offen offset:3072 sc1
    s_mov_b32 s45, 102400
    buffer_load_dwordx4 a[52:55], v115, s[20:23], s45 offen offset:0 sc1
    s_mov_b32 s45, 122880
    buffer_load_dwordx4 a[56:59], v114, s[20:23], s45 offen offset:0 sc1
    s_mov_b32 s45, 122880
    buffer_load_dwordx4 a[60:63], v114, s[20:23], s45 offen offset:1024 sc1
    s_mov_b32 s45, 122880
    buffer_load_dwordx4 a[64:67], v114, s[20:23], s45 offen offset:2048 sc1
    s_mov_b32 s45, 122880
    buffer_load_dwordx4 a[68:71], v114, s[20:23], s45 offen offset:3072 sc1
    s_mov_b32 s45, 122880
    buffer_load_dwordx4 a[72:75], v115, s[20:23], s45 offen offset:0 sc1
    s_mov_b32 s45, 143360
    buffer_load_dwordx4 a[76:79], v114, s[20:23], s45 offen offset:0 sc1
    s_mov_b32 s45, 143360
    buffer_load_dwordx4 a[80:83], v114, s[20:23], s45 offen offset:1024 sc1
    s_mov_b32 s45, 143360
    buffer_load_dwordx4 a[84:87], v114, s[20:23], s45 offen offset:2048 sc1
    s_mov_b32 s45, 143360
    buffer_load_dwordx4 a[88:91], v114, s[20:23], s45 offen offset:3072 sc1
    s_mov_b32 s45, 143360
    buffer_load_dwordx4 a[92:95], v115, s[20:23], s45 offen offset:0 sc1
    s_waitcnt vmcnt(0)
    s_branch L_published
L_spin_rows:
    s_mov_b32 s7, 32768
L_retry_rows:
    s_sleep 2
    buffer_load_dword v252, off, s[92:95], s74 sc1
    s_waitcnt vmcnt(0)
    v_cmp_gt_u32 vcc, 32, v252
    s_and_b64 vcc, vcc, exec
    s_cbranch_scc0 L_back_rows
    s_sub_u32 s7, s7, 1
    s_cbranch_scc0 L_retry_rows
    s_branch L_back_rows
L_spin_all:
    s_mov_b32 s7, 32768
L_retry_all:
    s_sleep 2
    buffer_load_dword v252, v253, s[92:95], 0 offen sc1
    s_waitcnt vmcnt(0)
    v_cmp_gt_u32 vcc, 32, v252
    s_and_b64 vcc, vcc, exec
    s_cbranch_scc0 L_back_all
    s_sub_u32 s7, s7, 1
    s_cbranch_scc0 L_retry_all
    s_branch L_back_all
L_rt_keys:
    s_lshl_b32 s40, s5, 13
    s_add_u32 s40, s40, 0x280008
    v_lshlrev_b32 v253, 4, v19
    buffer_load_dword v28, v253, s[76:79], s40 offen offset:0 sc1
    buffer_load_dword v29, v253, s[76:79], s40 offen offset:1024 sc1
    buffer_load_dword v30, v253, s[76:79], s40 offen offset:2048 sc1
    buffer_load_dword v31, v253, s[76:79], s40 offen offset:3072 sc1
    s_add_u32 s40, s40, 4096
    buffer_load_dword v32, v253, s[76:79], s40 offen offset:0 sc1
    buffer_load_dword v33, v253, s[76:79], s40 offen offset:1024 sc1
    buffer_load_dword v34, v253, s[76:79], s40 offen offset:2048 sc1
    buffer_load_dword v35, v253, s[76:79], s40 offen offset:3072 sc1
    s_branch L_rt_back_keys
L_rt_local:
    s_waitcnt vmcnt(11)
    s_mov_b32 s42, -1
    v_sub_u32 v20, s42, v28
    v_sub_u32 v21, s42, v29
    v_sub_u32 v22, s42, v30
    v_min3_u32 v20, v20, v21, v22
    v_sub_u32 v21, s42, v31
    v_sub_u32 v22, s42, v32
    v_min3_u32 v20, v20, v21, v22
    v_sub_u32 v21, s42, v33
    v_sub_u32 v22, s42, v34
    v_min3_u32 v20, v20, v21, v22
    v_sub_u32 v21, s42, v35
    v_min_u32 v20, v20, v21
    s_nop 1
    v_min_u32_dpp v20, v20, v20 row_shr:1 row_mask:0xf bank_mask:0xf
    s_nop 1
    v_min_u32_dpp v20, v20, v20 row_shr:2 row_mask:0xf bank_mask:0xf
    s_nop 1
    v_min_u32_dpp v20, v20, v20 row_shr:4 row_mask:0xf bank_mask:0xf
    s_nop 1
    v_min_u32_dpp v20, v20, v20 row_shr:8 row_mask:0xf bank_mask:0xf
    s_nop 1
    v_min_u32_dpp v20, v20, v20 row_bcast:15 row_mask:0xa bank_mask:0xf
    s_nop 1
    v_min_u32_dpp v20, v20, v20 row_bcast:31 row_mask:0xc bank_mask:0xf
    s_nop 0
    v_readlane_b32 s50, v20, 63
    s_sub_u32 s50, s42, s50
    s_sub_u32 s42, s50, 1
    v_sub_u32 v20, s42, v28
    v_sub_u32 v21, s42, v29
    v_sub_u32 v22, s42, v30
    v_min3_u32 v20, v20, v21, v22
    v_sub_u32 v21, s42, v31
    v_sub_u32 v22, s42, v32
    v_min3_u32 v20, v20, v21, v22
    v_sub_u32 v21, s42, v33
    v_sub_u32 v22, s42, v34
    v_min3_u32 v20, v20, v21, v22
    v_sub_u32 v21, s42, v35
    v_min_u32 v20, v20, v21
    s_nop 1
    v_min_u32_dpp v20, v20, v20 row_shr:1 row_mask:0xf bank_mask:0xf
    s_nop 1
    v_min_u32_dpp v20, v20, v20 row_shr:2 row_mask:0xf bank_mask:0xf
    s_nop 1
    v_min_u32_dpp v20, v20, v20 row_shr:4 row_mask:0xf bank_mask:0xf
    s_nop 1
    v_min_u32_dpp v20, v20, v20 row_shr:8 row_mask:0xf bank_mask:0xf
    s_nop 1
    v_min_u32_dpp v20, v20, v20 row_bcast:15 row_mask:0xa bank_mask:0xf
    s_nop 1
    v_min_u32_dpp v20, v20, v20 row_bcast:31 row_mask:0xc bank_mask:0xf
    s_nop 0
    v_readlane_b32 s51, v20, 63
    s_sub_u32 s51, s42, s51
    s_sub_u32 s42, s51, 1
    v_sub_u32 v20, s42, v28
    v_sub_u32 v21, s42, v29
    v_sub_u32 v22, s42, v30
    v_min3_u32 v20, v20, v21, v22
    v_sub_u32 v21, s42, v31
    v_sub_u32 v22, s42, v32
    v_min3_u32 v20, v20, v21, v22
    v_sub_u32 v21, s42, v33
    v_sub_u32 v22, s42, v34
    v_min3_u32 v20, v20, v21, v22
    v_sub_u32 v21, s42, v35
    v_min_u32 v20, v20, v21
    s_nop 1
    v_min_u32_dpp v20, v20, v20 row_shr:1 row_mask:0xf bank_mask:0xf
    s_nop 1
    v_min_u32_dpp v20, v20, v20 row_shr:2 row_mask:0xf bank_mask:0xf
    s_nop 1
    v_min_u32_dpp v20, v20, v20 row_shr:4 row_mask:0xf bank_mask:0xf
    s_nop 1
    v_min_u32_dpp v20, v20, v20 row_shr:8 row_mask:0xf bank_mask:0xf
    s_nop 1
    v_min_u32_dpp v20, v20, v20 row_bcast:15 row_mask:0xa bank_mask:0xf
    s_nop 1
    v_min_u32_dpp v20, v20, v20 row_bcast:31 row_mask:0xc bank_mask:0xf
    s_nop 0
    v_readlane_b32 s52, v20, 63
    s_sub_u32 s52, s42, s52
    s_sub_u32 s42, s52, 1
    v_sub_u32 v20, s42, v28
    v_sub_u32 v21, s42, v29
    v_sub_u32 v22, s42, v30
    v_min3_u32 v20, v20, v21, v22
    v_sub_u32 v21, s42, v31
    v_sub_u32 v22, s42, v32
    v_min3_u32 v20, v20, v21, v22
    v_sub_u32 v21, s42, v33
    v_sub_u32 v22, s42, v34
    v_min3_u32 v20, v20, v21, v22
    v_sub_u32 v21, s42, v35
    v_min_u32 v20, v20, v21
    s_nop 1
    v_min_u32_dpp v20, v20, v20 row_shr:1 row_mask:0xf bank_mask:0xf
    s_nop 1
    v_min_u32_dpp v20, v20, v20 row_shr:2 row_mask:0xf bank_mask:0xf
    s_nop 1
    v_min_u32_dpp v20, v20, v20 row_shr:4 row_mask:0xf bank_mask:0xf
    s_nop 1
    v_min_u32_dpp v20, v20, v20 row_shr:8 row_mask:0xf bank_mask:0xf
    s_nop 1
    v_min_u32_dpp v20, v20, v20 row_bcast:15 row_mask:0xa bank_mask:0xf
    s_nop 1
    v_min_u32_dpp v20, v20, v20 row_bcast:31 row_mask:0xc bank_mask:0xf
    s_nop 0
    v_readlane_b32 s53, v20, 63
    s_sub_u32 s53, s42, s53
    s_sub_u32 s42, s53, 1
    v_sub_u32 v20, s42, v28
    v_sub_u32 v21, s42, v29
    v_sub_u32 v22, s42, v30
    v_min3_u32 v20, v20, v21, v22
    v_sub_u32 v21, s42, v31
    v_sub_u32 v22, s42, v32
    v_min3_u32 v20, v20, v21, v22
    v_sub_u32 v21, s42, v33
    v_sub_u32 v22, s42, v34
    v_min3_u32 v20, v20, v21, v22
    v_sub_u32 v21, s42, v35
    v_min_u32 v20, v20, v21
    s_nop 1
    v_min_u32_dpp v20, v20, v20 row_shr:1 row_mask:0xf bank_mask:0xf
    s_nop 1
    v_min_u32_dpp v20, v20, v20 row_shr:2 row_mask:0xf bank_mask:0xf
    s_nop 1
    v_min_u32_dpp v20, v20, v20 row_shr:4 row_mask:0xf bank_mask:0xf
    s_nop 1
    v_min_u32_dpp v20, v20, v20 row_shr:8 row_mask:0xf bank_mask:0xf
    s_nop 1
    v_min_u32_dpp v20, v20, v20 row_bcast:15 row_mask:0xa bank_mask:0xf
    s_nop 1
    v_min_u32_dpp v20, v20, v20 row_bcast:31 row_mask:0xc bank_mask:0xf
    s_nop 0
    v_readlane_b32 s54, v20, 63
    s_sub_u32 s54, s42, s54
    s_sub_u32 s42, s54, 1
    v_sub_u32 v20, s42, v28
    v_sub_u32 v21, s42, v29
    v_sub_u32 v22, s42, v30
    v_min3_u32 v20, v20, v21, v22
    v_sub_u32 v21, s42, v31
    v_sub_u32 v22, s42, v32
    v_min3_u32 v20, v20, v21, v22
    v_sub_u32 v21, s42, v33
    v_sub_u32 v22, s42, v34
    v_min3_u32 v20, v20, v21, v22
    v_sub_u32 v21, s42, v35
    v_min_u32 v20, v20, v21
    s_nop 1
    v_min_u32_dpp v20, v20, v20 row_shr:1 row_mask:0xf bank_mask:0xf
    s_nop 1
    v_min_u32_dpp v20, v20, v20 row_shr:2 row_mask:0xf bank_mask:0xf
    s_nop 1
    v_min_u32_dpp v20, v20, v20 row_shr:4 row_mask:0xf bank_mask:0xf
    s_nop 1
    v_min_u32_dpp v20, v20, v20 row_shr:8 row_mask:0xf bank_mask:0xf
    s_nop 1
    v_min_u32_dpp v20, v20, v20 row_bcast:15 row_mask:0xa bank_mask:0xf
    s_nop 1
    v_min_u32_dpp v20, v20, v20 row_bcast:31 row_mask:0xc bank_mask:0xf
    s_nop 0
    v_readlane_b32 s55, v20, 63
    s_sub_u32 s55, s42, s55
    s_sub_u32 s42, s55, 1
    v_sub_u32 v20, s42, v28
    v_sub_u32 v21, s42, v29
    v_sub_u32 v22, s42, v30
    v_min3_u32 v20, v20, v21, v22
    v_sub_u32 v21, s42, v31
    v_sub_u32 v22, s42, v32
    v_min3_u32 v20, v20, v21, v22
    v_sub_u32 v21, s42, v33
    v_sub_u32 v22, s42, v34
    v_min3_u32 v20, v20, v21, v22
    v_sub_u32 v21, s42, v35
    v_min_u32 v20, v20, v21
    s_nop 1
    v_min_u32_dpp v20, v20, v20 row_shr:1 row_mask:0xf bank_mask:0xf
    s_nop 1
    v_min_u32_dpp v20, v20, v20 row_shr:2 row_mask:0xf bank_mask:0xf
    s_nop 1
    v_min_u32_dpp v20, v20, v20 row_shr:4 row_mask:0xf bank_mask:0xf
    s_nop 1
    v_min_u32_dpp v20, v20, v20 row_shr:8 row_mask:0xf bank_mask:0xf
    s_nop 1
    v_min_u32_dpp v20, v20, v20 row_bcast:15 row_mask:0xa bank_mask:0xf
    s_nop 1
    v_min_u32_dpp v20, v20, v20 row_bcast:31 row_mask:0xc bank_mask:0xf
    s_nop 0
    v_readlane_b32 s56, v20, 63
    s_sub_u32 s56, s42, s56
    s_sub_u32 s42, s56, 1
    v_sub_u32 v20, s42, v28
    v_sub_u32 v21, s42, v29
    v_sub_u32 v22, s42, v30
    v_min3_u32 v20, v20, v21, v22
    v_sub_u32 v21, s42, v31
    v_sub_u32 v22, s42, v32
    v_min3_u32 v20, v20, v21, v22
    v_sub_u32 v21, s42, v33
    v_sub_u32 v22, s42, v34
    v_min3_u32 v20, v20, v21, v22
    v_sub_u32 v21, s42, v35
    v_min_u32 v20, v20, v21
    s_nop 1
    v_min_u32_dpp v20, v20, v20 row_shr:1 row_mask:0xf bank_mask:0xf
    s_nop 1
    v_min_u32_dpp v20, v20, v20 row_shr:2 row_mask:0xf bank_mask:0xf
    s_nop 1
    v_min_u32_dpp v20, v20, v20 row_shr:4 row_mask:0xf bank_mask:0xf
    s_nop 1
    v_min_u32_dpp v20, v20, v20 row_shr:8 row_mask:0xf bank_mask:0xf
    s_nop 1
    v_min_u32_dpp v20, v20, v20 row_bcast:15 row_mask:0xa bank_mask:0xf
    s_nop 1
    v_min_u32_dpp v20, v20, v20 row_bcast:31 row_mask:0xc bank_mask:0xf
    s_nop 0
    v_readlane_b32 s57, v20, 63
    s_sub_u32 s57, s42, s57
    s_sub_u32 s42, s57, 1
    v_mov_b32 v20, s50
    v_writelane_b32 v20, s51, 1
    v_writelane_b32 v20, s52, 2
    v_writelane_b32 v20, s53, 3
    v_writelane_b32 v20, s54, 4
    v_writelane_b32 v20, s55, 5
    v_writelane_b32 v20, s56, 6
    v_writelane_b32 v20, s57, 7
    s_lshl_b32 s42, s5, 8
    s_add_u32 s42, s42, 86016
    v_lshl_add_u32 v21, v19, 2, s42
    ds_write_b32 v21, v20
    s_waitcnt lgkmcnt(0)
    s_branch L_rt_back_local
L_rt_merge:
    v_bfe_u32 v21, v19, 3, 2
    v_lshlrev_b32 v21, 8, v21
    v_and_b32 v20, 7, v19
    v_lshl_add_u32 v21, v20, 2, v21
    v_add_u32 v21, 86016, v21
    ds_read_b32 v20, v21
    s_waitcnt lgkmcnt(0)
    s_mov_b32 s42, -1
    v_sub_u32 v21, s42, v20
    s_nop 1
    v_min_u32_dpp v21, v21, v21 row_shr:1 row_mask:0xf bank_mask:0xf
    s_nop 1
    v_min_u32_dpp v21, v21, v21 row_shr:2 row_mask:0xf bank_mask:0xf
    s_nop 1
    v_min_u32_dpp v21, v21, v21 row_shr:4 row_mask:0xf bank_mask:0xf
    s_nop 1
    v_min_u32_dpp v21, v21, v21 row_shr:8 row_mask:0xf bank_mask:0xf
    s_nop 1
    v_min_u32_dpp v21, v21, v21 row_bcast:15 row_mask:0xa bank_mask:0xf
    s_nop 1
    v_min_u32_dpp v21, v21, v21 row_bcast:31 row_mask:0xc bank_mask:0xf
    s_nop 0
    v_readlane_b32 s50, v21, 63
    s_sub_u32 s50, s42, s50
    s_sub_u32 s42, s50, 1
    v_sub_u32 v21, s42, v20
    s_nop 1
    v_min_u32_dpp v21, v21, v21 row_shr:1 row_mask:0xf bank_mask:0xf
    s_nop 1
    v_min_u32_dpp v21, v21, v21 row_shr:2 row_mask:0xf bank_mask:0xf
    s_nop 1
    v_min_u32_dpp v21, v21, v21 row_shr:4 row_mask:0xf bank_mask:0xf
    s_nop 1
    v_min_u32_dpp v21, v21, v21 row_shr:8 row_mask:0xf bank_mask:0xf
    s_nop 1
    v_min_u32_dpp v21, v21, v21 row_bcast:15 row_mask:0xa bank_mask:0xf
    s_nop 1
    v_min_u32_dpp v21, v21, v21 row_bcast:31 row_mask:0xc bank_mask:0xf
    s_nop 0
    v_readlane_b32 s51, v21, 63
    s_sub_u32 s51, s42, s51
    s_sub_u32 s42, s51, 1
    v_sub_u32 v21, s42, v20
    s_nop 1
    v_min_u32_dpp v21, v21, v21 row_shr:1 row_mask:0xf bank_mask:0xf
    s_nop 1
    v_min_u32_dpp v21, v21, v21 row_shr:2 row_mask:0xf bank_mask:0xf
    s_nop 1
    v_min_u32_dpp v21, v21, v21 row_shr:4 row_mask:0xf bank_mask:0xf
    s_nop 1
    v_min_u32_dpp v21, v21, v21 row_shr:8 row_mask:0xf bank_mask:0xf
    s_nop 1
    v_min_u32_dpp v21, v21, v21 row_bcast:15 row_mask:0xa bank_mask:0xf
    s_nop 1
    v_min_u32_dpp v21, v21, v21 row_bcast:31 row_mask:0xc bank_mask:0xf
    s_nop 0
    v_readlane_b32 s52, v21, 63
    s_sub_u32 s52, s42, s52
    s_sub_u32 s42, s52, 1
    v_sub_u32 v21, s42, v20
    s_nop 1
    v_min_u32_dpp v21, v21, v21 row_shr:1 row_mask:0xf bank_mask:0xf
    s_nop 1
    v_min_u32_dpp v21, v21, v21 row_shr:2 row_mask:0xf bank_mask:0xf
    s_nop 1
    v_min_u32_dpp v21, v21, v21 row_shr:4 row_mask:0xf bank_mask:0xf
    s_nop 1
    v_min_u32_dpp v21, v21, v21 row_shr:8 row_mask:0xf bank_mask:0xf
    s_nop 1
    v_min_u32_dpp v21, v21, v21 row_bcast:15 row_mask:0xa bank_mask:0xf
    s_nop 1
    v_min_u32_dpp v21, v21, v21 row_bcast:31 row_mask:0xc bank_mask:0xf
    s_nop 0
    v_readlane_b32 s53, v21, 63
    s_sub_u32 s53, s42, s53
    s_sub_u32 s42, s53, 1
    v_sub_u32 v21, s42, v20
    s_nop 1
    v_min_u32_dpp v21, v21, v21 row_shr:1 row_mask:0xf bank_mask:0xf
    s_nop 1
    v_min_u32_dpp v21, v21, v21 row_shr:2 row_mask:0xf bank_mask:0xf
    s_nop 1
    v_min_u32_dpp v21, v21, v21 row_shr:4 row_mask:0xf bank_mask:0xf
    s_nop 1
    v_min_u32_dpp v21, v21, v21 row_shr:8 row_mask:0xf bank_mask:0xf
    s_nop 1
    v_min_u32_dpp v21, v21, v21 row_bcast:15 row_mask:0xa bank_mask:0xf
    s_nop 1
    v_min_u32_dpp v21, v21, v21 row_bcast:31 row_mask:0xc bank_mask:0xf
    s_nop 0
    v_readlane_b32 s54, v21, 63
    s_sub_u32 s54, s42, s54
    s_sub_u32 s42, s54, 1
    v_sub_u32 v21, s42, v20
    s_nop 1
    v_min_u32_dpp v21, v21, v21 row_shr:1 row_mask:0xf bank_mask:0xf
    s_nop 1
    v_min_u32_dpp v21, v21, v21 row_shr:2 row_mask:0xf bank_mask:0xf
    s_nop 1
    v_min_u32_dpp v21, v21, v21 row_shr:4 row_mask:0xf bank_mask:0xf
    s_nop 1
    v_min_u32_dpp v21, v21, v21 row_shr:8 row_mask:0xf bank_mask:0xf
    s_nop 1
    v_min_u32_dpp v21, v21, v21 row_bcast:15 row_mask:0xa bank_mask:0xf
    s_nop 1
    v_min_u32_dpp v21, v21, v21 row_bcast:31 row_mask:0xc bank_mask:0xf
    s_nop 0
    v_readlane_b32 s55, v21, 63
    s_sub_u32 s55, s42, s55
    s_sub_u32 s42, s55, 1
    v_sub_u32 v21, s42, v20
    s_nop 1
    v_min_u32_dpp v21, v21, v21 row_shr:1 row_mask:0xf bank_mask:0xf
    s_nop 1
    v_min_u32_dpp v21, v21, v21 row_shr:2 row_mask:0xf bank_mask:0xf
    s_nop 1
    v_min_u32_dpp v21, v21, v21 row_shr:4 row_mask:0xf bank_mask:0xf
    s_nop 1
    v_min_u32_dpp v21, v21, v21 row_shr:8 row_mask:0xf bank_mask:0xf
    s_nop 1
    v_min_u32_dpp v21, v21, v21 row_bcast:15 row_mask:0xa bank_mask:0xf
    s_nop 1
    v_min_u32_dpp v21, v21, v21 row_bcast:31 row_mask:0xc bank_mask:0xf
    s_nop 0
    v_readlane_b32 s56, v21, 63
    s_sub_u32 s56, s42, s56
    s_sub_u32 s42, s56, 1
    v_sub_u32 v21, s42, v20
    s_nop 1
    v_min_u32_dpp v21, v21, v21 row_shr:1 row_mask:0xf bank_mask:0xf
    s_nop 1
    v_min_u32_dpp v21, v21, v21 row_shr:2 row_mask:0xf bank_mask:0xf
    s_nop 1
    v_min_u32_dpp v21, v21, v21 row_shr:4 row_mask:0xf bank_mask:0xf
    s_nop 1
    v_min_u32_dpp v21, v21, v21 row_shr:8 row_mask:0xf bank_mask:0xf
    s_nop 1
    v_min_u32_dpp v21, v21, v21 row_bcast:15 row_mask:0xa bank_mask:0xf
    s_nop 1
    v_min_u32_dpp v21, v21, v21 row_bcast:31 row_mask:0xc bank_mask:0xf
    s_nop 0
    v_readlane_b32 s57, v21, 63
    s_sub_u32 s57, s42, s57
    s_sub_u32 s42, s57, 1
    v_mov_b32 v20, s50
    v_writelane_b32 v20, s51, 1
    v_writelane_b32 v20, s52, 2
    v_writelane_b32 v20, s53, 3
    v_writelane_b32 v20, s54, 4
    v_writelane_b32 v20, s55, 5
    v_writelane_b32 v20, s56, 6
    v_writelane_b32 v20, s57, 7
    v_lshlrev_b32 v21, 2, v19
    s_mov_b32 s42, 0x29b000
    s_mov_b64 exec, 0xff
    buffer_store_dword v20, v21, s[76:79], s42 offen sc1
    s_mov_b64 exec, -1
    s_branch L_rt_back_merge
L_site0:
    s_mov_b32 s43, m0
    s_mov_b32 m0, s38
    s_add_u32 s38, s38, 1024
    buffer_load_dwordx4 v24, s[16:19], s37 offen lds
    s_mov_b32 m0, s43
    s_add_u32 s37, s37, 221184
    s_cmp_eq_u32 s35, 9
    s_cselect_b32 s36, 4, s36
    s_branch L_site_back0
L_site1:
    s_mov_b32 s43, m0
    s_mov_b32 m0, s38
    s_add_u32 s38, s38, 1024
    buffer_load_dwordx4 v24, s[16:19], s37 offen lds
    s_mov_b32 m0, s43
    s_add_u32 s37, s37, 221184
    s_cmp_eq_u32 s35, 9
    s_cselect_b32 s36, 4, s36
    s_branch L_site_back1
L_once_pack:
    s_mov_b64 exec, 1
    buffer_store_dword v27, off, s[76:79], s75 sc1
    s_mov_b64 exec, -1
    s_branch L_once_back_pack
L_site2:
    s_mov_b32 s43, m0
    s_mov_b32 m0, s38
    s_add_u32 s38, s38, 1024
    buffer_load_dwordx4 v24, s[16:19], s37 offen lds
    s_mov_b32 m0, s43
    s_add_u32 s37, s37, 221184
    s_cmp_eq_u32 s35, 9
    s_cselect_b32 s36, 4, s36
    s_branch L_site_back2
L_site3:
    s_mov_b32 s43, m0
    s_mov_b32 m0, s38
    s_add_u32 s38, s38, 1024
    buffer_load_dwordx4 v24, s[16:19], s37 offen lds
    s_mov_b32 m0, s43
    s_add_u32 s37, s37, 221184
    s_cmp_eq_u32 s35, 9
    s_cselect_b32 s36, 4, s36
    s_branch L_site_back3
L_spin_pack:
    s_mov_b32 s7, 32768
L_retry_pack:
    s_sleep 2
    buffer_load_dwordx4 v[28:31], v32, s[76:79], 0 offen sc1
    s_waitcnt vmcnt(0)
    v_min3_u32 v28, v28, v29, v30
    v_min_u32 v28, v28, v31
    v_cmp_gt_u32 vcc, 1, v28
    s_and_b64 vcc, vcc, exec
    s_cbranch_scc0 L_back_pack
    s_sub_u32 s7, s7, 1
    s_cbranch_scc0 L_retry_pack
    s_branch L_back_pack
L_spin_sel:
    s_mov_b32 s7, 32768
L_retry_sel:
    s_sleep 2
    buffer_load_dword v249, v21, s[76:79], 0 offen sc1
    s_waitcnt vmcnt(0)
    v_cmp_eq_u32 vcc, 0, v249
    s_and_b64 vcc, vcc, exec
    s_cbranch_scc0 L_back_sel
    s_sub_u32 s7, s7, 1
    s_cbranch_scc0 L_retry_sel
    s_branch L_back_sel
L_spin_ffn:
    s_mov_b32 s7, 32768
L_retry_ffn:
    s_sleep 2
    buffer_load_dwordx4 v[252:255], v20, s[76:79], 0 offen sc1
    s_waitcnt vmcnt(0)
    v_min3_u32 v252, v252, v253, v254
    v_min_u32 v252, v252, v255
    v_cmp_gt_u32 vcc, 2, v252
    s_and_b64 vcc, vcc, exec
    s_cbranch_scc0 L_back_ffn
    s_sub_u32 s7, s7, 1
    s_cbranch_scc0 L_retry_ffn
    s_branch L_back_ffn
L_spin_o:
    s_mov_b32 s7, 32768
L_retry_o:
    s_sleep 2
    buffer_load_dwordx4 v[252:255], v1, s[76:79], 0 offen sc1
    s_waitcnt vmcnt(0)
    v_min3_u32 v252, v252, v253, v254
    v_min_u32 v252, v252, v255
    v_cmp_gt_u32 vcc, 1, v252
    s_and_b64 vcc, vcc, exec
    s_cbranch_scc0 L_back_o
    s_sub_u32 s7, s7, 1
    s_cbranch_scc0 L_retry_o
    s_branch L_back_o
L_spin_upd:
    s_mov_b32 s7, 32768
L_retry_upd:
    s_sleep 2
    buffer_load_dwordx2 v[20:21], v11, s[76:79], 0 offen offset:0 sc1
    buffer_load_dwordx2 v[246:247], v11, s[76:79], 0 offen offset:32 sc1
    buffer_load_dwordx2 v[248:249], v11, s[76:79], 0 offen offset:64 sc1
    buffer_load_dwordx2 v[252:253], v11, s[76:79], 0 offen offset:96 sc1
    buffer_load_dwordx2 v[254:255], v11, s[76:79], 0 offen offset:128 sc1
    s_waitcnt vmcnt(0)
    v_max3_u32 v1, v20, v21, v246
    v_max3_u32 v1, v1, v247, v248
    v_max3_u32 v1, v1, v249, v252
    v_max3_u32 v1, v1, v253, v254
    v_max_u32 v1, v1, v255
    v_cmp_eq_u32 vcc, -1, v1
    s_and_b64 vcc, vcc, exec
    s_cbranch_scc0 L_back_upd
    s_sub_u32 s7, s7, 1
    s_cbranch_scc0 L_retry_upd
    s_branch L_back_upd
L_spin_half:
    s_mov_b32 s7, 32768
L_retry_half:
    s_sleep 2
    buffer_load_dword v1, off, s[76:79], s37 sc1
    s_waitcnt vmcnt(0)
    v_cmp_ne_u32 vcc, 3, v1
    s_and_b64 vcc, vcc, exec
    s_cbranch_scc0 L_back_half
    s_sub_u32 s7, s7, 1
    s_cbranch_scc0 L_retry_half
    s_branch L_back_half
L_code_end:
    s_endpgm

.section .rodata,"a"
.p2align 6
.amdhsa_kernel recurrent_scan__mha_block_cached__moe_arch_mod__prompt_kernel
  .amdhsa_next_free_vgpr 512
  .amdhsa_next_free_sgpr 102
  .amdhsa_accum_offset 256
  .amdhsa_group_segment_fixed_size 0
  .amdhsa_kernarg_size 104
  .amdhsa_user_sgpr_count 2
  .amdhsa_user_sgpr_kernarg_segment_ptr 1
  .amdhsa_system_sgpr_workgroup_id_x 1
  .amdhsa_float_denorm_mode_32 3
.end_amdhsa_kernel
```

```asm
; @launch grid=(256,1,1) block=(256,1,1) lds=163840
.amdgcn_target "amdgcn-amd-amdhsa--gfx950"
.text
.globl recurrent_scan__mha_block_cached__moe_arch_mod__prompt_kernel
.p2align 8
.type recurrent_scan__mha_block_cached__moe_arch_mod__prompt_kernel,@function
recurrent_scan__mha_block_cached__moe_arch_mod__prompt_kernel:
    s_cmp_ge_u32 s2, 256
    s_cbranch_scc1 L_end
    s_load_dwordx16 s[48:63], s[0:1], 0
    s_load_dwordx8 s[64:71], s[0:1], 64
    s_load_dwordx2 s[72:73], s[0:1], 96
    s_getpc_b64 s[40:41]
L_touch:
    s_bfe_u32 s42, s2, 0x20003
    s_lshl_b32 s42, s42, 8
    v_add_u32 v252, s42, v0
    v_min_u32 v252, (L_code_end - L_touch) / 128, v252
    v_lshlrev_b32 v252, 7, v252
    global_load_dword a120, v252, s[40:41]
    v_lshrrev_b32 v116, 6, v0
    v_and_b32 v19, 63, v0
    s_and_b32 s40, s2, 7
    v_readfirstlane_b32 s5, v116
    s_lshl_b32 s40, s40, 2
    s_bfe_u32 s41, s2, 0x20003
    s_add_u32 s3, s40, s41
    s_lshr_b32 s4, s2, 5
    s_lshl_b32 s74, s4, 5
    s_add_u32 s6, s74, s3
    v_lshrrev_b32 v118, 4, v19
    v_and_b32 v117, 15, v19
    v_lshlrev_b32 v119, 1, v118
    v_xor_b32 v119, v117, v119
    s_lshl_b32 s42, s5, 4
    v_add_u32 v120, s42, v118
    v_lshlrev_b32 v121, 4, v119
    v_xor_b32 v122, 0x80, v121
    v_lshl_add_u32 v123, v120, 13, v121
    v_lshl_add_u32 v116, v120, 13, v122
    v_add_u32 v44, 0, v123
    v_add_u32 v45, 31744, v123
    v_add_u32 v46, 63488, v116
    v_add_u32 v47, 95232, v116
    v_lshl_add_u32 v17, v120, 8, v121
    v_lshl_add_u32 v18, v120, 8, v122
    v_xor_b32 v117, v117, v118
    v_xor_b32 v121, 0, v117
    v_lshlrev_b32 v121, 4, v121
    v_lshl_add_u32 v13, v120, 8, v121
    v_xor_b32 v121, 4, v117
    v_lshlrev_b32 v121, 4, v121
    v_lshl_add_u32 v14, v120, 8, v121
    v_xor_b32 v121, 8, v117
    v_lshlrev_b32 v121, 4, v121
    v_lshl_add_u32 v15, v120, 8, v121
    v_xor_b32 v121, 12, v117
    v_lshlrev_b32 v121, 4, v121
    v_lshl_add_u32 v16, v120, 8, v121
    v_lshrrev_b32 v116, 3, v19
    v_and_b32 v117, 7, v19
    v_xor_b32 v117, v117, v118
    v_mul_u32_u24 v116, 1280, v116
    s_mul_i32 s42, s5, 81920
    v_lshl_add_u32 v119, v117, 4, v116
    v_xor_b32 v117, 4, v117
    v_lshl_add_u32 v120, v117, 4, v116
    v_add_u32 v119, s42, v119
    v_add_u32 v120, s42, v120
    v_add_u32 v36, 0, v119
    v_add_u32 v37, 9216, v120
    v_add_u32 v38, 18432, v119
    v_add_u32 v39, 27648, v120
    v_add_u32 v40, 40960, v119
    v_add_u32 v41, 50176, v120
    v_add_u32 v42, 59392, v119
    v_add_u32 v43, 68608, v120
    s_lshl_b32 s43, s6, 2
    s_add_u32 s43, s43, s5
    s_lshl_b32 s43, s43, 1
    s_mul_i32 s38, s5, 24576
    s_lshl_b32 s40, s5, 12
    s_add_u32 s39, s40, 98304
    s_mov_b32 s34, s39
    s_mov_b32 s28, 0
    s_mov_b32 s29, 0
    s_and_b32 s40, s3, 31
    s_mul_i32 s40, s40, 10
    s_lshr_b32 s40, s40, 5
    s_lshl_b32 s36, s40, 7
    s_waitcnt lgkmcnt(0)
    s_mov_b32 s88, s48
    s_mov_b32 s89, s49
    s_mov_b32 s90, 0x280000
    s_mov_b32 s91, 0x20000
    s_mov_b32 s92, s60
    s_mov_b32 s93, s61
    s_mov_b32 s94, 0x500
    s_mov_b32 s95, 0x20000
    s_lshl_b32 s40, s3, 8
    s_add_u32 s20, s54, s40
    s_addc_u32 s21, s55, 0
    s_mov_b32 s22, 0x4fe100
    s_mov_b32 s23, 0x20000
    s_mul_i32 s40, s4, 327680
    s_add_u32 s16, s48, s40
    s_addc_u32 s17, s49, 0
    s_mov_b32 s18, 0x50000
    s_mov_b32 s19, 0x20000
    s_add_u32 m0, s39, 0
    s_mov_b32 s37, 0
    buffer_load_dwordx4 v44, s[20:23], s37 offen offset:0 lds
    buffer_load_dwordx4 v45, s[20:23], s37 offen offset:1024 lds
    buffer_load_dwordx4 v46, s[20:23], s37 offen offset:2048 lds
    buffer_load_dwordx4 v47, s[20:23], s37 offen offset:3072 lds
    s_add_u32 m0, s38, 0
    s_mov_b32 s36, 0
    buffer_load_dwordx4 v36, s[16:19], s36 offen offset:0 lds
    buffer_load_dwordx4 v37, s[16:19], s36 offen offset:1024 lds
    buffer_load_dwordx4 v38, s[16:19], s36 offen offset:2048 lds
    buffer_load_dwordx4 v39, s[16:19], s36 offen offset:3072 lds
    s_add_u32 m0, s38, 4096
    s_nop 0
    buffer_load_dwordx4 v40, s[16:19], s36 offen offset:0 lds
    buffer_load_dwordx4 v41, s[16:19], s36 offen offset:1024 lds
    buffer_load_dwordx4 v42, s[16:19], s36 offen offset:2048 lds
    buffer_load_dwordx4 v43, s[16:19], s36 offen offset:3072 lds
    v_lshrrev_b32 v108, 5, v19
    v_add_u32 v108, s43, v108
    v_and_b32 v110, 31, v19
    v_lshlrev_b32 v110, 3, v110
    v_mul_u32_u24 v109, 1280, v108
    v_add_u32 v109, v109, v110
    buffer_load_dwordx2 v[60:61], v109, s[88:91], 0 offen offset:0
    buffer_load_dwordx2 v[62:63], v109, s[88:91], 0 offen offset:256
    buffer_load_dwordx2 v[64:65], v109, s[88:91], 0 offen offset:512
    buffer_load_dwordx2 v[66:67], v109, s[88:91], 0 offen offset:768
    buffer_load_dwordx2 v[68:69], v109, s[88:91], 0 offen offset:1024
    buffer_load_dwordx2 v[70:71], v110, s[92:95], 0 offen offset:0
    buffer_load_dwordx2 v[72:73], v110, s[92:95], 0 offen offset:256
    buffer_load_dwordx2 v[74:75], v110, s[92:95], 0 offen offset:512
    buffer_load_dwordx2 v[76:77], v110, s[92:95], 0 offen offset:768
    buffer_load_dwordx2 v[78:79], v110, s[92:95], 0 offen offset:1024
    s_lshl_b32 s40, s3, 19
    s_add_u32 s8, s50, s40
    s_addc_u32 s9, s51, 0
    s_mov_b32 s10, 0x80000
    s_mov_b32 s11, 0x20000
    s_add_u32 s12, s52, s40
    s_addc_u32 s13, s53, 0
    s_mov_b32 s14, 0x80000
    s_mov_b32 s15, 0x20000
    s_and_b32 s40, s5, 1
    s_lshl_b32 s40, s40, 12
    s_cmp_ge_u32 s5, 2
    s_cselect_b32 s30, 32, 8
    s_cselect_b32 s31, 40, 16
    s_cselect_b32 s32, 0, 56
    s_cselect_b32 s33, 48, 24
    s_lshl_b32 s30, s30, 10
    s_add_u32 s30, s30, s40
    s_lshl_b32 s31, s31, 10
    s_add_u32 s31, s31, s40
    s_lshl_b32 s32, s32, 10
    s_add_u32 s32, s32, s40
    s_lshl_b32 s33, s33, 10
    s_add_u32 s33, s33, s40
    s_mov_b32 s44, 0x3e0293ee
    s_mov_b32 s45, 4096
    s_mov_b32 s76, s72
    s_mov_b32 s77, s73
    s_mov_b32 s78, 0x2500000
    s_mov_b32 s79, 0x20000
    s_mov_b32 s92, s70
    s_mov_b32 s93, s71
    s_mov_b32 s94, 0x100
    s_mov_b32 s95, 0x20000
    s_lshl_b32 s41, s4, 2
    s_add_u32 s41, s41, s5
    s_lshl_b32 s40, s41, 5
    s_add_u32 s40, s40, s3
    s_lshl_b32 s40, s40, 14
    s_add_u32 s40, s40, 0x400000
    s_add_u32 s24, s72, s40
    s_addc_u32 s25, s73, 0
    s_mov_b32 s26, 0x4000
    s_mov_b32 s27, 0x20000
    s_and_b32 s42, s3, 3
    s_lshl_b32 s42, s42, 2
    s_lshr_b32 s40, s6, 2
    s_lshl_b32 s40, s40, 7
    s_add_u32 s40, s40, s42
    s_add_u32 s75, s40, 0x290000
    s_lshr_b32 s40, s3, 2
    s_lshl_b32 s40, s40, 7
    s_add_u32 s40, s40, s42
    s_lshl_b32 s42, s41, 10
    s_add_u32 s40, s40, s42
    s_add_u32 s58, s40, 0x292000
    s_cmp_eq_u32 s5, 0
    s_cselect_b32 s59, 5, 8
    s_lshl_b32 s41, s41, 10
    s_add_u32 s46, s41, 0x280000
    v_lshrrev_b32 v116, 4, v19
    v_and_b32 v117, 15, v19
    v_lshlrev_b32 v59, 4, v117
    v_xor_b32 v118, v116, v117
    v_lshlrev_b32 v119, 8, v117
    v_add_u32 v119, 98304, v119
    s_add_u32 s41, s5, 0
    s_and_b32 s41, s41, 3
    s_lshl_b32 s41, s41, 2
    v_xor_b32 v120, s41, v118
    v_lshl_add_u32 v1, v120, 4, v119
    s_add_u32 s41, s5, 1
    s_and_b32 s41, s41, 3
    s_lshl_b32 s41, s41, 2
    v_xor_b32 v120, s41, v118
    v_lshl_add_u32 v2, v120, 4, v119
    s_add_u32 s41, s5, 2
    s_and_b32 s41, s41, 3
    s_lshl_b32 s41, s41, 2
    v_xor_b32 v120, s41, v118
    v_lshl_add_u32 v3, v120, 4, v119
    s_add_u32 s41, s5, 3
    s_and_b32 s41, s41, 3
    s_lshl_b32 s41, s41, 2
    v_xor_b32 v120, s41, v118
    v_lshl_add_u32 v4, v120, 4, v119
    v_lshrrev_b32 v118, 1, v117
    v_xor_b32 v118, v116, v118
    v_lshlrev_b32 v119, 7, v117
    v_add_u32 v119, s38, v119
    v_xor_b32 v120, 0, v118
    v_lshl_add_u32 v48, v120, 4, v119
    v_xor_b32 v120, 4, v118
    v_lshl_add_u32 v49, v120, 4, v119
    v_bfe_u32 v118, v19, 2, 2
    v_bfe_u32 v119, v19, 2, 3
    v_and_b32 v120, 3, v19
    v_lshlrev_b32 v120, 3, v120
    v_lshl_add_u32 v121, v116, 2, v118
    v_lshl_add_u32 v121, v121, 8, v120
    v_lshl_add_u32 v122, v116, 3, v118
    v_lshl_add_u32 v122, v122, 8, v120
    v_add_u32 v122, 98304, v122
    v_xor_b32 v123, 0, v119
    v_lshl_add_u32 v5, v123, 5, v121
    v_xor_b32 v123, 1, v119
    v_lshl_add_u32 v6, v123, 5, v121
    v_xor_b32 v123, 2, v119
    v_lshl_add_u32 v7, v123, 5, v121
    v_xor_b32 v123, 3, v119
    v_lshl_add_u32 v8, v123, 5, v121
    v_xor_b32 v123, 4, v119
    v_lshl_add_u32 v9, v123, 5, v121
    v_xor_b32 v123, 5, v119
    v_lshl_add_u32 v10, v123, 5, v121
    v_xor_b32 v123, 6, v119
    v_lshl_add_u32 v11, v123, 5, v121
    v_xor_b32 v123, 7, v119
    v_lshl_add_u32 v12, v123, 5, v121
    s_lshl_b32 s42, s5, 1
    s_add_u32 s41, s42, 0
    s_and_b32 s41, s41, 7
    v_xor_b32 v123, s41, v119
    v_lshl_add_u32 v50, v123, 5, v122
    s_add_u32 s41, s42, 1
    s_and_b32 s41, s41, 7
    v_xor_b32 v123, s41, v119
    v_lshl_add_u32 v51, v123, 5, v122
    s_add_u32 s41, s42, 2
    s_and_b32 s41, s41, 7
    v_xor_b32 v123, s41, v119
    v_lshl_add_u32 v52, v123, 5, v122
    s_add_u32 s41, s42, 3
    s_and_b32 s41, s41, 7
    v_xor_b32 v123, s41, v119
    v_lshl_add_u32 v53, v123, 5, v122
    s_add_u32 s41, s42, 4
    s_and_b32 s41, s41, 7
    v_xor_b32 v123, s41, v119
    v_lshl_add_u32 v54, v123, 5, v122
    s_add_u32 s41, s42, 5
    s_and_b32 s41, s41, 7
    v_xor_b32 v123, s41, v119
    v_lshl_add_u32 v55, v123, 5, v122
    s_add_u32 s41, s42, 6
    s_and_b32 s41, s41, 7
    v_xor_b32 v123, s41, v119
    v_lshl_add_u32 v56, v123, 5, v122
    s_add_u32 s41, s42, 7
    s_and_b32 s41, s41, 7
    v_xor_b32 v123, s41, v119
    v_lshl_add_u32 v57, v123, 5, v122
    s_lshl_b32 s41, s5, 7
    s_add_u32 s41, s41, 86016
    v_lshl_add_u32 v58, v116, 4, s41
    v_mov_b32 v32, 0x3f803f80
    v_mov_b32 v33, 0x3f803f80
    v_mov_b32 v34, 0x3f803f80
    v_mov_b32 v35, 0x3f803f80
    v_and_b32 v120, 1, v19
    v_cmp_eq_u32 vcc, 0, v120
    v_mov_b32 v121, 0x44444444
    v_mov_b32 v122, 0xeeeeeeee
    v_cndmask_b32 v248, v122, v121, vcc
    v_and_b32 v120, 2, v19
    v_cmp_eq_u32 vcc, 0, v120
    v_mov_b32 v27, 1
    v_mov_b32 v28, 0
    v_cndmask_b32 v244, 0, v32, vcc
    v_cndmask_b32 v245, 0, v32, vcc
    v_cndmask_b32 v246, 0, v32, vcc
    v_cndmask_b32 v247, 0, v32, vcc
    v_accvgpr_write_b32 a224, 0
    v_accvgpr_write_b32 a225, 0
    v_accvgpr_write_b32 a226, 0
    v_accvgpr_write_b32 a227, 0
    v_accvgpr_write_b32 a228, 0
    v_accvgpr_write_b32 a229, 0
    v_accvgpr_write_b32 a230, 0
    v_accvgpr_write_b32 a231, 0
    v_accvgpr_write_b32 a232, 0
    v_accvgpr_write_b32 a233, 0
    v_accvgpr_write_b32 a234, 0
    v_accvgpr_write_b32 a235, 0
    v_accvgpr_write_b32 a236, 0
    v_accvgpr_write_b32 a237, 0
    v_accvgpr_write_b32 a238, 0
    v_accvgpr_write_b32 a239, 0
    s_mul_i32 s47, s5, 5120
    s_mov_b32 s96, s56
    s_mov_b32 s97, s57
    s_mov_b32 s98, 0x500000
    s_mov_b32 s99, 0x20000
    s_lshr_b32 s40, s6, 1
    s_and_b32 s41, s6, 1
    s_lshl_b32 s41, s41, 2
    s_add_u32 s41, s41, s5
    s_add_u32 s47, s47, 65536
    s_mul_i32 s42, s40, 40960
    s_mul_i32 s43, s41, 160
    s_add_u32 s42, s42, s43
    v_add_u32 v25, 0, v19
    v_mul_u32_u24 v26, 6554, v25
    v_lshrrev_b32 v26, 16, v26
    v_mul_u32_u24 v20, 1120, v26
    v_lshl_add_u32 v20, v25, 4, v20
    v_add_u32 v20, s42, v20
    v_add_u32 v25, 64, v19
    v_mul_u32_u24 v26, 6554, v25
    v_lshrrev_b32 v26, 16, v26
    v_mul_u32_u24 v21, 1120, v26
    v_lshl_add_u32 v21, v25, 4, v21
    v_add_u32 v21, s42, v21
    v_add_u32 v25, 128, v19
    v_mul_u32_u24 v26, 6554, v25
    v_lshrrev_b32 v26, 16, v26
    v_mul_u32_u24 v22, 1120, v26
    v_lshl_add_u32 v22, v25, 4, v22
    v_add_u32 v22, s42, v22
    v_add_u32 v25, 192, v19
    v_mul_u32_u24 v26, 6554, v25
    v_lshrrev_b32 v26, 16, v26
    v_mul_u32_u24 v23, 1120, v26
    v_lshl_add_u32 v23, v25, 4, v23
    v_add_u32 v23, s42, v23
    v_add_u32 v25, 256, v19
    v_mul_u32_u24 v26, 6554, v25
    v_lshrrev_b32 v26, 16, v26
    v_mul_u32_u24 v24, 1120, v26
    v_lshl_add_u32 v24, v25, 4, v24
    v_add_u32 v24, s42, v24
    v_lshrrev_b32 v25, 2, v19
    v_mul_u32_u24 v25, 160, v25
    v_and_b32 v26, 3, v19
    v_lshl_add_u32 v25, v26, 3, v25
    v_add_u32 v25, s47, v25
    s_lshl_b32 s42, s41, 7
    s_add_u32 s42, s42, s40
    s_mul_i32 s42, s42, 5120
    s_add_u32 s42, s42, 0x1400000
    v_lshlrev_b32 v26, 4, v19
    v_add_u32 v26, s42, v26
    s_add_u32 m0, s39, 16384
    s_mov_b32 s37, 524288
    buffer_load_dwordx4 v44, s[20:23], s37 offen offset:0 lds
    buffer_load_dwordx4 v45, s[20:23], s37 offen offset:1024 lds
    buffer_load_dwordx4 v46, s[20:23], s37 offen offset:2048 lds
    buffer_load_dwordx4 v47, s[20:23], s37 offen offset:3072 lds
    s_add_u32 m0, s38, 8192
    s_mov_b32 s36, 128
    buffer_load_dwordx4 v36, s[16:19], s36 offen offset:0 lds
    buffer_load_dwordx4 v37, s[16:19], s36 offen offset:1024 lds
    buffer_load_dwordx4 v38, s[16:19], s36 offen offset:2048 lds
    buffer_load_dwordx4 v39, s[16:19], s36 offen offset:3072 lds
    s_add_u32 m0, s38, 12288
    s_nop 0
    buffer_load_dwordx4 v40, s[16:19], s36 offen offset:0 lds
    buffer_load_dwordx4 v41, s[16:19], s36 offen offset:1024 lds
    buffer_load_dwordx4 v42, s[16:19], s36 offen offset:2048 lds
    buffer_load_dwordx4 v43, s[16:19], s36 offen offset:3072 lds
    s_add_u32 m0, s39, 32768
    s_mov_b32 s37, 1048576
    buffer_load_dwordx4 v44, s[20:23], s37 offen offset:0 lds
    buffer_load_dwordx4 v45, s[20:23], s37 offen offset:1024 lds
    buffer_load_dwordx4 v46, s[20:23], s37 offen offset:2048 lds
    buffer_load_dwordx4 v47, s[20:23], s37 offen offset:3072 lds
    s_waitcnt vmcnt(26)
    s_barrier
    ds_read_b64_tr_b16 a[0:1], v50 offset:0
    ds_read_b64_tr_b16 a[2:3], v50 offset:1024
    ds_read_b128 a[32:35], v48 offset:0
    ds_read_b128 a[36:39], v48 offset:2048
    ds_read_b128 a[40:43], v48 offset:4096
    ds_read_b128 a[44:47], v48 offset:6144
    ds_read_b64_tr_b16 a[4:5], v51 offset:0
    ds_read_b64_tr_b16 a[6:7], v51 offset:1024
    ds_read_b64_tr_b16 a[8:9], v52 offset:0
    ds_read_b64_tr_b16 a[10:11], v52 offset:1024
    ds_read_b64_tr_b16 a[12:13], v53 offset:0
    ds_read_b64_tr_b16 a[14:15], v53 offset:1024
    ds_read_b64_tr_b16 a[16:17], v54 offset:0
    ds_read_b64_tr_b16 a[18:19], v54 offset:1024
    ds_read_b64_tr_b16 a[20:21], v55 offset:0
    ds_read_b64_tr_b16 a[22:23], v55 offset:1024
    ds_read_b64_tr_b16 a[24:25], v56 offset:0
    ds_read_b64_tr_b16 a[26:27], v56 offset:1024
    ds_read_b64_tr_b16 a[28:29], v57 offset:0
    ds_read_b64_tr_b16 a[30:31], v57 offset:1024
    s_waitcnt lgkmcnt(0)
    v_mfma_f32_16x16x32_bf16 v[100:103], a[0:3], v[32:35], 0
    s_waitcnt vmcnt(16)
    ds_read_b64_tr_b16 a[48:49], v50 offset:8192
    v_mfma_f32_16x16x32_bf16 v[104:107], a[4:7], v[32:35], 0
    s_add_u32 m0, s38, 16384
    s_mov_b32 s36, 256
    ds_read_b64_tr_b16 a[50:51], v50 offset:9216
    v_mfma_f32_16x16x32_bf16 v[116:119], a[0:3], a[32:35], 0
    s_lshl_b32 s40, s6, 7
    buffer_load_dwordx4 v36, s[16:19], s36 offen offset:0 lds
    v_mfma_f32_16x16x32_bf16 v[148:151], a[0:3], a[36:39], 0
    s_add_u32 s41, s40, 0x292000
    ds_read_b128 a[80:83], v49 offset:0
    v_mfma_f32_16x16x32_bf16 v[180:183], a[0:3], a[40:43], 0
    s_add_u32 s40, s40, 0x290000
    ds_read_b128 a[84:87], v49 offset:2048
    v_mfma_f32_16x16x32_bf16 v[212:215], a[0:3], a[44:47], 0
    s_cmp_lt_u32 s6, 64
    s_cselect_b32 s40, s40, 0x2500000
    buffer_load_dwordx4 v37, s[16:19], s36 offen offset:1024 lds
    v_mfma_f32_16x16x32_bf16 v[216:219], a[4:7], a[44:47], 0
    s_cmp_eq_u32 s5, 1
    s_cselect_b32 s40, s40, 0x2500000
    ds_read_b128 a[88:91], v49 offset:4096
    v_mfma_f32_16x16x32_bf16 v[184:187], a[4:7], a[40:43], 0
    s_cmp_eq_u32 s5, 0
    s_cselect_b32 s40, s41, s40
    ds_read_b128 a[92:95], v49 offset:6144
    v_mfma_f32_16x16x32_bf16 v[152:155], a[4:7], a[36:39], 0
    s_add_u32 s41, s41, 0xe000
    ds_read_b64_tr_b16 a[52:53], v51 offset:8192
    v_mfma_f32_16x16x32_bf16 v[120:123], a[4:7], a[32:35], 0
    s_cmp_eq_u32 s5, 3
    s_cselect_b32 s40, s41, s40
    buffer_load_dwordx4 v38, s[16:19], s36 offen offset:2048 lds
    v_mfma_f32_16x16x32_bf16 v[124:127], a[8:11], a[32:35], 0
    s_lshl_b32 s41, s6, 2
    ds_read_b64_tr_b16 a[54:55], v51 offset:9216
    v_mfma_f32_16x16x32_bf16 v[156:159], a[8:11], a[36:39], 0
    s_add_u32 s41, s41, s5
    ds_read_b64_tr_b16 a[56:57], v52 offset:8192
    v_mfma_f32_16x16x32_bf16 v[188:191], a[8:11], a[40:43], 0
    s_cmp_eq_u32 s41, 1022
    s_cselect_b32 s40, 0x29b000, s40
    ds_read_b64_tr_b16 a[58:59], v52 offset:9216
    v_mfma_f32_16x16x32_bf16 v[220:223], a[8:11], a[44:47], 0
    s_lshl_b32 s41, s6, 7
    buffer_load_dwordx4 v39, s[16:19], s36 offen offset:3072 lds
    v_mfma_f32_16x16x32_bf16 v[224:227], a[12:15], a[44:47], 0
    s_add_u32 s41, s41, 0x29c000
    ds_read_b64_tr_b16 a[60:61], v53 offset:8192
    v_mfma_f32_16x16x32_bf16 v[192:195], a[12:15], a[40:43], 0
    s_xor_b32 s42, s5, 2
    ds_read_b64_tr_b16 a[62:63], v53 offset:9216
    v_mfma_f32_16x16x32_bf16 v[160:163], a[12:15], a[36:39], 0
    s_add_u32 m0, s38, 20480
    ds_read_b64_tr_b16 a[64:65], v54 offset:8192
    v_mfma_f32_16x16x32_bf16 v[128:131], a[12:15], a[32:35], 0
    s_lshl_b32 s42, s42, 8
    buffer_load_dwordx4 v40, s[16:19], s36 offen offset:0 lds
    v_mfma_f32_16x16x32_bf16 v[132:135], a[16:19], a[32:35], 0
    s_add_u32 s42, s42, s6
    ds_read_b64_tr_b16 a[66:67], v54 offset:9216
    v_mfma_f32_16x16x32_bf16 v[164:167], a[16:19], a[36:39], 0
    s_cmp_lt_u32 s42, 80
    s_cselect_b32 s40, s41, s40
    s_cselect_b32 s41, -1, 0
    ds_read_b64_tr_b16 a[68:69], v55 offset:8192
    v_mov_b32 v28, s41
    v_lshlrev_b32 v29, 2, v19
    v_mfma_f32_16x16x32_bf16 v[196:199], a[16:19], a[40:43], 0
    buffer_load_dwordx4 v41, s[16:19], s36 offen offset:1024 lds
    s_mov_b32 exec_hi, 0
    buffer_store_dword v28, v29, s[76:79], s40 offen sc1
    s_mov_b32 exec_hi, -1
    v_lshlrev_b32 v80, 16, v60
    v_and_b32 v81, 0xffff0000, v60
    v_lshlrev_b32 v82, 16, v61
    v_and_b32 v83, 0xffff0000, v61
    v_lshlrev_b32 v84, 16, v62
    v_and_b32 v85, 0xffff0000, v62
    v_mfma_f32_16x16x32_bf16 v[228:231], a[16:19], a[44:47], 0
    ds_read_b64_tr_b16 a[70:71], v55 offset:9216
    v_lshlrev_b32 v86, 16, v63
    v_mfma_f32_16x16x32_bf16 v[232:235], a[20:23], a[44:47], 0
    ds_read_b64_tr_b16 a[72:73], v56 offset:8192
    v_and_b32 v87, 0xffff0000, v63
    v_lshlrev_b32 v88, 16, v64
    v_mfma_f32_16x16x32_bf16 v[200:203], a[20:23], a[40:43], 0
    ds_read_b64_tr_b16 a[74:75], v56 offset:9216
    v_and_b32 v89, 0xffff0000, v64
    v_mfma_f32_16x16x32_bf16 v[168:171], a[20:23], a[36:39], 0
    buffer_load_dwordx4 v42, s[16:19], s36 offen offset:2048 lds
    v_lshlrev_b32 v90, 16, v65
    v_mfma_f32_16x16x32_bf16 v[136:139], a[20:23], a[32:35], 0
    ds_read_b64_tr_b16 a[76:77], v57 offset:8192
    v_and_b32 v91, 0xffff0000, v65
    v_lshlrev_b32 v92, 16, v66
    v_mfma_f32_16x16x32_bf16 v[140:143], a[24:27], a[32:35], 0
    ds_read_b64_tr_b16 a[78:79], v57 offset:9216
    v_and_b32 v93, 0xffff0000, v66
    v_mfma_f32_16x16x32_bf16 v[172:175], a[24:27], a[36:39], 0
    v_lshlrev_b32 v94, 16, v67
    v_and_b32 v95, 0xffff0000, v67
    v_mfma_f32_16x16x32_bf16 v[204:207], a[24:27], a[40:43], 0
    buffer_load_dwordx4 v43, s[16:19], s36 offen offset:3072 lds
    v_lshlrev_b32 v96, 16, v68
    v_mfma_f32_16x16x32_bf16 v[236:239], a[24:27], a[44:47], 0
    v_and_b32 v97, 0xffff0000, v68
    v_lshlrev_b32 v98, 16, v69
    v_mfma_f32_16x16x32_bf16 v[240:243], a[28:31], a[44:47], 0
    v_and_b32 v99, 0xffff0000, v69
    v_add_f32 v109, v80, v81
    v_mfma_f32_16x16x32_bf16 v[208:211], a[28:31], a[40:43], 0
    v_add_f32 v110, v82, v83
    v_add_f32 v109, v109, v84
    v_mfma_f32_16x16x32_bf16 v[176:179], a[28:31], a[36:39], 0
    v_add_f32 v110, v110, v85
    v_add_f32 v109, v109, v86
    v_mfma_f32_16x16x32_bf16 v[144:147], a[28:31], a[32:35], 0
    v_add_f32 v110, v110, v87
    v_add_f32 v109, v109, v88
    s_waitcnt vmcnt(13) lgkmcnt(0)
    s_barrier
    v_mfma_f32_16x16x32_bf16 v[100:103], a[48:51], v[32:35], v[100:103]
    ds_read_b64_tr_b16 a[0:1], v50 offset:16384
    v_add_f32 v110, v110, v89
    v_mfma_f32_16x16x32_bf16 v[104:107], a[52:55], v[32:35], v[104:107]
    s_add_u32 m0, s39, 0
    s_mov_b32 s37, 1572864
    ds_read_b64_tr_b16 a[2:3], v50 offset:17408
    v_add_f32 v109, v109, v90
    v_mfma_f32_16x16x32_bf16 v[116:119], a[48:51], a[80:83], v[116:119]
    buffer_load_dwordx4 v44, s[20:23], s37 offen offset:0 lds
    v_mfma_f32_16x16x32_bf16 v[148:151], a[48:51], a[84:87], v[148:151]
    ds_read_b128 a[32:35], v48 offset:8192
    v_add_f32 v110, v110, v91
    v_mfma_f32_16x16x32_bf16 v[180:183], a[48:51], a[88:91], v[180:183]
    ds_read_b128 a[36:39], v48 offset:10240
    v_add_f32 v109, v109, v92
    v_mfma_f32_16x16x32_bf16 v[212:215], a[48:51], a[92:95], v[212:215]
    ds_read_b128 a[40:43], v48 offset:12288
    v_add_f32 v110, v110, v93
    v_mfma_f32_16x16x32_bf16 v[216:219], a[52:55], a[92:95], v[216:219]
    ds_read_b128 a[44:47], v48 offset:14336
    v_add_f32 v109, v109, v94
    v_mfma_f32_16x16x32_bf16 v[184:187], a[52:55], a[88:91], v[184:187]
    buffer_load_dwordx4 v45, s[20:23], s37 offen offset:1024 lds
    v_add_f32 v110, v110, v95
    v_mfma_f32_16x16x32_bf16 v[152:155], a[52:55], a[84:87], v[152:155]
    ds_read_b64_tr_b16 a[4:5], v51 offset:16384
    v_add_f32 v109, v109, v96
    v_add_f32 v110, v110, v97
    v_mfma_f32_16x16x32_bf16 v[120:123], a[52:55], a[80:83], v[120:123]
    ds_read_b64_tr_b16 a[6:7], v51 offset:17408
    v_add_f32 v109, v109, v98
    v_mfma_f32_16x16x32_bf16 v[124:127], a[56:59], a[80:83], v[124:127]
    ds_read_b64_tr_b16 a[8:9], v52 offset:16384
    v_add_f32 v110, v110, v99
    v_mfma_f32_16x16x32_bf16 v[156:159], a[56:59], a[84:87], v[156:159]
    ds_read_b64_tr_b16 a[10:11], v52 offset:17408
    v_add_f32 v109, v109, v110
    v_mfma_f32_16x16x32_bf16 v[188:191], a[56:59], a[88:91], v[188:191]
    buffer_load_dwordx4 v46, s[20:23], s37 offen offset:2048 lds
    v_add_f32_dpp v109, v109, v109 quad_perm:[1,0,3,2] row_mask:0xf bank_mask:0xf
    v_mfma_f32_16x16x32_bf16 v[220:223], a[56:59], a[92:95], v[220:223]
    ds_read_b64_tr_b16 a[12:13], v53 offset:16384
    v_add_f32_dpp v109, v109, v109 quad_perm:[2,3,0,1] row_mask:0xf bank_mask:0xf
    v_mfma_f32_16x16x32_bf16 v[224:227], a[60:63], a[92:95], v[224:227]
    ds_read_b64_tr_b16 a[14:15], v53 offset:17408
    v_add_f32_dpp v109, v109, v109 row_half_mirror row_mask:0xf bank_mask:0xf
    v_mfma_f32_16x16x32_bf16 v[192:195], a[60:63], a[88:91], v[192:195]
    ds_read_b64_tr_b16 a[16:17], v54 offset:16384
    v_add_f32_dpp v109, v109, v109 row_mirror row_mask:0xf bank_mask:0xf
    v_mov_b32 v110, v109
    v_mfma_f32_16x16x32_bf16 v[160:163], a[60:63], a[84:87], v[160:163]
    ds_read_b64_tr_b16 a[18:19], v54 offset:17408
    v_permlane16_swap_b32 v109, v110
    v_add_f32 v109, v109, v110
    v_mul_f32 v111, 0x3acccccd, v109
    v_mfma_f32_16x16x32_bf16 v[128:131], a[60:63], a[80:83], v[128:131]
    buffer_load_dwordx4 v47, s[20:23], s37 offen offset:3072 lds
    v_sub_f32 v60, v80, v111
    v_mfma_f32_16x16x32_bf16 v[132:135], a[64:67], a[80:83], v[132:135]
    ds_read_b64_tr_b16 a[20:21], v55 offset:16384
    v_mul_f32 v109, v60, v60
    v_mfma_f32_16x16x32_bf16 v[164:167], a[64:67], a[84:87], v[164:167]
    ds_read_b64_tr_b16 a[22:23], v55 offset:17408
    v_sub_f32 v61, v81, v111
    v_mul_f32 v112, v61, v61
    v_mfma_f32_16x16x32_bf16 v[196:199], a[64:67], a[88:91], v[196:199]
    ds_read_b64_tr_b16 a[24:25], v56 offset:16384
    v_sub_f32 v60, v82, v111
    v_mfma_f32_16x16x32_bf16 v[228:231], a[64:67], a[92:95], v[228:231]
    s_add_u32 m0, s38, 0
    s_mov_b32 s36, 384
    ds_read_b64_tr_b16 a[26:27], v56 offset:17408
    v_fmac_f32 v109, v60, v60
    v_mfma_f32_16x16x32_bf16 v[232:235], a[68:71], a[92:95], v[232:235]
    buffer_load_dwordx4 v36, s[16:19], s36 offen offset:0 lds
    v_sub_f32 v61, v83, v111
    v_fmac_f32 v112, v61, v61
    v_mfma_f32_16x16x32_bf16 v[200:203], a[68:71], a[88:91], v[200:203]
    ds_read_b64_tr_b16 a[28:29], v57 offset:16384
    v_sub_f32 v60, v84, v111
    v_mfma_f32_16x16x32_bf16 v[168:171], a[68:71], a[84:87], v[168:171]
    ds_read_b64_tr_b16 a[30:31], v57 offset:17408
    v_fmac_f32 v109, v60, v60
    v_mfma_f32_16x16x32_bf16 v[136:139], a[68:71], a[80:83], v[136:139]
    v_sub_f32 v61, v85, v111
    v_fmac_f32 v112, v61, v61
    v_mfma_f32_16x16x32_bf16 v[140:143], a[72:75], a[80:83], v[140:143]
    v_sub_f32 v60, v86, v111
    v_fmac_f32 v109, v60, v60
    v_mfma_f32_16x16x32_bf16 v[172:175], a[72:75], a[84:87], v[172:175]
    buffer_load_dwordx4 v37, s[16:19], s36 offen offset:1024 lds
    v_sub_f32 v61, v87, v111
    v_mfma_f32_16x16x32_bf16 v[204:207], a[72:75], a[88:91], v[204:207]
    v_fmac_f32 v112, v61, v61
    v_sub_f32 v60, v88, v111
    v_mfma_f32_16x16x32_bf16 v[236:239], a[72:75], a[92:95], v[236:239]
    v_fmac_f32 v109, v60, v60
    v_sub_f32 v61, v89, v111
    v_mfma_f32_16x16x32_bf16 v[240:243], a[76:79], a[92:95], v[240:243]
    v_fmac_f32 v112, v61, v61
    v_sub_f32 v60, v90, v111
    v_mfma_f32_16x16x32_bf16 v[208:211], a[76:79], a[88:91], v[208:211]
    v_fmac_f32 v109, v60, v60
    v_sub_f32 v61, v91, v111
    v_mfma_f32_16x16x32_bf16 v[176:179], a[76:79], a[84:87], v[176:179]
    v_fmac_f32 v112, v61, v61
    v_sub_f32 v60, v92, v111
    v_mfma_f32_16x16x32_bf16 v[144:147], a[76:79], a[80:83], v[144:147]
    v_fmac_f32 v109, v60, v60
    v_sub_f32 v61, v93, v111
    s_waitcnt lgkmcnt(0)
    v_mfma_f32_16x16x32_bf16 v[100:103], a[0:3], v[32:35], v[100:103]
    ds_read_b64_tr_b16 a[48:49], v50 offset:24576
    v_fmac_f32 v112, v61, v61
    v_mfma_f32_16x16x32_bf16 v[104:107], a[4:7], v[32:35], v[104:107]
    ds_read_b64_tr_b16 a[50:51], v50 offset:25600
    v_sub_f32 v60, v94, v111
    v_mfma_f32_16x16x32_bf16 v[116:119], a[0:3], a[32:35], v[116:119]
    buffer_load_dwordx4 v38, s[16:19], s36 offen offset:2048 lds
    v_mfma_f32_16x16x32_bf16 v[148:151], a[0:3], a[36:39], v[148:151]
    ds_read_b128 a[80:83], v49 offset:8192
    v_fmac_f32 v109, v60, v60
    v_mfma_f32_16x16x32_bf16 v[180:183], a[0:3], a[40:43], v[180:183]
    ds_read_b128 a[84:87], v49 offset:10240
    v_sub_f32 v61, v95, v111
    v_mfma_f32_16x16x32_bf16 v[212:215], a[0:3], a[44:47], v[212:215]
    ds_read_b128 a[88:91], v49 offset:12288
    v_fmac_f32 v112, v61, v61
    v_mfma_f32_16x16x32_bf16 v[216:219], a[4:7], a[44:47], v[216:219]
    ds_read_b128 a[92:95], v49 offset:14336
    v_sub_f32 v60, v96, v111
    v_mfma_f32_16x16x32_bf16 v[184:187], a[4:7], a[40:43], v[184:187]
    buffer_load_dwordx4 v39, s[16:19], s36 offen offset:3072 lds
    v_fmac_f32 v109, v60, v60
    v_mfma_f32_16x16x32_bf16 v[152:155], a[4:7], a[36:39], v[152:155]
    ds_read_b64_tr_b16 a[52:53], v51 offset:24576
    v_sub_f32 v61, v97, v111
    v_mfma_f32_16x16x32_bf16 v[120:123], a[4:7], a[32:35], v[120:123]
    ds_read_b64_tr_b16 a[54:55], v51 offset:25600
    v_fmac_f32 v112, v61, v61
    v_mfma_f32_16x16x32_bf16 v[124:127], a[8:11], a[32:35], v[124:127]
    ds_read_b64_tr_b16 a[56:57], v52 offset:24576
    v_sub_f32 v60, v98, v111
    v_mfma_f32_16x16x32_bf16 v[156:159], a[8:11], a[36:39], v[156:159]
    s_add_u32 m0, s38, 4096
    ds_read_b64_tr_b16 a[58:59], v52 offset:25600
    v_fmac_f32 v109, v60, v60
    v_sub_f32 v61, v99, v111
    v_mfma_f32_16x16x32_bf16 v[188:191], a[8:11], a[40:43], v[188:191]
    buffer_load_dwordx4 v40, s[16:19], s36 offen offset:0 lds
    v_fmac_f32 v112, v61, v61
    v_mfma_f32_16x16x32_bf16 v[220:223], a[8:11], a[44:47], v[220:223]
    ds_read_b64_tr_b16 a[60:61], v53 offset:24576
    v_add_f32 v109, v109, v112
    v_mfma_f32_16x16x32_bf16 v[224:227], a[12:15], a[44:47], v[224:227]
    ds_read_b64_tr_b16 a[62:63], v53 offset:25600
    v_add_f32_dpp v109, v109, v109 quad_perm:[1,0,3,2] row_mask:0xf bank_mask:0xf
    v_mfma_f32_16x16x32_bf16 v[192:195], a[12:15], a[40:43], v[192:195]
    ds_read_b64_tr_b16 a[64:65], v54 offset:24576
    v_add_f32_dpp v109, v109, v109 quad_perm:[2,3,0,1] row_mask:0xf bank_mask:0xf
    v_mfma_f32_16x16x32_bf16 v[160:163], a[12:15], a[36:39], v[160:163]
    ds_read_b64_tr_b16 a[66:67], v54 offset:25600
    v_add_f32_dpp v109, v109, v109 row_half_mirror row_mask:0xf bank_mask:0xf
    v_mfma_f32_16x16x32_bf16 v[128:131], a[12:15], a[32:35], v[128:131]
    buffer_load_dwordx4 v41, s[16:19], s36 offen offset:1024 lds
    v_add_f32_dpp v109, v109, v109 row_mirror row_mask:0xf bank_mask:0xf
    v_mov_b32 v110, v109
    v_mfma_f32_16x16x32_bf16 v[132:135], a[16:19], a[32:35], v[132:135]
    ds_read_b64_tr_b16 a[68:69], v55 offset:24576
    v_permlane16_swap_b32 v109, v110
    v_add_f32 v109, v109, v110
    v_mfma_f32_16x16x32_bf16 v[164:167], a[16:19], a[36:39], v[164:167]
    ds_read_b64_tr_b16 a[70:71], v55 offset:25600
    v_mul_f32 v109, 0x3acccccd, v109
    v_cvt_pk_bf16_f32 v110, v111, v109
    v_mfma_f32_16x16x32_bf16 v[196:199], a[16:19], a[40:43], v[196:199]
    ds_read_b64_tr_b16 a[72:73], v56 offset:24576
    v_lshlrev_b32 v111, 16, v110
    v_mfma_f32_16x16x32_bf16 v[228:231], a[16:19], a[44:47], v[228:231]
    ds_read_b64_tr_b16 a[74:75], v56 offset:25600
    v_and_b32 v109, 0xffff0000, v110
    v_mfma_f32_16x16x32_bf16 v[232:235], a[20:23], a[44:47], v[232:235]
    buffer_load_dwordx4 v42, s[16:19], s36 offen offset:2048 lds
    v_add_f32 v109, 0x3727c5ac, v109
    v_cvt_pk_bf16_f32 v109, v109, v109
    v_mfma_f32_16x16x32_bf16 v[200:203], a[20:23], a[40:43], v[200:203]
    ds_read_b64_tr_b16 a[76:77], v57 offset:24576
    v_lshlrev_b32 v109, 16, v109
    v_mfma_f32_16x16x32_bf16 v[168:171], a[20:23], a[36:39], v[168:171]
    ds_read_b64_tr_b16 a[78:79], v57 offset:25600
    v_sqrt_f32 v109, v109
    v_mfma_f32_16x16x32_bf16 v[136:139], a[20:23], a[32:35], v[136:139]
    v_sub_f32 v80, v80, v111
    v_sub_f32 v81, v81, v111
    v_mfma_f32_16x16x32_bf16 v[140:143], a[24:27], a[32:35], v[140:143]
    v_sub_f32 v82, v82, v111
    v_sub_f32 v83, v83, v111
    v_mfma_f32_16x16x32_bf16 v[172:175], a[24:27], a[36:39], v[172:175]
    buffer_load_dwordx4 v43, s[16:19], s36 offen offset:3072 lds
    v_sub_f32 v84, v84, v111
    v_mfma_f32_16x16x32_bf16 v[204:207], a[24:27], a[40:43], v[204:207]
    v_sub_f32 v85, v85, v111
    v_sub_f32 v86, v86, v111
    v_mfma_f32_16x16x32_bf16 v[236:239], a[24:27], a[44:47], v[236:239]
    v_sub_f32 v87, v87, v111
    v_sub_f32 v88, v88, v111
    v_mfma_f32_16x16x32_bf16 v[240:243], a[28:31], a[44:47], v[240:243]
    v_sub_f32 v89, v89, v111
    v_sub_f32 v90, v90, v111
    v_mfma_f32_16x16x32_bf16 v[208:211], a[28:31], a[40:43], v[208:211]
    v_sub_f32 v91, v91, v111
    v_sub_f32 v92, v92, v111
    v_mfma_f32_16x16x32_bf16 v[176:179], a[28:31], a[36:39], v[176:179]
    v_sub_f32 v93, v93, v111
    v_sub_f32 v94, v94, v111
    v_mfma_f32_16x16x32_bf16 v[144:147], a[28:31], a[32:35], v[144:147]
    v_sub_f32 v95, v95, v111
    v_sub_f32 v96, v96, v111
    s_waitcnt vmcnt(12) lgkmcnt(0)
    s_barrier
    v_mfma_f32_16x16x32_bf16 v[100:103], a[48:51], v[32:35], v[100:103]
    ds_read_b64_tr_b16 a[0:1], v50 offset:32768
    v_sub_f32 v97, v97, v111
    v_mfma_f32_16x16x32_bf16 v[104:107], a[52:55], v[32:35], v[104:107]
    s_add_u32 m0, s39, 16384
    s_mov_b32 s37, 2097152
    ds_read_b64_tr_b16 a[2:3], v50 offset:33792
    v_sub_f32 v98, v98, v111
    v_mfma_f32_16x16x32_bf16 v[116:119], a[48:51], a[80:83], v[116:119]
    buffer_load_dwordx4 v44, s[20:23], s37 offen offset:0 lds
    v_mfma_f32_16x16x32_bf16 v[148:151], a[48:51], a[84:87], v[148:151]
    ds_read_b128 a[32:35], v48 offset:16384
    v_sub_f32 v99, v99, v111
    v_mfma_f32_16x16x32_bf16 v[180:183], a[48:51], a[88:91], v[180:183]
    ds_read_b128 a[36:39], v48 offset:18432
    v_cvt_pk_bf16_f32 v109, v109, v109
    v_mfma_f32_16x16x32_bf16 v[212:215], a[48:51], a[92:95], v[212:215]
    ds_read_b128 a[40:43], v48 offset:20480
    v_lshlrev_b32 v109, 16, v109
    v_mfma_f32_16x16x32_bf16 v[216:219], a[52:55], a[92:95], v[216:219]
    ds_read_b128 a[44:47], v48 offset:22528
    v_rcp_f32 v112, v109
    v_mfma_f32_16x16x32_bf16 v[184:187], a[52:55], a[88:91], v[184:187]
    buffer_load_dwordx4 v45, s[20:23], s37 offen offset:1024 lds
    v_cvt_pk_bf16_f32 v60, v80, v81
    v_mfma_f32_16x16x32_bf16 v[152:155], a[52:55], a[84:87], v[152:155]
    ds_read_b64_tr_b16 a[4:5], v51 offset:32768
    v_cvt_pk_bf16_f32 v61, v82, v83
    v_mfma_f32_16x16x32_bf16 v[120:123], a[52:55], a[80:83], v[120:123]
    ds_read_b64_tr_b16 a[6:7], v51 offset:33792
    v_cvt_pk_bf16_f32 v62, v84, v85
    v_mfma_f32_16x16x32_bf16 v[124:127], a[56:59], a[80:83], v[124:127]
    ds_read_b64_tr_b16 a[8:9], v52 offset:32768
    v_cvt_pk_bf16_f32 v63, v86, v87
    v_mfma_f32_16x16x32_bf16 v[156:159], a[56:59], a[84:87], v[156:159]
    ds_read_b64_tr_b16 a[10:11], v52 offset:33792
    v_cvt_pk_bf16_f32 v64, v88, v89
    v_cvt_pk_bf16_f32 v65, v90, v91
    v_mfma_f32_16x16x32_bf16 v[188:191], a[56:59], a[88:91], v[188:191]
    buffer_load_dwordx4 v46, s[20:23], s37 offen offset:2048 lds
    v_cvt_pk_bf16_f32 v66, v92, v93
    v_mfma_f32_16x16x32_bf16 v[220:223], a[56:59], a[92:95], v[220:223]
    ds_read_b64_tr_b16 a[12:13], v53 offset:32768
    v_cvt_pk_bf16_f32 v67, v94, v95
    v_mfma_f32_16x16x32_bf16 v[224:227], a[60:63], a[92:95], v[224:227]
    ds_read_b64_tr_b16 a[14:15], v53 offset:33792
    v_cvt_pk_bf16_f32 v68, v96, v97
    v_cvt_pk_bf16_f32 v69, v98, v99
    v_mfma_f32_16x16x32_bf16 v[192:195], a[60:63], a[88:91], v[192:195]
    ds_read_b64_tr_b16 a[16:17], v54 offset:32768
    v_lshlrev_b32 v80, 16, v60
    v_mfma_f32_16x16x32_bf16 v[160:163], a[60:63], a[84:87], v[160:163]
    ds_read_b64_tr_b16 a[18:19], v54 offset:33792
    v_and_b32 v81, 0xffff0000, v60
    v_lshlrev_b32 v82, 16, v61
    v_mfma_f32_16x16x32_bf16 v[128:131], a[60:63], a[80:83], v[128:131]
    buffer_load_dwordx4 v47, s[20:23], s37 offen offset:3072 lds
    v_and_b32 v83, 0xffff0000, v61
    v_mfma_f32_16x16x32_bf16 v[132:135], a[64:67], a[80:83], v[132:135]
    ds_read_b64_tr_b16 a[20:21], v55 offset:32768
    v_lshlrev_b32 v84, 16, v62
    v_mfma_f32_16x16x32_bf16 v[164:167], a[64:67], a[84:87], v[164:167]
    ds_read_b64_tr_b16 a[22:23], v55 offset:33792
    v_and_b32 v85, 0xffff0000, v62
    v_lshlrev_b32 v86, 16, v63
    v_mfma_f32_16x16x32_bf16 v[196:199], a[64:67], a[88:91], v[196:199]
    ds_read_b64_tr_b16 a[24:25], v56 offset:32768
    v_and_b32 v87, 0xffff0000, v63
    v_mfma_f32_16x16x32_bf16 v[228:231], a[64:67], a[92:95], v[228:231]
    s_add_u32 m0, s38, 8192
    s_mov_b32 s36, 512
    ds_read_b64_tr_b16 a[26:27], v56 offset:33792
    v_lshlrev_b32 v88, 16, v64
    v_mfma_f32_16x16x32_bf16 v[232:235], a[68:71], a[92:95], v[232:235]
    buffer_load_dwordx4 v36, s[16:19], s36 offen offset:0 lds
    v_and_b32 v89, 0xffff0000, v64
    v_lshlrev_b32 v90, 16, v65
    v_mfma_f32_16x16x32_bf16 v[200:203], a[68:71], a[88:91], v[200:203]
    ds_read_b64_tr_b16 a[28:29], v57 offset:32768
    v_and_b32 v91, 0xffff0000, v65
    v_mfma_f32_16x16x32_bf16 v[168:171], a[68:71], a[84:87], v[168:171]
    ds_read_b64_tr_b16 a[30:31], v57 offset:33792
    v_lshlrev_b32 v92, 16, v66
    v_mfma_f32_16x16x32_bf16 v[136:139], a[68:71], a[80:83], v[136:139]
    v_and_b32 v93, 0xffff0000, v66
    v_lshlrev_b32 v94, 16, v67
    v_mfma_f32_16x16x32_bf16 v[140:143], a[72:75], a[80:83], v[140:143]
    v_and_b32 v95, 0xffff0000, v67
    v_lshlrev_b32 v96, 16, v68
    v_mfma_f32_16x16x32_bf16 v[172:175], a[72:75], a[84:87], v[172:175]
    buffer_load_dwordx4 v37, s[16:19], s36 offen offset:1024 lds
    v_and_b32 v97, 0xffff0000, v68
    v_mfma_f32_16x16x32_bf16 v[204:207], a[72:75], a[88:91], v[204:207]
    v_lshlrev_b32 v98, 16, v69
    v_and_b32 v99, 0xffff0000, v69
    v_mfma_f32_16x16x32_bf16 v[236:239], a[72:75], a[92:95], v[236:239]
    v_mul_f32 v80, v80, v112
    v_mul_f32 v81, v81, v112
    v_mfma_f32_16x16x32_bf16 v[240:243], a[76:79], a[92:95], v[240:243]
    v_mul_f32 v82, v82, v112
    v_mul_f32 v83, v83, v112
    v_mfma_f32_16x16x32_bf16 v[208:211], a[76:79], a[88:91], v[208:211]
    v_mul_f32 v84, v84, v112
    v_mul_f32 v85, v85, v112
    v_mfma_f32_16x16x32_bf16 v[176:179], a[76:79], a[84:87], v[176:179]
    v_mul_f32 v86, v86, v112
    v_mul_f32 v87, v87, v112
    v_mfma_f32_16x16x32_bf16 v[144:147], a[76:79], a[80:83], v[144:147]
    v_mul_f32 v88, v88, v112
    v_mul_f32 v89, v89, v112
    s_waitcnt lgkmcnt(0)
    v_mfma_f32_16x16x32_bf16 v[100:103], a[0:3], v[32:35], v[100:103]
    ds_read_b64_tr_b16 a[48:49], v50 offset:40960
    v_mul_f32 v90, v90, v112
    v_mfma_f32_16x16x32_bf16 v[104:107], a[4:7], v[32:35], v[104:107]
    ds_read_b64_tr_b16 a[50:51], v50 offset:41984
    v_mul_f32 v91, v91, v112
    v_mfma_f32_16x16x32_bf16 v[116:119], a[0:3], a[32:35], v[116:119]
    buffer_load_dwordx4 v38, s[16:19], s36 offen offset:2048 lds
    v_mfma_f32_16x16x32_bf16 v[148:151], a[0:3], a[36:39], v[148:151]
    ds_read_b128 a[80:83], v49 offset:16384
    v_mul_f32 v92, v92, v112
    v_mfma_f32_16x16x32_bf16 v[180:183], a[0:3], a[40:43], v[180:183]
    ds_read_b128 a[84:87], v49 offset:18432
    v_mul_f32 v93, v93, v112
    v_mfma_f32_16x16x32_bf16 v[212:215], a[0:3], a[44:47], v[212:215]
    ds_read_b128 a[88:91], v49 offset:20480
    v_mul_f32 v94, v94, v112
    v_mfma_f32_16x16x32_bf16 v[216:219], a[4:7], a[44:47], v[216:219]
    ds_read_b128 a[92:95], v49 offset:22528
    v_mul_f32 v95, v95, v112
    v_mfma_f32_16x16x32_bf16 v[184:187], a[4:7], a[40:43], v[184:187]
    buffer_load_dwordx4 v39, s[16:19], s36 offen offset:3072 lds
    v_mul_f32 v96, v96, v112
    v_mfma_f32_16x16x32_bf16 v[152:155], a[4:7], a[36:39], v[152:155]
    ds_read_b64_tr_b16 a[52:53], v51 offset:40960
    v_mul_f32 v97, v97, v112
    v_mfma_f32_16x16x32_bf16 v[120:123], a[4:7], a[32:35], v[120:123]
    ds_read_b64_tr_b16 a[54:55], v51 offset:41984
    v_mul_f32 v98, v98, v112
    v_mfma_f32_16x16x32_bf16 v[124:127], a[8:11], a[32:35], v[124:127]
    ds_read_b64_tr_b16 a[56:57], v52 offset:40960
    v_mul_f32 v99, v99, v112
    v_mfma_f32_16x16x32_bf16 v[156:159], a[8:11], a[36:39], v[156:159]
    s_add_u32 m0, s38, 12288
    ds_read_b64_tr_b16 a[58:59], v52 offset:41984
    v_cvt_pk_bf16_f32 v60, v80, v81
    v_cvt_pk_bf16_f32 v61, v82, v83
    v_mfma_f32_16x16x32_bf16 v[188:191], a[8:11], a[40:43], v[188:191]
    buffer_load_dwordx4 v40, s[16:19], s36 offen offset:0 lds
    v_cvt_pk_bf16_f32 v62, v84, v85
    v_mfma_f32_16x16x32_bf16 v[220:223], a[8:11], a[44:47], v[220:223]
    ds_read_b64_tr_b16 a[60:61], v53 offset:40960
    v_cvt_pk_bf16_f32 v63, v86, v87
    v_mfma_f32_16x16x32_bf16 v[224:227], a[12:15], a[44:47], v[224:227]
    ds_read_b64_tr_b16 a[62:63], v53 offset:41984
    v_cvt_pk_bf16_f32 v64, v88, v89
    v_cvt_pk_bf16_f32 v65, v90, v91
    v_mfma_f32_16x16x32_bf16 v[192:195], a[12:15], a[40:43], v[192:195]
    ds_read_b64_tr_b16 a[64:65], v54 offset:40960
    v_cvt_pk_bf16_f32 v66, v92, v93
    v_mfma_f32_16x16x32_bf16 v[160:163], a[12:15], a[36:39], v[160:163]
    ds_read_b64_tr_b16 a[66:67], v54 offset:41984
    v_cvt_pk_bf16_f32 v67, v94, v95
    v_cvt_pk_bf16_f32 v68, v96, v97
    v_mfma_f32_16x16x32_bf16 v[128:131], a[12:15], a[32:35], v[128:131]
    buffer_load_dwordx4 v41, s[16:19], s36 offen offset:1024 lds
    v_cvt_pk_bf16_f32 v69, v98, v99
    v_mfma_f32_16x16x32_bf16 v[132:135], a[16:19], a[32:35], v[132:135]
    ds_read_b64_tr_b16 a[68:69], v55 offset:40960
    v_mov_b32 v109, 0
    v_mfma_f32_16x16x32_bf16 v[164:167], a[16:19], a[36:39], v[164:167]
    ds_read_b64_tr_b16 a[70:71], v55 offset:41984
    v_dot2c_f32_bf16 v109, v60, v70
    v_dot2c_f32_bf16 v109, v61, v71
    v_dot2c_f32_bf16 v109, v62, v72
    v_dot2c_f32_bf16 v109, v63, v73
    v_dot2c_f32_bf16 v109, v64, v74
    v_dot2c_f32_bf16 v109, v65, v75
    v_dot2c_f32_bf16 v109, v66, v76
    v_dot2c_f32_bf16 v109, v67, v77
    v_dot2c_f32_bf16 v109, v68, v78
    v_dot2c_f32_bf16 v109, v69, v79
    s_nop 2
    v_mfma_f32_16x16x32_bf16 v[196:199], a[16:19], a[40:43], v[196:199]
    ds_read_b64_tr_b16 a[72:73], v56 offset:40960
    v_add_f32_dpp v109, v109, v109 quad_perm:[1,0,3,2] row_mask:0xf bank_mask:0xf
    v_mfma_f32_16x16x32_bf16 v[228:231], a[16:19], a[44:47], v[228:231]
    ds_read_b64_tr_b16 a[74:75], v56 offset:41984
    v_add_f32_dpp v109, v109, v109 quad_perm:[2,3,0,1] row_mask:0xf bank_mask:0xf
    v_mfma_f32_16x16x32_bf16 v[232:235], a[20:23], a[44:47], v[232:235]
    buffer_load_dwordx4 v42, s[16:19], s36 offen offset:2048 lds
    v_add_f32_dpp v109, v109, v109 row_half_mirror row_mask:0xf bank_mask:0xf
    v_mfma_f32_16x16x32_bf16 v[200:203], a[20:23], a[40:43], v[200:203]
    ds_read_b64_tr_b16 a[76:77], v57 offset:40960
    v_add_f32_dpp v109, v109, v109 row_mirror row_mask:0xf bank_mask:0xf
    v_mov_b32 v110, v109
    v_mfma_f32_16x16x32_bf16 v[168:171], a[20:23], a[36:39], v[168:171]
    ds_read_b64_tr_b16 a[78:79], v57 offset:41984
    v_permlane16_swap_b32 v109, v110
    v_add_f32 v109, v109, v110
    v_mfma_f32_16x16x32_bf16 v[136:139], a[20:23], a[32:35], v[136:139]
    v_cvt_pk_bf16_f32 v109, v109, v109
    v_lshlrev_b32 v109, 16, v109
    v_mfma_f32_16x16x32_bf16 v[140:143], a[24:27], a[32:35], v[140:143]
    v_ashrrev_i32 v110, 31, v109
    v_or_b32 v110, 0x80000000, v110
    v_mfma_f32_16x16x32_bf16 v[172:175], a[24:27], a[36:39], v[172:175]
    buffer_load_dwordx4 v43, s[16:19], s36 offen offset:3072 lds
    v_xor_b32 v109, v109, v110
    v_mfma_f32_16x16x32_bf16 v[204:207], a[24:27], a[40:43], v[204:207]
    v_and_b32 v109, 0xffff0000, v109
    v_sub_u32 v110, 0xffff, v108
    v_mfma_f32_16x16x32_bf16 v[236:239], a[24:27], a[44:47], v[236:239]
    v_or_b32 v62, v109, v110
    v_mov_b32 v60, v111
    v_mfma_f32_16x16x32_bf16 v[240:243], a[28:31], a[44:47], v[240:243]
    v_mov_b32 v61, v112
    v_mov_b32 v63, 0
    v_mfma_f32_16x16x32_bf16 v[208:211], a[28:31], a[40:43], v[208:211]
    v_lshlrev_b32 v110, 4, v108
    v_mfma_f32_16x16x32_bf16 v[176:179], a[28:31], a[36:39], v[176:179]
    s_mov_b32 s40, 0x280000
    s_mov_b32 exec_lo, 1
    s_mov_b32 exec_hi, 1
    buffer_store_dwordx4 v[60:63], v110, s[76:79], s40 offen sc1
    s_mov_b64 exec, -1
    v_mfma_f32_16x16x32_bf16 v[144:147], a[28:31], a[32:35], v[144:147]
    s_waitcnt vmcnt(13) lgkmcnt(0)
    s_barrier
    v_mfma_f32_16x16x32_bf16 v[100:103], a[48:51], v[32:35], v[100:103]
    ds_read_b64_tr_b16 a[0:1], v50 offset:0
    v_mfma_f32_16x16x32_bf16 v[104:107], a[52:55], v[32:35], v[104:107]
    s_add_u32 m0, s39, 32768
    s_mov_b32 s37, 2621440
    ds_read_b64_tr_b16 a[2:3], v50 offset:1024
    v_mfma_f32_16x16x32_bf16 v[116:119], a[48:51], a[80:83], v[116:119]
    buffer_load_dwordx4 v44, s[20:23], s37 offen offset:0 lds
    v_mfma_f32_16x16x32_bf16 v[148:151], a[48:51], a[84:87], v[148:151]
    ds_read_b128 a[32:35], v48 offset:0
    v_mfma_f32_16x16x32_bf16 v[180:183], a[48:51], a[88:91], v[180:183]
    ds_read_b128 a[36:39], v48 offset:2048
    v_mfma_f32_16x16x32_bf16 v[212:215], a[48:51], a[92:95], v[212:215]
    ds_read_b128 a[40:43], v48 offset:4096
    v_mfma_f32_16x16x32_bf16 v[216:219], a[52:55], a[92:95], v[216:219]
    ds_read_b128 a[44:47], v48 offset:6144
    v_mfma_f32_16x16x32_bf16 v[184:187], a[52:55], a[88:91], v[184:187]
    buffer_load_dwordx4 v45, s[20:23], s37 offen offset:1024 lds
    v_mfma_f32_16x16x32_bf16 v[152:155], a[52:55], a[84:87], v[152:155]
    ds_read_b64_tr_b16 a[4:5], v51 offset:0
    v_mfma_f32_16x16x32_bf16 v[120:123], a[52:55], a[80:83], v[120:123]
    ds_read_b64_tr_b16 a[6:7], v51 offset:1024
    v_mfma_f32_16x16x32_bf16 v[124:127], a[56:59], a[80:83], v[124:127]
    ds_read_b64_tr_b16 a[8:9], v52 offset:0
    v_mfma_f32_16x16x32_bf16 v[156:159], a[56:59], a[84:87], v[156:159]
    ds_read_b64_tr_b16 a[10:11], v52 offset:1024
    v_mfma_f32_16x16x32_bf16 v[188:191], a[56:59], a[88:91], v[188:191]
    buffer_load_dwordx4 v46, s[20:23], s37 offen offset:2048 lds
    v_mfma_f32_16x16x32_bf16 v[220:223], a[56:59], a[92:95], v[220:223]
    ds_read_b64_tr_b16 a[12:13], v53 offset:0
    v_mfma_f32_16x16x32_bf16 v[224:227], a[60:63], a[92:95], v[224:227]
    ds_read_b64_tr_b16 a[14:15], v53 offset:1024
    v_mfma_f32_16x16x32_bf16 v[192:195], a[60:63], a[88:91], v[192:195]
    ds_read_b64_tr_b16 a[16:17], v54 offset:0
    v_mfma_f32_16x16x32_bf16 v[160:163], a[60:63], a[84:87], v[160:163]
    ds_read_b64_tr_b16 a[18:19], v54 offset:1024
    v_mfma_f32_16x16x32_bf16 v[128:131], a[60:63], a[80:83], v[128:131]
    buffer_load_dwordx4 v47, s[20:23], s37 offen offset:3072 lds
    v_mfma_f32_16x16x32_bf16 v[132:135], a[64:67], a[80:83], v[132:135]
    ds_read_b64_tr_b16 a[20:21], v55 offset:0
    v_mfma_f32_16x16x32_bf16 v[164:167], a[64:67], a[84:87], v[164:167]
    ds_read_b64_tr_b16 a[22:23], v55 offset:1024
    v_mfma_f32_16x16x32_bf16 v[196:199], a[64:67], a[88:91], v[196:199]
    ds_read_b64_tr_b16 a[24:25], v56 offset:0
    v_mfma_f32_16x16x32_bf16 v[228:231], a[64:67], a[92:95], v[228:231]
    s_add_u32 m0, s38, 16384
    s_mov_b32 s36, 640
    ds_read_b64_tr_b16 a[26:27], v56 offset:1024
    v_mfma_f32_16x16x32_bf16 v[232:235], a[68:71], a[92:95], v[232:235]
    buffer_load_dwordx4 v36, s[16:19], s36 offen offset:0 lds
    v_mfma_f32_16x16x32_bf16 v[200:203], a[68:71], a[88:91], v[200:203]
    ds_read_b64_tr_b16 a[28:29], v57 offset:0
    v_mfma_f32_16x16x32_bf16 v[168:171], a[68:71], a[84:87], v[168:171]
    ds_read_b64_tr_b16 a[30:31], v57 offset:1024
    v_mfma_f32_16x16x32_bf16 v[136:139], a[68:71], a[80:83], v[136:139]
    v_mfma_f32_16x16x32_bf16 v[140:143], a[72:75], a[80:83], v[140:143]
    v_mfma_f32_16x16x32_bf16 v[172:175], a[72:75], a[84:87], v[172:175]
    buffer_load_dwordx4 v37, s[16:19], s36 offen offset:1024 lds
    v_mfma_f32_16x16x32_bf16 v[204:207], a[72:75], a[88:91], v[204:207]
    v_mfma_f32_16x16x32_bf16 v[236:239], a[72:75], a[92:95], v[236:239]
    v_mfma_f32_16x16x32_bf16 v[240:243], a[76:79], a[92:95], v[240:243]
    v_mfma_f32_16x16x32_bf16 v[208:211], a[76:79], a[88:91], v[208:211]
    v_mfma_f32_16x16x32_bf16 v[176:179], a[76:79], a[84:87], v[176:179]
    v_mfma_f32_16x16x32_bf16 v[144:147], a[76:79], a[80:83], v[144:147]
    s_waitcnt lgkmcnt(0)
    v_mfma_f32_16x16x32_bf16 v[100:103], a[0:3], v[32:35], v[100:103]
    ds_read_b64_tr_b16 a[48:49], v50 offset:8192
    v_mfma_f32_16x16x32_bf16 v[104:107], a[4:7], v[32:35], v[104:107]
    ds_read_b64_tr_b16 a[50:51], v50 offset:9216
    v_mfma_f32_16x16x32_bf16 v[116:119], a[0:3], a[32:35], v[116:119]
    buffer_load_dwordx4 v38, s[16:19], s36 offen offset:2048 lds
    v_mfma_f32_16x16x32_bf16 v[148:151], a[0:3], a[36:39], v[148:151]
    ds_read_b128 a[80:83], v49 offset:0
    v_mfma_f32_16x16x32_bf16 v[180:183], a[0:3], a[40:43], v[180:183]
    ds_read_b128 a[84:87], v49 offset:2048
    v_mfma_f32_16x16x32_bf16 v[212:215], a[0:3], a[44:47], v[212:215]
    ds_read_b128 a[88:91], v49 offset:4096
    v_mfma_f32_16x16x32_bf16 v[216:219], a[4:7], a[44:47], v[216:219]
    ds_read_b128 a[92:95], v49 offset:6144
    v_mfma_f32_16x16x32_bf16 v[184:187], a[4:7], a[40:43], v[184:187]
    buffer_load_dwordx4 v39, s[16:19], s36 offen offset:3072 lds
    v_mfma_f32_16x16x32_bf16 v[152:155], a[4:7], a[36:39], v[152:155]
    ds_read_b64_tr_b16 a[52:53], v51 offset:8192
    v_mfma_f32_16x16x32_bf16 v[120:123], a[4:7], a[32:35], v[120:123]
    ds_read_b64_tr_b16 a[54:55], v51 offset:9216
    v_mfma_f32_16x16x32_bf16 v[124:127], a[8:11], a[32:35], v[124:127]
    ds_read_b64_tr_b16 a[56:57], v52 offset:8192
    v_mfma_f32_16x16x32_bf16 v[156:159], a[8:11], a[36:39], v[156:159]
    s_add_u32 m0, s38, 20480
    ds_read_b64_tr_b16 a[58:59], v52 offset:9216
    v_mfma_f32_16x16x32_bf16 v[188:191], a[8:11], a[40:43], v[188:191]
    buffer_load_dwordx4 v40, s[16:19], s36 offen offset:0 lds
    v_mfma_f32_16x16x32_bf16 v[220:223], a[8:11], a[44:47], v[220:223]
    ds_read_b64_tr_b16 a[60:61], v53 offset:8192
    v_mfma_f32_16x16x32_bf16 v[224:227], a[12:15], a[44:47], v[224:227]
    ds_read_b64_tr_b16 a[62:63], v53 offset:9216
    v_mfma_f32_16x16x32_bf16 v[192:195], a[12:15], a[40:43], v[192:195]
    ds_read_b64_tr_b16 a[64:65], v54 offset:8192
    v_mfma_f32_16x16x32_bf16 v[160:163], a[12:15], a[36:39], v[160:163]
    ds_read_b64_tr_b16 a[66:67], v54 offset:9216
    v_mfma_f32_16x16x32_bf16 v[128:131], a[12:15], a[32:35], v[128:131]
    buffer_load_dwordx4 v41, s[16:19], s36 offen offset:1024 lds
    v_mfma_f32_16x16x32_bf16 v[132:135], a[16:19], a[32:35], v[132:135]
    ds_read_b64_tr_b16 a[68:69], v55 offset:8192
    v_mfma_f32_16x16x32_bf16 v[164:167], a[16:19], a[36:39], v[164:167]
    ds_read_b64_tr_b16 a[70:71], v55 offset:9216
    v_mfma_f32_16x16x32_bf16 v[196:199], a[16:19], a[40:43], v[196:199]
    ds_read_b64_tr_b16 a[72:73], v56 offset:8192
    v_mfma_f32_16x16x32_bf16 v[228:231], a[16:19], a[44:47], v[228:231]
    ds_read_b64_tr_b16 a[74:75], v56 offset:9216
    v_mfma_f32_16x16x32_bf16 v[232:235], a[20:23], a[44:47], v[232:235]
    buffer_load_dwordx4 v42, s[16:19], s36 offen offset:2048 lds
    v_mfma_f32_16x16x32_bf16 v[200:203], a[20:23], a[40:43], v[200:203]
    ds_read_b64_tr_b16 a[76:77], v57 offset:8192
    v_mfma_f32_16x16x32_bf16 v[168:171], a[20:23], a[36:39], v[168:171]
    ds_read_b64_tr_b16 a[78:79], v57 offset:9216
    v_mfma_f32_16x16x32_bf16 v[136:139], a[20:23], a[32:35], v[136:139]
    v_mfma_f32_16x16x32_bf16 v[140:143], a[24:27], a[32:35], v[140:143]
    v_mfma_f32_16x16x32_bf16 v[172:175], a[24:27], a[36:39], v[172:175]
    buffer_load_dwordx4 v43, s[16:19], s36 offen offset:3072 lds
    v_mfma_f32_16x16x32_bf16 v[204:207], a[24:27], a[40:43], v[204:207]
    v_mfma_f32_16x16x32_bf16 v[236:239], a[24:27], a[44:47], v[236:239]
    v_mfma_f32_16x16x32_bf16 v[240:243], a[28:31], a[44:47], v[240:243]
    v_mfma_f32_16x16x32_bf16 v[208:211], a[28:31], a[40:43], v[208:211]
    v_mfma_f32_16x16x32_bf16 v[176:179], a[28:31], a[36:39], v[176:179]
    v_mfma_f32_16x16x32_bf16 v[144:147], a[28:31], a[32:35], v[144:147]
    s_waitcnt vmcnt(13) lgkmcnt(0)
    s_barrier
    v_mfma_f32_16x16x32_bf16 v[100:103], a[48:51], v[32:35], v[100:103]
    ds_read_b64_tr_b16 a[0:1], v50 offset:16384
    v_mfma_f32_16x16x32_bf16 v[104:107], a[52:55], v[32:35], v[104:107]
    s_add_u32 m0, s39, 0
    s_mov_b32 s37, 3145728
    ds_read_b64_tr_b16 a[2:3], v50 offset:17408
    v_mfma_f32_16x16x32_bf16 v[116:119], a[48:51], a[80:83], v[116:119]
    buffer_load_dwordx4 v44, s[20:23], s37 offen offset:0 lds
    v_mfma_f32_16x16x32_bf16 v[148:151], a[48:51], a[84:87], v[148:151]
    ds_read_b128 a[32:35], v48 offset:8192
    v_mfma_f32_16x16x32_bf16 v[180:183], a[48:51], a[88:91], v[180:183]
    ds_read_b128 a[36:39], v48 offset:10240
    v_mfma_f32_16x16x32_bf16 v[212:215], a[48:51], a[92:95], v[212:215]
    ds_read_b128 a[40:43], v48 offset:12288
    v_mfma_f32_16x16x32_bf16 v[216:219], a[52:55], a[92:95], v[216:219]
    ds_read_b128 a[44:47], v48 offset:14336
    v_mfma_f32_16x16x32_bf16 v[184:187], a[52:55], a[88:91], v[184:187]
    buffer_load_dwordx4 v45, s[20:23], s37 offen offset:1024 lds
    v_mfma_f32_16x16x32_bf16 v[152:155], a[52:55], a[84:87], v[152:155]
    ds_read_b64_tr_b16 a[4:5], v51 offset:16384
    v_mfma_f32_16x16x32_bf16 v[120:123], a[52:55], a[80:83], v[120:123]
    ds_read_b64_tr_b16 a[6:7], v51 offset:17408
    v_mfma_f32_16x16x32_bf16 v[124:127], a[56:59], a[80:83], v[124:127]
    ds_read_b64_tr_b16 a[8:9], v52 offset:16384
    v_mfma_f32_16x16x32_bf16 v[156:159], a[56:59], a[84:87], v[156:159]
    ds_read_b64_tr_b16 a[10:11], v52 offset:17408
    v_mfma_f32_16x16x32_bf16 v[188:191], a[56:59], a[88:91], v[188:191]
    buffer_load_dwordx4 v46, s[20:23], s37 offen offset:2048 lds
    v_mfma_f32_16x16x32_bf16 v[220:223], a[56:59], a[92:95], v[220:223]
    ds_read_b64_tr_b16 a[12:13], v53 offset:16384
    v_mfma_f32_16x16x32_bf16 v[224:227], a[60:63], a[92:95], v[224:227]
    ds_read_b64_tr_b16 a[14:15], v53 offset:17408
    v_mfma_f32_16x16x32_bf16 v[192:195], a[60:63], a[88:91], v[192:195]
    ds_read_b64_tr_b16 a[16:17], v54 offset:16384
    v_mfma_f32_16x16x32_bf16 v[160:163], a[60:63], a[84:87], v[160:163]
    ds_read_b64_tr_b16 a[18:19], v54 offset:17408
    v_mfma_f32_16x16x32_bf16 v[128:131], a[60:63], a[80:83], v[128:131]
    buffer_load_dwordx4 v47, s[20:23], s37 offen offset:3072 lds
    v_mfma_f32_16x16x32_bf16 v[132:135], a[64:67], a[80:83], v[132:135]
    ds_read_b64_tr_b16 a[20:21], v55 offset:16384
    v_mfma_f32_16x16x32_bf16 v[164:167], a[64:67], a[84:87], v[164:167]
    ds_read_b64_tr_b16 a[22:23], v55 offset:17408
    v_mfma_f32_16x16x32_bf16 v[196:199], a[64:67], a[88:91], v[196:199]
    ds_read_b64_tr_b16 a[24:25], v56 offset:16384
    v_mfma_f32_16x16x32_bf16 v[228:231], a[64:67], a[92:95], v[228:231]
    s_add_u32 m0, s38, 0
    s_mov_b32 s36, 768
    ds_read_b64_tr_b16 a[26:27], v56 offset:17408
    v_mfma_f32_16x16x32_bf16 v[232:235], a[68:71], a[92:95], v[232:235]
    buffer_load_dwordx4 v36, s[16:19], s36 offen offset:0 lds
    v_mfma_f32_16x16x32_bf16 v[200:203], a[68:71], a[88:91], v[200:203]
    ds_read_b64_tr_b16 a[28:29], v57 offset:16384
    v_mfma_f32_16x16x32_bf16 v[168:171], a[68:71], a[84:87], v[168:171]
    ds_read_b64_tr_b16 a[30:31], v57 offset:17408
    v_mfma_f32_16x16x32_bf16 v[136:139], a[68:71], a[80:83], v[136:139]
    v_mfma_f32_16x16x32_bf16 v[140:143], a[72:75], a[80:83], v[140:143]
    v_mfma_f32_16x16x32_bf16 v[172:175], a[72:75], a[84:87], v[172:175]
    buffer_load_dwordx4 v37, s[16:19], s36 offen offset:1024 lds
    v_mfma_f32_16x16x32_bf16 v[204:207], a[72:75], a[88:91], v[204:207]
    v_mfma_f32_16x16x32_bf16 v[236:239], a[72:75], a[92:95], v[236:239]
    v_mfma_f32_16x16x32_bf16 v[240:243], a[76:79], a[92:95], v[240:243]
    v_mfma_f32_16x16x32_bf16 v[208:211], a[76:79], a[88:91], v[208:211]
    v_mfma_f32_16x16x32_bf16 v[176:179], a[76:79], a[84:87], v[176:179]
    v_mfma_f32_16x16x32_bf16 v[144:147], a[76:79], a[80:83], v[144:147]
    s_waitcnt lgkmcnt(0)
    v_mfma_f32_16x16x32_bf16 v[100:103], a[0:3], v[32:35], v[100:103]
    ds_read_b64_tr_b16 a[48:49], v50 offset:24576
    v_mfma_f32_16x16x32_bf16 v[104:107], a[4:7], v[32:35], v[104:107]
    ds_read_b64_tr_b16 a[50:51], v50 offset:25600
    v_mfma_f32_16x16x32_bf16 v[116:119], a[0:3], a[32:35], v[116:119]
    buffer_load_dwordx4 v38, s[16:19], s36 offen offset:2048 lds
    v_mfma_f32_16x16x32_bf16 v[148:151], a[0:3], a[36:39], v[148:151]
    ds_read_b128 a[80:83], v49 offset:8192
    v_mfma_f32_16x16x32_bf16 v[180:183], a[0:3], a[40:43], v[180:183]
    ds_read_b128 a[84:87], v49 offset:10240
    v_mfma_f32_16x16x32_bf16 v[212:215], a[0:3], a[44:47], v[212:215]
    ds_read_b128 a[88:91], v49 offset:12288
    v_mfma_f32_16x16x32_bf16 v[216:219], a[4:7], a[44:47], v[216:219]
    ds_read_b128 a[92:95], v49 offset:14336
    v_mfma_f32_16x16x32_bf16 v[184:187], a[4:7], a[40:43], v[184:187]
    buffer_load_dwordx4 v39, s[16:19], s36 offen offset:3072 lds
    v_mfma_f32_16x16x32_bf16 v[152:155], a[4:7], a[36:39], v[152:155]
    ds_read_b64_tr_b16 a[52:53], v51 offset:24576
    v_mfma_f32_16x16x32_bf16 v[120:123], a[4:7], a[32:35], v[120:123]
    ds_read_b64_tr_b16 a[54:55], v51 offset:25600
    v_mfma_f32_16x16x32_bf16 v[124:127], a[8:11], a[32:35], v[124:127]
    ds_read_b64_tr_b16 a[56:57], v52 offset:24576
    v_mfma_f32_16x16x32_bf16 v[156:159], a[8:11], a[36:39], v[156:159]
    s_add_u32 m0, s38, 4096
    ds_read_b64_tr_b16 a[58:59], v52 offset:25600
    v_mfma_f32_16x16x32_bf16 v[188:191], a[8:11], a[40:43], v[188:191]
    buffer_load_dwordx4 v40, s[16:19], s36 offen offset:0 lds
    v_mfma_f32_16x16x32_bf16 v[220:223], a[8:11], a[44:47], v[220:223]
    ds_read_b64_tr_b16 a[60:61], v53 offset:24576
    v_mfma_f32_16x16x32_bf16 v[224:227], a[12:15], a[44:47], v[224:227]
    ds_read_b64_tr_b16 a[62:63], v53 offset:25600
    v_mfma_f32_16x16x32_bf16 v[192:195], a[12:15], a[40:43], v[192:195]
    ds_read_b64_tr_b16 a[64:65], v54 offset:24576
    v_mfma_f32_16x16x32_bf16 v[160:163], a[12:15], a[36:39], v[160:163]
    ds_read_b64_tr_b16 a[66:67], v54 offset:25600
    v_mfma_f32_16x16x32_bf16 v[128:131], a[12:15], a[32:35], v[128:131]
    buffer_load_dwordx4 v41, s[16:19], s36 offen offset:1024 lds
    v_mfma_f32_16x16x32_bf16 v[132:135], a[16:19], a[32:35], v[132:135]
    ds_read_b64_tr_b16 a[68:69], v55 offset:24576
    v_mfma_f32_16x16x32_bf16 v[164:167], a[16:19], a[36:39], v[164:167]
    ds_read_b64_tr_b16 a[70:71], v55 offset:25600
    v_mfma_f32_16x16x32_bf16 v[196:199], a[16:19], a[40:43], v[196:199]
    ds_read_b64_tr_b16 a[72:73], v56 offset:24576
    v_mfma_f32_16x16x32_bf16 v[228:231], a[16:19], a[44:47], v[228:231]
    ds_read_b64_tr_b16 a[74:75], v56 offset:25600
    v_mfma_f32_16x16x32_bf16 v[232:235], a[20:23], a[44:47], v[232:235]
    buffer_load_dwordx4 v42, s[16:19], s36 offen offset:2048 lds
    v_mfma_f32_16x16x32_bf16 v[200:203], a[20:23], a[40:43], v[200:203]
    ds_read_b64_tr_b16 a[76:77], v57 offset:24576
    v_mfma_f32_16x16x32_bf16 v[168:171], a[20:23], a[36:39], v[168:171]
    ds_read_b64_tr_b16 a[78:79], v57 offset:25600
    v_mfma_f32_16x16x32_bf16 v[136:139], a[20:23], a[32:35], v[136:139]
    v_mfma_f32_16x16x32_bf16 v[140:143], a[24:27], a[32:35], v[140:143]
    v_mfma_f32_16x16x32_bf16 v[172:175], a[24:27], a[36:39], v[172:175]
    buffer_load_dwordx4 v43, s[16:19], s36 offen offset:3072 lds
    v_mfma_f32_16x16x32_bf16 v[204:207], a[24:27], a[40:43], v[204:207]
    v_mfma_f32_16x16x32_bf16 v[236:239], a[24:27], a[44:47], v[236:239]
    v_mfma_f32_16x16x32_bf16 v[240:243], a[28:31], a[44:47], v[240:243]
    v_mfma_f32_16x16x32_bf16 v[208:211], a[28:31], a[40:43], v[208:211]
    v_mfma_f32_16x16x32_bf16 v[176:179], a[28:31], a[36:39], v[176:179]
    v_mfma_f32_16x16x32_bf16 v[144:147], a[28:31], a[32:35], v[144:147]
    s_waitcnt vmcnt(12) lgkmcnt(0)
    s_barrier
    s_cmp_lg_u32 s5, 0
    s_cbranch_scc1 L_signalled
    s_mov_b64 exec, 1
    buffer_atomic_add v27, off, s[92:95], s74 sc1
    s_mov_b64 exec, -1
L_signalled:
    v_mfma_f32_16x16x32_bf16 v[100:103], a[48:51], v[32:35], v[100:103]
    ds_read_b64_tr_b16 a[0:1], v50 offset:32768
    v_mfma_f32_16x16x32_bf16 v[104:107], a[52:55], v[32:35], v[104:107]
    s_add_u32 m0, s39, 16384
    s_mov_b32 s37, 3670016
    ds_read_b64_tr_b16 a[2:3], v50 offset:33792
    v_mfma_f32_16x16x32_bf16 v[116:119], a[48:51], a[80:83], v[116:119]
    buffer_load_dwordx4 v44, s[20:23], s37 offen offset:0 lds
    v_mfma_f32_16x16x32_bf16 v[148:151], a[48:51], a[84:87], v[148:151]
    ds_read_b128 a[32:35], v48 offset:16384
    v_mfma_f32_16x16x32_bf16 v[180:183], a[48:51], a[88:91], v[180:183]
    ds_read_b128 a[36:39], v48 offset:18432
    v_mfma_f32_16x16x32_bf16 v[212:215], a[48:51], a[92:95], v[212:215]
    buffer_load_dwordx4 v45, s[20:23], s37 offen offset:1024 lds
    v_mfma_f32_16x16x32_bf16 v[216:219], a[52:55], a[92:95], v[216:219]
    ds_read_b128 a[40:43], v48 offset:20480
    v_mfma_f32_16x16x32_bf16 v[184:187], a[52:55], a[88:91], v[184:187]
    ds_read_b128 a[44:47], v48 offset:22528
    v_mfma_f32_16x16x32_bf16 v[152:155], a[52:55], a[84:87], v[152:155]
    ds_read_b64_tr_b16 a[4:5], v51 offset:32768
    v_mfma_f32_16x16x32_bf16 v[120:123], a[52:55], a[80:83], v[120:123]
    buffer_load_dwordx4 v46, s[20:23], s37 offen offset:2048 lds
    v_mfma_f32_16x16x32_bf16 v[124:127], a[56:59], a[80:83], v[124:127]
    ds_read_b64_tr_b16 a[6:7], v51 offset:33792
    v_mfma_f32_16x16x32_bf16 v[156:159], a[56:59], a[84:87], v[156:159]
    ds_read_b64_tr_b16 a[8:9], v52 offset:32768
    v_mfma_f32_16x16x32_bf16 v[188:191], a[56:59], a[88:91], v[188:191]
    ds_read_b64_tr_b16 a[10:11], v52 offset:33792
    v_mfma_f32_16x16x32_bf16 v[220:223], a[56:59], a[92:95], v[220:223]
    buffer_load_dwordx4 v47, s[20:23], s37 offen offset:3072 lds
    v_mfma_f32_16x16x32_bf16 v[224:227], a[60:63], a[92:95], v[224:227]
    ds_read_b64_tr_b16 a[12:13], v53 offset:32768
    v_mfma_f32_16x16x32_bf16 v[192:195], a[60:63], a[88:91], v[192:195]
    ds_read_b64_tr_b16 a[14:15], v53 offset:33792
    v_mfma_f32_16x16x32_bf16 v[160:163], a[60:63], a[84:87], v[160:163]
    s_add_u32 m0, s38, 8192
    s_mov_b32 s36, 896
    ds_read_b64_tr_b16 a[16:17], v54 offset:32768
    v_mfma_f32_16x16x32_bf16 v[128:131], a[60:63], a[80:83], v[128:131]
    buffer_load_dwordx4 v36, s[16:19], s36 offen offset:0 lds
    v_mfma_f32_16x16x32_bf16 v[132:135], a[64:67], a[80:83], v[132:135]
    ds_read_b64_tr_b16 a[18:19], v54 offset:33792
    v_mfma_f32_16x16x32_bf16 v[164:167], a[64:67], a[84:87], v[164:167]
    ds_read_b64_tr_b16 a[20:21], v55 offset:32768
    v_mfma_f32_16x16x32_bf16 v[196:199], a[64:67], a[88:91], v[196:199]
    buffer_load_dwordx4 v37, s[16:19], s36 offen offset:1024 lds
    v_mfma_f32_16x16x32_bf16 v[228:231], a[64:67], a[92:95], v[228:231]
    ds_read_b64_tr_b16 a[22:23], v55 offset:33792
    v_mfma_f32_16x16x32_bf16 v[232:235], a[68:71], a[92:95], v[232:235]
    ds_read_b64_tr_b16 a[24:25], v56 offset:32768
    v_mfma_f32_16x16x32_bf16 v[200:203], a[68:71], a[88:91], v[200:203]
    ds_read_b64_tr_b16 a[26:27], v56 offset:33792
    v_mfma_f32_16x16x32_bf16 v[168:171], a[68:71], a[84:87], v[168:171]
    buffer_load_dwordx4 v38, s[16:19], s36 offen offset:2048 lds
    v_mfma_f32_16x16x32_bf16 v[136:139], a[68:71], a[80:83], v[136:139]
    ds_read_b64_tr_b16 a[28:29], v57 offset:32768
    v_mfma_f32_16x16x32_bf16 v[140:143], a[72:75], a[80:83], v[140:143]
    ds_read_b64_tr_b16 a[30:31], v57 offset:33792
    v_mfma_f32_16x16x32_bf16 v[172:175], a[72:75], a[84:87], v[172:175]
    v_mfma_f32_16x16x32_bf16 v[204:207], a[72:75], a[88:91], v[204:207]
    buffer_load_dwordx4 v39, s[16:19], s36 offen offset:3072 lds
    v_mfma_f32_16x16x32_bf16 v[236:239], a[72:75], a[92:95], v[236:239]
    v_mfma_f32_16x16x32_bf16 v[240:243], a[76:79], a[92:95], v[240:243]
    v_mfma_f32_16x16x32_bf16 v[208:211], a[76:79], a[88:91], v[208:211]
    v_mfma_f32_16x16x32_bf16 v[176:179], a[76:79], a[84:87], v[176:179]
    v_mfma_f32_16x16x32_bf16 v[144:147], a[76:79], a[80:83], v[144:147]
    s_waitcnt lgkmcnt(0)
    v_mfma_f32_16x16x32_bf16 v[100:103], a[0:3], v[32:35], v[100:103]
    ds_read_b64_tr_b16 a[48:49], v50 offset:40960
    v_mfma_f32_16x16x32_bf16 v[104:107], a[4:7], v[32:35], v[104:107]
    s_add_u32 m0, s38, 12288
    ds_read_b64_tr_b16 a[50:51], v50 offset:41984
    v_mfma_f32_16x16x32_bf16 v[116:119], a[0:3], a[32:35], v[116:119]
    buffer_load_dwordx4 v40, s[16:19], s36 offen offset:0 lds
    v_mfma_f32_16x16x32_bf16 v[148:151], a[0:3], a[36:39], v[148:151]
    ds_read_b128 a[80:83], v49 offset:16384
    v_mfma_f32_16x16x32_bf16 v[180:183], a[0:3], a[40:43], v[180:183]
    ds_read_b128 a[84:87], v49 offset:18432
    v_mfma_f32_16x16x32_bf16 v[212:215], a[0:3], a[44:47], v[212:215]
    buffer_load_dwordx4 v41, s[16:19], s36 offen offset:1024 lds
    v_mfma_f32_16x16x32_bf16 v[216:219], a[4:7], a[44:47], v[216:219]
    ds_read_b128 a[88:91], v49 offset:20480
    v_mfma_f32_16x16x32_bf16 v[184:187], a[4:7], a[40:43], v[184:187]
    ds_read_b128 a[92:95], v49 offset:22528
    v_mfma_f32_16x16x32_bf16 v[152:155], a[4:7], a[36:39], v[152:155]
    ds_read_b64_tr_b16 a[52:53], v51 offset:40960
    v_mfma_f32_16x16x32_bf16 v[120:123], a[4:7], a[32:35], v[120:123]
    buffer_load_dwordx4 v42, s[16:19], s36 offen offset:2048 lds
    v_mfma_f32_16x16x32_bf16 v[124:127], a[8:11], a[32:35], v[124:127]
    ds_read_b64_tr_b16 a[54:55], v51 offset:41984
    v_mfma_f32_16x16x32_bf16 v[156:159], a[8:11], a[36:39], v[156:159]
    ds_read_b64_tr_b16 a[56:57], v52 offset:40960
    v_mfma_f32_16x16x32_bf16 v[188:191], a[8:11], a[40:43], v[188:191]
    ds_read_b64_tr_b16 a[58:59], v52 offset:41984
    v_mfma_f32_16x16x32_bf16 v[220:223], a[8:11], a[44:47], v[220:223]
    buffer_load_dwordx4 v43, s[16:19], s36 offen offset:3072 lds
    v_mfma_f32_16x16x32_bf16 v[224:227], a[12:15], a[44:47], v[224:227]
    ds_read_b64_tr_b16 a[60:61], v53 offset:40960
    v_mfma_f32_16x16x32_bf16 v[192:195], a[12:15], a[40:43], v[192:195]
    ds_read_b64_tr_b16 a[62:63], v53 offset:41984
    v_mfma_f32_16x16x32_bf16 v[160:163], a[12:15], a[36:39], v[160:163]
    s_add_u32 m0, s34, 49152
    ds_read_b64_tr_b16 a[64:65], v54 offset:40960
    v_mfma_f32_16x16x32_bf16 v[128:131], a[12:15], a[32:35], v[128:131]
    buffer_load_dwordx4 v13, s[8:11], s28 offen offset:0 lds
    v_mfma_f32_16x16x32_bf16 v[132:135], a[16:19], a[32:35], v[132:135]
    ds_read_b64_tr_b16 a[66:67], v54 offset:41984
    v_mfma_f32_16x16x32_bf16 v[164:167], a[16:19], a[36:39], v[164:167]
    ds_read_b64_tr_b16 a[68:69], v55 offset:40960
    v_mfma_f32_16x16x32_bf16 v[196:199], a[16:19], a[40:43], v[196:199]
    buffer_load_dwordx4 v14, s[8:11], s28 offen offset:1024 lds
    v_mfma_f32_16x16x32_bf16 v[228:231], a[16:19], a[44:47], v[228:231]
    ds_read_b64_tr_b16 a[70:71], v55 offset:41984
    v_mfma_f32_16x16x32_bf16 v[232:235], a[20:23], a[44:47], v[232:235]
    ds_read_b64_tr_b16 a[72:73], v56 offset:40960
    v_mfma_f32_16x16x32_bf16 v[200:203], a[20:23], a[40:43], v[200:203]
    ds_read_b64_tr_b16 a[74:75], v56 offset:41984
    v_mfma_f32_16x16x32_bf16 v[168:171], a[20:23], a[36:39], v[168:171]
    buffer_load_dwordx4 v15, s[8:11], s28 offen offset:2048 lds
    v_mfma_f32_16x16x32_bf16 v[136:139], a[20:23], a[32:35], v[136:139]
    ds_read_b64_tr_b16 a[76:77], v57 offset:40960
    v_mfma_f32_16x16x32_bf16 v[140:143], a[24:27], a[32:35], v[140:143]
    ds_read_b64_tr_b16 a[78:79], v57 offset:41984
    v_mfma_f32_16x16x32_bf16 v[172:175], a[24:27], a[36:39], v[172:175]
    v_mfma_f32_16x16x32_bf16 v[204:207], a[24:27], a[40:43], v[204:207]
    buffer_load_dwordx4 v16, s[8:11], s28 offen offset:3072 lds
    v_mfma_f32_16x16x32_bf16 v[236:239], a[24:27], a[44:47], v[236:239]
    v_mfma_f32_16x16x32_bf16 v[240:243], a[28:31], a[44:47], v[240:243]
    v_mfma_f32_16x16x32_bf16 v[208:211], a[28:31], a[40:43], v[208:211]
    v_mfma_f32_16x16x32_bf16 v[176:179], a[28:31], a[36:39], v[176:179]
    v_mfma_f32_16x16x32_bf16 v[144:147], a[28:31], a[32:35], v[144:147]
    s_add_u32 s28, s28, 16384
    s_waitcnt vmcnt(16) lgkmcnt(0)
    s_barrier
    v_mfma_f32_16x16x32_bf16 v[100:103], a[48:51], v[32:35], v[100:103]
    ds_read_b64_tr_b16 a[0:1], v50 offset:0
    v_mfma_f32_16x16x32_bf16 v[104:107], a[52:55], v[32:35], v[104:107]
    s_add_u32 m0, s39, 32768
    s_mov_b32 s37, 4194304
    ds_read_b64_tr_b16 a[2:3], v50 offset:1024
    v_mfma_f32_16x16x32_bf16 v[116:119], a[48:51], a[80:83], v[116:119]
    buffer_load_dwordx4 v44, s[20:23], s37 offen offset:0 lds
    v_mfma_f32_16x16x32_bf16 v[148:151], a[48:51], a[84:87], v[148:151]
    ds_read_b128 a[32:35], v48 offset:0
    v_mfma_f32_16x16x32_bf16 v[180:183], a[48:51], a[88:91], v[180:183]
    ds_read_b128 a[36:39], v48 offset:2048
    v_mfma_f32_16x16x32_bf16 v[212:215], a[48:51], a[92:95], v[212:215]
    ds_read_b128 a[40:43], v48 offset:4096
    v_mfma_f32_16x16x32_bf16 v[216:219], a[52:55], a[92:95], v[216:219]
    ds_read_b128 a[44:47], v48 offset:6144
    v_mfma_f32_16x16x32_bf16 v[184:187], a[52:55], a[88:91], v[184:187]
    buffer_load_dwordx4 v45, s[20:23], s37 offen offset:1024 lds
    v_mfma_f32_16x16x32_bf16 v[152:155], a[52:55], a[84:87], v[152:155]
    ds_read_b64_tr_b16 a[4:5], v51 offset:0
    v_mfma_f32_16x16x32_bf16 v[120:123], a[52:55], a[80:83], v[120:123]
    ds_read_b64_tr_b16 a[6:7], v51 offset:1024
    v_mfma_f32_16x16x32_bf16 v[124:127], a[56:59], a[80:83], v[124:127]
    ds_read_b64_tr_b16 a[8:9], v52 offset:0
    v_mfma_f32_16x16x32_bf16 v[156:159], a[56:59], a[84:87], v[156:159]
    ds_read_b64_tr_b16 a[10:11], v52 offset:1024
    v_mfma_f32_16x16x32_bf16 v[188:191], a[56:59], a[88:91], v[188:191]
    buffer_load_dwordx4 v46, s[20:23], s37 offen offset:2048 lds
    v_mfma_f32_16x16x32_bf16 v[220:223], a[56:59], a[92:95], v[220:223]
    ds_read_b64_tr_b16 a[12:13], v53 offset:0
    v_mfma_f32_16x16x32_bf16 v[224:227], a[60:63], a[92:95], v[224:227]
    ds_read_b64_tr_b16 a[14:15], v53 offset:1024
    v_mfma_f32_16x16x32_bf16 v[192:195], a[60:63], a[88:91], v[192:195]
    ds_read_b64_tr_b16 a[16:17], v54 offset:0
    v_mfma_f32_16x16x32_bf16 v[160:163], a[60:63], a[84:87], v[160:163]
    ds_read_b64_tr_b16 a[18:19], v54 offset:1024
    v_mfma_f32_16x16x32_bf16 v[128:131], a[60:63], a[80:83], v[128:131]
    buffer_load_dwordx4 v47, s[20:23], s37 offen offset:3072 lds
    v_mfma_f32_16x16x32_bf16 v[132:135], a[64:67], a[80:83], v[132:135]
    ds_read_b64_tr_b16 a[20:21], v55 offset:0
    v_mfma_f32_16x16x32_bf16 v[164:167], a[64:67], a[84:87], v[164:167]
    ds_read_b64_tr_b16 a[22:23], v55 offset:1024
    v_mfma_f32_16x16x32_bf16 v[196:199], a[64:67], a[88:91], v[196:199]
    ds_read_b64_tr_b16 a[24:25], v56 offset:0
    v_mfma_f32_16x16x32_bf16 v[228:231], a[64:67], a[92:95], v[228:231]
    s_add_u32 m0, s38, 16384
    s_mov_b32 s36, 1024
    ds_read_b64_tr_b16 a[26:27], v56 offset:1024
    v_mfma_f32_16x16x32_bf16 v[232:235], a[68:71], a[92:95], v[232:235]
    buffer_load_dwordx4 v36, s[16:19], s36 offen offset:0 lds
    v_mfma_f32_16x16x32_bf16 v[200:203], a[68:71], a[88:91], v[200:203]
    ds_read_b64_tr_b16 a[28:29], v57 offset:0
    v_mfma_f32_16x16x32_bf16 v[168:171], a[68:71], a[84:87], v[168:171]
    ds_read_b64_tr_b16 a[30:31], v57 offset:1024
    v_mfma_f32_16x16x32_bf16 v[136:139], a[68:71], a[80:83], v[136:139]
    v_mfma_f32_16x16x32_bf16 v[140:143], a[72:75], a[80:83], v[140:143]
    v_mfma_f32_16x16x32_bf16 v[172:175], a[72:75], a[84:87], v[172:175]
    buffer_load_dwordx4 v37, s[16:19], s36 offen offset:1024 lds
    v_mfma_f32_16x16x32_bf16 v[204:207], a[72:75], a[88:91], v[204:207]
    v_mfma_f32_16x16x32_bf16 v[236:239], a[72:75], a[92:95], v[236:239]
    v_mfma_f32_16x16x32_bf16 v[240:243], a[76:79], a[92:95], v[240:243]
    v_mfma_f32_16x16x32_bf16 v[208:211], a[76:79], a[88:91], v[208:211]
    v_mfma_f32_16x16x32_bf16 v[176:179], a[76:79], a[84:87], v[176:179]
    v_mfma_f32_16x16x32_bf16 v[144:147], a[76:79], a[80:83], v[144:147]
    s_waitcnt lgkmcnt(0)
    v_mfma_f32_16x16x32_bf16 v[100:103], a[0:3], v[32:35], v[100:103]
    ds_read_b64_tr_b16 a[48:49], v50 offset:8192
    v_mfma_f32_16x16x32_bf16 v[104:107], a[4:7], v[32:35], v[104:107]
    ds_read_b64_tr_b16 a[50:51], v50 offset:9216
    v_mfma_f32_16x16x32_bf16 v[116:119], a[0:3], a[32:35], v[116:119]
    buffer_load_dwordx4 v38, s[16:19], s36 offen offset:2048 lds
    v_mfma_f32_16x16x32_bf16 v[148:151], a[0:3], a[36:39], v[148:151]
    ds_read_b128 a[80:83], v49 offset:0
    v_mfma_f32_16x16x32_bf16 v[180:183], a[0:3], a[40:43], v[180:183]
    ds_read_b128 a[84:87], v49 offset:2048
    v_mfma_f32_16x16x32_bf16 v[212:215], a[0:3], a[44:47], v[212:215]
    ds_read_b128 a[88:91], v49 offset:4096
    v_mfma_f32_16x16x32_bf16 v[216:219], a[4:7], a[44:47], v[216:219]
    ds_read_b128 a[92:95], v49 offset:6144
    v_mfma_f32_16x16x32_bf16 v[184:187], a[4:7], a[40:43], v[184:187]
    buffer_load_dwordx4 v39, s[16:19], s36 offen offset:3072 lds
    v_mfma_f32_16x16x32_bf16 v[152:155], a[4:7], a[36:39], v[152:155]
    ds_read_b64_tr_b16 a[52:53], v51 offset:8192
    v_mfma_f32_16x16x32_bf16 v[120:123], a[4:7], a[32:35], v[120:123]
    ds_read_b64_tr_b16 a[54:55], v51 offset:9216
    v_mfma_f32_16x16x32_bf16 v[124:127], a[8:11], a[32:35], v[124:127]
    ds_read_b64_tr_b16 a[56:57], v52 offset:8192
    v_mfma_f32_16x16x32_bf16 v[156:159], a[8:11], a[36:39], v[156:159]
    s_add_u32 m0, s38, 20480
    ds_read_b64_tr_b16 a[58:59], v52 offset:9216
    v_mfma_f32_16x16x32_bf16 v[188:191], a[8:11], a[40:43], v[188:191]
    buffer_load_dwordx4 v40, s[16:19], s36 offen offset:0 lds
    v_mfma_f32_16x16x32_bf16 v[220:223], a[8:11], a[44:47], v[220:223]
    ds_read_b64_tr_b16 a[60:61], v53 offset:8192
    v_mfma_f32_16x16x32_bf16 v[224:227], a[12:15], a[44:47], v[224:227]
    ds_read_b64_tr_b16 a[62:63], v53 offset:9216
    v_mfma_f32_16x16x32_bf16 v[192:195], a[12:15], a[40:43], v[192:195]
    ds_read_b64_tr_b16 a[64:65], v54 offset:8192
    v_mfma_f32_16x16x32_bf16 v[160:163], a[12:15], a[36:39], v[160:163]
    ds_read_b64_tr_b16 a[66:67], v54 offset:9216
    v_mfma_f32_16x16x32_bf16 v[128:131], a[12:15], a[32:35], v[128:131]
    buffer_load_dwordx4 v41, s[16:19], s36 offen offset:1024 lds
    v_mfma_f32_16x16x32_bf16 v[132:135], a[16:19], a[32:35], v[132:135]
    ds_read_b64_tr_b16 a[68:69], v55 offset:8192
    v_mfma_f32_16x16x32_bf16 v[164:167], a[16:19], a[36:39], v[164:167]
    ds_read_b64_tr_b16 a[70:71], v55 offset:9216
    v_mfma_f32_16x16x32_bf16 v[196:199], a[16:19], a[40:43], v[196:199]
    ds_read_b64_tr_b16 a[72:73], v56 offset:8192
    v_mfma_f32_16x16x32_bf16 v[228:231], a[16:19], a[44:47], v[228:231]
    ds_read_b64_tr_b16 a[74:75], v56 offset:9216
    v_mfma_f32_16x16x32_bf16 v[232:235], a[20:23], a[44:47], v[232:235]
    buffer_load_dwordx4 v42, s[16:19], s36 offen offset:2048 lds
    v_mfma_f32_16x16x32_bf16 v[200:203], a[20:23], a[40:43], v[200:203]
    ds_read_b64_tr_b16 a[76:77], v57 offset:8192
    v_mfma_f32_16x16x32_bf16 v[168:171], a[20:23], a[36:39], v[168:171]
    ds_read_b64_tr_b16 a[78:79], v57 offset:9216
    v_mfma_f32_16x16x32_bf16 v[136:139], a[20:23], a[32:35], v[136:139]
    v_mfma_f32_16x16x32_bf16 v[140:143], a[24:27], a[32:35], v[140:143]
    v_mfma_f32_16x16x32_bf16 v[172:175], a[24:27], a[36:39], v[172:175]
    buffer_load_dwordx4 v43, s[16:19], s36 offen offset:3072 lds
    v_mfma_f32_16x16x32_bf16 v[204:207], a[24:27], a[40:43], v[204:207]
    v_mfma_f32_16x16x32_bf16 v[236:239], a[24:27], a[44:47], v[236:239]
    v_mfma_f32_16x16x32_bf16 v[240:243], a[28:31], a[44:47], v[240:243]
    v_mfma_f32_16x16x32_bf16 v[208:211], a[28:31], a[40:43], v[208:211]
    v_mfma_f32_16x16x32_bf16 v[176:179], a[28:31], a[36:39], v[176:179]
    v_mfma_f32_16x16x32_bf16 v[144:147], a[28:31], a[32:35], v[144:147]
    s_waitcnt vmcnt(16) lgkmcnt(0)
    s_barrier
    v_mfma_f32_16x16x32_bf16 v[100:103], a[48:51], v[32:35], v[100:103]
    ds_read_b64_tr_b16 a[0:1], v50 offset:16384
    v_mfma_f32_16x16x32_bf16 v[104:107], a[52:55], v[32:35], v[104:107]
    s_add_u32 m0, s39, 0
    s_mov_b32 s37, 4718592
    ds_read_b64_tr_b16 a[2:3], v50 offset:17408
    v_mfma_f32_16x16x32_bf16 v[116:119], a[48:51], a[80:83], v[116:119]
    buffer_load_dwordx4 v44, s[20:23], s37 offen offset:0 lds
    v_mfma_f32_16x16x32_bf16 v[148:151], a[48:51], a[84:87], v[148:151]
    ds_read_b128 a[32:35], v48 offset:8192
    v_mfma_f32_16x16x32_bf16 v[180:183], a[48:51], a[88:91], v[180:183]
    ds_read_b128 a[36:39], v48 offset:10240
    v_mfma_f32_16x16x32_bf16 v[212:215], a[48:51], a[92:95], v[212:215]
    ds_read_b128 a[40:43], v48 offset:12288
    v_mfma_f32_16x16x32_bf16 v[216:219], a[52:55], a[92:95], v[216:219]
    ds_read_b128 a[44:47], v48 offset:14336
    v_mfma_f32_16x16x32_bf16 v[184:187], a[52:55], a[88:91], v[184:187]
    buffer_load_dwordx4 v45, s[20:23], s37 offen offset:1024 lds
    v_mfma_f32_16x16x32_bf16 v[152:155], a[52:55], a[84:87], v[152:155]
    ds_read_b64_tr_b16 a[4:5], v51 offset:16384
    v_mfma_f32_16x16x32_bf16 v[120:123], a[52:55], a[80:83], v[120:123]
    ds_read_b64_tr_b16 a[6:7], v51 offset:17408
    v_mfma_f32_16x16x32_bf16 v[124:127], a[56:59], a[80:83], v[124:127]
    ds_read_b64_tr_b16 a[8:9], v52 offset:16384
    v_mfma_f32_16x16x32_bf16 v[156:159], a[56:59], a[84:87], v[156:159]
    ds_read_b64_tr_b16 a[10:11], v52 offset:17408
    v_mfma_f32_16x16x32_bf16 v[188:191], a[56:59], a[88:91], v[188:191]
    buffer_load_dwordx4 v46, s[20:23], s37 offen offset:2048 lds
    v_mfma_f32_16x16x32_bf16 v[220:223], a[56:59], a[92:95], v[220:223]
    ds_read_b64_tr_b16 a[12:13], v53 offset:16384
    v_mfma_f32_16x16x32_bf16 v[224:227], a[60:63], a[92:95], v[224:227]
    ds_read_b64_tr_b16 a[14:15], v53 offset:17408
    v_mfma_f32_16x16x32_bf16 v[192:195], a[60:63], a[88:91], v[192:195]
    ds_read_b64_tr_b16 a[16:17], v54 offset:16384
    v_mfma_f32_16x16x32_bf16 v[160:163], a[60:63], a[84:87], v[160:163]
    ds_read_b64_tr_b16 a[18:19], v54 offset:17408
    v_mfma_f32_16x16x32_bf16 v[128:131], a[60:63], a[80:83], v[128:131]
    buffer_load_dwordx4 v47, s[20:23], s37 offen offset:3072 lds
    v_mfma_f32_16x16x32_bf16 v[132:135], a[64:67], a[80:83], v[132:135]
    ds_read_b64_tr_b16 a[20:21], v55 offset:16384
    v_mfma_f32_16x16x32_bf16 v[164:167], a[64:67], a[84:87], v[164:167]
    ds_read_b64_tr_b16 a[22:23], v55 offset:17408
    v_mfma_f32_16x16x32_bf16 v[196:199], a[64:67], a[88:91], v[196:199]
    ds_read_b64_tr_b16 a[24:25], v56 offset:16384
    v_mfma_f32_16x16x32_bf16 v[228:231], a[64:67], a[92:95], v[228:231]
    s_add_u32 m0, s38, 0
    s_mov_b32 s36, 1152
    ds_read_b64_tr_b16 a[26:27], v56 offset:17408
    v_mfma_f32_16x16x32_bf16 v[232:235], a[68:71], a[92:95], v[232:235]
    buffer_load_dword v252, off, s[92:95], s74 sc1
    buffer_load_dwordx4 v36, s[16:19], s36 offen offset:0 lds
    v_mfma_f32_16x16x32_bf16 v[200:203], a[68:71], a[88:91], v[200:203]
    ds_read_b64_tr_b16 a[28:29], v57 offset:16384
    v_mfma_f32_16x16x32_bf16 v[168:171], a[68:71], a[84:87], v[168:171]
    ds_read_b64_tr_b16 a[30:31], v57 offset:17408
    v_mfma_f32_16x16x32_bf16 v[136:139], a[68:71], a[80:83], v[136:139]
    v_mfma_f32_16x16x32_bf16 v[140:143], a[72:75], a[80:83], v[140:143]
    v_mfma_f32_16x16x32_bf16 v[172:175], a[72:75], a[84:87], v[172:175]
    buffer_load_dwordx4 v37, s[16:19], s36 offen offset:1024 lds
    v_mfma_f32_16x16x32_bf16 v[204:207], a[72:75], a[88:91], v[204:207]
    v_mfma_f32_16x16x32_bf16 v[236:239], a[72:75], a[92:95], v[236:239]
    v_mfma_f32_16x16x32_bf16 v[240:243], a[76:79], a[92:95], v[240:243]
    v_mfma_f32_16x16x32_bf16 v[208:211], a[76:79], a[88:91], v[208:211]
    v_mfma_f32_16x16x32_bf16 v[176:179], a[76:79], a[84:87], v[176:179]
    v_mfma_f32_16x16x32_bf16 v[144:147], a[76:79], a[80:83], v[144:147]
    s_waitcnt lgkmcnt(0)
    v_mfma_f32_16x16x32_bf16 v[100:103], a[0:3], v[32:35], v[100:103]
    ds_read_b64_tr_b16 a[48:49], v50 offset:24576
    v_mfma_f32_16x16x32_bf16 v[104:107], a[4:7], v[32:35], v[104:107]
    ds_read_b64_tr_b16 a[50:51], v50 offset:25600
    v_mfma_f32_16x16x32_bf16 v[116:119], a[0:3], a[32:35], v[116:119]
    buffer_load_dwordx4 v38, s[16:19], s36 offen offset:2048 lds
    v_mfma_f32_16x16x32_bf16 v[148:151], a[0:3], a[36:39], v[148:151]
    ds_read_b128 a[80:83], v49 offset:8192
    v_mfma_f32_16x16x32_bf16 v[180:183], a[0:3], a[40:43], v[180:183]
    ds_read_b128 a[84:87], v49 offset:10240
    v_mfma_f32_16x16x32_bf16 v[212:215], a[0:3], a[44:47], v[212:215]
    ds_read_b128 a[88:91], v49 offset:12288
    v_mfma_f32_16x16x32_bf16 v[216:219], a[4:7], a[44:47], v[216:219]
    ds_read_b128 a[92:95], v49 offset:14336
    v_mfma_f32_16x16x32_bf16 v[184:187], a[4:7], a[40:43], v[184:187]
    buffer_load_dwordx4 v39, s[16:19], s36 offen offset:3072 lds
    v_mfma_f32_16x16x32_bf16 v[152:155], a[4:7], a[36:39], v[152:155]
    ds_read_b64_tr_b16 a[52:53], v51 offset:24576
    v_mfma_f32_16x16x32_bf16 v[120:123], a[4:7], a[32:35], v[120:123]
    ds_read_b64_tr_b16 a[54:55], v51 offset:25600
    v_mfma_f32_16x16x32_bf16 v[124:127], a[8:11], a[32:35], v[124:127]
    ds_read_b64_tr_b16 a[56:57], v52 offset:24576
    v_mfma_f32_16x16x32_bf16 v[156:159], a[8:11], a[36:39], v[156:159]
    s_add_u32 m0, s38, 4096
    ds_read_b64_tr_b16 a[58:59], v52 offset:25600
    v_mfma_f32_16x16x32_bf16 v[188:191], a[8:11], a[40:43], v[188:191]
    buffer_load_dwordx4 v40, s[16:19], s36 offen offset:0 lds
    v_mfma_f32_16x16x32_bf16 v[220:223], a[8:11], a[44:47], v[220:223]
    ds_read_b64_tr_b16 a[60:61], v53 offset:24576
    v_mfma_f32_16x16x32_bf16 v[224:227], a[12:15], a[44:47], v[224:227]
    ds_read_b64_tr_b16 a[62:63], v53 offset:25600
    v_mfma_f32_16x16x32_bf16 v[192:195], a[12:15], a[40:43], v[192:195]
    ds_read_b64_tr_b16 a[64:65], v54 offset:24576
    v_mfma_f32_16x16x32_bf16 v[160:163], a[12:15], a[36:39], v[160:163]
    ds_read_b64_tr_b16 a[66:67], v54 offset:25600
    v_mfma_f32_16x16x32_bf16 v[128:131], a[12:15], a[32:35], v[128:131]
    buffer_load_dwordx4 v41, s[16:19], s36 offen offset:1024 lds
    v_mfma_f32_16x16x32_bf16 v[132:135], a[16:19], a[32:35], v[132:135]
    ds_read_b64_tr_b16 a[68:69], v55 offset:24576
    v_mfma_f32_16x16x32_bf16 v[164:167], a[16:19], a[36:39], v[164:167]
    ds_read_b64_tr_b16 a[70:71], v55 offset:25600
    v_mfma_f32_16x16x32_bf16 v[196:199], a[16:19], a[40:43], v[196:199]
    ds_read_b64_tr_b16 a[72:73], v56 offset:24576
    v_mfma_f32_16x16x32_bf16 v[228:231], a[16:19], a[44:47], v[228:231]
    ds_read_b64_tr_b16 a[74:75], v56 offset:25600
    v_mfma_f32_16x16x32_bf16 v[232:235], a[20:23], a[44:47], v[232:235]
    buffer_load_dwordx4 v42, s[16:19], s36 offen offset:2048 lds
    v_mfma_f32_16x16x32_bf16 v[200:203], a[20:23], a[40:43], v[200:203]
    ds_read_b64_tr_b16 a[76:77], v57 offset:24576
    v_mfma_f32_16x16x32_bf16 v[168:171], a[20:23], a[36:39], v[168:171]
    ds_read_b64_tr_b16 a[78:79], v57 offset:25600
    v_mfma_f32_16x16x32_bf16 v[136:139], a[20:23], a[32:35], v[136:139]
    v_mfma_f32_16x16x32_bf16 v[140:143], a[24:27], a[32:35], v[140:143]
    v_mfma_f32_16x16x32_bf16 v[172:175], a[24:27], a[36:39], v[172:175]
    buffer_load_dwordx4 v43, s[16:19], s36 offen offset:3072 lds
    v_mfma_f32_16x16x32_bf16 v[204:207], a[24:27], a[40:43], v[204:207]
    v_mfma_f32_16x16x32_bf16 v[236:239], a[24:27], a[44:47], v[236:239]
    v_mfma_f32_16x16x32_bf16 v[240:243], a[28:31], a[44:47], v[240:243]
    v_mfma_f32_16x16x32_bf16 v[208:211], a[28:31], a[40:43], v[208:211]
    v_mfma_f32_16x16x32_bf16 v[176:179], a[28:31], a[36:39], v[176:179]
    v_mfma_f32_16x16x32_bf16 v[144:147], a[28:31], a[32:35], v[144:147]
    s_waitcnt vmcnt(13) lgkmcnt(0)
    s_barrier
    v_mfma_f32_16x16x32_bf16 v[100:103], a[48:51], v[32:35], v[100:103]
    ds_read_b64_tr_b16 a[0:1], v50 offset:32768
    v_mfma_f32_16x16x32_bf16 v[104:107], a[52:55], v[32:35], v[104:107]
    s_add_u32 m0, s34, 16384
    ds_read_b64_tr_b16 a[2:3], v50 offset:33792
    v_mfma_f32_16x16x32_bf16 v[116:119], a[48:51], a[80:83], v[116:119]
    buffer_load_dwordx4 v13, s[8:11], s28 offen offset:0 lds
    v_mfma_f32_16x16x32_bf16 v[148:151], a[48:51], a[84:87], v[148:151]
    ds_read_b128 a[32:35], v48 offset:16384
    v_mfma_f32_16x16x32_bf16 v[180:183], a[48:51], a[88:91], v[180:183]
    ds_read_b128 a[36:39], v48 offset:18432
    v_mfma_f32_16x16x32_bf16 v[212:215], a[48:51], a[92:95], v[212:215]
    ds_read_b128 a[40:43], v48 offset:20480
    v_mfma_f32_16x16x32_bf16 v[216:219], a[52:55], a[92:95], v[216:219]
    ds_read_b128 a[44:47], v48 offset:22528
    v_mfma_f32_16x16x32_bf16 v[184:187], a[52:55], a[88:91], v[184:187]
    ds_read_b64_tr_b16 a[4:5], v51 offset:32768
    v_mfma_f32_16x16x32_bf16 v[152:155], a[52:55], a[84:87], v[152:155]
    ds_read_b64_tr_b16 a[6:7], v51 offset:33792
    v_mfma_f32_16x16x32_bf16 v[120:123], a[52:55], a[80:83], v[120:123]
    ds_read_b64_tr_b16 a[8:9], v52 offset:32768
    v_mfma_f32_16x16x32_bf16 v[124:127], a[56:59], a[80:83], v[124:127]
    ds_read_b64_tr_b16 a[10:11], v52 offset:33792
    v_mfma_f32_16x16x32_bf16 v[156:159], a[56:59], a[84:87], v[156:159]
    ds_read_b64_tr_b16 a[12:13], v53 offset:32768
    v_mfma_f32_16x16x32_bf16 v[188:191], a[56:59], a[88:91], v[188:191]
    ds_read_b64_tr_b16 a[14:15], v53 offset:33792
    v_mfma_f32_16x16x32_bf16 v[220:223], a[56:59], a[92:95], v[220:223]
    ds_read_b64_tr_b16 a[16:17], v54 offset:32768
    v_mfma_f32_16x16x32_bf16 v[224:227], a[60:63], a[92:95], v[224:227]
    ds_read_b64_tr_b16 a[18:19], v54 offset:33792
    v_mfma_f32_16x16x32_bf16 v[192:195], a[60:63], a[88:91], v[192:195]
    ds_read_b64_tr_b16 a[20:21], v55 offset:32768
    v_mfma_f32_16x16x32_bf16 v[160:163], a[60:63], a[84:87], v[160:163]
    ds_read_b64_tr_b16 a[22:23], v55 offset:33792
    v_mfma_f32_16x16x32_bf16 v[128:131], a[60:63], a[80:83], v[128:131]
    buffer_load_dwordx4 v14, s[8:11], s28 offen offset:1024 lds
    v_mfma_f32_16x16x32_bf16 v[132:135], a[64:67], a[80:83], v[132:135]
    ds_read_b64_tr_b16 a[24:25], v56 offset:32768
    v_mfma_f32_16x16x32_bf16 v[164:167], a[64:67], a[84:87], v[164:167]
    ds_read_b64_tr_b16 a[26:27], v56 offset:33792
    v_mfma_f32_16x16x32_bf16 v[196:199], a[64:67], a[88:91], v[196:199]
    ds_read_b64_tr_b16 a[28:29], v57 offset:32768
    v_mfma_f32_16x16x32_bf16 v[228:231], a[64:67], a[92:95], v[228:231]
    s_waitcnt vmcnt(10)
    v_cmp_gt_u32 vcc, 32, v252
    s_and_b64 vcc, vcc, exec
    s_cbranch_scc1 L_spin_rows
L_back_rows:
    buffer_load_dwordx2 v[108:109], v59, s[76:79], s46 offen offset:0 sc1
    buffer_load_dwordx2 v[110:111], v59, s[76:79], s46 offen offset:256 sc1
    buffer_load_dwordx2 v[112:113], v59, s[76:79], s46 offen offset:512 sc1
    buffer_load_dwordx2 v[114:115], v59, s[76:79], s46 offen offset:768 sc1
    ds_read_b64_tr_b16 a[30:31], v57 offset:33792
    v_mfma_f32_16x16x32_bf16 v[232:235], a[68:71], a[92:95], v[232:235]
    v_mfma_f32_16x16x32_bf16 v[200:203], a[68:71], a[88:91], v[200:203]
    v_mfma_f32_16x16x32_bf16 v[168:171], a[68:71], a[84:87], v[168:171]
    v_mfma_f32_16x16x32_bf16 v[136:139], a[68:71], a[80:83], v[136:139]
    v_mfma_f32_16x16x32_bf16 v[140:143], a[72:75], a[80:83], v[140:143]
    v_mfma_f32_16x16x32_bf16 v[172:175], a[72:75], a[84:87], v[172:175]
    v_mfma_f32_16x16x32_bf16 v[204:207], a[72:75], a[88:91], v[204:207]
    v_mfma_f32_16x16x32_bf16 v[236:239], a[72:75], a[92:95], v[236:239]
    v_mfma_f32_16x16x32_bf16 v[240:243], a[76:79], a[92:95], v[240:243]
    v_mfma_f32_16x16x32_bf16 v[208:211], a[76:79], a[88:91], v[208:211]
    v_mfma_f32_16x16x32_bf16 v[176:179], a[76:79], a[84:87], v[176:179]
    v_mfma_f32_16x16x32_bf16 v[144:147], a[76:79], a[80:83], v[144:147]
    s_waitcnt lgkmcnt(0)
    v_mfma_f32_16x16x32_bf16 v[100:103], a[0:3], v[32:35], v[100:103]
    ds_read_b64_tr_b16 a[48:49], v50 offset:40960
    v_mfma_f32_16x16x32_bf16 v[104:107], a[4:7], v[32:35], v[104:107]
    ds_read_b64_tr_b16 a[50:51], v50 offset:41984
    v_mfma_f32_16x16x32_bf16 v[116:119], a[0:3], a[32:35], v[116:119]
    buffer_load_dwordx4 v15, s[8:11], s28 offen offset:2048 lds
    v_mfma_f32_16x16x32_bf16 v[148:151], a[0:3], a[36:39], v[148:151]
    ds_read_b128 a[80:83], v49 offset:16384
    v_mfma_f32_16x16x32_bf16 v[180:183], a[0:3], a[40:43], v[180:183]
    ds_read_b128 a[84:87], v49 offset:18432
    v_mfma_f32_16x16x32_bf16 v[212:215], a[0:3], a[44:47], v[212:215]
    ds_read_b128 a[88:91], v49 offset:20480
    v_mfma_f32_16x16x32_bf16 v[216:219], a[4:7], a[44:47], v[216:219]
    ds_read_b128 a[92:95], v49 offset:22528
    v_mfma_f32_16x16x32_bf16 v[184:187], a[4:7], a[40:43], v[184:187]
    ds_read_b64_tr_b16 a[52:53], v51 offset:40960
    v_mfma_f32_16x16x32_bf16 v[152:155], a[4:7], a[36:39], v[152:155]
    ds_read_b64_tr_b16 a[54:55], v51 offset:41984
    v_mfma_f32_16x16x32_bf16 v[120:123], a[4:7], a[32:35], v[120:123]
    ds_read_b64_tr_b16 a[56:57], v52 offset:40960
    v_mfma_f32_16x16x32_bf16 v[124:127], a[8:11], a[32:35], v[124:127]
    ds_read_b64_tr_b16 a[58:59], v52 offset:41984
    v_mfma_f32_16x16x32_bf16 v[156:159], a[8:11], a[36:39], v[156:159]
    ds_read_b64_tr_b16 a[60:61], v53 offset:40960
    v_mfma_f32_16x16x32_bf16 v[188:191], a[8:11], a[40:43], v[188:191]
    ds_read_b64_tr_b16 a[62:63], v53 offset:41984
    v_mfma_f32_16x16x32_bf16 v[220:223], a[8:11], a[44:47], v[220:223]
    ds_read_b64_tr_b16 a[64:65], v54 offset:40960
    v_mfma_f32_16x16x32_bf16 v[224:227], a[12:15], a[44:47], v[224:227]
    ds_read_b64_tr_b16 a[66:67], v54 offset:41984
    v_mfma_f32_16x16x32_bf16 v[192:195], a[12:15], a[40:43], v[192:195]
    ds_read_b64_tr_b16 a[68:69], v55 offset:40960
    v_mfma_f32_16x16x32_bf16 v[160:163], a[12:15], a[36:39], v[160:163]
    ds_read_b64_tr_b16 a[70:71], v55 offset:41984
    v_mfma_f32_16x16x32_bf16 v[128:131], a[12:15], a[32:35], v[128:131]
    buffer_load_dwordx4 v16, s[8:11], s28 offen offset:3072 lds
    v_mfma_f32_16x16x32_bf16 v[132:135], a[16:19], a[32:35], v[132:135]
    ds_read_b64_tr_b16 a[72:73], v56 offset:40960
    v_mfma_f32_16x16x32_bf16 v[164:167], a[16:19], a[36:39], v[164:167]
    ds_read_b64_tr_b16 a[74:75], v56 offset:41984
    v_mfma_f32_16x16x32_bf16 v[196:199], a[16:19], a[40:43], v[196:199]
    ds_read_b64_tr_b16 a[76:77], v57 offset:40960
    v_mfma_f32_16x16x32_bf16 v[228:231], a[16:19], a[44:47], v[228:231]
    ds_read_b64_tr_b16 a[78:79], v57 offset:41984
    v_mfma_f32_16x16x32_bf16 v[232:235], a[20:23], a[44:47], v[232:235]
    v_mfma_f32_16x16x32_bf16 v[200:203], a[20:23], a[40:43], v[200:203]
    v_mfma_f32_16x16x32_bf16 v[168:171], a[20:23], a[36:39], v[168:171]
    v_mfma_f32_16x16x32_bf16 v[136:139], a[20:23], a[32:35], v[136:139]
    v_mfma_f32_16x16x32_bf16 v[140:143], a[24:27], a[32:35], v[140:143]
    v_mfma_f32_16x16x32_bf16 v[172:175], a[24:27], a[36:39], v[172:175]
    v_mfma_f32_16x16x32_bf16 v[204:207], a[24:27], a[40:43], v[204:207]
    v_mfma_f32_16x16x32_bf16 v[236:239], a[24:27], a[44:47], v[236:239]
    v_mfma_f32_16x16x32_bf16 v[240:243], a[28:31], a[44:47], v[240:243]
    v_mfma_f32_16x16x32_bf16 v[208:211], a[28:31], a[40:43], v[208:211]
    v_mfma_f32_16x16x32_bf16 v[176:179], a[28:31], a[36:39], v[176:179]
    v_mfma_f32_16x16x32_bf16 v[144:147], a[28:31], a[32:35], v[144:147]
    s_add_u32 s28, s28, 16384
    s_waitcnt vmcnt(8) lgkmcnt(0)
    s_barrier
    v_mfma_f32_16x16x32_bf16 v[100:103], a[48:51], v[32:35], v[100:103]
    ds_read_b64_tr_b16 a[0:1], v50 offset:0
    v_mfma_f32_16x16x32_bf16 v[104:107], a[52:55], v[32:35], v[104:107]
    s_add_u32 m0, s34, 32768
    ds_read_b64_tr_b16 a[2:3], v50 offset:1024
    v_mfma_f32_16x16x32_bf16 v[116:119], a[48:51], a[80:83], v[116:119]
    buffer_load_dwordx4 v13, s[8:11], s28 offen offset:0 lds
    v_mfma_f32_16x16x32_bf16 v[148:151], a[48:51], a[84:87], v[148:151]
    ds_read_b128 a[32:35], v48 offset:0
    v_mfma_f32_16x16x32_bf16 v[180:183], a[48:51], a[88:91], v[180:183]
    ds_read_b128 a[36:39], v48 offset:2048
    v_mfma_f32_16x16x32_bf16 v[212:215], a[48:51], a[92:95], v[212:215]
    ds_read_b128 a[40:43], v48 offset:4096
    v_mfma_f32_16x16x32_bf16 v[216:219], a[52:55], a[92:95], v[216:219]
    ds_read_b128 a[44:47], v48 offset:6144
    v_mfma_f32_16x16x32_bf16 v[184:187], a[52:55], a[88:91], v[184:187]
    ds_read_b64_tr_b16 a[4:5], v51 offset:0
    v_mfma_f32_16x16x32_bf16 v[152:155], a[52:55], a[84:87], v[152:155]
    ds_read_b64_tr_b16 a[6:7], v51 offset:1024
    v_mfma_f32_16x16x32_bf16 v[120:123], a[52:55], a[80:83], v[120:123]
    buffer_load_dwordx4 v14, s[8:11], s28 offen offset:1024 lds
    v_mfma_f32_16x16x32_bf16 v[124:127], a[56:59], a[80:83], v[124:127]
    ds_read_b64_tr_b16 a[8:9], v52 offset:0
    v_mfma_f32_16x16x32_bf16 v[156:159], a[56:59], a[84:87], v[156:159]
    ds_read_b64_tr_b16 a[10:11], v52 offset:1024
    v_mfma_f32_16x16x32_bf16 v[188:191], a[56:59], a[88:91], v[188:191]
    ds_read_b64_tr_b16 a[12:13], v53 offset:0
    v_mfma_f32_16x16x32_bf16 v[220:223], a[56:59], a[92:95], v[220:223]
    ds_read_b64_tr_b16 a[14:15], v53 offset:1024
    v_mfma_f32_16x16x32_bf16 v[224:227], a[60:63], a[92:95], v[224:227]
    ds_read_b64_tr_b16 a[16:17], v54 offset:0
    v_mfma_f32_16x16x32_bf16 v[192:195], a[60:63], a[88:91], v[192:195]
    ds_read_b64_tr_b16 a[18:19], v54 offset:1024
    v_mfma_f32_16x16x32_bf16 v[160:163], a[60:63], a[84:87], v[160:163]
    ds_read_b64_tr_b16 a[20:21], v55 offset:0
    v_mfma_f32_16x16x32_bf16 v[128:131], a[60:63], a[80:83], v[128:131]
    buffer_load_dwordx4 v15, s[8:11], s28 offen offset:2048 lds
    v_mfma_f32_16x16x32_bf16 v[132:135], a[64:67], a[80:83], v[132:135]
    ds_read_b64_tr_b16 a[22:23], v55 offset:1024
    v_mfma_f32_16x16x32_bf16 v[164:167], a[64:67], a[84:87], v[164:167]
    ds_read_b64_tr_b16 a[24:25], v56 offset:0
    v_mfma_f32_16x16x32_bf16 v[196:199], a[64:67], a[88:91], v[196:199]
    ds_read_b64_tr_b16 a[26:27], v56 offset:1024
    v_mfma_f32_16x16x32_bf16 v[228:231], a[64:67], a[92:95], v[228:231]
    ds_read_b64_tr_b16 a[28:29], v57 offset:0
    v_mfma_f32_16x16x32_bf16 v[232:235], a[68:71], a[92:95], v[232:235]
    ds_read_b64_tr_b16 a[30:31], v57 offset:1024
    v_mfma_f32_16x16x32_bf16 v[200:203], a[68:71], a[88:91], v[200:203]
    v_mfma_f32_16x16x32_bf16 v[168:171], a[68:71], a[84:87], v[168:171]
    buffer_load_dwordx4 v16, s[8:11], s28 offen offset:3072 lds
    v_mfma_f32_16x16x32_bf16 v[136:139], a[68:71], a[80:83], v[136:139]
    v_mfma_f32_16x16x32_bf16 v[140:143], a[72:75], a[80:83], v[140:143]
    v_mfma_f32_16x16x32_bf16 v[172:175], a[72:75], a[84:87], v[172:175]
    v_mfma_f32_16x16x32_bf16 v[204:207], a[72:75], a[88:91], v[204:207]
    v_mfma_f32_16x16x32_bf16 v[236:239], a[72:75], a[92:95], v[236:239]
    v_mfma_f32_16x16x32_bf16 v[240:243], a[76:79], a[92:95], v[240:243]
    v_mfma_f32_16x16x32_bf16 v[208:211], a[76:79], a[88:91], v[208:211]
    v_mfma_f32_16x16x32_bf16 v[176:179], a[76:79], a[84:87], v[176:179]
    v_mfma_f32_16x16x32_bf16 v[144:147], a[76:79], a[80:83], v[144:147]
    s_waitcnt lgkmcnt(0)
    v_mfma_f32_16x16x32_bf16 v[100:103], a[0:3], v[32:35], v[100:103]
    ds_read_b64_tr_b16 a[48:49], v50 offset:8192
    v_mfma_f32_16x16x32_bf16 v[104:107], a[4:7], v[32:35], v[104:107]
    s_add_u32 s28, s28, 16384
    s_mov_b32 m0, s30
    ds_read_b64_tr_b16 a[50:51], v50 offset:9216
    v_mfma_f32_16x16x32_bf16 v[116:119], a[0:3], a[32:35], v[116:119]
    buffer_load_dwordx4 v17, s[12:15], s29 offen offset:0 lds
    v_mfma_f32_16x16x32_bf16 v[148:151], a[0:3], a[36:39], v[148:151]
    ds_read_b64_tr_b16 a[52:53], v51 offset:8192
    v_mfma_f32_16x16x32_bf16 v[180:183], a[0:3], a[40:43], v[180:183]
    ds_read_b64_tr_b16 a[54:55], v51 offset:9216
    v_mfma_f32_16x16x32_bf16 v[212:215], a[0:3], a[44:47], v[212:215]
    ds_read_b128 a[80:83], v49 offset:0
    v_mfma_f32_16x16x32_bf16 v[216:219], a[4:7], a[44:47], v[216:219]
    ds_read_b128 a[84:87], v49 offset:2048
    v_mfma_f32_16x16x32_bf16 v[184:187], a[4:7], a[40:43], v[184:187]
    ds_read_b128 a[88:91], v49 offset:4096
    v_mfma_f32_16x16x32_bf16 v[152:155], a[4:7], a[36:39], v[152:155]
    ds_read_b128 a[92:95], v49 offset:6144
    v_mfma_f32_16x16x32_bf16 v[120:123], a[4:7], a[32:35], v[120:123]
    buffer_load_dwordx4 v18, s[12:15], s29 offen offset:1024 lds
    v_mfma_f32_16x16x32_bf16 v[124:127], a[8:11], a[32:35], v[124:127]
    ds_read_b64_tr_b16 a[56:57], v52 offset:8192
    v_mfma_f32_16x16x32_bf16 v[156:159], a[8:11], a[36:39], v[156:159]
    ds_read_b64_tr_b16 a[58:59], v52 offset:9216
    v_mfma_f32_16x16x32_bf16 v[188:191], a[8:11], a[40:43], v[188:191]
    ds_read_b64_tr_b16 a[60:61], v53 offset:8192
    v_mfma_f32_16x16x32_bf16 v[220:223], a[8:11], a[44:47], v[220:223]
    ds_read_b64_tr_b16 a[62:63], v53 offset:9216
    v_mfma_f32_16x16x32_bf16 v[224:227], a[12:15], a[44:47], v[224:227]
    ds_read_b64_tr_b16 a[64:65], v54 offset:8192
    v_mfma_f32_16x16x32_bf16 v[192:195], a[12:15], a[40:43], v[192:195]
    s_waitcnt lgkmcnt(9)
    ds_read_b64_tr_b16 a[66:67], v54 offset:9216
    v_mfma_f32_16x16x32_bf16 v[100:103], a[48:51], v[32:35], v[100:103]
    ds_read_b64_tr_b16 a[68:69], v55 offset:8192
    v_mfma_f32_16x16x32_bf16 v[104:107], a[52:55], v[32:35], v[104:107]
    buffer_load_dwordx4 v17, s[12:15], s29 offen offset:2048 lds
    v_mfma_f32_16x16x32_bf16 v[160:163], a[12:15], a[36:39], v[160:163]
    ds_read_b64_tr_b16 a[70:71], v55 offset:9216
    v_mfma_f32_16x16x32_bf16 v[128:131], a[12:15], a[32:35], v[128:131]
    ds_read_b64_tr_b16 a[72:73], v56 offset:8192
    v_mfma_f32_16x16x32_bf16 v[132:135], a[16:19], a[32:35], v[132:135]
    ds_read_b64_tr_b16 a[74:75], v56 offset:9216
    v_mfma_f32_16x16x32_bf16 v[164:167], a[16:19], a[36:39], v[164:167]
    ds_read_b64_tr_b16 a[76:77], v57 offset:8192
    v_mfma_f32_16x16x32_bf16 v[196:199], a[16:19], a[40:43], v[196:199]
    ds_read_b64_tr_b16 a[78:79], v57 offset:9216
    v_mfma_f32_16x16x32_bf16 v[228:231], a[16:19], a[44:47], v[228:231]
    ds_write_b128 v58, v[100:103] offset:0
    v_mfma_f32_16x16x32_bf16 v[232:235], a[20:23], a[44:47], v[232:235]
    buffer_load_dwordx4 v18, s[12:15], s29 offen offset:3072 lds
    v_mfma_f32_16x16x32_bf16 v[200:203], a[20:23], a[40:43], v[200:203]
    ds_write_b128 v58, v[104:107] offset:64
    v_mfma_f32_16x16x32_bf16 v[168:171], a[20:23], a[36:39], v[168:171]
    ds_write_b128 v58, v[100:103] offset:512
    v_mfma_f32_16x16x32_bf16 v[136:139], a[20:23], a[32:35], v[136:139]
    ds_write_b128 v58, v[104:107] offset:576
    v_mfma_f32_16x16x32_bf16 v[140:143], a[24:27], a[32:35], v[140:143]
    v_mfma_f32_16x16x32_bf16 v[172:175], a[24:27], a[36:39], v[172:175]
    v_mfma_f32_16x16x32_bf16 v[204:207], a[24:27], a[40:43], v[204:207]
    v_mfma_f32_16x16x32_bf16 v[236:239], a[24:27], a[44:47], v[236:239]
    v_mfma_f32_16x16x32_bf16 v[240:243], a[28:31], a[44:47], v[240:243]
    v_mfma_f32_16x16x32_bf16 v[208:211], a[28:31], a[40:43], v[208:211]
    v_mfma_f32_16x16x32_bf16 v[176:179], a[28:31], a[36:39], v[176:179]
    v_mfma_f32_16x16x32_bf16 v[144:147], a[28:31], a[32:35], v[144:147]
    s_add_u32 s29, s29, 16384
    s_waitcnt vmcnt(10) lgkmcnt(0)
    s_barrier
    v_mfma_f32_16x16x32_bf16 v[116:119], a[48:51], a[80:83], v[116:119]
    ds_read_b128 v[68:71], v58 offset:0
    v_mfma_f32_16x16x32_bf16 v[120:123], a[52:55], a[80:83], v[120:123]
    ds_read_b128 v[72:75], v58 offset:64
    v_mul_f32 v109, s44, v109
    v_mfma_f32_16x16x32_bf16 v[124:127], a[56:59], a[80:83], v[124:127]
    ds_read_b128 v[76:79], v58 offset:128
    v_mul_f32 v111, s44, v111
    v_mfma_f32_16x16x32_bf16 v[128:131], a[60:63], a[80:83], v[128:131]
    ds_read_b128 v[80:83], v58 offset:192
    v_mul_f32 v113, s44, v113
    v_mfma_f32_16x16x32_bf16 v[132:135], a[64:67], a[80:83], v[132:135]
    ds_read_b128 v[84:87], v58 offset:256
    v_mfma_f32_16x16x32_bf16 v[136:139], a[68:71], a[80:83], v[136:139]
    ds_read_b128 v[88:91], v58 offset:320
    v_mul_f32 v115, s44, v115
    v_mfma_f32_16x16x32_bf16 v[140:143], a[72:75], a[80:83], v[140:143]
    ds_read_b128 v[92:95], v58 offset:384
    v_and_b32 v253, 7, v19
    v_mfma_f32_16x16x32_bf16 v[144:147], a[76:79], a[80:83], v[144:147]
    ds_read_b128 v[96:99], v58 offset:448
    v_lshlrev_b32 v253, 5, v253
    v_mfma_f32_16x16x32_bf16 v[148:151], a[48:51], a[84:87], v[148:151]
    ds_read_b128 a[128:131], v1 offset:49152
    v_mfma_f32_16x16x32_bf16 v[152:155], a[52:55], a[84:87], v[152:155]
    ds_read_b128 a[132:135], v2 offset:49152
    v_mfma_f32_16x16x32_bf16 v[156:159], a[56:59], a[84:87], v[156:159]
    ds_read_b128 a[136:139], v3 offset:49152
    v_mfma_f32_16x16x32_bf16 v[160:163], a[60:63], a[84:87], v[160:163]
    ds_read_b128 a[140:143], v4 offset:49152
    v_mfma_f32_16x16x32_bf16 v[164:167], a[64:67], a[84:87], v[164:167]
    ds_read_b128 a[144:147], v1 offset:53248
    v_mfma_f32_16x16x32_bf16 v[168:171], a[68:71], a[84:87], v[168:171]
    ds_read_b128 a[148:151], v2 offset:53248
    v_mfma_f32_16x16x32_bf16 v[172:175], a[72:75], a[84:87], v[172:175]
    ds_read_b128 a[152:155], v3 offset:53248
    v_mfma_f32_16x16x32_bf16 v[176:179], a[76:79], a[84:87], v[176:179]
    ds_read_b128 a[156:159], v4 offset:53248
    buffer_load_dword v252, v253, s[92:95], 0 offen sc1
    s_waitcnt lgkmcnt(8)
    v_pk_fma_f32 v[116:117], v[108:109], v[68:69], v[116:117] op_sel_hi:[0,1,1] neg_lo:[1,0,0] neg_hi:[1,0,0]
    v_pk_fma_f32 v[118:119], v[108:109], v[70:71], v[118:119] op_sel_hi:[0,1,1] neg_lo:[1,0,0] neg_hi:[1,0,0]
    v_pk_fma_f32 v[120:121], v[108:109], v[72:73], v[120:121] op_sel_hi:[0,1,1] neg_lo:[1,0,0] neg_hi:[1,0,0]
    v_pk_fma_f32 v[122:123], v[108:109], v[74:75], v[122:123] op_sel_hi:[0,1,1] neg_lo:[1,0,0] neg_hi:[1,0,0]
    v_pk_fma_f32 v[124:125], v[108:109], v[76:77], v[124:125] op_sel_hi:[0,1,1] neg_lo:[1,0,0] neg_hi:[1,0,0]
    v_pk_fma_f32 v[126:127], v[108:109], v[78:79], v[126:127] op_sel_hi:[0,1,1] neg_lo:[1,0,0] neg_hi:[1,0,0]
    v_pk_fma_f32 v[128:129], v[108:109], v[80:81], v[128:129] op_sel_hi:[0,1,1] neg_lo:[1,0,0] neg_hi:[1,0,0]
    v_pk_fma_f32 v[130:131], v[108:109], v[82:83], v[130:131] op_sel_hi:[0,1,1] neg_lo:[1,0,0] neg_hi:[1,0,0]
    v_pk_fma_f32 v[132:133], v[108:109], v[84:85], v[132:133] op_sel_hi:[0,1,1] neg_lo:[1,0,0] neg_hi:[1,0,0]
    v_pk_fma_f32 v[134:135], v[108:109], v[86:87], v[134:135] op_sel_hi:[0,1,1] neg_lo:[1,0,0] neg_hi:[1,0,0]
    v_pk_fma_f32 v[136:137], v[108:109], v[88:89], v[136:137] op_sel_hi:[0,1,1] neg_lo:[1,0,0] neg_hi:[1,0,0]
    v_pk_fma_f32 v[138:139], v[108:109], v[90:91], v[138:139] op_sel_hi:[0,1,1] neg_lo:[1,0,0] neg_hi:[1,0,0]
    v_pk_fma_f32 v[140:141], v[108:109], v[92:93], v[140:141] op_sel_hi:[0,1,1] neg_lo:[1,0,0] neg_hi:[1,0,0]
    v_pk_fma_f32 v[142:143], v[108:109], v[94:95], v[142:143] op_sel_hi:[0,1,1] neg_lo:[1,0,0] neg_hi:[1,0,0]
    v_pk_fma_f32 v[144:145], v[108:109], v[96:97], v[144:145] op_sel_hi:[0,1,1] neg_lo:[1,0,0] neg_hi:[1,0,0]
    v_pk_fma_f32 v[146:147], v[108:109], v[98:99], v[146:147] op_sel_hi:[0,1,1] neg_lo:[1,0,0] neg_hi:[1,0,0]
    v_pk_mul_f32 v[116:117], v[116:117], v[108:109] op_sel:[0,1] op_sel_hi:[1,1]
    v_pk_mul_f32 v[118:119], v[118:119], v[108:109] op_sel:[0,1] op_sel_hi:[1,1]
    v_pk_mul_f32 v[120:121], v[120:121], v[108:109] op_sel:[0,1] op_sel_hi:[1,1]
    v_pk_mul_f32 v[122:123], v[122:123], v[108:109] op_sel:[0,1] op_sel_hi:[1,1]
    v_pk_mul_f32 v[124:125], v[124:125], v[108:109] op_sel:[0,1] op_sel_hi:[1,1]
    v_pk_mul_f32 v[126:127], v[126:127], v[108:109] op_sel:[0,1] op_sel_hi:[1,1]
    v_pk_mul_f32 v[128:129], v[128:129], v[108:109] op_sel:[0,1] op_sel_hi:[1,1]
    v_pk_mul_f32 v[130:131], v[130:131], v[108:109] op_sel:[0,1] op_sel_hi:[1,1]
    v_pk_mul_f32 v[132:133], v[132:133], v[108:109] op_sel:[0,1] op_sel_hi:[1,1]
    v_pk_mul_f32 v[134:135], v[134:135], v[108:109] op_sel:[0,1] op_sel_hi:[1,1]
    v_pk_mul_f32 v[136:137], v[136:137], v[108:109] op_sel:[0,1] op_sel_hi:[1,1]
    v_pk_mul_f32 v[138:139], v[138:139], v[108:109] op_sel:[0,1] op_sel_hi:[1,1]
    v_pk_mul_f32 v[140:141], v[140:141], v[108:109] op_sel:[0,1] op_sel_hi:[1,1]
    v_pk_mul_f32 v[142:143], v[142:143], v[108:109] op_sel:[0,1] op_sel_hi:[1,1]
    v_pk_mul_f32 v[144:145], v[144:145], v[108:109] op_sel:[0,1] op_sel_hi:[1,1]
    v_pk_mul_f32 v[146:147], v[146:147], v[108:109] op_sel:[0,1] op_sel_hi:[1,1]
    v_mfma_f32_16x16x32_bf16 v[180:183], a[48:51], a[88:91], v[180:183]
    ds_read_b128 a[160:163], v1 offset:57344
    v_cvt_pk_bf16_f32 v36, v116, v117
    v_cvt_pk_bf16_f32 v37, v118, v119
    v_cvt_pk_bf16_f32 v38, v120, v121
    v_cvt_pk_bf16_f32 v39, v122, v123
    v_mfma_f32_16x16x32_bf16 v[184:187], a[52:55], a[88:91], v[184:187]
    ds_read_b128 a[164:167], v2 offset:57344
    v_cvt_pk_bf16_f32 v40, v124, v125
    v_cvt_pk_bf16_f32 v41, v126, v127
    v_cvt_pk_bf16_f32 v42, v128, v129
    v_cvt_pk_bf16_f32 v43, v130, v131
    v_mfma_f32_16x16x32_bf16 v[188:191], a[56:59], a[88:91], v[188:191]
    ds_read_b128 a[168:171], v3 offset:57344
    v_cvt_pk_bf16_f32 v44, v132, v133
    v_cvt_pk_bf16_f32 v45, v134, v135
    v_cvt_pk_bf16_f32 v46, v136, v137
    v_cvt_pk_bf16_f32 v47, v138, v139
    v_mfma_f32_16x16x32_bf16 v[192:195], a[60:63], a[88:91], v[192:195]
    ds_read_b128 a[172:175], v4 offset:57344
    v_cvt_pk_bf16_f32 v48, v140, v141
    v_cvt_pk_bf16_f32 v49, v142, v143
    v_cvt_pk_bf16_f32 v50, v144, v145
    v_cvt_pk_bf16_f32 v51, v146, v147
    v_mfma_f32_16x16x32_bf16 v[196:199], a[64:67], a[88:91], v[196:199]
    ds_read_b128 a[176:179], v1 offset:61440
    v_permlane32_swap_b32 v36, v38
    v_permlane32_swap_b32 v37, v39
    v_permlane32_swap_b32 v40, v42
    v_permlane32_swap_b32 v41, v43
    v_mfma_f32_16x16x32_bf16 v[200:203], a[68:71], a[88:91], v[200:203]
    ds_read_b128 a[180:183], v2 offset:61440
    v_permlane32_swap_b32 v44, v46
    v_permlane32_swap_b32 v45, v47
    v_permlane32_swap_b32 v48, v50
    v_permlane32_swap_b32 v49, v51
    v_mfma_f32_16x16x32_bf16 v[204:207], a[72:75], a[88:91], v[204:207]
    ds_read_b128 a[184:187], v3 offset:61440
    v_permlane16_swap_b32 v36, v38
    v_permlane16_swap_b32 v37, v39
    v_permlane16_swap_b32 v40, v42
    v_permlane16_swap_b32 v41, v43
    v_mfma_f32_16x16x32_bf16 v[208:211], a[76:79], a[88:91], v[208:211]
    ds_read_b128 a[188:191], v4 offset:61440
    v_permlane16_swap_b32 v44, v46
    v_permlane16_swap_b32 v45, v47
    v_permlane16_swap_b32 v48, v50
    v_permlane16_swap_b32 v49, v51
    v_pk_fma_f32 v[148:149], v[110:111], v[68:69], v[148:149] op_sel_hi:[0,1,1] neg_lo:[1,0,0] neg_hi:[1,0,0]
    v_pk_fma_f32 v[150:151], v[110:111], v[70:71], v[150:151] op_sel_hi:[0,1,1] neg_lo:[1,0,0] neg_hi:[1,0,0]
    v_pk_fma_f32 v[152:153], v[110:111], v[72:73], v[152:153] op_sel_hi:[0,1,1] neg_lo:[1,0,0] neg_hi:[1,0,0]
    v_pk_fma_f32 v[154:155], v[110:111], v[74:75], v[154:155] op_sel_hi:[0,1,1] neg_lo:[1,0,0] neg_hi:[1,0,0]
    v_pk_fma_f32 v[156:157], v[110:111], v[76:77], v[156:157] op_sel_hi:[0,1,1] neg_lo:[1,0,0] neg_hi:[1,0,0]
    v_pk_fma_f32 v[158:159], v[110:111], v[78:79], v[158:159] op_sel_hi:[0,1,1] neg_lo:[1,0,0] neg_hi:[1,0,0]
    v_pk_fma_f32 v[160:161], v[110:111], v[80:81], v[160:161] op_sel_hi:[0,1,1] neg_lo:[1,0,0] neg_hi:[1,0,0]
    v_pk_fma_f32 v[162:163], v[110:111], v[82:83], v[162:163] op_sel_hi:[0,1,1] neg_lo:[1,0,0] neg_hi:[1,0,0]
    v_pk_fma_f32 v[164:165], v[110:111], v[84:85], v[164:165] op_sel_hi:[0,1,1] neg_lo:[1,0,0] neg_hi:[1,0,0]
    v_pk_fma_f32 v[166:167], v[110:111], v[86:87], v[166:167] op_sel_hi:[0,1,1] neg_lo:[1,0,0] neg_hi:[1,0,0]
    v_pk_fma_f32 v[168:169], v[110:111], v[88:89], v[168:169] op_sel_hi:[0,1,1] neg_lo:[1,0,0] neg_hi:[1,0,0]
    v_pk_fma_f32 v[170:171], v[110:111], v[90:91], v[170:171] op_sel_hi:[0,1,1] neg_lo:[1,0,0] neg_hi:[1,0,0]
    v_pk_fma_f32 v[172:173], v[110:111], v[92:93], v[172:173] op_sel_hi:[0,1,1] neg_lo:[1,0,0] neg_hi:[1,0,0]
    v_pk_fma_f32 v[174:175], v[110:111], v[94:95], v[174:175] op_sel_hi:[0,1,1] neg_lo:[1,0,0] neg_hi:[1,0,0]
    v_pk_fma_f32 v[176:177], v[110:111], v[96:97], v[176:177] op_sel_hi:[0,1,1] neg_lo:[1,0,0] neg_hi:[1,0,0]
    v_pk_fma_f32 v[178:179], v[110:111], v[98:99], v[178:179] op_sel_hi:[0,1,1] neg_lo:[1,0,0] neg_hi:[1,0,0]
    v_pk_mul_f32 v[148:149], v[148:149], v[110:111] op_sel:[0,1] op_sel_hi:[1,1]
    v_pk_mul_f32 v[150:151], v[150:151], v[110:111] op_sel:[0,1] op_sel_hi:[1,1]
    v_pk_mul_f32 v[152:153], v[152:153], v[110:111] op_sel:[0,1] op_sel_hi:[1,1]
    v_pk_mul_f32 v[154:155], v[154:155], v[110:111] op_sel:[0,1] op_sel_hi:[1,1]
    v_pk_mul_f32 v[156:157], v[156:157], v[110:111] op_sel:[0,1] op_sel_hi:[1,1]
    v_pk_mul_f32 v[158:159], v[158:159], v[110:111] op_sel:[0,1] op_sel_hi:[1,1]
    v_pk_mul_f32 v[160:161], v[160:161], v[110:111] op_sel:[0,1] op_sel_hi:[1,1]
    v_pk_mul_f32 v[162:163], v[162:163], v[110:111] op_sel:[0,1] op_sel_hi:[1,1]
    v_pk_mul_f32 v[164:165], v[164:165], v[110:111] op_sel:[0,1] op_sel_hi:[1,1]
    v_pk_mul_f32 v[166:167], v[166:167], v[110:111] op_sel:[0,1] op_sel_hi:[1,1]
    v_pk_mul_f32 v[168:169], v[168:169], v[110:111] op_sel:[0,1] op_sel_hi:[1,1]
    v_pk_mul_f32 v[170:171], v[170:171], v[110:111] op_sel:[0,1] op_sel_hi:[1,1]
    v_pk_mul_f32 v[172:173], v[172:173], v[110:111] op_sel:[0,1] op_sel_hi:[1,1]
    v_pk_mul_f32 v[174:175], v[174:175], v[110:111] op_sel:[0,1] op_sel_hi:[1,1]
    v_pk_mul_f32 v[176:177], v[176:177], v[110:111] op_sel:[0,1] op_sel_hi:[1,1]
    v_pk_mul_f32 v[178:179], v[178:179], v[110:111] op_sel:[0,1] op_sel_hi:[1,1]
    v_mfma_f32_16x16x32_bf16 v[212:215], a[48:51], a[92:95], v[212:215]
    s_add_u32 m0, s47, 0
    s_nop 0
    buffer_load_dwordx4 v20, s[96:99], 0 offen lds
    v_cvt_pk_bf16_f32 v52, v148, v149
    v_cvt_pk_bf16_f32 v53, v150, v151
    v_cvt_pk_bf16_f32 v54, v152, v153
    v_cvt_pk_bf16_f32 v55, v154, v155
    v_mfma_f32_16x16x32_bf16 v[216:219], a[52:55], a[92:95], v[216:219]
    s_add_u32 m0, s47, 1024
    s_nop 0
    buffer_load_dwordx4 v21, s[96:99], 0 offen lds
    v_cvt_pk_bf16_f32 v56, v156, v157
    v_cvt_pk_bf16_f32 v57, v158, v159
    v_cvt_pk_bf16_f32 v58, v160, v161
    v_cvt_pk_bf16_f32 v59, v162, v163
    v_mfma_f32_16x16x32_bf16 v[220:223], a[56:59], a[92:95], v[220:223]
    s_add_u32 m0, s47, 2048
    s_nop 0
    buffer_load_dwordx4 v22, s[96:99], 0 offen lds
    v_cvt_pk_bf16_f32 v60, v164, v165
    v_cvt_pk_bf16_f32 v61, v166, v167
    v_cvt_pk_bf16_f32 v62, v168, v169
    v_cvt_pk_bf16_f32 v63, v170, v171
    v_mfma_f32_16x16x32_bf16 v[224:227], a[60:63], a[92:95], v[224:227]
    s_add_u32 m0, s47, 3072
    s_nop 0
    buffer_load_dwordx4 v23, s[96:99], 0 offen lds
    v_cvt_pk_bf16_f32 v64, v172, v173
    v_cvt_pk_bf16_f32 v65, v174, v175
    v_cvt_pk_bf16_f32 v66, v176, v177
    v_cvt_pk_bf16_f32 v67, v178, v179
    v_mfma_f32_16x16x32_bf16 v[228:231], a[64:67], a[92:95], v[228:231]
    s_add_u32 m0, s47, 4096
    s_nop 0
    buffer_load_dwordx4 v24, s[96:99], 0 offen lds
    v_permlane32_swap_b32 v52, v54
    v_permlane32_swap_b32 v53, v55
    v_permlane32_swap_b32 v56, v58
    v_permlane32_swap_b32 v57, v59
    v_mfma_f32_16x16x32_bf16 v[232:235], a[68:71], a[92:95], v[232:235]
    v_permlane32_swap_b32 v60, v62
    v_permlane32_swap_b32 v61, v63
    v_permlane32_swap_b32 v64, v66
    v_permlane32_swap_b32 v65, v67
    v_mfma_f32_16x16x32_bf16 v[236:239], a[72:75], a[92:95], v[236:239]
    v_permlane16_swap_b32 v52, v54
    v_permlane16_swap_b32 v53, v55
    v_permlane16_swap_b32 v56, v58
    v_permlane16_swap_b32 v57, v59
    v_mfma_f32_16x16x32_bf16 v[240:243], a[76:79], a[92:95], v[240:243]
    v_permlane16_swap_b32 v60, v62
    v_permlane16_swap_b32 v61, v63
    v_permlane16_swap_b32 v64, v66
    v_permlane16_swap_b32 v65, v67
    v_pk_fma_f32 v[180:181], v[112:113], v[68:69], v[180:181] op_sel_hi:[0,1,1] neg_lo:[1,0,0] neg_hi:[1,0,0]
    v_pk_fma_f32 v[182:183], v[112:113], v[70:71], v[182:183] op_sel_hi:[0,1,1] neg_lo:[1,0,0] neg_hi:[1,0,0]
    v_pk_fma_f32 v[184:185], v[112:113], v[72:73], v[184:185] op_sel_hi:[0,1,1] neg_lo:[1,0,0] neg_hi:[1,0,0]
    v_pk_fma_f32 v[186:187], v[112:113], v[74:75], v[186:187] op_sel_hi:[0,1,1] neg_lo:[1,0,0] neg_hi:[1,0,0]
    v_pk_fma_f32 v[188:189], v[112:113], v[76:77], v[188:189] op_sel_hi:[0,1,1] neg_lo:[1,0,0] neg_hi:[1,0,0]
    v_pk_fma_f32 v[190:191], v[112:113], v[78:79], v[190:191] op_sel_hi:[0,1,1] neg_lo:[1,0,0] neg_hi:[1,0,0]
    v_pk_fma_f32 v[192:193], v[112:113], v[80:81], v[192:193] op_sel_hi:[0,1,1] neg_lo:[1,0,0] neg_hi:[1,0,0]
    v_pk_fma_f32 v[194:195], v[112:113], v[82:83], v[194:195] op_sel_hi:[0,1,1] neg_lo:[1,0,0] neg_hi:[1,0,0]
    v_pk_fma_f32 v[196:197], v[112:113], v[84:85], v[196:197] op_sel_hi:[0,1,1] neg_lo:[1,0,0] neg_hi:[1,0,0]
    v_pk_fma_f32 v[198:199], v[112:113], v[86:87], v[198:199] op_sel_hi:[0,1,1] neg_lo:[1,0,0] neg_hi:[1,0,0]
    v_pk_fma_f32 v[200:201], v[112:113], v[88:89], v[200:201] op_sel_hi:[0,1,1] neg_lo:[1,0,0] neg_hi:[1,0,0]
    v_pk_fma_f32 v[202:203], v[112:113], v[90:91], v[202:203] op_sel_hi:[0,1,1] neg_lo:[1,0,0] neg_hi:[1,0,0]
    v_pk_fma_f32 v[204:205], v[112:113], v[92:93], v[204:205] op_sel_hi:[0,1,1] neg_lo:[1,0,0] neg_hi:[1,0,0]
    v_pk_fma_f32 v[206:207], v[112:113], v[94:95], v[206:207] op_sel_hi:[0,1,1] neg_lo:[1,0,0] neg_hi:[1,0,0]
    v_pk_fma_f32 v[208:209], v[112:113], v[96:97], v[208:209] op_sel_hi:[0,1,1] neg_lo:[1,0,0] neg_hi:[1,0,0]
    v_pk_fma_f32 v[210:211], v[112:113], v[98:99], v[210:211] op_sel_hi:[0,1,1] neg_lo:[1,0,0] neg_hi:[1,0,0]
    v_pk_mul_f32 v[180:181], v[180:181], v[112:113] op_sel:[0,1] op_sel_hi:[1,1]
    v_pk_mul_f32 v[182:183], v[182:183], v[112:113] op_sel:[0,1] op_sel_hi:[1,1]
    v_pk_mul_f32 v[184:185], v[184:185], v[112:113] op_sel:[0,1] op_sel_hi:[1,1]
    v_pk_mul_f32 v[186:187], v[186:187], v[112:113] op_sel:[0,1] op_sel_hi:[1,1]
    v_pk_mul_f32 v[188:189], v[188:189], v[112:113] op_sel:[0,1] op_sel_hi:[1,1]
    v_pk_mul_f32 v[190:191], v[190:191], v[112:113] op_sel:[0,1] op_sel_hi:[1,1]
    v_pk_mul_f32 v[192:193], v[192:193], v[112:113] op_sel:[0,1] op_sel_hi:[1,1]
    v_pk_mul_f32 v[194:195], v[194:195], v[112:113] op_sel:[0,1] op_sel_hi:[1,1]
    v_pk_mul_f32 v[196:197], v[196:197], v[112:113] op_sel:[0,1] op_sel_hi:[1,1]
    v_pk_mul_f32 v[198:199], v[198:199], v[112:113] op_sel:[0,1] op_sel_hi:[1,1]
    v_pk_mul_f32 v[200:201], v[200:201], v[112:113] op_sel:[0,1] op_sel_hi:[1,1]
    v_pk_mul_f32 v[202:203], v[202:203], v[112:113] op_sel:[0,1] op_sel_hi:[1,1]
    v_pk_mul_f32 v[204:205], v[204:205], v[112:113] op_sel:[0,1] op_sel_hi:[1,1]
    v_pk_mul_f32 v[206:207], v[206:207], v[112:113] op_sel:[0,1] op_sel_hi:[1,1]
    v_pk_mul_f32 v[208:209], v[208:209], v[112:113] op_sel:[0,1] op_sel_hi:[1,1]
    v_pk_mul_f32 v[210:211], v[210:211], v[112:113] op_sel:[0,1] op_sel_hi:[1,1]
    v_pk_fma_f32 v[212:213], v[114:115], v[68:69], v[212:213] op_sel_hi:[0,1,1] neg_lo:[1,0,0] neg_hi:[1,0,0]
    v_pk_fma_f32 v[214:215], v[114:115], v[70:71], v[214:215] op_sel_hi:[0,1,1] neg_lo:[1,0,0] neg_hi:[1,0,0]
    v_pk_fma_f32 v[216:217], v[114:115], v[72:73], v[216:217] op_sel_hi:[0,1,1] neg_lo:[1,0,0] neg_hi:[1,0,0]
    v_pk_fma_f32 v[218:219], v[114:115], v[74:75], v[218:219] op_sel_hi:[0,1,1] neg_lo:[1,0,0] neg_hi:[1,0,0]
    v_pk_fma_f32 v[220:221], v[114:115], v[76:77], v[220:221] op_sel_hi:[0,1,1] neg_lo:[1,0,0] neg_hi:[1,0,0]
    v_pk_fma_f32 v[222:223], v[114:115], v[78:79], v[222:223] op_sel_hi:[0,1,1] neg_lo:[1,0,0] neg_hi:[1,0,0]
    v_pk_fma_f32 v[224:225], v[114:115], v[80:81], v[224:225] op_sel_hi:[0,1,1] neg_lo:[1,0,0] neg_hi:[1,0,0]
    v_pk_fma_f32 v[226:227], v[114:115], v[82:83], v[226:227] op_sel_hi:[0,1,1] neg_lo:[1,0,0] neg_hi:[1,0,0]
    v_pk_fma_f32 v[228:229], v[114:115], v[84:85], v[228:229] op_sel_hi:[0,1,1] neg_lo:[1,0,0] neg_hi:[1,0,0]
    v_pk_fma_f32 v[230:231], v[114:115], v[86:87], v[230:231] op_sel_hi:[0,1,1] neg_lo:[1,0,0] neg_hi:[1,0,0]
    v_pk_fma_f32 v[232:233], v[114:115], v[88:89], v[232:233] op_sel_hi:[0,1,1] neg_lo:[1,0,0] neg_hi:[1,0,0]
    v_pk_fma_f32 v[234:235], v[114:115], v[90:91], v[234:235] op_sel_hi:[0,1,1] neg_lo:[1,0,0] neg_hi:[1,0,0]
    v_pk_fma_f32 v[236:237], v[114:115], v[92:93], v[236:237] op_sel_hi:[0,1,1] neg_lo:[1,0,0] neg_hi:[1,0,0]
    v_pk_fma_f32 v[238:239], v[114:115], v[94:95], v[238:239] op_sel_hi:[0,1,1] neg_lo:[1,0,0] neg_hi:[1,0,0]
    v_pk_fma_f32 v[240:241], v[114:115], v[96:97], v[240:241] op_sel_hi:[0,1,1] neg_lo:[1,0,0] neg_hi:[1,0,0]
    v_pk_fma_f32 v[242:243], v[114:115], v[98:99], v[242:243] op_sel_hi:[0,1,1] neg_lo:[1,0,0] neg_hi:[1,0,0]
    s_waitcnt lgkmcnt(0)
    v_mfma_f32_16x16x32_bf16 v[116:119], a[128:131], v[36:39], 0
    v_cvt_pk_bf16_f32 v68, v180, v181
    v_cvt_pk_bf16_f32 v69, v182, v183
    v_cvt_pk_bf16_f32 v70, v184, v185
    v_cvt_pk_bf16_f32 v71, v186, v187
    v_mfma_f32_16x16x32_bf16 v[116:119], a[132:135], v[40:43], v[116:119]
    v_cvt_pk_bf16_f32 v72, v188, v189
    v_cvt_pk_bf16_f32 v73, v190, v191
    v_cvt_pk_bf16_f32 v74, v192, v193
    v_cvt_pk_bf16_f32 v75, v194, v195
    v_mfma_f32_16x16x32_bf16 v[116:119], a[136:139], v[44:47], v[116:119]
    v_cvt_pk_bf16_f32 v76, v196, v197
    v_cvt_pk_bf16_f32 v77, v198, v199
    v_cvt_pk_bf16_f32 v78, v200, v201
    v_cvt_pk_bf16_f32 v79, v202, v203
    v_mfma_f32_16x16x32_bf16 v[116:119], a[140:143], v[48:51], v[116:119]
    v_cvt_pk_bf16_f32 v80, v204, v205
    v_cvt_pk_bf16_f32 v81, v206, v207
    v_cvt_pk_bf16_f32 v82, v208, v209
    v_cvt_pk_bf16_f32 v83, v210, v211
    v_mfma_f32_16x16x32_bf16 v[132:135], a[144:147], v[36:39], 0
    v_permlane32_swap_b32 v68, v70
    v_permlane32_swap_b32 v69, v71
    v_permlane32_swap_b32 v72, v74
    v_permlane32_swap_b32 v73, v75
    v_mfma_f32_16x16x32_bf16 v[132:135], a[148:151], v[40:43], v[132:135]
    v_permlane32_swap_b32 v76, v78
    v_permlane32_swap_b32 v77, v79
    v_permlane32_swap_b32 v80, v82
    v_permlane32_swap_b32 v81, v83
    v_mfma_f32_16x16x32_bf16 v[132:135], a[152:155], v[44:47], v[132:135]
    v_permlane16_swap_b32 v68, v70
    v_permlane16_swap_b32 v69, v71
    v_permlane16_swap_b32 v72, v74
    v_permlane16_swap_b32 v73, v75
    v_mfma_f32_16x16x32_bf16 v[132:135], a[156:159], v[48:51], v[132:135]
    v_permlane16_swap_b32 v76, v78
    v_permlane16_swap_b32 v77, v79
    v_permlane16_swap_b32 v80, v82
    v_permlane16_swap_b32 v81, v83
    v_pk_mul_f32 v[212:213], v[212:213], v[114:115] op_sel:[0,1] op_sel_hi:[1,1]
    v_pk_mul_f32 v[214:215], v[214:215], v[114:115] op_sel:[0,1] op_sel_hi:[1,1]
    v_pk_mul_f32 v[216:217], v[216:217], v[114:115] op_sel:[0,1] op_sel_hi:[1,1]
    v_pk_mul_f32 v[218:219], v[218:219], v[114:115] op_sel:[0,1] op_sel_hi:[1,1]
    v_pk_mul_f32 v[220:221], v[220:221], v[114:115] op_sel:[0,1] op_sel_hi:[1,1]
    v_pk_mul_f32 v[222:223], v[222:223], v[114:115] op_sel:[0,1] op_sel_hi:[1,1]
    v_pk_mul_f32 v[224:225], v[224:225], v[114:115] op_sel:[0,1] op_sel_hi:[1,1]
    v_pk_mul_f32 v[226:227], v[226:227], v[114:115] op_sel:[0,1] op_sel_hi:[1,1]
    v_pk_mul_f32 v[228:229], v[228:229], v[114:115] op_sel:[0,1] op_sel_hi:[1,1]
    v_pk_mul_f32 v[230:231], v[230:231], v[114:115] op_sel:[0,1] op_sel_hi:[1,1]
    v_pk_mul_f32 v[232:233], v[232:233], v[114:115] op_sel:[0,1] op_sel_hi:[1,1]
    v_pk_mul_f32 v[234:235], v[234:235], v[114:115] op_sel:[0,1] op_sel_hi:[1,1]
    v_pk_mul_f32 v[236:237], v[236:237], v[114:115] op_sel:[0,1] op_sel_hi:[1,1]
    v_pk_mul_f32 v[238:239], v[238:239], v[114:115] op_sel:[0,1] op_sel_hi:[1,1]
    v_pk_mul_f32 v[240:241], v[240:241], v[114:115] op_sel:[0,1] op_sel_hi:[1,1]
    v_pk_mul_f32 v[242:243], v[242:243], v[114:115] op_sel:[0,1] op_sel_hi:[1,1]
    v_mfma_f32_16x16x32_bf16 v[120:123], a[140:143], v[64:67], 0
    v_cvt_pk_bf16_f32 v84, v212, v213
    v_cvt_pk_bf16_f32 v85, v214, v215
    v_cvt_pk_bf16_f32 v86, v216, v217
    v_cvt_pk_bf16_f32 v87, v218, v219
    v_mfma_f32_16x16x32_bf16 v[120:123], a[136:139], v[60:63], v[120:123]
    v_cvt_pk_bf16_f32 v88, v220, v221
    v_cvt_pk_bf16_f32 v89, v222, v223
    v_cvt_pk_bf16_f32 v90, v224, v225
    v_cvt_pk_bf16_f32 v91, v226, v227
    v_mfma_f32_16x16x32_bf16 v[120:123], a[132:135], v[56:59], v[120:123]
    v_cvt_pk_bf16_f32 v92, v228, v229
    v_cvt_pk_bf16_f32 v93, v230, v231
    v_cvt_pk_bf16_f32 v94, v232, v233
    v_cvt_pk_bf16_f32 v95, v234, v235
    v_mfma_f32_16x16x32_bf16 v[120:123], a[128:131], v[52:55], v[120:123]
    v_cvt_pk_bf16_f32 v96, v236, v237
    v_cvt_pk_bf16_f32 v97, v238, v239
    v_cvt_pk_bf16_f32 v98, v240, v241
    v_cvt_pk_bf16_f32 v99, v242, v243
    v_mfma_f32_16x16x32_bf16 v[136:139], a[156:159], v[64:67], 0
    v_permlane32_swap_b32 v84, v86
    v_permlane32_swap_b32 v85, v87
    v_permlane32_swap_b32 v88, v90
    v_permlane32_swap_b32 v89, v91
    v_mfma_f32_16x16x32_bf16 v[136:139], a[152:155], v[60:63], v[136:139]
    v_permlane32_swap_b32 v92, v94
    v_permlane32_swap_b32 v93, v95
    v_permlane32_swap_b32 v96, v98
    v_permlane32_swap_b32 v97, v99
    v_mfma_f32_16x16x32_bf16 v[136:139], a[148:151], v[56:59], v[136:139]
    v_permlane16_swap_b32 v84, v86
    v_permlane16_swap_b32 v85, v87
    v_permlane16_swap_b32 v88, v90
    v_permlane16_swap_b32 v89, v91
    v_mfma_f32_16x16x32_bf16 v[136:139], a[144:147], v[52:55], v[136:139]
    v_permlane16_swap_b32 v92, v94
    v_permlane16_swap_b32 v93, v95
    v_permlane16_swap_b32 v96, v98
    v_permlane16_swap_b32 v97, v99
    v_mfma_f32_16x16x32_bf16 v[124:127], a[128:131], v[68:71], 0
    v_max3_f32 v28, v116, v117, v118
    v_max3_f32 v30, v120, v121, v122
    v_mfma_f32_16x16x32_bf16 v[124:127], a[132:135], v[72:75], v[124:127]
    v_max3_f32 v29, v119, v132, v133
    v_max3_f32 v31, v123, v136, v137
    v_max3_f32 v28, v28, v134, v135
    v_mfma_f32_16x16x32_bf16 v[124:127], a[136:139], v[76:79], v[124:127]
    v_max3_f32 v30, v30, v138, v139
    v_max_f32 v28, v28, v29
    v_max_f32 v30, v30, v31
    v_mfma_f32_16x16x32_bf16 v[124:127], a[140:143], v[80:83], v[124:127]
    v_mov_b32 v29, v28
    v_mov_b32 v31, v30
    s_nop 0
    v_permlane32_swap_b32 v28, v29
    v_mfma_f32_16x16x32_bf16 v[140:143], a[144:147], v[68:71], 0
    v_permlane32_swap_b32 v30, v31
    v_max_f32 v28, v28, v29
    v_mfma_f32_16x16x32_bf16 v[140:143], a[148:151], v[72:75], v[140:143]
    v_max_f32 v30, v30, v31
    v_mov_b32 v29, v28
    v_mov_b32 v31, v30
    v_mfma_f32_16x16x32_bf16 v[140:143], a[152:155], v[76:79], v[140:143]
    v_permlane16_swap_b32 v28, v29
    v_permlane16_swap_b32 v30, v31
    v_max_f32 v28, v28, v29
    v_mfma_f32_16x16x32_bf16 v[140:143], a[156:159], v[80:83], v[140:143]
    v_max_f32 v30, v30, v31
    v_sub_f32 v100, 0, v28
    v_sub_f32 v104, 0, v30
    v_mfma_f32_16x16x32_bf16 v[128:131], a[140:143], v[96:99], 0
    v_sub_f32 v101, 0, v28
    v_sub_f32 v105, 0, v30
    v_mfma_f32_16x16x32_bf16 v[128:131], a[136:139], v[92:95], v[128:131]
    v_sub_f32 v102, 0, v28
    v_sub_f32 v106, 0, v30
    v_sub_f32 v103, 0, v28
    v_mfma_f32_16x16x32_bf16 v[128:131], a[132:135], v[88:91], v[128:131]
    v_sub_f32 v107, 0, v30
    v_sub_f32 v116, v116, v28
    v_sub_f32 v120, v120, v30
    v_mfma_f32_16x16x32_bf16 v[128:131], a[128:131], v[84:87], v[128:131]
    v_sub_f32 v117, v117, v28
    v_sub_f32 v121, v121, v30
    v_sub_f32 v118, v118, v28
    v_mfma_f32_16x16x32_bf16 v[144:147], a[156:159], v[96:99], 0
    v_sub_f32 v122, v122, v30
    v_sub_f32 v119, v119, v28
    v_mfma_f32_16x16x32_bf16 v[144:147], a[152:155], v[92:95], v[144:147]
    v_sub_f32 v123, v123, v30
    v_sub_f32 v132, v132, v28
    v_sub_f32 v136, v136, v30
    v_mfma_f32_16x16x32_bf16 v[144:147], a[148:151], v[88:91], v[144:147]
    v_sub_f32 v133, v133, v28
    v_sub_f32 v137, v137, v30
    v_sub_f32 v134, v134, v28
    v_mfma_f32_16x16x32_bf16 v[144:147], a[144:147], v[84:87], v[144:147]
    v_sub_f32 v138, v138, v30
    v_sub_f32 v135, v135, v28
    v_sub_f32 v139, v139, v30
    s_waitcnt vmcnt(14)
    s_barrier
    v_mfma_f32_16x16x32_bf16 v[148:151], a[160:163], v[36:39], v[100:103]
    s_add_u32 m0, s34, 0
    s_nop 3
    v_mfma_f32_16x16x32_bf16 v[148:151], a[164:167], v[40:43], v[148:151]
    ds_read_b128 a[128:131], v1 offset:16384
    v_max3_f32 v32, v124, v125, v126
    v_max3_f32 v34, v128, v129, v130
    v_mfma_f32_16x16x32_bf16 v[148:151], a[168:171], v[44:47], v[148:151]
    ds_read_b128 a[132:135], v2 offset:16384
    v_max3_f32 v33, v127, v140, v141
    v_max3_f32 v35, v131, v144, v145
    v_max3_f32 v32, v32, v142, v143
    v_mfma_f32_16x16x32_bf16 v[148:151], a[172:175], v[48:51], v[148:151]
    buffer_load_dwordx4 v13, s[8:11], s28 offen offset:0 lds
    v_max3_f32 v34, v34, v146, v147
    v_max_f32 v32, v32, v33
    v_max_f32 v34, v34, v35
    v_mfma_f32_16x16x32_bf16 v[152:155], a[172:175], v[64:67], v[104:107]
    v_mov_b32 v33, v32
    v_mov_b32 v35, v34
    s_nop 0
    v_permlane32_swap_b32 v32, v33
    v_mfma_f32_16x16x32_bf16 v[152:155], a[168:171], v[60:63], v[152:155]
    v_permlane32_swap_b32 v34, v35
    v_max_f32 v32, v32, v33
    v_max_f32 v34, v34, v35
    v_mfma_f32_16x16x32_bf16 v[152:155], a[164:167], v[56:59], v[152:155]
    v_mov_b32 v33, v32
    v_mov_b32 v35, v34
    s_nop 0
    v_permlane16_swap_b32 v32, v33
    v_mfma_f32_16x16x32_bf16 v[152:155], a[160:163], v[52:55], v[152:155]
    v_permlane16_swap_b32 v34, v35
    v_max_f32 v32, v32, v33
    v_max_f32 v34, v34, v35
    v_mfma_f32_16x16x32_bf16 v[164:167], a[176:179], v[36:39], v[100:103]
    v_sub_f32 v108, 0, v32
    v_sub_f32 v112, 0, v34
    v_sub_f32 v109, 0, v32
    v_mfma_f32_16x16x32_bf16 v[164:167], a[180:183], v[40:43], v[164:167]
    v_sub_f32 v113, 0, v34
    v_sub_f32 v110, 0, v32
    v_sub_f32 v114, 0, v34
    v_mfma_f32_16x16x32_bf16 v[164:167], a[184:187], v[44:47], v[164:167]
    v_sub_f32 v111, 0, v32
    v_sub_f32 v115, 0, v34
    v_sub_f32 v124, v124, v32
    v_mfma_f32_16x16x32_bf16 v[164:167], a[188:191], v[48:51], v[164:167]
    v_sub_f32 v128, v128, v34
    v_sub_f32 v125, v125, v32
    v_sub_f32 v129, v129, v34
    v_mfma_f32_16x16x32_bf16 v[168:171], a[188:191], v[64:67], v[104:107]
    v_sub_f32 v126, v126, v32
    v_sub_f32 v130, v130, v34
    v_sub_f32 v127, v127, v32
    v_mfma_f32_16x16x32_bf16 v[168:171], a[184:187], v[60:63], v[168:171]
    v_sub_f32 v131, v131, v34
    v_sub_f32 v140, v140, v32
    v_sub_f32 v144, v144, v34
    v_mfma_f32_16x16x32_bf16 v[168:171], a[180:183], v[56:59], v[168:171]
    v_sub_f32 v141, v141, v32
    v_sub_f32 v145, v145, v34
    v_sub_f32 v142, v142, v32
    v_mfma_f32_16x16x32_bf16 v[168:171], a[176:179], v[52:55], v[168:171]
    v_sub_f32 v146, v146, v34
    v_sub_f32 v143, v143, v32
    v_sub_f32 v147, v147, v34
    s_nop 0
    v_mfma_f32_16x16x32_bf16 v[156:159], a[160:163], v[68:71], v[108:111]
    ds_read_b128 a[136:139], v3 offset:16384
    v_mfma_f32_16x16x32_bf16 v[156:159], a[164:167], v[72:75], v[156:159]
    ds_read_b128 a[140:143], v4 offset:16384
    v_mfma_f32_16x16x32_bf16 v[156:159], a[168:171], v[76:79], v[156:159]
    buffer_load_dwordx4 v14, s[8:11], s28 offen offset:1024 lds
    v_mfma_f32_16x16x32_bf16 v[156:159], a[172:175], v[80:83], v[156:159]
    v_mfma_f32_16x16x32_bf16 v[160:163], a[172:175], v[96:99], v[112:115]
    v_mfma_f32_16x16x32_bf16 v[160:163], a[168:171], v[92:95], v[160:163]
    v_mfma_f32_16x16x32_bf16 v[160:163], a[164:167], v[88:91], v[160:163]
    v_mfma_f32_16x16x32_bf16 v[160:163], a[160:163], v[84:87], v[160:163]
    s_waitcnt lgkmcnt(2)
    v_mfma_f32_16x16x32_bf16 v[172:175], a[176:179], v[68:71], v[108:111]
    s_waitcnt vmcnt(7)
    ds_read_b128 a[144:147], v1 offset:20480
    v_exp_f32 v116, v116
    v_mfma_f32_16x16x32_bf16 v[172:175], a[180:183], v[72:75], v[172:175]
    ds_read_b128 a[148:151], v2 offset:20480
    v_exp_f32 v117, v117
    v_mfma_f32_16x16x32_bf16 v[172:175], a[184:187], v[76:79], v[172:175]
    v_cvt_pk_bf16_f32 v180, v116, v117
    v_exp_f32 v118, v118
    v_mfma_f32_16x16x32_bf16 v[172:175], a[188:191], v[80:83], v[172:175]
    v_exp_f32 v119, v119
    v_mfma_f32_16x16x32_bf16 v[176:179], a[188:191], v[96:99], v[112:115]
    v_cvt_pk_bf16_f32 v181, v118, v119
    v_exp_f32 v120, v120
    v_mfma_f32_16x16x32_bf16 v[176:179], a[184:187], v[92:95], v[176:179]
    v_exp_f32 v121, v121
    v_mfma_f32_16x16x32_bf16 v[176:179], a[180:183], v[88:91], v[176:179]
    buffer_load_dwordx4 v15, s[8:11], s28 offen offset:2048 lds
    v_cvt_pk_bf16_f32 v188, v120, v121
    v_exp_f32 v122, v122
    v_mfma_f32_16x16x32_bf16 v[176:179], a[176:179], v[84:87], v[176:179]
    s_waitcnt lgkmcnt(2)
    v_exp_f32 v123, v123
    v_mfma_f32_16x16x32_bf16 v[116:119], a[128:131], v[36:39], v[100:103]
    ds_read_b128 a[152:155], v3 offset:20480
    v_cvt_pk_bf16_f32 v189, v122, v123
    v_exp_f32 v124, v124
    v_mfma_f32_16x16x32_bf16 v[116:119], a[132:135], v[40:43], v[116:119]
    ds_read_b128 a[156:159], v4 offset:20480
    v_exp_f32 v125, v125
    v_mfma_f32_16x16x32_bf16 v[116:119], a[136:139], v[44:47], v[116:119]
    v_cvt_pk_bf16_f32 v196, v124, v125
    v_exp_f32 v126, v126
    v_cmp_gt_u32 vcc, 32, v252
    s_and_b64 vcc, vcc, exec
    s_cbranch_scc1 L_spin_all
L_back_all:
    v_mfma_f32_16x16x32_bf16 v[116:119], a[140:143], v[48:51], v[116:119]
    s_cmp_eq_u32 s6, 255
    s_cbranch_scc1 L_rt_keys
L_rt_back_keys:
    v_exp_f32 v127, v127
    v_mfma_f32_16x16x32_bf16 v[120:123], a[140:143], v[64:67], v[104:107]
    v_cvt_pk_bf16_f32 v197, v126, v127
    v_exp_f32 v128, v128
    v_mfma_f32_16x16x32_bf16 v[120:123], a[136:139], v[60:63], v[120:123]
    v_exp_f32 v129, v129
    v_mfma_f32_16x16x32_bf16 v[120:123], a[132:135], v[56:59], v[120:123]
    buffer_load_dwordx4 v16, s[8:11], s28 offen offset:3072 lds
    v_cvt_pk_bf16_f32 v204, v128, v129
    v_exp_f32 v130, v130
    v_mfma_f32_16x16x32_bf16 v[120:123], a[128:131], v[52:55], v[120:123]
    s_waitcnt lgkmcnt(2)
    v_exp_f32 v131, v131
    v_mfma_f32_16x16x32_bf16 v[124:127], a[128:131], v[68:71], v[108:111]
    ds_read_b128 a[160:163], v1 offset:24576
    v_cvt_pk_bf16_f32 v205, v130, v131
    v_exp_f32 v132, v132
    v_mfma_f32_16x16x32_bf16 v[124:127], a[132:135], v[72:75], v[124:127]
    ds_read_b128 a[164:167], v2 offset:24576
    v_exp_f32 v133, v133
    v_mfma_f32_16x16x32_bf16 v[124:127], a[136:139], v[76:79], v[124:127]
    v_cvt_pk_bf16_f32 v182, v132, v133
    v_exp_f32 v134, v134
    v_mfma_f32_16x16x32_bf16 v[124:127], a[140:143], v[80:83], v[124:127]
    v_exp_f32 v135, v135
    v_mfma_f32_16x16x32_bf16 v[128:131], a[140:143], v[96:99], v[112:115]
    v_cvt_pk_bf16_f32 v183, v134, v135
    v_exp_f32 v136, v136
    v_mfma_f32_16x16x32_bf16 v[128:131], a[136:139], v[92:95], v[128:131]
    s_add_u32 s28, s28, 16384
    s_mov_b32 m0, s31
    v_exp_f32 v137, v137
    v_mfma_f32_16x16x32_bf16 v[128:131], a[132:135], v[88:91], v[128:131]
    buffer_load_dwordx4 v17, s[12:15], s29 offen offset:0 lds
    v_cvt_pk_bf16_f32 v190, v136, v137
    v_exp_f32 v138, v138
    v_mfma_f32_16x16x32_bf16 v[128:131], a[128:131], v[84:87], v[128:131]
    s_waitcnt lgkmcnt(2)
    v_exp_f32 v139, v139
    v_mfma_f32_16x16x32_bf16 v[132:135], a[144:147], v[36:39], v[100:103]
    ds_read_b128 a[168:171], v3 offset:24576
    v_cvt_pk_bf16_f32 v191, v138, v139
    v_exp_f32 v140, v140
    v_mfma_f32_16x16x32_bf16 v[132:135], a[148:151], v[40:43], v[132:135]
    ds_read_b128 a[172:175], v4 offset:24576
    v_exp_f32 v141, v141
    v_mfma_f32_16x16x32_bf16 v[132:135], a[152:155], v[44:47], v[132:135]
    v_cvt_pk_bf16_f32 v198, v140, v141
    v_exp_f32 v142, v142
    v_mfma_f32_16x16x32_bf16 v[132:135], a[156:159], v[48:51], v[132:135]
    v_exp_f32 v143, v143
    v_mfma_f32_16x16x32_bf16 v[136:139], a[156:159], v[64:67], v[104:107]
    v_cvt_pk_bf16_f32 v199, v142, v143
    v_exp_f32 v144, v144
    v_mfma_f32_16x16x32_bf16 v[136:139], a[152:155], v[60:63], v[136:139]
    v_exp_f32 v145, v145
    v_mfma_f32_16x16x32_bf16 v[136:139], a[148:151], v[56:59], v[136:139]
    buffer_load_dwordx4 v18, s[12:15], s29 offen offset:1024 lds
    v_cvt_pk_bf16_f32 v206, v144, v145
    v_exp_f32 v146, v146
    v_mfma_f32_16x16x32_bf16 v[136:139], a[144:147], v[52:55], v[136:139]
    s_waitcnt lgkmcnt(2)
    v_exp_f32 v147, v147
    v_mfma_f32_16x16x32_bf16 v[140:143], a[144:147], v[68:71], v[108:111]
    ds_read_b128 a[176:179], v1 offset:28672
    v_cvt_pk_bf16_f32 v207, v146, v147
    v_exp_f32 v148, v148
    v_mfma_f32_16x16x32_bf16 v[140:143], a[148:151], v[72:75], v[140:143]
    ds_read_b128 a[180:183], v2 offset:28672
    v_exp_f32 v149, v149
    v_mfma_f32_16x16x32_bf16 v[140:143], a[152:155], v[76:79], v[140:143]
    v_cvt_pk_bf16_f32 v184, v148, v149
    v_exp_f32 v150, v150
    v_mfma_f32_16x16x32_bf16 v[140:143], a[156:159], v[80:83], v[140:143]
    v_exp_f32 v151, v151
    v_mfma_f32_16x16x32_bf16 v[144:147], a[156:159], v[96:99], v[112:115]
    v_cvt_pk_bf16_f32 v185, v150, v151
    v_exp_f32 v152, v152
    v_mfma_f32_16x16x32_bf16 v[144:147], a[152:155], v[92:95], v[144:147]
    v_exp_f32 v153, v153
    v_mfma_f32_16x16x32_bf16 v[144:147], a[148:151], v[88:91], v[144:147]
    buffer_load_dwordx4 v17, s[12:15], s29 offen offset:2048 lds
    v_cvt_pk_bf16_f32 v192, v152, v153
    v_exp_f32 v154, v154
    v_mfma_f32_16x16x32_bf16 v[144:147], a[144:147], v[84:87], v[144:147]
    s_waitcnt lgkmcnt(2)
    v_exp_f32 v155, v155
    v_mfma_f32_16x16x32_bf16 v[148:151], a[160:163], v[36:39], v[100:103]
    ds_read_b128 a[184:187], v3 offset:28672
    v_cvt_pk_bf16_f32 v193, v154, v155
    v_exp_f32 v156, v156
    v_mfma_f32_16x16x32_bf16 v[148:151], a[164:167], v[40:43], v[148:151]
    ds_read_b128 a[188:191], v4 offset:28672
    v_exp_f32 v157, v157
    v_mfma_f32_16x16x32_bf16 v[148:151], a[168:171], v[44:47], v[148:151]
    v_cvt_pk_bf16_f32 v200, v156, v157
    v_exp_f32 v158, v158
    v_mfma_f32_16x16x32_bf16 v[148:151], a[172:175], v[48:51], v[148:151]
    v_exp_f32 v159, v159
    v_mfma_f32_16x16x32_bf16 v[152:155], a[172:175], v[64:67], v[104:107]
    v_cvt_pk_bf16_f32 v201, v158, v159
    v_exp_f32 v160, v160
    v_mfma_f32_16x16x32_bf16 v[152:155], a[168:171], v[60:63], v[152:155]
    v_exp_f32 v161, v161
    v_mfma_f32_16x16x32_bf16 v[152:155], a[164:167], v[56:59], v[152:155]
    buffer_load_dwordx4 v18, s[12:15], s29 offen offset:3072 lds
    v_cvt_pk_bf16_f32 v208, v160, v161
    v_exp_f32 v162, v162
    v_mfma_f32_16x16x32_bf16 v[152:155], a[160:163], v[52:55], v[152:155]
    s_waitcnt vmcnt(14) lgkmcnt(2)
    s_barrier
    s_add_u32 s29, s29, 16384
    v_exp_f32 v163, v163
    v_mfma_f32_16x16x32_bf16 v[156:159], a[160:163], v[68:71], v[108:111]
    s_waitcnt vmcnt(8)
    ds_read_b64_tr_b16 a[192:193], v5 offset:8192
    v_cvt_pk_bf16_f32 v209, v162, v163
    v_exp_f32 v164, v164
    v_mfma_f32_16x16x32_bf16 v[156:159], a[164:167], v[72:75], v[156:159]
    ds_read_b64_tr_b16 a[194:195], v5 offset:12288
    v_exp_f32 v165, v165
    v_mfma_f32_16x16x32_bf16 v[156:159], a[168:171], v[76:79], v[156:159]
    ds_read_b128 a[128:131], v1 offset:32768
    ds_read_b64_tr_b16 a[240:241], v25 offset:0
    v_cvt_pk_bf16_f32 v186, v164, v165
    v_exp_f32 v166, v166
    v_mfma_f32_16x16x32_bf16 v[156:159], a[172:175], v[80:83], v[156:159]
    ds_read_b64_tr_b16 a[196:197], v5 offset:32768
    v_exp_f32 v167, v167
    v_mfma_f32_16x16x32_bf16 v[160:163], a[172:175], v[96:99], v[112:115]
    ds_read_b64_tr_b16 a[198:199], v5 offset:36864
    ds_read_b64_tr_b16 a[242:243], v25 offset:2560
    v_cvt_pk_bf16_f32 v187, v166, v167
    v_exp_f32 v168, v168
    v_mfma_f32_16x16x32_bf16 v[160:163], a[168:171], v[92:95], v[160:163]
    s_add_u32 m0, s34, 49152
    ds_read_b128 a[132:135], v2 offset:32768
    ds_read_b64_tr_b16 a[244:245], v25 offset:32
    v_exp_f32 v169, v169
    v_mfma_f32_16x16x32_bf16 v[160:163], a[164:167], v[88:91], v[160:163]
    buffer_load_dwordx4 v13, s[8:11], s28 offen offset:0 lds
    v_cvt_pk_bf16_f32 v194, v168, v169
    v_exp_f32 v170, v170
    v_mfma_f32_16x16x32_bf16 v[160:163], a[160:163], v[84:87], v[160:163]
    s_waitcnt lgkmcnt(6)
    ds_read_b64_tr_b16 a[246:247], v25 offset:2592
    v_exp_f32 v171, v171
    v_mfma_f32_16x16x32_bf16 v[164:167], a[176:179], v[36:39], v[100:103]
    ds_read_b64_tr_b16 a[200:201], v6 offset:8192
    ds_read_b64_tr_b16 a[248:249], v25 offset:64
    v_cvt_pk_bf16_f32 v195, v170, v171
    v_exp_f32 v172, v172
    v_mfma_f32_16x16x32_bf16 v[164:167], a[180:183], v[40:43], v[164:167]
    ds_read_b64_tr_b16 a[202:203], v6 offset:12288
    v_exp_f32 v173, v173
    v_mfma_f32_16x16x32_bf16 v[164:167], a[184:187], v[44:47], v[164:167]
    ds_read_b128 a[136:139], v3 offset:32768
    ds_read_b64_tr_b16 a[250:251], v25 offset:2624
    v_cvt_pk_bf16_f32 v202, v172, v173
    v_exp_f32 v174, v174
    v_mfma_f32_16x16x32_bf16 v[164:167], a[188:191], v[48:51], v[164:167]
    ds_read_b64_tr_b16 a[204:205], v6 offset:32768
    ds_read_b64_tr_b16 a[252:253], v25 offset:96
    v_exp_f32 v175, v175
    v_mfma_f32_16x16x32_bf16 v[168:171], a[188:191], v[64:67], v[104:107]
    ds_read_b64_tr_b16 a[206:207], v6 offset:36864
    v_cvt_pk_bf16_f32 v203, v174, v175
    v_exp_f32 v176, v176
    v_mfma_f32_16x16x32_bf16 v[168:171], a[184:187], v[60:63], v[168:171]
    ds_read_b128 a[140:143], v4 offset:32768
    ds_read_b64_tr_b16 a[254:255], v25 offset:2656
    v_exp_f32 v177, v177
    v_mfma_f32_16x16x32_bf16 v[168:171], a[180:183], v[56:59], v[168:171]
    buffer_load_dwordx4 v14, s[8:11], s28 offen offset:1024 lds
    ds_read_b64_tr_b16 v[252:253], v25 offset:128
    v_cvt_pk_bf16_f32 v210, v176, v177
    v_exp_f32 v178, v178
    v_mfma_f32_16x16x32_bf16 v[168:171], a[176:179], v[52:55], v[168:171]
    s_waitcnt lgkmcnt(6)
    ds_read_b64_tr_b16 v[254:255], v25 offset:2688
    v_exp_f32 v179, v179
    v_mfma_f32_16x16x32_bf16 v[172:175], a[176:179], v[68:71], v[108:111]
    s_mov_b32 s16, s62
    v_exp_f32 v116, v116
    v_mfma_f32_16x16x32_bf16 v[172:175], a[180:183], v[72:75], v[172:175]
    s_mov_b32 s17, s63
    ds_read_b64_tr_b16 a[208:209], v7 offset:8192
    v_cvt_pk_bf16_f32 v211, v178, v179
    v_mfma_f32_16x16x32_bf16 v[172:175], a[184:187], v[76:79], v[172:175]
    s_mov_b32 s18, 0x21c000
    v_exp_f32 v117, v117
    v_mfma_f32_16x16x32_bf16 v[172:175], a[188:191], v[80:83], v[172:175]
    s_mov_b32 s19, 0x20000
    ds_read_b64_tr_b16 a[210:211], v7 offset:12288
    v_mfma_f32_16x16x32_bf16 v[176:179], a[188:191], v[96:99], v[112:115]
    s_mov_b32 s20, s64
    v_exp_f32 v118, v118
    v_mfma_f32_16x16x32_bf16 v[176:179], a[184:187], v[92:95], v[176:179]
    s_mov_b32 s21, s65
    ds_read_b128 a[144:147], v1 offset:36864
    v_cvt_pk_bf16_f32 v212, v116, v117
    v_mfma_f32_16x16x32_bf16 v[176:179], a[180:183], v[88:91], v[176:179]
    s_mov_b32 s22, 0x21c000
    v_exp_f32 v119, v119
    v_mfma_f32_16x16x32_bf16 v[176:179], a[176:179], v[84:87], v[176:179]
    s_mov_b32 s23, 0x20000
    ds_read_b64_tr_b16 a[212:213], v7 offset:32768
    v_mfma_f32_16x16x32_bf16 a[0:3], a[192:195], v[180:183], 0
    s_mov_b32 s96, s66
    v_exp_f32 v120, v120
    v_mfma_f32_16x16x32_bf16 a[0:3], a[196:199], v[184:187], a[0:3]
    s_mov_b32 s97, s67
    ds_read_b64_tr_b16 a[214:215], v7 offset:36864
    v_cvt_pk_bf16_f32 v213, v118, v119
    v_mfma_f32_16x16x32_bf16 a[4:7], a[196:199], v[192:195], 0
    s_mov_b32 s98, 0x21c000
    v_exp_f32 v121, v121
    v_mfma_f32_16x16x32_bf16 a[4:7], a[192:195], v[188:191], a[4:7]
    s_mov_b32 s99, 0x20000
    ds_read_b128 a[148:151], v2 offset:36864
    v_cvt_pk_bf16_f32 v220, v120, v121
    v_mfma_f32_16x16x32_bf16 a[8:11], a[192:195], v[196:199], 0
    v_exp_f32 v122, v122
    v_mfma_f32_16x16x32_bf16 a[8:11], a[196:199], v[200:203], a[8:11]
    buffer_load_dwordx4 v15, s[8:11], s28 offen offset:2048 lds
    v_mfma_f32_16x16x32_bf16 a[12:15], a[196:199], v[208:211], 0
    v_exp_f32 v123, v123
    v_mfma_f32_16x16x32_bf16 a[12:15], a[192:195], v[204:207], a[12:15]
    s_waitcnt lgkmcnt(6)
    v_mul_u32_u24 v24, 3456, v19
    v_mfma_f32_16x16x32_bf16 v[116:119], a[128:131], v[36:39], v[100:103]
    s_lshl_b32 s40, s6, 4
    v_exp_f32 v124, v124
    v_mfma_f32_16x16x32_bf16 v[116:119], a[132:135], v[40:43], v[116:119]
    ds_read_b64_tr_b16 a[216:217], v8 offset:8192
    v_cvt_pk_bf16_f32 v221, v122, v123
    v_mfma_f32_16x16x32_bf16 v[116:119], a[136:139], v[44:47], v[116:119]
    v_exp_f32 v125, v125
    v_mfma_f32_16x16x32_bf16 v[116:119], a[140:143], v[48:51], v[116:119]
    ds_read_b64_tr_b16 a[218:219], v8 offset:12288
    v_add_u32 v24, s40, v24
    v_mfma_f32_16x16x32_bf16 v[120:123], a[140:143], v[64:67], v[104:107]
    s_cmp_ge_u32 s5, 2
    s_cselect_b32 s16, s20, s16
    s_cselect_b32 s17, s21, s17
    v_exp_f32 v126, v126
    v_mfma_f32_16x16x32_bf16 v[120:123], a[136:139], v[60:63], v[120:123]
    s_cmp_ge_u32 s6, 216
    s_cselect_b32 s18, 0, s18
    ds_read_b128 a[152:155], v3 offset:36864
    v_cvt_pk_bf16_f32 v228, v124, v125
    v_mfma_f32_16x16x32_bf16 v[120:123], a[132:135], v[56:59], v[120:123]
    s_and_b32 s40, s5, 1
    v_exp_f32 v127, v127
    v_mfma_f32_16x16x32_bf16 v[120:123], a[128:131], v[52:55], v[120:123]
    s_mul_i32 s37, s40, 1105920
    ds_read_b64_tr_b16 a[220:221], v8 offset:32768
    v_mfma_f32_16x16x32_bf16 a[16:19], a[200:203], v[180:183], 0
    s_mul_i32 s38, s5, 5120
    v_exp_f32 v128, v128
    v_mfma_f32_16x16x32_bf16 a[16:19], a[204:207], v[184:187], a[16:19]
    s_add_u32 s38, s38, 65536
    ds_read_b64_tr_b16 a[222:223], v8 offset:36864
    v_cvt_pk_bf16_f32 v229, v126, v127
    v_mfma_f32_16x16x32_bf16 a[20:23], a[204:207], v[192:195], 0
    s_mov_b32 s36, 4
    buffer_store_dwordx4 a[240:243], v26, s[76:79], 0 offen offset:0 sc1
    v_exp_f32 v129, v129
    v_mfma_f32_16x16x32_bf16 a[20:23], a[200:203], v[188:191], a[20:23]
    ds_read_b128 a[156:159], v4 offset:36864
    v_mfma_f32_16x16x32_bf16 a[24:27], a[200:203], v[196:199], 0
    v_exp_f32 v130, v130
    v_mfma_f32_16x16x32_bf16 a[24:27], a[204:207], v[200:203], a[24:27]
    v_cvt_pk_bf16_f32 v236, v128, v129
    v_mfma_f32_16x16x32_bf16 a[28:31], a[204:207], v[208:211], 0
    v_exp_f32 v131, v131
    v_mfma_f32_16x16x32_bf16 a[28:31], a[200:203], v[204:207], a[28:31]
    buffer_load_dwordx4 v16, s[8:11], s28 offen offset:3072 lds
    v_smfmac_f32_16x16x64_bf16 a[224:227], v[244:247], v[180:187], v248
    s_waitcnt lgkmcnt(6)
    buffer_store_dwordx4 a[244:247], v26, s[76:79], 0 offen offset:1024 sc1
    v_mfma_f32_16x16x32_bf16 v[124:127], a[128:131], v[68:71], v[108:111]
    v_exp_f32 v132, v132
    v_mfma_f32_16x16x32_bf16 v[124:127], a[132:135], v[72:75], v[124:127]
    ds_read_b64_tr_b16 a[192:193], v9 offset:8192
    v_cvt_pk_bf16_f32 v237, v130, v131
    v_mfma_f32_16x16x32_bf16 v[124:127], a[136:139], v[76:79], v[124:127]
    v_exp_f32 v133, v133
    v_mfma_f32_16x16x32_bf16 v[124:127], a[140:143], v[80:83], v[124:127]
    ds_read_b64_tr_b16 a[194:195], v9 offset:12288
    v_mfma_f32_16x16x32_bf16 v[128:131], a[140:143], v[96:99], v[112:115]
    v_exp_f32 v134, v134
    v_mfma_f32_16x16x32_bf16 v[128:131], a[136:139], v[92:95], v[128:131]
    ds_read_b128 a[160:163], v1 offset:40960
    v_cvt_pk_bf16_f32 v214, v132, v133
    v_mfma_f32_16x16x32_bf16 v[128:131], a[132:135], v[88:91], v[128:131]
    v_exp_f32 v135, v135
    v_mfma_f32_16x16x32_bf16 v[128:131], a[128:131], v[84:87], v[128:131]
    ds_read_b64_tr_b16 a[196:197], v9 offset:32768
    v_mfma_f32_16x16x32_bf16 a[32:35], a[208:211], v[180:183], 0
    v_exp_f32 v136, v136
    v_mfma_f32_16x16x32_bf16 a[32:35], a[212:215], v[184:187], a[32:35]
    ds_read_b64_tr_b16 a[198:199], v9 offset:36864
    v_cvt_pk_bf16_f32 v215, v134, v135
    v_mfma_f32_16x16x32_bf16 a[36:39], a[212:215], v[192:195], 0
    v_exp_f32 v137, v137
    v_mfma_f32_16x16x32_bf16 a[36:39], a[208:211], v[188:191], a[36:39]
    ds_read_b128 a[164:167], v2 offset:40960
    v_cvt_pk_bf16_f32 v222, v136, v137
    v_mfma_f32_16x16x32_bf16 a[40:43], a[208:211], v[196:199], 0
    s_add_u32 s28, s28, 16384
    s_mov_b32 m0, s32
    buffer_store_dwordx4 a[248:251], v26, s[76:79], 0 offen offset:2048 sc1
    v_exp_f32 v138, v138
    v_mfma_f32_16x16x32_bf16 a[40:43], a[212:215], v[200:203], a[40:43]
    buffer_load_dwordx4 v17, s[12:15], s29 offen offset:0 lds
    v_mfma_f32_16x16x32_bf16 a[44:47], a[212:215], v[208:211], 0
    v_exp_f32 v139, v139
    v_mfma_f32_16x16x32_bf16 a[44:47], a[208:211], v[204:207], a[44:47]
    s_waitcnt lgkmcnt(6)
    buffer_store_dwordx4 a[252:255], v26, s[76:79], 0 offen offset:3072 sc1
    v_mfma_f32_16x16x32_bf16 v[132:135], a[144:147], v[36:39], v[100:103]
    v_exp_f32 v140, v140
    v_mfma_f32_16x16x32_bf16 v[132:135], a[148:151], v[40:43], v[132:135]
    ds_read_b64_tr_b16 a[200:201], v10 offset:8192
    v_cvt_pk_bf16_f32 v223, v138, v139
    v_mfma_f32_16x16x32_bf16 v[132:135], a[152:155], v[44:47], v[132:135]
    v_exp_f32 v141, v141
    v_mfma_f32_16x16x32_bf16 v[132:135], a[156:159], v[48:51], v[132:135]
    ds_read_b64_tr_b16 a[202:203], v10 offset:12288
    v_mfma_f32_16x16x32_bf16 v[136:139], a[156:159], v[64:67], v[104:107]
    v_exp_f32 v142, v142
    v_mfma_f32_16x16x32_bf16 v[136:139], a[152:155], v[60:63], v[136:139]
    ds_read_b128 a[168:171], v3 offset:40960
    v_cvt_pk_bf16_f32 v230, v140, v141
    v_mfma_f32_16x16x32_bf16 v[136:139], a[148:151], v[56:59], v[136:139]
    v_exp_f32 v143, v143
    v_mfma_f32_16x16x32_bf16 v[136:139], a[144:147], v[52:55], v[136:139]
    ds_read_b64_tr_b16 a[204:205], v10 offset:32768
    v_mfma_f32_16x16x32_bf16 a[48:51], a[216:219], v[180:183], 0
    v_exp_f32 v144, v144
    v_mfma_f32_16x16x32_bf16 a[48:51], a[220:223], v[184:187], a[48:51]
    ds_read_b64_tr_b16 a[206:207], v10 offset:36864
    v_cvt_pk_bf16_f32 v231, v142, v143
    v_mfma_f32_16x16x32_bf16 a[52:55], a[220:223], v[192:195], 0
    v_exp_f32 v145, v145
    v_mfma_f32_16x16x32_bf16 a[52:55], a[216:219], v[188:191], a[52:55]
    ds_read_b128 a[172:175], v4 offset:40960
    v_mfma_f32_16x16x32_bf16 a[56:59], a[216:219], v[196:199], 0
    v_exp_f32 v146, v146
    v_mfma_f32_16x16x32_bf16 a[56:59], a[220:223], v[200:203], a[56:59]
    v_cvt_pk_bf16_f32 v238, v144, v145
    v_mfma_f32_16x16x32_bf16 a[60:63], a[220:223], v[208:211], 0
    v_exp_f32 v147, v147
    v_mfma_f32_16x16x32_bf16 a[60:63], a[216:219], v[204:207], a[60:63]
    buffer_load_dwordx4 v18, s[12:15], s29 offen offset:1024 lds
    v_smfmac_f32_16x16x64_bf16 a[228:231], v[244:247], v[188:195], v248
    s_waitcnt lgkmcnt(6)
    buffer_store_dwordx4 v[252:255], v26, s[76:79], s45 offen offset:0 sc1
    v_mfma_f32_16x16x32_bf16 v[140:143], a[144:147], v[68:71], v[108:111]
    s_cmp_eq_u32 s6, 255
    s_cbranch_scc1 L_rt_local
L_rt_back_local:
    v_exp_f32 v148, v148
    v_mfma_f32_16x16x32_bf16 v[140:143], a[148:151], v[72:75], v[140:143]
    ds_read_b64_tr_b16 a[208:209], v11 offset:8192
    v_cvt_pk_bf16_f32 v239, v146, v147
    v_mfma_f32_16x16x32_bf16 v[140:143], a[152:155], v[76:79], v[140:143]
    v_exp_f32 v149, v149
    v_mfma_f32_16x16x32_bf16 v[140:143], a[156:159], v[80:83], v[140:143]
    ds_read_b64_tr_b16 a[210:211], v11 offset:12288
    v_mfma_f32_16x16x32_bf16 v[144:147], a[156:159], v[96:99], v[112:115]
    v_exp_f32 v150, v150
    v_mfma_f32_16x16x32_bf16 v[144:147], a[152:155], v[92:95], v[144:147]
    ds_read_b128 a[176:179], v1 offset:45056
    v_cvt_pk_bf16_f32 v216, v148, v149
    v_mfma_f32_16x16x32_bf16 v[144:147], a[148:151], v[88:91], v[144:147]
    v_exp_f32 v151, v151
    v_mfma_f32_16x16x32_bf16 v[144:147], a[144:147], v[84:87], v[144:147]
    ds_read_b64_tr_b16 a[212:213], v11 offset:32768
    v_mfma_f32_16x16x32_bf16 a[64:67], a[192:195], v[180:183], 0
    v_exp_f32 v152, v152
    v_mfma_f32_16x16x32_bf16 a[64:67], a[196:199], v[184:187], a[64:67]
    ds_read_b64_tr_b16 a[214:215], v11 offset:36864
    v_cvt_pk_bf16_f32 v217, v150, v151
    v_mfma_f32_16x16x32_bf16 a[68:71], a[196:199], v[192:195], 0
    v_exp_f32 v153, v153
    v_mfma_f32_16x16x32_bf16 a[68:71], a[192:195], v[188:191], a[68:71]
    ds_read_b128 a[180:183], v2 offset:45056
    v_cvt_pk_bf16_f32 v224, v152, v153
    v_mfma_f32_16x16x32_bf16 a[72:75], a[192:195], v[196:199], 0
    v_exp_f32 v154, v154
    v_mfma_f32_16x16x32_bf16 a[72:75], a[196:199], v[200:203], a[72:75]
    buffer_load_dwordx4 v17, s[12:15], s29 offen offset:2048 lds
    v_mfma_f32_16x16x32_bf16 a[76:79], a[196:199], v[208:211], 0
    v_exp_f32 v155, v155
    v_mfma_f32_16x16x32_bf16 a[76:79], a[192:195], v[204:207], a[76:79]
    s_waitcnt lgkmcnt(6)
    v_mfma_f32_16x16x32_bf16 v[148:151], a[160:163], v[36:39], v[100:103]
    v_exp_f32 v156, v156
    v_mfma_f32_16x16x32_bf16 v[148:151], a[164:167], v[40:43], v[148:151]
    ds_read_b64_tr_b16 a[216:217], v12 offset:8192
    v_cvt_pk_bf16_f32 v225, v154, v155
    v_mfma_f32_16x16x32_bf16 v[148:151], a[168:171], v[44:47], v[148:151]
    v_exp_f32 v157, v157
    v_mfma_f32_16x16x32_bf16 v[148:151], a[172:175], v[48:51], v[148:151]
    ds_read_b64_tr_b16 a[218:219], v12 offset:12288
    v_mfma_f32_16x16x32_bf16 v[152:155], a[172:175], v[64:67], v[104:107]
    v_exp_f32 v158, v158
    v_mfma_f32_16x16x32_bf16 v[152:155], a[168:171], v[60:63], v[152:155]
    ds_read_b128 a[184:187], v3 offset:45056
    v_cvt_pk_bf16_f32 v232, v156, v157
    v_mfma_f32_16x16x32_bf16 v[152:155], a[164:167], v[56:59], v[152:155]
    v_exp_f32 v159, v159
    v_mfma_f32_16x16x32_bf16 v[152:155], a[160:163], v[52:55], v[152:155]
    ds_read_b64_tr_b16 a[220:221], v12 offset:32768
    v_mfma_f32_16x16x32_bf16 a[80:83], a[200:203], v[180:183], 0
    v_exp_f32 v160, v160
    v_mfma_f32_16x16x32_bf16 a[80:83], a[204:207], v[184:187], a[80:83]
    ds_read_b64_tr_b16 a[222:223], v12 offset:36864
    v_cvt_pk_bf16_f32 v233, v158, v159
    v_mfma_f32_16x16x32_bf16 a[84:87], a[204:207], v[192:195], 0
    v_exp_f32 v161, v161
    v_mfma_f32_16x16x32_bf16 a[84:87], a[200:203], v[188:191], a[84:87]
    ds_read_b128 a[188:191], v4 offset:45056
    v_mfma_f32_16x16x32_bf16 a[88:91], a[200:203], v[196:199], 0
    v_exp_f32 v162, v162
    v_mfma_f32_16x16x32_bf16 a[88:91], a[204:207], v[200:203], a[88:91]
    v_cvt_pk_bf16_f32 v240, v160, v161
    v_mfma_f32_16x16x32_bf16 a[92:95], a[204:207], v[208:211], 0
    v_exp_f32 v163, v163
    v_mfma_f32_16x16x32_bf16 a[92:95], a[200:203], v[204:207], a[92:95]
    buffer_load_dwordx4 v18, s[12:15], s29 offen offset:3072 lds
    v_smfmac_f32_16x16x64_bf16 a[232:235], v[244:247], v[196:203], v248
    s_waitcnt vmcnt(13) lgkmcnt(6)
    s_barrier
    s_add_u32 s29, s29, 16384
    v_mfma_f32_16x16x32_bf16 v[156:159], a[160:163], v[68:71], v[108:111]
    v_exp_f32 v164, v164
    v_mfma_f32_16x16x32_bf16 v[156:159], a[164:167], v[72:75], v[156:159]
    ds_read_b64_tr_b16 a[192:193], v5 offset:16384
    v_cvt_pk_bf16_f32 v241, v162, v163
    v_mfma_f32_16x16x32_bf16 v[156:159], a[168:171], v[76:79], v[156:159]
    v_exp_f32 v165, v165
    v_mfma_f32_16x16x32_bf16 v[156:159], a[172:175], v[80:83], v[156:159]
    ds_read_b64_tr_b16 a[194:195], v5 offset:20480
    v_mfma_f32_16x16x32_bf16 v[160:163], a[172:175], v[96:99], v[112:115]
    v_exp_f32 v166, v166
    v_mfma_f32_16x16x32_bf16 v[160:163], a[168:171], v[92:95], v[160:163]
    ds_read_b128 a[128:131], v1 offset:0
    v_cvt_pk_bf16_f32 v218, v164, v165
    v_mfma_f32_16x16x32_bf16 v[160:163], a[164:167], v[88:91], v[160:163]
    v_exp_f32 v167, v167
    v_mfma_f32_16x16x32_bf16 v[160:163], a[160:163], v[84:87], v[160:163]
    ds_read_b64_tr_b16 a[196:197], v5 offset:40960
    v_mfma_f32_16x16x32_bf16 a[96:99], a[208:211], v[180:183], 0
    v_exp_f32 v168, v168
    v_mfma_f32_16x16x32_bf16 a[96:99], a[212:215], v[184:187], a[96:99]
    ds_read_b64_tr_b16 a[198:199], v5 offset:45056
    v_cvt_pk_bf16_f32 v219, v166, v167
    v_mfma_f32_16x16x32_bf16 a[100:103], a[212:215], v[192:195], 0
    v_exp_f32 v169, v169
    v_mfma_f32_16x16x32_bf16 a[100:103], a[208:211], v[188:191], a[100:103]
    ds_read_b128 a[132:135], v2 offset:0
    v_cvt_pk_bf16_f32 v226, v168, v169
    v_mfma_f32_16x16x32_bf16 a[104:107], a[208:211], v[196:199], 0
    s_add_u32 m0, s34, 16384
    v_exp_f32 v170, v170
    v_mfma_f32_16x16x32_bf16 a[104:107], a[212:215], v[200:203], a[104:107]
    buffer_load_dwordx4 v13, s[8:11], s28 offen offset:0 lds
    v_mfma_f32_16x16x32_bf16 a[108:111], a[212:215], v[208:211], 0
    v_exp_f32 v171, v171
    v_mfma_f32_16x16x32_bf16 a[108:111], a[208:211], v[204:207], a[108:111]
    s_waitcnt lgkmcnt(6)
    v_mfma_f32_16x16x32_bf16 v[164:167], a[176:179], v[36:39], v[100:103]
    s_cmp_eq_u32 s6, 255
    s_cbranch_scc1 L_rt_merge
L_rt_back_merge:
    v_exp_f32 v172, v172
    v_mfma_f32_16x16x32_bf16 v[164:167], a[180:183], v[40:43], v[164:167]
    ds_read_b64_tr_b16 a[200:201], v6 offset:16384
    v_cvt_pk_bf16_f32 v227, v170, v171
    v_mfma_f32_16x16x32_bf16 v[164:167], a[184:187], v[44:47], v[164:167]
    v_exp_f32 v173, v173
    v_mfma_f32_16x16x32_bf16 v[164:167], a[188:191], v[48:51], v[164:167]
    ds_read_b64_tr_b16 a[202:203], v6 offset:20480
    v_mfma_f32_16x16x32_bf16 v[168:171], a[188:191], v[64:67], v[104:107]
    v_exp_f32 v174, v174
    v_mfma_f32_16x16x32_bf16 v[168:171], a[184:187], v[60:63], v[168:171]
    ds_read_b128 a[136:139], v3 offset:0
    v_cvt_pk_bf16_f32 v234, v172, v173
    v_mfma_f32_16x16x32_bf16 v[168:171], a[180:183], v[56:59], v[168:171]
    v_exp_f32 v175, v175
    v_mfma_f32_16x16x32_bf16 v[168:171], a[176:179], v[52:55], v[168:171]
    ds_read_b64_tr_b16 a[204:205], v6 offset:40960
    v_mfma_f32_16x16x32_bf16 a[112:115], a[216:219], v[180:183], 0
    v_exp_f32 v176, v176
    v_mfma_f32_16x16x32_bf16 a[112:115], a[220:223], v[184:187], a[112:115]
    ds_read_b64_tr_b16 a[206:207], v6 offset:45056
    v_cvt_pk_bf16_f32 v235, v174, v175
    v_mfma_f32_16x16x32_bf16 a[116:119], a[220:223], v[192:195], 0
    v_exp_f32 v177, v177
    v_mfma_f32_16x16x32_bf16 a[116:119], a[216:219], v[188:191], a[116:119]
    ds_read_b128 a[140:143], v4 offset:0
    v_mfma_f32_16x16x32_bf16 a[120:123], a[216:219], v[196:199], 0
    v_exp_f32 v178, v178
    v_mfma_f32_16x16x32_bf16 a[120:123], a[220:223], v[200:203], a[120:123]
    v_cvt_pk_bf16_f32 v242, v176, v177
    v_mfma_f32_16x16x32_bf16 a[124:127], a[220:223], v[208:211], 0
    v_exp_f32 v179, v179
    v_mfma_f32_16x16x32_bf16 a[124:127], a[216:219], v[204:207], a[124:127]
    buffer_load_dwordx4 v14, s[8:11], s28 offen offset:1024 lds
    v_smfmac_f32_16x16x64_bf16 a[236:239], v[244:247], v[204:211], v248
    s_waitcnt lgkmcnt(6)
    s_mov_b32 s35, 5
.p2align 6
L_attn_loop:
    v_mfma_f32_16x16x32_bf16 v[172:175], a[176:179], v[68:71], v[108:111]
    v_exp_f32 v116, v116
    v_mfma_f32_16x16x32_bf16 v[172:175], a[180:183], v[72:75], v[172:175]
    ds_read_b64_tr_b16 a[208:209], v7 offset:16384
    v_cvt_pk_bf16_f32 v243, v178, v179
    v_mfma_f32_16x16x32_bf16 v[172:175], a[184:187], v[76:79], v[172:175]
    v_exp_f32 v117, v117
    v_mfma_f32_16x16x32_bf16 v[172:175], a[188:191], v[80:83], v[172:175]
    ds_read_b64_tr_b16 a[210:211], v7 offset:20480
    v_mfma_f32_16x16x32_bf16 v[176:179], a[188:191], v[96:99], v[112:115]
    v_exp_f32 v118, v118
    v_mfma_f32_16x16x32_bf16 v[176:179], a[184:187], v[92:95], v[176:179]
    ds_read_b128 a[144:147], v1 offset:4096
    v_cvt_pk_bf16_f32 v180, v116, v117
    v_mfma_f32_16x16x32_bf16 v[176:179], a[180:183], v[88:91], v[176:179]
    v_exp_f32 v119, v119
    v_mfma_f32_16x16x32_bf16 v[176:179], a[176:179], v[84:87], v[176:179]
    ds_read_b64_tr_b16 a[212:213], v7 offset:40960
    v_mfma_f32_16x16x32_bf16 a[0:3], a[192:195], v[212:215], a[0:3]
    v_exp_f32 v120, v120
    v_mfma_f32_16x16x32_bf16 a[0:3], a[196:199], v[216:219], a[0:3]
    ds_read_b64_tr_b16 a[214:215], v7 offset:45056
    v_cvt_pk_bf16_f32 v181, v118, v119
    v_mfma_f32_16x16x32_bf16 a[4:7], a[196:199], v[224:227], a[4:7]
    v_exp_f32 v121, v121
    v_mfma_f32_16x16x32_bf16 a[4:7], a[192:195], v[220:223], a[4:7]
    ds_read_b128 a[148:151], v2 offset:4096
    v_cvt_pk_bf16_f32 v188, v120, v121
    v_mfma_f32_16x16x32_bf16 a[8:11], a[192:195], v[228:231], a[8:11]
    v_exp_f32 v122, v122
    v_mfma_f32_16x16x32_bf16 a[8:11], a[196:199], v[232:235], a[8:11]
    buffer_load_dwordx4 v15, s[8:11], s28 offen offset:2048 lds
    v_mfma_f32_16x16x32_bf16 a[12:15], a[196:199], v[240:243], a[12:15]
    v_exp_f32 v123, v123
    v_mfma_f32_16x16x32_bf16 a[12:15], a[192:195], v[236:239], a[12:15]
    s_waitcnt lgkmcnt(6)
    v_mfma_f32_16x16x32_bf16 v[116:119], a[128:131], v[36:39], v[100:103]
    v_exp_f32 v124, v124
    v_mfma_f32_16x16x32_bf16 v[116:119], a[132:135], v[40:43], v[116:119]
    ds_read_b64_tr_b16 a[216:217], v8 offset:16384
    v_cvt_pk_bf16_f32 v189, v122, v123
    v_mfma_f32_16x16x32_bf16 v[116:119], a[136:139], v[44:47], v[116:119]
    v_exp_f32 v125, v125
    v_mfma_f32_16x16x32_bf16 v[116:119], a[140:143], v[48:51], v[116:119]
    ds_read_b64_tr_b16 a[218:219], v8 offset:20480
    v_mfma_f32_16x16x32_bf16 v[120:123], a[140:143], v[64:67], v[104:107]
    v_exp_f32 v126, v126
    v_mfma_f32_16x16x32_bf16 v[120:123], a[136:139], v[60:63], v[120:123]
    ds_read_b128 a[152:155], v3 offset:4096
    v_cvt_pk_bf16_f32 v196, v124, v125
    v_mfma_f32_16x16x32_bf16 v[120:123], a[132:135], v[56:59], v[120:123]
    v_exp_f32 v127, v127
    v_mfma_f32_16x16x32_bf16 v[120:123], a[128:131], v[52:55], v[120:123]
    ds_read_b64_tr_b16 a[220:221], v8 offset:40960
    v_mfma_f32_16x16x32_bf16 a[16:19], a[200:203], v[212:215], a[16:19]
    v_exp_f32 v128, v128
    v_mfma_f32_16x16x32_bf16 a[16:19], a[204:207], v[216:219], a[16:19]
    ds_read_b64_tr_b16 a[222:223], v8 offset:45056
    v_cvt_pk_bf16_f32 v197, v126, v127
    v_mfma_f32_16x16x32_bf16 a[20:23], a[204:207], v[224:227], a[20:23]
    v_exp_f32 v129, v129
    v_mfma_f32_16x16x32_bf16 a[20:23], a[200:203], v[220:223], a[20:23]
    ds_read_b128 a[156:159], v4 offset:4096
    v_mfma_f32_16x16x32_bf16 a[24:27], a[200:203], v[228:231], a[24:27]
    v_exp_f32 v130, v130
    v_mfma_f32_16x16x32_bf16 a[24:27], a[204:207], v[232:235], a[24:27]
    v_cvt_pk_bf16_f32 v204, v128, v129
    v_mfma_f32_16x16x32_bf16 a[28:31], a[204:207], v[240:243], a[28:31]
    v_exp_f32 v131, v131
    v_mfma_f32_16x16x32_bf16 a[28:31], a[200:203], v[236:239], a[28:31]
    buffer_load_dwordx4 v16, s[8:11], s28 offen offset:3072 lds
    v_smfmac_f32_16x16x64_bf16 a[224:227], v[244:247], v[212:219], v248
    s_waitcnt lgkmcnt(6)
    v_mfma_f32_16x16x32_bf16 v[124:127], a[128:131], v[68:71], v[108:111]
    s_cmp_eq_u32 s36, 0
    s_cbranch_scc1 L_site0
L_site_back0:
    v_exp_f32 v132, v132
    v_mfma_f32_16x16x32_bf16 v[124:127], a[132:135], v[72:75], v[124:127]
    ds_read_b64_tr_b16 a[192:193], v9 offset:16384
    v_cvt_pk_bf16_f32 v205, v130, v131
    v_mfma_f32_16x16x32_bf16 v[124:127], a[136:139], v[76:79], v[124:127]
    v_exp_f32 v133, v133
    v_mfma_f32_16x16x32_bf16 v[124:127], a[140:143], v[80:83], v[124:127]
    ds_read_b64_tr_b16 a[194:195], v9 offset:20480
    v_mfma_f32_16x16x32_bf16 v[128:131], a[140:143], v[96:99], v[112:115]
    v_exp_f32 v134, v134
    v_mfma_f32_16x16x32_bf16 v[128:131], a[136:139], v[92:95], v[128:131]
    ds_read_b128 a[160:163], v1 offset:8192
    v_cvt_pk_bf16_f32 v182, v132, v133
    v_mfma_f32_16x16x32_bf16 v[128:131], a[132:135], v[88:91], v[128:131]
    v_exp_f32 v135, v135
    v_mfma_f32_16x16x32_bf16 v[128:131], a[128:131], v[84:87], v[128:131]
    ds_read_b64_tr_b16 a[196:197], v9 offset:40960
    v_mfma_f32_16x16x32_bf16 a[32:35], a[208:211], v[212:215], a[32:35]
    v_exp_f32 v136, v136
    v_mfma_f32_16x16x32_bf16 a[32:35], a[212:215], v[216:219], a[32:35]
    ds_read_b64_tr_b16 a[198:199], v9 offset:45056
    v_cvt_pk_bf16_f32 v183, v134, v135
    v_mfma_f32_16x16x32_bf16 a[36:39], a[212:215], v[224:227], a[36:39]
    v_exp_f32 v137, v137
    v_mfma_f32_16x16x32_bf16 a[36:39], a[208:211], v[220:223], a[36:39]
    ds_read_b128 a[164:167], v2 offset:8192
    v_cvt_pk_bf16_f32 v190, v136, v137
    v_mfma_f32_16x16x32_bf16 a[40:43], a[208:211], v[228:231], a[40:43]
    s_add_u32 s28, s28, 16384
    s_mov_b32 m0, s33
    v_exp_f32 v138, v138
    v_mfma_f32_16x16x32_bf16 a[40:43], a[212:215], v[232:235], a[40:43]
    buffer_load_dwordx4 v17, s[12:15], s29 offen offset:0 lds
    v_mfma_f32_16x16x32_bf16 a[44:47], a[212:215], v[240:243], a[44:47]
    v_exp_f32 v139, v139
    v_mfma_f32_16x16x32_bf16 a[44:47], a[208:211], v[236:239], a[44:47]
    s_waitcnt lgkmcnt(6)
    v_mfma_f32_16x16x32_bf16 v[132:135], a[144:147], v[36:39], v[100:103]
    v_exp_f32 v140, v140
    v_mfma_f32_16x16x32_bf16 v[132:135], a[148:151], v[40:43], v[132:135]
    ds_read_b64_tr_b16 a[200:201], v10 offset:16384
    v_cvt_pk_bf16_f32 v191, v138, v139
    v_mfma_f32_16x16x32_bf16 v[132:135], a[152:155], v[44:47], v[132:135]
    v_exp_f32 v141, v141
    v_mfma_f32_16x16x32_bf16 v[132:135], a[156:159], v[48:51], v[132:135]
    ds_read_b64_tr_b16 a[202:203], v10 offset:20480
    v_mfma_f32_16x16x32_bf16 v[136:139], a[156:159], v[64:67], v[104:107]
    v_exp_f32 v142, v142
    v_mfma_f32_16x16x32_bf16 v[136:139], a[152:155], v[60:63], v[136:139]
    ds_read_b128 a[168:171], v3 offset:8192
    v_cvt_pk_bf16_f32 v198, v140, v141
    v_mfma_f32_16x16x32_bf16 v[136:139], a[148:151], v[56:59], v[136:139]
    v_exp_f32 v143, v143
    v_mfma_f32_16x16x32_bf16 v[136:139], a[144:147], v[52:55], v[136:139]
    ds_read_b64_tr_b16 a[204:205], v10 offset:40960
    v_mfma_f32_16x16x32_bf16 a[48:51], a[216:219], v[212:215], a[48:51]
    v_exp_f32 v144, v144
    v_mfma_f32_16x16x32_bf16 a[48:51], a[220:223], v[216:219], a[48:51]
    ds_read_b64_tr_b16 a[206:207], v10 offset:45056
    v_cvt_pk_bf16_f32 v199, v142, v143
    v_mfma_f32_16x16x32_bf16 a[52:55], a[220:223], v[224:227], a[52:55]
    v_exp_f32 v145, v145
    v_mfma_f32_16x16x32_bf16 a[52:55], a[216:219], v[220:223], a[52:55]
    ds_read_b128 a[172:175], v4 offset:8192
    v_mfma_f32_16x16x32_bf16 a[56:59], a[216:219], v[228:231], a[56:59]
    v_exp_f32 v146, v146
    v_mfma_f32_16x16x32_bf16 a[56:59], a[220:223], v[232:235], a[56:59]
    v_cvt_pk_bf16_f32 v206, v144, v145
    v_mfma_f32_16x16x32_bf16 a[60:63], a[220:223], v[240:243], a[60:63]
    v_exp_f32 v147, v147
    v_mfma_f32_16x16x32_bf16 a[60:63], a[216:219], v[236:239], a[60:63]
    buffer_load_dwordx4 v18, s[12:15], s29 offen offset:1024 lds
    v_smfmac_f32_16x16x64_bf16 a[228:231], v[244:247], v[220:227], v248
    s_waitcnt lgkmcnt(6)
    v_mfma_f32_16x16x32_bf16 v[140:143], a[144:147], v[68:71], v[108:111]
    v_exp_f32 v148, v148
    v_mfma_f32_16x16x32_bf16 v[140:143], a[148:151], v[72:75], v[140:143]
    ds_read_b64_tr_b16 a[208:209], v11 offset:16384
    v_cvt_pk_bf16_f32 v207, v146, v147
    v_mfma_f32_16x16x32_bf16 v[140:143], a[152:155], v[76:79], v[140:143]
    v_exp_f32 v149, v149
    v_mfma_f32_16x16x32_bf16 v[140:143], a[156:159], v[80:83], v[140:143]
    ds_read_b64_tr_b16 a[210:211], v11 offset:20480
    v_mfma_f32_16x16x32_bf16 v[144:147], a[156:159], v[96:99], v[112:115]
    v_exp_f32 v150, v150
    v_mfma_f32_16x16x32_bf16 v[144:147], a[152:155], v[92:95], v[144:147]
    ds_read_b128 a[176:179], v1 offset:12288
    v_cvt_pk_bf16_f32 v184, v148, v149
    v_mfma_f32_16x16x32_bf16 v[144:147], a[148:151], v[88:91], v[144:147]
    v_exp_f32 v151, v151
    v_mfma_f32_16x16x32_bf16 v[144:147], a[144:147], v[84:87], v[144:147]
    ds_read_b64_tr_b16 a[212:213], v11 offset:40960
    v_mfma_f32_16x16x32_bf16 a[64:67], a[192:195], v[212:215], a[64:67]
    v_exp_f32 v152, v152
    v_mfma_f32_16x16x32_bf16 a[64:67], a[196:199], v[216:219], a[64:67]
    ds_read_b64_tr_b16 a[214:215], v11 offset:45056
    v_cvt_pk_bf16_f32 v185, v150, v151
    v_mfma_f32_16x16x32_bf16 a[68:71], a[196:199], v[224:227], a[68:71]
    v_exp_f32 v153, v153
    v_mfma_f32_16x16x32_bf16 a[68:71], a[192:195], v[220:223], a[68:71]
    ds_read_b128 a[180:183], v2 offset:12288
    v_cvt_pk_bf16_f32 v192, v152, v153
    v_mfma_f32_16x16x32_bf16 a[72:75], a[192:195], v[228:231], a[72:75]
    v_exp_f32 v154, v154
    v_mfma_f32_16x16x32_bf16 a[72:75], a[196:199], v[232:235], a[72:75]
    buffer_load_dwordx4 v17, s[12:15], s29 offen offset:2048 lds
    v_mfma_f32_16x16x32_bf16 a[76:79], a[196:199], v[240:243], a[76:79]
    v_exp_f32 v155, v155
    v_mfma_f32_16x16x32_bf16 a[76:79], a[192:195], v[236:239], a[76:79]
    s_waitcnt lgkmcnt(6)
    v_mfma_f32_16x16x32_bf16 v[148:151], a[160:163], v[36:39], v[100:103]
    v_exp_f32 v156, v156
    v_mfma_f32_16x16x32_bf16 v[148:151], a[164:167], v[40:43], v[148:151]
    ds_read_b64_tr_b16 a[216:217], v12 offset:16384
    v_cvt_pk_bf16_f32 v193, v154, v155
    v_mfma_f32_16x16x32_bf16 v[148:151], a[168:171], v[44:47], v[148:151]
    v_exp_f32 v157, v157
    v_mfma_f32_16x16x32_bf16 v[148:151], a[172:175], v[48:51], v[148:151]
    ds_read_b64_tr_b16 a[218:219], v12 offset:20480
    v_mfma_f32_16x16x32_bf16 v[152:155], a[172:175], v[64:67], v[104:107]
    v_exp_f32 v158, v158
    v_mfma_f32_16x16x32_bf16 v[152:155], a[168:171], v[60:63], v[152:155]
    ds_read_b128 a[184:187], v3 offset:12288
    v_cvt_pk_bf16_f32 v200, v156, v157
    v_mfma_f32_16x16x32_bf16 v[152:155], a[164:167], v[56:59], v[152:155]
    v_exp_f32 v159, v159
    v_mfma_f32_16x16x32_bf16 v[152:155], a[160:163], v[52:55], v[152:155]
    ds_read_b64_tr_b16 a[220:221], v12 offset:40960
    v_mfma_f32_16x16x32_bf16 a[80:83], a[200:203], v[212:215], a[80:83]
    v_exp_f32 v160, v160
    v_mfma_f32_16x16x32_bf16 a[80:83], a[204:207], v[216:219], a[80:83]
    ds_read_b64_tr_b16 a[222:223], v12 offset:45056
    v_cvt_pk_bf16_f32 v201, v158, v159
    v_mfma_f32_16x16x32_bf16 a[84:87], a[204:207], v[224:227], a[84:87]
    v_exp_f32 v161, v161
    v_mfma_f32_16x16x32_bf16 a[84:87], a[200:203], v[220:223], a[84:87]
    ds_read_b128 a[188:191], v4 offset:12288
    v_mfma_f32_16x16x32_bf16 a[88:91], a[200:203], v[228:231], a[88:91]
    v_exp_f32 v162, v162
    v_mfma_f32_16x16x32_bf16 a[88:91], a[204:207], v[232:235], a[88:91]
    v_cvt_pk_bf16_f32 v208, v160, v161
    v_mfma_f32_16x16x32_bf16 a[92:95], a[204:207], v[240:243], a[92:95]
    v_exp_f32 v163, v163
    v_mfma_f32_16x16x32_bf16 a[92:95], a[200:203], v[236:239], a[92:95]
    buffer_load_dwordx4 v18, s[12:15], s29 offen offset:3072 lds
    v_smfmac_f32_16x16x64_bf16 a[232:235], v[244:247], v[228:235], v248
    s_waitcnt vmcnt(8) lgkmcnt(6)
    s_barrier
    s_add_u32 s29, s29, 16384
    v_mfma_f32_16x16x32_bf16 v[156:159], a[160:163], v[68:71], v[108:111]
    v_exp_f32 v164, v164
    v_mfma_f32_16x16x32_bf16 v[156:159], a[164:167], v[72:75], v[156:159]
    ds_read_b64_tr_b16 a[192:193], v5 offset:57344
    v_cvt_pk_bf16_f32 v209, v162, v163
    v_mfma_f32_16x16x32_bf16 v[156:159], a[168:171], v[76:79], v[156:159]
    v_exp_f32 v165, v165
    v_mfma_f32_16x16x32_bf16 v[156:159], a[172:175], v[80:83], v[156:159]
    ds_read_b64_tr_b16 a[194:195], v5 offset:61440
    v_mfma_f32_16x16x32_bf16 v[160:163], a[172:175], v[96:99], v[112:115]
    v_exp_f32 v166, v166
    v_mfma_f32_16x16x32_bf16 v[160:163], a[168:171], v[92:95], v[160:163]
    ds_read_b128 a[128:131], v1 offset:49152
    v_cvt_pk_bf16_f32 v186, v164, v165
    v_mfma_f32_16x16x32_bf16 v[160:163], a[164:167], v[88:91], v[160:163]
    v_exp_f32 v167, v167
    v_mfma_f32_16x16x32_bf16 v[160:163], a[160:163], v[84:87], v[160:163]
    ds_read_b64_tr_b16 a[196:197], v5 offset:0
    v_mfma_f32_16x16x32_bf16 a[96:99], a[208:211], v[212:215], a[96:99]
    v_exp_f32 v168, v168
    v_mfma_f32_16x16x32_bf16 a[96:99], a[212:215], v[216:219], a[96:99]
    ds_read_b64_tr_b16 a[198:199], v5 offset:4096
    v_cvt_pk_bf16_f32 v187, v166, v167
    v_mfma_f32_16x16x32_bf16 a[100:103], a[212:215], v[224:227], a[100:103]
    v_exp_f32 v169, v169
    v_mfma_f32_16x16x32_bf16 a[100:103], a[208:211], v[220:223], a[100:103]
    ds_read_b128 a[132:135], v2 offset:49152
    v_cvt_pk_bf16_f32 v194, v168, v169
    v_mfma_f32_16x16x32_bf16 a[104:107], a[208:211], v[228:231], a[104:107]
    s_add_u32 m0, s34, 32768
    v_exp_f32 v170, v170
    v_mfma_f32_16x16x32_bf16 a[104:107], a[212:215], v[232:235], a[104:107]
    buffer_load_dwordx4 v13, s[8:11], s28 offen offset:0 lds
    v_mfma_f32_16x16x32_bf16 a[108:111], a[212:215], v[240:243], a[108:111]
    v_exp_f32 v171, v171
    v_mfma_f32_16x16x32_bf16 a[108:111], a[208:211], v[236:239], a[108:111]
    s_waitcnt lgkmcnt(6)
    v_mfma_f32_16x16x32_bf16 v[164:167], a[176:179], v[36:39], v[100:103]
    v_exp_f32 v172, v172
    v_mfma_f32_16x16x32_bf16 v[164:167], a[180:183], v[40:43], v[164:167]
    ds_read_b64_tr_b16 a[200:201], v6 offset:57344
    v_cvt_pk_bf16_f32 v195, v170, v171
    v_mfma_f32_16x16x32_bf16 v[164:167], a[184:187], v[44:47], v[164:167]
    v_exp_f32 v173, v173
    v_mfma_f32_16x16x32_bf16 v[164:167], a[188:191], v[48:51], v[164:167]
    ds_read_b64_tr_b16 a[202:203], v6 offset:61440
    v_mfma_f32_16x16x32_bf16 v[168:171], a[188:191], v[64:67], v[104:107]
    v_exp_f32 v174, v174
    v_mfma_f32_16x16x32_bf16 v[168:171], a[184:187], v[60:63], v[168:171]
    ds_read_b128 a[136:139], v3 offset:49152
    v_cvt_pk_bf16_f32 v202, v172, v173
    v_mfma_f32_16x16x32_bf16 v[168:171], a[180:183], v[56:59], v[168:171]
    v_exp_f32 v175, v175
    v_mfma_f32_16x16x32_bf16 v[168:171], a[176:179], v[52:55], v[168:171]
    ds_read_b64_tr_b16 a[204:205], v6 offset:0
    v_mfma_f32_16x16x32_bf16 a[112:115], a[216:219], v[212:215], a[112:115]
    v_exp_f32 v176, v176
    v_mfma_f32_16x16x32_bf16 a[112:115], a[220:223], v[216:219], a[112:115]
    ds_read_b64_tr_b16 a[206:207], v6 offset:4096
    v_cvt_pk_bf16_f32 v203, v174, v175
    v_mfma_f32_16x16x32_bf16 a[116:119], a[220:223], v[224:227], a[116:119]
    v_exp_f32 v177, v177
    v_mfma_f32_16x16x32_bf16 a[116:119], a[216:219], v[220:223], a[116:119]
    ds_read_b128 a[140:143], v4 offset:49152
    v_mfma_f32_16x16x32_bf16 a[120:123], a[216:219], v[228:231], a[120:123]
    v_exp_f32 v178, v178
    v_mfma_f32_16x16x32_bf16 a[120:123], a[220:223], v[232:235], a[120:123]
    v_cvt_pk_bf16_f32 v210, v176, v177
    v_mfma_f32_16x16x32_bf16 a[124:127], a[220:223], v[240:243], a[124:127]
    v_exp_f32 v179, v179
    v_mfma_f32_16x16x32_bf16 a[124:127], a[216:219], v[236:239], a[124:127]
    buffer_load_dwordx4 v14, s[8:11], s28 offen offset:1024 lds
    v_smfmac_f32_16x16x64_bf16 a[236:239], v[244:247], v[236:243], v248
    s_waitcnt lgkmcnt(6)
    v_mfma_f32_16x16x32_bf16 v[172:175], a[176:179], v[68:71], v[108:111]
    v_exp_f32 v116, v116
    v_mfma_f32_16x16x32_bf16 v[172:175], a[180:183], v[72:75], v[172:175]
    ds_read_b64_tr_b16 a[208:209], v7 offset:57344
    v_cvt_pk_bf16_f32 v211, v178, v179
    v_mfma_f32_16x16x32_bf16 v[172:175], a[184:187], v[76:79], v[172:175]
    v_exp_f32 v117, v117
    v_mfma_f32_16x16x32_bf16 v[172:175], a[188:191], v[80:83], v[172:175]
    ds_read_b64_tr_b16 a[210:211], v7 offset:61440
    v_mfma_f32_16x16x32_bf16 v[176:179], a[188:191], v[96:99], v[112:115]
    v_exp_f32 v118, v118
    v_mfma_f32_16x16x32_bf16 v[176:179], a[184:187], v[92:95], v[176:179]
    ds_read_b128 a[144:147], v1 offset:53248
    v_cvt_pk_bf16_f32 v212, v116, v117
    v_mfma_f32_16x16x32_bf16 v[176:179], a[180:183], v[88:91], v[176:179]
    v_exp_f32 v119, v119
    v_mfma_f32_16x16x32_bf16 v[176:179], a[176:179], v[84:87], v[176:179]
    ds_read_b64_tr_b16 a[212:213], v7 offset:0
    v_mfma_f32_16x16x32_bf16 a[0:3], a[192:195], v[180:183], a[0:3]
    v_exp_f32 v120, v120
    v_mfma_f32_16x16x32_bf16 a[0:3], a[196:199], v[184:187], a[0:3]
    ds_read_b64_tr_b16 a[214:215], v7 offset:4096
    v_cvt_pk_bf16_f32 v213, v118, v119
    v_mfma_f32_16x16x32_bf16 a[4:7], a[196:199], v[192:195], a[4:7]
    v_exp_f32 v121, v121
    v_mfma_f32_16x16x32_bf16 a[4:7], a[192:195], v[188:191], a[4:7]
    ds_read_b128 a[148:151], v2 offset:53248
    v_cvt_pk_bf16_f32 v220, v120, v121
    v_mfma_f32_16x16x32_bf16 a[8:11], a[192:195], v[196:199], a[8:11]
    v_exp_f32 v122, v122
    v_mfma_f32_16x16x32_bf16 a[8:11], a[196:199], v[200:203], a[8:11]
    buffer_load_dwordx4 v15, s[8:11], s28 offen offset:2048 lds
    v_mfma_f32_16x16x32_bf16 a[12:15], a[196:199], v[208:211], a[12:15]
    v_exp_f32 v123, v123
    v_mfma_f32_16x16x32_bf16 a[12:15], a[192:195], v[204:207], a[12:15]
    s_waitcnt lgkmcnt(6)
    v_mfma_f32_16x16x32_bf16 v[116:119], a[128:131], v[36:39], v[100:103]
    v_exp_f32 v124, v124
    v_mfma_f32_16x16x32_bf16 v[116:119], a[132:135], v[40:43], v[116:119]
    ds_read_b64_tr_b16 a[216:217], v8 offset:57344
    v_cvt_pk_bf16_f32 v221, v122, v123
    v_mfma_f32_16x16x32_bf16 v[116:119], a[136:139], v[44:47], v[116:119]
    v_exp_f32 v125, v125
    v_mfma_f32_16x16x32_bf16 v[116:119], a[140:143], v[48:51], v[116:119]
    ds_read_b64_tr_b16 a[218:219], v8 offset:61440
    v_mfma_f32_16x16x32_bf16 v[120:123], a[140:143], v[64:67], v[104:107]
    v_exp_f32 v126, v126
    v_mfma_f32_16x16x32_bf16 v[120:123], a[136:139], v[60:63], v[120:123]
    ds_read_b128 a[152:155], v3 offset:53248
    v_cvt_pk_bf16_f32 v228, v124, v125
    v_mfma_f32_16x16x32_bf16 v[120:123], a[132:135], v[56:59], v[120:123]
    v_exp_f32 v127, v127
    v_mfma_f32_16x16x32_bf16 v[120:123], a[128:131], v[52:55], v[120:123]
    ds_read_b64_tr_b16 a[220:221], v8 offset:0
    v_mfma_f32_16x16x32_bf16 a[16:19], a[200:203], v[180:183], a[16:19]
    v_exp_f32 v128, v128
    v_mfma_f32_16x16x32_bf16 a[16:19], a[204:207], v[184:187], a[16:19]
    ds_read_b64_tr_b16 a[222:223], v8 offset:4096
    v_cvt_pk_bf16_f32 v229, v126, v127
    v_mfma_f32_16x16x32_bf16 a[20:23], a[204:207], v[192:195], a[20:23]
    v_exp_f32 v129, v129
    v_mfma_f32_16x16x32_bf16 a[20:23], a[200:203], v[188:191], a[20:23]
    ds_read_b128 a[156:159], v4 offset:53248
    v_mfma_f32_16x16x32_bf16 a[24:27], a[200:203], v[196:199], a[24:27]
    v_exp_f32 v130, v130
    v_mfma_f32_16x16x32_bf16 a[24:27], a[204:207], v[200:203], a[24:27]
    v_cvt_pk_bf16_f32 v236, v128, v129
    v_mfma_f32_16x16x32_bf16 a[28:31], a[204:207], v[208:211], a[28:31]
    v_exp_f32 v131, v131
    v_mfma_f32_16x16x32_bf16 a[28:31], a[200:203], v[204:207], a[28:31]
    buffer_load_dwordx4 v16, s[8:11], s28 offen offset:3072 lds
    v_smfmac_f32_16x16x64_bf16 a[224:227], v[244:247], v[180:187], v248
    s_waitcnt lgkmcnt(6)
    v_mfma_f32_16x16x32_bf16 v[124:127], a[128:131], v[68:71], v[108:111]
    s_cmp_eq_u32 s36, 1
    s_cbranch_scc1 L_site1
L_site_back1:
    v_exp_f32 v132, v132
    v_mfma_f32_16x16x32_bf16 v[124:127], a[132:135], v[72:75], v[124:127]
    ds_read_b64_tr_b16 a[192:193], v9 offset:57344
    v_cvt_pk_bf16_f32 v237, v130, v131
    v_mfma_f32_16x16x32_bf16 v[124:127], a[136:139], v[76:79], v[124:127]
    v_exp_f32 v133, v133
    v_mfma_f32_16x16x32_bf16 v[124:127], a[140:143], v[80:83], v[124:127]
    ds_read_b64_tr_b16 a[194:195], v9 offset:61440
    v_mfma_f32_16x16x32_bf16 v[128:131], a[140:143], v[96:99], v[112:115]
    v_exp_f32 v134, v134
    v_mfma_f32_16x16x32_bf16 v[128:131], a[136:139], v[92:95], v[128:131]
    ds_read_b128 a[160:163], v1 offset:57344
    v_cvt_pk_bf16_f32 v214, v132, v133
    v_mfma_f32_16x16x32_bf16 v[128:131], a[132:135], v[88:91], v[128:131]
    v_exp_f32 v135, v135
    v_mfma_f32_16x16x32_bf16 v[128:131], a[128:131], v[84:87], v[128:131]
    ds_read_b64_tr_b16 a[196:197], v9 offset:0
    v_mfma_f32_16x16x32_bf16 a[32:35], a[208:211], v[180:183], a[32:35]
    v_exp_f32 v136, v136
    v_mfma_f32_16x16x32_bf16 a[32:35], a[212:215], v[184:187], a[32:35]
    ds_read_b64_tr_b16 a[198:199], v9 offset:4096
    v_cvt_pk_bf16_f32 v215, v134, v135
    v_mfma_f32_16x16x32_bf16 a[36:39], a[212:215], v[192:195], a[36:39]
    v_exp_f32 v137, v137
    v_mfma_f32_16x16x32_bf16 a[36:39], a[208:211], v[188:191], a[36:39]
    ds_read_b128 a[164:167], v2 offset:57344
    v_cvt_pk_bf16_f32 v222, v136, v137
    v_mfma_f32_16x16x32_bf16 a[40:43], a[208:211], v[196:199], a[40:43]
    s_add_u32 s28, s28, 16384
    s_mov_b32 m0, s30
    v_exp_f32 v138, v138
    v_mfma_f32_16x16x32_bf16 a[40:43], a[212:215], v[200:203], a[40:43]
    buffer_load_dwordx4 v17, s[12:15], s29 offen offset:0 lds
    v_mfma_f32_16x16x32_bf16 a[44:47], a[212:215], v[208:211], a[44:47]
    v_exp_f32 v139, v139
    v_mfma_f32_16x16x32_bf16 a[44:47], a[208:211], v[204:207], a[44:47]
    s_waitcnt lgkmcnt(6)
    v_mfma_f32_16x16x32_bf16 v[132:135], a[144:147], v[36:39], v[100:103]
    v_exp_f32 v140, v140
    v_mfma_f32_16x16x32_bf16 v[132:135], a[148:151], v[40:43], v[132:135]
    ds_read_b64_tr_b16 a[200:201], v10 offset:57344
    v_cvt_pk_bf16_f32 v223, v138, v139
    v_mfma_f32_16x16x32_bf16 v[132:135], a[152:155], v[44:47], v[132:135]
    v_exp_f32 v141, v141
    v_mfma_f32_16x16x32_bf16 v[132:135], a[156:159], v[48:51], v[132:135]
    ds_read_b64_tr_b16 a[202:203], v10 offset:61440
    v_mfma_f32_16x16x32_bf16 v[136:139], a[156:159], v[64:67], v[104:107]
    v_exp_f32 v142, v142
    v_mfma_f32_16x16x32_bf16 v[136:139], a[152:155], v[60:63], v[136:139]
    ds_read_b128 a[168:171], v3 offset:57344
    v_cvt_pk_bf16_f32 v230, v140, v141
    v_mfma_f32_16x16x32_bf16 v[136:139], a[148:151], v[56:59], v[136:139]
    v_exp_f32 v143, v143
    v_mfma_f32_16x16x32_bf16 v[136:139], a[144:147], v[52:55], v[136:139]
    ds_read_b64_tr_b16 a[204:205], v10 offset:0
    v_mfma_f32_16x16x32_bf16 a[48:51], a[216:219], v[180:183], a[48:51]
    v_exp_f32 v144, v144
    v_mfma_f32_16x16x32_bf16 a[48:51], a[220:223], v[184:187], a[48:51]
    ds_read_b64_tr_b16 a[206:207], v10 offset:4096
    v_cvt_pk_bf16_f32 v231, v142, v143
    v_mfma_f32_16x16x32_bf16 a[52:55], a[220:223], v[192:195], a[52:55]
    v_exp_f32 v145, v145
    v_mfma_f32_16x16x32_bf16 a[52:55], a[216:219], v[188:191], a[52:55]
    ds_read_b128 a[172:175], v4 offset:57344
    v_mfma_f32_16x16x32_bf16 a[56:59], a[216:219], v[196:199], a[56:59]
    v_exp_f32 v146, v146
    v_mfma_f32_16x16x32_bf16 a[56:59], a[220:223], v[200:203], a[56:59]
    v_cvt_pk_bf16_f32 v238, v144, v145
    v_mfma_f32_16x16x32_bf16 a[60:63], a[220:223], v[208:211], a[60:63]
    v_exp_f32 v147, v147
    v_mfma_f32_16x16x32_bf16 a[60:63], a[216:219], v[204:207], a[60:63]
    buffer_load_dwordx4 v18, s[12:15], s29 offen offset:1024 lds
    v_smfmac_f32_16x16x64_bf16 a[228:231], v[244:247], v[188:195], v248
    s_waitcnt lgkmcnt(6)
    v_mfma_f32_16x16x32_bf16 v[140:143], a[144:147], v[68:71], v[108:111]
    v_exp_f32 v148, v148
    v_mfma_f32_16x16x32_bf16 v[140:143], a[148:151], v[72:75], v[140:143]
    ds_read_b64_tr_b16 a[208:209], v11 offset:57344
    v_cvt_pk_bf16_f32 v239, v146, v147
    v_mfma_f32_16x16x32_bf16 v[140:143], a[152:155], v[76:79], v[140:143]
    v_exp_f32 v149, v149
    v_mfma_f32_16x16x32_bf16 v[140:143], a[156:159], v[80:83], v[140:143]
    ds_read_b64_tr_b16 a[210:211], v11 offset:61440
    v_mfma_f32_16x16x32_bf16 v[144:147], a[156:159], v[96:99], v[112:115]
    v_exp_f32 v150, v150
    v_mfma_f32_16x16x32_bf16 v[144:147], a[152:155], v[92:95], v[144:147]
    ds_read_b128 a[176:179], v1 offset:61440
    v_cvt_pk_bf16_f32 v216, v148, v149
    v_mfma_f32_16x16x32_bf16 v[144:147], a[148:151], v[88:91], v[144:147]
    v_exp_f32 v151, v151
    v_mfma_f32_16x16x32_bf16 v[144:147], a[144:147], v[84:87], v[144:147]
    ds_read_b64_tr_b16 a[212:213], v11 offset:0
    v_mfma_f32_16x16x32_bf16 a[64:67], a[192:195], v[180:183], a[64:67]
    v_exp_f32 v152, v152
    v_mfma_f32_16x16x32_bf16 a[64:67], a[196:199], v[184:187], a[64:67]
    ds_read_b64_tr_b16 a[214:215], v11 offset:4096
    v_cvt_pk_bf16_f32 v217, v150, v151
    v_mfma_f32_16x16x32_bf16 a[68:71], a[196:199], v[192:195], a[68:71]
    v_exp_f32 v153, v153
    v_mfma_f32_16x16x32_bf16 a[68:71], a[192:195], v[188:191], a[68:71]
    ds_read_b128 a[180:183], v2 offset:61440
    v_cvt_pk_bf16_f32 v224, v152, v153
    v_mfma_f32_16x16x32_bf16 a[72:75], a[192:195], v[196:199], a[72:75]
    v_exp_f32 v154, v154
    v_mfma_f32_16x16x32_bf16 a[72:75], a[196:199], v[200:203], a[72:75]
    buffer_load_dwordx4 v17, s[12:15], s29 offen offset:2048 lds
    v_mfma_f32_16x16x32_bf16 a[76:79], a[196:199], v[208:211], a[76:79]
    v_exp_f32 v155, v155
    v_mfma_f32_16x16x32_bf16 a[76:79], a[192:195], v[204:207], a[76:79]
    s_waitcnt lgkmcnt(6)
    v_mfma_f32_16x16x32_bf16 v[148:151], a[160:163], v[36:39], v[100:103]
    v_exp_f32 v156, v156
    v_mfma_f32_16x16x32_bf16 v[148:151], a[164:167], v[40:43], v[148:151]
    ds_read_b64_tr_b16 a[216:217], v12 offset:57344
    v_cvt_pk_bf16_f32 v225, v154, v155
    v_mfma_f32_16x16x32_bf16 v[148:151], a[168:171], v[44:47], v[148:151]
    v_exp_f32 v157, v157
    v_mfma_f32_16x16x32_bf16 v[148:151], a[172:175], v[48:51], v[148:151]
    ds_read_b64_tr_b16 a[218:219], v12 offset:61440
    v_mfma_f32_16x16x32_bf16 v[152:155], a[172:175], v[64:67], v[104:107]
    v_exp_f32 v158, v158
    v_mfma_f32_16x16x32_bf16 v[152:155], a[168:171], v[60:63], v[152:155]
    ds_read_b128 a[184:187], v3 offset:61440
    v_cvt_pk_bf16_f32 v232, v156, v157
    v_mfma_f32_16x16x32_bf16 v[152:155], a[164:167], v[56:59], v[152:155]
    v_exp_f32 v159, v159
    v_mfma_f32_16x16x32_bf16 v[152:155], a[160:163], v[52:55], v[152:155]
    ds_read_b64_tr_b16 a[220:221], v12 offset:0
    v_mfma_f32_16x16x32_bf16 a[80:83], a[200:203], v[180:183], a[80:83]
    v_exp_f32 v160, v160
    v_mfma_f32_16x16x32_bf16 a[80:83], a[204:207], v[184:187], a[80:83]
    ds_read_b64_tr_b16 a[222:223], v12 offset:4096
    v_cvt_pk_bf16_f32 v233, v158, v159
    v_mfma_f32_16x16x32_bf16 a[84:87], a[204:207], v[192:195], a[84:87]
    v_exp_f32 v161, v161
    v_mfma_f32_16x16x32_bf16 a[84:87], a[200:203], v[188:191], a[84:87]
    ds_read_b128 a[188:191], v4 offset:61440
    v_mfma_f32_16x16x32_bf16 a[88:91], a[200:203], v[196:199], a[88:91]
    v_exp_f32 v162, v162
    v_mfma_f32_16x16x32_bf16 a[88:91], a[204:207], v[200:203], a[88:91]
    v_cvt_pk_bf16_f32 v240, v160, v161
    v_mfma_f32_16x16x32_bf16 a[92:95], a[204:207], v[208:211], a[92:95]
    v_exp_f32 v163, v163
    v_mfma_f32_16x16x32_bf16 a[92:95], a[200:203], v[204:207], a[92:95]
    buffer_load_dwordx4 v18, s[12:15], s29 offen offset:3072 lds
    v_smfmac_f32_16x16x64_bf16 a[232:235], v[244:247], v[196:203], v248
    s_waitcnt vmcnt(8) lgkmcnt(6)
    s_barrier
    s_add_u32 s29, s29, 16384
    v_mfma_f32_16x16x32_bf16 v[156:159], a[160:163], v[68:71], v[108:111]
    v_exp_f32 v164, v164
    v_mfma_f32_16x16x32_bf16 v[156:159], a[164:167], v[72:75], v[156:159]
    ds_read_b64_tr_b16 a[192:193], v5 offset:24576
    v_cvt_pk_bf16_f32 v241, v162, v163
    v_mfma_f32_16x16x32_bf16 v[156:159], a[168:171], v[76:79], v[156:159]
    v_exp_f32 v165, v165
    v_mfma_f32_16x16x32_bf16 v[156:159], a[172:175], v[80:83], v[156:159]
    ds_read_b64_tr_b16 a[194:195], v5 offset:28672
    v_mfma_f32_16x16x32_bf16 v[160:163], a[172:175], v[96:99], v[112:115]
    v_exp_f32 v166, v166
    v_mfma_f32_16x16x32_bf16 v[160:163], a[168:171], v[92:95], v[160:163]
    ds_read_b128 a[128:131], v1 offset:16384
    v_cvt_pk_bf16_f32 v218, v164, v165
    v_mfma_f32_16x16x32_bf16 v[160:163], a[164:167], v[88:91], v[160:163]
    v_exp_f32 v167, v167
    v_mfma_f32_16x16x32_bf16 v[160:163], a[160:163], v[84:87], v[160:163]
    ds_read_b64_tr_b16 a[196:197], v5 offset:49152
    v_mfma_f32_16x16x32_bf16 a[96:99], a[208:211], v[180:183], a[96:99]
    v_exp_f32 v168, v168
    v_mfma_f32_16x16x32_bf16 a[96:99], a[212:215], v[184:187], a[96:99]
    ds_read_b64_tr_b16 a[198:199], v5 offset:53248
    v_cvt_pk_bf16_f32 v219, v166, v167
    v_mfma_f32_16x16x32_bf16 a[100:103], a[212:215], v[192:195], a[100:103]
    v_exp_f32 v169, v169
    v_mfma_f32_16x16x32_bf16 a[100:103], a[208:211], v[188:191], a[100:103]
    ds_read_b128 a[132:135], v2 offset:16384
    v_cvt_pk_bf16_f32 v226, v168, v169
    v_mfma_f32_16x16x32_bf16 a[104:107], a[208:211], v[196:199], a[104:107]
    s_add_u32 m0, s34, 0
    v_exp_f32 v170, v170
    v_mfma_f32_16x16x32_bf16 a[104:107], a[212:215], v[200:203], a[104:107]
    buffer_load_dwordx4 v13, s[8:11], s28 offen offset:0 lds
    v_mfma_f32_16x16x32_bf16 a[108:111], a[212:215], v[208:211], a[108:111]
    v_exp_f32 v171, v171
    v_mfma_f32_16x16x32_bf16 a[108:111], a[208:211], v[204:207], a[108:111]
    s_waitcnt lgkmcnt(6)
    v_mfma_f32_16x16x32_bf16 v[164:167], a[176:179], v[36:39], v[100:103]
    s_cmp_eq_u32 s59, s35
    s_cbranch_scc1 L_once_pack
L_once_back_pack:
    v_exp_f32 v172, v172
    v_mfma_f32_16x16x32_bf16 v[164:167], a[180:183], v[40:43], v[164:167]
    ds_read_b64_tr_b16 a[200:201], v6 offset:24576
    v_cvt_pk_bf16_f32 v227, v170, v171
    v_mfma_f32_16x16x32_bf16 v[164:167], a[184:187], v[44:47], v[164:167]
    v_exp_f32 v173, v173
    v_mfma_f32_16x16x32_bf16 v[164:167], a[188:191], v[48:51], v[164:167]
    ds_read_b64_tr_b16 a[202:203], v6 offset:28672
    v_mfma_f32_16x16x32_bf16 v[168:171], a[188:191], v[64:67], v[104:107]
    v_exp_f32 v174, v174
    v_mfma_f32_16x16x32_bf16 v[168:171], a[184:187], v[60:63], v[168:171]
    ds_read_b128 a[136:139], v3 offset:16384
    v_cvt_pk_bf16_f32 v234, v172, v173
    v_mfma_f32_16x16x32_bf16 v[168:171], a[180:183], v[56:59], v[168:171]
    v_exp_f32 v175, v175
    v_mfma_f32_16x16x32_bf16 v[168:171], a[176:179], v[52:55], v[168:171]
    ds_read_b64_tr_b16 a[204:205], v6 offset:49152
    v_mfma_f32_16x16x32_bf16 a[112:115], a[216:219], v[180:183], a[112:115]
    v_exp_f32 v176, v176
    v_mfma_f32_16x16x32_bf16 a[112:115], a[220:223], v[184:187], a[112:115]
    ds_read_b64_tr_b16 a[206:207], v6 offset:53248
    v_cvt_pk_bf16_f32 v235, v174, v175
    v_mfma_f32_16x16x32_bf16 a[116:119], a[220:223], v[192:195], a[116:119]
    v_exp_f32 v177, v177
    v_mfma_f32_16x16x32_bf16 a[116:119], a[216:219], v[188:191], a[116:119]
    ds_read_b128 a[140:143], v4 offset:16384
    v_mfma_f32_16x16x32_bf16 a[120:123], a[216:219], v[196:199], a[120:123]
    v_exp_f32 v178, v178
    v_mfma_f32_16x16x32_bf16 a[120:123], a[220:223], v[200:203], a[120:123]
    v_cvt_pk_bf16_f32 v242, v176, v177
    v_mfma_f32_16x16x32_bf16 a[124:127], a[220:223], v[208:211], a[124:127]
    v_exp_f32 v179, v179
    v_mfma_f32_16x16x32_bf16 a[124:127], a[216:219], v[204:207], a[124:127]
    buffer_load_dwordx4 v14, s[8:11], s28 offen offset:1024 lds
    v_smfmac_f32_16x16x64_bf16 a[236:239], v[244:247], v[204:211], v248
    s_waitcnt lgkmcnt(6)
    v_mfma_f32_16x16x32_bf16 v[172:175], a[176:179], v[68:71], v[108:111]
    v_exp_f32 v116, v116
    v_mfma_f32_16x16x32_bf16 v[172:175], a[180:183], v[72:75], v[172:175]
    ds_read_b64_tr_b16 a[208:209], v7 offset:24576
    v_cvt_pk_bf16_f32 v243, v178, v179
    v_mfma_f32_16x16x32_bf16 v[172:175], a[184:187], v[76:79], v[172:175]
    v_exp_f32 v117, v117
    v_mfma_f32_16x16x32_bf16 v[172:175], a[188:191], v[80:83], v[172:175]
    ds_read_b64_tr_b16 a[210:211], v7 offset:28672
    v_mfma_f32_16x16x32_bf16 v[176:179], a[188:191], v[96:99], v[112:115]
    v_exp_f32 v118, v118
    v_mfma_f32_16x16x32_bf16 v[176:179], a[184:187], v[92:95], v[176:179]
    ds_read_b128 a[144:147], v1 offset:20480
    v_cvt_pk_bf16_f32 v180, v116, v117
    v_mfma_f32_16x16x32_bf16 v[176:179], a[180:183], v[88:91], v[176:179]
    v_exp_f32 v119, v119
    v_mfma_f32_16x16x32_bf16 v[176:179], a[176:179], v[84:87], v[176:179]
    ds_read_b64_tr_b16 a[212:213], v7 offset:49152
    v_mfma_f32_16x16x32_bf16 a[0:3], a[192:195], v[212:215], a[0:3]
    v_exp_f32 v120, v120
    v_mfma_f32_16x16x32_bf16 a[0:3], a[196:199], v[216:219], a[0:3]
    ds_read_b64_tr_b16 a[214:215], v7 offset:53248
    v_cvt_pk_bf16_f32 v181, v118, v119
    v_mfma_f32_16x16x32_bf16 a[4:7], a[196:199], v[224:227], a[4:7]
    v_exp_f32 v121, v121
    v_mfma_f32_16x16x32_bf16 a[4:7], a[192:195], v[220:223], a[4:7]
    ds_read_b128 a[148:151], v2 offset:20480
    v_cvt_pk_bf16_f32 v188, v120, v121
    v_mfma_f32_16x16x32_bf16 a[8:11], a[192:195], v[228:231], a[8:11]
    v_exp_f32 v122, v122
    v_mfma_f32_16x16x32_bf16 a[8:11], a[196:199], v[232:235], a[8:11]
    buffer_load_dwordx4 v15, s[8:11], s28 offen offset:2048 lds
    v_mfma_f32_16x16x32_bf16 a[12:15], a[196:199], v[240:243], a[12:15]
    v_exp_f32 v123, v123
    v_mfma_f32_16x16x32_bf16 a[12:15], a[192:195], v[236:239], a[12:15]
    s_waitcnt lgkmcnt(6)
    v_mfma_f32_16x16x32_bf16 v[116:119], a[128:131], v[36:39], v[100:103]
    v_exp_f32 v124, v124
    v_mfma_f32_16x16x32_bf16 v[116:119], a[132:135], v[40:43], v[116:119]
    ds_read_b64_tr_b16 a[216:217], v8 offset:24576
    v_cvt_pk_bf16_f32 v189, v122, v123
    v_mfma_f32_16x16x32_bf16 v[116:119], a[136:139], v[44:47], v[116:119]
    v_exp_f32 v125, v125
    v_mfma_f32_16x16x32_bf16 v[116:119], a[140:143], v[48:51], v[116:119]
    ds_read_b64_tr_b16 a[218:219], v8 offset:28672
    v_mfma_f32_16x16x32_bf16 v[120:123], a[140:143], v[64:67], v[104:107]
    v_exp_f32 v126, v126
    v_mfma_f32_16x16x32_bf16 v[120:123], a[136:139], v[60:63], v[120:123]
    ds_read_b128 a[152:155], v3 offset:20480
    v_cvt_pk_bf16_f32 v196, v124, v125
    v_mfma_f32_16x16x32_bf16 v[120:123], a[132:135], v[56:59], v[120:123]
    v_exp_f32 v127, v127
    v_mfma_f32_16x16x32_bf16 v[120:123], a[128:131], v[52:55], v[120:123]
    ds_read_b64_tr_b16 a[220:221], v8 offset:49152
    v_mfma_f32_16x16x32_bf16 a[16:19], a[200:203], v[212:215], a[16:19]
    v_exp_f32 v128, v128
    v_mfma_f32_16x16x32_bf16 a[16:19], a[204:207], v[216:219], a[16:19]
    ds_read_b64_tr_b16 a[222:223], v8 offset:53248
    v_cvt_pk_bf16_f32 v197, v126, v127
    v_mfma_f32_16x16x32_bf16 a[20:23], a[204:207], v[224:227], a[20:23]
    v_exp_f32 v129, v129
    v_mfma_f32_16x16x32_bf16 a[20:23], a[200:203], v[220:223], a[20:23]
    ds_read_b128 a[156:159], v4 offset:20480
    v_mfma_f32_16x16x32_bf16 a[24:27], a[200:203], v[228:231], a[24:27]
    v_exp_f32 v130, v130
    v_mfma_f32_16x16x32_bf16 a[24:27], a[204:207], v[232:235], a[24:27]
    v_cvt_pk_bf16_f32 v204, v128, v129
    v_mfma_f32_16x16x32_bf16 a[28:31], a[204:207], v[240:243], a[28:31]
    v_exp_f32 v131, v131
    v_mfma_f32_16x16x32_bf16 a[28:31], a[200:203], v[236:239], a[28:31]
    buffer_load_dwordx4 v16, s[8:11], s28 offen offset:3072 lds
    v_smfmac_f32_16x16x64_bf16 a[224:227], v[244:247], v[212:219], v248
    s_waitcnt lgkmcnt(6)
    v_mfma_f32_16x16x32_bf16 v[124:127], a[128:131], v[68:71], v[108:111]
    s_cmp_eq_u32 s36, 2
    s_cbranch_scc1 L_site2
L_site_back2:
    v_exp_f32 v132, v132
    v_mfma_f32_16x16x32_bf16 v[124:127], a[132:135], v[72:75], v[124:127]
    ds_read_b64_tr_b16 a[192:193], v9 offset:24576
    v_cvt_pk_bf16_f32 v205, v130, v131
    v_mfma_f32_16x16x32_bf16 v[124:127], a[136:139], v[76:79], v[124:127]
    v_exp_f32 v133, v133
    v_mfma_f32_16x16x32_bf16 v[124:127], a[140:143], v[80:83], v[124:127]
    ds_read_b64_tr_b16 a[194:195], v9 offset:28672
    v_mfma_f32_16x16x32_bf16 v[128:131], a[140:143], v[96:99], v[112:115]
    v_exp_f32 v134, v134
    v_mfma_f32_16x16x32_bf16 v[128:131], a[136:139], v[92:95], v[128:131]
    ds_read_b128 a[160:163], v1 offset:24576
    v_cvt_pk_bf16_f32 v182, v132, v133
    v_mfma_f32_16x16x32_bf16 v[128:131], a[132:135], v[88:91], v[128:131]
    v_exp_f32 v135, v135
    v_mfma_f32_16x16x32_bf16 v[128:131], a[128:131], v[84:87], v[128:131]
    ds_read_b64_tr_b16 a[196:197], v9 offset:49152
    v_mfma_f32_16x16x32_bf16 a[32:35], a[208:211], v[212:215], a[32:35]
    v_exp_f32 v136, v136
    v_mfma_f32_16x16x32_bf16 a[32:35], a[212:215], v[216:219], a[32:35]
    ds_read_b64_tr_b16 a[198:199], v9 offset:53248
    v_cvt_pk_bf16_f32 v183, v134, v135
    v_mfma_f32_16x16x32_bf16 a[36:39], a[212:215], v[224:227], a[36:39]
    v_exp_f32 v137, v137
    v_mfma_f32_16x16x32_bf16 a[36:39], a[208:211], v[220:223], a[36:39]
    ds_read_b128 a[164:167], v2 offset:24576
    v_cvt_pk_bf16_f32 v190, v136, v137
    v_mfma_f32_16x16x32_bf16 a[40:43], a[208:211], v[228:231], a[40:43]
    s_add_u32 s28, s28, 16384
    s_mov_b32 m0, s31
    v_exp_f32 v138, v138
    v_mfma_f32_16x16x32_bf16 a[40:43], a[212:215], v[232:235], a[40:43]
    buffer_load_dwordx4 v17, s[12:15], s29 offen offset:0 lds
    v_mfma_f32_16x16x32_bf16 a[44:47], a[212:215], v[240:243], a[44:47]
    v_exp_f32 v139, v139
    v_mfma_f32_16x16x32_bf16 a[44:47], a[208:211], v[236:239], a[44:47]
    s_waitcnt lgkmcnt(6)
    v_mfma_f32_16x16x32_bf16 v[132:135], a[144:147], v[36:39], v[100:103]
    v_exp_f32 v140, v140
    v_mfma_f32_16x16x32_bf16 v[132:135], a[148:151], v[40:43], v[132:135]
    ds_read_b64_tr_b16 a[200:201], v10 offset:24576
    v_cvt_pk_bf16_f32 v191, v138, v139
    v_mfma_f32_16x16x32_bf16 v[132:135], a[152:155], v[44:47], v[132:135]
    v_exp_f32 v141, v141
    v_mfma_f32_16x16x32_bf16 v[132:135], a[156:159], v[48:51], v[132:135]
    ds_read_b64_tr_b16 a[202:203], v10 offset:28672
    v_mfma_f32_16x16x32_bf16 v[136:139], a[156:159], v[64:67], v[104:107]
    v_exp_f32 v142, v142
    v_mfma_f32_16x16x32_bf16 v[136:139], a[152:155], v[60:63], v[136:139]
    ds_read_b128 a[168:171], v3 offset:24576
    v_cvt_pk_bf16_f32 v198, v140, v141
    v_mfma_f32_16x16x32_bf16 v[136:139], a[148:151], v[56:59], v[136:139]
    v_exp_f32 v143, v143
    v_mfma_f32_16x16x32_bf16 v[136:139], a[144:147], v[52:55], v[136:139]
    ds_read_b64_tr_b16 a[204:205], v10 offset:49152
    v_mfma_f32_16x16x32_bf16 a[48:51], a[216:219], v[212:215], a[48:51]
    v_exp_f32 v144, v144
    v_mfma_f32_16x16x32_bf16 a[48:51], a[220:223], v[216:219], a[48:51]
    ds_read_b64_tr_b16 a[206:207], v10 offset:53248
    v_cvt_pk_bf16_f32 v199, v142, v143
    v_mfma_f32_16x16x32_bf16 a[52:55], a[220:223], v[224:227], a[52:55]
    v_exp_f32 v145, v145
    v_mfma_f32_16x16x32_bf16 a[52:55], a[216:219], v[220:223], a[52:55]
    ds_read_b128 a[172:175], v4 offset:24576
    v_mfma_f32_16x16x32_bf16 a[56:59], a[216:219], v[228:231], a[56:59]
    v_exp_f32 v146, v146
    v_mfma_f32_16x16x32_bf16 a[56:59], a[220:223], v[232:235], a[56:59]
    v_cvt_pk_bf16_f32 v206, v144, v145
    v_mfma_f32_16x16x32_bf16 a[60:63], a[220:223], v[240:243], a[60:63]
    v_exp_f32 v147, v147
    v_mfma_f32_16x16x32_bf16 a[60:63], a[216:219], v[236:239], a[60:63]
    buffer_load_dwordx4 v18, s[12:15], s29 offen offset:1024 lds
    v_smfmac_f32_16x16x64_bf16 a[228:231], v[244:247], v[220:227], v248
    s_waitcnt lgkmcnt(6)
    v_mfma_f32_16x16x32_bf16 v[140:143], a[144:147], v[68:71], v[108:111]
    v_exp_f32 v148, v148
    v_mfma_f32_16x16x32_bf16 v[140:143], a[148:151], v[72:75], v[140:143]
    ds_read_b64_tr_b16 a[208:209], v11 offset:24576
    v_cvt_pk_bf16_f32 v207, v146, v147
    v_mfma_f32_16x16x32_bf16 v[140:143], a[152:155], v[76:79], v[140:143]
    v_exp_f32 v149, v149
    v_mfma_f32_16x16x32_bf16 v[140:143], a[156:159], v[80:83], v[140:143]
    ds_read_b64_tr_b16 a[210:211], v11 offset:28672
    v_mfma_f32_16x16x32_bf16 v[144:147], a[156:159], v[96:99], v[112:115]
    v_exp_f32 v150, v150
    v_mfma_f32_16x16x32_bf16 v[144:147], a[152:155], v[92:95], v[144:147]
    ds_read_b128 a[176:179], v1 offset:28672
    v_cvt_pk_bf16_f32 v184, v148, v149
    v_mfma_f32_16x16x32_bf16 v[144:147], a[148:151], v[88:91], v[144:147]
    v_exp_f32 v151, v151
    v_mfma_f32_16x16x32_bf16 v[144:147], a[144:147], v[84:87], v[144:147]
    ds_read_b64_tr_b16 a[212:213], v11 offset:49152
    v_mfma_f32_16x16x32_bf16 a[64:67], a[192:195], v[212:215], a[64:67]
    v_exp_f32 v152, v152
    v_mfma_f32_16x16x32_bf16 a[64:67], a[196:199], v[216:219], a[64:67]
    ds_read_b64_tr_b16 a[214:215], v11 offset:53248
    v_cvt_pk_bf16_f32 v185, v150, v151
    v_mfma_f32_16x16x32_bf16 a[68:71], a[196:199], v[224:227], a[68:71]
    v_exp_f32 v153, v153
    v_mfma_f32_16x16x32_bf16 a[68:71], a[192:195], v[220:223], a[68:71]
    ds_read_b128 a[180:183], v2 offset:28672
    v_cvt_pk_bf16_f32 v192, v152, v153
    v_mfma_f32_16x16x32_bf16 a[72:75], a[192:195], v[228:231], a[72:75]
    v_exp_f32 v154, v154
    v_mfma_f32_16x16x32_bf16 a[72:75], a[196:199], v[232:235], a[72:75]
    buffer_load_dwordx4 v17, s[12:15], s29 offen offset:2048 lds
    v_mfma_f32_16x16x32_bf16 a[76:79], a[196:199], v[240:243], a[76:79]
    v_exp_f32 v155, v155
    v_mfma_f32_16x16x32_bf16 a[76:79], a[192:195], v[236:239], a[76:79]
    s_waitcnt lgkmcnt(6)
    v_mfma_f32_16x16x32_bf16 v[148:151], a[160:163], v[36:39], v[100:103]
    v_exp_f32 v156, v156
    v_mfma_f32_16x16x32_bf16 v[148:151], a[164:167], v[40:43], v[148:151]
    ds_read_b64_tr_b16 a[216:217], v12 offset:24576
    v_cvt_pk_bf16_f32 v193, v154, v155
    v_mfma_f32_16x16x32_bf16 v[148:151], a[168:171], v[44:47], v[148:151]
    v_exp_f32 v157, v157
    v_mfma_f32_16x16x32_bf16 v[148:151], a[172:175], v[48:51], v[148:151]
    ds_read_b64_tr_b16 a[218:219], v12 offset:28672
    v_mfma_f32_16x16x32_bf16 v[152:155], a[172:175], v[64:67], v[104:107]
    v_exp_f32 v158, v158
    v_mfma_f32_16x16x32_bf16 v[152:155], a[168:171], v[60:63], v[152:155]
    ds_read_b128 a[184:187], v3 offset:28672
    v_cvt_pk_bf16_f32 v200, v156, v157
    v_mfma_f32_16x16x32_bf16 v[152:155], a[164:167], v[56:59], v[152:155]
    v_exp_f32 v159, v159
    v_mfma_f32_16x16x32_bf16 v[152:155], a[160:163], v[52:55], v[152:155]
    ds_read_b64_tr_b16 a[220:221], v12 offset:49152
    v_mfma_f32_16x16x32_bf16 a[80:83], a[200:203], v[212:215], a[80:83]
    v_exp_f32 v160, v160
    v_mfma_f32_16x16x32_bf16 a[80:83], a[204:207], v[216:219], a[80:83]
    ds_read_b64_tr_b16 a[222:223], v12 offset:53248
    v_cvt_pk_bf16_f32 v201, v158, v159
    v_mfma_f32_16x16x32_bf16 a[84:87], a[204:207], v[224:227], a[84:87]
    v_exp_f32 v161, v161
    v_mfma_f32_16x16x32_bf16 a[84:87], a[200:203], v[220:223], a[84:87]
    ds_read_b128 a[188:191], v4 offset:28672
    v_mfma_f32_16x16x32_bf16 a[88:91], a[200:203], v[228:231], a[88:91]
    v_exp_f32 v162, v162
    v_mfma_f32_16x16x32_bf16 a[88:91], a[204:207], v[232:235], a[88:91]
    v_cvt_pk_bf16_f32 v208, v160, v161
    v_mfma_f32_16x16x32_bf16 a[92:95], a[204:207], v[240:243], a[92:95]
    v_exp_f32 v163, v163
    v_mfma_f32_16x16x32_bf16 a[92:95], a[200:203], v[236:239], a[92:95]
    buffer_load_dwordx4 v18, s[12:15], s29 offen offset:3072 lds
    v_smfmac_f32_16x16x64_bf16 a[232:235], v[244:247], v[228:235], v248
    s_waitcnt vmcnt(8) lgkmcnt(6)
    s_barrier
    s_add_u32 s29, s29, 16384
    v_mfma_f32_16x16x32_bf16 v[156:159], a[160:163], v[68:71], v[108:111]
    v_exp_f32 v164, v164
    v_mfma_f32_16x16x32_bf16 v[156:159], a[164:167], v[72:75], v[156:159]
    ds_read_b64_tr_b16 a[192:193], v5 offset:8192
    v_cvt_pk_bf16_f32 v209, v162, v163
    v_mfma_f32_16x16x32_bf16 v[156:159], a[168:171], v[76:79], v[156:159]
    v_exp_f32 v165, v165
    v_mfma_f32_16x16x32_bf16 v[156:159], a[172:175], v[80:83], v[156:159]
    ds_read_b64_tr_b16 a[194:195], v5 offset:12288
    v_mfma_f32_16x16x32_bf16 v[160:163], a[172:175], v[96:99], v[112:115]
    v_exp_f32 v166, v166
    v_mfma_f32_16x16x32_bf16 v[160:163], a[168:171], v[92:95], v[160:163]
    ds_read_b128 a[128:131], v1 offset:32768
    v_cvt_pk_bf16_f32 v186, v164, v165
    v_mfma_f32_16x16x32_bf16 v[160:163], a[164:167], v[88:91], v[160:163]
    v_exp_f32 v167, v167
    v_mfma_f32_16x16x32_bf16 v[160:163], a[160:163], v[84:87], v[160:163]
    ds_read_b64_tr_b16 a[196:197], v5 offset:32768
    v_mfma_f32_16x16x32_bf16 a[96:99], a[208:211], v[212:215], a[96:99]
    v_exp_f32 v168, v168
    v_mfma_f32_16x16x32_bf16 a[96:99], a[212:215], v[216:219], a[96:99]
    ds_read_b64_tr_b16 a[198:199], v5 offset:36864
    v_cvt_pk_bf16_f32 v187, v166, v167
    v_mfma_f32_16x16x32_bf16 a[100:103], a[212:215], v[224:227], a[100:103]
    v_exp_f32 v169, v169
    v_mfma_f32_16x16x32_bf16 a[100:103], a[208:211], v[220:223], a[100:103]
    ds_read_b128 a[132:135], v2 offset:32768
    v_cvt_pk_bf16_f32 v194, v168, v169
    v_mfma_f32_16x16x32_bf16 a[104:107], a[208:211], v[228:231], a[104:107]
    s_add_u32 m0, s34, 49152
    v_exp_f32 v170, v170
    v_mfma_f32_16x16x32_bf16 a[104:107], a[212:215], v[232:235], a[104:107]
    buffer_load_dwordx4 v13, s[8:11], s28 offen offset:0 lds
    v_mfma_f32_16x16x32_bf16 a[108:111], a[212:215], v[240:243], a[108:111]
    v_exp_f32 v171, v171
    v_mfma_f32_16x16x32_bf16 a[108:111], a[208:211], v[236:239], a[108:111]
    s_waitcnt lgkmcnt(6)
    v_mfma_f32_16x16x32_bf16 v[164:167], a[176:179], v[36:39], v[100:103]
    v_exp_f32 v172, v172
    v_mfma_f32_16x16x32_bf16 v[164:167], a[180:183], v[40:43], v[164:167]
    ds_read_b64_tr_b16 a[200:201], v6 offset:8192
    v_cvt_pk_bf16_f32 v195, v170, v171
    v_mfma_f32_16x16x32_bf16 v[164:167], a[184:187], v[44:47], v[164:167]
    v_exp_f32 v173, v173
    v_mfma_f32_16x16x32_bf16 v[164:167], a[188:191], v[48:51], v[164:167]
    ds_read_b64_tr_b16 a[202:203], v6 offset:12288
    v_mfma_f32_16x16x32_bf16 v[168:171], a[188:191], v[64:67], v[104:107]
    v_exp_f32 v174, v174
    v_mfma_f32_16x16x32_bf16 v[168:171], a[184:187], v[60:63], v[168:171]
    ds_read_b128 a[136:139], v3 offset:32768
    v_cvt_pk_bf16_f32 v202, v172, v173
    v_mfma_f32_16x16x32_bf16 v[168:171], a[180:183], v[56:59], v[168:171]
    v_exp_f32 v175, v175
    v_mfma_f32_16x16x32_bf16 v[168:171], a[176:179], v[52:55], v[168:171]
    ds_read_b64_tr_b16 a[204:205], v6 offset:32768
    v_mfma_f32_16x16x32_bf16 a[112:115], a[216:219], v[212:215], a[112:115]
    v_exp_f32 v176, v176
    v_mfma_f32_16x16x32_bf16 a[112:115], a[220:223], v[216:219], a[112:115]
    ds_read_b64_tr_b16 a[206:207], v6 offset:36864
    v_cvt_pk_bf16_f32 v203, v174, v175
    v_mfma_f32_16x16x32_bf16 a[116:119], a[220:223], v[224:227], a[116:119]
    v_exp_f32 v177, v177
    v_mfma_f32_16x16x32_bf16 a[116:119], a[216:219], v[220:223], a[116:119]
    ds_read_b128 a[140:143], v4 offset:32768
    v_mfma_f32_16x16x32_bf16 a[120:123], a[216:219], v[228:231], a[120:123]
    v_exp_f32 v178, v178
    v_mfma_f32_16x16x32_bf16 a[120:123], a[220:223], v[232:235], a[120:123]
    v_cvt_pk_bf16_f32 v210, v176, v177
    v_mfma_f32_16x16x32_bf16 a[124:127], a[220:223], v[240:243], a[124:127]
    v_exp_f32 v179, v179
    v_mfma_f32_16x16x32_bf16 a[124:127], a[216:219], v[236:239], a[124:127]
    buffer_load_dwordx4 v14, s[8:11], s28 offen offset:1024 lds
    v_smfmac_f32_16x16x64_bf16 a[236:239], v[244:247], v[236:243], v248
    s_waitcnt lgkmcnt(6)
    v_mfma_f32_16x16x32_bf16 v[172:175], a[176:179], v[68:71], v[108:111]
    v_exp_f32 v116, v116
    v_mfma_f32_16x16x32_bf16 v[172:175], a[180:183], v[72:75], v[172:175]
    ds_read_b64_tr_b16 a[208:209], v7 offset:8192
    v_cvt_pk_bf16_f32 v211, v178, v179
    v_mfma_f32_16x16x32_bf16 v[172:175], a[184:187], v[76:79], v[172:175]
    v_exp_f32 v117, v117
    v_mfma_f32_16x16x32_bf16 v[172:175], a[188:191], v[80:83], v[172:175]
    ds_read_b64_tr_b16 a[210:211], v7 offset:12288
    v_mfma_f32_16x16x32_bf16 v[176:179], a[188:191], v[96:99], v[112:115]
    v_exp_f32 v118, v118
    v_mfma_f32_16x16x32_bf16 v[176:179], a[184:187], v[92:95], v[176:179]
    ds_read_b128 a[144:147], v1 offset:36864
    v_cvt_pk_bf16_f32 v212, v116, v117
    v_mfma_f32_16x16x32_bf16 v[176:179], a[180:183], v[88:91], v[176:179]
    v_exp_f32 v119, v119
    v_mfma_f32_16x16x32_bf16 v[176:179], a[176:179], v[84:87], v[176:179]
    ds_read_b64_tr_b16 a[212:213], v7 offset:32768
    v_mfma_f32_16x16x32_bf16 a[0:3], a[192:195], v[180:183], a[0:3]
    v_exp_f32 v120, v120
    v_mfma_f32_16x16x32_bf16 a[0:3], a[196:199], v[184:187], a[0:3]
    ds_read_b64_tr_b16 a[214:215], v7 offset:36864
    v_cvt_pk_bf16_f32 v213, v118, v119
    v_mfma_f32_16x16x32_bf16 a[4:7], a[196:199], v[192:195], a[4:7]
    v_exp_f32 v121, v121
    v_mfma_f32_16x16x32_bf16 a[4:7], a[192:195], v[188:191], a[4:7]
    ds_read_b128 a[148:151], v2 offset:36864
    v_cvt_pk_bf16_f32 v220, v120, v121
    v_mfma_f32_16x16x32_bf16 a[8:11], a[192:195], v[196:199], a[8:11]
    v_exp_f32 v122, v122
    v_mfma_f32_16x16x32_bf16 a[8:11], a[196:199], v[200:203], a[8:11]
    buffer_load_dwordx4 v15, s[8:11], s28 offen offset:2048 lds
    v_mfma_f32_16x16x32_bf16 a[12:15], a[196:199], v[208:211], a[12:15]
    v_exp_f32 v123, v123
    v_mfma_f32_16x16x32_bf16 a[12:15], a[192:195], v[204:207], a[12:15]
    s_waitcnt lgkmcnt(6)
    v_mfma_f32_16x16x32_bf16 v[116:119], a[128:131], v[36:39], v[100:103]
    v_exp_f32 v124, v124
    v_mfma_f32_16x16x32_bf16 v[116:119], a[132:135], v[40:43], v[116:119]
    ds_read_b64_tr_b16 a[216:217], v8 offset:8192
    v_cvt_pk_bf16_f32 v221, v122, v123
    v_mfma_f32_16x16x32_bf16 v[116:119], a[136:139], v[44:47], v[116:119]
    v_exp_f32 v125, v125
    v_mfma_f32_16x16x32_bf16 v[116:119], a[140:143], v[48:51], v[116:119]
    ds_read_b64_tr_b16 a[218:219], v8 offset:12288
    v_mfma_f32_16x16x32_bf16 v[120:123], a[140:143], v[64:67], v[104:107]
    v_exp_f32 v126, v126
    v_mfma_f32_16x16x32_bf16 v[120:123], a[136:139], v[60:63], v[120:123]
    ds_read_b128 a[152:155], v3 offset:36864
    v_cvt_pk_bf16_f32 v228, v124, v125
    v_mfma_f32_16x16x32_bf16 v[120:123], a[132:135], v[56:59], v[120:123]
    v_exp_f32 v127, v127
    v_mfma_f32_16x16x32_bf16 v[120:123], a[128:131], v[52:55], v[120:123]
    ds_read_b64_tr_b16 a[220:221], v8 offset:32768
    v_mfma_f32_16x16x32_bf16 a[16:19], a[200:203], v[180:183], a[16:19]
    v_exp_f32 v128, v128
    v_mfma_f32_16x16x32_bf16 a[16:19], a[204:207], v[184:187], a[16:19]
    ds_read_b64_tr_b16 a[222:223], v8 offset:36864
    v_cvt_pk_bf16_f32 v229, v126, v127
    v_mfma_f32_16x16x32_bf16 a[20:23], a[204:207], v[192:195], a[20:23]
    v_exp_f32 v129, v129
    v_mfma_f32_16x16x32_bf16 a[20:23], a[200:203], v[188:191], a[20:23]
    ds_read_b128 a[156:159], v4 offset:36864
    v_mfma_f32_16x16x32_bf16 a[24:27], a[200:203], v[196:199], a[24:27]
    v_exp_f32 v130, v130
    v_mfma_f32_16x16x32_bf16 a[24:27], a[204:207], v[200:203], a[24:27]
    v_cvt_pk_bf16_f32 v236, v128, v129
    v_mfma_f32_16x16x32_bf16 a[28:31], a[204:207], v[208:211], a[28:31]
    v_exp_f32 v131, v131
    v_mfma_f32_16x16x32_bf16 a[28:31], a[200:203], v[204:207], a[28:31]
    buffer_load_dwordx4 v16, s[8:11], s28 offen offset:3072 lds
    v_smfmac_f32_16x16x64_bf16 a[224:227], v[244:247], v[180:187], v248
    s_waitcnt lgkmcnt(6)
    v_mfma_f32_16x16x32_bf16 v[124:127], a[128:131], v[68:71], v[108:111]
    s_cmp_eq_u32 s36, 3
    s_cbranch_scc1 L_site3
L_site_back3:
    v_exp_f32 v132, v132
    v_mfma_f32_16x16x32_bf16 v[124:127], a[132:135], v[72:75], v[124:127]
    ds_read_b64_tr_b16 a[192:193], v9 offset:8192
    v_cvt_pk_bf16_f32 v237, v130, v131
    v_mfma_f32_16x16x32_bf16 v[124:127], a[136:139], v[76:79], v[124:127]
    v_exp_f32 v133, v133
    v_mfma_f32_16x16x32_bf16 v[124:127], a[140:143], v[80:83], v[124:127]
    ds_read_b64_tr_b16 a[194:195], v9 offset:12288
    v_mfma_f32_16x16x32_bf16 v[128:131], a[140:143], v[96:99], v[112:115]
    v_exp_f32 v134, v134
    v_mfma_f32_16x16x32_bf16 v[128:131], a[136:139], v[92:95], v[128:131]
    ds_read_b128 a[160:163], v1 offset:40960
    v_cvt_pk_bf16_f32 v214, v132, v133
    v_mfma_f32_16x16x32_bf16 v[128:131], a[132:135], v[88:91], v[128:131]
    v_exp_f32 v135, v135
    v_mfma_f32_16x16x32_bf16 v[128:131], a[128:131], v[84:87], v[128:131]
    ds_read_b64_tr_b16 a[196:197], v9 offset:32768
    v_mfma_f32_16x16x32_bf16 a[32:35], a[208:211], v[180:183], a[32:35]
    v_exp_f32 v136, v136
    v_mfma_f32_16x16x32_bf16 a[32:35], a[212:215], v[184:187], a[32:35]
    ds_read_b64_tr_b16 a[198:199], v9 offset:36864
    v_cvt_pk_bf16_f32 v215, v134, v135
    v_mfma_f32_16x16x32_bf16 a[36:39], a[212:215], v[192:195], a[36:39]
    v_exp_f32 v137, v137
    v_mfma_f32_16x16x32_bf16 a[36:39], a[208:211], v[188:191], a[36:39]
    ds_read_b128 a[164:167], v2 offset:40960
    v_cvt_pk_bf16_f32 v222, v136, v137
    v_mfma_f32_16x16x32_bf16 a[40:43], a[208:211], v[196:199], a[40:43]
    s_add_u32 s28, s28, 16384
    s_mov_b32 m0, s32
    v_exp_f32 v138, v138
    v_mfma_f32_16x16x32_bf16 a[40:43], a[212:215], v[200:203], a[40:43]
    buffer_load_dwordx4 v17, s[12:15], s29 offen offset:0 lds
    v_mfma_f32_16x16x32_bf16 a[44:47], a[212:215], v[208:211], a[44:47]
    v_exp_f32 v139, v139
    v_mfma_f32_16x16x32_bf16 a[44:47], a[208:211], v[204:207], a[44:47]
    s_waitcnt lgkmcnt(6)
    v_mfma_f32_16x16x32_bf16 v[132:135], a[144:147], v[36:39], v[100:103]
    v_exp_f32 v140, v140
    v_mfma_f32_16x16x32_bf16 v[132:135], a[148:151], v[40:43], v[132:135]
    ds_read_b64_tr_b16 a[200:201], v10 offset:8192
    v_cvt_pk_bf16_f32 v223, v138, v139
    v_mfma_f32_16x16x32_bf16 v[132:135], a[152:155], v[44:47], v[132:135]
    v_exp_f32 v141, v141
    v_mfma_f32_16x16x32_bf16 v[132:135], a[156:159], v[48:51], v[132:135]
    ds_read_b64_tr_b16 a[202:203], v10 offset:12288
    v_mfma_f32_16x16x32_bf16 v[136:139], a[156:159], v[64:67], v[104:107]
    v_exp_f32 v142, v142
    v_mfma_f32_16x16x32_bf16 v[136:139], a[152:155], v[60:63], v[136:139]
    ds_read_b128 a[168:171], v3 offset:40960
    v_cvt_pk_bf16_f32 v230, v140, v141
    v_mfma_f32_16x16x32_bf16 v[136:139], a[148:151], v[56:59], v[136:139]
    v_exp_f32 v143, v143
    v_mfma_f32_16x16x32_bf16 v[136:139], a[144:147], v[52:55], v[136:139]
    ds_read_b64_tr_b16 a[204:205], v10 offset:32768
    v_mfma_f32_16x16x32_bf16 a[48:51], a[216:219], v[180:183], a[48:51]
    v_exp_f32 v144, v144
    v_mfma_f32_16x16x32_bf16 a[48:51], a[220:223], v[184:187], a[48:51]
    ds_read_b64_tr_b16 a[206:207], v10 offset:36864
    v_cvt_pk_bf16_f32 v231, v142, v143
    v_mfma_f32_16x16x32_bf16 a[52:55], a[220:223], v[192:195], a[52:55]
    v_exp_f32 v145, v145
    v_mfma_f32_16x16x32_bf16 a[52:55], a[216:219], v[188:191], a[52:55]
    ds_read_b128 a[172:175], v4 offset:40960
    v_mfma_f32_16x16x32_bf16 a[56:59], a[216:219], v[196:199], a[56:59]
    v_exp_f32 v146, v146
    v_mfma_f32_16x16x32_bf16 a[56:59], a[220:223], v[200:203], a[56:59]
    v_cvt_pk_bf16_f32 v238, v144, v145
    v_mfma_f32_16x16x32_bf16 a[60:63], a[220:223], v[208:211], a[60:63]
    v_exp_f32 v147, v147
    v_mfma_f32_16x16x32_bf16 a[60:63], a[216:219], v[204:207], a[60:63]
    buffer_load_dwordx4 v18, s[12:15], s29 offen offset:1024 lds
    v_smfmac_f32_16x16x64_bf16 a[228:231], v[244:247], v[188:195], v248
    s_waitcnt lgkmcnt(6)
    v_mfma_f32_16x16x32_bf16 v[140:143], a[144:147], v[68:71], v[108:111]
    v_exp_f32 v148, v148
    v_mfma_f32_16x16x32_bf16 v[140:143], a[148:151], v[72:75], v[140:143]
    ds_read_b64_tr_b16 a[208:209], v11 offset:8192
    v_cvt_pk_bf16_f32 v239, v146, v147
    v_mfma_f32_16x16x32_bf16 v[140:143], a[152:155], v[76:79], v[140:143]
    v_exp_f32 v149, v149
    v_mfma_f32_16x16x32_bf16 v[140:143], a[156:159], v[80:83], v[140:143]
    ds_read_b64_tr_b16 a[210:211], v11 offset:12288
    v_mfma_f32_16x16x32_bf16 v[144:147], a[156:159], v[96:99], v[112:115]
    v_exp_f32 v150, v150
    v_mfma_f32_16x16x32_bf16 v[144:147], a[152:155], v[92:95], v[144:147]
    ds_read_b128 a[176:179], v1 offset:45056
    v_cvt_pk_bf16_f32 v216, v148, v149
    v_mfma_f32_16x16x32_bf16 v[144:147], a[148:151], v[88:91], v[144:147]
    v_exp_f32 v151, v151
    v_mfma_f32_16x16x32_bf16 v[144:147], a[144:147], v[84:87], v[144:147]
    ds_read_b64_tr_b16 a[212:213], v11 offset:32768
    v_mfma_f32_16x16x32_bf16 a[64:67], a[192:195], v[180:183], a[64:67]
    v_exp_f32 v152, v152
    v_mfma_f32_16x16x32_bf16 a[64:67], a[196:199], v[184:187], a[64:67]
    ds_read_b64_tr_b16 a[214:215], v11 offset:36864
    v_cvt_pk_bf16_f32 v217, v150, v151
    v_mfma_f32_16x16x32_bf16 a[68:71], a[196:199], v[192:195], a[68:71]
    v_exp_f32 v153, v153
    v_mfma_f32_16x16x32_bf16 a[68:71], a[192:195], v[188:191], a[68:71]
    ds_read_b128 a[180:183], v2 offset:45056
    v_cvt_pk_bf16_f32 v224, v152, v153
    v_mfma_f32_16x16x32_bf16 a[72:75], a[192:195], v[196:199], a[72:75]
    v_exp_f32 v154, v154
    v_mfma_f32_16x16x32_bf16 a[72:75], a[196:199], v[200:203], a[72:75]
    buffer_load_dwordx4 v17, s[12:15], s29 offen offset:2048 lds
    v_mfma_f32_16x16x32_bf16 a[76:79], a[196:199], v[208:211], a[76:79]
    v_exp_f32 v155, v155
    v_mfma_f32_16x16x32_bf16 a[76:79], a[192:195], v[204:207], a[76:79]
    s_waitcnt lgkmcnt(6)
    v_mfma_f32_16x16x32_bf16 v[148:151], a[160:163], v[36:39], v[100:103]
    v_exp_f32 v156, v156
    v_mfma_f32_16x16x32_bf16 v[148:151], a[164:167], v[40:43], v[148:151]
    ds_read_b64_tr_b16 a[216:217], v12 offset:8192
    v_cvt_pk_bf16_f32 v225, v154, v155
    v_mfma_f32_16x16x32_bf16 v[148:151], a[168:171], v[44:47], v[148:151]
    v_exp_f32 v157, v157
    v_mfma_f32_16x16x32_bf16 v[148:151], a[172:175], v[48:51], v[148:151]
    ds_read_b64_tr_b16 a[218:219], v12 offset:12288
    v_mfma_f32_16x16x32_bf16 v[152:155], a[172:175], v[64:67], v[104:107]
    v_exp_f32 v158, v158
    v_mfma_f32_16x16x32_bf16 v[152:155], a[168:171], v[60:63], v[152:155]
    ds_read_b128 a[184:187], v3 offset:45056
    v_cvt_pk_bf16_f32 v232, v156, v157
    v_mfma_f32_16x16x32_bf16 v[152:155], a[164:167], v[56:59], v[152:155]
    v_exp_f32 v159, v159
    v_mfma_f32_16x16x32_bf16 v[152:155], a[160:163], v[52:55], v[152:155]
    ds_read_b64_tr_b16 a[220:221], v12 offset:32768
    v_mfma_f32_16x16x32_bf16 a[80:83], a[200:203], v[180:183], a[80:83]
    v_exp_f32 v160, v160
    v_mfma_f32_16x16x32_bf16 a[80:83], a[204:207], v[184:187], a[80:83]
    ds_read_b64_tr_b16 a[222:223], v12 offset:36864
    v_cvt_pk_bf16_f32 v233, v158, v159
    v_mfma_f32_16x16x32_bf16 a[84:87], a[204:207], v[192:195], a[84:87]
    v_exp_f32 v161, v161
    v_mfma_f32_16x16x32_bf16 a[84:87], a[200:203], v[188:191], a[84:87]
    ds_read_b128 a[188:191], v4 offset:45056
    v_mfma_f32_16x16x32_bf16 a[88:91], a[200:203], v[196:199], a[88:91]
    v_exp_f32 v162, v162
    v_mfma_f32_16x16x32_bf16 a[88:91], a[204:207], v[200:203], a[88:91]
    v_cvt_pk_bf16_f32 v240, v160, v161
    v_mfma_f32_16x16x32_bf16 a[92:95], a[204:207], v[208:211], a[92:95]
    v_exp_f32 v163, v163
    v_mfma_f32_16x16x32_bf16 a[92:95], a[200:203], v[204:207], a[92:95]
    buffer_load_dwordx4 v18, s[12:15], s29 offen offset:3072 lds
    v_smfmac_f32_16x16x64_bf16 a[232:235], v[244:247], v[196:203], v248
    s_waitcnt vmcnt(8) lgkmcnt(6)
    s_barrier
    s_add_u32 s29, s29, 16384
    v_mfma_f32_16x16x32_bf16 v[156:159], a[160:163], v[68:71], v[108:111]
    v_exp_f32 v164, v164
    v_mfma_f32_16x16x32_bf16 v[156:159], a[164:167], v[72:75], v[156:159]
    ds_read_b64_tr_b16 a[192:193], v5 offset:16384
    v_cvt_pk_bf16_f32 v241, v162, v163
    v_mfma_f32_16x16x32_bf16 v[156:159], a[168:171], v[76:79], v[156:159]
    v_exp_f32 v165, v165
    v_mfma_f32_16x16x32_bf16 v[156:159], a[172:175], v[80:83], v[156:159]
    ds_read_b64_tr_b16 a[194:195], v5 offset:20480
    v_mfma_f32_16x16x32_bf16 v[160:163], a[172:175], v[96:99], v[112:115]
    v_exp_f32 v166, v166
    v_mfma_f32_16x16x32_bf16 v[160:163], a[168:171], v[92:95], v[160:163]
    ds_read_b128 a[128:131], v1 offset:0
    v_cvt_pk_bf16_f32 v218, v164, v165
    v_mfma_f32_16x16x32_bf16 v[160:163], a[164:167], v[88:91], v[160:163]
    v_exp_f32 v167, v167
    v_mfma_f32_16x16x32_bf16 v[160:163], a[160:163], v[84:87], v[160:163]
    ds_read_b64_tr_b16 a[196:197], v5 offset:40960
    v_mfma_f32_16x16x32_bf16 a[96:99], a[208:211], v[180:183], a[96:99]
    v_exp_f32 v168, v168
    v_mfma_f32_16x16x32_bf16 a[96:99], a[212:215], v[184:187], a[96:99]
    ds_read_b64_tr_b16 a[198:199], v5 offset:45056
    v_cvt_pk_bf16_f32 v219, v166, v167
    v_mfma_f32_16x16x32_bf16 a[100:103], a[212:215], v[192:195], a[100:103]
    v_exp_f32 v169, v169
    v_mfma_f32_16x16x32_bf16 a[100:103], a[208:211], v[188:191], a[100:103]
    ds_read_b128 a[132:135], v2 offset:0
    v_cvt_pk_bf16_f32 v226, v168, v169
    v_mfma_f32_16x16x32_bf16 a[104:107], a[208:211], v[196:199], a[104:107]
    s_add_u32 m0, s34, 16384
    v_exp_f32 v170, v170
    v_mfma_f32_16x16x32_bf16 a[104:107], a[212:215], v[200:203], a[104:107]
    buffer_load_dwordx4 v13, s[8:11], s28 offen offset:0 lds
    v_mfma_f32_16x16x32_bf16 a[108:111], a[212:215], v[208:211], a[108:111]
    v_exp_f32 v171, v171
    v_mfma_f32_16x16x32_bf16 a[108:111], a[208:211], v[204:207], a[108:111]
    s_waitcnt lgkmcnt(6)
    v_mfma_f32_16x16x32_bf16 v[164:167], a[176:179], v[36:39], v[100:103]
    s_mov_b32 s36, s5
    v_exp_f32 v172, v172
    v_mfma_f32_16x16x32_bf16 v[164:167], a[180:183], v[40:43], v[164:167]
    ds_read_b64_tr_b16 a[200:201], v6 offset:16384
    v_cvt_pk_bf16_f32 v227, v170, v171
    v_mfma_f32_16x16x32_bf16 v[164:167], a[184:187], v[44:47], v[164:167]
    v_exp_f32 v173, v173
    v_mfma_f32_16x16x32_bf16 v[164:167], a[188:191], v[48:51], v[164:167]
    ds_read_b64_tr_b16 a[202:203], v6 offset:20480
    v_mfma_f32_16x16x32_bf16 v[168:171], a[188:191], v[64:67], v[104:107]
    v_exp_f32 v174, v174
    v_mfma_f32_16x16x32_bf16 v[168:171], a[184:187], v[60:63], v[168:171]
    ds_read_b128 a[136:139], v3 offset:0
    v_cvt_pk_bf16_f32 v234, v172, v173
    v_mfma_f32_16x16x32_bf16 v[168:171], a[180:183], v[56:59], v[168:171]
    v_exp_f32 v175, v175
    v_mfma_f32_16x16x32_bf16 v[168:171], a[176:179], v[52:55], v[168:171]
    ds_read_b64_tr_b16 a[204:205], v6 offset:40960
    v_mfma_f32_16x16x32_bf16 a[112:115], a[216:219], v[180:183], a[112:115]
    v_exp_f32 v176, v176
    v_mfma_f32_16x16x32_bf16 a[112:115], a[220:223], v[184:187], a[112:115]
    ds_read_b64_tr_b16 a[206:207], v6 offset:45056
    v_cvt_pk_bf16_f32 v235, v174, v175
    v_mfma_f32_16x16x32_bf16 a[116:119], a[220:223], v[192:195], a[116:119]
    v_exp_f32 v177, v177
    v_mfma_f32_16x16x32_bf16 a[116:119], a[216:219], v[188:191], a[116:119]
    ds_read_b128 a[140:143], v4 offset:0
    v_mfma_f32_16x16x32_bf16 a[120:123], a[216:219], v[196:199], a[120:123]
    v_exp_f32 v178, v178
    v_mfma_f32_16x16x32_bf16 a[120:123], a[220:223], v[200:203], a[120:123]
    v_cvt_pk_bf16_f32 v242, v176, v177
    v_mfma_f32_16x16x32_bf16 a[124:127], a[220:223], v[208:211], a[124:127]
    v_exp_f32 v179, v179
    v_mfma_f32_16x16x32_bf16 a[124:127], a[216:219], v[204:207], a[124:127]
    buffer_load_dwordx4 v14, s[8:11], s28 offen offset:1024 lds
    v_smfmac_f32_16x16x64_bf16 a[236:239], v[244:247], v[204:211], v248
    s_waitcnt lgkmcnt(6)
    s_sub_u32 s35, s35, 1
    s_cbranch_scc0 L_attn_loop
    v_mfma_f32_16x16x32_bf16 v[172:175], a[176:179], v[68:71], v[108:111]
    s_bfe_u32 s47, s2, 0x10003
    v_exp_f32 v116, v116
    v_mfma_f32_16x16x32_bf16 v[172:175], a[180:183], v[72:75], v[172:175]
    s_bfe_u32 s40, s2, 0x20001
    ds_read_b64_tr_b16 a[208:209], v7 offset:16384
    v_cvt_pk_bf16_f32 v243, v178, v179
    v_mfma_f32_16x16x32_bf16 v[172:175], a[184:187], v[76:79], v[172:175]
    s_lshl_b32 s40, s40, 3
    v_exp_f32 v117, v117
    v_mfma_f32_16x16x32_bf16 v[172:175], a[188:191], v[80:83], v[172:175]
    s_bfe_u32 s41, s2, 0x30003
    ds_read_b64_tr_b16 a[210:211], v7 offset:20480
    v_and_b32 v21, 7, v19
    v_mfma_f32_16x16x32_bf16 v[176:179], a[188:191], v[96:99], v[112:115]
    s_add_u32 s87, s40, s41
    v_exp_f32 v118, v118
    v_mfma_f32_16x16x32_bf16 v[176:179], a[184:187], v[92:95], v[176:179]
    s_and_b32 s40, s2, 1
    ds_read_b128 a[144:147], v1 offset:4096
    v_cvt_pk_bf16_f32 v180, v116, v117
    v_mfma_f32_16x16x32_bf16 v[176:179], a[180:183], v[88:91], v[176:179]
    s_lshl_b32 s40, s40, 2
    v_exp_f32 v119, v119
    v_mfma_f32_16x16x32_bf16 v[176:179], a[176:179], v[84:87], v[176:179]
    s_lshr_b32 s41, s2, 6
    ds_read_b64_tr_b16 a[212:213], v7 offset:40960
    v_lshlrev_b32 v21, 2, v21
    v_mfma_f32_16x16x32_bf16 a[0:3], a[192:195], v[212:215], a[0:3]
    s_add_u32 s100, s40, s41
    v_exp_f32 v120, v120
    v_mfma_f32_16x16x32_bf16 a[0:3], a[196:199], v[216:219], a[0:3]
    s_add_u32 s16, s72, 0x1a00000
    s_addc_u32 s17, s73, 0
    ds_read_b64_tr_b16 a[214:215], v7 offset:45056
    v_cvt_pk_bf16_f32 v181, v118, v119
    v_mfma_f32_16x16x32_bf16 a[4:7], a[196:199], v[224:227], a[4:7]
    s_mov_b32 s18, 0x438000
    v_exp_f32 v121, v121
    v_mfma_f32_16x16x32_bf16 a[4:7], a[192:195], v[220:223], a[4:7]
    s_mov_b32 s19, 0x20000
    ds_read_b128 a[148:151], v2 offset:4096
    v_cvt_pk_bf16_f32 v188, v120, v121
    v_mfma_f32_16x16x32_bf16 a[8:11], a[192:195], v[228:231], a[8:11]
    v_exp_f32 v122, v122
    v_mfma_f32_16x16x32_bf16 a[8:11], a[196:199], v[232:235], a[8:11]
    buffer_load_dwordx4 v15, s[8:11], s28 offen offset:2048 lds
    v_add_u32 v21, 0x29b000, v21
    v_mfma_f32_16x16x32_bf16 a[12:15], a[196:199], v[240:243], a[12:15]
    v_exp_f32 v123, v123
    v_mfma_f32_16x16x32_bf16 a[12:15], a[192:195], v[236:239], a[12:15]
    s_waitcnt lgkmcnt(6)
    buffer_load_dword v249, v21, s[76:79], 0 offen sc1
    v_mfma_f32_16x16x32_bf16 v[116:119], a[128:131], v[36:39], v[100:103]
    v_exp_f32 v124, v124
    v_mfma_f32_16x16x32_bf16 v[116:119], a[132:135], v[40:43], v[116:119]
    ds_read_b64_tr_b16 a[216:217], v8 offset:16384
    v_cvt_pk_bf16_f32 v189, v122, v123
    v_mfma_f32_16x16x32_bf16 v[116:119], a[136:139], v[44:47], v[116:119]
    v_exp_f32 v125, v125
    v_mfma_f32_16x16x32_bf16 v[116:119], a[140:143], v[48:51], v[116:119]
    ds_read_b64_tr_b16 a[218:219], v8 offset:20480
    v_lshlrev_b32 v32, 7, v19
    v_mfma_f32_16x16x32_bf16 v[120:123], a[140:143], v[64:67], v[104:107]
    v_exp_f32 v126, v126
    v_mfma_f32_16x16x32_bf16 v[120:123], a[136:139], v[60:63], v[120:123]
    ds_read_b128 a[152:155], v3 offset:4096
    v_cvt_pk_bf16_f32 v196, v124, v125
    v_mfma_f32_16x16x32_bf16 v[120:123], a[132:135], v[56:59], v[120:123]
    v_exp_f32 v127, v127
    v_mfma_f32_16x16x32_bf16 v[120:123], a[128:131], v[52:55], v[120:123]
    ds_read_b64_tr_b16 a[220:221], v8 offset:40960
    v_add_u32 v32, 0x290000, v32
    v_mfma_f32_16x16x32_bf16 a[16:19], a[200:203], v[212:215], a[16:19]
    v_exp_f32 v128, v128
    v_mfma_f32_16x16x32_bf16 a[16:19], a[204:207], v[216:219], a[16:19]
    ds_read_b64_tr_b16 a[222:223], v8 offset:45056
    v_cvt_pk_bf16_f32 v197, v126, v127
    v_mfma_f32_16x16x32_bf16 a[20:23], a[204:207], v[224:227], a[20:23]
    v_exp_f32 v129, v129
    v_mfma_f32_16x16x32_bf16 a[20:23], a[200:203], v[220:223], a[20:23]
    ds_read_b128 a[156:159], v4 offset:4096
    v_mfma_f32_16x16x32_bf16 a[24:27], a[200:203], v[228:231], a[24:27]
    v_exp_f32 v130, v130
    v_mfma_f32_16x16x32_bf16 a[24:27], a[204:207], v[232:235], a[24:27]
    v_cvt_pk_bf16_f32 v204, v128, v129
    v_mfma_f32_16x16x32_bf16 a[28:31], a[204:207], v[240:243], a[28:31]
    v_exp_f32 v131, v131
    v_mfma_f32_16x16x32_bf16 a[28:31], a[200:203], v[236:239], a[28:31]
    buffer_load_dwordx4 v16, s[8:11], s28 offen offset:3072 lds
    v_smfmac_f32_16x16x64_bf16 a[224:227], v[244:247], v[212:219], v248
    s_waitcnt lgkmcnt(6)
    buffer_load_dwordx4 v[28:31], v32, s[76:79], 0 offen sc1
    v_mfma_f32_16x16x32_bf16 v[124:127], a[128:131], v[68:71], v[108:111]
    v_exp_f32 v132, v132
    v_mfma_f32_16x16x32_bf16 v[124:127], a[132:135], v[72:75], v[124:127]
    ds_read_b64_tr_b16 a[192:193], v9 offset:16384
    v_cvt_pk_bf16_f32 v205, v130, v131
    v_mfma_f32_16x16x32_bf16 v[124:127], a[136:139], v[76:79], v[124:127]
    v_exp_f32 v133, v133
    v_mfma_f32_16x16x32_bf16 v[124:127], a[140:143], v[80:83], v[124:127]
    ds_read_b64_tr_b16 a[194:195], v9 offset:20480
    v_mov_b32 v24, 0x3f803f80
    v_mfma_f32_16x16x32_bf16 v[128:131], a[140:143], v[96:99], v[112:115]
    v_exp_f32 v134, v134
    v_mfma_f32_16x16x32_bf16 v[128:131], a[136:139], v[92:95], v[128:131]
    ds_read_b128 a[160:163], v1 offset:8192
    v_cvt_pk_bf16_f32 v182, v132, v133
    v_mfma_f32_16x16x32_bf16 v[128:131], a[132:135], v[88:91], v[128:131]
    v_exp_f32 v135, v135
    v_accvgpr_write_b32 a240, v24
    v_mfma_f32_16x16x32_bf16 v[128:131], a[128:131], v[84:87], v[128:131]
    ds_read_b64_tr_b16 a[196:197], v9 offset:40960
    v_accvgpr_write_b32 a241, v24
    v_mfma_f32_16x16x32_bf16 a[32:35], a[208:211], v[212:215], a[32:35]
    v_exp_f32 v136, v136
    v_mfma_f32_16x16x32_bf16 a[32:35], a[212:215], v[216:219], a[32:35]
    ds_read_b64_tr_b16 a[198:199], v9 offset:45056
    v_cvt_pk_bf16_f32 v183, v134, v135
    v_lshlrev_b32 v25, 4, v19
    v_mfma_f32_16x16x32_bf16 a[36:39], a[212:215], v[224:227], a[36:39]
    s_mul_i32 s40, s5, 3072
    v_exp_f32 v137, v137
    v_mfma_f32_16x16x32_bf16 a[36:39], a[208:211], v[220:223], a[36:39]
    s_mul_i32 s41, s6, 10240
    ds_read_b128 a[164:167], v2 offset:8192
    v_cvt_pk_bf16_f32 v190, v136, v137
    v_mfma_f32_16x16x32_bf16 a[40:43], a[208:211], v[228:231], a[40:43]
    s_add_u32 s28, s28, 16384
    s_mov_b32 m0, s33
    v_exp_f32 v138, v138
    v_accvgpr_write_b32 a242, v24
    v_mfma_f32_16x16x32_bf16 a[40:43], a[212:215], v[232:235], a[40:43]
    s_add_u32 s41, s41, s40
    buffer_load_dwordx4 v17, s[12:15], s29 offen offset:0 lds
    v_mfma_f32_16x16x32_bf16 a[44:47], a[212:215], v[240:243], a[44:47]
    v_exp_f32 v139, v139
    v_mfma_f32_16x16x32_bf16 a[44:47], a[208:211], v[236:239], a[44:47]
    s_waitcnt lgkmcnt(6)
    v_accvgpr_write_b32 a243, v24
    v_accvgpr_write_b32 a244, v24
    v_mfma_f32_16x16x32_bf16 v[132:135], a[144:147], v[36:39], v[100:103]
    v_exp_f32 v140, v140
    v_mfma_f32_16x16x32_bf16 v[132:135], a[148:151], v[40:43], v[132:135]
    ds_read_b64_tr_b16 a[200:201], v10 offset:16384
    v_cvt_pk_bf16_f32 v191, v138, v139
    v_mfma_f32_16x16x32_bf16 v[132:135], a[152:155], v[44:47], v[132:135]
    v_exp_f32 v141, v141
    v_mfma_f32_16x16x32_bf16 v[132:135], a[156:159], v[48:51], v[132:135]
    ds_read_b64_tr_b16 a[202:203], v10 offset:20480
    v_accvgpr_write_b32 a245, v24
    v_mfma_f32_16x16x32_bf16 v[136:139], a[156:159], v[64:67], v[104:107]
    v_exp_f32 v142, v142
    v_mfma_f32_16x16x32_bf16 v[136:139], a[152:155], v[60:63], v[136:139]
    ds_read_b128 a[168:171], v3 offset:8192
    v_cvt_pk_bf16_f32 v198, v140, v141
    v_mfma_f32_16x16x32_bf16 v[136:139], a[148:151], v[56:59], v[136:139]
    v_exp_f32 v143, v143
    v_mfma_f32_16x16x32_bf16 v[136:139], a[144:147], v[52:55], v[136:139]
    ds_read_b64_tr_b16 a[204:205], v10 offset:40960
    v_accvgpr_write_b32 a246, v24
    v_mfma_f32_16x16x32_bf16 a[48:51], a[216:219], v[212:215], a[48:51]
    v_exp_f32 v144, v144
    v_mfma_f32_16x16x32_bf16 a[48:51], a[220:223], v[216:219], a[48:51]
    ds_read_b64_tr_b16 a[206:207], v10 offset:45056
    v_cvt_pk_bf16_f32 v199, v142, v143
    v_mfma_f32_16x16x32_bf16 a[52:55], a[220:223], v[224:227], a[52:55]
    v_exp_f32 v145, v145
    v_mfma_f32_16x16x32_bf16 a[52:55], a[216:219], v[220:223], a[52:55]
    ds_read_b128 a[172:175], v4 offset:8192
    v_accvgpr_write_b32 a247, v24
    v_mfma_f32_16x16x32_bf16 a[56:59], a[216:219], v[228:231], a[56:59]
    v_exp_f32 v146, v146
    v_mfma_f32_16x16x32_bf16 a[56:59], a[220:223], v[232:235], a[56:59]
    v_cvt_pk_bf16_f32 v206, v144, v145
    v_accvgpr_write_b32 a248, v24
    v_mfma_f32_16x16x32_bf16 a[60:63], a[220:223], v[240:243], a[60:63]
    v_exp_f32 v147, v147
    v_mfma_f32_16x16x32_bf16 a[60:63], a[216:219], v[236:239], a[60:63]
    buffer_load_dwordx4 v18, s[12:15], s29 offen offset:1024 lds
    v_smfmac_f32_16x16x64_bf16 a[228:231], v[244:247], v[220:227], v248
    s_waitcnt lgkmcnt(6)
    v_accvgpr_write_b32 a249, v24
    v_accvgpr_write_b32 a250, v24
    v_mfma_f32_16x16x32_bf16 v[140:143], a[144:147], v[68:71], v[108:111]
    v_exp_f32 v148, v148
    v_mfma_f32_16x16x32_bf16 v[140:143], a[148:151], v[72:75], v[140:143]
    ds_read_b64_tr_b16 a[208:209], v11 offset:16384
    v_cvt_pk_bf16_f32 v207, v146, v147
    v_mfma_f32_16x16x32_bf16 v[140:143], a[152:155], v[76:79], v[140:143]
    v_exp_f32 v149, v149
    v_mfma_f32_16x16x32_bf16 v[140:143], a[156:159], v[80:83], v[140:143]
    ds_read_b64_tr_b16 a[210:211], v11 offset:20480
    v_accvgpr_write_b32 a251, v24
    v_mfma_f32_16x16x32_bf16 v[144:147], a[156:159], v[96:99], v[112:115]
    v_exp_f32 v150, v150
    v_mfma_f32_16x16x32_bf16 v[144:147], a[152:155], v[92:95], v[144:147]
    ds_read_b128 a[176:179], v1 offset:12288
    v_cvt_pk_bf16_f32 v184, v148, v149
    v_mfma_f32_16x16x32_bf16 v[144:147], a[148:151], v[88:91], v[144:147]
    v_exp_f32 v151, v151
    v_mfma_f32_16x16x32_bf16 v[144:147], a[144:147], v[84:87], v[144:147]
    ds_read_b64_tr_b16 a[212:213], v11 offset:40960
    v_accvgpr_write_b32 a252, v24
    v_mfma_f32_16x16x32_bf16 a[64:67], a[192:195], v[212:215], a[64:67]
    v_exp_f32 v152, v152
    v_mfma_f32_16x16x32_bf16 a[64:67], a[196:199], v[216:219], a[64:67]
    ds_read_b64_tr_b16 a[214:215], v11 offset:45056
    v_cvt_pk_bf16_f32 v185, v150, v151
    v_mfma_f32_16x16x32_bf16 a[68:71], a[196:199], v[224:227], a[68:71]
    v_exp_f32 v153, v153
    v_mfma_f32_16x16x32_bf16 a[68:71], a[192:195], v[220:223], a[68:71]
    ds_read_b128 a[180:183], v2 offset:12288
    v_cvt_pk_bf16_f32 v192, v152, v153
    v_mfma_f32_16x16x32_bf16 a[72:75], a[192:195], v[228:231], a[72:75]
    v_exp_f32 v154, v154
    v_mfma_f32_16x16x32_bf16 a[72:75], a[196:199], v[232:235], a[72:75]
    buffer_load_dwordx4 v17, s[12:15], s29 offen offset:2048 lds
    s_mov_b32 s43, m0
    s_add_u32 m0, s40, 86016
    s_nop 0
    buffer_load_dwordx4 v25, s[96:99], s41 offen offset:0 lds
    s_mov_b32 m0, s43
    v_accvgpr_write_b32 a253, v24
    v_mfma_f32_16x16x32_bf16 a[76:79], a[196:199], v[240:243], a[76:79]
    v_exp_f32 v155, v155
    v_mfma_f32_16x16x32_bf16 a[76:79], a[192:195], v[236:239], a[76:79]
    s_waitcnt lgkmcnt(6)
    v_accvgpr_write_b32 a254, v24
    v_accvgpr_write_b32 a255, v24
    v_mfma_f32_16x16x32_bf16 v[148:151], a[160:163], v[36:39], v[100:103]
    v_exp_f32 v156, v156
    v_mfma_f32_16x16x32_bf16 v[148:151], a[164:167], v[40:43], v[148:151]
    ds_read_b64_tr_b16 a[216:217], v12 offset:16384
    v_cvt_pk_bf16_f32 v193, v154, v155
    v_mfma_f32_16x16x32_bf16 v[148:151], a[168:171], v[44:47], v[148:151]
    v_exp_f32 v157, v157
    v_mfma_f32_16x16x32_bf16 v[148:151], a[172:175], v[48:51], v[148:151]
    ds_read_b64_tr_b16 a[218:219], v12 offset:20480
    v_mov_b32 v252, v24
    v_mfma_f32_16x16x32_bf16 v[152:155], a[172:175], v[64:67], v[104:107]
    v_exp_f32 v158, v158
    v_mfma_f32_16x16x32_bf16 v[152:155], a[168:171], v[60:63], v[152:155]
    ds_read_b128 a[184:187], v3 offset:12288
    v_cvt_pk_bf16_f32 v200, v156, v157
    v_mfma_f32_16x16x32_bf16 v[152:155], a[164:167], v[56:59], v[152:155]
    v_exp_f32 v159, v159
    v_mfma_f32_16x16x32_bf16 v[152:155], a[160:163], v[52:55], v[152:155]
    ds_read_b64_tr_b16 a[220:221], v12 offset:40960
    s_mov_b32 s43, m0
    s_add_u32 m0, s40, 86016
    s_nop 0
    buffer_load_dwordx4 v25, s[96:99], s41 offen offset:1024 lds
    s_mov_b32 m0, s43
    v_mov_b32 v253, v24
    v_mfma_f32_16x16x32_bf16 a[80:83], a[200:203], v[212:215], a[80:83]
    v_exp_f32 v160, v160
    v_mfma_f32_16x16x32_bf16 a[80:83], a[204:207], v[216:219], a[80:83]
    ds_read_b64_tr_b16 a[222:223], v12 offset:45056
    v_cvt_pk_bf16_f32 v201, v158, v159
    v_mfma_f32_16x16x32_bf16 a[84:87], a[204:207], v[224:227], a[84:87]
    v_exp_f32 v161, v161
    v_mfma_f32_16x16x32_bf16 a[84:87], a[200:203], v[220:223], a[84:87]
    ds_read_b128 a[188:191], v4 offset:12288
    v_mov_b32 v254, v24
    v_mfma_f32_16x16x32_bf16 a[88:91], a[200:203], v[228:231], a[88:91]
    v_exp_f32 v162, v162
    v_mfma_f32_16x16x32_bf16 a[88:91], a[204:207], v[232:235], a[88:91]
    v_cvt_pk_bf16_f32 v208, v160, v161
    v_mov_b32 v255, v24
    v_mfma_f32_16x16x32_bf16 a[92:95], a[204:207], v[240:243], a[92:95]
    v_exp_f32 v163, v163
    v_mfma_f32_16x16x32_bf16 a[92:95], a[200:203], v[236:239], a[92:95]
    buffer_load_dwordx4 v18, s[12:15], s29 offen offset:3072 lds
    v_smfmac_f32_16x16x64_bf16 a[232:235], v[244:247], v[228:235], v248
    s_waitcnt vmcnt(12) lgkmcnt(6)
    s_barrier
    s_add_u32 s29, s29, 16384
    s_mov_b32 s43, m0
    s_add_u32 m0, s40, 86016
    s_nop 0
    buffer_load_dwordx4 v25, s[96:99], s41 offen offset:2048 lds
    s_mov_b32 m0, s43
    v_mfma_f32_16x16x32_bf16 v[156:159], a[160:163], v[68:71], v[108:111]
    s_waitcnt vmcnt(7)
    v_exp_f32 v164, v164
    v_mfma_f32_16x16x32_bf16 v[156:159], a[164:167], v[72:75], v[156:159]
    ds_read_b64_tr_b16 a[192:193], v5 offset:57344
    v_cvt_pk_bf16_f32 v209, v162, v163
    v_mfma_f32_16x16x32_bf16 v[156:159], a[168:171], v[76:79], v[156:159]
    v_exp_f32 v165, v165
    v_mfma_f32_16x16x32_bf16 v[156:159], a[172:175], v[80:83], v[156:159]
    ds_read_b64_tr_b16 a[194:195], v5 offset:61440
    v_cmp_eq_u32 vcc, 0, v249
    s_and_b64 vcc, vcc, exec
    s_cbranch_scc1 L_spin_sel
L_back_sel:
    v_mfma_f32_16x16x32_bf16 v[160:163], a[172:175], v[96:99], v[112:115]
    v_exp_f32 v166, v166
    v_mfma_f32_16x16x32_bf16 v[160:163], a[168:171], v[92:95], v[160:163]
    ds_read_b128 a[128:131], v1 offset:49152
    v_cvt_pk_bf16_f32 v186, v164, v165
    v_mfma_f32_16x16x32_bf16 v[160:163], a[164:167], v[88:91], v[160:163]
    v_exp_f32 v167, v167
    v_mfma_f32_16x16x32_bf16 v[160:163], a[160:163], v[84:87], v[160:163]
    ds_read_b64_tr_b16 a[196:197], v5 offset:0
    v_min3_u32 v28, v28, v29, v30
    v_mfma_f32_16x16x32_bf16 a[96:99], a[208:211], v[212:215], a[96:99]
    v_exp_f32 v168, v168
    v_mfma_f32_16x16x32_bf16 a[96:99], a[212:215], v[216:219], a[96:99]
    ds_read_b64_tr_b16 a[198:199], v5 offset:4096
    v_cvt_pk_bf16_f32 v187, v166, v167
    v_mfma_f32_16x16x32_bf16 a[100:103], a[212:215], v[224:227], a[100:103]
    v_exp_f32 v169, v169
    v_mfma_f32_16x16x32_bf16 a[100:103], a[208:211], v[220:223], a[100:103]
    ds_read_b128 a[132:135], v2 offset:49152
    v_cvt_pk_bf16_f32 v194, v168, v169
    v_mfma_f32_16x16x32_bf16 a[104:107], a[208:211], v[228:231], a[104:107]
    s_add_u32 m0, s34, 32768
    v_exp_f32 v170, v170
    v_mfma_f32_16x16x32_bf16 a[104:107], a[212:215], v[232:235], a[104:107]
    buffer_load_dwordx4 v13, s[8:11], s28 offen offset:0 lds
    v_mfma_f32_16x16x32_bf16 a[108:111], a[212:215], v[240:243], a[108:111]
    v_exp_f32 v171, v171
    v_mfma_f32_16x16x32_bf16 a[108:111], a[208:211], v[236:239], a[108:111]
    s_waitcnt lgkmcnt(6)
    v_min_u32 v28, v28, v31
    v_cmp_gt_u32 vcc, 1, v28
    s_and_b64 vcc, vcc, exec
    s_cbranch_scc1 L_spin_pack
L_back_pack:
    v_mfma_f32_16x16x32_bf16 v[164:167], a[176:179], v[36:39], v[100:103]
    v_exp_f32 v172, v172
    v_mfma_f32_16x16x32_bf16 v[164:167], a[180:183], v[40:43], v[164:167]
    ds_read_b64_tr_b16 a[200:201], v6 offset:57344
    v_cvt_pk_bf16_f32 v195, v170, v171
    v_mfma_f32_16x16x32_bf16 v[164:167], a[184:187], v[44:47], v[164:167]
    v_exp_f32 v173, v173
    v_mfma_f32_16x16x32_bf16 v[164:167], a[188:191], v[48:51], v[164:167]
    ds_read_b64_tr_b16 a[202:203], v6 offset:61440
    v_mfma_f32_16x16x32_bf16 v[168:171], a[188:191], v[64:67], v[104:107]
    v_exp_f32 v174, v174
    v_mfma_f32_16x16x32_bf16 v[168:171], a[184:187], v[60:63], v[168:171]
    ds_read_b128 a[136:139], v3 offset:49152
    v_cvt_pk_bf16_f32 v202, v172, v173
    v_mfma_f32_16x16x32_bf16 v[168:171], a[180:183], v[56:59], v[168:171]
    v_exp_f32 v175, v175
    v_mfma_f32_16x16x32_bf16 v[168:171], a[176:179], v[52:55], v[168:171]
    ds_read_b64_tr_b16 a[204:205], v6 offset:0
    v_mfma_f32_16x16x32_bf16 a[112:115], a[216:219], v[212:215], a[112:115]
    v_exp_f32 v176, v176
    v_mfma_f32_16x16x32_bf16 a[112:115], a[220:223], v[216:219], a[112:115]
    ds_read_b64_tr_b16 a[206:207], v6 offset:4096
    v_cvt_pk_bf16_f32 v203, v174, v175
    v_mfma_f32_16x16x32_bf16 a[116:119], a[220:223], v[224:227], a[116:119]
    v_exp_f32 v177, v177
    v_mfma_f32_16x16x32_bf16 a[116:119], a[216:219], v[220:223], a[116:119]
    ds_read_b128 a[140:143], v4 offset:49152
    v_mfma_f32_16x16x32_bf16 a[120:123], a[216:219], v[228:231], a[120:123]
    v_exp_f32 v178, v178
    v_mfma_f32_16x16x32_bf16 a[120:123], a[220:223], v[232:235], a[120:123]
    v_cvt_pk_bf16_f32 v210, v176, v177
    v_mfma_f32_16x16x32_bf16 a[124:127], a[220:223], v[240:243], a[124:127]
    v_exp_f32 v179, v179
    v_mfma_f32_16x16x32_bf16 a[124:127], a[216:219], v[236:239], a[124:127]
    buffer_load_dwordx4 v14, s[8:11], s28 offen offset:1024 lds
    v_smfmac_f32_16x16x64_bf16 a[236:239], v[244:247], v[236:243], v248
    s_waitcnt lgkmcnt(6)
    v_mfma_f32_16x16x32_bf16 v[172:175], a[176:179], v[68:71], v[108:111]
    v_exp_f32 v116, v116
    v_mfma_f32_16x16x32_bf16 v[172:175], a[180:183], v[72:75], v[172:175]
    ds_read_b64_tr_b16 a[208:209], v7 offset:57344
    v_cvt_pk_bf16_f32 v211, v178, v179
    v_mfma_f32_16x16x32_bf16 v[172:175], a[184:187], v[76:79], v[172:175]
    v_exp_f32 v117, v117
    v_mfma_f32_16x16x32_bf16 v[172:175], a[188:191], v[80:83], v[172:175]
    ds_read_b64_tr_b16 a[210:211], v7 offset:61440
    v_mov_b32 v22, v249
    v_mfma_f32_16x16x32_bf16 v[176:179], a[188:191], v[96:99], v[112:115]
    v_exp_f32 v118, v118
    v_mfma_f32_16x16x32_bf16 v[176:179], a[184:187], v[92:95], v[176:179]
    ds_read_b128 a[144:147], v1 offset:53248
    v_cvt_pk_bf16_f32 v212, v116, v117
    v_mfma_f32_16x16x32_bf16 v[176:179], a[180:183], v[88:91], v[176:179]
    v_exp_f32 v119, v119
    v_mfma_f32_16x16x32_bf16 v[176:179], a[176:179], v[84:87], v[176:179]
    ds_read_b64_tr_b16 a[212:213], v7 offset:0
    v_not_b32 v22, v22
    v_mfma_f32_16x16x32_bf16 a[0:3], a[192:195], v[180:183], a[0:3]
    v_exp_f32 v120, v120
    v_mfma_f32_16x16x32_bf16 a[0:3], a[196:199], v[184:187], a[0:3]
    ds_read_b64_tr_b16 a[214:215], v7 offset:4096
    v_cvt_pk_bf16_f32 v213, v118, v119
    v_mfma_f32_16x16x32_bf16 a[4:7], a[196:199], v[192:195], a[4:7]
    v_exp_f32 v121, v121
    v_mfma_f32_16x16x32_bf16 a[4:7], a[192:195], v[188:191], a[4:7]
    ds_read_b128 a[148:151], v2 offset:53248
    v_cvt_pk_bf16_f32 v220, v120, v121
    v_mfma_f32_16x16x32_bf16 a[8:11], a[192:195], v[196:199], a[8:11]
    v_exp_f32 v122, v122
    v_and_b32 v22, 0x7ff, v22
    v_mfma_f32_16x16x32_bf16 a[8:11], a[196:199], v[200:203], a[8:11]
    buffer_load_dwordx4 v15, s[8:11], s28 offen offset:2048 lds
    v_mfma_f32_16x16x32_bf16 a[12:15], a[196:199], v[208:211], a[12:15]
    v_exp_f32 v123, v123
    v_mfma_f32_16x16x32_bf16 a[12:15], a[192:195], v[204:207], a[12:15]
    s_waitcnt lgkmcnt(6)
    v_lshrrev_b32 v24, 4, v19
    v_lshlrev_b32 v23, 4, v22
    v_mfma_f32_16x16x32_bf16 v[116:119], a[128:131], v[36:39], v[100:103]
    v_exp_f32 v124, v124
    v_mfma_f32_16x16x32_bf16 v[116:119], a[132:135], v[40:43], v[116:119]
    ds_read_b64_tr_b16 a[216:217], v8 offset:57344
    v_cvt_pk_bf16_f32 v221, v122, v123
    v_mfma_f32_16x16x32_bf16 v[116:119], a[136:139], v[44:47], v[116:119]
    v_exp_f32 v125, v125
    v_mfma_f32_16x16x32_bf16 v[116:119], a[140:143], v[48:51], v[116:119]
    ds_read_b64_tr_b16 a[218:219], v8 offset:61440
    v_mul_u32_u24 v22, 1280, v22
    v_mfma_f32_16x16x32_bf16 v[120:123], a[140:143], v[64:67], v[104:107]
    v_exp_f32 v126, v126
    v_mfma_f32_16x16x32_bf16 v[120:123], a[136:139], v[60:63], v[120:123]
    ds_read_b128 a[152:155], v3 offset:53248
    v_cvt_pk_bf16_f32 v228, v124, v125
    v_mfma_f32_16x16x32_bf16 v[120:123], a[132:135], v[56:59], v[120:123]
    v_exp_f32 v127, v127
    v_mfma_f32_16x16x32_bf16 v[120:123], a[128:131], v[52:55], v[120:123]
    ds_read_b64_tr_b16 a[220:221], v8 offset:0
    v_lshl_add_u32 v22, v24, 4, v22
    v_mfma_f32_16x16x32_bf16 a[16:19], a[200:203], v[180:183], a[16:19]
    s_mul_i32 s40, s5, 320
    v_exp_f32 v128, v128
    v_mfma_f32_16x16x32_bf16 a[16:19], a[204:207], v[184:187], a[16:19]
    s_mov_b32 s41, 0x280000
    ds_read_b64_tr_b16 a[222:223], v8 offset:4096
    v_cvt_pk_bf16_f32 v229, v126, v127
    v_mfma_f32_16x16x32_bf16 a[20:23], a[204:207], v[192:195], a[20:23]
    v_exp_f32 v129, v129
    v_mfma_f32_16x16x32_bf16 a[20:23], a[200:203], v[188:191], a[20:23]
    ds_read_b128 a[156:159], v4 offset:53248
    v_mfma_f32_16x16x32_bf16 a[24:27], a[200:203], v[196:199], a[24:27]
    v_exp_f32 v130, v130
    v_mfma_f32_16x16x32_bf16 a[24:27], a[204:207], v[200:203], a[24:27]
    v_cvt_pk_bf16_f32 v236, v128, v129
    v_mfma_f32_16x16x32_bf16 a[28:31], a[204:207], v[208:211], a[28:31]
    v_exp_f32 v131, v131
    v_mfma_f32_16x16x32_bf16 a[28:31], a[200:203], v[204:207], a[28:31]
    buffer_load_dwordx4 v16, s[8:11], s28 offen offset:3072 lds
    v_smfmac_f32_16x16x64_bf16 a[224:227], v[244:247], v[180:187], v248
    s_waitcnt lgkmcnt(6)
    buffer_load_dwordx2 v[20:21], v23, s[76:79], s41 offen sc1
    v_mfma_f32_16x16x32_bf16 v[124:127], a[128:131], v[68:71], v[108:111]
    v_exp_f32 v132, v132
    v_mfma_f32_16x16x32_bf16 v[124:127], a[132:135], v[72:75], v[124:127]
    ds_read_b64_tr_b16 a[192:193], v9 offset:57344
    v_cvt_pk_bf16_f32 v237, v130, v131
    v_mfma_f32_16x16x32_bf16 v[124:127], a[136:139], v[76:79], v[124:127]
    v_exp_f32 v133, v133
    v_mfma_f32_16x16x32_bf16 v[124:127], a[140:143], v[80:83], v[124:127]
    ds_read_b64_tr_b16 a[194:195], v9 offset:61440
    v_mfma_f32_16x16x32_bf16 v[128:131], a[140:143], v[96:99], v[112:115]
    v_exp_f32 v134, v134
    v_mfma_f32_16x16x32_bf16 v[128:131], a[136:139], v[92:95], v[128:131]
    ds_read_b128 a[160:163], v1 offset:57344
    v_cvt_pk_bf16_f32 v214, v132, v133
    v_mfma_f32_16x16x32_bf16 v[128:131], a[132:135], v[88:91], v[128:131]
    v_exp_f32 v135, v135
    v_mfma_f32_16x16x32_bf16 v[128:131], a[128:131], v[84:87], v[128:131]
    ds_read_b64_tr_b16 a[196:197], v9 offset:0
    v_mfma_f32_16x16x32_bf16 a[32:35], a[208:211], v[180:183], a[32:35]
    v_exp_f32 v136, v136
    v_mfma_f32_16x16x32_bf16 a[32:35], a[212:215], v[184:187], a[32:35]
    ds_read_b64_tr_b16 a[198:199], v9 offset:4096
    v_cvt_pk_bf16_f32 v215, v134, v135
    v_mfma_f32_16x16x32_bf16 a[36:39], a[212:215], v[192:195], a[36:39]
    v_exp_f32 v137, v137
    v_mfma_f32_16x16x32_bf16 a[36:39], a[208:211], v[188:191], a[36:39]
    ds_read_b128 a[164:167], v2 offset:57344
    v_cvt_pk_bf16_f32 v222, v136, v137
    v_mfma_f32_16x16x32_bf16 a[40:43], a[208:211], v[196:199], a[40:43]
    s_add_u32 s28, s28, 16384
    s_mov_b32 m0, s30
    v_exp_f32 v138, v138
    v_mfma_f32_16x16x32_bf16 a[40:43], a[212:215], v[200:203], a[40:43]
    buffer_load_dwordx4 v17, s[12:15], s29 offen offset:0 lds
    v_mfma_f32_16x16x32_bf16 a[44:47], a[212:215], v[208:211], a[44:47]
    s_mov_b32 exec_lo, 0x00ff00ff
    s_mov_b32 exec_hi, 0x00ff00ff
    buffer_load_dwordx4 a[240:243], v22, s[88:91], s40 offen offset:0
    s_mov_b64 exec, -1
    v_exp_f32 v139, v139
    v_mfma_f32_16x16x32_bf16 a[44:47], a[208:211], v[204:207], a[44:47]
    s_waitcnt lgkmcnt(6)
    s_mov_b32 exec_lo, 0x00ff00ff
    s_mov_b32 exec_hi, 0x00ff00ff
    buffer_load_dwordx4 a[244:247], v22, s[88:91], s40 offen offset:64
    s_mov_b64 exec, -1
    v_mfma_f32_16x16x32_bf16 v[132:135], a[144:147], v[36:39], v[100:103]
    v_exp_f32 v140, v140
    v_mfma_f32_16x16x32_bf16 v[132:135], a[148:151], v[40:43], v[132:135]
    ds_read_b64_tr_b16 a[200:201], v10 offset:57344
    v_cvt_pk_bf16_f32 v223, v138, v139
    v_mfma_f32_16x16x32_bf16 v[132:135], a[152:155], v[44:47], v[132:135]
    v_exp_f32 v141, v141
    v_mfma_f32_16x16x32_bf16 v[132:135], a[156:159], v[48:51], v[132:135]
    ds_read_b64_tr_b16 a[202:203], v10 offset:61440
    v_mfma_f32_16x16x32_bf16 v[136:139], a[156:159], v[64:67], v[104:107]
    v_exp_f32 v142, v142
    v_mfma_f32_16x16x32_bf16 v[136:139], a[152:155], v[60:63], v[136:139]
    ds_read_b128 a[168:171], v3 offset:57344
    v_cvt_pk_bf16_f32 v230, v140, v141
    v_mfma_f32_16x16x32_bf16 v[136:139], a[148:151], v[56:59], v[136:139]
    v_exp_f32 v143, v143
    v_mfma_f32_16x16x32_bf16 v[136:139], a[144:147], v[52:55], v[136:139]
    ds_read_b64_tr_b16 a[204:205], v10 offset:0
    s_mov_b32 exec_lo, 0x00ff00ff
    s_mov_b32 exec_hi, 0x00ff00ff
    buffer_load_dwordx4 a[248:251], v22, s[88:91], s40 offen offset:128
    s_mov_b64 exec, -1
    v_mfma_f32_16x16x32_bf16 a[48:51], a[216:219], v[180:183], a[48:51]
    v_exp_f32 v144, v144
    v_mfma_f32_16x16x32_bf16 a[48:51], a[220:223], v[184:187], a[48:51]
    ds_read_b64_tr_b16 a[206:207], v10 offset:4096
    v_cvt_pk_bf16_f32 v231, v142, v143
    v_mfma_f32_16x16x32_bf16 a[52:55], a[220:223], v[192:195], a[52:55]
    v_exp_f32 v145, v145
    v_mfma_f32_16x16x32_bf16 a[52:55], a[216:219], v[188:191], a[52:55]
    ds_read_b128 a[172:175], v4 offset:57344
    v_mfma_f32_16x16x32_bf16 a[56:59], a[216:219], v[196:199], a[56:59]
    s_mov_b32 exec_lo, 0x00ff00ff
    s_mov_b32 exec_hi, 0x00ff00ff
    buffer_load_dwordx4 a[252:255], v22, s[88:91], s40 offen offset:192
    s_mov_b64 exec, -1
    v_exp_f32 v146, v146
    v_mfma_f32_16x16x32_bf16 a[56:59], a[220:223], v[200:203], a[56:59]
    v_cvt_pk_bf16_f32 v238, v144, v145
    v_mfma_f32_16x16x32_bf16 a[60:63], a[220:223], v[208:211], a[60:63]
    v_exp_f32 v147, v147
    v_mfma_f32_16x16x32_bf16 a[60:63], a[216:219], v[204:207], a[60:63]
    buffer_load_dwordx4 v18, s[12:15], s29 offen offset:1024 lds
    v_smfmac_f32_16x16x64_bf16 a[228:231], v[244:247], v[188:195], v248
    s_waitcnt lgkmcnt(6)
    s_mov_b32 exec_lo, 0x00ff00ff
    s_mov_b32 exec_hi, 0x00ff00ff
    buffer_load_dwordx4 v[252:255], v22, s[88:91], s40 offen offset:256
    s_mov_b64 exec, -1
    v_mfma_f32_16x16x32_bf16 v[140:143], a[144:147], v[68:71], v[108:111]
    v_exp_f32 v148, v148
    v_mfma_f32_16x16x32_bf16 v[140:143], a[148:151], v[72:75], v[140:143]
    ds_read_b64_tr_b16 a[208:209], v11 offset:57344
    v_cvt_pk_bf16_f32 v239, v146, v147
    v_mfma_f32_16x16x32_bf16 v[140:143], a[152:155], v[76:79], v[140:143]
    v_exp_f32 v149, v149
    v_lshrrev_b32 v22, 4, v19
    v_mfma_f32_16x16x32_bf16 v[140:143], a[156:159], v[80:83], v[140:143]
    ds_read_b64_tr_b16 a[210:211], v11 offset:61440
    v_bfe_u32 v24, v19, 2, 2
    v_mfma_f32_16x16x32_bf16 v[144:147], a[156:159], v[96:99], v[112:115]
    v_exp_f32 v150, v150
    v_mfma_f32_16x16x32_bf16 v[144:147], a[152:155], v[92:95], v[144:147]
    ds_read_b128 a[176:179], v1 offset:61440
    v_cvt_pk_bf16_f32 v216, v148, v149
    v_mfma_f32_16x16x32_bf16 v[144:147], a[148:151], v[88:91], v[144:147]
    v_exp_f32 v151, v151
    v_lshl_add_u32 v22, v22, 3, v24
    v_mfma_f32_16x16x32_bf16 v[144:147], a[144:147], v[84:87], v[144:147]
    ds_read_b64_tr_b16 a[212:213], v11 offset:0
    v_and_b32 v24, 1, v19
    v_mfma_f32_16x16x32_bf16 a[64:67], a[192:195], v[180:183], a[64:67]
    v_exp_f32 v152, v152
    v_mfma_f32_16x16x32_bf16 a[64:67], a[196:199], v[184:187], a[64:67]
    ds_read_b64_tr_b16 a[214:215], v11 offset:4096
    v_cvt_pk_bf16_f32 v217, v150, v151
    v_mfma_f32_16x16x32_bf16 a[68:71], a[196:199], v[192:195], a[68:71]
    v_exp_f32 v153, v153
    v_mfma_f32_16x16x32_bf16 a[68:71], a[192:195], v[188:191], a[68:71]
    ds_read_b128 a[180:183], v2 offset:61440
    v_cvt_pk_bf16_f32 v224, v152, v153
    v_lshl_add_u32 v22, v22, 1, v24
    v_mfma_f32_16x16x32_bf16 a[72:75], a[192:195], v[196:199], a[72:75]
    v_exp_f32 v154, v154
    v_mfma_f32_16x16x32_bf16 a[72:75], a[196:199], v[200:203], a[72:75]
    buffer_load_dwordx4 v17, s[12:15], s29 offen offset:2048 lds
    v_bfe_u32 v24, v19, 1, 1
    v_mfma_f32_16x16x32_bf16 a[76:79], a[196:199], v[208:211], a[76:79]
    v_exp_f32 v155, v155
    v_mfma_f32_16x16x32_bf16 a[76:79], a[192:195], v[204:207], a[76:79]
    s_waitcnt lgkmcnt(6)
    v_mul_u32_u24 v24, 10240, v24
    v_lshl_add_u32 v22, v22, 3, v24
    v_mfma_f32_16x16x32_bf16 v[148:151], a[160:163], v[36:39], v[100:103]
    s_mul_i32 s42, s5, 2560
    v_exp_f32 v156, v156
    v_mfma_f32_16x16x32_bf16 v[148:151], a[164:167], v[40:43], v[148:151]
    s_add_u32 s42, s42, 65536
    ds_read_b64_tr_b16 a[216:217], v12 offset:57344
    v_cvt_pk_bf16_f32 v225, v154, v155
    v_mfma_f32_16x16x32_bf16 v[148:151], a[168:171], v[44:47], v[148:151]
    v_exp_f32 v157, v157
    v_mfma_f32_16x16x32_bf16 v[148:151], a[172:175], v[48:51], v[148:151]
    ds_read_b64_tr_b16 a[218:219], v12 offset:61440
    v_add_u32 v22, s42, v22
    v_mfma_f32_16x16x32_bf16 v[152:155], a[172:175], v[64:67], v[104:107]
    s_mov_b32 s42, 65536
    v_exp_f32 v158, v158
    v_mfma_f32_16x16x32_bf16 v[152:155], a[168:171], v[60:63], v[152:155]
    ds_read_b128 a[184:187], v3 offset:61440
    v_cvt_pk_bf16_f32 v232, v156, v157
    v_mfma_f32_16x16x32_bf16 v[152:155], a[164:167], v[56:59], v[152:155]
    v_exp_f32 v159, v159
    v_mfma_f32_16x16x32_bf16 v[152:155], a[160:163], v[52:55], v[152:155]
    ds_read_b64_tr_b16 a[220:221], v12 offset:0
    v_lshl_add_u32 v23, v19, 4, s42
    v_mfma_f32_16x16x32_bf16 a[80:83], a[200:203], v[180:183], a[80:83]
    v_exp_f32 v160, v160
    v_mfma_f32_16x16x32_bf16 a[80:83], a[204:207], v[184:187], a[80:83]
    ds_read_b64_tr_b16 a[222:223], v12 offset:4096
    v_cvt_pk_bf16_f32 v233, v158, v159
    v_mfma_f32_16x16x32_bf16 a[84:87], a[204:207], v[192:195], a[84:87]
    v_exp_f32 v161, v161
    v_mfma_f32_16x16x32_bf16 a[84:87], a[200:203], v[188:191], a[84:87]
    ds_read_b128 a[188:191], v4 offset:61440
    v_readlane_b32 s50, v249, 0
    v_mfma_f32_16x16x32_bf16 a[88:91], a[200:203], v[196:199], a[88:91]
    v_exp_f32 v162, v162
    v_mfma_f32_16x16x32_bf16 a[88:91], a[204:207], v[200:203], a[88:91]
    v_cvt_pk_bf16_f32 v240, v160, v161
    v_readlane_b32 s51, v249, 1
    v_mfma_f32_16x16x32_bf16 a[92:95], a[204:207], v[208:211], a[92:95]
    v_exp_f32 v163, v163
    v_mfma_f32_16x16x32_bf16 a[92:95], a[200:203], v[204:207], a[92:95]
    buffer_load_dwordx4 v18, s[12:15], s29 offen offset:3072 lds
    v_smfmac_f32_16x16x64_bf16 a[232:235], v[244:247], v[196:203], v248
    s_waitcnt vmcnt(15) lgkmcnt(6)
    s_barrier
    s_add_u32 s29, s29, 16384
    v_readlane_b32 s52, v249, 2
    v_mfma_f32_16x16x32_bf16 v[156:159], a[160:163], v[68:71], v[108:111]
    v_exp_f32 v164, v164
    v_mfma_f32_16x16x32_bf16 v[156:159], a[164:167], v[72:75], v[156:159]
    ds_read_b64_tr_b16 a[192:193], v5 offset:24576
    v_cvt_pk_bf16_f32 v241, v162, v163
    v_mfma_f32_16x16x32_bf16 v[156:159], a[168:171], v[76:79], v[156:159]
    v_exp_f32 v165, v165
    v_mfma_f32_16x16x32_bf16 v[156:159], a[172:175], v[80:83], v[156:159]
    ds_read_b64_tr_b16 a[194:195], v5 offset:28672
    v_readlane_b32 s53, v249, 3
    v_mfma_f32_16x16x32_bf16 v[160:163], a[172:175], v[96:99], v[112:115]
    v_exp_f32 v166, v166
    v_mfma_f32_16x16x32_bf16 v[160:163], a[168:171], v[92:95], v[160:163]
    ds_read_b128 a[128:131], v1 offset:16384
    v_cvt_pk_bf16_f32 v218, v164, v165
    v_mfma_f32_16x16x32_bf16 v[160:163], a[164:167], v[88:91], v[160:163]
    v_exp_f32 v167, v167
    v_mfma_f32_16x16x32_bf16 v[160:163], a[160:163], v[84:87], v[160:163]
    ds_read_b64_tr_b16 a[196:197], v5 offset:49152
    v_readlane_b32 s54, v249, 4
    v_mfma_f32_16x16x32_bf16 a[96:99], a[208:211], v[180:183], a[96:99]
    v_exp_f32 v168, v168
    v_mfma_f32_16x16x32_bf16 a[96:99], a[212:215], v[184:187], a[96:99]
    ds_read_b64_tr_b16 a[198:199], v5 offset:53248
    v_cvt_pk_bf16_f32 v219, v166, v167
    v_mfma_f32_16x16x32_bf16 a[100:103], a[212:215], v[192:195], a[100:103]
    v_exp_f32 v169, v169
    v_mfma_f32_16x16x32_bf16 a[100:103], a[208:211], v[188:191], a[100:103]
    ds_read_b128 a[132:135], v2 offset:16384
    v_cvt_pk_bf16_f32 v226, v168, v169
    v_readlane_b32 s55, v249, 5
    v_mfma_f32_16x16x32_bf16 a[104:107], a[208:211], v[196:199], a[104:107]
    s_add_u32 m0, s34, 0
    v_exp_f32 v170, v170
    v_mfma_f32_16x16x32_bf16 a[104:107], a[212:215], v[200:203], a[104:107]
    buffer_load_dwordx4 v13, s[8:11], s28 offen offset:0 lds
    v_readlane_b32 s56, v249, 6
    v_mfma_f32_16x16x32_bf16 a[108:111], a[212:215], v[208:211], a[108:111]
    v_exp_f32 v171, v171
    v_mfma_f32_16x16x32_bf16 a[108:111], a[208:211], v[204:207], a[108:111]
    s_waitcnt lgkmcnt(6)
    v_readlane_b32 s57, v249, 7
    v_mfma_f32_16x16x32_bf16 v[164:167], a[176:179], v[36:39], v[100:103]
    v_exp_f32 v172, v172
    v_mfma_f32_16x16x32_bf16 v[164:167], a[180:183], v[40:43], v[164:167]
    ds_read_b64_tr_b16 a[200:201], v6 offset:24576
    v_cvt_pk_bf16_f32 v227, v170, v171
    v_mfma_f32_16x16x32_bf16 v[164:167], a[184:187], v[44:47], v[164:167]
    v_exp_f32 v173, v173
    v_mfma_f32_16x16x32_bf16 v[164:167], a[188:191], v[48:51], v[164:167]
    ds_read_b64_tr_b16 a[202:203], v6 offset:28672
    v_mfma_f32_16x16x32_bf16 v[168:171], a[188:191], v[64:67], v[104:107]
    v_exp_f32 v174, v174
    v_mfma_f32_16x16x32_bf16 v[168:171], a[184:187], v[60:63], v[168:171]
    ds_read_b128 a[136:139], v3 offset:16384
    v_cvt_pk_bf16_f32 v234, v172, v173
    v_mfma_f32_16x16x32_bf16 v[168:171], a[180:183], v[56:59], v[168:171]
    v_exp_f32 v175, v175
    v_mfma_f32_16x16x32_bf16 v[168:171], a[176:179], v[52:55], v[168:171]
    ds_read_b64_tr_b16 a[204:205], v6 offset:49152
    ds_read_b64_tr_b16 v[24:25], v22 offset:0
    v_mfma_f32_16x16x32_bf16 a[112:115], a[216:219], v[180:183], a[112:115]
    v_exp_f32 v176, v176
    v_mfma_f32_16x16x32_bf16 a[112:115], a[220:223], v[184:187], a[112:115]
    ds_read_b64_tr_b16 a[206:207], v6 offset:53248
    v_cvt_pk_bf16_f32 v235, v174, v175
    v_mfma_f32_16x16x32_bf16 a[116:119], a[220:223], v[192:195], a[116:119]
    v_exp_f32 v177, v177
    v_mfma_f32_16x16x32_bf16 a[116:119], a[216:219], v[188:191], a[116:119]
    ds_read_b128 a[140:143], v4 offset:16384
    ds_read_b64_tr_b16 v[26:27], v22 offset:64
    v_mfma_f32_16x16x32_bf16 a[120:123], a[216:219], v[196:199], a[120:123]
    v_exp_f32 v178, v178
    v_mfma_f32_16x16x32_bf16 a[120:123], a[220:223], v[200:203], a[120:123]
    ds_read_b64_tr_b16 v[28:29], v22 offset:512
    v_cvt_pk_bf16_f32 v242, v176, v177
    v_mfma_f32_16x16x32_bf16 a[124:127], a[220:223], v[208:211], a[124:127]
    v_exp_f32 v179, v179
    v_mfma_f32_16x16x32_bf16 a[124:127], a[216:219], v[204:207], a[124:127]
    buffer_load_dwordx4 v14, s[8:11], s28 offen offset:1024 lds
    v_smfmac_f32_16x16x64_bf16 a[236:239], v[244:247], v[204:211], v248
    s_waitcnt lgkmcnt(6)
    ds_read_b64_tr_b16 v[30:31], v22 offset:576
    v_mfma_f32_16x16x32_bf16 v[172:175], a[176:179], v[68:71], v[108:111]
    v_exp_f32 v116, v116
    v_mfma_f32_16x16x32_bf16 v[172:175], a[180:183], v[72:75], v[172:175]
    ds_read_b64_tr_b16 a[208:209], v7 offset:24576
    v_cvt_pk_bf16_f32 v243, v178, v179
    v_mfma_f32_16x16x32_bf16 v[172:175], a[184:187], v[76:79], v[172:175]
    v_exp_f32 v117, v117
    v_mfma_f32_16x16x32_bf16 v[172:175], a[188:191], v[80:83], v[172:175]
    ds_read_b64_tr_b16 a[210:211], v7 offset:28672
    v_mfma_f32_16x16x32_bf16 v[176:179], a[188:191], v[96:99], v[112:115]
    v_exp_f32 v118, v118
    v_mfma_f32_16x16x32_bf16 v[176:179], a[184:187], v[92:95], v[176:179]
    ds_read_b128 a[144:147], v1 offset:20480
    v_cvt_pk_bf16_f32 v180, v116, v117
    v_mfma_f32_16x16x32_bf16 v[176:179], a[180:183], v[88:91], v[176:179]
    v_exp_f32 v119, v119
    v_mfma_f32_16x16x32_bf16 v[176:179], a[176:179], v[84:87], v[176:179]
    ds_read_b64_tr_b16 a[212:213], v7 offset:49152
    v_mfma_f32_16x16x32_bf16 a[0:3], a[192:195], v[212:215], a[0:3]
    v_exp_f32 v120, v120
    v_mfma_f32_16x16x32_bf16 a[0:3], a[196:199], v[216:219], a[0:3]
    ds_read_b64_tr_b16 a[214:215], v7 offset:53248
    v_cvt_pk_bf16_f32 v181, v118, v119
    v_mfma_f32_16x16x32_bf16 a[4:7], a[196:199], v[224:227], a[4:7]
    v_exp_f32 v121, v121
    v_mfma_f32_16x16x32_bf16 a[4:7], a[192:195], v[220:223], a[4:7]
    ds_read_b128 a[148:151], v2 offset:20480
    v_cvt_pk_bf16_f32 v188, v120, v121
    v_mfma_f32_16x16x32_bf16 a[8:11], a[192:195], v[228:231], a[8:11]
    v_exp_f32 v122, v122
    v_mfma_f32_16x16x32_bf16 a[8:11], a[196:199], v[232:235], a[8:11]
    buffer_load_dwordx4 v15, s[8:11], s28 offen offset:2048 lds
    v_mfma_f32_16x16x32_bf16 a[12:15], a[196:199], v[240:243], a[12:15]
    v_exp_f32 v123, v123
    v_mfma_f32_16x16x32_bf16 a[12:15], a[192:195], v[236:239], a[12:15]
    s_waitcnt lgkmcnt(6)
    v_mfma_f32_16x16x32_bf16 v[116:119], a[128:131], v[36:39], v[100:103]
    s_waitcnt vmcnt(5)
    v_exp_f32 v124, v124
    v_mfma_f32_16x16x32_bf16 v[32:35], v[24:27], a[240:243], 0
    v_mfma_f32_16x16x32_bf16 v[32:35], v[28:31], a[244:247], v[32:35]
    ds_read_b64_tr_b16 v[24:25], v22 offset:1024
    v_mfma_f32_16x16x32_bf16 v[116:119], a[132:135], v[40:43], v[116:119]
    ds_read_b64_tr_b16 a[216:217], v8 offset:24576
    v_cvt_pk_bf16_f32 v189, v122, v123
    v_mfma_f32_16x16x32_bf16 v[116:119], a[136:139], v[44:47], v[116:119]
    v_exp_f32 v125, v125
    v_mfma_f32_16x16x32_bf16 v[116:119], a[140:143], v[48:51], v[116:119]
    ds_read_b64_tr_b16 a[218:219], v8 offset:28672
    v_mfma_f32_16x16x32_bf16 v[120:123], a[140:143], v[64:67], v[104:107]
    v_exp_f32 v126, v126
    v_mfma_f32_16x16x32_bf16 v[120:123], a[136:139], v[60:63], v[120:123]
    ds_read_b128 a[152:155], v3 offset:20480
    v_cvt_pk_bf16_f32 v196, v124, v125
    v_mfma_f32_16x16x32_bf16 v[120:123], a[132:135], v[56:59], v[120:123]
    v_exp_f32 v127, v127
    v_mfma_f32_16x16x32_bf16 v[120:123], a[128:131], v[52:55], v[120:123]
    ds_read_b64_tr_b16 a[220:221], v8 offset:49152
    v_mfma_f32_16x16x32_bf16 a[16:19], a[200:203], v[212:215], a[16:19]
    v_exp_f32 v128, v128
    v_mfma_f32_16x16x32_bf16 a[16:19], a[204:207], v[216:219], a[16:19]
    ds_read_b64_tr_b16 a[222:223], v8 offset:53248
    v_cvt_pk_bf16_f32 v197, v126, v127
    v_mfma_f32_16x16x32_bf16 a[20:23], a[204:207], v[224:227], a[20:23]
    v_exp_f32 v129, v129
    v_mfma_f32_16x16x32_bf16 a[20:23], a[200:203], v[220:223], a[20:23]
    ds_read_b128 a[156:159], v4 offset:20480
    v_mfma_f32_16x16x32_bf16 a[24:27], a[200:203], v[228:231], a[24:27]
    v_exp_f32 v130, v130
    v_mfma_f32_16x16x32_bf16 a[24:27], a[204:207], v[232:235], a[24:27]
    ds_read_b64_tr_b16 v[26:27], v22 offset:1088
    v_cvt_pk_bf16_f32 v204, v128, v129
    v_mfma_f32_16x16x32_bf16 a[28:31], a[204:207], v[240:243], a[28:31]
    v_exp_f32 v131, v131
    v_mfma_f32_16x16x32_bf16 a[28:31], a[200:203], v[236:239], a[28:31]
    buffer_load_dwordx4 v16, s[8:11], s28 offen offset:3072 lds
    v_smfmac_f32_16x16x64_bf16 a[224:227], v[244:247], v[212:219], v248
    s_waitcnt lgkmcnt(6)
    ds_read_b64_tr_b16 v[28:29], v22 offset:1536
    ds_read_b64_tr_b16 v[30:31], v22 offset:1600
    v_mfma_f32_16x16x32_bf16 v[124:127], a[128:131], v[68:71], v[108:111]
    s_mul_i32 s40, s5, 2560
    v_exp_f32 v132, v132
    v_mfma_f32_16x16x32_bf16 v[124:127], a[132:135], v[72:75], v[124:127]
    ds_read_b64_tr_b16 a[192:193], v9 offset:24576
    v_cvt_pk_bf16_f32 v205, v130, v131
    v_mfma_f32_16x16x32_bf16 v[124:127], a[136:139], v[76:79], v[124:127]
    v_exp_f32 v133, v133
    v_add_u32 v0, s40, v23
    v_mfma_f32_16x16x32_bf16 v[124:127], a[140:143], v[80:83], v[124:127]
    ds_read_b64_tr_b16 a[194:195], v9 offset:28672
    v_mfma_f32_16x16x32_bf16 v[128:131], a[140:143], v[96:99], v[112:115]
    v_exp_f32 v134, v134
    v_mfma_f32_16x16x32_bf16 v[128:131], a[136:139], v[92:95], v[128:131]
    ds_read_b128 a[160:163], v1 offset:24576
    v_cvt_pk_bf16_f32 v182, v132, v133
    v_mfma_f32_16x16x32_bf16 v[128:131], a[132:135], v[88:91], v[128:131]
    v_exp_f32 v135, v135
    v_mfma_f32_16x16x32_bf16 v[128:131], a[128:131], v[84:87], v[128:131]
    ds_read_b64_tr_b16 a[196:197], v9 offset:49152
    v_mfma_f32_16x16x32_bf16 a[32:35], a[208:211], v[212:215], a[32:35]
    v_exp_f32 v136, v136
    v_mfma_f32_16x16x32_bf16 a[32:35], a[212:215], v[216:219], a[32:35]
    s_waitcnt lgkmcnt(4)
    ds_read_b64_tr_b16 a[198:199], v9 offset:53248
    v_cvt_pk_bf16_f32 v183, v134, v135
    v_mfma_f32_16x16x32_bf16 v[32:35], v[24:27], a[248:251], v[32:35]
    v_mfma_f32_16x16x32_bf16 v[32:35], v[28:31], a[252:255], v[32:35]
    ds_read_b64_tr_b16 v[24:25], v22 offset:2048
    v_mfma_f32_16x16x32_bf16 a[36:39], a[212:215], v[224:227], a[36:39]
    v_exp_f32 v137, v137
    v_mfma_f32_16x16x32_bf16 a[36:39], a[208:211], v[220:223], a[36:39]
    ds_read_b128 a[164:167], v2 offset:24576
    v_cvt_pk_bf16_f32 v190, v136, v137
    v_mfma_f32_16x16x32_bf16 a[40:43], a[208:211], v[228:231], a[40:43]
    s_add_u32 s28, s28, 16384
    s_mov_b32 m0, s31
    v_exp_f32 v138, v138
    v_mfma_f32_16x16x32_bf16 a[40:43], a[212:215], v[232:235], a[40:43]
    buffer_load_dwordx4 v17, s[12:15], s29 offen offset:0 lds
    v_mfma_f32_16x16x32_bf16 a[44:47], a[212:215], v[240:243], a[44:47]
    v_exp_f32 v139, v139
    v_mfma_f32_16x16x32_bf16 a[44:47], a[208:211], v[236:239], a[44:47]
    s_waitcnt lgkmcnt(6)
    ds_read_b64_tr_b16 v[26:27], v22 offset:2112
    v_mfma_f32_16x16x32_bf16 v[132:135], a[144:147], v[36:39], v[100:103]
    v_exp_f32 v140, v140
    v_mfma_f32_16x16x32_bf16 v[132:135], a[148:151], v[40:43], v[132:135]
    ds_read_b64_tr_b16 a[200:201], v10 offset:24576
    v_cvt_pk_bf16_f32 v191, v138, v139
    v_mfma_f32_16x16x32_bf16 v[132:135], a[152:155], v[44:47], v[132:135]
    v_exp_f32 v141, v141
    v_mfma_f32_16x16x32_bf16 v[132:135], a[156:159], v[48:51], v[132:135]
    ds_read_b64_tr_b16 a[202:203], v10 offset:28672
    v_mfma_f32_16x16x32_bf16 v[136:139], a[156:159], v[64:67], v[104:107]
    v_exp_f32 v142, v142
    v_mfma_f32_16x16x32_bf16 v[136:139], a[152:155], v[60:63], v[136:139]
    ds_read_b128 a[168:171], v3 offset:24576
    v_cvt_pk_bf16_f32 v198, v140, v141
    v_mfma_f32_16x16x32_bf16 v[136:139], a[148:151], v[56:59], v[136:139]
    v_exp_f32 v143, v143
    v_mfma_f32_16x16x32_bf16 v[136:139], a[144:147], v[52:55], v[136:139]
    ds_read_b64_tr_b16 a[204:205], v10 offset:49152
    v_mfma_f32_16x16x32_bf16 a[48:51], a[216:219], v[212:215], a[48:51]
    s_waitcnt lgkmcnt(4)
    v_exp_f32 v144, v144
    v_mfma_f32_16x16x32_bf16 v[32:35], v[24:27], v[252:255], v[32:35]
    v_mfma_f32_16x16x32_bf16 a[48:51], a[220:223], v[216:219], a[48:51]
    ds_read_b64_tr_b16 a[206:207], v10 offset:53248
    v_cvt_pk_bf16_f32 v199, v142, v143
    v_mfma_f32_16x16x32_bf16 a[52:55], a[220:223], v[224:227], a[52:55]
    v_exp_f32 v145, v145
    v_mfma_f32_16x16x32_bf16 a[52:55], a[216:219], v[220:223], a[52:55]
    ds_read_b128 a[172:175], v4 offset:24576
    v_mfma_f32_16x16x32_bf16 a[56:59], a[216:219], v[228:231], a[56:59]
    v_exp_f32 v146, v146
    v_mfma_f32_16x16x32_bf16 a[56:59], a[220:223], v[232:235], a[56:59]
    v_cvt_pk_bf16_f32 v206, v144, v145
    v_mfma_f32_16x16x32_bf16 a[60:63], a[220:223], v[240:243], a[60:63]
    v_exp_f32 v147, v147
    v_mfma_f32_16x16x32_bf16 a[60:63], a[216:219], v[236:239], a[60:63]
    buffer_load_dwordx4 v18, s[12:15], s29 offen offset:1024 lds
    v_smfmac_f32_16x16x64_bf16 a[228:231], v[244:247], v[220:227], v248
    s_waitcnt lgkmcnt(6)
    v_mfma_f32_16x16x32_bf16 v[140:143], a[144:147], v[68:71], v[108:111]
    v_exp_f32 v148, v148
    v_mfma_f32_16x16x32_bf16 v[140:143], a[148:151], v[72:75], v[140:143]
    ds_read_b64_tr_b16 a[208:209], v11 offset:24576
    v_cvt_pk_bf16_f32 v207, v146, v147
    v_mfma_f32_16x16x32_bf16 v[140:143], a[152:155], v[76:79], v[140:143]
    v_exp_f32 v149, v149
    v_mfma_f32_16x16x32_bf16 v[140:143], a[156:159], v[80:83], v[140:143]
    ds_read_b64_tr_b16 a[210:211], v11 offset:28672
    v_mfma_f32_16x16x32_bf16 v[144:147], a[156:159], v[96:99], v[112:115]
    v_exp_f32 v150, v150
    v_mfma_f32_16x16x32_bf16 v[144:147], a[152:155], v[92:95], v[144:147]
    ds_read_b128 a[176:179], v1 offset:28672
    v_cvt_pk_bf16_f32 v184, v148, v149
    v_mfma_f32_16x16x32_bf16 v[144:147], a[148:151], v[88:91], v[144:147]
    v_exp_f32 v151, v151
    v_mfma_f32_16x16x32_bf16 v[144:147], a[144:147], v[84:87], v[144:147]
    ds_read_b64_tr_b16 a[212:213], v11 offset:49152
    ds_write_b128 v0, v[32:35]
    v_bfe_u32 v22, v19, 2, 3
    v_mfma_f32_16x16x32_bf16 a[64:67], a[192:195], v[212:215], a[64:67]
    v_exp_f32 v152, v152
    v_mul_u32_u24 v22, 160, v22
    v_mfma_f32_16x16x32_bf16 a[64:67], a[196:199], v[216:219], a[64:67]
    ds_read_b64_tr_b16 a[214:215], v11 offset:53248
    v_cvt_pk_bf16_f32 v185, v150, v151
    v_mfma_f32_16x16x32_bf16 a[68:71], a[196:199], v[224:227], a[68:71]
    v_exp_f32 v153, v153
    v_and_b32 v28, 3, v19
    v_mfma_f32_16x16x32_bf16 a[68:71], a[192:195], v[220:223], a[68:71]
    ds_read_b128 a[180:183], v2 offset:28672
    v_cvt_pk_bf16_f32 v192, v152, v153
    v_add_u32 v22, v22, v28
    v_mfma_f32_16x16x32_bf16 a[72:75], a[192:195], v[228:231], a[72:75]
    s_mul_i32 s42, s5, 320
    v_exp_f32 v154, v154
    v_mfma_f32_16x16x32_bf16 a[72:75], a[196:199], v[232:235], a[72:75]
    s_add_u32 s42, s42, 86016
    buffer_load_dwordx4 v17, s[12:15], s29 offen offset:2048 lds
    v_mfma_f32_16x16x32_bf16 a[76:79], a[196:199], v[240:243], a[76:79]
    v_exp_f32 v155, v155
    v_mfma_f32_16x16x32_bf16 a[76:79], a[192:195], v[236:239], a[76:79]
    s_waitcnt lgkmcnt(6)
    v_lshl_add_u32 v22, v22, 3, s42
    v_mfma_f32_16x16x32_bf16 v[148:151], a[160:163], v[36:39], v[100:103]
    v_exp_f32 v156, v156
    v_mfma_f32_16x16x32_bf16 v[148:151], a[164:167], v[40:43], v[148:151]
    ds_read_b64_tr_b16 a[216:217], v12 offset:24576
    v_cvt_pk_bf16_f32 v193, v154, v155
    v_mfma_f32_16x16x32_bf16 v[148:151], a[168:171], v[44:47], v[148:151]
    v_exp_f32 v157, v157
    v_mfma_f32_16x16x32_bf16 v[148:151], a[172:175], v[48:51], v[148:151]
    ds_read_b64_tr_b16 a[218:219], v12 offset:28672
    v_mfma_f32_16x16x32_bf16 v[152:155], a[172:175], v[64:67], v[104:107]
    v_exp_f32 v158, v158
    v_mfma_f32_16x16x32_bf16 v[152:155], a[168:171], v[60:63], v[152:155]
    ds_read_b128 a[184:187], v3 offset:28672
    v_cvt_pk_bf16_f32 v200, v156, v157
    v_mfma_f32_16x16x32_bf16 v[152:155], a[164:167], v[56:59], v[152:155]
    v_exp_f32 v159, v159
    v_mfma_f32_16x16x32_bf16 v[152:155], a[160:163], v[52:55], v[152:155]
    ds_read_b64_tr_b16 a[220:221], v12 offset:49152
    v_mfma_f32_16x16x32_bf16 a[80:83], a[200:203], v[212:215], a[80:83]
    v_exp_f32 v160, v160
    v_mfma_f32_16x16x32_bf16 a[80:83], a[204:207], v[216:219], a[80:83]
    ds_read_b64_tr_b16 a[222:223], v12 offset:53248
    v_cvt_pk_bf16_f32 v201, v158, v159
    v_mfma_f32_16x16x32_bf16 a[84:87], a[204:207], v[224:227], a[84:87]
    v_exp_f32 v161, v161
    v_mfma_f32_16x16x32_bf16 a[84:87], a[200:203], v[220:223], a[84:87]
    ds_read_b128 a[188:191], v4 offset:28672
    v_mfma_f32_16x16x32_bf16 a[88:91], a[200:203], v[228:231], a[88:91]
    v_exp_f32 v162, v162
    v_mfma_f32_16x16x32_bf16 a[88:91], a[204:207], v[232:235], a[88:91]
    v_cvt_pk_bf16_f32 v208, v160, v161
    v_mfma_f32_16x16x32_bf16 a[92:95], a[204:207], v[240:243], a[92:95]
    v_exp_f32 v163, v163
    v_mfma_f32_16x16x32_bf16 a[92:95], a[200:203], v[236:239], a[92:95]
    buffer_load_dwordx4 v18, s[12:15], s29 offen offset:3072 lds
    v_smfmac_f32_16x16x64_bf16 a[232:235], v[244:247], v[228:235], v248
    s_waitcnt vmcnt(8) lgkmcnt(6)
    s_barrier
    s_add_u32 s29, s29, 16384
    v_mfma_f32_16x16x32_bf16 v[156:159], a[160:163], v[68:71], v[108:111]
    v_exp_f32 v164, v164
    v_mfma_f32_16x16x32_bf16 v[156:159], a[164:167], v[72:75], v[156:159]
    ds_read_b64_tr_b16 a[192:193], v5 offset:8192
    v_cvt_pk_bf16_f32 v209, v162, v163
    v_mfma_f32_16x16x32_bf16 v[156:159], a[168:171], v[76:79], v[156:159]
    v_exp_f32 v165, v165
    v_mfma_f32_16x16x32_bf16 v[156:159], a[172:175], v[80:83], v[156:159]
    ds_read_b64_tr_b16 a[194:195], v5 offset:12288
    ds_read_b128 v[24:27], v23 offset:0
    v_mfma_f32_16x16x32_bf16 v[160:163], a[172:175], v[96:99], v[112:115]
    v_exp_f32 v166, v166
    v_mfma_f32_16x16x32_bf16 v[160:163], a[168:171], v[92:95], v[160:163]
    ds_read_b128 a[128:131], v1 offset:32768
    v_cvt_pk_bf16_f32 v186, v164, v165
    v_mfma_f32_16x16x32_bf16 v[160:163], a[164:167], v[88:91], v[160:163]
    v_exp_f32 v167, v167
    v_mfma_f32_16x16x32_bf16 v[160:163], a[160:163], v[84:87], v[160:163]
    ds_read_b64_tr_b16 a[196:197], v5 offset:32768
    ds_read_b128 v[28:31], v23 offset:2560
    v_mfma_f32_16x16x32_bf16 a[96:99], a[208:211], v[212:215], a[96:99]
    v_exp_f32 v168, v168
    v_mfma_f32_16x16x32_bf16 a[96:99], a[212:215], v[216:219], a[96:99]
    ds_read_b64_tr_b16 a[198:199], v5 offset:36864
    v_cvt_pk_bf16_f32 v187, v166, v167
    v_mfma_f32_16x16x32_bf16 a[100:103], a[212:215], v[224:227], a[100:103]
    v_exp_f32 v169, v169
    v_mfma_f32_16x16x32_bf16 a[100:103], a[208:211], v[220:223], a[100:103]
    ds_read_b128 a[132:135], v2 offset:32768
    v_cvt_pk_bf16_f32 v194, v168, v169
    v_mfma_f32_16x16x32_bf16 a[104:107], a[208:211], v[228:231], a[104:107]
    s_mov_b32 m0, s32
    v_exp_f32 v170, v170
    v_mfma_f32_16x16x32_bf16 a[104:107], a[212:215], v[232:235], a[104:107]
    buffer_load_dwordx4 v17, s[12:15], s29 offen offset:0 lds
    v_mfma_f32_16x16x32_bf16 a[108:111], a[212:215], v[240:243], a[108:111]
    v_exp_f32 v171, v171
    v_mfma_f32_16x16x32_bf16 a[108:111], a[208:211], v[236:239], a[108:111]
    s_waitcnt lgkmcnt(6)
    ds_read_b128 v[32:35], v23 offset:5120
    ds_read_b128 v[252:255], v23 offset:7680
    v_mfma_f32_16x16x32_bf16 v[164:167], a[176:179], v[36:39], v[100:103]
    v_exp_f32 v172, v172
    v_mfma_f32_16x16x32_bf16 v[164:167], a[180:183], v[40:43], v[164:167]
    ds_read_b64_tr_b16 a[200:201], v6 offset:8192
    v_cvt_pk_bf16_f32 v195, v170, v171
    v_mfma_f32_16x16x32_bf16 v[164:167], a[184:187], v[44:47], v[164:167]
    v_exp_f32 v173, v173
    v_mfma_f32_16x16x32_bf16 v[164:167], a[188:191], v[48:51], v[164:167]
    ds_read_b64_tr_b16 a[202:203], v6 offset:12288
    v_mfma_f32_16x16x32_bf16 v[168:171], a[188:191], v[64:67], v[104:107]
    v_exp_f32 v174, v174
    v_mfma_f32_16x16x32_bf16 v[168:171], a[184:187], v[60:63], v[168:171]
    ds_read_b128 a[136:139], v3 offset:32768
    v_cvt_pk_bf16_f32 v202, v172, v173
    v_mfma_f32_16x16x32_bf16 v[168:171], a[180:183], v[56:59], v[168:171]
    v_exp_f32 v175, v175
    v_mfma_f32_16x16x32_bf16 v[168:171], a[176:179], v[52:55], v[168:171]
    ds_read_b64_tr_b16 a[204:205], v6 offset:32768
    ds_read_b64_tr_b16 a[240:241], v22 offset:0
    v_mfma_f32_16x16x32_bf16 a[112:115], a[216:219], v[212:215], a[112:115]
    v_exp_f32 v176, v176
    v_mfma_f32_16x16x32_bf16 a[112:115], a[220:223], v[216:219], a[112:115]
    ds_read_b64_tr_b16 a[206:207], v6 offset:36864
    v_cvt_pk_bf16_f32 v203, v174, v175
    v_mfma_f32_16x16x32_bf16 a[116:119], a[220:223], v[224:227], a[116:119]
    v_exp_f32 v177, v177
    v_mfma_f32_16x16x32_bf16 a[116:119], a[216:219], v[220:223], a[116:119]
    ds_read_b128 a[140:143], v4 offset:32768
    ds_read_b64_tr_b16 a[242:243], v22 offset:32
    v_mfma_f32_16x16x32_bf16 a[120:123], a[216:219], v[228:231], a[120:123]
    v_exp_f32 v178, v178
    v_mfma_f32_16x16x32_bf16 a[120:123], a[220:223], v[232:235], a[120:123]
    ds_read_b64_tr_b16 a[244:245], v22 offset:64
    v_cvt_pk_bf16_f32 v210, v176, v177
    v_mfma_f32_16x16x32_bf16 a[124:127], a[220:223], v[240:243], a[124:127]
    v_exp_f32 v179, v179
    v_mfma_f32_16x16x32_bf16 a[124:127], a[216:219], v[236:239], a[124:127]
    buffer_load_dwordx4 v18, s[12:15], s29 offen offset:1024 lds
    v_smfmac_f32_16x16x64_bf16 a[236:239], v[244:247], v[236:243], v248
    s_waitcnt lgkmcnt(6)
    ds_read_b64_tr_b16 a[246:247], v22 offset:96
    v_mfma_f32_16x16x32_bf16 v[172:175], a[176:179], v[68:71], v[108:111]
    v_exp_f32 v116, v116
    v_mfma_f32_16x16x32_bf16 v[172:175], a[180:183], v[72:75], v[172:175]
    ds_read_b64_tr_b16 a[208:209], v7 offset:8192
    v_cvt_pk_bf16_f32 v211, v178, v179
    v_add_f32 v24, v24, v28
    v_mfma_f32_16x16x32_bf16 v[172:175], a[184:187], v[76:79], v[172:175]
    v_exp_f32 v117, v117
    v_add_f32 v25, v25, v29
    v_mfma_f32_16x16x32_bf16 v[172:175], a[188:191], v[80:83], v[172:175]
    ds_read_b64_tr_b16 a[210:211], v7 offset:12288
    v_add_f32 v26, v26, v30
    v_mfma_f32_16x16x32_bf16 v[176:179], a[188:191], v[96:99], v[112:115]
    v_exp_f32 v118, v118
    v_mfma_f32_16x16x32_bf16 v[176:179], a[184:187], v[92:95], v[176:179]
    ds_read_b128 a[144:147], v1 offset:36864
    v_cvt_pk_bf16_f32 v212, v116, v117
    v_add_f32 v27, v27, v31
    v_mfma_f32_16x16x32_bf16 v[176:179], a[180:183], v[88:91], v[176:179]
    v_exp_f32 v119, v119
    v_add_f32 v24, v24, v32
    v_mfma_f32_16x16x32_bf16 v[176:179], a[176:179], v[84:87], v[176:179]
    ds_read_b64_tr_b16 a[212:213], v7 offset:32768
    v_add_f32 v25, v25, v33
    v_mfma_f32_16x16x32_bf16 a[0:3], a[192:195], v[180:183], a[0:3]
    v_exp_f32 v120, v120
    v_mfma_f32_16x16x32_bf16 a[0:3], a[196:199], v[184:187], a[0:3]
    ds_read_b64_tr_b16 a[214:215], v7 offset:36864
    v_cvt_pk_bf16_f32 v213, v118, v119
    v_add_f32 v26, v26, v34
    v_mfma_f32_16x16x32_bf16 a[4:7], a[196:199], v[192:195], a[4:7]
    v_exp_f32 v121, v121
    v_add_f32 v27, v27, v35
    v_mfma_f32_16x16x32_bf16 a[4:7], a[192:195], v[188:191], a[4:7]
    ds_read_b128 a[148:151], v2 offset:36864
    v_cvt_pk_bf16_f32 v220, v120, v121
    v_add_f32 v24, v24, v252
    v_mfma_f32_16x16x32_bf16 a[8:11], a[192:195], v[196:199], a[8:11]
    v_exp_f32 v122, v122
    v_mfma_f32_16x16x32_bf16 a[8:11], a[196:199], v[200:203], a[8:11]
    buffer_load_dwordx4 v17, s[12:15], s29 offen offset:2048 lds
    v_add_f32 v25, v25, v253
    v_mfma_f32_16x16x32_bf16 a[12:15], a[196:199], v[208:211], a[12:15]
    v_exp_f32 v123, v123
    v_add_f32 v26, v26, v254
    v_mfma_f32_16x16x32_bf16 a[12:15], a[192:195], v[204:207], a[12:15]
    s_waitcnt lgkmcnt(6)
    ds_read_b64_tr_b16 a[248:249], v22 offset:128
    v_add_f32 v27, v27, v255
    v_mfma_f32_16x16x32_bf16 v[116:119], a[128:131], v[36:39], v[100:103]
    v_exp_f32 v124, v124
    v_mfma_f32_16x16x32_bf16 v[116:119], a[132:135], v[40:43], v[116:119]
    ds_read_b64_tr_b16 a[216:217], v8 offset:8192
    v_cvt_pk_bf16_f32 v221, v122, v123
    v_mov_b32_dpp v28, v24 row_newbcast:8 row_mask:0xf bank_mask:0xf
    v_mfma_f32_16x16x32_bf16 v[116:119], a[136:139], v[44:47], v[116:119]
    v_exp_f32 v125, v125
    v_mov_b32_dpp v29, v25 row_newbcast:8 row_mask:0xf bank_mask:0xf
    v_mfma_f32_16x16x32_bf16 v[116:119], a[140:143], v[48:51], v[116:119]
    ds_read_b64_tr_b16 a[218:219], v8 offset:12288
    v_mov_b32_dpp v30, v26 row_newbcast:8 row_mask:0xf bank_mask:0xf
    v_mfma_f32_16x16x32_bf16 v[120:123], a[140:143], v[64:67], v[104:107]
    v_exp_f32 v126, v126
    v_mfma_f32_16x16x32_bf16 v[120:123], a[136:139], v[60:63], v[120:123]
    ds_read_b128 a[152:155], v3 offset:36864
    v_cvt_pk_bf16_f32 v228, v124, v125
    v_mov_b32_dpp v31, v27 row_newbcast:8 row_mask:0xf bank_mask:0xf
    v_mfma_f32_16x16x32_bf16 v[120:123], a[132:135], v[56:59], v[120:123]
    v_exp_f32 v127, v127
    v_mfma_f32_16x16x32_bf16 v[120:123], a[128:131], v[52:55], v[120:123]
    ds_read_b64_tr_b16 a[220:221], v8 offset:32768
    v_fma_f32 v24, -v20, v28, v24
    v_mfma_f32_16x16x32_bf16 a[16:19], a[200:203], v[180:183], a[16:19]
    v_exp_f32 v128, v128
    v_fma_f32 v25, -v20, v29, v25
    v_mfma_f32_16x16x32_bf16 a[16:19], a[204:207], v[184:187], a[16:19]
    ds_read_b64_tr_b16 a[222:223], v8 offset:36864
    v_cvt_pk_bf16_f32 v229, v126, v127
    v_fma_f32 v26, -v20, v30, v26
    v_mfma_f32_16x16x32_bf16 a[20:23], a[204:207], v[192:195], a[20:23]
    v_exp_f32 v129, v129
    v_mfma_f32_16x16x32_bf16 a[20:23], a[200:203], v[188:191], a[20:23]
    ds_read_b128 a[156:159], v4 offset:36864
    v_fma_f32 v27, -v20, v31, v27
    v_mfma_f32_16x16x32_bf16 a[24:27], a[200:203], v[196:199], a[24:27]
    v_exp_f32 v130, v130
    v_mul_f32 v24, v24, v21
    v_mfma_f32_16x16x32_bf16 a[24:27], a[204:207], v[200:203], a[24:27]
    v_cvt_pk_bf16_f32 v236, v128, v129
    v_mul_f32 v25, v25, v21
    v_mfma_f32_16x16x32_bf16 a[28:31], a[204:207], v[208:211], a[28:31]
    v_exp_f32 v131, v131
    v_mfma_f32_16x16x32_bf16 a[28:31], a[200:203], v[204:207], a[28:31]
    buffer_load_dwordx4 v18, s[12:15], s29 offen offset:3072 lds
    v_mul_f32 v26, v26, v21
    v_smfmac_f32_16x16x64_bf16 a[224:227], v[244:247], v[180:187], v248
    s_waitcnt lgkmcnt(6)
    s_add_u32 s29, s29, 16384
    ds_read_b64_tr_b16 a[250:251], v22 offset:160
    ds_read_b64_tr_b16 a[252:253], v22 offset:192
    ds_read_b64_tr_b16 a[254:255], v22 offset:224
    v_mul_f32 v27, v27, v21
    v_cvt_pk_bf16_f32 v28, v24, v25
    v_mfma_f32_16x16x32_bf16 v[124:127], a[128:131], v[68:71], v[108:111]
    v_exp_f32 v132, v132
    v_mfma_f32_16x16x32_bf16 v[124:127], a[132:135], v[72:75], v[124:127]
    ds_read_b64_tr_b16 a[192:193], v9 offset:8192
    v_cvt_pk_bf16_f32 v237, v130, v131
    v_mfma_f32_16x16x32_bf16 v[124:127], a[136:139], v[76:79], v[124:127]
    v_exp_f32 v133, v133
    v_cvt_pk_bf16_f32 v29, v26, v27
    v_mfma_f32_16x16x32_bf16 v[124:127], a[140:143], v[80:83], v[124:127]
    ds_read_b64_tr_b16 a[194:195], v9 offset:12288
    v_lshlrev_b32 v24, 16, v28
    v_mfma_f32_16x16x32_bf16 v[128:131], a[140:143], v[96:99], v[112:115]
    v_exp_f32 v134, v134
    v_mfma_f32_16x16x32_bf16 v[128:131], a[136:139], v[92:95], v[128:131]
    ds_read_b128 a[160:163], v1 offset:40960
    v_cvt_pk_bf16_f32 v214, v132, v133
    v_and_b32 v25, 0xffff0000, v28
    v_mfma_f32_16x16x32_bf16 v[128:131], a[132:135], v[88:91], v[128:131]
    v_exp_f32 v135, v135
    v_lshlrev_b32 v26, 16, v29
    v_mfma_f32_16x16x32_bf16 v[128:131], a[128:131], v[84:87], v[128:131]
    ds_read_b64_tr_b16 a[196:197], v9 offset:32768
    v_and_b32 v27, 0xffff0000, v29
    v_mfma_f32_16x16x32_bf16 a[32:35], a[208:211], v[180:183], a[32:35]
    v_exp_f32 v136, v136
    v_mfma_f32_16x16x32_bf16 a[32:35], a[212:215], v[184:187], a[32:35]
    ds_read_b64_tr_b16 a[198:199], v9 offset:36864
    v_cvt_pk_bf16_f32 v215, v134, v135
    v_mov_b32 v32, v24
    v_mfma_f32_16x16x32_bf16 a[36:39], a[212:215], v[192:195], a[36:39]
    v_exp_f32 v137, v137
    v_mov_b32 v33, v25
    v_mfma_f32_16x16x32_bf16 a[36:39], a[208:211], v[188:191], a[36:39]
    ds_read_b128 a[164:167], v2 offset:40960
    v_mov_b32 v34, v26
    v_mfma_f32_16x16x32_bf16 a[40:43], a[208:211], v[196:199], a[40:43]
    v_exp_f32 v138, v138
    v_mfma_f32_16x16x32_bf16 a[40:43], a[212:215], v[200:203], a[40:43]
    v_cvt_pk_bf16_f32 v222, v136, v137
    v_mov_b32 v35, v27
    v_mfma_f32_16x16x32_bf16 a[44:47], a[212:215], v[208:211], a[44:47]
    v_exp_f32 v139, v139
    v_permlane32_swap_b32 v24, v32
    v_mfma_f32_16x16x32_bf16 a[44:47], a[208:211], v[204:207], a[44:47]
    s_waitcnt lgkmcnt(6)
    v_permlane32_swap_b32 v25, v33
    v_mfma_f32_16x16x32_bf16 v[132:135], a[144:147], v[36:39], v[100:103]
    s_mul_i32 s46, s5, 10240
    v_exp_f32 v140, v140
    v_mfma_f32_16x16x32_bf16 v[132:135], a[148:151], v[40:43], v[132:135]
    s_lshl_b32 s40, s100, 1
    ds_read_b64_tr_b16 a[200:201], v10 offset:8192
    v_cvt_pk_bf16_f32 v223, v138, v139
    v_permlane32_swap_b32 v26, v34
    v_mfma_f32_16x16x32_bf16 v[132:135], a[152:155], v[44:47], v[132:135]
    s_add_u32 s40, s40, s47
    v_exp_f32 v141, v141
    v_permlane32_swap_b32 v27, v35
    v_mfma_f32_16x16x32_bf16 v[132:135], a[156:159], v[48:51], v[132:135]
    s_mul_i32 s40, s40, 327680
    ds_read_b64_tr_b16 a[202:203], v10 offset:12288
    v_mul_f32 v28, 0xbfb8aa3b, v24
    v_mfma_f32_16x16x32_bf16 v[136:139], a[156:159], v[64:67], v[104:107]
    s_add_u32 s40, s40, 0x1400000
    v_exp_f32 v142, v142
    v_mfma_f32_16x16x32_bf16 v[136:139], a[152:155], v[60:63], v[136:139]
    s_add_u32 s20, s72, s40
    s_addc_u32 s21, s73, 0
    ds_read_b128 a[168:171], v3 offset:40960
    v_cvt_pk_bf16_f32 v230, v140, v141
    v_mul_f32 v29, 0xbfb8aa3b, v25
    v_mfma_f32_16x16x32_bf16 v[136:139], a[148:151], v[56:59], v[136:139]
    s_mov_b32 s22, 0x50000
    v_exp_f32 v143, v143
    v_mfma_f32_16x16x32_bf16 v[136:139], a[144:147], v[52:55], v[136:139]
    s_mov_b32 s23, 0x20000
    ds_read_b64_tr_b16 a[204:205], v10 offset:32768
    v_mul_f32 v30, 0xbfb8aa3b, v26
    v_mfma_f32_16x16x32_bf16 a[48:51], a[216:219], v[180:183], a[48:51]
    s_mul_i32 s40, s5, 5120
    v_exp_f32 v144, v144
    v_mul_f32 v31, 0xbfb8aa3b, v27
    v_mfma_f32_16x16x32_bf16 a[48:51], a[220:223], v[184:187], a[48:51]
    ds_read_b64_tr_b16 a[206:207], v10 offset:36864
    v_cvt_pk_bf16_f32 v231, v142, v143
    v_exp_f32 v28, v28
    v_mfma_f32_16x16x32_bf16 a[52:55], a[220:223], v[192:195], a[52:55]
    v_exp_f32 v145, v145
    v_mfma_f32_16x16x32_bf16 a[52:55], a[216:219], v[188:191], a[52:55]
    ds_read_b128 a[172:175], v4 offset:40960
    v_exp_f32 v29, v29
    v_mfma_f32_16x16x32_bf16 a[56:59], a[216:219], v[196:199], a[56:59]
    v_exp_f32 v146, v146
    v_exp_f32 v30, v30
    v_mfma_f32_16x16x32_bf16 a[56:59], a[220:223], v[200:203], a[56:59]
    v_cvt_pk_bf16_f32 v238, v144, v145
    v_lshl_add_u32 v254, v19, 4, s40
    v_mfma_f32_16x16x32_bf16 a[60:63], a[220:223], v[208:211], a[60:63]
    v_exp_f32 v147, v147
    v_exp_f32 v31, v31
    v_mfma_f32_16x16x32_bf16 a[60:63], a[216:219], v[204:207], a[60:63]
    v_add_f32 v28, 1.0, v28
    v_add_f32 v29, 1.0, v29
    v_smfmac_f32_16x16x64_bf16 a[228:231], v[244:247], v[188:195], v248
    s_waitcnt lgkmcnt(6)
    v_add_f32 v30, 1.0, v30
    v_add_f32 v31, 1.0, v31
    v_mfma_f32_16x16x32_bf16 v[140:143], a[144:147], v[68:71], v[108:111]
    v_exp_f32 v148, v148
    v_mfma_f32_16x16x32_bf16 v[140:143], a[148:151], v[72:75], v[140:143]
    ds_read_b64_tr_b16 a[208:209], v11 offset:8192
    v_cvt_pk_bf16_f32 v239, v146, v147
    v_mfma_f32_16x16x32_bf16 v[140:143], a[152:155], v[76:79], v[140:143]
    v_exp_f32 v149, v149
    v_mfma_f32_16x16x32_bf16 v[140:143], a[156:159], v[80:83], v[140:143]
    ds_read_b64_tr_b16 a[210:211], v11 offset:12288
    v_rcp_f32 v28, v28
    v_mfma_f32_16x16x32_bf16 v[144:147], a[156:159], v[96:99], v[112:115]
    v_exp_f32 v150, v150
    v_mfma_f32_16x16x32_bf16 v[144:147], a[152:155], v[92:95], v[144:147]
    ds_read_b128 a[176:179], v1 offset:45056
    v_cvt_pk_bf16_f32 v216, v148, v149
    v_rcp_f32 v29, v29
    v_mfma_f32_16x16x32_bf16 v[144:147], a[148:151], v[88:91], v[144:147]
    v_exp_f32 v151, v151
    v_rcp_f32 v30, v30
    v_mfma_f32_16x16x32_bf16 v[144:147], a[144:147], v[84:87], v[144:147]
    ds_read_b64_tr_b16 a[212:213], v11 offset:32768
    v_rcp_f32 v31, v31
    v_mfma_f32_16x16x32_bf16 a[64:67], a[192:195], v[180:183], a[64:67]
    v_exp_f32 v152, v152
    v_mfma_f32_16x16x32_bf16 a[64:67], a[196:199], v[184:187], a[64:67]
    ds_read_b64_tr_b16 a[214:215], v11 offset:36864
    v_cvt_pk_bf16_f32 v217, v150, v151
    v_mul_f32 v24, v24, v28
    v_mfma_f32_16x16x32_bf16 a[68:71], a[196:199], v[192:195], a[68:71]
    v_exp_f32 v153, v153
    v_mul_f32 v25, v25, v29
    v_mfma_f32_16x16x32_bf16 a[68:71], a[192:195], v[188:191], a[68:71]
    ds_read_b128 a[180:183], v2 offset:45056
    v_mul_f32 v26, v26, v30
    v_mfma_f32_16x16x32_bf16 a[72:75], a[192:195], v[196:199], a[72:75]
    v_exp_f32 v154, v154
    v_mfma_f32_16x16x32_bf16 a[72:75], a[196:199], v[200:203], a[72:75]
    v_cvt_pk_bf16_f32 v224, v152, v153
    v_mul_f32 v27, v27, v31
    v_mfma_f32_16x16x32_bf16 a[76:79], a[196:199], v[208:211], a[76:79]
    v_exp_f32 v155, v155
    v_cvt_pk_bf16_f32 v28, v24, v25
    v_mfma_f32_16x16x32_bf16 a[76:79], a[192:195], v[204:207], a[76:79]
    s_waitcnt lgkmcnt(6)
    v_cvt_pk_bf16_f32 v29, v26, v27
    v_lshlrev_b32 v24, 16, v28
    v_mfma_f32_16x16x32_bf16 v[148:151], a[160:163], v[36:39], v[100:103]
    v_exp_f32 v156, v156
    v_mfma_f32_16x16x32_bf16 v[148:151], a[164:167], v[40:43], v[148:151]
    ds_read_b64_tr_b16 a[216:217], v12 offset:8192
    v_cvt_pk_bf16_f32 v225, v154, v155
    v_mfma_f32_16x16x32_bf16 v[148:151], a[168:171], v[44:47], v[148:151]
    v_exp_f32 v157, v157
    v_and_b32 v25, 0xffff0000, v28
    v_mfma_f32_16x16x32_bf16 v[148:151], a[172:175], v[48:51], v[148:151]
    ds_read_b64_tr_b16 a[218:219], v12 offset:12288
    v_lshlrev_b32 v26, 16, v29
    v_mfma_f32_16x16x32_bf16 v[152:155], a[172:175], v[64:67], v[104:107]
    v_exp_f32 v158, v158
    v_mfma_f32_16x16x32_bf16 v[152:155], a[168:171], v[60:63], v[152:155]
    ds_read_b128 a[184:187], v3 offset:45056
    v_cvt_pk_bf16_f32 v232, v156, v157
    v_and_b32 v27, 0xffff0000, v29
    v_mfma_f32_16x16x32_bf16 v[152:155], a[164:167], v[56:59], v[152:155]
    v_exp_f32 v159, v159
    v_mfma_f32_16x16x32_bf16 v[152:155], a[160:163], v[52:55], v[152:155]
    ds_read_b64_tr_b16 a[220:221], v12 offset:32768
    v_mul_f32 v24, v24, v32
    v_mfma_f32_16x16x32_bf16 a[80:83], a[200:203], v[180:183], a[80:83]
    v_exp_f32 v160, v160
    v_mul_f32 v25, v25, v33
    v_mfma_f32_16x16x32_bf16 a[80:83], a[204:207], v[184:187], a[80:83]
    ds_read_b64_tr_b16 a[222:223], v12 offset:36864
    v_cvt_pk_bf16_f32 v233, v158, v159
    v_mul_f32 v26, v26, v34
    v_mfma_f32_16x16x32_bf16 a[84:87], a[204:207], v[192:195], a[84:87]
    v_exp_f32 v161, v161
    v_mfma_f32_16x16x32_bf16 a[84:87], a[200:203], v[188:191], a[84:87]
    ds_read_b128 a[188:191], v4 offset:45056
    v_mul_f32 v27, v27, v35
    v_mfma_f32_16x16x32_bf16 a[88:91], a[200:203], v[196:199], a[88:91]
    v_exp_f32 v162, v162
    v_cmp_gt_u32 vcc, 32, v19
    v_mfma_f32_16x16x32_bf16 a[88:91], a[204:207], v[200:203], a[88:91]
    v_cvt_pk_bf16_f32 v240, v160, v161
    v_cvt_pk_bf16_f32 v252, v24, v25
    v_mfma_f32_16x16x32_bf16 a[92:95], a[204:207], v[208:211], a[92:95]
    v_exp_f32 v163, v163
    v_mfma_f32_16x16x32_bf16 a[92:95], a[200:203], v[204:207], a[92:95]
    v_cvt_pk_bf16_f32 v253, v26, v27
    v_cndmask_b32 v252, 0, v252, vcc
    v_smfmac_f32_16x16x64_bf16 a[232:235], v[244:247], v[196:203], v248
    s_waitcnt vmcnt(4) lgkmcnt(0)
    s_barrier
    v_cndmask_b32 v253, 0, v253, vcc
    v_and_b32 v23, 7, v19
    v_mfma_f32_16x16x32_bf16 v[156:159], a[160:163], v[68:71], v[108:111]
    v_exp_f32 v164, v164
    v_mfma_f32_16x16x32_bf16 v[156:159], a[164:167], v[72:75], v[156:159]
    ds_read_b64_tr_b16 a[192:193], v5 offset:16384
    v_cvt_pk_bf16_f32 v241, v162, v163
    v_mfma_f32_16x16x32_bf16 v[156:159], a[168:171], v[76:79], v[156:159]
    v_exp_f32 v165, v165
    v_mfma_f32_16x16x32_bf16 v[156:159], a[172:175], v[80:83], v[156:159]
    ds_read_b64_tr_b16 a[194:195], v5 offset:20480
    v_mul_u32_u24 v23, 34560, v23
    v_mfma_f32_16x16x32_bf16 v[160:163], a[172:175], v[96:99], v[112:115]
    v_exp_f32 v166, v166
    v_mfma_f32_16x16x32_bf16 v[160:163], a[168:171], v[92:95], v[160:163]
    ds_read_b128 a[128:131], v1 offset:0
    v_cvt_pk_bf16_f32 v218, v164, v165
    v_lshrrev_b32 v0, 4, v19
    v_mfma_f32_16x16x32_bf16 v[160:163], a[164:167], v[88:91], v[160:163]
    v_exp_f32 v167, v167
    v_add_u32 v23, v23, v0
    v_mfma_f32_16x16x32_bf16 v[160:163], a[160:163], v[84:87], v[160:163]
    ds_read_b64_tr_b16 a[196:197], v5 offset:40960
    v_and_b32 v0, 8, v19
    v_mfma_f32_16x16x32_bf16 a[96:99], a[208:211], v[180:183], a[96:99]
    v_exp_f32 v168, v168
    v_mfma_f32_16x16x32_bf16 a[96:99], a[212:215], v[184:187], a[96:99]
    ds_read_b64_tr_b16 a[198:199], v5 offset:45056
    v_cvt_pk_bf16_f32 v219, v166, v167
    v_lshrrev_b32 v0, 1, v0
    v_mfma_f32_16x16x32_bf16 a[100:103], a[212:215], v[192:195], a[100:103]
    v_exp_f32 v169, v169
    v_add_lshl_u32 v23, v23, v0, 4
    v_mfma_f32_16x16x32_bf16 a[100:103], a[208:211], v[188:191], a[100:103]
    s_mul_i32 s42, s5, 1080
    ds_read_b128 a[132:135], v2 offset:0
    v_cvt_pk_bf16_f32 v226, v168, v169
    v_mfma_f32_16x16x32_bf16 a[104:107], a[208:211], v[196:199], a[104:107]
    s_add_u32 s42, s42, s6
    v_exp_f32 v170, v170
    v_mfma_f32_16x16x32_bf16 a[104:107], a[212:215], v[200:203], a[104:107]
    s_lshl_b32 s42, s42, 7
    s_mov_b32 m0, s33
    s_nop 0
    buffer_load_dwordx4 v17, s[12:15], s29 offen offset:0 lds
    v_mfma_f32_16x16x32_bf16 a[108:111], a[212:215], v[208:211], a[108:111]
    s_cmp_lt_u32 s6, 216
    s_cselect_b32 s42, s42, 0x438000
    v_exp_f32 v171, v171
    v_mfma_f32_16x16x32_bf16 a[108:111], a[208:211], v[204:207], a[108:111]
    s_waitcnt lgkmcnt(6)
    s_add_u32 m0, s46, 122880
    s_mov_b32 s45, 245760
    buffer_load_dwordx4 v254, s[20:23], s45 offen sc1 lds
    v_mfma_f32_16x16x32_bf16 v[164:167], a[176:179], v[36:39], v[100:103]
    v_exp_f32 v172, v172
    v_mfma_f32_16x16x16_bf16 v[24:27], a[240:241], v[252:253], 0
    v_mfma_f32_16x16x16_bf16 v[28:31], a[242:243], v[252:253], 0
    s_add_u32 m0, s46, 123904
    s_mov_b32 s45, 246784
    buffer_load_dwordx4 v254, s[20:23], s45 offen sc1 lds
    v_mfma_f32_16x16x32_bf16 v[164:167], a[180:183], v[40:43], v[164:167]
    ds_read_b64_tr_b16 a[200:201], v6 offset:16384
    v_cvt_pk_bf16_f32 v227, v170, v171
    v_mfma_f32_16x16x32_bf16 v[164:167], a[184:187], v[44:47], v[164:167]
    v_exp_f32 v173, v173
    v_mfma_f32_16x16x32_bf16 v[164:167], a[188:191], v[48:51], v[164:167]
    ds_read_b64_tr_b16 a[202:203], v6 offset:20480
    v_mfma_f32_16x16x32_bf16 v[168:171], a[188:191], v[64:67], v[104:107]
    v_exp_f32 v174, v174
    v_mfma_f32_16x16x32_bf16 v[168:171], a[184:187], v[60:63], v[168:171]
    ds_read_b128 a[136:139], v3 offset:0
    v_cvt_pk_bf16_f32 v234, v172, v173
    v_mfma_f32_16x16x32_bf16 v[168:171], a[180:183], v[56:59], v[168:171]
    v_exp_f32 v175, v175
    v_mfma_f32_16x16x32_bf16 v[168:171], a[176:179], v[52:55], v[168:171]
    ds_read_b64_tr_b16 a[204:205], v6 offset:40960
    v_mov_b32_dpp v24, v28 row_shr:8 row_mask:0xf bank_mask:0xc
    v_mfma_f32_16x16x32_bf16 a[112:115], a[216:219], v[180:183], a[112:115]
    v_exp_f32 v176, v176
    v_mfma_f32_16x16x32_bf16 a[112:115], a[220:223], v[184:187], a[112:115]
    ds_read_b64_tr_b16 a[206:207], v6 offset:45056
    v_cvt_pk_bf16_f32 v235, v174, v175
    v_mfma_f32_16x16x32_bf16 a[116:119], a[220:223], v[192:195], a[116:119]
    v_exp_f32 v177, v177
    v_mov_b32_dpp v25, v29 row_shr:8 row_mask:0xf bank_mask:0xc
    v_mfma_f32_16x16x32_bf16 a[116:119], a[216:219], v[188:191], a[116:119]
    ds_read_b128 a[140:143], v4 offset:0
    v_mov_b32_dpp v26, v30 row_shr:8 row_mask:0xf bank_mask:0xc
    v_mfma_f32_16x16x32_bf16 a[120:123], a[216:219], v[196:199], a[120:123]
    v_exp_f32 v178, v178
    v_mov_b32_dpp v27, v31 row_shr:8 row_mask:0xf bank_mask:0xc
    v_mfma_f32_16x16x32_bf16 a[120:123], a[220:223], v[200:203], a[120:123]
    buffer_store_dwordx4 v[24:27], v23, s[16:19], s42 offen sc1
    v_cvt_pk_bf16_f32 v242, v176, v177
    v_mfma_f32_16x16x32_bf16 a[124:127], a[220:223], v[208:211], a[124:127]
    s_add_u32 s42, s42, 27648
    v_exp_f32 v179, v179
    v_mfma_f32_16x16x32_bf16 a[124:127], a[216:219], v[204:207], a[124:127]
    s_mov_b32 m0, s33
    s_nop 0
    buffer_load_dwordx4 v18, s[12:15], s29 offen offset:1024 lds
    v_smfmac_f32_16x16x64_bf16 a[236:239], v[244:247], v[204:211], v248
    s_waitcnt lgkmcnt(6)
    ds_read_b64_tr_b16 a[240:241], v22 offset:256
    ds_read_b64_tr_b16 a[242:243], v22 offset:288
    v_mfma_f32_16x16x32_bf16 v[172:175], a[176:179], v[68:71], v[108:111]
    v_exp_f32 v116, v116
    v_mfma_f32_16x16x16_bf16 v[32:35], a[244:245], v[252:253], 0
    v_mfma_f32_16x16x16_bf16 v[28:31], a[246:247], v[252:253], 0
    s_add_u32 m0, s46, 124928
    s_mov_b32 s45, 247808
    buffer_load_dwordx4 v254, s[20:23], s45 offen sc1 lds
    v_mfma_f32_16x16x32_bf16 v[172:175], a[180:183], v[72:75], v[172:175]
    ds_read_b64_tr_b16 a[208:209], v7 offset:16384
    v_cvt_pk_bf16_f32 v243, v178, v179
    v_mfma_f32_16x16x32_bf16 v[172:175], a[184:187], v[76:79], v[172:175]
    v_exp_f32 v117, v117
    v_mfma_f32_16x16x32_bf16 v[172:175], a[188:191], v[80:83], v[172:175]
    ds_read_b64_tr_b16 a[210:211], v7 offset:20480
    v_mfma_f32_16x16x32_bf16 v[176:179], a[188:191], v[96:99], v[112:115]
    v_exp_f32 v118, v118
    v_mfma_f32_16x16x32_bf16 v[176:179], a[184:187], v[92:95], v[176:179]
    ds_read_b128 a[144:147], v1 offset:4096
    v_cvt_pk_bf16_f32 v180, v116, v117
    v_mfma_f32_16x16x32_bf16 v[176:179], a[180:183], v[88:91], v[176:179]
    v_exp_f32 v119, v119
    v_mfma_f32_16x16x32_bf16 v[176:179], a[176:179], v[84:87], v[176:179]
    ds_read_b64_tr_b16 a[212:213], v7 offset:40960
    v_mov_b32_dpp v32, v28 row_shr:8 row_mask:0xf bank_mask:0xc
    v_mfma_f32_16x16x32_bf16 a[0:3], a[192:195], v[212:215], a[0:3]
    v_exp_f32 v120, v120
    v_mfma_f32_16x16x32_bf16 a[0:3], a[196:199], v[216:219], a[0:3]
    ds_read_b64_tr_b16 a[214:215], v7 offset:45056
    v_cvt_pk_bf16_f32 v181, v118, v119
    v_mfma_f32_16x16x32_bf16 a[4:7], a[196:199], v[224:227], a[4:7]
    v_exp_f32 v121, v121
    v_mfma_f32_16x16x32_bf16 a[4:7], a[192:195], v[220:223], a[4:7]
    ds_read_b128 a[148:151], v2 offset:4096
    v_cvt_pk_bf16_f32 v188, v120, v121
    v_mov_b32_dpp v33, v29 row_shr:8 row_mask:0xf bank_mask:0xc
    v_mfma_f32_16x16x32_bf16 a[8:11], a[192:195], v[228:231], a[8:11]
    v_exp_f32 v122, v122
    v_mov_b32_dpp v34, v30 row_shr:8 row_mask:0xf bank_mask:0xc
    v_mfma_f32_16x16x32_bf16 a[8:11], a[196:199], v[232:235], a[8:11]
    s_mov_b32 m0, s33
    s_nop 0
    buffer_load_dwordx4 v17, s[12:15], s29 offen offset:2048 lds
    v_mov_b32_dpp v35, v31 row_shr:8 row_mask:0xf bank_mask:0xc
    v_mfma_f32_16x16x32_bf16 a[12:15], a[196:199], v[240:243], a[12:15]
    buffer_store_dwordx4 v[32:35], v23, s[16:19], s42 offen sc1
    v_exp_f32 v123, v123
    v_mfma_f32_16x16x32_bf16 a[12:15], a[192:195], v[236:239], a[12:15]
    s_waitcnt lgkmcnt(6)
    s_add_u32 s42, s42, 27648
    s_add_u32 m0, s46, 125952
    s_mov_b32 s45, 248832
    buffer_load_dwordx4 v254, s[20:23], s45 offen sc1 lds
    v_mfma_f32_16x16x32_bf16 v[116:119], a[128:131], v[36:39], v[100:103]
    v_exp_f32 v124, v124
    v_mfma_f32_16x16x16_bf16 v[24:27], a[248:249], v[252:253], 0
    v_mfma_f32_16x16x16_bf16 v[28:31], a[250:251], v[252:253], 0
    s_add_u32 m0, s46, 126976
    s_mov_b32 s45, 249856
    buffer_load_dwordx4 v254, s[20:23], s45 offen sc1 lds
    v_mfma_f32_16x16x32_bf16 v[116:119], a[132:135], v[40:43], v[116:119]
    ds_read_b64_tr_b16 a[216:217], v8 offset:16384
    v_cvt_pk_bf16_f32 v189, v122, v123
    v_mfma_f32_16x16x32_bf16 v[116:119], a[136:139], v[44:47], v[116:119]
    v_exp_f32 v125, v125
    v_mfma_f32_16x16x32_bf16 v[116:119], a[140:143], v[48:51], v[116:119]
    ds_read_b64_tr_b16 a[218:219], v8 offset:20480
    v_mfma_f32_16x16x32_bf16 v[120:123], a[140:143], v[64:67], v[104:107]
    v_exp_f32 v126, v126
    v_mfma_f32_16x16x32_bf16 v[120:123], a[136:139], v[60:63], v[120:123]
    ds_read_b128 a[152:155], v3 offset:4096
    v_cvt_pk_bf16_f32 v196, v124, v125
    v_mfma_f32_16x16x32_bf16 v[120:123], a[132:135], v[56:59], v[120:123]
    v_exp_f32 v127, v127
    v_mfma_f32_16x16x32_bf16 v[120:123], a[128:131], v[52:55], v[120:123]
    ds_read_b64_tr_b16 a[220:221], v8 offset:40960
    v_mov_b32_dpp v24, v28 row_shr:8 row_mask:0xf bank_mask:0xc
    v_mfma_f32_16x16x32_bf16 a[16:19], a[200:203], v[212:215], a[16:19]
    v_exp_f32 v128, v128
    v_mfma_f32_16x16x32_bf16 a[16:19], a[204:207], v[216:219], a[16:19]
    ds_read_b64_tr_b16 a[222:223], v8 offset:45056
    v_cvt_pk_bf16_f32 v197, v126, v127
    v_mfma_f32_16x16x32_bf16 a[20:23], a[204:207], v[224:227], a[20:23]
    v_exp_f32 v129, v129
    v_mfma_f32_16x16x32_bf16 a[20:23], a[200:203], v[220:223], a[20:23]
    ds_read_b128 a[156:159], v4 offset:4096
    v_mov_b32_dpp v25, v29 row_shr:8 row_mask:0xf bank_mask:0xc
    v_mfma_f32_16x16x32_bf16 a[24:27], a[200:203], v[228:231], a[24:27]
    v_exp_f32 v130, v130
    v_mfma_f32_16x16x32_bf16 a[24:27], a[204:207], v[232:235], a[24:27]
    v_cvt_pk_bf16_f32 v204, v128, v129
    v_mov_b32_dpp v26, v30 row_shr:8 row_mask:0xf bank_mask:0xc
    v_mfma_f32_16x16x32_bf16 a[28:31], a[204:207], v[240:243], a[28:31]
    v_exp_f32 v131, v131
    v_mov_b32_dpp v27, v31 row_shr:8 row_mask:0xf bank_mask:0xc
    v_mfma_f32_16x16x32_bf16 a[28:31], a[200:203], v[236:239], a[28:31]
    s_mov_b32 m0, s33
    s_nop 0
    buffer_load_dwordx4 v18, s[12:15], s29 offen offset:3072 lds
    buffer_store_dwordx4 v[24:27], v23, s[16:19], s42 offen sc1
    v_smfmac_f32_16x16x64_bf16 a[224:227], v[244:247], v[212:219], v248
    s_waitcnt lgkmcnt(6)
    s_add_u32 s29, s29, 16384
    s_add_u32 s42, s42, 27648
    s_add_u32 m0, s46, 128000
    s_mov_b32 s45, 266240
    buffer_load_dwordx4 v254, s[20:23], s45 offen sc1 lds
    v_mfma_f32_16x16x32_bf16 v[124:127], a[128:131], v[68:71], v[108:111]
    v_exp_f32 v132, v132
    v_mfma_f32_16x16x16_bf16 v[32:35], a[252:253], v[252:253], 0
    v_mfma_f32_16x16x16_bf16 v[28:31], a[254:255], v[252:253], 0
    s_add_u32 m0, s46, 129024
    s_mov_b32 s45, 267264
    buffer_load_dwordx4 v254, s[20:23], s45 offen sc1 lds
    v_mfma_f32_16x16x32_bf16 v[124:127], a[132:135], v[72:75], v[124:127]
    ds_read_b64_tr_b16 a[192:193], v9 offset:16384
    v_cvt_pk_bf16_f32 v205, v130, v131
    v_mfma_f32_16x16x32_bf16 v[124:127], a[136:139], v[76:79], v[124:127]
    v_exp_f32 v133, v133
    v_mfma_f32_16x16x32_bf16 v[124:127], a[140:143], v[80:83], v[124:127]
    ds_read_b64_tr_b16 a[194:195], v9 offset:20480
    v_mfma_f32_16x16x32_bf16 v[128:131], a[140:143], v[96:99], v[112:115]
    v_exp_f32 v134, v134
    v_mfma_f32_16x16x32_bf16 v[128:131], a[136:139], v[92:95], v[128:131]
    ds_read_b128 a[160:163], v1 offset:8192
    v_cvt_pk_bf16_f32 v182, v132, v133
    v_mfma_f32_16x16x32_bf16 v[128:131], a[132:135], v[88:91], v[128:131]
    v_exp_f32 v135, v135
    v_mfma_f32_16x16x32_bf16 v[128:131], a[128:131], v[84:87], v[128:131]
    ds_read_b64_tr_b16 a[196:197], v9 offset:40960
    v_mov_b32_dpp v32, v28 row_shr:8 row_mask:0xf bank_mask:0xc
    v_mfma_f32_16x16x32_bf16 a[32:35], a[208:211], v[212:215], a[32:35]
    v_exp_f32 v136, v136
    v_mfma_f32_16x16x32_bf16 a[32:35], a[212:215], v[216:219], a[32:35]
    ds_read_b64_tr_b16 a[198:199], v9 offset:45056
    v_cvt_pk_bf16_f32 v183, v134, v135
    v_mfma_f32_16x16x32_bf16 a[36:39], a[212:215], v[224:227], a[36:39]
    v_exp_f32 v137, v137
    v_mfma_f32_16x16x32_bf16 a[36:39], a[208:211], v[220:223], a[36:39]
    ds_read_b128 a[164:167], v2 offset:8192
    v_mov_b32_dpp v33, v29 row_shr:8 row_mask:0xf bank_mask:0xc
    v_mfma_f32_16x16x32_bf16 a[40:43], a[208:211], v[228:231], a[40:43]
    v_exp_f32 v138, v138
    v_mov_b32_dpp v34, v30 row_shr:8 row_mask:0xf bank_mask:0xc
    v_mfma_f32_16x16x32_bf16 a[40:43], a[212:215], v[232:235], a[40:43]
    v_cvt_pk_bf16_f32 v190, v136, v137
    v_mov_b32_dpp v35, v31 row_shr:8 row_mask:0xf bank_mask:0xc
    v_mfma_f32_16x16x32_bf16 a[44:47], a[212:215], v[240:243], a[44:47]
    buffer_store_dwordx4 v[32:35], v23, s[16:19], s42 offen sc1
    v_exp_f32 v139, v139
    v_mfma_f32_16x16x32_bf16 a[44:47], a[208:211], v[236:239], a[44:47]
    s_waitcnt lgkmcnt(6)
    s_add_u32 s42, s42, 27648
    s_add_u32 m0, s46, 130048
    s_mov_b32 s45, 268288
    buffer_load_dwordx4 v254, s[20:23], s45 offen sc1 lds
    v_mfma_f32_16x16x32_bf16 v[132:135], a[144:147], v[36:39], v[100:103]
    v_exp_f32 v140, v140
    v_mfma_f32_16x16x16_bf16 v[24:27], a[240:241], v[252:253], 0
    v_mfma_f32_16x16x16_bf16 v[28:31], a[242:243], v[252:253], 0
    s_add_u32 m0, s46, 131072
    s_mov_b32 s45, 269312
    buffer_load_dwordx4 v254, s[20:23], s45 offen sc1 lds
    v_mfma_f32_16x16x32_bf16 v[132:135], a[148:151], v[40:43], v[132:135]
    ds_read_b64_tr_b16 a[200:201], v10 offset:16384
    v_cvt_pk_bf16_f32 v191, v138, v139
    v_mfma_f32_16x16x32_bf16 v[132:135], a[152:155], v[44:47], v[132:135]
    v_exp_f32 v141, v141
    v_mfma_f32_16x16x32_bf16 v[132:135], a[156:159], v[48:51], v[132:135]
    ds_read_b64_tr_b16 a[202:203], v10 offset:20480
    v_mfma_f32_16x16x32_bf16 v[136:139], a[156:159], v[64:67], v[104:107]
    v_exp_f32 v142, v142
    v_mfma_f32_16x16x32_bf16 v[136:139], a[152:155], v[60:63], v[136:139]
    ds_read_b128 a[168:171], v3 offset:8192
    v_cvt_pk_bf16_f32 v198, v140, v141
    v_mfma_f32_16x16x32_bf16 v[136:139], a[148:151], v[56:59], v[136:139]
    v_exp_f32 v143, v143
    v_mfma_f32_16x16x32_bf16 v[136:139], a[144:147], v[52:55], v[136:139]
    ds_read_b64_tr_b16 a[204:205], v10 offset:40960
    v_mov_b32_dpp v24, v28 row_shr:8 row_mask:0xf bank_mask:0xc
    v_mfma_f32_16x16x32_bf16 a[48:51], a[216:219], v[212:215], a[48:51]
    v_exp_f32 v144, v144
    v_mfma_f32_16x16x32_bf16 a[48:51], a[220:223], v[216:219], a[48:51]
    ds_read_b64_tr_b16 a[206:207], v10 offset:45056
    v_cvt_pk_bf16_f32 v199, v142, v143
    v_mfma_f32_16x16x32_bf16 a[52:55], a[220:223], v[224:227], a[52:55]
    v_exp_f32 v145, v145
    v_mfma_f32_16x16x32_bf16 a[52:55], a[216:219], v[220:223], a[52:55]
    ds_read_b128 a[172:175], v4 offset:8192
    v_mov_b32_dpp v25, v29 row_shr:8 row_mask:0xf bank_mask:0xc
    v_mfma_f32_16x16x32_bf16 a[56:59], a[216:219], v[228:231], a[56:59]
    v_exp_f32 v146, v146
    v_mfma_f32_16x16x32_bf16 a[56:59], a[220:223], v[232:235], a[56:59]
    v_cvt_pk_bf16_f32 v206, v144, v145
    v_mov_b32_dpp v26, v30 row_shr:8 row_mask:0xf bank_mask:0xc
    v_mfma_f32_16x16x32_bf16 a[60:63], a[220:223], v[240:243], a[60:63]
    v_exp_f32 v147, v147
    v_mov_b32_dpp v27, v31 row_shr:8 row_mask:0xf bank_mask:0xc
    v_mfma_f32_16x16x32_bf16 a[60:63], a[216:219], v[236:239], a[60:63]
    buffer_store_dwordx4 v[24:27], v23, s[16:19], s42 offen sc1
    v_smfmac_f32_16x16x64_bf16 a[228:231], v[244:247], v[220:227], v248
    s_waitcnt lgkmcnt(6)
    s_add_u32 s42, s42, 27648
    s_add_u32 m0, s46, 132096
    s_mov_b32 s45, 270336
    buffer_load_dwordx4 v254, s[20:23], s45 offen sc1 lds
    v_mfma_f32_16x16x32_bf16 v[140:143], a[144:147], v[68:71], v[108:111]
    v_exp_f32 v148, v148
    v_mfma_f32_16x16x32_bf16 v[140:143], a[148:151], v[72:75], v[140:143]
    ds_read_b64_tr_b16 a[208:209], v11 offset:16384
    v_cvt_pk_bf16_f32 v207, v146, v147
    v_mfma_f32_16x16x32_bf16 v[140:143], a[152:155], v[76:79], v[140:143]
    v_exp_f32 v149, v149
    v_mfma_f32_16x16x32_bf16 v[140:143], a[156:159], v[80:83], v[140:143]
    ds_read_b64_tr_b16 a[210:211], v11 offset:20480
    v_mfma_f32_16x16x32_bf16 v[144:147], a[156:159], v[96:99], v[112:115]
    v_exp_f32 v150, v150
    v_mfma_f32_16x16x32_bf16 v[144:147], a[152:155], v[92:95], v[144:147]
    ds_read_b128 a[176:179], v1 offset:12288
    v_cvt_pk_bf16_f32 v184, v148, v149
    v_mfma_f32_16x16x32_bf16 v[144:147], a[148:151], v[88:91], v[144:147]
    v_exp_f32 v151, v151
    v_mfma_f32_16x16x32_bf16 v[144:147], a[144:147], v[84:87], v[144:147]
    ds_read_b64_tr_b16 a[212:213], v11 offset:40960
    v_mfma_f32_16x16x32_bf16 a[64:67], a[192:195], v[212:215], a[64:67]
    v_exp_f32 v152, v152
    v_mfma_f32_16x16x32_bf16 a[64:67], a[196:199], v[216:219], a[64:67]
    ds_read_b64_tr_b16 a[214:215], v11 offset:45056
    v_cvt_pk_bf16_f32 v185, v150, v151
    v_mfma_f32_16x16x32_bf16 a[68:71], a[196:199], v[224:227], a[68:71]
    v_exp_f32 v153, v153
    v_mfma_f32_16x16x32_bf16 a[68:71], a[192:195], v[220:223], a[68:71]
    ds_read_b128 a[180:183], v2 offset:12288
    v_mfma_f32_16x16x32_bf16 a[72:75], a[192:195], v[228:231], a[72:75]
    v_exp_f32 v154, v154
    v_mfma_f32_16x16x32_bf16 a[72:75], a[196:199], v[232:235], a[72:75]
    v_cvt_pk_bf16_f32 v192, v152, v153
    v_mfma_f32_16x16x32_bf16 a[76:79], a[196:199], v[240:243], a[76:79]
    v_exp_f32 v155, v155
    v_mfma_f32_16x16x32_bf16 a[76:79], a[192:195], v[236:239], a[76:79]
    s_waitcnt lgkmcnt(6)
    v_mfma_f32_16x16x32_bf16 v[148:151], a[160:163], v[36:39], v[100:103]
    v_exp_f32 v156, v156
    v_mfma_f32_16x16x32_bf16 v[148:151], a[164:167], v[40:43], v[148:151]
    ds_read_b64_tr_b16 a[216:217], v12 offset:16384
    v_cvt_pk_bf16_f32 v193, v154, v155
    v_mfma_f32_16x16x32_bf16 v[148:151], a[168:171], v[44:47], v[148:151]
    v_exp_f32 v157, v157
    v_mfma_f32_16x16x32_bf16 v[148:151], a[172:175], v[48:51], v[148:151]
    ds_read_b64_tr_b16 a[218:219], v12 offset:20480
    v_mfma_f32_16x16x32_bf16 v[152:155], a[172:175], v[64:67], v[104:107]
    v_exp_f32 v158, v158
    v_mfma_f32_16x16x32_bf16 v[152:155], a[168:171], v[60:63], v[152:155]
    ds_read_b128 a[184:187], v3 offset:12288
    v_cvt_pk_bf16_f32 v200, v156, v157
    v_mfma_f32_16x16x32_bf16 v[152:155], a[164:167], v[56:59], v[152:155]
    v_exp_f32 v159, v159
    v_mfma_f32_16x16x32_bf16 v[152:155], a[160:163], v[52:55], v[152:155]
    ds_read_b64_tr_b16 a[220:221], v12 offset:40960
    v_mfma_f32_16x16x32_bf16 a[80:83], a[200:203], v[212:215], a[80:83]
    v_exp_f32 v160, v160
    v_mfma_f32_16x16x32_bf16 a[80:83], a[204:207], v[216:219], a[80:83]
    ds_read_b64_tr_b16 a[222:223], v12 offset:45056
    v_cvt_pk_bf16_f32 v201, v158, v159
    v_mfma_f32_16x16x32_bf16 a[84:87], a[204:207], v[224:227], a[84:87]
    v_exp_f32 v161, v161
    v_mfma_f32_16x16x32_bf16 a[84:87], a[200:203], v[220:223], a[84:87]
    ds_read_b128 a[188:191], v4 offset:12288
    v_mfma_f32_16x16x32_bf16 a[88:91], a[200:203], v[228:231], a[88:91]
    v_exp_f32 v162, v162
    v_mfma_f32_16x16x32_bf16 a[88:91], a[204:207], v[232:235], a[88:91]
    v_cvt_pk_bf16_f32 v208, v160, v161
    v_mfma_f32_16x16x32_bf16 a[92:95], a[204:207], v[240:243], a[92:95]
    v_exp_f32 v163, v163
    v_mfma_f32_16x16x32_bf16 a[92:95], a[200:203], v[236:239], a[92:95]
    v_smfmac_f32_16x16x64_bf16 a[232:235], v[244:247], v[228:235], v248
    s_waitcnt vmcnt(19) lgkmcnt(0)
    s_barrier
    v_mfma_f32_16x16x32_bf16 v[156:159], a[160:163], v[68:71], v[108:111]
    v_exp_f32 v164, v164
    v_mfma_f32_16x16x32_bf16 v[156:159], a[164:167], v[72:75], v[156:159]
    ds_read_b64_tr_b16 a[192:193], v5 offset:57344
    v_cvt_pk_bf16_f32 v209, v162, v163
    v_mfma_f32_16x16x32_bf16 v[156:159], a[168:171], v[76:79], v[156:159]
    v_exp_f32 v165, v165
    v_mfma_f32_16x16x32_bf16 v[156:159], a[172:175], v[80:83], v[156:159]
    ds_read_b64_tr_b16 a[194:195], v5 offset:61440
    v_mfma_f32_16x16x32_bf16 v[160:163], a[172:175], v[96:99], v[112:115]
    v_exp_f32 v166, v166
    v_mfma_f32_16x16x32_bf16 v[160:163], a[168:171], v[92:95], v[160:163]
    ds_read_b64_tr_b16 a[196:197], v5 offset:0
    v_cvt_pk_bf16_f32 v186, v164, v165
    v_mfma_f32_16x16x32_bf16 v[160:163], a[164:167], v[88:91], v[160:163]
    s_add_u32 m0, s46, 81920
    s_mov_b32 s45, 286720
    buffer_load_dwordx4 v254, s[20:23], s45 offen sc1 lds
    v_exp_f32 v167, v167
    v_mfma_f32_16x16x32_bf16 v[160:163], a[160:163], v[84:87], v[160:163]
    ds_read_b64_tr_b16 a[198:199], v5 offset:4096
    v_mfma_f32_16x16x32_bf16 a[96:99], a[208:211], v[212:215], a[96:99]
    v_exp_f32 v168, v168
    v_mfma_f32_16x16x32_bf16 a[96:99], a[212:215], v[216:219], a[96:99]
    v_cvt_pk_bf16_f32 v187, v166, v167
    v_mfma_f32_16x16x32_bf16 a[100:103], a[212:215], v[224:227], a[100:103]
    v_exp_f32 v169, v169
    v_mfma_f32_16x16x32_bf16 a[100:103], a[208:211], v[220:223], a[100:103]
    s_add_u32 m0, s46, 82944
    s_mov_b32 s45, 287744
    buffer_load_dwordx4 v254, s[20:23], s45 offen sc1 lds
    v_mfma_f32_16x16x32_bf16 a[104:107], a[208:211], v[228:231], a[104:107]
    v_exp_f32 v170, v170
    v_mfma_f32_16x16x32_bf16 a[104:107], a[212:215], v[232:235], a[104:107]
    v_cvt_pk_bf16_f32 v194, v168, v169
    v_mfma_f32_16x16x32_bf16 a[108:111], a[212:215], v[240:243], a[108:111]
    v_exp_f32 v171, v171
    v_mfma_f32_16x16x32_bf16 a[108:111], a[208:211], v[236:239], a[108:111]
    s_waitcnt lgkmcnt(4)
    s_add_u32 m0, s46, 83968
    s_mov_b32 s45, 288768
    buffer_load_dwordx4 v254, s[20:23], s45 offen sc1 lds
    v_mfma_f32_16x16x32_bf16 v[164:167], a[176:179], v[36:39], v[100:103]
    v_exp_f32 v172, v172
    v_mfma_f32_16x16x32_bf16 v[164:167], a[180:183], v[40:43], v[164:167]
    ds_read_b64_tr_b16 a[200:201], v6 offset:57344
    v_cvt_pk_bf16_f32 v195, v170, v171
    v_mfma_f32_16x16x32_bf16 v[164:167], a[184:187], v[44:47], v[164:167]
    v_exp_f32 v173, v173
    v_mfma_f32_16x16x32_bf16 v[164:167], a[188:191], v[48:51], v[164:167]
    ds_read_b64_tr_b16 a[202:203], v6 offset:61440
    v_mfma_f32_16x16x32_bf16 v[168:171], a[188:191], v[64:67], v[104:107]
    v_exp_f32 v174, v174
    v_mfma_f32_16x16x32_bf16 v[168:171], a[184:187], v[60:63], v[168:171]
    ds_read_b64_tr_b16 a[204:205], v6 offset:0
    v_cvt_pk_bf16_f32 v202, v172, v173
    v_mfma_f32_16x16x32_bf16 v[168:171], a[180:183], v[56:59], v[168:171]
    v_exp_f32 v175, v175
    v_mfma_f32_16x16x32_bf16 v[168:171], a[176:179], v[52:55], v[168:171]
    ds_read_b64_tr_b16 a[206:207], v6 offset:4096
    v_mfma_f32_16x16x32_bf16 a[112:115], a[216:219], v[212:215], a[112:115]
    v_exp_f32 v176, v176
    v_mfma_f32_16x16x32_bf16 a[112:115], a[220:223], v[216:219], a[112:115]
    v_cvt_pk_bf16_f32 v203, v174, v175
    v_mfma_f32_16x16x32_bf16 a[116:119], a[220:223], v[224:227], a[116:119]
    s_add_u32 m0, s46, 84992
    s_mov_b32 s45, 289792
    buffer_load_dwordx4 v254, s[20:23], s45 offen sc1 lds
    v_exp_f32 v177, v177
    v_mfma_f32_16x16x32_bf16 a[116:119], a[216:219], v[220:223], a[116:119]
    s_add_u32 m0, s46, 86016
    s_mov_b32 s45, 290816
    buffer_load_dwordx4 v254, s[20:23], s45 offen sc1 lds
    v_mfma_f32_16x16x32_bf16 a[120:123], a[216:219], v[228:231], a[120:123]
    v_exp_f32 v178, v178
    v_mfma_f32_16x16x32_bf16 a[120:123], a[220:223], v[232:235], a[120:123]
    v_cvt_pk_bf16_f32 v210, v176, v177
    v_mfma_f32_16x16x32_bf16 a[124:127], a[220:223], v[240:243], a[124:127]
    v_exp_f32 v179, v179
    v_mfma_f32_16x16x32_bf16 a[124:127], a[216:219], v[236:239], a[124:127]
    v_smfmac_f32_16x16x64_bf16 a[236:239], v[244:247], v[236:243], v248
    s_waitcnt lgkmcnt(4)
    v_mfma_f32_16x16x32_bf16 v[172:175], a[176:179], v[68:71], v[108:111]
    v_exp_f32 v116, v116
    v_mfma_f32_16x16x32_bf16 v[172:175], a[180:183], v[72:75], v[172:175]
    ds_read_b64_tr_b16 a[208:209], v7 offset:57344
    v_cvt_pk_bf16_f32 v211, v178, v179
    v_mfma_f32_16x16x32_bf16 v[172:175], a[184:187], v[76:79], v[172:175]
    v_exp_f32 v117, v117
    v_mfma_f32_16x16x32_bf16 v[172:175], a[188:191], v[80:83], v[172:175]
    ds_read_b64_tr_b16 a[210:211], v7 offset:61440
    v_mfma_f32_16x16x32_bf16 v[176:179], a[188:191], v[96:99], v[112:115]
    v_exp_f32 v118, v118
    v_mfma_f32_16x16x32_bf16 v[176:179], a[184:187], v[92:95], v[176:179]
    ds_read_b64_tr_b16 a[212:213], v7 offset:0
    v_cvt_pk_bf16_f32 v212, v116, v117
    v_mfma_f32_16x16x32_bf16 v[176:179], a[180:183], v[88:91], v[176:179]
    v_exp_f32 v119, v119
    v_mfma_f32_16x16x32_bf16 v[176:179], a[176:179], v[84:87], v[176:179]
    ds_read_b64_tr_b16 a[214:215], v7 offset:4096
    v_mfma_f32_16x16x32_bf16 a[0:3], a[192:195], v[180:183], a[0:3]
    v_exp_f32 v120, v120
    v_mfma_f32_16x16x32_bf16 a[0:3], a[196:199], v[184:187], a[0:3]
    s_add_u32 m0, s46, 87040
    s_mov_b32 s45, 307200
    buffer_load_dwordx4 v254, s[20:23], s45 offen sc1 lds
    v_cvt_pk_bf16_f32 v213, v118, v119
    v_mfma_f32_16x16x32_bf16 a[4:7], a[196:199], v[192:195], a[4:7]
    v_exp_f32 v121, v121
    v_mfma_f32_16x16x32_bf16 a[4:7], a[192:195], v[188:191], a[4:7]
    s_add_u32 m0, s46, 88064
    s_mov_b32 s45, 308224
    buffer_load_dwordx4 v254, s[20:23], s45 offen sc1 lds
    v_mfma_f32_16x16x32_bf16 a[8:11], a[192:195], v[196:199], a[8:11]
    v_exp_f32 v122, v122
    v_mfma_f32_16x16x32_bf16 a[8:11], a[196:199], v[200:203], a[8:11]
    v_cvt_pk_bf16_f32 v220, v120, v121
    v_mfma_f32_16x16x32_bf16 a[12:15], a[196:199], v[208:211], a[12:15]
    v_exp_f32 v123, v123
    v_mfma_f32_16x16x32_bf16 a[12:15], a[192:195], v[204:207], a[12:15]
    s_waitcnt lgkmcnt(4)
    s_add_u32 m0, s46, 89088
    s_mov_b32 s45, 309248
    buffer_load_dwordx4 v254, s[20:23], s45 offen sc1 lds
    v_mfma_f32_16x16x32_bf16 a[16:19], a[200:203], v[180:183], a[16:19]
    ds_read_b64_tr_b16 a[216:217], v8 offset:57344
    v_cvt_pk_bf16_f32 v221, v122, v123
    v_exp_f32 v124, v124
    v_mfma_f32_16x16x32_bf16 a[16:19], a[204:207], v[184:187], a[16:19]
    ds_read_b64_tr_b16 a[218:219], v8 offset:61440
    v_exp_f32 v125, v125
    v_mfma_f32_16x16x32_bf16 a[20:23], a[204:207], v[192:195], a[20:23]
    ds_read_b64_tr_b16 a[220:221], v8 offset:0
    v_cvt_pk_bf16_f32 v228, v124, v125
    v_exp_f32 v126, v126
    v_mov_b32 v114, v254
    v_mfma_f32_16x16x32_bf16 a[20:23], a[200:203], v[188:191], a[20:23]
    ds_read_b64_tr_b16 a[222:223], v8 offset:4096
    v_exp_f32 v127, v127
    v_mfma_f32_16x16x32_bf16 a[24:27], a[200:203], v[196:199], a[24:27]
    v_cvt_pk_bf16_f32 v229, v126, v127
    v_exp_f32 v128, v128
    v_mfma_f32_16x16x32_bf16 a[24:27], a[204:207], v[200:203], a[24:27]
    v_exp_f32 v129, v129
    v_add_u32 v115, 4096, v254
    v_mfma_f32_16x16x32_bf16 a[28:31], a[204:207], v[208:211], a[28:31]
    v_cvt_pk_bf16_f32 v236, v128, v129
    v_exp_f32 v130, v130
    v_mfma_f32_16x16x32_bf16 a[28:31], a[200:203], v[204:207], a[28:31]
    v_exp_f32 v131, v131
    v_smfmac_f32_16x16x64_bf16 a[224:227], v[244:247], v[180:187], v248
    s_waitcnt lgkmcnt(4)
    s_add_u32 m0, s46, 90112
    s_mov_b32 s45, 310272
    buffer_load_dwordx4 v254, s[20:23], s45 offen sc1 lds
    v_mov_b32 v0, 2
    v_mfma_f32_16x16x32_bf16 a[32:35], a[208:211], v[180:183], a[32:35]
    ds_read_b64_tr_b16 a[192:193], v9 offset:57344
    v_cvt_pk_bf16_f32 v237, v130, v131
    v_exp_f32 v132, v132
    v_mfma_f32_16x16x32_bf16 a[32:35], a[212:215], v[184:187], a[32:35]
    ds_read_b64_tr_b16 a[194:195], v9 offset:61440
    v_exp_f32 v133, v133
    v_mfma_f32_16x16x32_bf16 a[36:39], a[212:215], v[192:195], a[36:39]
    ds_read_b64_tr_b16 a[196:197], v9 offset:0
    v_cvt_pk_bf16_f32 v214, v132, v133
    v_exp_f32 v134, v134
    v_mfma_f32_16x16x32_bf16 a[36:39], a[208:211], v[188:191], a[36:39]
    ds_read_b64_tr_b16 a[198:199], v9 offset:4096
    v_exp_f32 v135, v135
    v_mfma_f32_16x16x32_bf16 a[40:43], a[208:211], v[196:199], a[40:43]
    v_cvt_pk_bf16_f32 v215, v134, v135
    v_exp_f32 v136, v136
    v_mfma_f32_16x16x32_bf16 a[40:43], a[212:215], v[200:203], a[40:43]
    v_exp_f32 v137, v137
    v_mfma_f32_16x16x32_bf16 a[44:47], a[212:215], v[208:211], a[44:47]
    v_cvt_pk_bf16_f32 v222, v136, v137
    v_exp_f32 v138, v138
    v_mfma_f32_16x16x32_bf16 a[44:47], a[208:211], v[204:207], a[44:47]
    s_waitcnt lgkmcnt(4)
    s_add_u32 m0, s46, 91136
    s_mov_b32 s45, 311296
    buffer_load_dwordx4 v254, s[20:23], s45 offen sc1 lds
    v_exp_f32 v139, v139
    v_mfma_f32_16x16x32_bf16 a[48:51], a[216:219], v[180:183], a[48:51]
    s_mov_b32 s45, 0
    ds_read_b64_tr_b16 a[200:201], v10 offset:57344
    v_cvt_pk_bf16_f32 v223, v138, v139
    v_exp_f32 v140, v140
    v_mfma_f32_16x16x32_bf16 a[48:51], a[220:223], v[184:187], a[48:51]
    ds_read_b64_tr_b16 a[202:203], v10 offset:61440
    v_exp_f32 v141, v141
    v_mfma_f32_16x16x32_bf16 a[52:55], a[220:223], v[192:195], a[52:55]
    ds_read_b64_tr_b16 a[204:205], v10 offset:0
    buffer_load_dwordx4 a[128:131], v114, s[20:23], s45 offen offset:0 sc1
    v_cvt_pk_bf16_f32 v230, v140, v141
    v_exp_f32 v142, v142
    v_mfma_f32_16x16x32_bf16 a[52:55], a[216:219], v[188:191], a[52:55]
    s_mov_b32 s45, 0
    ds_read_b64_tr_b16 a[206:207], v10 offset:4096
    v_exp_f32 v143, v143
    v_mfma_f32_16x16x32_bf16 a[56:59], a[216:219], v[196:199], a[56:59]
    v_cvt_pk_bf16_f32 v231, v142, v143
    v_exp_f32 v144, v144
    v_mfma_f32_16x16x32_bf16 a[56:59], a[220:223], v[200:203], a[56:59]
    buffer_load_dwordx4 a[132:135], v114, s[20:23], s45 offen offset:1024 sc1
    v_exp_f32 v145, v145
    v_mfma_f32_16x16x32_bf16 a[60:63], a[220:223], v[208:211], a[60:63]
    s_mov_b32 s45, 0
    v_cvt_pk_bf16_f32 v238, v144, v145
    v_exp_f32 v146, v146
    v_mfma_f32_16x16x32_bf16 a[60:63], a[216:219], v[204:207], a[60:63]
    v_exp_f32 v147, v147
    v_smfmac_f32_16x16x64_bf16 a[228:231], v[244:247], v[188:195], v248
    s_waitcnt lgkmcnt(4)
    buffer_load_dwordx4 a[136:139], v114, s[20:23], s45 offen offset:2048 sc1
    v_mfma_f32_16x16x32_bf16 a[64:67], a[192:195], v[180:183], a[64:67]
    s_mov_b32 s45, 0
    ds_read_b64_tr_b16 a[208:209], v11 offset:57344
    v_cvt_pk_bf16_f32 v239, v146, v147
    v_exp_f32 v148, v148
    v_mfma_f32_16x16x32_bf16 a[64:67], a[196:199], v[184:187], a[64:67]
    ds_read_b64_tr_b16 a[210:211], v11 offset:61440
    buffer_load_dwordx4 a[140:143], v114, s[20:23], s45 offen offset:3072 sc1
    v_exp_f32 v149, v149
    v_mfma_f32_16x16x32_bf16 a[68:71], a[196:199], v[192:195], a[68:71]
    s_mov_b32 s45, 0
    ds_read_b64_tr_b16 a[212:213], v11 offset:0
    v_cvt_pk_bf16_f32 v216, v148, v149
    v_exp_f32 v150, v150
    v_mfma_f32_16x16x32_bf16 a[68:71], a[192:195], v[188:191], a[68:71]
    ds_read_b64_tr_b16 a[214:215], v11 offset:4096
    v_exp_f32 v151, v151
    v_mfma_f32_16x16x32_bf16 a[72:75], a[192:195], v[196:199], a[72:75]
    buffer_load_dwordx4 a[144:147], v115, s[20:23], s45 offen offset:0 sc1
    v_cvt_pk_bf16_f32 v217, v150, v151
    v_exp_f32 v152, v152
    v_mfma_f32_16x16x32_bf16 a[72:75], a[196:199], v[200:203], a[72:75]
    s_mov_b32 s45, 20480
    v_exp_f32 v153, v153
    v_mfma_f32_16x16x32_bf16 a[76:79], a[196:199], v[208:211], a[76:79]
    buffer_load_dwordx4 a[148:151], v114, s[20:23], s45 offen offset:0 sc1
    v_cvt_pk_bf16_f32 v224, v152, v153
    v_exp_f32 v154, v154
    v_mfma_f32_16x16x32_bf16 a[76:79], a[192:195], v[204:207], a[76:79]
    s_waitcnt lgkmcnt(4)
    v_exp_f32 v155, v155
    v_mfma_f32_16x16x32_bf16 a[80:83], a[200:203], v[180:183], a[80:83]
    s_mov_b32 s45, 20480
    ds_read_b64_tr_b16 a[216:217], v12 offset:57344
    v_cvt_pk_bf16_f32 v225, v154, v155
    v_exp_f32 v156, v156
    v_mfma_f32_16x16x32_bf16 a[80:83], a[204:207], v[184:187], a[80:83]
    ds_read_b64_tr_b16 a[218:219], v12 offset:61440
    buffer_load_dwordx4 a[152:155], v114, s[20:23], s45 offen offset:1024 sc1
    v_exp_f32 v157, v157
    v_mfma_f32_16x16x32_bf16 a[84:87], a[204:207], v[192:195], a[84:87]
    s_mov_b32 s45, 20480
    ds_read_b64_tr_b16 a[220:221], v12 offset:0
    v_cvt_pk_bf16_f32 v232, v156, v157
    v_exp_f32 v158, v158
    v_mfma_f32_16x16x32_bf16 a[84:87], a[200:203], v[188:191], a[84:87]
    ds_read_b64_tr_b16 a[222:223], v12 offset:4096
    v_exp_f32 v159, v159
    v_mfma_f32_16x16x32_bf16 a[88:91], a[200:203], v[196:199], a[88:91]
    buffer_load_dwordx4 a[156:159], v114, s[20:23], s45 offen offset:2048 sc1
    v_cvt_pk_bf16_f32 v233, v158, v159
    v_exp_f32 v160, v160
    v_mfma_f32_16x16x32_bf16 a[88:91], a[204:207], v[200:203], a[88:91]
    s_mov_b32 s45, 20480
    v_exp_f32 v161, v161
    v_mfma_f32_16x16x32_bf16 a[92:95], a[204:207], v[208:211], a[92:95]
    v_cvt_pk_bf16_f32 v240, v160, v161
    v_exp_f32 v162, v162
    v_mfma_f32_16x16x32_bf16 a[92:95], a[200:203], v[204:207], a[92:95]
    buffer_load_dwordx4 a[160:163], v114, s[20:23], s45 offen offset:3072 sc1
    v_exp_f32 v163, v163
    v_smfmac_f32_16x16x64_bf16 a[232:235], v[244:247], v[196:203], v248
    s_waitcnt vmcnt(20) lgkmcnt(0)
    s_barrier
    v_mfma_f32_16x16x32_bf16 a[96:99], a[208:211], v[180:183], a[96:99]
    s_mov_b32 s45, 20480
    ds_read_b64_tr_b16 a[192:193], v5 offset:24576
    buffer_load_dwordx4 a[164:167], v115, s[20:23], s45 offen offset:0 sc1
    v_cvt_pk_bf16_f32 v241, v162, v163
    v_exp_f32 v164, v164
    v_mfma_f32_16x16x32_bf16 a[96:99], a[212:215], v[184:187], a[96:99]
    s_mov_b32 s45, 40960
    ds_read_b64_tr_b16 a[194:195], v5 offset:28672
    v_exp_f32 v165, v165
    v_mfma_f32_16x16x32_bf16 a[100:103], a[212:215], v[192:195], a[100:103]
    ds_read_b64_tr_b16 a[196:197], v5 offset:49152
    v_cvt_pk_bf16_f32 v218, v164, v165
    v_exp_f32 v166, v166
    v_mfma_f32_16x16x32_bf16 a[100:103], a[208:211], v[188:191], a[100:103]
    ds_read_b64_tr_b16 a[198:199], v5 offset:53248
    buffer_load_dwordx4 a[168:171], v114, s[20:23], s45 offen offset:0 sc1
    v_exp_f32 v167, v167
    v_mfma_f32_16x16x32_bf16 a[104:107], a[208:211], v[196:199], a[104:107]
    s_mov_b32 s45, 40960
    v_cvt_pk_bf16_f32 v219, v166, v167
    v_exp_f32 v168, v168
    v_mfma_f32_16x16x32_bf16 a[104:107], a[212:215], v[200:203], a[104:107]
    buffer_load_dwordx4 a[172:175], v114, s[20:23], s45 offen offset:1024 sc1
    v_exp_f32 v169, v169
    v_mfma_f32_16x16x32_bf16 a[108:111], a[212:215], v[208:211], a[108:111]
    s_mov_b32 s45, 40960
    v_cvt_pk_bf16_f32 v226, v168, v169
    v_exp_f32 v170, v170
    v_mfma_f32_16x16x32_bf16 a[108:111], a[208:211], v[204:207], a[108:111]
    s_waitcnt lgkmcnt(4)
    s_cmp_lg_u32 s5, 0
    s_cbranch_scc1 L_ffn_flagged
    s_mov_b64 exec, 1
    buffer_store_dword v0, off, s[76:79], s75 sc1
    s_mov_b64 exec, -1
L_ffn_flagged:
    v_exp_f32 v171, v171
    v_mfma_f32_16x16x32_bf16 a[112:115], a[216:219], v[180:183], a[112:115]
    ds_read_b64_tr_b16 a[200:201], v6 offset:24576
    buffer_load_dwordx4 a[176:179], v114, s[20:23], s45 offen offset:2048 sc1
    v_cvt_pk_bf16_f32 v227, v170, v171
    v_exp_f32 v172, v172
    v_mfma_f32_16x16x32_bf16 a[112:115], a[220:223], v[184:187], a[112:115]
    s_mov_b32 s45, 40960
    ds_read_b64_tr_b16 a[202:203], v6 offset:28672
    v_exp_f32 v173, v173
    v_mfma_f32_16x16x32_bf16 a[116:119], a[220:223], v[192:195], a[116:119]
    ds_read_b64_tr_b16 a[204:205], v6 offset:49152
    v_cvt_pk_bf16_f32 v234, v172, v173
    v_exp_f32 v174, v174
    v_mfma_f32_16x16x32_bf16 a[116:119], a[216:219], v[188:191], a[116:119]
    ds_read_b64_tr_b16 a[206:207], v6 offset:53248
    buffer_load_dwordx4 a[180:183], v114, s[20:23], s45 offen offset:3072 sc1
    v_exp_f32 v175, v175
    v_mfma_f32_16x16x32_bf16 a[120:123], a[216:219], v[196:199], a[120:123]
    s_mov_b32 s45, 40960
    v_cvt_pk_bf16_f32 v235, v174, v175
    v_exp_f32 v176, v176
    v_mfma_f32_16x16x32_bf16 a[120:123], a[220:223], v[200:203], a[120:123]
    v_exp_f32 v177, v177
    v_mfma_f32_16x16x32_bf16 a[124:127], a[220:223], v[208:211], a[124:127]
    buffer_load_dwordx4 a[184:187], v115, s[20:23], s45 offen offset:0 sc1
    v_cvt_pk_bf16_f32 v242, v176, v177
    v_exp_f32 v178, v178
    v_mfma_f32_16x16x32_bf16 a[124:127], a[216:219], v[204:207], a[124:127]
    s_mov_b32 s45, 61440
    v_exp_f32 v179, v179
    v_smfmac_f32_16x16x64_bf16 a[236:239], v[244:247], v[204:211], v248
    s_waitcnt lgkmcnt(4)
    buffer_load_dwordx4 a[188:191], v114, s[20:23], s45 offen offset:0 sc1
    v_mfma_f32_16x16x32_bf16 a[0:3], a[192:195], v[212:215], a[0:3]
    s_lshl_b32 s40, s87, 2
    ds_read_b64_tr_b16 a[208:209], v7 offset:24576
    v_cvt_pk_bf16_f32 v243, v178, v179
    v_mfma_f32_16x16x32_bf16 a[0:3], a[196:199], v[216:219], a[0:3]
    s_add_u32 s40, s40, s5
    ds_read_b64_tr_b16 a[210:211], v7 offset:28672
    v_smfmac_f32_16x16x64_bf16 a[224:227], v[244:247], v[212:219], v248
    s_lshl_b32 s40, s40, 4
    ds_read_b64_tr_b16 a[212:213], v7 offset:49152
    v_and_b32 v35, 15, v19
    v_smfmac_f32_16x16x64_bf16 a[228:231], v[244:247], v[220:227], v248
    ds_read_b64_tr_b16 a[214:215], v7 offset:53248
    v_add_u32 v35, s40, v35
    v_smfmac_f32_16x16x64_bf16 a[232:235], v[244:247], v[228:235], v248
    v_mul_u32_u24 v34, 1280, v35
    v_lshrrev_b32 v116, 4, v19
    v_smfmac_f32_16x16x64_bf16 a[236:239], v[244:247], v[236:243], v248
    v_lshl_add_u32 v34, v116, 3, v34
    v_mfma_f32_16x16x32_bf16 a[4:7], a[196:199], v[224:227], a[4:7]
    s_mul_i32 s40, s100, 160
    v_add_u32 v34, s40, v34
    v_lshlrev_b32 v116, 4, v35
    v_mfma_f32_16x16x32_bf16 a[4:7], a[192:195], v[220:223], a[4:7]
    s_mov_b32 s40, 0x280000
    buffer_load_dwordx2 v[32:33], v116, s[76:79], s40 offen sc1
    v_mfma_f32_16x16x32_bf16 a[8:11], a[192:195], v[228:231], a[8:11]
    buffer_load_dwordx2 v[22:23], v34, s[88:91], 0 offen offset:0
    v_mfma_f32_16x16x32_bf16 a[8:11], a[196:199], v[232:235], a[8:11]
    buffer_load_dwordx2 v[24:25], v34, s[88:91], 0 offen offset:32
    v_mfma_f32_16x16x32_bf16 a[12:15], a[196:199], v[240:243], a[12:15]
    buffer_load_dwordx2 v[26:27], v34, s[88:91], 0 offen offset:64
    v_mfma_f32_16x16x32_bf16 a[12:15], a[192:195], v[236:239], a[12:15]
    s_waitcnt lgkmcnt(4)
    buffer_load_dwordx2 v[28:29], v34, s[88:91], 0 offen offset:96
    v_mfma_f32_16x16x32_bf16 a[16:19], a[200:203], v[212:215], a[16:19]
    ds_read_b64_tr_b16 a[216:217], v8 offset:24576
    v_accvgpr_read_b32 v100, a224
    v_mfma_f32_16x16x32_bf16 a[16:19], a[204:207], v[216:219], a[16:19]
    ds_read_b64_tr_b16 a[218:219], v8 offset:28672
    v_accvgpr_read_b32 v104, a225
    v_accvgpr_read_b32 v101, a228
    v_accvgpr_read_b32 v105, a229
    v_mfma_f32_16x16x32_bf16 a[20:23], a[204:207], v[224:227], a[20:23]
    ds_read_b64_tr_b16 a[220:221], v8 offset:49152
    v_accvgpr_read_b32 v102, a232
    v_accvgpr_read_b32 v106, a233
    v_mfma_f32_16x16x32_bf16 a[20:23], a[200:203], v[220:223], a[20:23]
    ds_read_b64_tr_b16 a[222:223], v8 offset:53248
    v_accvgpr_read_b32 v103, a236
    v_accvgpr_read_b32 v107, a237
    v_add_f32 v100, v100, v104
    v_mfma_f32_16x16x32_bf16 a[24:27], a[200:203], v[228:231], a[24:27]
    buffer_load_dwordx2 v[30:31], v34, s[88:91], 0 offen offset:128
    v_add_f32 v101, v101, v105
    v_add_f32 v102, v102, v106
    v_add_f32 v103, v103, v107
    v_mfma_f32_16x16x32_bf16 a[24:27], a[204:207], v[232:235], a[24:27]
    v_lshlrev_b32 v20, 7, v19
    v_add_u32 v20, 0x290000, v20
    v_maximum3_f32 v108, v100, v101, v102
    v_maximum3_f32 v108, v108, v103, v103
    v_mfma_f32_16x16x32_bf16 a[28:31], a[204:207], v[240:243], a[28:31]
    buffer_load_dwordx4 v[252:255], v20, s[76:79], 0 offen sc1
    v_mul_f32 v108, 0x4d800000, v108
    v_mov_b32 v109, 0
    v_lshlrev_b32 v110, 4, v19
    v_mfma_f32_16x16x32_bf16 a[28:31], a[200:203], v[236:239], a[28:31]
    s_waitcnt lgkmcnt(4)
    v_rcp_f32 v100, v100
    v_rcp_f32 v101, v101
    v_rcp_f32 v102, v102
    v_rcp_f32 v103, v103
    v_mfma_f32_16x16x32_bf16 a[32:35], a[208:211], v[212:215], a[32:35]
    s_mov_b32 s36, 0
    ds_read_b64_tr_b16 a[192:193], v9 offset:24576
    v_accvgpr_read_b32 v120, a0
    v_accvgpr_read_b32 v121, a1
    v_accvgpr_read_b32 v122, a2
    v_accvgpr_read_b32 v123, a3
    v_mfma_f32_16x16x32_bf16 a[32:35], a[212:215], v[216:219], a[32:35]
    ds_read_b64_tr_b16 a[194:195], v9 offset:28672
    v_accvgpr_read_b32 v124, a16
    v_accvgpr_read_b32 v125, a17
    v_accvgpr_read_b32 v126, a18
    v_accvgpr_read_b32 v127, a19
    v_maximum3_f32 v108, v108, |v120|, |v121|
    v_maximum3_f32 v109, v109, |v122|, |v123|
    v_mfma_f32_16x16x32_bf16 a[36:39], a[212:215], v[224:227], a[36:39]
    ds_read_b64_tr_b16 a[196:197], v9 offset:49152
    v_maximum3_f32 v108, v108, |v124|, |v125|
    v_maximum3_f32 v109, v109, |v126|, |v127|
    v_mul_f32 v120, v120, v100
    v_mul_f32 v121, v121, v100
    v_mul_f32 v122, v122, v100
    v_mul_f32 v123, v123, v100
    v_mfma_f32_16x16x32_bf16 a[36:39], a[208:211], v[220:223], a[36:39]
    ds_read_b64_tr_b16 a[198:199], v9 offset:53248
    v_mul_f32 v124, v124, v100
    v_mul_f32 v125, v125, v100
    v_mul_f32 v126, v126, v100
    v_mul_f32 v127, v127, v100
    v_cvt_pk_bf16_f32 v152, v120, v121
    v_cvt_pk_bf16_f32 v153, v122, v123
    v_cvt_pk_bf16_f32 v154, v124, v125
    v_mfma_f32_16x16x32_bf16 a[40:43], a[208:211], v[228:231], a[40:43]
    v_cvt_pk_bf16_f32 v155, v126, v127
    v_mfma_f32_16x16x32_bf16 a[40:43], a[212:215], v[232:235], a[40:43]
    buffer_store_dwordx4 v[152:155], v110, s[24:27], s36 offen offset:0 sc1
    v_accvgpr_read_b32 v128, a4
    v_accvgpr_read_b32 v129, a5
    v_accvgpr_read_b32 v130, a6
    v_accvgpr_read_b32 v131, a7
    v_accvgpr_read_b32 v132, a20
    v_accvgpr_read_b32 v133, a21
    v_accvgpr_read_b32 v134, a22
    v_accvgpr_read_b32 v135, a23
    v_maximum3_f32 v108, v108, |v128|, |v129|
    v_maximum3_f32 v109, v109, |v130|, |v131|
    v_mfma_f32_16x16x32_bf16 a[44:47], a[212:215], v[240:243], a[44:47]
    v_maximum3_f32 v108, v108, |v132|, |v133|
    v_maximum3_f32 v109, v109, |v134|, |v135|
    v_mul_f32 v128, v128, v101
    v_mul_f32 v129, v129, v101
    v_mul_f32 v130, v130, v101
    v_mul_f32 v131, v131, v101
    v_mul_f32 v132, v132, v101
    v_mfma_f32_16x16x32_bf16 a[44:47], a[208:211], v[236:239], a[44:47]
    s_waitcnt lgkmcnt(4)
    v_mul_f32 v133, v133, v101
    v_mul_f32 v134, v134, v101
    v_mul_f32 v135, v135, v101
    v_cvt_pk_bf16_f32 v156, v128, v129
    v_cvt_pk_bf16_f32 v157, v130, v131
    v_cvt_pk_bf16_f32 v158, v132, v133
    v_mfma_f32_16x16x32_bf16 a[48:51], a[216:219], v[212:215], a[48:51]
    ds_read_b64_tr_b16 a[200:201], v10 offset:24576
    v_cvt_pk_bf16_f32 v159, v134, v135
    v_mfma_f32_16x16x32_bf16 a[48:51], a[220:223], v[216:219], a[48:51]
    ds_read_b64_tr_b16 a[202:203], v10 offset:28672
    buffer_store_dwordx4 v[156:159], v110, s[24:27], s36 offen offset:1024 sc1
    v_accvgpr_read_b32 v136, a8
    v_accvgpr_read_b32 v137, a9
    v_accvgpr_read_b32 v138, a10
    v_accvgpr_read_b32 v139, a11
    v_accvgpr_read_b32 v140, a24
    v_accvgpr_read_b32 v141, a25
    v_accvgpr_read_b32 v142, a26
    v_accvgpr_read_b32 v143, a27
    v_maximum3_f32 v108, v108, |v136|, |v137|
    v_maximum3_f32 v109, v109, |v138|, |v139|
    v_maximum3_f32 v108, v108, |v140|, |v141|
    v_mfma_f32_16x16x32_bf16 a[52:55], a[220:223], v[224:227], a[52:55]
    ds_read_b64_tr_b16 a[204:205], v10 offset:49152
    v_maximum3_f32 v109, v109, |v142|, |v143|
    v_mul_f32 v136, v136, v102
    v_mul_f32 v137, v137, v102
    v_mul_f32 v138, v138, v102
    v_mul_f32 v139, v139, v102
    v_mul_f32 v140, v140, v102
    v_mfma_f32_16x16x32_bf16 a[52:55], a[216:219], v[220:223], a[52:55]
    ds_read_b64_tr_b16 a[206:207], v10 offset:53248
    v_mul_f32 v141, v141, v102
    v_mul_f32 v142, v142, v102
    v_mul_f32 v143, v143, v102
    v_cvt_pk_bf16_f32 v160, v136, v137
    v_cvt_pk_bf16_f32 v161, v138, v139
    v_cvt_pk_bf16_f32 v162, v140, v141
    v_mfma_f32_16x16x32_bf16 a[56:59], a[216:219], v[228:231], a[56:59]
    v_cvt_pk_bf16_f32 v163, v142, v143
    v_mfma_f32_16x16x32_bf16 a[56:59], a[220:223], v[232:235], a[56:59]
    buffer_store_dwordx4 v[160:163], v110, s[24:27], s36 offen offset:2048 sc1
    v_accvgpr_read_b32 v144, a12
    v_accvgpr_read_b32 v145, a13
    v_accvgpr_read_b32 v146, a14
    v_accvgpr_read_b32 v147, a15
    v_accvgpr_read_b32 v148, a28
    v_accvgpr_read_b32 v149, a29
    v_accvgpr_read_b32 v150, a30
    v_accvgpr_read_b32 v151, a31
    v_maximum3_f32 v108, v108, |v144|, |v145|
    v_maximum3_f32 v109, v109, |v146|, |v147|
    v_maximum3_f32 v108, v108, |v148|, |v149|
    v_mfma_f32_16x16x32_bf16 a[60:63], a[220:223], v[240:243], a[60:63]
    v_maximum3_f32 v109, v109, |v150|, |v151|
    v_mul_f32 v144, v144, v103
    v_mul_f32 v145, v145, v103
    v_mul_f32 v146, v146, v103
    v_mul_f32 v147, v147, v103
    v_mul_f32 v148, v148, v103
    v_mfma_f32_16x16x32_bf16 a[60:63], a[216:219], v[236:239], a[60:63]
    s_waitcnt lgkmcnt(4)
    v_mul_f32 v149, v149, v103
    v_mul_f32 v150, v150, v103
    v_mul_f32 v151, v151, v103
    v_cvt_pk_bf16_f32 v164, v144, v145
    v_cvt_pk_bf16_f32 v165, v146, v147
    v_cvt_pk_bf16_f32 v166, v148, v149
    v_cvt_pk_bf16_f32 v167, v150, v151
    buffer_store_dwordx4 v[164:167], v110, s[24:27], s36 offen offset:3072 sc1
    v_mfma_f32_16x16x32_bf16 a[64:67], a[192:195], v[212:215], a[64:67]
    s_mov_b32 s36, 4096
    ds_read_b64_tr_b16 a[208:209], v11 offset:24576
    v_accvgpr_read_b32 v120, a32
    v_accvgpr_read_b32 v121, a33
    v_accvgpr_read_b32 v122, a34
    v_accvgpr_read_b32 v123, a35
    v_accvgpr_read_b32 v124, a48
    v_mfma_f32_16x16x32_bf16 a[64:67], a[196:199], v[216:219], a[64:67]
    ds_read_b64_tr_b16 a[210:211], v11 offset:28672
    v_accvgpr_read_b32 v125, a49
    v_accvgpr_read_b32 v126, a50
    v_accvgpr_read_b32 v127, a51
    v_maximum3_f32 v108, v108, |v120|, |v121|
    v_maximum3_f32 v109, v109, |v122|, |v123|
    v_maximum3_f32 v108, v108, |v124|, |v125|
    v_maximum3_f32 v109, v109, |v126|, |v127|
    v_mfma_f32_16x16x32_bf16 a[68:71], a[196:199], v[224:227], a[68:71]
    ds_read_b64_tr_b16 a[212:213], v11 offset:49152
    v_mul_f32 v120, v120, v100
    v_mul_f32 v121, v121, v100
    v_mul_f32 v122, v122, v100
    v_mul_f32 v123, v123, v100
    v_mul_f32 v124, v124, v100
    v_mul_f32 v125, v125, v100
    v_mul_f32 v126, v126, v100
    v_mfma_f32_16x16x32_bf16 a[68:71], a[192:195], v[220:223], a[68:71]
    ds_read_b64_tr_b16 a[214:215], v11 offset:53248
    v_mul_f32 v127, v127, v100
    v_cvt_pk_bf16_f32 v152, v120, v121
    v_cvt_pk_bf16_f32 v153, v122, v123
    v_cvt_pk_bf16_f32 v154, v124, v125
    v_cvt_pk_bf16_f32 v155, v126, v127
    v_mfma_f32_16x16x32_bf16 a[72:75], a[192:195], v[228:231], a[72:75]
    buffer_store_dwordx4 v[152:155], v110, s[24:27], s36 offen offset:0 sc1
    v_mfma_f32_16x16x32_bf16 a[72:75], a[196:199], v[232:235], a[72:75]
    s_mov_b32 s45, 61440
    buffer_load_dwordx4 a[0:3], v114, s[20:23], s45 offen offset:1024 sc1
    v_mfma_f32_16x16x32_bf16 a[76:79], a[196:199], v[240:243], a[76:79]
    s_mov_b32 s45, 61440
    buffer_load_dwordx4 a[4:7], v114, s[20:23], s45 offen offset:2048 sc1
    v_accvgpr_read_b32 v128, a36
    v_accvgpr_read_b32 v129, a37
    v_accvgpr_read_b32 v130, a38
    v_accvgpr_read_b32 v131, a39
    v_accvgpr_read_b32 v132, a52
    v_accvgpr_read_b32 v133, a53
    v_accvgpr_read_b32 v134, a54
    v_accvgpr_read_b32 v135, a55
    v_maximum3_f32 v108, v108, |v128|, |v129|
    v_maximum3_f32 v109, v109, |v130|, |v131|
    v_maximum3_f32 v108, v108, |v132|, |v133|
    v_maximum3_f32 v109, v109, |v134|, |v135|
    v_mul_f32 v128, v128, v101
    v_mul_f32 v129, v129, v101
    v_mul_f32 v130, v130, v101
    v_mul_f32 v131, v131, v101
    v_mul_f32 v132, v132, v101
    v_mul_f32 v133, v133, v101
    v_mul_f32 v134, v134, v101
    v_mul_f32 v135, v135, v101
    v_mfma_f32_16x16x32_bf16 a[76:79], a[192:195], v[236:239], a[76:79]
    s_waitcnt lgkmcnt(4)
    v_cvt_pk_bf16_f32 v156, v128, v129
    v_cvt_pk_bf16_f32 v157, v130, v131
    v_cvt_pk_bf16_f32 v158, v132, v133
    v_cvt_pk_bf16_f32 v159, v134, v135
    v_mfma_f32_16x16x32_bf16 a[80:83], a[200:203], v[212:215], a[80:83]
    ds_read_b64_tr_b16 a[216:217], v12 offset:24576
    buffer_store_dwordx4 v[156:159], v110, s[24:27], s36 offen offset:1024 sc1
    v_mfma_f32_16x16x32_bf16 a[80:83], a[204:207], v[216:219], a[80:83]
    s_mov_b32 s45, 61440
    ds_read_b64_tr_b16 a[218:219], v12 offset:28672
    buffer_load_dwordx4 a[8:11], v114, s[20:23], s45 offen offset:3072 sc1
    v_mfma_f32_16x16x32_bf16 a[84:87], a[204:207], v[224:227], a[84:87]
    s_mov_b32 s45, 61440
    ds_read_b64_tr_b16 a[220:221], v12 offset:49152
    buffer_load_dwordx4 a[12:15], v115, s[20:23], s45 offen offset:0 sc1
    v_accvgpr_read_b32 v136, a40
    v_accvgpr_read_b32 v137, a41
    v_accvgpr_read_b32 v138, a42
    v_accvgpr_read_b32 v139, a43
    v_accvgpr_read_b32 v140, a56
    v_accvgpr_read_b32 v141, a57
    v_accvgpr_read_b32 v142, a58
    v_accvgpr_read_b32 v143, a59
    v_maximum3_f32 v108, v108, |v136|, |v137|
    v_maximum3_f32 v109, v109, |v138|, |v139|
    v_maximum3_f32 v108, v108, |v140|, |v141|
    v_maximum3_f32 v109, v109, |v142|, |v143|
    v_mul_f32 v136, v136, v102
    v_mul_f32 v137, v137, v102
    v_mul_f32 v138, v138, v102
    v_mul_f32 v139, v139, v102
    v_mul_f32 v140, v140, v102
    v_mul_f32 v141, v141, v102
    v_mul_f32 v142, v142, v102
    v_mul_f32 v143, v143, v102
    v_mfma_f32_16x16x32_bf16 a[84:87], a[200:203], v[220:223], a[84:87]
    ds_read_b64_tr_b16 a[222:223], v12 offset:53248
    v_cvt_pk_bf16_f32 v160, v136, v137
    v_cvt_pk_bf16_f32 v161, v138, v139
    v_cvt_pk_bf16_f32 v162, v140, v141
    v_cvt_pk_bf16_f32 v163, v142, v143
    v_mfma_f32_16x16x32_bf16 a[88:91], a[200:203], v[228:231], a[88:91]
    buffer_store_dwordx4 v[160:163], v110, s[24:27], s36 offen offset:2048 sc1
    v_mfma_f32_16x16x32_bf16 a[88:91], a[204:207], v[232:235], a[88:91]
    s_mov_b32 s45, 81920
    buffer_load_dwordx4 a[16:19], v114, s[20:23], s45 offen offset:0 sc1
    v_mfma_f32_16x16x32_bf16 a[92:95], a[204:207], v[240:243], a[92:95]
    s_mov_b32 s45, 81920
    buffer_load_dwordx4 a[20:23], v114, s[20:23], s45 offen offset:1024 sc1
    v_accvgpr_read_b32 v144, a44
    v_accvgpr_read_b32 v145, a45
    v_accvgpr_read_b32 v146, a46
    v_accvgpr_read_b32 v147, a47
    v_accvgpr_read_b32 v148, a60
    v_accvgpr_read_b32 v149, a61
    v_accvgpr_read_b32 v150, a62
    v_accvgpr_read_b32 v151, a63
    v_maximum3_f32 v108, v108, |v144|, |v145|
    v_maximum3_f32 v109, v109, |v146|, |v147|
    v_maximum3_f32 v108, v108, |v148|, |v149|
    v_maximum3_f32 v109, v109, |v150|, |v151|
    v_mul_f32 v144, v144, v103
    v_mul_f32 v145, v145, v103
    v_mul_f32 v146, v146, v103
    v_mul_f32 v147, v147, v103
    v_mul_f32 v148, v148, v103
    v_mul_f32 v149, v149, v103
    v_mul_f32 v150, v150, v103
    v_mul_f32 v151, v151, v103
    v_mfma_f32_16x16x32_bf16 a[92:95], a[200:203], v[236:239], a[92:95]
    s_waitcnt lgkmcnt(4)
    v_cvt_pk_bf16_f32 v164, v144, v145
    v_cvt_pk_bf16_f32 v165, v146, v147
    v_cvt_pk_bf16_f32 v166, v148, v149
    v_cvt_pk_bf16_f32 v167, v150, v151
    buffer_store_dwordx4 v[164:167], v110, s[24:27], s36 offen offset:3072 sc1
    s_mov_b32 s45, 81920
    buffer_load_dwordx4 a[24:27], v114, s[20:23], s45 offen offset:2048 sc1
    s_mov_b32 s45, 81920
    buffer_load_dwordx4 a[28:31], v114, s[20:23], s45 offen offset:3072 sc1
    v_mfma_f32_16x16x32_bf16 a[96:99], a[208:211], v[212:215], a[96:99]
    s_mov_b32 s36, 8192
    v_accvgpr_read_b32 v120, a64
    v_accvgpr_read_b32 v121, a65
    v_accvgpr_read_b32 v122, a66
    v_accvgpr_read_b32 v123, a67
    v_accvgpr_read_b32 v124, a80
    v_mfma_f32_16x16x32_bf16 a[96:99], a[212:215], v[216:219], a[96:99]
    v_accvgpr_read_b32 v125, a81
    v_accvgpr_read_b32 v126, a82
    v_accvgpr_read_b32 v127, a83
    v_maximum3_f32 v108, v108, |v120|, |v121|
    v_maximum3_f32 v109, v109, |v122|, |v123|
    v_maximum3_f32 v108, v108, |v124|, |v125|
    v_maximum3_f32 v109, v109, |v126|, |v127|
    v_mfma_f32_16x16x32_bf16 a[100:103], a[212:215], v[224:227], a[100:103]
    v_mul_f32 v120, v120, v100
    v_mul_f32 v121, v121, v100
    v_mul_f32 v122, v122, v100
    v_mul_f32 v123, v123, v100
    v_mul_f32 v124, v124, v100
    v_mul_f32 v125, v125, v100
    v_mul_f32 v126, v126, v100
    v_mfma_f32_16x16x32_bf16 a[100:103], a[208:211], v[220:223], a[100:103]
    v_mul_f32 v127, v127, v100
    v_cvt_pk_bf16_f32 v152, v120, v121
    v_cvt_pk_bf16_f32 v153, v122, v123
    v_cvt_pk_bf16_f32 v154, v124, v125
    v_cvt_pk_bf16_f32 v155, v126, v127
    v_mfma_f32_16x16x32_bf16 a[104:107], a[208:211], v[228:231], a[104:107]
    buffer_store_dwordx4 v[152:155], v110, s[24:27], s36 offen offset:0 sc1
    v_mfma_f32_16x16x32_bf16 a[104:107], a[212:215], v[232:235], a[104:107]
    s_mov_b32 s45, 81920
    buffer_load_dwordx4 a[32:35], v115, s[20:23], s45 offen offset:0 sc1
    v_mfma_f32_16x16x32_bf16 a[108:111], a[212:215], v[240:243], a[108:111]
    s_mov_b32 s45, 102400
    buffer_load_dwordx4 a[36:39], v114, s[20:23], s45 offen offset:0 sc1
    v_accvgpr_read_b32 v128, a68
    v_accvgpr_read_b32 v129, a69
    v_accvgpr_read_b32 v130, a70
    v_accvgpr_read_b32 v131, a71
    v_accvgpr_read_b32 v132, a84
    v_accvgpr_read_b32 v133, a85
    v_accvgpr_read_b32 v134, a86
    v_accvgpr_read_b32 v135, a87
    v_maximum3_f32 v108, v108, |v128|, |v129|
    v_maximum3_f32 v109, v109, |v130|, |v131|
    v_maximum3_f32 v108, v108, |v132|, |v133|
    v_maximum3_f32 v109, v109, |v134|, |v135|
    v_mul_f32 v128, v128, v101
    v_mul_f32 v129, v129, v101
    v_mul_f32 v130, v130, v101
    v_mul_f32 v131, v131, v101
    v_mul_f32 v132, v132, v101
    v_mul_f32 v133, v133, v101
    v_mul_f32 v134, v134, v101
    v_mul_f32 v135, v135, v101
    v_mfma_f32_16x16x32_bf16 a[108:111], a[208:211], v[236:239], a[108:111]
    s_waitcnt lgkmcnt(0)
    v_cvt_pk_bf16_f32 v156, v128, v129
    v_cvt_pk_bf16_f32 v157, v130, v131
    v_cvt_pk_bf16_f32 v158, v132, v133
    v_cvt_pk_bf16_f32 v159, v134, v135
    v_mfma_f32_16x16x32_bf16 a[112:115], a[216:219], v[212:215], a[112:115]
    buffer_store_dwordx4 v[156:159], v110, s[24:27], s36 offen offset:1024 sc1
    v_mfma_f32_16x16x32_bf16 a[112:115], a[220:223], v[216:219], a[112:115]
    s_mov_b32 s45, 102400
    buffer_load_dwordx4 a[40:43], v114, s[20:23], s45 offen offset:1024 sc1
    v_mfma_f32_16x16x32_bf16 a[116:119], a[220:223], v[224:227], a[116:119]
    s_mov_b32 s45, 102400
    buffer_load_dwordx4 a[44:47], v114, s[20:23], s45 offen offset:2048 sc1
    v_accvgpr_read_b32 v136, a72
    v_accvgpr_read_b32 v137, a73
    v_accvgpr_read_b32 v138, a74
    v_accvgpr_read_b32 v139, a75
    v_accvgpr_read_b32 v140, a88
    v_accvgpr_read_b32 v141, a89
    v_accvgpr_read_b32 v142, a90
    v_accvgpr_read_b32 v143, a91
    v_maximum3_f32 v108, v108, |v136|, |v137|
    v_maximum3_f32 v109, v109, |v138|, |v139|
    v_maximum3_f32 v108, v108, |v140|, |v141|
    v_maximum3_f32 v109, v109, |v142|, |v143|
    v_mul_f32 v136, v136, v102
    v_mul_f32 v137, v137, v102
    v_mul_f32 v138, v138, v102
    v_mul_f32 v139, v139, v102
    v_mul_f32 v140, v140, v102
    v_mul_f32 v141, v141, v102
    v_mul_f32 v142, v142, v102
    v_mul_f32 v143, v143, v102
    v_mfma_f32_16x16x32_bf16 a[116:119], a[216:219], v[220:223], a[116:119]
    v_cvt_pk_bf16_f32 v160, v136, v137
    v_cvt_pk_bf16_f32 v161, v138, v139
    v_cvt_pk_bf16_f32 v162, v140, v141
    v_cvt_pk_bf16_f32 v163, v142, v143
    v_mfma_f32_16x16x32_bf16 a[120:123], a[216:219], v[228:231], a[120:123]
    buffer_store_dwordx4 v[160:163], v110, s[24:27], s36 offen offset:2048 sc1
    v_mfma_f32_16x16x32_bf16 a[120:123], a[220:223], v[232:235], a[120:123]
    s_mov_b32 s45, 102400
    buffer_load_dwordx4 a[48:51], v114, s[20:23], s45 offen offset:3072 sc1
    v_mfma_f32_16x16x32_bf16 a[124:127], a[220:223], v[240:243], a[124:127]
    s_mov_b32 s45, 102400
    buffer_load_dwordx4 a[52:55], v115, s[20:23], s45 offen offset:0 sc1
    v_accvgpr_read_b32 v144, a76
    v_accvgpr_read_b32 v145, a77
    v_accvgpr_read_b32 v146, a78
    v_accvgpr_read_b32 v147, a79
    v_accvgpr_read_b32 v148, a92
    v_accvgpr_read_b32 v149, a93
    v_accvgpr_read_b32 v150, a94
    v_accvgpr_read_b32 v151, a95
    v_maximum3_f32 v108, v108, |v144|, |v145|
    v_maximum3_f32 v109, v109, |v146|, |v147|
    v_maximum3_f32 v108, v108, |v148|, |v149|
    v_maximum3_f32 v109, v109, |v150|, |v151|
    v_mul_f32 v144, v144, v103
    v_mul_f32 v145, v145, v103
    v_mul_f32 v146, v146, v103
    v_mul_f32 v147, v147, v103
    v_mul_f32 v148, v148, v103
    v_mul_f32 v149, v149, v103
    v_mul_f32 v150, v150, v103
    v_mul_f32 v151, v151, v103
    v_mfma_f32_16x16x32_bf16 a[124:127], a[216:219], v[236:239], a[124:127]
    v_cvt_pk_bf16_f32 v164, v144, v145
    v_cvt_pk_bf16_f32 v165, v146, v147
    v_cvt_pk_bf16_f32 v166, v148, v149
    v_cvt_pk_bf16_f32 v167, v150, v151
    buffer_store_dwordx4 v[164:167], v110, s[24:27], s36 offen offset:3072 sc1
    s_mov_b32 s45, 122880
    buffer_load_dwordx4 a[56:59], v114, s[20:23], s45 offen offset:0 sc1
    s_mov_b32 s45, 122880
    buffer_load_dwordx4 a[60:63], v114, s[20:23], s45 offen offset:1024 sc1
    s_mov_b32 s36, 12288
    v_accvgpr_read_b32 v120, a96
    v_accvgpr_read_b32 v121, a97
    v_accvgpr_read_b32 v122, a98
    v_accvgpr_read_b32 v123, a99
    v_accvgpr_read_b32 v124, a112
    v_accvgpr_read_b32 v125, a113
    v_accvgpr_read_b32 v126, a114
    v_accvgpr_read_b32 v127, a115
    v_maximum3_f32 v108, v108, |v120|, |v121|
    v_maximum3_f32 v109, v109, |v122|, |v123|
    v_maximum3_f32 v108, v108, |v124|, |v125|
    v_maximum3_f32 v109, v109, |v126|, |v127|
    v_mul_f32 v120, v120, v100
    v_mul_f32 v121, v121, v100
    v_mul_f32 v122, v122, v100
    v_mul_f32 v123, v123, v100
    v_mul_f32 v124, v124, v100
    v_mul_f32 v125, v125, v100
    v_mul_f32 v126, v126, v100
    v_mul_f32 v127, v127, v100
    v_cvt_pk_bf16_f32 v152, v120, v121
    v_cvt_pk_bf16_f32 v153, v122, v123
    v_cvt_pk_bf16_f32 v154, v124, v125
    v_cvt_pk_bf16_f32 v155, v126, v127
    buffer_store_dwordx4 v[152:155], v110, s[24:27], s36 offen offset:0 sc1
    s_mov_b32 s45, 122880
    buffer_load_dwordx4 a[64:67], v114, s[20:23], s45 offen offset:2048 sc1
    s_mov_b32 s45, 122880
    buffer_load_dwordx4 a[68:71], v114, s[20:23], s45 offen offset:3072 sc1
    v_accvgpr_read_b32 v128, a100
    v_accvgpr_read_b32 v129, a101
    v_accvgpr_read_b32 v130, a102
    v_accvgpr_read_b32 v131, a103
    v_accvgpr_read_b32 v132, a116
    v_accvgpr_read_b32 v133, a117
    v_accvgpr_read_b32 v134, a118
    v_accvgpr_read_b32 v135, a119
    v_maximum3_f32 v108, v108, |v128|, |v129|
    v_maximum3_f32 v109, v109, |v130|, |v131|
    v_maximum3_f32 v108, v108, |v132|, |v133|
    v_maximum3_f32 v109, v109, |v134|, |v135|
    v_mul_f32 v128, v128, v101
    v_mul_f32 v129, v129, v101
    v_mul_f32 v130, v130, v101
    v_mul_f32 v131, v131, v101
    v_mul_f32 v132, v132, v101
    v_mul_f32 v133, v133, v101
    v_mul_f32 v134, v134, v101
    v_mul_f32 v135, v135, v101
    v_cvt_pk_bf16_f32 v156, v128, v129
    v_cvt_pk_bf16_f32 v157, v130, v131
    v_cvt_pk_bf16_f32 v158, v132, v133
    v_cvt_pk_bf16_f32 v159, v134, v135
    buffer_store_dwordx4 v[156:159], v110, s[24:27], s36 offen offset:1024 sc1
    s_mov_b32 s45, 122880
    buffer_load_dwordx4 a[72:75], v115, s[20:23], s45 offen offset:0 sc1
    s_mov_b32 s45, 143360
    buffer_load_dwordx4 a[76:79], v114, s[20:23], s45 offen offset:0 sc1
    v_accvgpr_read_b32 v136, a104
    v_accvgpr_read_b32 v137, a105
    v_accvgpr_read_b32 v138, a106
    v_accvgpr_read_b32 v139, a107
    v_accvgpr_read_b32 v140, a120
    v_accvgpr_read_b32 v141, a121
    v_accvgpr_read_b32 v142, a122
    v_accvgpr_read_b32 v143, a123
    v_maximum3_f32 v108, v108, |v136|, |v137|
    v_maximum3_f32 v109, v109, |v138|, |v139|
    v_maximum3_f32 v108, v108, |v140|, |v141|
    v_maximum3_f32 v109, v109, |v142|, |v143|
    v_mul_f32 v136, v136, v102
    v_mul_f32 v137, v137, v102
    v_mul_f32 v138, v138, v102
    v_mul_f32 v139, v139, v102
    v_mul_f32 v140, v140, v102
    v_mul_f32 v141, v141, v102
    v_mul_f32 v142, v142, v102
    v_mul_f32 v143, v143, v102
    v_cvt_pk_bf16_f32 v160, v136, v137
    v_cvt_pk_bf16_f32 v161, v138, v139
    v_cvt_pk_bf16_f32 v162, v140, v141
    v_cvt_pk_bf16_f32 v163, v142, v143
    buffer_store_dwordx4 v[160:163], v110, s[24:27], s36 offen offset:2048 sc1
    s_mov_b32 s45, 143360
    buffer_load_dwordx4 a[80:83], v114, s[20:23], s45 offen offset:1024 sc1
    s_mov_b32 s45, 143360
    buffer_load_dwordx4 a[84:87], v114, s[20:23], s45 offen offset:2048 sc1
    v_accvgpr_read_b32 v144, a108
    v_accvgpr_read_b32 v145, a109
    v_accvgpr_read_b32 v146, a110
    v_accvgpr_read_b32 v147, a111
    v_accvgpr_read_b32 v148, a124
    v_accvgpr_read_b32 v149, a125
    v_accvgpr_read_b32 v150, a126
    v_accvgpr_read_b32 v151, a127
    v_maximum3_f32 v108, v108, |v144|, |v145|
    v_maximum3_f32 v109, v109, |v146|, |v147|
    v_maximum3_f32 v108, v108, |v148|, |v149|
    v_maximum3_f32 v109, v109, |v150|, |v151|
    v_mul_f32 v144, v144, v103
    v_mul_f32 v145, v145, v103
    v_mul_f32 v146, v146, v103
    v_mul_f32 v147, v147, v103
    v_mul_f32 v148, v148, v103
    v_mul_f32 v149, v149, v103
    v_mul_f32 v150, v150, v103
    v_mul_f32 v151, v151, v103
    v_cvt_pk_bf16_f32 v164, v144, v145
    v_cvt_pk_bf16_f32 v165, v146, v147
    v_cvt_pk_bf16_f32 v166, v148, v149
    v_cvt_pk_bf16_f32 v167, v150, v151
    buffer_store_dwordx4 v[164:167], v110, s[24:27], s36 offen offset:3072 sc1
    s_mov_b32 s45, 143360
    buffer_load_dwordx4 a[88:91], v114, s[20:23], s45 offen offset:3072 sc1
    s_mov_b32 s45, 143360
    buffer_load_dwordx4 a[92:95], v115, s[20:23], s45 offen offset:0 sc1
    v_maximum3_f32 v108, v108, v109, v109
    v_cmp_ngt_f32 vcc, 0x7f800000, v108
    s_and_b64 vcc, vcc, exec
    s_cbranch_scc1 L_slow
L_published:
    v_mov_b32 v16, v114
    v_mov_b32 v17, v115
    v_mov_b32 v3, v249
    v_mov_b32 v2, 1
    s_waitcnt vmcnt(40)
    v_lshlrev_b32 v166, 16, v22
    v_and_b32 v167, 0xffff0000, v22
    v_lshlrev_b32 v168, 16, v23
    v_and_b32 v169, 0xffff0000, v23
    v_lshlrev_b32 v170, 16, v24
    v_and_b32 v171, 0xffff0000, v24
    v_lshlrev_b32 v172, 16, v25
    v_and_b32 v173, 0xffff0000, v25
    v_lshlrev_b32 v174, 16, v26
    v_and_b32 v175, 0xffff0000, v26
    v_lshlrev_b32 v176, 16, v27
    v_and_b32 v177, 0xffff0000, v27
    v_lshlrev_b32 v178, 16, v28
    v_and_b32 v179, 0xffff0000, v28
    v_lshlrev_b32 v180, 16, v29
    v_and_b32 v181, 0xffff0000, v29
    v_lshlrev_b32 v182, 16, v30
    v_and_b32 v183, 0xffff0000, v30
    v_lshlrev_b32 v184, 16, v31
    v_and_b32 v185, 0xffff0000, v31
    v_pk_add_f32 v[166:167], v[166:167], v[32:33] op_sel_hi:[1,0] neg_lo:[0,1] neg_hi:[0,1]
    v_pk_add_f32 v[168:169], v[168:169], v[32:33] op_sel_hi:[1,0] neg_lo:[0,1] neg_hi:[0,1]
    v_pk_add_f32 v[170:171], v[170:171], v[32:33] op_sel_hi:[1,0] neg_lo:[0,1] neg_hi:[0,1]
    v_pk_add_f32 v[172:173], v[172:173], v[32:33] op_sel_hi:[1,0] neg_lo:[0,1] neg_hi:[0,1]
    v_pk_add_f32 v[174:175], v[174:175], v[32:33] op_sel_hi:[1,0] neg_lo:[0,1] neg_hi:[0,1]
    v_pk_add_f32 v[176:177], v[176:177], v[32:33] op_sel_hi:[1,0] neg_lo:[0,1] neg_hi:[0,1]
    v_pk_add_f32 v[178:179], v[178:179], v[32:33] op_sel_hi:[1,0] neg_lo:[0,1] neg_hi:[0,1]
    v_pk_add_f32 v[180:181], v[180:181], v[32:33] op_sel_hi:[1,0] neg_lo:[0,1] neg_hi:[0,1]
    v_pk_add_f32 v[182:183], v[182:183], v[32:33] op_sel_hi:[1,0] neg_lo:[0,1] neg_hi:[0,1]
    v_pk_add_f32 v[184:185], v[184:185], v[32:33] op_sel_hi:[1,0] neg_lo:[0,1] neg_hi:[0,1]
    v_cvt_pk_bf16_f32 v36, v166, v167
    v_cvt_pk_bf16_f32 v37, v168, v169
    v_cvt_pk_bf16_f32 v38, v170, v171
    v_cvt_pk_bf16_f32 v39, v172, v173
    v_cvt_pk_bf16_f32 v40, v174, v175
    v_cvt_pk_bf16_f32 v41, v176, v177
    v_cvt_pk_bf16_f32 v42, v178, v179
    v_cvt_pk_bf16_f32 v43, v180, v181
    v_cvt_pk_bf16_f32 v44, v182, v183
    v_cvt_pk_bf16_f32 v45, v184, v185
    v_lshlrev_b32 v166, 16, v36
    v_and_b32 v167, 0xffff0000, v36
    v_lshlrev_b32 v168, 16, v37
    v_and_b32 v169, 0xffff0000, v37
    v_lshlrev_b32 v170, 16, v38
    v_and_b32 v171, 0xffff0000, v38
    v_lshlrev_b32 v172, 16, v39
    v_and_b32 v173, 0xffff0000, v39
    v_lshlrev_b32 v174, 16, v40
    v_and_b32 v175, 0xffff0000, v40
    v_lshlrev_b32 v176, 16, v41
    v_and_b32 v177, 0xffff0000, v41
    v_lshlrev_b32 v178, 16, v42
    v_and_b32 v179, 0xffff0000, v42
    v_lshlrev_b32 v180, 16, v43
    v_and_b32 v181, 0xffff0000, v43
    v_lshlrev_b32 v182, 16, v44
    v_and_b32 v183, 0xffff0000, v44
    v_lshlrev_b32 v184, 16, v45
    v_and_b32 v185, 0xffff0000, v45
    v_pk_mul_f32 v[166:167], v[166:167], v[32:33] op_sel:[0,1] op_sel_hi:[1,1]
    v_pk_mul_f32 v[168:169], v[168:169], v[32:33] op_sel:[0,1] op_sel_hi:[1,1]
    v_pk_mul_f32 v[170:171], v[170:171], v[32:33] op_sel:[0,1] op_sel_hi:[1,1]
    v_pk_mul_f32 v[172:173], v[172:173], v[32:33] op_sel:[0,1] op_sel_hi:[1,1]
    v_pk_mul_f32 v[174:175], v[174:175], v[32:33] op_sel:[0,1] op_sel_hi:[1,1]
    v_pk_mul_f32 v[176:177], v[176:177], v[32:33] op_sel:[0,1] op_sel_hi:[1,1]
    v_pk_mul_f32 v[178:179], v[178:179], v[32:33] op_sel:[0,1] op_sel_hi:[1,1]
    v_pk_mul_f32 v[180:181], v[180:181], v[32:33] op_sel:[0,1] op_sel_hi:[1,1]
    v_pk_mul_f32 v[182:183], v[182:183], v[32:33] op_sel:[0,1] op_sel_hi:[1,1]
    v_pk_mul_f32 v[184:185], v[184:185], v[32:33] op_sel:[0,1] op_sel_hi:[1,1]
    v_cvt_pk_bf16_f32 v36, v166, v167
    v_cvt_pk_bf16_f32 v37, v168, v169
    v_cvt_pk_bf16_f32 v38, v170, v171
    v_cvt_pk_bf16_f32 v39, v172, v173
    v_cvt_pk_bf16_f32 v40, v174, v175
    v_cvt_pk_bf16_f32 v41, v176, v177
    v_cvt_pk_bf16_f32 v42, v178, v179
    v_cvt_pk_bf16_f32 v43, v180, v181
    v_cvt_pk_bf16_f32 v44, v182, v183
    v_cvt_pk_bf16_f32 v45, v184, v185
    s_lshr_b32 s40, s87, 1
    s_lshl_b32 s40, s40, 2
    s_add_u32 s40, s40, s47
    s_lshl_b32 s40, s40, 18
    s_add_u32 s40, s40, 0x400000
    s_add_u32 s8, s72, s40
    s_addc_u32 s9, s73, 0
    s_mov_b32 s10, 0xc0000
    s_mov_b32 s11, 0x20000
    s_mov_b32 s12, s68
    s_mov_b32 s13, s69
    s_mov_b32 s14, 0x280000
    s_mov_b32 s15, 0x20000
    s_xor_b32 s40, s47, 1
    s_lshl_b32 s30, s40, 19
    s_lshl_b32 s31, s47, 19
    s_add_u32 s40, s5, 0
    s_and_b32 s40, s40, 3
    s_lshl_b32 s41, s5, 2
    s_add_u32 s41, s41, s40
    s_lshl_b32 s41, s41, 10
    v_lshl_add_u32 v4, v19, 4, s41
    s_add_u32 s40, s5, 1
    s_and_b32 s40, s40, 3
    s_lshl_b32 s41, s5, 2
    s_add_u32 s41, s41, s40
    s_lshl_b32 s41, s41, 10
    v_lshl_add_u32 v5, v19, 4, s41
    s_add_u32 s40, s5, 2
    s_and_b32 s40, s40, 3
    s_lshl_b32 s41, s5, 2
    s_add_u32 s41, s41, s40
    s_lshl_b32 s41, s41, 10
    v_lshl_add_u32 v6, v19, 4, s41
    s_add_u32 s40, s5, 3
    s_and_b32 s40, s40, 3
    s_lshl_b32 s41, s5, 2
    s_add_u32 s41, s41, s40
    s_lshl_b32 s41, s41, 10
    v_lshl_add_u32 v7, v19, 4, s41
    s_add_u32 s40, s46, 122880
    v_lshl_add_u32 v8, v19, 4, s40
    s_add_u32 s40, s46, 81920
    v_lshl_add_u32 v9, v19, 4, s40
    s_lshl_b32 s40, s46, 1
    v_lshl_add_u32 v10, v19, 4, s40
    s_waitcnt vmcnt(2)
    s_mov_b64 exec, 1
    buffer_store_dword v2, off, s[76:79], s58 sc1
    s_mov_b64 exec, -1
    v_min3_u32 v252, v252, v253, v254
    v_min_u32 v252, v252, v255
    v_cmp_gt_u32 vcc, 2, v252
    s_and_b64 vcc, vcc, exec
    s_cbranch_scc1 L_spin_ffn
L_back_ffn:
    s_and_b32 s40, s87, 30
    s_lshl_b32 s40, s40, 1
    s_add_u32 s40, s40, s47
    s_lshl_b32 s40, s40, 9
    s_mov_b32 s45, 163840
    buffer_load_dwordx4 v[46:49], v16, s[20:23], s45 offen offset:0 sc1
    s_add_u32 s40, s40, 0x292000
    v_bfe_u32 v1, v19, 2, 1
    v_lshlrev_b32 v1, 3, v1
    v_and_or_b32 v1, v19, 3, v1
    buffer_load_dwordx4 v[50:53], v16, s[20:23], s45 offen offset:1024 sc1
    v_lshl_add_u32 v1, v1, 7, s40
    v_mov_b32 v2, 3
    v_mov_b32 v11, 0x2500000
    s_not_b32 s40, s50
    buffer_load_dwordx4 v[54:57], v16, s[20:23], s45 offen offset:2048 sc1
    s_and_b32 s40, s40, 0x7ff
    v_cmp_eq_u32 vcc, s40, v35
    v_mov_b32 v12, 0x29c000
    s_nop 0
    buffer_load_dwordx4 v[58:61], v16, s[20:23], s45 offen offset:3072 sc1
    v_cndmask_b32 v11, v11, v12, vcc
    s_not_b32 s40, s51
    s_and_b32 s40, s40, 0x7ff
    v_cmp_eq_u32 vcc, s40, v35
    buffer_load_dwordx4 v[62:65], v17, s[20:23], s45 offen offset:0 sc1
    v_mov_b32 v12, 0x29c500
    s_nop 0
    v_cndmask_b32 v11, v11, v12, vcc
    s_not_b32 s40, s52
    s_mov_b32 s45, 184320
    buffer_load_dwordx4 v[66:69], v16, s[20:23], s45 offen offset:0 sc1
    s_and_b32 s40, s40, 0x7ff
    v_cmp_eq_u32 vcc, s40, v35
    v_mov_b32 v12, 0x29ca00
    s_nop 0
    buffer_load_dwordx4 v[70:73], v16, s[20:23], s45 offen offset:1024 sc1
    v_cndmask_b32 v11, v11, v12, vcc
    s_not_b32 s40, s53
    s_and_b32 s40, s40, 0x7ff
    v_cmp_eq_u32 vcc, s40, v35
    buffer_load_dwordx4 v[74:77], v16, s[20:23], s45 offen offset:2048 sc1
    v_mov_b32 v12, 0x29cf00
    s_nop 0
    v_cndmask_b32 v11, v11, v12, vcc
    s_not_b32 s40, s54
    buffer_load_dwordx4 v[78:81], v16, s[20:23], s45 offen offset:3072 sc1
    s_and_b32 s40, s40, 0x7ff
    v_cmp_eq_u32 vcc, s40, v35
    v_mov_b32 v12, 0x29d400
    s_nop 0
    buffer_load_dwordx4 v[82:85], v17, s[20:23], s45 offen offset:0 sc1
    v_cndmask_b32 v11, v11, v12, vcc
    s_not_b32 s40, s55
    s_and_b32 s40, s40, 0x7ff
    v_cmp_eq_u32 vcc, s40, v35
    s_mov_b32 s45, 204800
    buffer_load_dwordx4 v[86:89], v16, s[20:23], s45 offen offset:0 sc1
    v_mov_b32 v12, 0x29d900
    s_nop 0
    v_cndmask_b32 v11, v11, v12, vcc
    s_not_b32 s40, s56
    buffer_load_dwordx4 v[90:93], v16, s[20:23], s45 offen offset:1024 sc1
    s_and_b32 s40, s40, 0x7ff
    v_cmp_eq_u32 vcc, s40, v35
    v_mov_b32 v12, 0x29de00
    s_nop 0
    buffer_load_dwordx4 v[94:97], v16, s[20:23], s45 offen offset:2048 sc1
    v_cndmask_b32 v11, v11, v12, vcc
    s_not_b32 s40, s57
    s_and_b32 s40, s40, 0x7ff
    v_cmp_eq_u32 vcc, s40, v35
    buffer_load_dwordx4 v[98:101], v16, s[20:23], s45 offen offset:3072 sc1
    v_mov_b32 v12, 0x29e300
    s_nop 0
    v_cndmask_b32 v11, v11, v12, vcc
    v_mul_u32_u24 v12, 1280, v35
    buffer_load_dwordx4 v[102:105], v17, s[20:23], s45 offen offset:0 sc1
    v_sub_u32 v12, v34, v12
    v_add_u32 v11, v11, v12
    buffer_load_dwordx4 v[252:255], v1, s[76:79], 0 offen sc1
    s_mul_i32 s40, s6, 27648
    s_lshl_b32 s41, s5, 10
    s_add_u32 s40, s40, s41
    v_lshlrev_b32 v154, 4, v19
    buffer_load_dwordx4 v[126:129], v154, s[16:19], s40 offen sc1
    s_add_u32 s40, s40, 4096
    buffer_load_dwordx4 v[130:133], v154, s[16:19], s40 offen sc1
    s_add_u32 s40, s40, 4096
    buffer_load_dwordx4 v[134:137], v154, s[16:19], s40 offen sc1
    s_add_u32 s40, s40, 4096
    buffer_load_dwordx4 v[138:141], v154, s[16:19], s40 offen sc1
    s_add_u32 s40, s40, 4096
    buffer_load_dwordx4 v[142:145], v154, s[16:19], s40 offen sc1
    s_add_u32 s40, s40, 4096
    buffer_load_dwordx4 v[146:149], v154, s[16:19], s40 offen sc1
    s_add_u32 s40, s40, 4096
    s_cmp_eq_u32 s5, 3
    s_cselect_b32 s40, 0x438000, s40
    buffer_load_dwordx4 v[150:153], v154, s[16:19], s40 offen sc1
    s_mov_b32 s45, 225280
    buffer_load_dwordx4 v[106:109], v16, s[20:23], s45 offen offset:0 sc1
    buffer_load_dwordx4 v[110:113], v16, s[20:23], s45 offen offset:1024 sc1
    buffer_load_dwordx4 v[114:117], v16, s[20:23], s45 offen offset:2048 sc1
    buffer_load_dwordx4 v[118:121], v16, s[20:23], s45 offen offset:3072 sc1
    buffer_load_dwordx4 v[122:125], v17, s[20:23], s45 offen offset:0 sc1
    s_cmp_lg_u32 s5, 0
    s_cbranch_scc1 L_back_o
    s_waitcnt vmcnt(12)
    v_min3_u32 v252, v252, v253, v254
    v_min_u32 v252, v252, v255
    v_cmp_gt_u32 vcc, 1, v252
    s_and_b64 vcc, vcc, exec
    s_cbranch_scc1 L_spin_o
L_back_o:
    s_barrier
    s_add_u32 s44, s30, 0
    buffer_load_dwordx4 a[96:99], v4, s[8:11], s44 offen sc1
    buffer_load_dwordx4 a[100:103], v5, s[8:11], s44 offen sc1
    buffer_load_dwordx4 a[104:107], v6, s[8:11], s44 offen sc1
    buffer_load_dwordx4 a[108:111], v7, s[8:11], s44 offen sc1
    s_add_u32 s44, s30, 16384
    buffer_load_dwordx4 a[112:115], v4, s[8:11], s44 offen sc1
    buffer_load_dwordx4 a[116:119], v5, s[8:11], s44 offen sc1
    buffer_load_dwordx4 a[120:123], v6, s[8:11], s44 offen sc1
    buffer_load_dwordx4 a[124:127], v7, s[8:11], s44 offen sc1
    s_add_u32 s44, s30, 32768
    buffer_load_dwordx4 a[192:195], v4, s[8:11], s44 offen sc1
    buffer_load_dwordx4 a[196:199], v5, s[8:11], s44 offen sc1
    buffer_load_dwordx4 a[200:203], v6, s[8:11], s44 offen sc1
    buffer_load_dwordx4 a[204:207], v7, s[8:11], s44 offen sc1
    s_add_u32 s44, s30, 49152
    buffer_load_dwordx4 a[208:211], v4, s[8:11], s44 offen sc1
    buffer_load_dwordx4 a[212:215], v5, s[8:11], s44 offen sc1
    buffer_load_dwordx4 a[216:219], v6, s[8:11], s44 offen sc1
    buffer_load_dwordx4 a[220:223], v7, s[8:11], s44 offen sc1
    s_waitcnt vmcnt(8)
    v_mfma_f32_16x16x32_bf16 v[166:169], a[128:131], a[96:99], 0
    v_add_f32 v126, v126, v130
    v_mfma_f32_16x16x32_bf16 v[166:169], a[148:151], a[112:115], v[166:169]
    s_add_u32 s44, s30, 65536
    buffer_load_dwordx4 a[224:227], v4, s[8:11], s44 offen sc1
    v_add_f32 v127, v127, v131
    v_add_f32 v128, v128, v132
    v_mfma_f32_16x16x32_bf16 v[186:189], a[148:151], a[116:119], 0
    v_add_f32 v129, v129, v133
    v_mfma_f32_16x16x32_bf16 v[186:189], a[128:131], a[100:103], v[186:189]
    v_add_f32 v126, v126, v134
    v_add_f32 v127, v127, v135
    v_mfma_f32_16x16x32_bf16 v[206:209], a[128:131], a[104:107], 0
    buffer_load_dwordx4 a[228:231], v5, s[8:11], s44 offen sc1
    v_add_f32 v128, v128, v136
    v_add_f32 v129, v129, v137
    v_mfma_f32_16x16x32_bf16 v[206:209], a[148:151], a[120:123], v[206:209]
    v_add_f32 v126, v126, v138
    v_mfma_f32_16x16x32_bf16 v[226:229], a[148:151], a[124:127], 0
    v_add_f32 v127, v127, v139
    v_add_f32 v128, v128, v140
    v_mfma_f32_16x16x32_bf16 v[226:229], a[128:131], a[108:111], v[226:229]
    v_add_f32 v129, v129, v141
    v_mfma_f32_16x16x32_bf16 v[170:173], a[132:135], a[96:99], 0
    buffer_load_dwordx4 a[232:235], v6, s[8:11], s44 offen sc1
    v_add_f32 v126, v126, v142
    v_add_f32 v127, v127, v143
    v_mfma_f32_16x16x32_bf16 v[170:173], a[152:155], a[112:115], v[170:173]
    v_add_f32 v128, v128, v144
    v_add_f32 v129, v129, v145
    v_mfma_f32_16x16x32_bf16 v[190:193], a[152:155], a[116:119], 0
    v_add_f32 v126, v126, v146
    v_mfma_f32_16x16x32_bf16 v[190:193], a[132:135], a[100:103], v[190:193]
    v_add_f32 v127, v127, v147
    v_add_f32 v128, v128, v148
    v_mfma_f32_16x16x32_bf16 v[210:213], a[132:135], a[104:107], 0
    buffer_load_dwordx4 a[236:239], v7, s[8:11], s44 offen sc1
    v_add_f32 v129, v129, v149
    v_mfma_f32_16x16x32_bf16 v[210:213], a[152:155], a[120:123], v[210:213]
    v_add_f32 v126, v126, v150
    v_add_f32 v127, v127, v151
    v_mfma_f32_16x16x32_bf16 v[230:233], a[152:155], a[124:127], 0
    v_add_f32 v128, v128, v152
    v_add_f32 v129, v129, v153
    v_mfma_f32_16x16x32_bf16 v[230:233], a[132:135], a[108:111], v[230:233]
    v_add_f32_dpp v126, v126, v126 row_ror:8 row_mask:0xf bank_mask:0xf
    v_mfma_f32_16x16x32_bf16 v[174:177], a[136:139], a[96:99], 0
    s_add_u32 s44, s30, 81920
    buffer_load_dwordx4 a[240:243], v4, s[8:11], s44 offen sc1
    v_add_f32_dpp v127, v127, v127 row_ror:8 row_mask:0xf bank_mask:0xf
    v_add_f32_dpp v128, v128, v128 row_ror:8 row_mask:0xf bank_mask:0xf
    v_mfma_f32_16x16x32_bf16 v[174:177], a[156:159], a[112:115], v[174:177]
    v_add_f32_dpp v129, v129, v129 row_ror:8 row_mask:0xf bank_mask:0xf
    v_mov_b32 v130, v126
    v_mfma_f32_16x16x32_bf16 v[194:197], a[156:159], a[116:119], 0
    v_mov_b32 v131, v127
    v_mfma_f32_16x16x32_bf16 v[194:197], a[136:139], a[100:103], v[194:197]
    buffer_load_dwordx4 a[244:247], v5, s[8:11], s44 offen sc1
    v_mov_b32 v132, v128
    v_mov_b32 v133, v129
    v_mfma_f32_16x16x32_bf16 v[214:217], a[136:139], a[104:107], 0
    v_permlane16_swap_b32 v126, v130
    v_mfma_f32_16x16x32_bf16 v[214:217], a[156:159], a[120:123], v[214:217]
    v_permlane16_swap_b32 v127, v131
    v_permlane16_swap_b32 v128, v132
    v_mfma_f32_16x16x32_bf16 v[234:237], a[156:159], a[124:127], 0
    v_permlane16_swap_b32 v129, v133
    v_add_f32 v126, v126, v130
    v_mfma_f32_16x16x32_bf16 v[234:237], a[136:139], a[108:111], v[234:237]
    buffer_load_dwordx4 a[248:251], v6, s[8:11], s44 offen sc1
    v_add_f32 v127, v127, v131
    v_mfma_f32_16x16x32_bf16 v[178:181], a[140:143], a[96:99], 0
    v_add_f32 v128, v128, v132
    v_add_f32 v129, v129, v133
    v_mfma_f32_16x16x32_bf16 v[178:181], a[160:163], a[112:115], v[178:181]
    v_mov_b32 v130, v126
    v_mfma_f32_16x16x32_bf16 v[198:201], a[160:163], a[116:119], 0
    v_mov_b32 v131, v127
    v_mov_b32 v132, v128
    v_mfma_f32_16x16x32_bf16 v[198:201], a[140:143], a[100:103], v[198:201]
    buffer_load_dwordx4 a[252:255], v7, s[8:11], s44 offen sc1
    v_mov_b32 v133, v129
    v_permlane32_swap_b32 v126, v130
    v_mfma_f32_16x16x32_bf16 v[218:221], a[140:143], a[104:107], 0
    v_permlane32_swap_b32 v127, v131
    v_mfma_f32_16x16x32_bf16 v[218:221], a[160:163], a[120:123], v[218:221]
    v_permlane32_swap_b32 v128, v132
    v_permlane32_swap_b32 v129, v133
    v_mfma_f32_16x16x32_bf16 v[238:241], a[160:163], a[124:127], 0
    v_add_f32 v126, v126, v130
    v_mfma_f32_16x16x32_bf16 v[238:241], a[140:143], a[108:111], v[238:241]
    v_add_f32 v127, v127, v131
    v_add_f32 v128, v128, v132
    v_mfma_f32_16x16x32_bf16 v[182:185], a[144:147], a[96:99], 0
    v_add_f32 v129, v129, v133
    v_and_b32 v154, 7, v19
    v_mfma_f32_16x16x32_bf16 v[182:185], a[164:167], a[112:115], v[182:185]
    v_lshlrev_b32 v154, 4, v154
    v_mfma_f32_16x16x32_bf16 v[202:205], a[164:167], a[116:119], 0
    v_add_u32 v154, 0, v154
    s_lshl_b32 s40, s5, 7
    v_mfma_f32_16x16x32_bf16 v[202:205], a[144:147], a[100:103], v[202:205]
    v_add_u32 v155, s40, v154
    ds_write_b128 v155, v[126:129]
    v_mfma_f32_16x16x32_bf16 v[222:225], a[144:147], a[104:107], 0
    v_mfma_f32_16x16x32_bf16 v[222:225], a[164:167], a[120:123], v[222:225]
    v_mfma_f32_16x16x32_bf16 v[242:245], a[164:167], a[124:127], 0
    v_mfma_f32_16x16x32_bf16 v[242:245], a[144:147], a[108:111], v[242:245]
    s_waitcnt vmcnt(8)
    v_mfma_f32_16x16x32_bf16 v[166:169], a[168:171], a[192:195], v[166:169]
    s_waitcnt lgkmcnt(0)
    v_mfma_f32_16x16x32_bf16 v[166:169], a[188:191], a[208:211], v[166:169]
    s_add_u32 s44, s30, 196608
    buffer_load_dwordx4 a[96:99], v4, s[8:11], s44 offen sc1
    s_barrier
    v_mfma_f32_16x16x32_bf16 v[186:189], a[188:191], a[212:215], v[186:189]
    ds_read_b128 v[126:129], v154 offset:0
    ds_read_b128 v[130:133], v154 offset:128
    v_mfma_f32_16x16x32_bf16 v[186:189], a[168:171], a[196:199], v[186:189]
    ds_read_b128 v[134:137], v154 offset:256
    v_mfma_f32_16x16x32_bf16 v[206:209], a[168:171], a[200:203], v[206:209]
    buffer_load_dwordx4 a[100:103], v5, s[8:11], s44 offen sc1
    ds_read_b128 v[138:141], v154 offset:384
    s_mul_i32 s42, s6, 3277
    v_mfma_f32_16x16x32_bf16 v[206:209], a[188:191], a[216:219], v[206:209]
    s_lshr_b32 s42, s42, 16
    v_mfma_f32_16x16x32_bf16 v[226:229], a[188:191], a[220:223], v[226:229]
    s_min_u32 s42, s42, 7
    v_mfma_f32_16x16x32_bf16 v[226:229], a[168:171], a[204:207], v[226:229]
    v_readlane_b32 s40, v3, s42
    s_and_b32 s40, s40, 0xffff0000
    v_mfma_f32_16x16x32_bf16 v[170:173], a[172:175], a[192:195], v[170:173]
    buffer_load_dwordx4 a[104:107], v6, s[8:11], s44 offen sc1
    s_ashr_i32 s41, s40, 31
    v_mfma_f32_16x16x32_bf16 v[170:173], a[0:3], a[208:211], v[170:173]
    s_andn2_b32 s41, 0x7fff0000, s41
    s_or_b32 s41, s41, 0x80000000
    v_mfma_f32_16x16x32_bf16 v[190:193], a[0:3], a[212:215], v[190:193]
    s_xor_b32 s40, s40, s41
    v_mfma_f32_16x16x32_bf16 v[190:193], a[172:175], a[196:199], v[190:193]
    v_mov_b32 v142, 0xbfb8aa3b
    v_mfma_f32_16x16x32_bf16 v[210:213], a[172:175], a[200:203], v[210:213]
    buffer_load_dwordx4 a[108:111], v7, s[8:11], s44 offen sc1
    v_mul_f32 v142, s40, v142
    v_exp_f32 v142, v142
    v_mfma_f32_16x16x32_bf16 v[210:213], a[0:3], a[216:219], v[210:213]
    s_nop 0
    v_mfma_f32_16x16x32_bf16 v[230:233], a[0:3], a[220:223], v[230:233]
    v_add_f32 v142, 1.0, v142
    v_rcp_f32 v142, v142
    v_mfma_f32_16x16x32_bf16 v[230:233], a[172:175], a[204:207], v[230:233]
    s_nop 0
    v_mfma_f32_16x16x32_bf16 v[174:177], a[176:179], a[192:195], v[174:177]
    s_add_u32 s44, s30, 212992
    buffer_load_dwordx4 a[112:115], v4, s[8:11], s44 offen sc1
    v_cvt_pk_bf16_f32 v142, v142, v142
    v_mfma_f32_16x16x32_bf16 v[174:177], a[4:7], a[208:211], v[174:177]
    v_lshlrev_b32 v142, 16, v142
    s_lshl_b32 s40, s6, 6
    v_mfma_f32_16x16x32_bf16 v[194:197], a[4:7], a[212:215], v[194:197]
    s_add_u32 s40, s40, 0x29c000
    v_mfma_f32_16x16x32_bf16 v[194:197], a[176:179], a[196:199], v[194:197]
    buffer_load_dwordx4 a[116:119], v5, s[8:11], s44 offen sc1
    s_lshl_b32 s41, s5, 8
    s_add_u32 s41, s41, s6
    v_mfma_f32_16x16x32_bf16 v[214:217], a[176:179], a[200:203], v[214:217]
    s_cmp_lt_u32 s41, 160
    s_cselect_b32 s40, s40, 0x2500000
    v_mfma_f32_16x16x32_bf16 v[214:217], a[4:7], a[216:219], v[214:217]
    v_lshlrev_b32 v143, 3, v19
    v_mfma_f32_16x16x32_bf16 v[234:237], a[4:7], a[220:223], v[234:237]
    s_waitcnt lgkmcnt(0)
    v_add_f32 v126, v126, v130
    v_mfma_f32_16x16x32_bf16 v[234:237], a[176:179], a[204:207], v[234:237]
    buffer_load_dwordx4 a[120:123], v6, s[8:11], s44 offen sc1
    v_add_f32 v127, v127, v131
    v_mfma_f32_16x16x32_bf16 v[178:181], a[180:183], a[192:195], v[178:181]
    v_add_f32 v128, v128, v132
    v_add_f32 v129, v129, v133
    v_mfma_f32_16x16x32_bf16 v[178:181], a[8:11], a[208:211], v[178:181]
    v_add_f32 v126, v126, v134
    v_mfma_f32_16x16x32_bf16 v[198:201], a[8:11], a[212:215], v[198:201]
    v_add_f32 v127, v127, v135
    v_mfma_f32_16x16x32_bf16 v[198:201], a[180:183], a[196:199], v[198:201]
    buffer_load_dwordx4 a[124:127], v7, s[8:11], s44 offen sc1
    v_add_f32 v128, v128, v136
    v_add_f32 v129, v129, v137
    v_mfma_f32_16x16x32_bf16 v[218:221], a[180:183], a[200:203], v[218:221]
    v_add_f32 v126, v126, v138
    v_mfma_f32_16x16x32_bf16 v[218:221], a[8:11], a[216:219], v[218:221]
    v_add_f32 v127, v127, v139
    v_add_f32 v128, v128, v140
    v_mfma_f32_16x16x32_bf16 v[238:241], a[8:11], a[220:223], v[238:241]
    v_add_f32 v129, v129, v141
    v_mfma_f32_16x16x32_bf16 v[238:241], a[180:183], a[204:207], v[238:241]
    v_cvt_pk_bf16_f32 v130, v126, v127
    v_mfma_f32_16x16x32_bf16 v[182:185], a[184:187], a[192:195], v[182:185]
    v_cvt_pk_bf16_f32 v131, v128, v129
    v_lshlrev_b32 v126, 16, v130
    v_mfma_f32_16x16x32_bf16 v[182:185], a[12:15], a[208:211], v[182:185]
    v_and_b32 v127, 0xffff0000, v130
    v_mfma_f32_16x16x32_bf16 v[202:205], a[12:15], a[212:215], v[202:205]
    v_lshlrev_b32 v128, 16, v131
    v_and_b32 v129, 0xffff0000, v131
    v_mfma_f32_16x16x32_bf16 v[202:205], a[184:187], a[196:199], v[202:205]
    v_mul_f32 v126, v126, v142
    v_mfma_f32_16x16x32_bf16 v[222:225], a[184:187], a[200:203], v[222:225]
    v_mul_f32 v127, v127, v142
    v_mfma_f32_16x16x32_bf16 v[222:225], a[12:15], a[216:219], v[222:225]
    v_mul_f32 v128, v128, v142
    v_mul_f32 v129, v129, v142
    v_mfma_f32_16x16x32_bf16 v[242:245], a[12:15], a[220:223], v[242:245]
    v_cvt_pk_bf16_f32 v130, v126, v127
    v_mfma_f32_16x16x32_bf16 v[242:245], a[184:187], a[204:207], v[242:245]
    v_cvt_pk_bf16_f32 v131, v128, v129
    s_mov_b64 exec, 0xff
    buffer_store_dwordx2 v[130:131], v143, s[76:79], s40 offen sc1
    s_mov_b64 exec, -1
    s_waitcnt vmcnt(9)
    v_mfma_f32_16x16x32_bf16 v[166:169], a[16:19], a[224:227], v[166:169]
    v_mfma_f32_16x16x32_bf16 v[166:169], a[36:39], a[240:243], v[166:169]
    s_add_u32 s44, s30, 98304
    buffer_load_dwordx4 a[192:195], v4, s[8:11], s44 offen sc1
    v_mfma_f32_16x16x32_bf16 v[186:189], a[36:39], a[244:247], v[186:189]
    ds_read_b128 v[126:129], v8 offset:0
    v_mfma_f32_16x16x32_bf16 v[186:189], a[16:19], a[228:231], v[186:189]
    v_mfma_f32_16x16x32_bf16 v[206:209], a[16:19], a[232:235], v[206:209]
    buffer_load_dwordx4 a[196:199], v5, s[8:11], s44 offen sc1
    v_mfma_f32_16x16x32_bf16 v[206:209], a[36:39], a[248:251], v[206:209]
    ds_read_b128 v[130:133], v8 offset:1024
    v_mfma_f32_16x16x32_bf16 v[226:229], a[36:39], a[252:255], v[226:229]
    v_mfma_f32_16x16x32_bf16 v[226:229], a[16:19], a[236:239], v[226:229]
    ds_read_b128 v[134:137], v8 offset:2048
    v_mfma_f32_16x16x32_bf16 v[170:173], a[20:23], a[224:227], v[170:173]
    buffer_load_dwordx4 a[200:203], v6, s[8:11], s44 offen sc1
    v_mfma_f32_16x16x32_bf16 v[170:173], a[40:43], a[240:243], v[170:173]
    v_mfma_f32_16x16x32_bf16 v[190:193], a[40:43], a[244:247], v[190:193]
    ds_read_b128 v[138:141], v8 offset:3072
    v_mfma_f32_16x16x32_bf16 v[190:193], a[20:23], a[228:231], v[190:193]
    v_mfma_f32_16x16x32_bf16 v[210:213], a[20:23], a[232:235], v[210:213]
    buffer_load_dwordx4 a[204:207], v7, s[8:11], s44 offen sc1
    v_mfma_f32_16x16x32_bf16 v[210:213], a[40:43], a[248:251], v[210:213]
    ds_read_b128 v[142:145], v8 offset:4096
    v_mfma_f32_16x16x32_bf16 v[230:233], a[40:43], a[252:255], v[230:233]
    v_mfma_f32_16x16x32_bf16 v[230:233], a[20:23], a[236:239], v[230:233]
    ds_read_b128 v[146:149], v8 offset:5120
    v_mfma_f32_16x16x32_bf16 v[174:177], a[24:27], a[224:227], v[174:177]
    s_add_u32 s44, s30, 114688
    buffer_load_dwordx4 a[208:211], v4, s[8:11], s44 offen sc1
    v_mfma_f32_16x16x32_bf16 v[174:177], a[44:47], a[240:243], v[174:177]
    v_mfma_f32_16x16x32_bf16 v[194:197], a[44:47], a[244:247], v[194:197]
    ds_read_b128 v[150:153], v8 offset:6144
    v_mfma_f32_16x16x32_bf16 v[194:197], a[24:27], a[228:231], v[194:197]
    buffer_load_dwordx4 a[212:215], v5, s[8:11], s44 offen sc1
    v_mfma_f32_16x16x32_bf16 v[214:217], a[24:27], a[232:235], v[214:217]
    v_mfma_f32_16x16x32_bf16 v[214:217], a[44:47], a[248:251], v[214:217]
    ds_read_b128 v[154:157], v8 offset:7168
    v_mfma_f32_16x16x32_bf16 v[234:237], a[44:47], a[252:255], v[234:237]
    v_mfma_f32_16x16x32_bf16 v[234:237], a[24:27], a[236:239], v[234:237]
    buffer_load_dwordx4 a[216:219], v6, s[8:11], s44 offen sc1
    v_mfma_f32_16x16x32_bf16 v[178:181], a[28:31], a[224:227], v[178:181]
    ds_read_b128 v[158:161], v8 offset:8192
    v_mfma_f32_16x16x32_bf16 v[178:181], a[48:51], a[240:243], v[178:181]
    v_mfma_f32_16x16x32_bf16 v[198:201], a[48:51], a[244:247], v[198:201]
    ds_read_b128 v[162:165], v8 offset:9216
    v_mfma_f32_16x16x32_bf16 v[198:201], a[28:31], a[228:231], v[198:201]
    buffer_load_dwordx4 a[220:223], v7, s[8:11], s44 offen sc1
    v_mfma_f32_16x16x32_bf16 v[218:221], a[28:31], a[232:235], v[218:221]
    v_mfma_f32_16x16x32_bf16 v[218:221], a[48:51], a[248:251], v[218:221]
    v_mfma_f32_16x16x32_bf16 v[238:241], a[48:51], a[252:255], v[238:241]
    v_mfma_f32_16x16x32_bf16 v[238:241], a[28:31], a[236:239], v[238:241]
    v_mfma_f32_16x16x32_bf16 v[182:185], a[32:35], a[224:227], v[182:185]
    v_mfma_f32_16x16x32_bf16 v[182:185], a[52:55], a[240:243], v[182:185]
    v_mfma_f32_16x16x32_bf16 v[202:205], a[52:55], a[244:247], v[202:205]
    v_mfma_f32_16x16x32_bf16 v[202:205], a[32:35], a[228:231], v[202:205]
    v_mfma_f32_16x16x32_bf16 v[222:225], a[32:35], a[232:235], v[222:225]
    v_mfma_f32_16x16x32_bf16 v[222:225], a[52:55], a[248:251], v[222:225]
    v_mfma_f32_16x16x32_bf16 v[242:245], a[52:55], a[252:255], v[242:245]
    v_mfma_f32_16x16x32_bf16 v[242:245], a[32:35], a[236:239], v[242:245]
    s_waitcnt vmcnt(9) lgkmcnt(0)
    v_mfma_f32_16x16x32_bf16 v[166:169], v[126:129], a[96:99], v[166:169]
    v_mfma_f32_16x16x32_bf16 v[166:169], v[146:149], a[112:115], v[166:169]
    s_add_u32 s44, s30, 229376
    buffer_load_dwordx4 a[224:227], v4, s[8:11], s44 offen sc1
    v_mfma_f32_16x16x32_bf16 v[186:189], v[146:149], a[116:119], v[186:189]
    v_mfma_f32_16x16x32_bf16 v[186:189], v[126:129], a[100:103], v[186:189]
    v_mfma_f32_16x16x32_bf16 v[206:209], v[126:129], a[104:107], v[206:209]
    buffer_load_dwordx4 a[228:231], v5, s[8:11], s44 offen sc1
    v_mfma_f32_16x16x32_bf16 v[206:209], v[146:149], a[120:123], v[206:209]
    v_mfma_f32_16x16x32_bf16 v[226:229], v[146:149], a[124:127], v[226:229]
    v_mfma_f32_16x16x32_bf16 v[226:229], v[126:129], a[108:111], v[226:229]
    v_mfma_f32_16x16x32_bf16 v[170:173], v[130:133], a[96:99], v[170:173]
    buffer_load_dwordx4 a[232:235], v6, s[8:11], s44 offen sc1
    v_mfma_f32_16x16x32_bf16 v[170:173], v[150:153], a[112:115], v[170:173]
    v_mfma_f32_16x16x32_bf16 v[190:193], v[150:153], a[116:119], v[190:193]
    v_mfma_f32_16x16x32_bf16 v[190:193], v[130:133], a[100:103], v[190:193]
    v_mfma_f32_16x16x32_bf16 v[210:213], v[130:133], a[104:107], v[210:213]
    buffer_load_dwordx4 a[236:239], v7, s[8:11], s44 offen sc1
    v_mfma_f32_16x16x32_bf16 v[210:213], v[150:153], a[120:123], v[210:213]
    v_mfma_f32_16x16x32_bf16 v[230:233], v[150:153], a[124:127], v[230:233]
    v_mfma_f32_16x16x32_bf16 v[230:233], v[130:133], a[108:111], v[230:233]
    v_mfma_f32_16x16x32_bf16 v[174:177], v[134:137], a[96:99], v[174:177]
    s_add_u32 s44, s30, 245760
    buffer_load_dwordx4 a[240:243], v4, s[8:11], s44 offen sc1
    v_mfma_f32_16x16x32_bf16 v[174:177], v[154:157], a[112:115], v[174:177]
    v_mfma_f32_16x16x32_bf16 v[194:197], v[154:157], a[116:119], v[194:197]
    v_mfma_f32_16x16x32_bf16 v[194:197], v[134:137], a[100:103], v[194:197]
    buffer_load_dwordx4 a[244:247], v5, s[8:11], s44 offen sc1
    v_mfma_f32_16x16x32_bf16 v[214:217], v[134:137], a[104:107], v[214:217]
    v_mfma_f32_16x16x32_bf16 v[214:217], v[154:157], a[120:123], v[214:217]
    v_mfma_f32_16x16x32_bf16 v[234:237], v[154:157], a[124:127], v[234:237]
    v_mfma_f32_16x16x32_bf16 v[234:237], v[134:137], a[108:111], v[234:237]
    buffer_load_dwordx4 a[248:251], v6, s[8:11], s44 offen sc1
    v_mfma_f32_16x16x32_bf16 v[178:181], v[138:141], a[96:99], v[178:181]
    v_mfma_f32_16x16x32_bf16 v[178:181], v[158:161], a[112:115], v[178:181]
    v_mfma_f32_16x16x32_bf16 v[198:201], v[158:161], a[116:119], v[198:201]
    v_mfma_f32_16x16x32_bf16 v[198:201], v[138:141], a[100:103], v[198:201]
    buffer_load_dwordx4 a[252:255], v7, s[8:11], s44 offen sc1
    v_mfma_f32_16x16x32_bf16 v[218:221], v[138:141], a[104:107], v[218:221]
    v_mfma_f32_16x16x32_bf16 v[218:221], v[158:161], a[120:123], v[218:221]
    v_mfma_f32_16x16x32_bf16 v[238:241], v[158:161], a[124:127], v[238:241]
    v_mfma_f32_16x16x32_bf16 v[238:241], v[138:141], a[108:111], v[238:241]
    v_mfma_f32_16x16x32_bf16 v[182:185], v[142:145], a[96:99], v[182:185]
    v_mfma_f32_16x16x32_bf16 v[182:185], v[162:165], a[112:115], v[182:185]
    v_mfma_f32_16x16x32_bf16 v[202:205], v[162:165], a[116:119], v[202:205]
    v_mfma_f32_16x16x32_bf16 v[202:205], v[142:145], a[100:103], v[202:205]
    v_mfma_f32_16x16x32_bf16 v[222:225], v[142:145], a[104:107], v[222:225]
    v_mfma_f32_16x16x32_bf16 v[222:225], v[162:165], a[120:123], v[222:225]
    v_mfma_f32_16x16x32_bf16 v[242:245], v[162:165], a[124:127], v[242:245]
    v_mfma_f32_16x16x32_bf16 v[242:245], v[142:145], a[108:111], v[242:245]
    s_waitcnt vmcnt(8)
    v_mfma_f32_16x16x32_bf16 v[166:169], a[56:59], a[192:195], v[166:169]
    v_mfma_f32_16x16x32_bf16 v[166:169], a[76:79], a[208:211], v[166:169]
    s_add_u32 s44, s30, 131072
    buffer_load_dwordx4 a[96:99], v4, s[8:11], s44 offen sc1
    v_mfma_f32_16x16x32_bf16 v[186:189], a[76:79], a[212:215], v[186:189]
    ds_read_b128 v[126:129], v9 offset:0
    v_mfma_f32_16x16x32_bf16 v[186:189], a[56:59], a[196:199], v[186:189]
    v_mfma_f32_16x16x32_bf16 v[206:209], a[56:59], a[200:203], v[206:209]
    buffer_load_dwordx4 a[100:103], v5, s[8:11], s44 offen sc1
    v_mfma_f32_16x16x32_bf16 v[206:209], a[76:79], a[216:219], v[206:209]
    ds_read_b128 v[130:133], v9 offset:1024
    v_mfma_f32_16x16x32_bf16 v[226:229], a[76:79], a[220:223], v[226:229]
    v_mfma_f32_16x16x32_bf16 v[226:229], a[56:59], a[204:207], v[226:229]
    ds_read_b128 v[134:137], v9 offset:2048
    v_mfma_f32_16x16x32_bf16 v[170:173], a[60:63], a[192:195], v[170:173]
    buffer_load_dwordx4 a[104:107], v6, s[8:11], s44 offen sc1
    v_mfma_f32_16x16x32_bf16 v[170:173], a[80:83], a[208:211], v[170:173]
    v_mfma_f32_16x16x32_bf16 v[190:193], a[80:83], a[212:215], v[190:193]
    ds_read_b128 v[138:141], v9 offset:3072
    v_mfma_f32_16x16x32_bf16 v[190:193], a[60:63], a[196:199], v[190:193]
    v_mfma_f32_16x16x32_bf16 v[210:213], a[60:63], a[200:203], v[210:213]
    buffer_load_dwordx4 a[108:111], v7, s[8:11], s44 offen sc1
    v_mfma_f32_16x16x32_bf16 v[210:213], a[80:83], a[216:219], v[210:213]
    ds_read_b128 v[142:145], v9 offset:4096
    v_mfma_f32_16x16x32_bf16 v[230:233], a[80:83], a[220:223], v[230:233]
    v_mfma_f32_16x16x32_bf16 v[230:233], a[60:63], a[204:207], v[230:233]
    ds_read_b128 v[146:149], v9 offset:5120
    v_mfma_f32_16x16x32_bf16 v[174:177], a[64:67], a[192:195], v[174:177]
    s_add_u32 s44, s30, 147456
    buffer_load_dwordx4 a[112:115], v4, s[8:11], s44 offen sc1
    v_mfma_f32_16x16x32_bf16 v[174:177], a[84:87], a[208:211], v[174:177]
    v_mfma_f32_16x16x32_bf16 v[194:197], a[84:87], a[212:215], v[194:197]
    ds_read_b128 v[150:153], v9 offset:6144
    v_mfma_f32_16x16x32_bf16 v[194:197], a[64:67], a[196:199], v[194:197]
    buffer_load_dwordx4 a[116:119], v5, s[8:11], s44 offen sc1
    v_mfma_f32_16x16x32_bf16 v[214:217], a[64:67], a[200:203], v[214:217]
    v_mfma_f32_16x16x32_bf16 v[214:217], a[84:87], a[216:219], v[214:217]
    ds_read_b128 v[154:157], v9 offset:7168
    v_mfma_f32_16x16x32_bf16 v[234:237], a[84:87], a[220:223], v[234:237]
    v_mfma_f32_16x16x32_bf16 v[234:237], a[64:67], a[204:207], v[234:237]
    buffer_load_dwordx4 a[120:123], v6, s[8:11], s44 offen sc1
    v_mfma_f32_16x16x32_bf16 v[178:181], a[68:71], a[192:195], v[178:181]
    ds_read_b128 v[158:161], v9 offset:8192
    v_mfma_f32_16x16x32_bf16 v[178:181], a[88:91], a[208:211], v[178:181]
    v_mfma_f32_16x16x32_bf16 v[198:201], a[88:91], a[212:215], v[198:201]
    ds_read_b128 v[162:165], v9 offset:9216
    v_mfma_f32_16x16x32_bf16 v[198:201], a[68:71], a[196:199], v[198:201]
    buffer_load_dwordx4 a[124:127], v7, s[8:11], s44 offen sc1
    v_mfma_f32_16x16x32_bf16 v[218:221], a[68:71], a[200:203], v[218:221]
    v_mfma_f32_16x16x32_bf16 v[218:221], a[88:91], a[216:219], v[218:221]
    v_mfma_f32_16x16x32_bf16 v[238:241], a[88:91], a[220:223], v[238:241]
    v_mfma_f32_16x16x32_bf16 v[238:241], a[68:71], a[204:207], v[238:241]
    v_mfma_f32_16x16x32_bf16 v[182:185], a[72:75], a[192:195], v[182:185]
    v_mfma_f32_16x16x32_bf16 v[182:185], a[92:95], a[208:211], v[182:185]
    v_mfma_f32_16x16x32_bf16 v[202:205], a[92:95], a[212:215], v[202:205]
    v_mfma_f32_16x16x32_bf16 v[202:205], a[72:75], a[196:199], v[202:205]
    v_mfma_f32_16x16x32_bf16 v[222:225], a[72:75], a[200:203], v[222:225]
    v_mfma_f32_16x16x32_bf16 v[222:225], a[92:95], a[216:219], v[222:225]
    v_mfma_f32_16x16x32_bf16 v[242:245], a[92:95], a[220:223], v[242:245]
    v_mfma_f32_16x16x32_bf16 v[242:245], a[72:75], a[204:207], v[242:245]
    s_waitcnt vmcnt(8) lgkmcnt(0)
    v_mfma_f32_16x16x32_bf16 v[166:169], v[126:129], a[224:227], v[166:169]
    v_mfma_f32_16x16x32_bf16 v[166:169], v[146:149], a[240:243], v[166:169]
    s_add_u32 s44, s30, 163840
    buffer_load_dwordx4 a[192:195], v4, s[8:11], s44 offen sc1
    s_lshl_b32 s36, s2, 5
    v_mfma_f32_16x16x32_bf16 v[186:189], v[146:149], a[244:247], v[186:189]
    v_mfma_f32_16x16x32_bf16 v[186:189], v[126:129], a[228:231], v[186:189]
    s_add_u32 s36, s36, s5
    v_mfma_f32_16x16x32_bf16 v[206:209], v[126:129], a[232:235], v[206:209]
    buffer_load_dwordx4 a[196:199], v5, s[8:11], s44 offen sc1
    v_mfma_f32_16x16x32_bf16 v[206:209], v[146:149], a[248:251], v[206:209]
    s_lshl_b32 s36, s36, 2
    v_mfma_f32_16x16x32_bf16 v[226:229], v[146:149], a[252:255], v[226:229]
    s_add_u32 s36, s36, 0x2a0000
    v_mfma_f32_16x16x32_bf16 v[226:229], v[126:129], a[236:239], v[226:229]
    v_mfma_f32_16x16x32_bf16 v[170:173], v[130:133], a[224:227], v[170:173]
    buffer_load_dwordx4 a[200:203], v6, s[8:11], s44 offen sc1
    s_xor_b32 s37, s36, 1024
    v_mfma_f32_16x16x32_bf16 v[170:173], v[150:153], a[240:243], v[170:173]
    v_mfma_f32_16x16x32_bf16 v[190:193], v[150:153], a[244:247], v[190:193]
    s_sub_u32 s40, s5, 1
    v_mfma_f32_16x16x32_bf16 v[190:193], v[130:133], a[228:231], v[190:193]
    v_mfma_f32_16x16x32_bf16 v[210:213], v[130:133], a[232:235], v[210:213]
    buffer_load_dwordx4 a[204:207], v7, s[8:11], s44 offen sc1
    s_and_b32 s40, s40, 3
    v_mfma_f32_16x16x32_bf16 v[210:213], v[150:153], a[248:251], v[210:213]
    s_mul_i32 s40, s40, 20480
    v_mfma_f32_16x16x32_bf16 v[230:233], v[150:153], a[252:255], v[230:233]
    v_mfma_f32_16x16x32_bf16 v[230:233], v[130:133], a[236:239], v[230:233]
    v_lshl_add_u32 v13, v19, 4, s40
    v_mfma_f32_16x16x32_bf16 v[174:177], v[134:137], a[224:227], v[174:177]
    s_add_u32 s44, s30, 180224
    buffer_load_dwordx4 a[208:211], v4, s[8:11], s44 offen sc1
    v_mfma_f32_16x16x32_bf16 v[174:177], v[154:157], a[240:243], v[174:177]
    s_sub_u32 s40, s5, 2
    v_mfma_f32_16x16x32_bf16 v[194:197], v[154:157], a[244:247], v[194:197]
    v_mfma_f32_16x16x32_bf16 v[194:197], v[134:137], a[228:231], v[194:197]
    buffer_load_dwordx4 a[212:215], v5, s[8:11], s44 offen sc1
    s_and_b32 s40, s40, 3
    v_mfma_f32_16x16x32_bf16 v[214:217], v[134:137], a[232:235], v[214:217]
    s_mul_i32 s40, s40, 20480
    v_mfma_f32_16x16x32_bf16 v[214:217], v[154:157], a[248:251], v[214:217]
    v_mfma_f32_16x16x32_bf16 v[234:237], v[154:157], a[252:255], v[234:237]
    v_lshl_add_u32 v14, v19, 4, s40
    v_mfma_f32_16x16x32_bf16 v[234:237], v[134:137], a[236:239], v[234:237]
    buffer_load_dwordx4 a[216:219], v6, s[8:11], s44 offen sc1
    v_mfma_f32_16x16x32_bf16 v[178:181], v[138:141], a[224:227], v[178:181]
    s_sub_u32 s40, s5, 3
    v_mfma_f32_16x16x32_bf16 v[178:181], v[158:161], a[240:243], v[178:181]
    v_mfma_f32_16x16x32_bf16 v[198:201], v[158:161], a[244:247], v[198:201]
    s_and_b32 s40, s40, 3
    v_mfma_f32_16x16x32_bf16 v[198:201], v[138:141], a[228:231], v[198:201]
    buffer_load_dwordx4 a[220:223], v7, s[8:11], s44 offen sc1
    s_mul_i32 s40, s40, 20480
    v_mfma_f32_16x16x32_bf16 v[218:221], v[138:141], a[232:235], v[218:221]
    v_mfma_f32_16x16x32_bf16 v[218:221], v[158:161], a[248:251], v[218:221]
    v_lshl_add_u32 v15, v19, 4, s40
    v_mfma_f32_16x16x32_bf16 v[238:241], v[158:161], a[252:255], v[238:241]
    v_mfma_f32_16x16x32_bf16 v[238:241], v[138:141], a[236:239], v[238:241]
    s_lshl_b32 s40, s2, 2
    v_mfma_f32_16x16x32_bf16 v[182:185], v[142:145], a[224:227], v[182:185]
    v_mfma_f32_16x16x32_bf16 v[182:185], v[162:165], a[240:243], v[182:185]
    s_add_u32 s40, s40, s5
    v_mfma_f32_16x16x32_bf16 v[202:205], v[162:165], a[244:247], v[202:205]
    s_mul_i32 s40, s40, 5120
    v_mfma_f32_16x16x32_bf16 v[202:205], v[142:145], a[228:231], v[202:205]
    v_mfma_f32_16x16x32_bf16 v[222:225], v[142:145], a[232:235], v[222:225]
    s_add_u32 s40, s40, 0x2000000
    v_mfma_f32_16x16x32_bf16 v[222:225], v[162:165], a[248:251], v[222:225]
    v_mfma_f32_16x16x32_bf16 v[242:245], v[162:165], a[252:255], v[242:245]
    v_lshl_add_u32 v18, v19, 4, s40
    v_mfma_f32_16x16x32_bf16 v[242:245], v[142:145], a[236:239], v[242:245]
    s_mov_b32 s41, 4096
    s_waitcnt vmcnt(8)
    v_mfma_f32_16x16x32_bf16 v[166:169], v[46:49], a[96:99], v[166:169]
    v_mfma_f32_16x16x32_bf16 v[166:169], v[66:69], a[112:115], v[166:169]
    s_add_u32 s44, s31, 0
    buffer_load_dwordx4 a[224:227], v4, s[8:11], s44 offen sc1
    v_mfma_f32_16x16x32_bf16 v[186:189], v[66:69], a[116:119], v[186:189]
    v_mfma_f32_16x16x32_bf16 v[186:189], v[46:49], a[100:103], v[186:189]
    v_mfma_f32_16x16x32_bf16 v[206:209], v[46:49], a[104:107], v[206:209]
    buffer_load_dwordx4 a[228:231], v5, s[8:11], s44 offen sc1
    v_mfma_f32_16x16x32_bf16 v[206:209], v[66:69], a[120:123], v[206:209]
    v_mfma_f32_16x16x32_bf16 v[226:229], v[66:69], a[124:127], v[226:229]
    v_mfma_f32_16x16x32_bf16 v[226:229], v[46:49], a[108:111], v[226:229]
    v_mfma_f32_16x16x32_bf16 v[170:173], v[50:53], a[96:99], v[170:173]
    buffer_load_dwordx4 a[232:235], v6, s[8:11], s44 offen sc1
    v_mfma_f32_16x16x32_bf16 v[170:173], v[70:73], a[112:115], v[170:173]
    v_mfma_f32_16x16x32_bf16 v[190:193], v[70:73], a[116:119], v[190:193]
    v_mfma_f32_16x16x32_bf16 v[190:193], v[50:53], a[100:103], v[190:193]
    v_mfma_f32_16x16x32_bf16 v[210:213], v[50:53], a[104:107], v[210:213]
    buffer_load_dwordx4 a[236:239], v7, s[8:11], s44 offen sc1
    v_mfma_f32_16x16x32_bf16 v[210:213], v[70:73], a[120:123], v[210:213]
    v_mfma_f32_16x16x32_bf16 v[230:233], v[70:73], a[124:127], v[230:233]
    v_mfma_f32_16x16x32_bf16 v[230:233], v[50:53], a[108:111], v[230:233]
    v_mfma_f32_16x16x32_bf16 v[174:177], v[54:57], a[96:99], v[174:177]
    s_add_u32 s44, s31, 16384
    buffer_load_dwordx4 a[240:243], v4, s[8:11], s44 offen sc1
    v_mfma_f32_16x16x32_bf16 v[174:177], v[74:77], a[112:115], v[174:177]
    v_mfma_f32_16x16x32_bf16 v[194:197], v[74:77], a[116:119], v[194:197]
    v_mfma_f32_16x16x32_bf16 v[194:197], v[54:57], a[100:103], v[194:197]
    buffer_load_dwordx4 a[244:247], v5, s[8:11], s44 offen sc1
    v_mfma_f32_16x16x32_bf16 v[214:217], v[54:57], a[104:107], v[214:217]
    v_mfma_f32_16x16x32_bf16 v[214:217], v[74:77], a[120:123], v[214:217]
    v_mfma_f32_16x16x32_bf16 v[234:237], v[74:77], a[124:127], v[234:237]
    v_mfma_f32_16x16x32_bf16 v[234:237], v[54:57], a[108:111], v[234:237]
    buffer_load_dwordx4 a[248:251], v6, s[8:11], s44 offen sc1
    v_mfma_f32_16x16x32_bf16 v[178:181], v[58:61], a[96:99], v[178:181]
    v_mfma_f32_16x16x32_bf16 v[178:181], v[78:81], a[112:115], v[178:181]
    v_mfma_f32_16x16x32_bf16 v[198:201], v[78:81], a[116:119], v[198:201]
    v_mfma_f32_16x16x32_bf16 v[198:201], v[58:61], a[100:103], v[198:201]
    buffer_load_dwordx4 a[252:255], v7, s[8:11], s44 offen sc1
    v_mfma_f32_16x16x32_bf16 v[218:221], v[58:61], a[104:107], v[218:221]
    v_mfma_f32_16x16x32_bf16 v[218:221], v[78:81], a[120:123], v[218:221]
    v_mfma_f32_16x16x32_bf16 v[238:241], v[78:81], a[124:127], v[238:241]
    v_mfma_f32_16x16x32_bf16 v[238:241], v[58:61], a[108:111], v[238:241]
    v_mfma_f32_16x16x32_bf16 v[182:185], v[62:65], a[96:99], v[182:185]
    v_mfma_f32_16x16x32_bf16 v[182:185], v[82:85], a[112:115], v[182:185]
    v_mfma_f32_16x16x32_bf16 v[202:205], v[82:85], a[116:119], v[202:205]
    v_mfma_f32_16x16x32_bf16 v[202:205], v[62:65], a[100:103], v[202:205]
    v_mfma_f32_16x16x32_bf16 v[222:225], v[62:65], a[104:107], v[222:225]
    v_mfma_f32_16x16x32_bf16 v[222:225], v[82:85], a[120:123], v[222:225]
    v_mfma_f32_16x16x32_bf16 v[242:245], v[82:85], a[124:127], v[242:245]
    v_mfma_f32_16x16x32_bf16 v[242:245], v[62:65], a[108:111], v[242:245]
    s_waitcnt vmcnt(8)
    v_mfma_f32_16x16x32_bf16 v[186:189], v[86:89], a[196:199], v[186:189]
    v_mfma_f32_16x16x32_bf16 v[186:189], v[106:109], a[212:215], v[186:189]
    s_add_u32 s44, s31, 32768
    buffer_load_dwordx4 a[96:99], v4, s[8:11], s44 offen sc1
    v_mfma_f32_16x16x32_bf16 v[190:193], v[110:113], a[212:215], v[190:193]
    v_mfma_f32_16x16x32_bf16 v[190:193], v[90:93], a[196:199], v[190:193]
    v_mfma_f32_16x16x32_bf16 v[194:197], v[94:97], a[196:199], v[194:197]
    buffer_load_dwordx4 a[100:103], v5, s[8:11], s44 offen sc1
    v_mfma_f32_16x16x32_bf16 v[194:197], v[114:117], a[212:215], v[194:197]
    v_mfma_f32_16x16x32_bf16 v[198:201], v[118:121], a[212:215], v[198:201]
    v_mfma_f32_16x16x32_bf16 v[198:201], v[98:101], a[196:199], v[198:201]
    v_mfma_f32_16x16x32_bf16 v[202:205], v[102:105], a[196:199], v[202:205]
    buffer_load_dwordx4 a[104:107], v6, s[8:11], s44 offen sc1
    v_mfma_f32_16x16x32_bf16 v[202:205], v[122:125], a[212:215], v[202:205]
    ds_write_b128 v10, v[186:189] offset:0
    v_mfma_f32_16x16x32_bf16 v[206:209], v[106:109], a[216:219], v[206:209]
    v_mfma_f32_16x16x32_bf16 v[206:209], v[86:89], a[200:203], v[206:209]
    ds_write_b128 v10, v[190:193] offset:1024
    v_mfma_f32_16x16x32_bf16 v[210:213], v[90:93], a[200:203], v[210:213]
    buffer_load_dwordx4 a[108:111], v7, s[8:11], s44 offen sc1
    v_mfma_f32_16x16x32_bf16 v[210:213], v[110:113], a[216:219], v[210:213]
    ds_write_b128 v10, v[194:197] offset:2048
    v_mfma_f32_16x16x32_bf16 v[214:217], v[114:117], a[216:219], v[214:217]
    v_mfma_f32_16x16x32_bf16 v[214:217], v[94:97], a[200:203], v[214:217]
    ds_write_b128 v10, v[198:201] offset:3072
    v_mfma_f32_16x16x32_bf16 v[218:221], v[98:101], a[200:203], v[218:221]
    s_add_u32 s44, s31, 49152
    buffer_load_dwordx4 a[112:115], v4, s[8:11], s44 offen sc1
    v_mfma_f32_16x16x32_bf16 v[218:221], v[118:121], a[216:219], v[218:221]
    ds_write_b128 v10, v[202:205] offset:4096
    v_mfma_f32_16x16x32_bf16 v[222:225], v[122:125], a[216:219], v[222:225]
    v_mfma_f32_16x16x32_bf16 v[222:225], v[102:105], a[200:203], v[222:225]
    ds_write_b128 v10, v[206:209] offset:5120
    buffer_load_dwordx4 a[116:119], v5, s[8:11], s44 offen sc1
    v_mfma_f32_16x16x32_bf16 v[226:229], v[86:89], a[204:207], v[226:229]
    v_mfma_f32_16x16x32_bf16 v[226:229], v[106:109], a[220:223], v[226:229]
    ds_write_b128 v10, v[210:213] offset:6144
    v_mfma_f32_16x16x32_bf16 v[230:233], v[110:113], a[220:223], v[230:233]
    v_mfma_f32_16x16x32_bf16 v[230:233], v[90:93], a[204:207], v[230:233]
    ds_write_b128 v10, v[214:217] offset:7168
    buffer_load_dwordx4 a[120:123], v6, s[8:11], s44 offen sc1
    v_mfma_f32_16x16x32_bf16 v[234:237], v[94:97], a[204:207], v[234:237]
    v_mfma_f32_16x16x32_bf16 v[234:237], v[114:117], a[220:223], v[234:237]
    ds_write_b128 v10, v[218:221] offset:8192
    v_mfma_f32_16x16x32_bf16 v[238:241], v[118:121], a[220:223], v[238:241]
    v_mfma_f32_16x16x32_bf16 v[238:241], v[98:101], a[204:207], v[238:241]
    ds_write_b128 v10, v[222:225] offset:9216
    buffer_load_dwordx4 a[124:127], v7, s[8:11], s44 offen sc1
    v_mfma_f32_16x16x32_bf16 v[242:245], v[102:105], a[204:207], v[242:245]
    v_mfma_f32_16x16x32_bf16 v[242:245], v[122:125], a[220:223], v[242:245]
    ds_write_b128 v10, v[226:229] offset:10240
    v_mfma_f32_16x16x32_bf16 v[166:169], v[106:109], a[208:211], v[166:169]
    v_mfma_f32_16x16x32_bf16 v[166:169], v[86:89], a[192:195], v[166:169]
    ds_write_b128 v10, v[230:233] offset:11264
    v_mfma_f32_16x16x32_bf16 v[170:173], v[90:93], a[192:195], v[170:173]
    v_mfma_f32_16x16x32_bf16 v[170:173], v[110:113], a[208:211], v[170:173]
    ds_write_b128 v10, v[234:237] offset:12288
    v_mfma_f32_16x16x32_bf16 v[174:177], v[114:117], a[208:211], v[174:177]
    v_mfma_f32_16x16x32_bf16 v[174:177], v[94:97], a[192:195], v[174:177]
    ds_write_b128 v10, v[238:241] offset:13312
    v_mfma_f32_16x16x32_bf16 v[178:181], v[98:101], a[192:195], v[178:181]
    v_mfma_f32_16x16x32_bf16 v[178:181], v[118:121], a[208:211], v[178:181]
    ds_write_b128 v10, v[242:245] offset:14336
    v_mfma_f32_16x16x32_bf16 v[182:185], v[122:125], a[208:211], v[182:185]
    v_mfma_f32_16x16x32_bf16 v[182:185], v[102:105], a[192:195], v[182:185]
    s_waitcnt vmcnt(8)
    v_mfma_f32_16x16x32_bf16 v[186:189], a[128:131], a[228:231], 0
    s_nop 0
    v_mov_b32 v126, v166
    v_mfma_f32_16x16x32_bf16 v[186:189], a[148:151], a[244:247], v[186:189]
    s_add_u32 s44, s31, 65536
    buffer_load_dwordx4 a[192:195], v4, s[8:11], s44 offen sc1
    v_mov_b32 v127, v167
    v_mov_b32 v128, v168
    v_mov_b32 v129, v169
    v_mfma_f32_16x16x32_bf16 v[190:193], a[152:155], a[244:247], 0
    v_mov_b32 v130, v170
    v_mov_b32 v131, v171
    v_mov_b32 v132, v172
    v_mfma_f32_16x16x32_bf16 v[190:193], a[132:135], a[228:231], v[190:193]
    v_mov_b32 v133, v173
    s_waitcnt lgkmcnt(0)
    s_barrier
    v_mfma_f32_16x16x32_bf16 v[194:197], a[136:139], a[228:231], 0
    buffer_load_dwordx4 a[196:199], v5, s[8:11], s44 offen sc1
    ds_read_b128 v[146:149], v13 offset:0
    ds_read_b128 v[150:153], v13 offset:1024
    v_mfma_f32_16x16x32_bf16 v[194:197], a[156:159], a[244:247], v[194:197]
    ds_read_b128 v[154:157], v13 offset:2048
    ds_read_b128 v[158:161], v13 offset:3072
    ds_read_b128 v[162:165], v13 offset:4096
    v_mfma_f32_16x16x32_bf16 v[198:201], a[160:163], a[244:247], 0
    v_mov_b32 v134, v174
    v_mov_b32 v135, v175
    v_mov_b32 v136, v176
    v_mfma_f32_16x16x32_bf16 v[198:201], a[140:143], a[228:231], v[198:201]
    v_mov_b32 v137, v177
    v_mov_b32 v138, v178
    v_mov_b32 v139, v179
    v_mfma_f32_16x16x32_bf16 v[202:205], a[144:147], a[228:231], 0
    buffer_load_dwordx4 a[200:203], v6, s[8:11], s44 offen sc1
    v_mov_b32 v140, v180
    v_mov_b32 v141, v181
    v_mfma_f32_16x16x32_bf16 v[202:205], a[164:167], a[244:247], v[202:205]
    v_mov_b32 v142, v182
    v_mov_b32 v143, v183
    v_mov_b32 v144, v184
    v_mfma_f32_16x16x32_bf16 v[206:209], a[148:151], a[248:251], 0
    v_mov_b32 v145, v185
    s_waitcnt lgkmcnt(4)
    v_add_f32 v126, v126, v146
    v_mfma_f32_16x16x32_bf16 v[206:209], a[128:131], a[232:235], v[206:209]
    v_add_f32 v127, v127, v147
    v_add_f32 v128, v128, v148
    v_add_f32 v129, v129, v149
    v_mfma_f32_16x16x32_bf16 v[210:213], a[132:135], a[232:235], 0
    buffer_load_dwordx4 a[204:207], v7, s[8:11], s44 offen sc1
    ds_read_b128 v[146:149], v14 offset:5120
    s_waitcnt lgkmcnt(4)
    v_mfma_f32_16x16x32_bf16 v[210:213], a[152:155], a[248:251], v[210:213]
    v_add_f32 v130, v130, v150
    v_add_f32 v131, v131, v151
    v_add_f32 v132, v132, v152
    v_mfma_f32_16x16x32_bf16 v[214:217], a[156:159], a[248:251], 0
    v_add_f32 v133, v133, v153
    ds_read_b128 v[150:153], v14 offset:6144
    s_waitcnt lgkmcnt(4)
    v_mfma_f32_16x16x32_bf16 v[214:217], a[136:139], a[232:235], v[214:217]
    v_add_f32 v134, v134, v154
    v_add_f32 v135, v135, v155
    v_add_f32 v136, v136, v156
    v_mfma_f32_16x16x32_bf16 v[218:221], a[140:143], a[232:235], 0
    s_add_u32 s44, s31, 81920
    buffer_load_dwordx4 a[208:211], v4, s[8:11], s44 offen sc1
    v_add_f32 v137, v137, v157
    ds_read_b128 v[154:157], v14 offset:7168
    v_mfma_f32_16x16x32_bf16 v[218:221], a[160:163], a[248:251], v[218:221]
    s_waitcnt lgkmcnt(4)
    v_add_f32 v138, v138, v158
    v_add_f32 v139, v139, v159
    v_mfma_f32_16x16x32_bf16 v[222:225], a[164:167], a[248:251], 0
    v_add_f32 v140, v140, v160
    v_add_f32 v141, v141, v161
    ds_read_b128 v[158:161], v14 offset:8192
    v_mfma_f32_16x16x32_bf16 v[222:225], a[144:147], a[232:235], v[222:225]
    buffer_load_dwordx4 a[212:215], v5, s[8:11], s44 offen sc1
    s_waitcnt lgkmcnt(4)
    v_add_f32 v142, v142, v162
    v_add_f32 v143, v143, v163
    v_mfma_f32_16x16x32_bf16 v[226:229], a[128:131], a[236:239], 0
    v_add_f32 v144, v144, v164
    v_add_f32 v145, v145, v165
    v_mfma_f32_16x16x32_bf16 v[226:229], a[148:151], a[252:255], v[226:229]
    ds_read_b128 v[162:165], v14 offset:9216
    s_waitcnt lgkmcnt(4)
    v_add_f32 v126, v126, v146
    v_mfma_f32_16x16x32_bf16 v[230:233], a[152:155], a[252:255], 0
    v_add_f32 v127, v127, v147
    v_add_f32 v128, v128, v148
    v_add_f32 v129, v129, v149
    v_mfma_f32_16x16x32_bf16 v[230:233], a[132:135], a[236:239], v[230:233]
    buffer_load_dwordx4 a[216:219], v6, s[8:11], s44 offen sc1
    ds_read_b128 v[146:149], v15 offset:10240
    s_waitcnt lgkmcnt(4)
    v_add_f32 v130, v130, v150
    v_mfma_f32_16x16x32_bf16 v[234:237], a[136:139], a[236:239], 0
    v_add_f32 v131, v131, v151
    v_add_f32 v132, v132, v152
    v_mfma_f32_16x16x32_bf16 v[234:237], a[156:159], a[252:255], v[234:237]
    v_add_f32 v133, v133, v153
    ds_read_b128 v[150:153], v15 offset:11264
    s_waitcnt lgkmcnt(4)
    v_mfma_f32_16x16x32_bf16 v[238:241], a[160:163], a[252:255], 0
    v_add_f32 v134, v134, v154
    v_add_f32 v135, v135, v155
    v_add_f32 v136, v136, v156
    v_mfma_f32_16x16x32_bf16 v[238:241], a[140:143], a[236:239], v[238:241]
    buffer_load_dwordx4 a[220:223], v7, s[8:11], s44 offen sc1
    v_add_f32 v137, v137, v157
    ds_read_b128 v[154:157], v15 offset:12288
    s_waitcnt lgkmcnt(4)
    v_mfma_f32_16x16x32_bf16 v[242:245], a[144:147], a[236:239], 0
    v_add_f32 v138, v138, v158
    v_add_f32 v139, v139, v159
    v_mfma_f32_16x16x32_bf16 v[242:245], a[164:167], a[252:255], v[242:245]
    v_add_f32 v140, v140, v160
    v_add_f32 v141, v141, v161
    ds_read_b128 v[158:161], v15 offset:13312
    v_mfma_f32_16x16x32_bf16 v[166:169], a[148:151], a[240:243], 0
    s_waitcnt lgkmcnt(4)
    v_add_f32 v142, v142, v162
    v_add_f32 v143, v143, v163
    v_mfma_f32_16x16x32_bf16 v[166:169], a[128:131], a[224:227], v[166:169]
    v_add_f32 v144, v144, v164
    v_add_f32 v145, v145, v165
    ds_read_b128 v[162:165], v15 offset:14336
    v_mfma_f32_16x16x32_bf16 v[170:173], a[132:135], a[224:227], 0
    s_waitcnt lgkmcnt(4)
    v_add_f32 v126, v126, v146
    v_mfma_f32_16x16x32_bf16 v[170:173], a[152:155], a[240:243], v[170:173]
    v_add_f32 v127, v127, v147
    v_add_f32 v128, v128, v148
    v_add_f32 v129, v129, v149
    v_mfma_f32_16x16x32_bf16 v[174:177], a[156:159], a[240:243], 0
    s_waitcnt lgkmcnt(3)
    v_add_f32 v130, v130, v150
    v_add_f32 v131, v131, v151
    v_mfma_f32_16x16x32_bf16 v[174:177], a[136:139], a[224:227], v[174:177]
    v_add_f32 v132, v132, v152
    v_add_f32 v133, v133, v153
    s_waitcnt lgkmcnt(2)
    v_mfma_f32_16x16x32_bf16 v[178:181], a[140:143], a[224:227], 0
    v_add_f32 v134, v134, v154
    v_add_f32 v135, v135, v155
    v_mfma_f32_16x16x32_bf16 v[178:181], a[160:163], a[240:243], v[178:181]
    v_add_f32 v136, v136, v156
    v_add_f32 v137, v137, v157
    s_waitcnt lgkmcnt(1)
    v_mfma_f32_16x16x32_bf16 v[182:185], a[164:167], a[240:243], 0
    v_add_f32 v138, v138, v158
    v_add_f32 v139, v139, v159
    v_add_f32 v140, v140, v160
    v_mfma_f32_16x16x32_bf16 v[182:185], a[144:147], a[224:227], v[182:185]
    v_add_f32 v141, v141, v161
    s_waitcnt lgkmcnt(0)
    v_add_f32 v142, v142, v162
    s_waitcnt vmcnt(8)
    v_mfma_f32_16x16x32_bf16 v[166:169], a[168:171], a[96:99], v[166:169]
    v_mfma_f32_16x16x32_bf16 v[166:169], a[188:191], a[112:115], v[166:169]
    s_add_u32 s44, s31, 196608
    buffer_load_dwordx4 a[224:227], v4, s[8:11], s44 offen sc1
    v_mfma_f32_16x16x32_bf16 v[186:189], a[188:191], a[116:119], v[186:189]
    buffer_load_dwordx4 a[228:231], v5, s[8:11], s44 offen sc1
    v_mfma_f32_16x16x32_bf16 v[186:189], a[168:171], a[100:103], v[186:189]
    buffer_load_dwordx4 a[232:235], v6, s[8:11], s44 offen sc1
    v_add_f32 v143, v143, v163
    v_mfma_f32_16x16x32_bf16 v[206:209], a[168:171], a[104:107], v[206:209]
    buffer_load_dwordx4 a[236:239], v7, s[8:11], s44 offen sc1
    v_mfma_f32_16x16x32_bf16 v[206:209], a[188:191], a[120:123], v[206:209]
    v_mfma_f32_16x16x32_bf16 v[226:229], a[188:191], a[124:127], v[226:229]
    s_add_u32 s44, s31, 212992
    buffer_load_dwordx4 a[240:243], v4, s[8:11], s44 offen sc1
    v_add_f32 v144, v144, v164
    v_mfma_f32_16x16x32_bf16 v[226:229], a[168:171], a[108:111], v[226:229]
    buffer_load_dwordx4 a[244:247], v5, s[8:11], s44 offen sc1
    v_mfma_f32_16x16x32_bf16 v[170:173], a[172:175], a[96:99], v[170:173]
    buffer_load_dwordx4 a[248:251], v6, s[8:11], s44 offen sc1
    v_mfma_f32_16x16x32_bf16 v[170:173], a[0:3], a[112:115], v[170:173]
    buffer_load_dwordx4 a[252:255], v7, s[8:11], s44 offen sc1
    v_add_f32 v145, v145, v165
    v_mfma_f32_16x16x32_bf16 v[190:193], a[0:3], a[116:119], v[190:193]
    v_mfma_f32_16x16x32_bf16 v[190:193], a[172:175], a[100:103], v[190:193]
    v_mfma_f32_16x16x32_bf16 v[210:213], a[172:175], a[104:107], v[210:213]
    buffer_store_dwordx4 v[126:129], v18, s[76:79], 0 offen offset:0 sc1
    v_mfma_f32_16x16x32_bf16 v[210:213], a[0:3], a[120:123], v[210:213]
    v_mfma_f32_16x16x32_bf16 v[230:233], a[0:3], a[124:127], v[230:233]
    v_mfma_f32_16x16x32_bf16 v[230:233], a[172:175], a[108:111], v[230:233]
    v_mfma_f32_16x16x32_bf16 v[174:177], a[176:179], a[96:99], v[174:177]
    v_mfma_f32_16x16x32_bf16 v[174:177], a[4:7], a[112:115], v[174:177]
    v_mfma_f32_16x16x32_bf16 v[194:197], a[4:7], a[116:119], v[194:197]
    buffer_store_dwordx4 v[130:133], v18, s[76:79], 0 offen offset:1024 sc1
    v_mfma_f32_16x16x32_bf16 v[194:197], a[176:179], a[100:103], v[194:197]
    v_mfma_f32_16x16x32_bf16 v[214:217], a[176:179], a[104:107], v[214:217]
    v_mfma_f32_16x16x32_bf16 v[214:217], a[4:7], a[120:123], v[214:217]
    v_mfma_f32_16x16x32_bf16 v[234:237], a[4:7], a[124:127], v[234:237]
    v_mfma_f32_16x16x32_bf16 v[234:237], a[176:179], a[108:111], v[234:237]
    v_mfma_f32_16x16x32_bf16 v[178:181], a[180:183], a[96:99], v[178:181]
    buffer_store_dwordx4 v[134:137], v18, s[76:79], 0 offen offset:2048 sc1
    v_mfma_f32_16x16x32_bf16 v[178:181], a[8:11], a[112:115], v[178:181]
    v_mfma_f32_16x16x32_bf16 v[198:201], a[8:11], a[116:119], v[198:201]
    v_mfma_f32_16x16x32_bf16 v[198:201], a[180:183], a[100:103], v[198:201]
    v_mfma_f32_16x16x32_bf16 v[218:221], a[180:183], a[104:107], v[218:221]
    v_mfma_f32_16x16x32_bf16 v[218:221], a[8:11], a[120:123], v[218:221]
    v_mfma_f32_16x16x32_bf16 v[238:241], a[8:11], a[124:127], v[238:241]
    buffer_store_dwordx4 v[138:141], v18, s[76:79], 0 offen offset:3072 sc1
    v_mfma_f32_16x16x32_bf16 v[238:241], a[180:183], a[108:111], v[238:241]
    v_mfma_f32_16x16x32_bf16 v[182:185], a[184:187], a[96:99], v[182:185]
    v_mfma_f32_16x16x32_bf16 v[182:185], a[12:15], a[112:115], v[182:185]
    v_mfma_f32_16x16x32_bf16 v[202:205], a[12:15], a[116:119], v[202:205]
    v_mfma_f32_16x16x32_bf16 v[202:205], a[184:187], a[100:103], v[202:205]
    v_mfma_f32_16x16x32_bf16 v[222:225], a[184:187], a[104:107], v[222:225]
    buffer_store_dwordx4 v[142:145], v18, s[76:79], s41 offen offset:0 sc1
    v_mfma_f32_16x16x32_bf16 v[222:225], a[12:15], a[120:123], v[222:225]
    v_mfma_f32_16x16x32_bf16 v[242:245], a[12:15], a[124:127], v[242:245]
    v_mfma_f32_16x16x32_bf16 v[242:245], a[184:187], a[108:111], v[242:245]
    s_waitcnt vmcnt(13)
    v_mfma_f32_16x16x32_bf16 v[166:169], a[16:19], a[192:195], v[166:169]
    v_mfma_f32_16x16x32_bf16 v[166:169], a[36:39], a[208:211], v[166:169]
    s_add_u32 s44, s31, 98304
    buffer_load_dwordx4 a[96:99], v4, s[8:11], s44 offen sc1
    v_mfma_f32_16x16x32_bf16 v[186:189], a[36:39], a[212:215], v[186:189]
    v_mfma_f32_16x16x32_bf16 v[186:189], a[16:19], a[196:199], v[186:189]
    v_mfma_f32_16x16x32_bf16 v[206:209], a[16:19], a[200:203], v[206:209]
    buffer_load_dwordx4 a[100:103], v5, s[8:11], s44 offen sc1
    v_mfma_f32_16x16x32_bf16 v[206:209], a[36:39], a[216:219], v[206:209]
    v_mfma_f32_16x16x32_bf16 v[226:229], a[36:39], a[220:223], v[226:229]
    v_mfma_f32_16x16x32_bf16 v[226:229], a[16:19], a[204:207], v[226:229]
    v_mfma_f32_16x16x32_bf16 v[170:173], a[20:23], a[192:195], v[170:173]
    buffer_load_dwordx4 a[104:107], v6, s[8:11], s44 offen sc1
    v_mfma_f32_16x16x32_bf16 v[170:173], a[40:43], a[208:211], v[170:173]
    v_mfma_f32_16x16x32_bf16 v[190:193], a[40:43], a[212:215], v[190:193]
    v_mfma_f32_16x16x32_bf16 v[190:193], a[20:23], a[196:199], v[190:193]
    v_mfma_f32_16x16x32_bf16 v[210:213], a[20:23], a[200:203], v[210:213]
    buffer_load_dwordx4 a[108:111], v7, s[8:11], s44 offen sc1
    v_mfma_f32_16x16x32_bf16 v[210:213], a[40:43], a[216:219], v[210:213]
    v_mfma_f32_16x16x32_bf16 v[230:233], a[40:43], a[220:223], v[230:233]
    v_mfma_f32_16x16x32_bf16 v[230:233], a[20:23], a[204:207], v[230:233]
    ds_read_b128 v[126:129], v8 offset:0
    v_mfma_f32_16x16x32_bf16 v[174:177], a[24:27], a[192:195], v[174:177]
    s_add_u32 s44, s31, 114688
    buffer_load_dwordx4 a[112:115], v4, s[8:11], s44 offen sc1
    v_mfma_f32_16x16x32_bf16 v[174:177], a[44:47], a[208:211], v[174:177]
    v_mfma_f32_16x16x32_bf16 v[194:197], a[44:47], a[212:215], v[194:197]
    ds_read_b128 v[130:133], v8 offset:1024
    v_mfma_f32_16x16x32_bf16 v[194:197], a[24:27], a[196:199], v[194:197]
    buffer_load_dwordx4 a[116:119], v5, s[8:11], s44 offen sc1
    v_mfma_f32_16x16x32_bf16 v[214:217], a[24:27], a[200:203], v[214:217]
    v_mfma_f32_16x16x32_bf16 v[214:217], a[44:47], a[216:219], v[214:217]
    ds_read_b128 v[134:137], v8 offset:2048
    v_mfma_f32_16x16x32_bf16 v[234:237], a[44:47], a[220:223], v[234:237]
    v_mfma_f32_16x16x32_bf16 v[234:237], a[24:27], a[204:207], v[234:237]
    buffer_load_dwordx4 a[120:123], v6, s[8:11], s44 offen sc1
    v_mfma_f32_16x16x32_bf16 v[178:181], a[28:31], a[192:195], v[178:181]
    ds_read_b128 v[138:141], v8 offset:3072
    v_mfma_f32_16x16x32_bf16 v[178:181], a[48:51], a[208:211], v[178:181]
    v_mfma_f32_16x16x32_bf16 v[198:201], a[48:51], a[212:215], v[198:201]
    ds_read_b128 v[142:145], v8 offset:4096
    v_mfma_f32_16x16x32_bf16 v[198:201], a[28:31], a[196:199], v[198:201]
    buffer_load_dwordx4 a[124:127], v7, s[8:11], s44 offen sc1
    v_mfma_f32_16x16x32_bf16 v[218:221], a[28:31], a[200:203], v[218:221]
    v_mfma_f32_16x16x32_bf16 v[218:221], a[48:51], a[216:219], v[218:221]
    ds_read_b128 v[146:149], v8 offset:5120
    v_mfma_f32_16x16x32_bf16 v[238:241], a[48:51], a[220:223], v[238:241]
    v_mfma_f32_16x16x32_bf16 v[238:241], a[28:31], a[204:207], v[238:241]
    ds_read_b128 v[150:153], v8 offset:6144
    v_mfma_f32_16x16x32_bf16 v[182:185], a[32:35], a[192:195], v[182:185]
    v_mfma_f32_16x16x32_bf16 v[182:185], a[52:55], a[208:211], v[182:185]
    ds_read_b128 v[154:157], v8 offset:7168
    v_mfma_f32_16x16x32_bf16 v[202:205], a[52:55], a[212:215], v[202:205]
    v_mfma_f32_16x16x32_bf16 v[202:205], a[32:35], a[196:199], v[202:205]
    ds_read_b128 v[158:161], v8 offset:8192
    v_mfma_f32_16x16x32_bf16 v[222:225], a[32:35], a[200:203], v[222:225]
    v_mfma_f32_16x16x32_bf16 v[222:225], a[52:55], a[216:219], v[222:225]
    ds_read_b128 v[162:165], v8 offset:9216
    v_mfma_f32_16x16x32_bf16 v[242:245], a[52:55], a[220:223], v[242:245]
    buffer_load_dwordx2 v[20:21], v11, s[76:79], 0 offen offset:0 sc1
    buffer_load_dwordx2 v[246:247], v11, s[76:79], 0 offen offset:32 sc1
    buffer_load_dwordx2 v[248:249], v11, s[76:79], 0 offen offset:64 sc1
    buffer_load_dwordx2 v[252:253], v11, s[76:79], 0 offen offset:96 sc1
    buffer_load_dwordx2 v[254:255], v11, s[76:79], 0 offen offset:128 sc1
    v_mfma_f32_16x16x32_bf16 v[242:245], a[32:35], a[204:207], v[242:245]
    s_waitcnt vmcnt(18) lgkmcnt(0)
    v_mfma_f32_16x16x32_bf16 v[166:169], v[126:129], a[224:227], v[166:169]
    s_waitcnt vmcnt(13)
    s_mov_b64 exec, 1
    buffer_store_dword v2, off, s[76:79], s36 sc1
    s_mov_b64 exec, -1
    v_mfma_f32_16x16x32_bf16 v[166:169], v[146:149], a[240:243], v[166:169]
    s_add_u32 s44, s31, 229376
    buffer_load_dwordx4 a[192:195], v4, s[8:11], s44 offen sc1
    v_mfma_f32_16x16x32_bf16 v[186:189], v[146:149], a[244:247], v[186:189]
    v_mfma_f32_16x16x32_bf16 v[186:189], v[126:129], a[228:231], v[186:189]
    v_mfma_f32_16x16x32_bf16 v[206:209], v[126:129], a[232:235], v[206:209]
    buffer_load_dwordx4 a[196:199], v5, s[8:11], s44 offen sc1
    v_mfma_f32_16x16x32_bf16 v[206:209], v[146:149], a[248:251], v[206:209]
    v_mfma_f32_16x16x32_bf16 v[226:229], v[146:149], a[252:255], v[226:229]
    v_mfma_f32_16x16x32_bf16 v[226:229], v[126:129], a[236:239], v[226:229]
    v_mfma_f32_16x16x32_bf16 v[170:173], v[130:133], a[224:227], v[170:173]
    buffer_load_dwordx4 a[200:203], v6, s[8:11], s44 offen sc1
    v_mfma_f32_16x16x32_bf16 v[170:173], v[150:153], a[240:243], v[170:173]
    v_mfma_f32_16x16x32_bf16 v[190:193], v[150:153], a[244:247], v[190:193]
    v_mfma_f32_16x16x32_bf16 v[190:193], v[130:133], a[228:231], v[190:193]
    v_mfma_f32_16x16x32_bf16 v[210:213], v[130:133], a[232:235], v[210:213]
    buffer_load_dwordx4 a[204:207], v7, s[8:11], s44 offen sc1
    v_mfma_f32_16x16x32_bf16 v[210:213], v[150:153], a[248:251], v[210:213]
    v_mfma_f32_16x16x32_bf16 v[230:233], v[150:153], a[252:255], v[230:233]
    v_mfma_f32_16x16x32_bf16 v[230:233], v[130:133], a[236:239], v[230:233]
    v_mfma_f32_16x16x32_bf16 v[174:177], v[134:137], a[224:227], v[174:177]
    s_add_u32 s44, s31, 245760
    buffer_load_dwordx4 a[208:211], v4, s[8:11], s44 offen sc1
    v_mfma_f32_16x16x32_bf16 v[174:177], v[154:157], a[240:243], v[174:177]
    v_mfma_f32_16x16x32_bf16 v[194:197], v[154:157], a[244:247], v[194:197]
    v_mfma_f32_16x16x32_bf16 v[194:197], v[134:137], a[228:231], v[194:197]
    buffer_load_dwordx4 a[212:215], v5, s[8:11], s44 offen sc1
    v_mfma_f32_16x16x32_bf16 v[214:217], v[134:137], a[232:235], v[214:217]
    v_mfma_f32_16x16x32_bf16 v[214:217], v[154:157], a[248:251], v[214:217]
    v_mfma_f32_16x16x32_bf16 v[234:237], v[154:157], a[252:255], v[234:237]
    v_mfma_f32_16x16x32_bf16 v[234:237], v[134:137], a[236:239], v[234:237]
    buffer_load_dwordx4 a[216:219], v6, s[8:11], s44 offen sc1
    v_mfma_f32_16x16x32_bf16 v[178:181], v[138:141], a[224:227], v[178:181]
    v_mfma_f32_16x16x32_bf16 v[178:181], v[158:161], a[240:243], v[178:181]
    v_mfma_f32_16x16x32_bf16 v[198:201], v[158:161], a[244:247], v[198:201]
    v_mfma_f32_16x16x32_bf16 v[198:201], v[138:141], a[228:231], v[198:201]
    buffer_load_dwordx4 a[220:223], v7, s[8:11], s44 offen sc1
    v_mfma_f32_16x16x32_bf16 v[218:221], v[138:141], a[232:235], v[218:221]
    v_mfma_f32_16x16x32_bf16 v[218:221], v[158:161], a[248:251], v[218:221]
    v_mfma_f32_16x16x32_bf16 v[238:241], v[158:161], a[252:255], v[238:241]
    v_mfma_f32_16x16x32_bf16 v[238:241], v[138:141], a[236:239], v[238:241]
    v_mfma_f32_16x16x32_bf16 v[182:185], v[142:145], a[224:227], v[182:185]
    v_mfma_f32_16x16x32_bf16 v[182:185], v[162:165], a[240:243], v[182:185]
    v_mfma_f32_16x16x32_bf16 v[202:205], v[162:165], a[244:247], v[202:205]
    v_mfma_f32_16x16x32_bf16 v[202:205], v[142:145], a[228:231], v[202:205]
    v_mfma_f32_16x16x32_bf16 v[222:225], v[142:145], a[232:235], v[222:225]
    v_mfma_f32_16x16x32_bf16 v[222:225], v[162:165], a[248:251], v[222:225]
    v_mfma_f32_16x16x32_bf16 v[242:245], v[162:165], a[252:255], v[242:245]
    v_mfma_f32_16x16x32_bf16 v[242:245], v[142:145], a[236:239], v[242:245]
    s_waitcnt vmcnt(14)
    v_mfma_f32_16x16x32_bf16 v[166:169], a[56:59], a[96:99], v[166:169]
    v_mfma_f32_16x16x32_bf16 v[166:169], a[76:79], a[112:115], v[166:169]
    s_add_u32 s44, s31, 131072
    buffer_load_dwordx4 a[224:227], v4, s[8:11], s44 offen sc1
    v_mfma_f32_16x16x32_bf16 v[186:189], a[76:79], a[116:119], v[186:189]
    ds_read_b128 v[126:129], v9 offset:0
    v_mfma_f32_16x16x32_bf16 v[186:189], a[56:59], a[100:103], v[186:189]
    v_mfma_f32_16x16x32_bf16 v[206:209], a[56:59], a[104:107], v[206:209]
    buffer_load_dwordx4 a[228:231], v5, s[8:11], s44 offen sc1
    v_mfma_f32_16x16x32_bf16 v[206:209], a[76:79], a[120:123], v[206:209]
    ds_read_b128 v[130:133], v9 offset:1024
    v_mfma_f32_16x16x32_bf16 v[226:229], a[76:79], a[124:127], v[226:229]
    v_mfma_f32_16x16x32_bf16 v[226:229], a[56:59], a[108:111], v[226:229]
    ds_read_b128 v[134:137], v9 offset:2048
    v_mfma_f32_16x16x32_bf16 v[170:173], a[60:63], a[96:99], v[170:173]
    buffer_load_dwordx4 a[232:235], v6, s[8:11], s44 offen sc1
    v_mfma_f32_16x16x32_bf16 v[170:173], a[80:83], a[112:115], v[170:173]
    v_mfma_f32_16x16x32_bf16 v[190:193], a[80:83], a[116:119], v[190:193]
    ds_read_b128 v[138:141], v9 offset:3072
    v_mfma_f32_16x16x32_bf16 v[190:193], a[60:63], a[100:103], v[190:193]
    v_mfma_f32_16x16x32_bf16 v[210:213], a[60:63], a[104:107], v[210:213]
    buffer_load_dwordx4 a[236:239], v7, s[8:11], s44 offen sc1
    v_mfma_f32_16x16x32_bf16 v[210:213], a[80:83], a[120:123], v[210:213]
    ds_read_b128 v[142:145], v9 offset:4096
    v_mfma_f32_16x16x32_bf16 v[230:233], a[80:83], a[124:127], v[230:233]
    v_mfma_f32_16x16x32_bf16 v[230:233], a[60:63], a[108:111], v[230:233]
    ds_read_b128 v[146:149], v9 offset:5120
    v_mfma_f32_16x16x32_bf16 v[174:177], a[64:67], a[96:99], v[174:177]
    s_add_u32 s44, s31, 147456
    buffer_load_dwordx4 a[240:243], v4, s[8:11], s44 offen sc1
    v_mfma_f32_16x16x32_bf16 v[174:177], a[84:87], a[112:115], v[174:177]
    v_mfma_f32_16x16x32_bf16 v[194:197], a[84:87], a[116:119], v[194:197]
    ds_read_b128 v[150:153], v9 offset:6144
    v_mfma_f32_16x16x32_bf16 v[194:197], a[64:67], a[100:103], v[194:197]
    buffer_load_dwordx4 a[244:247], v5, s[8:11], s44 offen sc1
    v_mfma_f32_16x16x32_bf16 v[214:217], a[64:67], a[104:107], v[214:217]
    v_mfma_f32_16x16x32_bf16 v[214:217], a[84:87], a[120:123], v[214:217]
    ds_read_b128 v[154:157], v9 offset:7168
    v_mfma_f32_16x16x32_bf16 v[234:237], a[84:87], a[124:127], v[234:237]
    v_mfma_f32_16x16x32_bf16 v[234:237], a[64:67], a[108:111], v[234:237]
    buffer_load_dwordx4 a[248:251], v6, s[8:11], s44 offen sc1
    v_mfma_f32_16x16x32_bf16 v[178:181], a[68:71], a[96:99], v[178:181]
    ds_read_b128 v[158:161], v9 offset:8192
    v_mfma_f32_16x16x32_bf16 v[178:181], a[88:91], a[112:115], v[178:181]
    v_mfma_f32_16x16x32_bf16 v[198:201], a[88:91], a[116:119], v[198:201]
    ds_read_b128 v[162:165], v9 offset:9216
    v_mfma_f32_16x16x32_bf16 v[198:201], a[68:71], a[100:103], v[198:201]
    buffer_load_dwordx4 a[252:255], v7, s[8:11], s44 offen sc1
    v_mfma_f32_16x16x32_bf16 v[218:221], a[68:71], a[104:107], v[218:221]
    v_mfma_f32_16x16x32_bf16 v[218:221], a[88:91], a[120:123], v[218:221]
    v_mfma_f32_16x16x32_bf16 v[238:241], a[88:91], a[124:127], v[238:241]
    v_mfma_f32_16x16x32_bf16 v[238:241], a[68:71], a[108:111], v[238:241]
    v_mfma_f32_16x16x32_bf16 v[182:185], a[72:75], a[96:99], v[182:185]
    v_mfma_f32_16x16x32_bf16 v[182:185], a[92:95], a[112:115], v[182:185]
    v_mfma_f32_16x16x32_bf16 v[202:205], a[92:95], a[116:119], v[202:205]
    v_mfma_f32_16x16x32_bf16 v[202:205], a[72:75], a[100:103], v[202:205]
    v_mfma_f32_16x16x32_bf16 v[222:225], a[72:75], a[104:107], v[222:225]
    v_mfma_f32_16x16x32_bf16 v[222:225], a[92:95], a[120:123], v[222:225]
    v_mfma_f32_16x16x32_bf16 v[242:245], a[92:95], a[124:127], v[242:245]
    v_mfma_f32_16x16x32_bf16 v[242:245], a[72:75], a[108:111], v[242:245]
    s_waitcnt vmcnt(8) lgkmcnt(0)
    v_mfma_f32_16x16x32_bf16 v[166:169], v[126:129], a[192:195], v[166:169]
    v_max3_u32 v1, v20, v21, v246
    v_max3_u32 v1, v1, v247, v248
    v_max3_u32 v1, v1, v249, v252
    v_max3_u32 v1, v1, v253, v254
    v_max_u32 v1, v1, v255
    v_cmp_eq_u32 vcc, -1, v1
    s_and_b64 vcc, vcc, exec
    s_cbranch_scc1 L_spin_upd
L_back_upd:
    v_mfma_f32_16x16x32_bf16 v[166:169], v[146:149], a[208:211], v[166:169]
    s_add_u32 s44, s31, 163840
    buffer_load_dwordx4 a[96:99], v4, s[8:11], s44 offen sc1
    v_mfma_f32_16x16x32_bf16 v[186:189], v[146:149], a[212:215], v[186:189]
    v_mfma_f32_16x16x32_bf16 v[186:189], v[126:129], a[196:199], v[186:189]
    v_mfma_f32_16x16x32_bf16 v[206:209], v[126:129], a[200:203], v[206:209]
    buffer_load_dwordx4 a[100:103], v5, s[8:11], s44 offen sc1
    v_mfma_f32_16x16x32_bf16 v[206:209], v[146:149], a[216:219], v[206:209]
    v_mfma_f32_16x16x32_bf16 v[226:229], v[146:149], a[220:223], v[226:229]
    v_mfma_f32_16x16x32_bf16 v[226:229], v[126:129], a[204:207], v[226:229]
    v_mfma_f32_16x16x32_bf16 v[170:173], v[130:133], a[192:195], v[170:173]
    buffer_load_dwordx4 a[104:107], v6, s[8:11], s44 offen sc1
    v_mfma_f32_16x16x32_bf16 v[170:173], v[150:153], a[208:211], v[170:173]
    v_mfma_f32_16x16x32_bf16 v[190:193], v[150:153], a[212:215], v[190:193]
    v_mfma_f32_16x16x32_bf16 v[190:193], v[130:133], a[196:199], v[190:193]
    v_mfma_f32_16x16x32_bf16 v[210:213], v[130:133], a[200:203], v[210:213]
    buffer_load_dwordx4 a[108:111], v7, s[8:11], s44 offen sc1
    v_mfma_f32_16x16x32_bf16 v[210:213], v[150:153], a[216:219], v[210:213]
    v_mfma_f32_16x16x32_bf16 v[230:233], v[150:153], a[220:223], v[230:233]
    v_mfma_f32_16x16x32_bf16 v[230:233], v[130:133], a[204:207], v[230:233]
    v_mfma_f32_16x16x32_bf16 v[174:177], v[134:137], a[192:195], v[174:177]
    s_add_u32 s44, s31, 180224
    buffer_load_dwordx4 a[112:115], v4, s[8:11], s44 offen sc1
    v_mfma_f32_16x16x32_bf16 v[174:177], v[154:157], a[208:211], v[174:177]
    v_mfma_f32_16x16x32_bf16 v[194:197], v[154:157], a[212:215], v[194:197]
    v_mfma_f32_16x16x32_bf16 v[194:197], v[134:137], a[196:199], v[194:197]
    buffer_load_dwordx4 a[116:119], v5, s[8:11], s44 offen sc1
    v_mfma_f32_16x16x32_bf16 v[214:217], v[134:137], a[200:203], v[214:217]
    v_mfma_f32_16x16x32_bf16 v[214:217], v[154:157], a[216:219], v[214:217]
    v_mfma_f32_16x16x32_bf16 v[234:237], v[154:157], a[220:223], v[234:237]
    v_mfma_f32_16x16x32_bf16 v[234:237], v[134:137], a[204:207], v[234:237]
    buffer_load_dwordx4 a[120:123], v6, s[8:11], s44 offen sc1
    v_mfma_f32_16x16x32_bf16 v[178:181], v[138:141], a[192:195], v[178:181]
    v_mfma_f32_16x16x32_bf16 v[178:181], v[158:161], a[208:211], v[178:181]
    v_mfma_f32_16x16x32_bf16 v[198:201], v[158:161], a[212:215], v[198:201]
    v_mfma_f32_16x16x32_bf16 v[198:201], v[138:141], a[196:199], v[198:201]
    buffer_load_dwordx4 a[124:127], v7, s[8:11], s44 offen sc1
    v_mfma_f32_16x16x32_bf16 v[218:221], v[138:141], a[200:203], v[218:221]
    v_mfma_f32_16x16x32_bf16 v[218:221], v[158:161], a[216:219], v[218:221]
    v_mfma_f32_16x16x32_bf16 v[238:241], v[158:161], a[220:223], v[238:241]
    v_mfma_f32_16x16x32_bf16 v[238:241], v[138:141], a[204:207], v[238:241]
    v_mfma_f32_16x16x32_bf16 v[182:185], v[142:145], a[192:195], v[182:185]
    v_mfma_f32_16x16x32_bf16 v[182:185], v[162:165], a[208:211], v[182:185]
    v_mfma_f32_16x16x32_bf16 v[202:205], v[162:165], a[212:215], v[202:205]
    v_mfma_f32_16x16x32_bf16 v[202:205], v[142:145], a[196:199], v[202:205]
    v_mfma_f32_16x16x32_bf16 v[222:225], v[142:145], a[200:203], v[222:225]
    v_mfma_f32_16x16x32_bf16 v[222:225], v[162:165], a[216:219], v[222:225]
    v_mfma_f32_16x16x32_bf16 v[242:245], v[162:165], a[220:223], v[242:245]
    s_sub_u32 s40, s5, 1
    s_and_b32 s40, s40, 3
    s_mul_i32 s40, s40, 10240
    s_add_u32 s40, s40, 122880
    v_lshl_add_u32 v5, v19, 4, s40
    s_sub_u32 s40, s5, 2
    s_and_b32 s40, s40, 3
    s_mul_i32 s40, s40, 10240
    s_add_u32 s40, s40, 122880
    v_lshl_add_u32 v6, v19, 4, s40
    s_sub_u32 s40, s5, 3
    s_and_b32 s40, s40, 3
    s_mul_i32 s40, s40, 10240
    s_add_u32 s40, s40, 81920
    v_lshl_add_u32 v7, v19, 4, s40
    buffer_load_dword v1, off, s[76:79], s37 sc1
    v_mfma_f32_16x16x32_bf16 v[242:245], v[142:145], a[204:207], v[242:245]
    s_waitcnt vmcnt(9)
    v_mfma_f32_16x16x32_bf16 v[166:169], v[46:49], a[224:227], v[166:169]
    v_mfma_f32_16x16x32_bf16 v[166:169], v[66:69], a[240:243], v[166:169]
    v_lshlrev_b32 v126, 16, v36
    v_and_b32 v127, 0xffff0000, v36
    v_lshlrev_b32 v146, 16, v20
    v_and_b32 v147, 0xffff0000, v20
    v_mfma_f32_16x16x32_bf16 v[186:189], v[66:69], a[244:247], v[186:189]
    v_lshlrev_b32 v128, 16, v37
    v_and_b32 v129, 0xffff0000, v37
    v_lshlrev_b32 v148, 16, v21
    v_and_b32 v149, 0xffff0000, v21
    v_lshlrev_b32 v130, 16, v38
    v_mfma_f32_16x16x32_bf16 v[186:189], v[46:49], a[228:231], v[186:189]
    v_and_b32 v131, 0xffff0000, v38
    v_lshlrev_b32 v150, 16, v246
    v_and_b32 v151, 0xffff0000, v246
    v_lshlrev_b32 v132, 16, v39
    v_mfma_f32_16x16x32_bf16 v[206:209], v[46:49], a[232:235], v[206:209]
    v_and_b32 v133, 0xffff0000, v39
    v_lshlrev_b32 v152, 16, v247
    v_and_b32 v153, 0xffff0000, v247
    v_lshlrev_b32 v134, 16, v40
    v_and_b32 v135, 0xffff0000, v40
    v_mfma_f32_16x16x32_bf16 v[206:209], v[66:69], a[248:251], v[206:209]
    v_lshlrev_b32 v154, 16, v248
    v_and_b32 v155, 0xffff0000, v248
    v_lshlrev_b32 v136, 16, v41
    v_and_b32 v137, 0xffff0000, v41
    v_lshlrev_b32 v156, 16, v249
    v_mfma_f32_16x16x32_bf16 v[226:229], v[66:69], a[252:255], v[226:229]
    v_and_b32 v157, 0xffff0000, v249
    v_lshlrev_b32 v138, 16, v42
    v_and_b32 v139, 0xffff0000, v42
    v_lshlrev_b32 v158, 16, v252
    v_mfma_f32_16x16x32_bf16 v[226:229], v[46:49], a[236:239], v[226:229]
    v_and_b32 v159, 0xffff0000, v252
    v_lshlrev_b32 v140, 16, v43
    v_and_b32 v141, 0xffff0000, v43
    v_lshlrev_b32 v160, 16, v253
    v_and_b32 v161, 0xffff0000, v253
    v_mfma_f32_16x16x32_bf16 v[170:173], v[50:53], a[224:227], v[170:173]
    v_lshlrev_b32 v142, 16, v44
    v_and_b32 v143, 0xffff0000, v44
    v_lshlrev_b32 v162, 16, v254
    v_and_b32 v163, 0xffff0000, v254
    v_mfma_f32_16x16x32_bf16 v[170:173], v[70:73], a[240:243], v[170:173]
    v_lshlrev_b32 v144, 16, v45
    v_and_b32 v145, 0xffff0000, v45
    v_lshlrev_b32 v164, 16, v255
    v_and_b32 v165, 0xffff0000, v255
    v_add_f32 v126, v126, v146
    v_mfma_f32_16x16x32_bf16 v[190:193], v[70:73], a[244:247], v[190:193]
    v_add_f32 v127, v127, v147
    v_add_f32 v128, v128, v148
    v_add_f32 v129, v129, v149
    v_add_f32 v130, v130, v150
    v_add_f32 v131, v131, v151
    v_mfma_f32_16x16x32_bf16 v[190:193], v[50:53], a[228:231], v[190:193]
    v_add_f32 v132, v132, v152
    v_add_f32 v133, v133, v153
    v_add_f32 v134, v134, v154
    v_add_f32 v135, v135, v155
    v_mfma_f32_16x16x32_bf16 v[210:213], v[50:53], a[232:235], v[210:213]
    v_add_f32 v136, v136, v156
    v_add_f32 v137, v137, v157
    v_add_f32 v138, v138, v158
    v_add_f32 v139, v139, v159
    v_add_f32 v140, v140, v160
    v_mfma_f32_16x16x32_bf16 v[210:213], v[70:73], a[248:251], v[210:213]
    v_add_f32 v141, v141, v161
    v_add_f32 v142, v142, v162
    v_add_f32 v143, v143, v163
    v_add_f32 v144, v144, v164
    v_add_f32 v145, v145, v165
    v_mfma_f32_16x16x32_bf16 v[230:233], v[70:73], a[252:255], v[230:233]
    v_cvt_pk_bf16_f32 v146, v126, v127
    v_cvt_pk_bf16_f32 v147, v128, v129
    v_cvt_pk_bf16_f32 v148, v130, v131
    v_cvt_pk_bf16_f32 v149, v132, v133
    v_mfma_f32_16x16x32_bf16 v[230:233], v[50:53], a[236:239], v[230:233]
    v_cvt_pk_bf16_f32 v150, v134, v135
    v_cvt_pk_bf16_f32 v151, v136, v137
    v_cvt_pk_bf16_f32 v152, v138, v139
    v_cvt_pk_bf16_f32 v153, v140, v141
    v_cvt_pk_bf16_f32 v154, v142, v143
    v_mfma_f32_16x16x32_bf16 v[174:177], v[54:57], a[224:227], v[174:177]
    v_cvt_pk_bf16_f32 v155, v144, v145
    v_lshlrev_b32 v126, 16, v146
    v_and_b32 v127, 0xffff0000, v146
    v_lshlrev_b32 v128, 16, v147
    v_mfma_f32_16x16x32_bf16 v[174:177], v[74:77], a[240:243], v[174:177]
    v_and_b32 v129, 0xffff0000, v147
    v_lshlrev_b32 v130, 16, v148
    v_and_b32 v131, 0xffff0000, v148
    v_lshlrev_b32 v132, 16, v149
    v_and_b32 v133, 0xffff0000, v149
    v_mfma_f32_16x16x32_bf16 v[194:197], v[74:77], a[244:247], v[194:197]
    v_lshlrev_b32 v134, 16, v150
    v_and_b32 v135, 0xffff0000, v150
    v_lshlrev_b32 v136, 16, v151
    v_and_b32 v137, 0xffff0000, v151
    v_lshlrev_b32 v138, 16, v152
    v_mfma_f32_16x16x32_bf16 v[194:197], v[54:57], a[228:231], v[194:197]
    v_and_b32 v139, 0xffff0000, v152
    v_lshlrev_b32 v140, 16, v153
    v_and_b32 v141, 0xffff0000, v153
    v_lshlrev_b32 v142, 16, v154
    v_mfma_f32_16x16x32_bf16 v[214:217], v[54:57], a[232:235], v[214:217]
    v_and_b32 v143, 0xffff0000, v154
    v_lshlrev_b32 v144, 16, v155
    v_and_b32 v145, 0xffff0000, v155
    v_mul_f32 v146, 0xbfb8aa3b, v126
    v_mul_f32 v147, 0xbfb8aa3b, v127
    v_mfma_f32_16x16x32_bf16 v[214:217], v[74:77], a[248:251], v[214:217]
    v_mul_f32 v148, 0xbfb8aa3b, v128
    v_mul_f32 v149, 0xbfb8aa3b, v129
    v_mul_f32 v150, 0xbfb8aa3b, v130
    v_mul_f32 v151, 0xbfb8aa3b, v131
    v_mfma_f32_16x16x32_bf16 v[234:237], v[74:77], a[252:255], v[234:237]
    v_mul_f32 v152, 0xbfb8aa3b, v132
    v_mul_f32 v153, 0xbfb8aa3b, v133
    v_mul_f32 v154, 0xbfb8aa3b, v134
    v_mul_f32 v155, 0xbfb8aa3b, v135
    v_mul_f32 v156, 0xbfb8aa3b, v136
    v_mfma_f32_16x16x32_bf16 v[234:237], v[54:57], a[236:239], v[234:237]
    v_mul_f32 v157, 0xbfb8aa3b, v137
    v_mul_f32 v158, 0xbfb8aa3b, v138
    v_mul_f32 v159, 0xbfb8aa3b, v139
    v_mul_f32 v160, 0xbfb8aa3b, v140
    v_mul_f32 v161, 0xbfb8aa3b, v141
    v_mfma_f32_16x16x32_bf16 v[178:181], v[58:61], a[224:227], v[178:181]
    v_mul_f32 v162, 0xbfb8aa3b, v142
    v_mul_f32 v163, 0xbfb8aa3b, v143
    v_mul_f32 v164, 0xbfb8aa3b, v144
    v_mul_f32 v165, 0xbfb8aa3b, v145
    v_mfma_f32_16x16x32_bf16 v[178:181], v[78:81], a[240:243], v[178:181]
    v_exp_f32 v146, v146
    v_exp_f32 v147, v147
    v_exp_f32 v148, v148
    v_exp_f32 v149, v149
    v_exp_f32 v150, v150
    v_mfma_f32_16x16x32_bf16 v[198:201], v[78:81], a[244:247], v[198:201]
    v_exp_f32 v151, v151
    v_exp_f32 v152, v152
    v_exp_f32 v153, v153
    v_exp_f32 v154, v154
    v_exp_f32 v155, v155
    v_mfma_f32_16x16x32_bf16 v[198:201], v[58:61], a[228:231], v[198:201]
    v_exp_f32 v156, v156
    v_exp_f32 v157, v157
    v_exp_f32 v158, v158
    v_exp_f32 v159, v159
    v_mfma_f32_16x16x32_bf16 v[218:221], v[58:61], a[232:235], v[218:221]
    v_exp_f32 v160, v160
    v_exp_f32 v161, v161
    v_exp_f32 v162, v162
    v_exp_f32 v163, v163
    v_exp_f32 v164, v164
    v_mfma_f32_16x16x32_bf16 v[218:221], v[78:81], a[248:251], v[218:221]
    v_exp_f32 v165, v165
    v_add_f32 v146, 1.0, v146
    v_add_f32 v147, 1.0, v147
    v_add_f32 v148, 1.0, v148
    v_mfma_f32_16x16x32_bf16 v[238:241], v[78:81], a[252:255], v[238:241]
    v_add_f32 v149, 1.0, v149
    v_add_f32 v150, 1.0, v150
    v_add_f32 v151, 1.0, v151
    v_add_f32 v152, 1.0, v152
    v_add_f32 v153, 1.0, v153
    v_mfma_f32_16x16x32_bf16 v[238:241], v[58:61], a[236:239], v[238:241]
    v_add_f32 v154, 1.0, v154
    v_add_f32 v155, 1.0, v155
    v_add_f32 v156, 1.0, v156
    v_add_f32 v157, 1.0, v157
    v_add_f32 v158, 1.0, v158
    v_mfma_f32_16x16x32_bf16 v[182:185], v[62:65], a[224:227], v[182:185]
    v_add_f32 v159, 1.0, v159
    v_add_f32 v160, 1.0, v160
    v_add_f32 v161, 1.0, v161
    v_add_f32 v162, 1.0, v162
    v_mfma_f32_16x16x32_bf16 v[182:185], v[82:85], a[240:243], v[182:185]
    v_add_f32 v163, 1.0, v163
    v_add_f32 v164, 1.0, v164
    v_add_f32 v165, 1.0, v165
    v_rcp_f32 v146, v146
    v_rcp_f32 v147, v147
    v_mfma_f32_16x16x32_bf16 v[202:205], v[82:85], a[244:247], v[202:205]
    v_rcp_f32 v148, v148
    v_rcp_f32 v149, v149
    v_rcp_f32 v150, v150
    v_rcp_f32 v151, v151
    v_mfma_f32_16x16x32_bf16 v[202:205], v[62:65], a[228:231], v[202:205]
    v_rcp_f32 v152, v152
    v_rcp_f32 v153, v153
    v_rcp_f32 v154, v154
    v_rcp_f32 v155, v155
    v_rcp_f32 v156, v156
    v_mfma_f32_16x16x32_bf16 v[222:225], v[62:65], a[232:235], v[222:225]
    v_rcp_f32 v157, v157
    v_rcp_f32 v158, v158
    v_rcp_f32 v159, v159
    v_rcp_f32 v160, v160
    v_rcp_f32 v161, v161
    v_mfma_f32_16x16x32_bf16 v[222:225], v[82:85], a[248:251], v[222:225]
    v_rcp_f32 v162, v162
    v_rcp_f32 v163, v163
    v_rcp_f32 v164, v164
    v_rcp_f32 v165, v165
    v_mfma_f32_16x16x32_bf16 v[242:245], v[82:85], a[252:255], v[242:245]
    v_mul_f32 v126, v126, v146
    v_mul_f32 v127, v127, v147
    v_mul_f32 v128, v128, v148
    v_mul_f32 v129, v129, v149
    v_mul_f32 v130, v130, v150
    v_mfma_f32_16x16x32_bf16 v[242:245], v[62:65], a[236:239], v[242:245]
    v_mul_f32 v131, v131, v151
    v_mul_f32 v132, v132, v152
    v_mul_f32 v133, v133, v153
    v_mul_f32 v134, v134, v154
    v_mul_f32 v135, v135, v155
    s_waitcnt vmcnt(1)
    v_mfma_f32_16x16x32_bf16 v[186:189], v[86:89], a[100:103], v[186:189]
    s_waitcnt vmcnt(0)
    v_cmp_ne_u32 vcc, 3, v1
    s_and_b64 vcc, vcc, exec
    s_cbranch_scc1 L_spin_half
L_back_half:
    s_xor_b32 s40, s2, 8
    s_sub_u32 s40, s40, s2
    s_mul_i32 s40, s40, 20480
    v_add_u32 v18, s40, v18
    s_mov_b32 s41, 4096
    buffer_load_dwordx4 v[46:49], v18, s[76:79], 0 offen offset:0 sc1
    buffer_load_dwordx4 v[50:53], v18, s[76:79], 0 offen offset:1024 sc1
    buffer_load_dwordx4 v[54:57], v18, s[76:79], 0 offen offset:2048 sc1
    buffer_load_dwordx4 v[58:61], v18, s[76:79], 0 offen offset:3072 sc1
    buffer_load_dwordx4 v[62:65], v18, s[76:79], s41 offen offset:0 sc1
    v_mfma_f32_16x16x32_bf16 v[186:189], v[106:109], a[116:119], v[186:189]
    v_mul_f32 v136, v136, v156
    v_mfma_f32_16x16x32_bf16 v[190:193], v[110:113], a[116:119], v[190:193]
    v_mul_f32 v137, v137, v157
    v_mul_f32 v138, v138, v158
    v_mfma_f32_16x16x32_bf16 v[190:193], v[90:93], a[100:103], v[190:193]
    v_mul_f32 v139, v139, v159
    v_mfma_f32_16x16x32_bf16 v[194:197], v[94:97], a[100:103], v[194:197]
    v_mul_f32 v140, v140, v160
    v_mul_f32 v141, v141, v161
    v_mfma_f32_16x16x32_bf16 v[194:197], v[114:117], a[116:119], v[194:197]
    v_mul_f32 v142, v142, v162
    v_mfma_f32_16x16x32_bf16 v[198:201], v[118:121], a[116:119], v[198:201]
    v_mul_f32 v143, v143, v163
    v_mul_f32 v144, v144, v164
    v_mfma_f32_16x16x32_bf16 v[198:201], v[98:101], a[100:103], v[198:201]
    v_mul_f32 v145, v145, v165
    v_mfma_f32_16x16x32_bf16 v[202:205], v[102:105], a[100:103], v[202:205]
    v_cvt_pk_bf16_f32 v146, v126, v127
    v_cvt_pk_bf16_f32 v147, v128, v129
    v_mfma_f32_16x16x32_bf16 v[202:205], v[122:125], a[116:119], v[202:205]
    ds_write_b128 v8, v[186:189] offset:0
    v_cvt_pk_bf16_f32 v148, v130, v131
    v_mfma_f32_16x16x32_bf16 v[206:209], v[106:109], a[120:123], v[206:209]
    v_cvt_pk_bf16_f32 v149, v132, v133
    v_cvt_pk_bf16_f32 v150, v134, v135
    v_mfma_f32_16x16x32_bf16 v[206:209], v[86:89], a[104:107], v[206:209]
    ds_write_b128 v8, v[190:193] offset:1024
    v_cvt_pk_bf16_f32 v151, v136, v137
    v_mfma_f32_16x16x32_bf16 v[210:213], v[90:93], a[104:107], v[210:213]
    v_cvt_pk_bf16_f32 v152, v138, v139
    v_cvt_pk_bf16_f32 v153, v140, v141
    v_mfma_f32_16x16x32_bf16 v[210:213], v[110:113], a[120:123], v[210:213]
    ds_write_b128 v8, v[194:197] offset:2048
    v_cvt_pk_bf16_f32 v154, v142, v143
    v_cvt_pk_bf16_f32 v155, v144, v145
    v_mfma_f32_16x16x32_bf16 v[214:217], v[114:117], a[120:123], v[214:217]
    v_lshlrev_b32 v126, 16, v146
    v_mfma_f32_16x16x32_bf16 v[214:217], v[94:97], a[104:107], v[214:217]
    ds_write_b128 v8, v[198:201] offset:3072
    v_and_b32 v127, 0xffff0000, v146
    v_lshlrev_b32 v128, 16, v147
    v_mfma_f32_16x16x32_bf16 v[218:221], v[98:101], a[104:107], v[218:221]
    v_and_b32 v129, 0xffff0000, v147
    v_mfma_f32_16x16x32_bf16 v[218:221], v[118:121], a[120:123], v[218:221]
    ds_write_b128 v8, v[202:205] offset:4096
    v_lshlrev_b32 v130, 16, v148
    v_and_b32 v131, 0xffff0000, v148
    v_mfma_f32_16x16x32_bf16 v[222:225], v[122:125], a[120:123], v[222:225]
    v_lshlrev_b32 v132, 16, v149
    v_mfma_f32_16x16x32_bf16 v[222:225], v[102:105], a[104:107], v[222:225]
    ds_write_b128 v8, v[206:209] offset:5120
    v_and_b32 v133, 0xffff0000, v149
    v_lshlrev_b32 v134, 16, v150
    v_mfma_f32_16x16x32_bf16 v[226:229], v[86:89], a[108:111], v[226:229]
    v_and_b32 v135, 0xffff0000, v150
    v_mfma_f32_16x16x32_bf16 v[226:229], v[106:109], a[124:127], v[226:229]
    ds_write_b128 v8, v[210:213] offset:6144
    v_lshlrev_b32 v136, 16, v151
    v_and_b32 v137, 0xffff0000, v151
    v_mfma_f32_16x16x32_bf16 v[230:233], v[110:113], a[124:127], v[230:233]
    v_lshlrev_b32 v138, 16, v152
    v_mfma_f32_16x16x32_bf16 v[230:233], v[90:93], a[108:111], v[230:233]
    ds_write_b128 v8, v[214:217] offset:7168
    v_and_b32 v139, 0xffff0000, v152
    v_lshlrev_b32 v140, 16, v153
    v_mfma_f32_16x16x32_bf16 v[234:237], v[94:97], a[108:111], v[234:237]
    v_and_b32 v141, 0xffff0000, v153
    v_mfma_f32_16x16x32_bf16 v[234:237], v[114:117], a[124:127], v[234:237]
    ds_write_b128 v8, v[218:221] offset:8192
    v_lshlrev_b32 v142, 16, v154
    v_and_b32 v143, 0xffff0000, v154
    v_mfma_f32_16x16x32_bf16 v[238:241], v[118:121], a[124:127], v[238:241]
    v_lshlrev_b32 v144, 16, v155
    v_and_b32 v145, 0xffff0000, v155
    v_mfma_f32_16x16x32_bf16 v[238:241], v[98:101], a[108:111], v[238:241]
    ds_write_b128 v8, v[222:225] offset:9216
    v_lshlrev_b32 v146, 16, v22
    v_mfma_f32_16x16x32_bf16 v[242:245], v[102:105], a[108:111], v[242:245]
    v_and_b32 v147, 0xffff0000, v22
    v_lshlrev_b32 v148, 16, v23
    v_mfma_f32_16x16x32_bf16 v[242:245], v[122:125], a[124:127], v[242:245]
    ds_write_b128 v9, v[226:229] offset:0
    v_and_b32 v149, 0xffff0000, v23
    v_mfma_f32_16x16x32_bf16 v[166:169], v[106:109], a[112:115], v[166:169]
    v_lshlrev_b32 v150, 16, v24
    v_and_b32 v151, 0xffff0000, v24
    v_mfma_f32_16x16x32_bf16 v[166:169], v[86:89], a[96:99], v[166:169]
    ds_write_b128 v9, v[230:233] offset:1024
    v_lshlrev_b32 v152, 16, v25
    v_mfma_f32_16x16x32_bf16 v[170:173], v[90:93], a[96:99], v[170:173]
    v_and_b32 v153, 0xffff0000, v25
    v_lshlrev_b32 v154, 16, v26
    v_mfma_f32_16x16x32_bf16 v[170:173], v[110:113], a[112:115], v[170:173]
    ds_write_b128 v9, v[234:237] offset:2048
    v_and_b32 v155, 0xffff0000, v26
    v_mfma_f32_16x16x32_bf16 v[174:177], v[114:117], a[112:115], v[174:177]
    v_lshlrev_b32 v156, 16, v27
    v_and_b32 v157, 0xffff0000, v27
    v_mfma_f32_16x16x32_bf16 v[174:177], v[94:97], a[96:99], v[174:177]
    ds_write_b128 v9, v[238:241] offset:3072
    v_lshlrev_b32 v158, 16, v28
    v_mfma_f32_16x16x32_bf16 v[178:181], v[98:101], a[96:99], v[178:181]
    v_and_b32 v159, 0xffff0000, v28
    v_lshlrev_b32 v160, 16, v29
    v_mfma_f32_16x16x32_bf16 v[178:181], v[118:121], a[112:115], v[178:181]
    ds_write_b128 v9, v[242:245] offset:4096
    v_and_b32 v161, 0xffff0000, v29
    v_mfma_f32_16x16x32_bf16 v[182:185], v[122:125], a[112:115], v[182:185]
    v_lshlrev_b32 v162, 16, v30
    v_and_b32 v163, 0xffff0000, v30
    v_mfma_f32_16x16x32_bf16 v[182:185], v[102:105], a[96:99], v[182:185]
    v_lshlrev_b32 v164, 16, v31
    v_and_b32 v165, 0xffff0000, v31
    s_waitcnt lgkmcnt(0)
    s_barrier
    ds_read_b128 v[186:189], v5 offset:0
    ds_read_b128 v[190:193], v5 offset:1024
    ds_read_b128 v[194:197], v5 offset:2048
    ds_read_b128 v[198:201], v5 offset:3072
    ds_read_b128 v[202:205], v5 offset:4096
    ds_read_b128 v[206:209], v6 offset:5120
    ds_read_b128 v[210:213], v6 offset:6144
    ds_read_b128 v[214:217], v6 offset:7168
    ds_read_b128 v[218:221], v6 offset:8192
    ds_read_b128 v[222:225], v6 offset:9216
    ds_read_b128 v[226:229], v7 offset:0
    ds_read_b128 v[230:233], v7 offset:1024
    ds_read_b128 v[234:237], v7 offset:2048
    ds_read_b128 v[238:241], v7 offset:3072
    ds_read_b128 v[242:245], v7 offset:4096
    s_waitcnt lgkmcnt(10)
    v_pk_add_f32 v[166:167], v[166:167], v[186:187]
    v_pk_add_f32 v[168:169], v[168:169], v[188:189]
    v_pk_add_f32 v[170:171], v[170:171], v[190:191]
    v_pk_add_f32 v[172:173], v[172:173], v[192:193]
    v_pk_add_f32 v[174:175], v[174:175], v[194:195]
    v_pk_add_f32 v[176:177], v[176:177], v[196:197]
    v_pk_add_f32 v[178:179], v[178:179], v[198:199]
    v_pk_add_f32 v[180:181], v[180:181], v[200:201]
    v_pk_add_f32 v[182:183], v[182:183], v[202:203]
    v_pk_add_f32 v[184:185], v[184:185], v[204:205]
    s_waitcnt lgkmcnt(5)
    v_pk_add_f32 v[166:167], v[166:167], v[206:207]
    v_pk_add_f32 v[168:169], v[168:169], v[208:209]
    v_pk_add_f32 v[170:171], v[170:171], v[210:211]
    v_pk_add_f32 v[172:173], v[172:173], v[212:213]
    v_pk_add_f32 v[174:175], v[174:175], v[214:215]
    v_pk_add_f32 v[176:177], v[176:177], v[216:217]
    v_pk_add_f32 v[178:179], v[178:179], v[218:219]
    v_pk_add_f32 v[180:181], v[180:181], v[220:221]
    v_pk_add_f32 v[182:183], v[182:183], v[222:223]
    v_pk_add_f32 v[184:185], v[184:185], v[224:225]
    s_waitcnt lgkmcnt(0)
    v_pk_add_f32 v[166:167], v[166:167], v[226:227]
    v_pk_add_f32 v[168:169], v[168:169], v[228:229]
    v_pk_add_f32 v[170:171], v[170:171], v[230:231]
    v_pk_add_f32 v[172:173], v[172:173], v[232:233]
    v_pk_add_f32 v[174:175], v[174:175], v[234:235]
    v_pk_add_f32 v[176:177], v[176:177], v[236:237]
    v_pk_add_f32 v[178:179], v[178:179], v[238:239]
    v_pk_add_f32 v[180:181], v[180:181], v[240:241]
    v_pk_add_f32 v[182:183], v[182:183], v[242:243]
    v_pk_add_f32 v[184:185], v[184:185], v[244:245]
    s_waitcnt vmcnt(0)
    v_pk_add_f32 v[166:167], v[166:167], v[46:47]
    v_pk_add_f32 v[168:169], v[168:169], v[48:49]
    v_pk_add_f32 v[170:171], v[170:171], v[50:51]
    v_pk_add_f32 v[172:173], v[172:173], v[52:53]
    v_pk_add_f32 v[174:175], v[174:175], v[54:55]
    v_pk_add_f32 v[176:177], v[176:177], v[56:57]
    v_pk_add_f32 v[178:179], v[178:179], v[58:59]
    v_pk_add_f32 v[180:181], v[180:181], v[60:61]
    v_pk_add_f32 v[182:183], v[182:183], v[62:63]
    v_pk_add_f32 v[184:185], v[184:185], v[64:65]
    v_cvt_pk_bf16_f32 v66, v166, v167
    v_cvt_pk_bf16_f32 v67, v168, v169
    v_cvt_pk_bf16_f32 v68, v170, v171
    v_cvt_pk_bf16_f32 v69, v172, v173
    v_cvt_pk_bf16_f32 v70, v174, v175
    v_cvt_pk_bf16_f32 v71, v176, v177
    v_cvt_pk_bf16_f32 v72, v178, v179
    v_cvt_pk_bf16_f32 v73, v180, v181
    v_cvt_pk_bf16_f32 v74, v182, v183
    v_cvt_pk_bf16_f32 v75, v184, v185
    v_lshlrev_b32 v166, 16, v66
    v_and_b32 v167, 0xffff0000, v66
    v_lshlrev_b32 v168, 16, v67
    v_and_b32 v169, 0xffff0000, v67
    v_lshlrev_b32 v170, 16, v68
    v_and_b32 v171, 0xffff0000, v68
    v_lshlrev_b32 v172, 16, v69
    v_and_b32 v173, 0xffff0000, v69
    v_lshlrev_b32 v174, 16, v70
    v_and_b32 v175, 0xffff0000, v70
    v_lshlrev_b32 v176, 16, v71
    v_and_b32 v177, 0xffff0000, v71
    v_lshlrev_b32 v178, 16, v72
    v_and_b32 v179, 0xffff0000, v72
    v_lshlrev_b32 v180, 16, v73
    v_and_b32 v181, 0xffff0000, v73
    v_lshlrev_b32 v182, 16, v74
    v_and_b32 v183, 0xffff0000, v74
    v_lshlrev_b32 v184, 16, v75
    v_and_b32 v185, 0xffff0000, v75
    v_pk_mul_f32 v[166:167], v[166:167], v[126:127]
    v_pk_mul_f32 v[168:169], v[168:169], v[128:129]
    v_pk_mul_f32 v[170:171], v[170:171], v[130:131]
    v_pk_mul_f32 v[172:173], v[172:173], v[132:133]
    v_pk_mul_f32 v[174:175], v[174:175], v[134:135]
    v_pk_mul_f32 v[176:177], v[176:177], v[136:137]
    v_pk_mul_f32 v[178:179], v[178:179], v[138:139]
    v_pk_mul_f32 v[180:181], v[180:181], v[140:141]
    v_pk_mul_f32 v[182:183], v[182:183], v[142:143]
    v_pk_mul_f32 v[184:185], v[184:185], v[144:145]
    v_cvt_pk_bf16_f32 v66, v166, v167
    v_cvt_pk_bf16_f32 v67, v168, v169
    v_cvt_pk_bf16_f32 v68, v170, v171
    v_cvt_pk_bf16_f32 v69, v172, v173
    v_cvt_pk_bf16_f32 v70, v174, v175
    v_cvt_pk_bf16_f32 v71, v176, v177
    v_cvt_pk_bf16_f32 v72, v178, v179
    v_cvt_pk_bf16_f32 v73, v180, v181
    v_cvt_pk_bf16_f32 v74, v182, v183
    v_cvt_pk_bf16_f32 v75, v184, v185
    v_lshlrev_b32 v166, 16, v66
    v_and_b32 v167, 0xffff0000, v66
    v_lshlrev_b32 v168, 16, v67
    v_and_b32 v169, 0xffff0000, v67
    v_lshlrev_b32 v170, 16, v68
    v_and_b32 v171, 0xffff0000, v68
    v_lshlrev_b32 v172, 16, v69
    v_and_b32 v173, 0xffff0000, v69
    v_lshlrev_b32 v174, 16, v70
    v_and_b32 v175, 0xffff0000, v70
    v_lshlrev_b32 v176, 16, v71
    v_and_b32 v177, 0xffff0000, v71
    v_lshlrev_b32 v178, 16, v72
    v_and_b32 v179, 0xffff0000, v72
    v_lshlrev_b32 v180, 16, v73
    v_and_b32 v181, 0xffff0000, v73
    v_lshlrev_b32 v182, 16, v74
    v_and_b32 v183, 0xffff0000, v74
    v_lshlrev_b32 v184, 16, v75
    v_and_b32 v185, 0xffff0000, v75
    v_pk_add_f32 v[166:167], v[166:167], v[146:147]
    v_pk_add_f32 v[168:169], v[168:169], v[148:149]
    v_pk_add_f32 v[170:171], v[170:171], v[150:151]
    v_pk_add_f32 v[172:173], v[172:173], v[152:153]
    v_pk_add_f32 v[174:175], v[174:175], v[154:155]
    v_pk_add_f32 v[176:177], v[176:177], v[156:157]
    v_pk_add_f32 v[178:179], v[178:179], v[158:159]
    v_pk_add_f32 v[180:181], v[180:181], v[160:161]
    v_pk_add_f32 v[182:183], v[182:183], v[162:163]
    v_pk_add_f32 v[184:185], v[184:185], v[164:165]
    v_cvt_pk_bf16_f32 v66, v166, v167
    v_cvt_pk_bf16_f32 v67, v168, v169
    buffer_store_dwordx2 v[66:67], v34, s[12:15], 0 offen offset:0
    v_cvt_pk_bf16_f32 v68, v170, v171
    v_cvt_pk_bf16_f32 v69, v172, v173
    buffer_store_dwordx2 v[68:69], v34, s[12:15], 0 offen offset:32
    v_cvt_pk_bf16_f32 v70, v174, v175
    v_cvt_pk_bf16_f32 v71, v176, v177
    buffer_store_dwordx2 v[70:71], v34, s[12:15], 0 offen offset:64
    v_cvt_pk_bf16_f32 v72, v178, v179
    v_cvt_pk_bf16_f32 v73, v180, v181
    buffer_store_dwordx2 v[72:73], v34, s[12:15], 0 offen offset:96
    v_cvt_pk_bf16_f32 v74, v182, v183
    v_cvt_pk_bf16_f32 v75, v184, v185
    buffer_store_dwordx2 v[74:75], v34, s[12:15], 0 offen offset:128
L_end:
    s_endpgm
L_slow:
    s_lshl_b32 s40, s5, 12
    v_subrev_u32 v13, s40, v13
    v_subrev_u32 v14, s40, v14
    v_subrev_u32 v15, s40, v15
    v_subrev_u32 v16, s40, v16
    v_subrev_u32 v17, s40, v17
    v_subrev_u32 v18, s40, v18
    s_and_b32 s40, s5, 1
    s_lshr_b32 s41, s5, 1
    s_mul_i32 s41, s41, 3
    s_add_u32 s40, s40, s41
    s_add_u32 s40, s40, 1
    s_lshl_b32 s34, s40, 13
    s_sub_u32 s40, s34, 98304
    v_add_u32 v1, s40, v1
    v_add_u32 v2, s40, v2
    v_add_u32 v3, s40, v3
    v_add_u32 v4, s40, v4
    v_add_u32 v5, s34, v5
    v_add_u32 v6, s34, v6
    v_add_u32 v7, s34, v7
    v_add_u32 v8, s34, v8
    v_add_u32 v9, s34, v9
    v_add_u32 v10, s34, v10
    v_add_u32 v11, s34, v11
    v_add_u32 v12, s34, v12
    v_mov_b32 v212, 0xff800000
    v_mov_b32 v216, 0
    v_mov_b32 v213, 0xff800000
    v_mov_b32 v217, 0
    v_mov_b32 v214, 0xff800000
    v_mov_b32 v218, 0
    v_mov_b32 v215, 0xff800000
    v_mov_b32 v219, 0
    v_accvgpr_write_b32 a0, 0
    v_accvgpr_write_b32 a1, 0
    v_accvgpr_write_b32 a2, 0
    v_accvgpr_write_b32 a3, 0
    v_accvgpr_write_b32 a4, 0
    v_accvgpr_write_b32 a5, 0
    v_accvgpr_write_b32 a6, 0
    v_accvgpr_write_b32 a7, 0
    v_accvgpr_write_b32 a8, 0
    v_accvgpr_write_b32 a9, 0
    v_accvgpr_write_b32 a10, 0
    v_accvgpr_write_b32 a11, 0
    v_accvgpr_write_b32 a12, 0
    v_accvgpr_write_b32 a13, 0
    v_accvgpr_write_b32 a14, 0
    v_accvgpr_write_b32 a15, 0
    v_accvgpr_write_b32 a16, 0
    v_accvgpr_write_b32 a17, 0
    v_accvgpr_write_b32 a18, 0
    v_accvgpr_write_b32 a19, 0
    v_accvgpr_write_b32 a20, 0
    v_accvgpr_write_b32 a21, 0
    v_accvgpr_write_b32 a22, 0
    v_accvgpr_write_b32 a23, 0
    v_accvgpr_write_b32 a24, 0
    v_accvgpr_write_b32 a25, 0
    v_accvgpr_write_b32 a26, 0
    v_accvgpr_write_b32 a27, 0
    v_accvgpr_write_b32 a28, 0
    v_accvgpr_write_b32 a29, 0
    v_accvgpr_write_b32 a30, 0
    v_accvgpr_write_b32 a31, 0
    v_accvgpr_write_b32 a32, 0
    v_accvgpr_write_b32 a33, 0
    v_accvgpr_write_b32 a34, 0
    v_accvgpr_write_b32 a35, 0
    v_accvgpr_write_b32 a36, 0
    v_accvgpr_write_b32 a37, 0
    v_accvgpr_write_b32 a38, 0
    v_accvgpr_write_b32 a39, 0
    v_accvgpr_write_b32 a40, 0
    v_accvgpr_write_b32 a41, 0
    v_accvgpr_write_b32 a42, 0
    v_accvgpr_write_b32 a43, 0
    v_accvgpr_write_b32 a44, 0
    v_accvgpr_write_b32 a45, 0
    v_accvgpr_write_b32 a46, 0
    v_accvgpr_write_b32 a47, 0
    v_accvgpr_write_b32 a48, 0
    v_accvgpr_write_b32 a49, 0
    v_accvgpr_write_b32 a50, 0
    v_accvgpr_write_b32 a51, 0
    v_accvgpr_write_b32 a52, 0
    v_accvgpr_write_b32 a53, 0
    v_accvgpr_write_b32 a54, 0
    v_accvgpr_write_b32 a55, 0
    v_accvgpr_write_b32 a56, 0
    v_accvgpr_write_b32 a57, 0
    v_accvgpr_write_b32 a58, 0
    v_accvgpr_write_b32 a59, 0
    v_accvgpr_write_b32 a60, 0
    v_accvgpr_write_b32 a61, 0
    v_accvgpr_write_b32 a62, 0
    v_accvgpr_write_b32 a63, 0
    v_accvgpr_write_b32 a64, 0
    v_accvgpr_write_b32 a65, 0
    v_accvgpr_write_b32 a66, 0
    v_accvgpr_write_b32 a67, 0
    v_accvgpr_write_b32 a68, 0
    v_accvgpr_write_b32 a69, 0
    v_accvgpr_write_b32 a70, 0
    v_accvgpr_write_b32 a71, 0
    v_accvgpr_write_b32 a72, 0
    v_accvgpr_write_b32 a73, 0
    v_accvgpr_write_b32 a74, 0
    v_accvgpr_write_b32 a75, 0
    v_accvgpr_write_b32 a76, 0
    v_accvgpr_write_b32 a77, 0
    v_accvgpr_write_b32 a78, 0
    v_accvgpr_write_b32 a79, 0
    v_accvgpr_write_b32 a80, 0
    v_accvgpr_write_b32 a81, 0
    v_accvgpr_write_b32 a82, 0
    v_accvgpr_write_b32 a83, 0
    v_accvgpr_write_b32 a84, 0
    v_accvgpr_write_b32 a85, 0
    v_accvgpr_write_b32 a86, 0
    v_accvgpr_write_b32 a87, 0
    v_accvgpr_write_b32 a88, 0
    v_accvgpr_write_b32 a89, 0
    v_accvgpr_write_b32 a90, 0
    v_accvgpr_write_b32 a91, 0
    v_accvgpr_write_b32 a92, 0
    v_accvgpr_write_b32 a93, 0
    v_accvgpr_write_b32 a94, 0
    v_accvgpr_write_b32 a95, 0
    v_accvgpr_write_b32 a96, 0
    v_accvgpr_write_b32 a97, 0
    v_accvgpr_write_b32 a98, 0
    v_accvgpr_write_b32 a99, 0
    v_accvgpr_write_b32 a100, 0
    v_accvgpr_write_b32 a101, 0
    v_accvgpr_write_b32 a102, 0
    v_accvgpr_write_b32 a103, 0
    v_accvgpr_write_b32 a104, 0
    v_accvgpr_write_b32 a105, 0
    v_accvgpr_write_b32 a106, 0
    v_accvgpr_write_b32 a107, 0
    v_accvgpr_write_b32 a108, 0
    v_accvgpr_write_b32 a109, 0
    v_accvgpr_write_b32 a110, 0
    v_accvgpr_write_b32 a111, 0
    v_accvgpr_write_b32 a112, 0
    v_accvgpr_write_b32 a113, 0
    v_accvgpr_write_b32 a114, 0
    v_accvgpr_write_b32 a115, 0
    v_accvgpr_write_b32 a116, 0
    v_accvgpr_write_b32 a117, 0
    v_accvgpr_write_b32 a118, 0
    v_accvgpr_write_b32 a119, 0
    v_accvgpr_write_b32 a120, 0
    v_accvgpr_write_b32 a121, 0
    v_accvgpr_write_b32 a122, 0
    v_accvgpr_write_b32 a123, 0
    v_accvgpr_write_b32 a124, 0
    v_accvgpr_write_b32 a125, 0
    v_accvgpr_write_b32 a126, 0
    v_accvgpr_write_b32 a127, 0
    s_mov_b32 s28, 0
L_slow_loop:
    s_add_u32 m0, s34, 0
    s_add_u32 s40, s28, 0
    buffer_load_dwordx4 v13, s[8:11], s40 offen offset:0 lds
    buffer_load_dwordx4 v14, s[8:11], s40 offen offset:1024 lds
    buffer_load_dwordx4 v15, s[8:11], s40 offen offset:2048 lds
    buffer_load_dwordx4 v16, s[8:11], s40 offen offset:3072 lds
    s_add_u32 m0, s34, 4096
    s_add_u32 s40, s28, 4096
    buffer_load_dwordx4 v13, s[8:11], s40 offen offset:0 lds
    buffer_load_dwordx4 v14, s[8:11], s40 offen offset:1024 lds
    buffer_load_dwordx4 v15, s[8:11], s40 offen offset:2048 lds
    buffer_load_dwordx4 v16, s[8:11], s40 offen offset:3072 lds
    s_waitcnt vmcnt(0)
    ds_read_b128 v[148:151], v1 offset:0
    ds_read_b128 v[152:155], v2 offset:0
    ds_read_b128 v[156:159], v3 offset:0
    ds_read_b128 v[160:163], v4 offset:0
    ds_read_b128 v[164:167], v1 offset:4096
    ds_read_b128 v[168:171], v2 offset:4096
    ds_read_b128 v[172:175], v3 offset:4096
    ds_read_b128 v[176:179], v4 offset:4096
    s_waitcnt lgkmcnt(0)
    s_add_u32 m0, s34, 0
    s_add_u32 s40, s28, 0
    buffer_load_dwordx4 v17, s[12:15], s40 offen offset:0 lds
    buffer_load_dwordx4 v18, s[12:15], s40 offen offset:1024 lds
    buffer_load_dwordx4 v17, s[12:15], s40 offen offset:2048 lds
    buffer_load_dwordx4 v18, s[12:15], s40 offen offset:3072 lds
    s_add_u32 m0, s34, 4096
    s_add_u32 s40, s28, 4096
    buffer_load_dwordx4 v17, s[12:15], s40 offen offset:0 lds
    buffer_load_dwordx4 v18, s[12:15], s40 offen offset:1024 lds
    buffer_load_dwordx4 v17, s[12:15], s40 offen offset:2048 lds
    buffer_load_dwordx4 v18, s[12:15], s40 offen offset:3072 lds
    s_waitcnt vmcnt(0)
    ds_read_b64_tr_b16 v[196:197], v5 offset:0
    ds_read_b64_tr_b16 v[198:199], v5 offset:4096
    ds_read_b64_tr_b16 v[200:201], v6 offset:0
    ds_read_b64_tr_b16 v[202:203], v6 offset:4096
    ds_read_b64_tr_b16 v[204:205], v7 offset:0
    ds_read_b64_tr_b16 v[206:207], v7 offset:4096
    ds_read_b64_tr_b16 v[208:209], v8 offset:0
    ds_read_b64_tr_b16 v[210:211], v8 offset:4096
    ds_read_b64_tr_b16 v[228:229], v9 offset:0
    ds_read_b64_tr_b16 v[230:231], v9 offset:4096
    ds_read_b64_tr_b16 v[232:233], v10 offset:0
    ds_read_b64_tr_b16 v[234:235], v10 offset:4096
    ds_read_b64_tr_b16 v[236:237], v11 offset:0
    ds_read_b64_tr_b16 v[238:239], v11 offset:4096
    ds_read_b64_tr_b16 v[240:241], v12 offset:0
    ds_read_b64_tr_b16 v[242:243], v12 offset:4096
    v_mfma_f32_16x16x32_bf16 v[116:119], v[148:151], v[36:39], 0
    v_mfma_f32_16x16x32_bf16 v[116:119], v[152:155], v[40:43], v[116:119]
    v_mfma_f32_16x16x32_bf16 v[116:119], v[156:159], v[44:47], v[116:119]
    v_mfma_f32_16x16x32_bf16 v[116:119], v[160:163], v[48:51], v[116:119]
    v_mfma_f32_16x16x32_bf16 v[132:135], v[164:167], v[36:39], 0
    v_mfma_f32_16x16x32_bf16 v[132:135], v[168:171], v[40:43], v[132:135]
    v_mfma_f32_16x16x32_bf16 v[132:135], v[172:175], v[44:47], v[132:135]
    v_mfma_f32_16x16x32_bf16 v[132:135], v[176:179], v[48:51], v[132:135]
    v_mfma_f32_16x16x32_bf16 v[120:123], v[160:163], v[64:67], 0
    v_mfma_f32_16x16x32_bf16 v[120:123], v[156:159], v[60:63], v[120:123]
    v_mfma_f32_16x16x32_bf16 v[120:123], v[152:155], v[56:59], v[120:123]
    v_mfma_f32_16x16x32_bf16 v[120:123], v[148:151], v[52:55], v[120:123]
    v_mfma_f32_16x16x32_bf16 v[136:139], v[176:179], v[64:67], 0
    v_mfma_f32_16x16x32_bf16 v[136:139], v[172:175], v[60:63], v[136:139]
    v_mfma_f32_16x16x32_bf16 v[136:139], v[168:171], v[56:59], v[136:139]
    v_mfma_f32_16x16x32_bf16 v[136:139], v[164:167], v[52:55], v[136:139]
    v_mfma_f32_16x16x32_bf16 v[124:127], v[148:151], v[68:71], 0
    v_mfma_f32_16x16x32_bf16 v[124:127], v[152:155], v[72:75], v[124:127]
    v_mfma_f32_16x16x32_bf16 v[124:127], v[156:159], v[76:79], v[124:127]
    v_mfma_f32_16x16x32_bf16 v[124:127], v[160:163], v[80:83], v[124:127]
    v_mfma_f32_16x16x32_bf16 v[140:143], v[164:167], v[68:71], 0
    v_mfma_f32_16x16x32_bf16 v[140:143], v[168:171], v[72:75], v[140:143]
    v_mfma_f32_16x16x32_bf16 v[140:143], v[172:175], v[76:79], v[140:143]
    v_mfma_f32_16x16x32_bf16 v[140:143], v[176:179], v[80:83], v[140:143]
    v_mfma_f32_16x16x32_bf16 v[128:131], v[160:163], v[96:99], 0
    v_mfma_f32_16x16x32_bf16 v[128:131], v[156:159], v[92:95], v[128:131]
    v_mfma_f32_16x16x32_bf16 v[128:131], v[152:155], v[88:91], v[128:131]
    v_mfma_f32_16x16x32_bf16 v[128:131], v[148:151], v[84:87], v[128:131]
    v_mfma_f32_16x16x32_bf16 v[144:147], v[176:179], v[96:99], 0
    v_mfma_f32_16x16x32_bf16 v[144:147], v[172:175], v[92:95], v[144:147]
    v_mfma_f32_16x16x32_bf16 v[144:147], v[168:171], v[88:91], v[144:147]
    v_mfma_f32_16x16x32_bf16 v[144:147], v[164:167], v[84:87], v[144:147]
    s_waitcnt lgkmcnt(0)
    s_nop 7
    v_max3_f32 v224, v116, v117, v118
    v_max3_f32 v224, v224, v119, v132
    v_max3_f32 v224, v224, v133, v134
    v_max3_f32 v224, v224, v135, v212
    v_mov_b32 v225, v224
    s_nop 1
    v_permlane32_swap_b32 v224, v225
    v_max_f32 v224, v224, v225
    v_mov_b32 v225, v224
    s_nop 1
    v_permlane16_swap_b32 v224, v225
    v_max_f32 v224, v224, v225
    v_sub_f32 v220, v212, v224
    v_exp_f32 v220, v220
    v_mov_b32 v212, v224
    v_sub_f32 v116, v116, v224
    v_sub_f32 v117, v117, v224
    v_sub_f32 v118, v118, v224
    v_sub_f32 v119, v119, v224
    v_sub_f32 v132, v132, v224
    v_sub_f32 v133, v133, v224
    v_sub_f32 v134, v134, v224
    v_sub_f32 v135, v135, v224
    v_mul_f32 v216, v216, v220
    v_exp_f32 v116, v116
    v_exp_f32 v117, v117
    v_exp_f32 v118, v118
    v_exp_f32 v119, v119
    v_exp_f32 v132, v132
    v_exp_f32 v133, v133
    v_exp_f32 v134, v134
    v_exp_f32 v135, v135
    v_accvgpr_read_b32 v224, a0
    v_accvgpr_read_b32 v225, a1
    v_accvgpr_read_b32 v226, a2
    v_accvgpr_read_b32 v227, a3
    v_mul_f32 v224, v224, v220
    v_mul_f32 v225, v225, v220
    v_mul_f32 v226, v226, v220
    v_mul_f32 v227, v227, v220
    v_accvgpr_write_b32 a0, v224
    v_accvgpr_write_b32 a1, v225
    v_accvgpr_write_b32 a2, v226
    v_accvgpr_write_b32 a3, v227
    v_accvgpr_read_b32 v224, a16
    v_accvgpr_read_b32 v225, a17
    v_accvgpr_read_b32 v226, a18
    v_accvgpr_read_b32 v227, a19
    v_mul_f32 v224, v224, v220
    v_mul_f32 v225, v225, v220
    v_mul_f32 v226, v226, v220
    v_mul_f32 v227, v227, v220
    v_accvgpr_write_b32 a16, v224
    v_accvgpr_write_b32 a17, v225
    v_accvgpr_write_b32 a18, v226
    v_accvgpr_write_b32 a19, v227
    v_accvgpr_read_b32 v224, a32
    v_accvgpr_read_b32 v225, a33
    v_accvgpr_read_b32 v226, a34
    v_accvgpr_read_b32 v227, a35
    v_mul_f32 v224, v224, v220
    v_mul_f32 v225, v225, v220
    v_mul_f32 v226, v226, v220
    v_mul_f32 v227, v227, v220
    v_accvgpr_write_b32 a32, v224
    v_accvgpr_write_b32 a33, v225
    v_accvgpr_write_b32 a34, v226
    v_accvgpr_write_b32 a35, v227
    v_accvgpr_read_b32 v224, a48
    v_accvgpr_read_b32 v225, a49
    v_accvgpr_read_b32 v226, a50
    v_accvgpr_read_b32 v227, a51
    v_mul_f32 v224, v224, v220
    v_mul_f32 v225, v225, v220
    v_mul_f32 v226, v226, v220
    v_mul_f32 v227, v227, v220
    v_accvgpr_write_b32 a48, v224
    v_accvgpr_write_b32 a49, v225
    v_accvgpr_write_b32 a50, v226
    v_accvgpr_write_b32 a51, v227
    v_accvgpr_read_b32 v224, a64
    v_accvgpr_read_b32 v225, a65
    v_accvgpr_read_b32 v226, a66
    v_accvgpr_read_b32 v227, a67
    v_mul_f32 v224, v224, v220
    v_mul_f32 v225, v225, v220
    v_mul_f32 v226, v226, v220
    v_mul_f32 v227, v227, v220
    v_accvgpr_write_b32 a64, v224
    v_accvgpr_write_b32 a65, v225
    v_accvgpr_write_b32 a66, v226
    v_accvgpr_write_b32 a67, v227
    v_accvgpr_read_b32 v224, a80
    v_accvgpr_read_b32 v225, a81
    v_accvgpr_read_b32 v226, a82
    v_accvgpr_read_b32 v227, a83
    v_mul_f32 v224, v224, v220
    v_mul_f32 v225, v225, v220
    v_mul_f32 v226, v226, v220
    v_mul_f32 v227, v227, v220
    v_accvgpr_write_b32 a80, v224
    v_accvgpr_write_b32 a81, v225
    v_accvgpr_write_b32 a82, v226
    v_accvgpr_write_b32 a83, v227
    v_accvgpr_read_b32 v224, a96
    v_accvgpr_read_b32 v225, a97
    v_accvgpr_read_b32 v226, a98
    v_accvgpr_read_b32 v227, a99
    v_mul_f32 v224, v224, v220
    v_mul_f32 v225, v225, v220
    v_mul_f32 v226, v226, v220
    v_mul_f32 v227, v227, v220
    v_accvgpr_write_b32 a96, v224
    v_accvgpr_write_b32 a97, v225
    v_accvgpr_write_b32 a98, v226
    v_accvgpr_write_b32 a99, v227
    v_accvgpr_read_b32 v224, a112
    v_accvgpr_read_b32 v225, a113
    v_accvgpr_read_b32 v226, a114
    v_accvgpr_read_b32 v227, a115
    v_mul_f32 v224, v224, v220
    v_mul_f32 v225, v225, v220
    v_mul_f32 v226, v226, v220
    v_mul_f32 v227, v227, v220
    v_accvgpr_write_b32 a112, v224
    v_accvgpr_write_b32 a113, v225
    v_accvgpr_write_b32 a114, v226
    v_accvgpr_write_b32 a115, v227
    v_add_f32 v216, v216, v116
    v_add_f32 v216, v216, v117
    v_add_f32 v216, v216, v118
    v_add_f32 v216, v216, v119
    v_add_f32 v216, v216, v132
    v_add_f32 v216, v216, v133
    v_add_f32 v216, v216, v134
    v_add_f32 v216, v216, v135
    v_cvt_pk_bf16_f32 v180, v116, v117
    v_cvt_pk_bf16_f32 v181, v118, v119
    v_cvt_pk_bf16_f32 v182, v132, v133
    v_cvt_pk_bf16_f32 v183, v134, v135
    s_nop 1
    v_mfma_f32_16x16x32_bf16 a[0:3], v[196:199], v[180:183], a[0:3]
    v_mfma_f32_16x16x32_bf16 a[16:19], v[200:203], v[180:183], a[16:19]
    v_mfma_f32_16x16x32_bf16 a[32:35], v[204:207], v[180:183], a[32:35]
    v_mfma_f32_16x16x32_bf16 a[48:51], v[208:211], v[180:183], a[48:51]
    v_mfma_f32_16x16x32_bf16 a[64:67], v[228:231], v[180:183], a[64:67]
    v_mfma_f32_16x16x32_bf16 a[80:83], v[232:235], v[180:183], a[80:83]
    v_mfma_f32_16x16x32_bf16 a[96:99], v[236:239], v[180:183], a[96:99]
    v_mfma_f32_16x16x32_bf16 a[112:115], v[240:243], v[180:183], a[112:115]
    v_max3_f32 v224, v120, v121, v122
    v_max3_f32 v224, v224, v123, v136
    v_max3_f32 v224, v224, v137, v138
    v_max3_f32 v224, v224, v139, v213
    v_mov_b32 v225, v224
    s_nop 1
    v_permlane32_swap_b32 v224, v225
    v_max_f32 v224, v224, v225
    v_mov_b32 v225, v224
    s_nop 1
    v_permlane16_swap_b32 v224, v225
    v_max_f32 v224, v224, v225
    v_sub_f32 v220, v213, v224
    v_exp_f32 v220, v220
    v_mov_b32 v213, v224
    v_sub_f32 v120, v120, v224
    v_sub_f32 v121, v121, v224
    v_sub_f32 v122, v122, v224
    v_sub_f32 v123, v123, v224
    v_sub_f32 v136, v136, v224
    v_sub_f32 v137, v137, v224
    v_sub_f32 v138, v138, v224
    v_sub_f32 v139, v139, v224
    v_mul_f32 v217, v217, v220
    v_exp_f32 v120, v120
    v_exp_f32 v121, v121
    v_exp_f32 v122, v122
    v_exp_f32 v123, v123
    v_exp_f32 v136, v136
    v_exp_f32 v137, v137
    v_exp_f32 v138, v138
    v_exp_f32 v139, v139
    v_accvgpr_read_b32 v224, a4
    v_accvgpr_read_b32 v225, a5
    v_accvgpr_read_b32 v226, a6
    v_accvgpr_read_b32 v227, a7
    v_mul_f32 v224, v224, v220
    v_mul_f32 v225, v225, v220
    v_mul_f32 v226, v226, v220
    v_mul_f32 v227, v227, v220
    v_accvgpr_write_b32 a4, v224
    v_accvgpr_write_b32 a5, v225
    v_accvgpr_write_b32 a6, v226
    v_accvgpr_write_b32 a7, v227
    v_accvgpr_read_b32 v224, a20
    v_accvgpr_read_b32 v225, a21
    v_accvgpr_read_b32 v226, a22
    v_accvgpr_read_b32 v227, a23
    v_mul_f32 v224, v224, v220
    v_mul_f32 v225, v225, v220
    v_mul_f32 v226, v226, v220
    v_mul_f32 v227, v227, v220
    v_accvgpr_write_b32 a20, v224
    v_accvgpr_write_b32 a21, v225
    v_accvgpr_write_b32 a22, v226
    v_accvgpr_write_b32 a23, v227
    v_accvgpr_read_b32 v224, a36
    v_accvgpr_read_b32 v225, a37
    v_accvgpr_read_b32 v226, a38
    v_accvgpr_read_b32 v227, a39
    v_mul_f32 v224, v224, v220
    v_mul_f32 v225, v225, v220
    v_mul_f32 v226, v226, v220
    v_mul_f32 v227, v227, v220
    v_accvgpr_write_b32 a36, v224
    v_accvgpr_write_b32 a37, v225
    v_accvgpr_write_b32 a38, v226
    v_accvgpr_write_b32 a39, v227
    v_accvgpr_read_b32 v224, a52
    v_accvgpr_read_b32 v225, a53
    v_accvgpr_read_b32 v226, a54
    v_accvgpr_read_b32 v227, a55
    v_mul_f32 v224, v224, v220
    v_mul_f32 v225, v225, v220
    v_mul_f32 v226, v226, v220
    v_mul_f32 v227, v227, v220
    v_accvgpr_write_b32 a52, v224
    v_accvgpr_write_b32 a53, v225
    v_accvgpr_write_b32 a54, v226
    v_accvgpr_write_b32 a55, v227
    v_accvgpr_read_b32 v224, a68
    v_accvgpr_read_b32 v225, a69
    v_accvgpr_read_b32 v226, a70
    v_accvgpr_read_b32 v227, a71
    v_mul_f32 v224, v224, v220
    v_mul_f32 v225, v225, v220
    v_mul_f32 v226, v226, v220
    v_mul_f32 v227, v227, v220
    v_accvgpr_write_b32 a68, v224
    v_accvgpr_write_b32 a69, v225
    v_accvgpr_write_b32 a70, v226
    v_accvgpr_write_b32 a71, v227
    v_accvgpr_read_b32 v224, a84
    v_accvgpr_read_b32 v225, a85
    v_accvgpr_read_b32 v226, a86
    v_accvgpr_read_b32 v227, a87
    v_mul_f32 v224, v224, v220
    v_mul_f32 v225, v225, v220
    v_mul_f32 v226, v226, v220
    v_mul_f32 v227, v227, v220
    v_accvgpr_write_b32 a84, v224
    v_accvgpr_write_b32 a85, v225
    v_accvgpr_write_b32 a86, v226
    v_accvgpr_write_b32 a87, v227
    v_accvgpr_read_b32 v224, a100
    v_accvgpr_read_b32 v225, a101
    v_accvgpr_read_b32 v226, a102
    v_accvgpr_read_b32 v227, a103
    v_mul_f32 v224, v224, v220
    v_mul_f32 v225, v225, v220
    v_mul_f32 v226, v226, v220
    v_mul_f32 v227, v227, v220
    v_accvgpr_write_b32 a100, v224
    v_accvgpr_write_b32 a101, v225
    v_accvgpr_write_b32 a102, v226
    v_accvgpr_write_b32 a103, v227
    v_accvgpr_read_b32 v224, a116
    v_accvgpr_read_b32 v225, a117
    v_accvgpr_read_b32 v226, a118
    v_accvgpr_read_b32 v227, a119
    v_mul_f32 v224, v224, v220
    v_mul_f32 v225, v225, v220
    v_mul_f32 v226, v226, v220
    v_mul_f32 v227, v227, v220
    v_accvgpr_write_b32 a116, v224
    v_accvgpr_write_b32 a117, v225
    v_accvgpr_write_b32 a118, v226
    v_accvgpr_write_b32 a119, v227
    v_add_f32 v217, v217, v120
    v_add_f32 v217, v217, v121
    v_add_f32 v217, v217, v122
    v_add_f32 v217, v217, v123
    v_add_f32 v217, v217, v136
    v_add_f32 v217, v217, v137
    v_add_f32 v217, v217, v138
    v_add_f32 v217, v217, v139
    v_cvt_pk_bf16_f32 v184, v120, v121
    v_cvt_pk_bf16_f32 v185, v122, v123
    v_cvt_pk_bf16_f32 v186, v136, v137
    v_cvt_pk_bf16_f32 v187, v138, v139
    s_nop 1
    v_mfma_f32_16x16x32_bf16 a[4:7], v[196:199], v[184:187], a[4:7]
    v_mfma_f32_16x16x32_bf16 a[20:23], v[200:203], v[184:187], a[20:23]
    v_mfma_f32_16x16x32_bf16 a[36:39], v[204:207], v[184:187], a[36:39]
    v_mfma_f32_16x16x32_bf16 a[52:55], v[208:211], v[184:187], a[52:55]
    v_mfma_f32_16x16x32_bf16 a[68:71], v[228:231], v[184:187], a[68:71]
    v_mfma_f32_16x16x32_bf16 a[84:87], v[232:235], v[184:187], a[84:87]
    v_mfma_f32_16x16x32_bf16 a[100:103], v[236:239], v[184:187], a[100:103]
    v_mfma_f32_16x16x32_bf16 a[116:119], v[240:243], v[184:187], a[116:119]
    v_max3_f32 v224, v124, v125, v126
    v_max3_f32 v224, v224, v127, v140
    v_max3_f32 v224, v224, v141, v142
    v_max3_f32 v224, v224, v143, v214
    v_mov_b32 v225, v224
    s_nop 1
    v_permlane32_swap_b32 v224, v225
    v_max_f32 v224, v224, v225
    v_mov_b32 v225, v224
    s_nop 1
    v_permlane16_swap_b32 v224, v225
    v_max_f32 v224, v224, v225
    v_sub_f32 v220, v214, v224
    v_exp_f32 v220, v220
    v_mov_b32 v214, v224
    v_sub_f32 v124, v124, v224
    v_sub_f32 v125, v125, v224
    v_sub_f32 v126, v126, v224
    v_sub_f32 v127, v127, v224
    v_sub_f32 v140, v140, v224
    v_sub_f32 v141, v141, v224
    v_sub_f32 v142, v142, v224
    v_sub_f32 v143, v143, v224
    v_mul_f32 v218, v218, v220
    v_exp_f32 v124, v124
    v_exp_f32 v125, v125
    v_exp_f32 v126, v126
    v_exp_f32 v127, v127
    v_exp_f32 v140, v140
    v_exp_f32 v141, v141
    v_exp_f32 v142, v142
    v_exp_f32 v143, v143
    v_accvgpr_read_b32 v224, a8
    v_accvgpr_read_b32 v225, a9
    v_accvgpr_read_b32 v226, a10
    v_accvgpr_read_b32 v227, a11
    v_mul_f32 v224, v224, v220
    v_mul_f32 v225, v225, v220
    v_mul_f32 v226, v226, v220
    v_mul_f32 v227, v227, v220
    v_accvgpr_write_b32 a8, v224
    v_accvgpr_write_b32 a9, v225
    v_accvgpr_write_b32 a10, v226
    v_accvgpr_write_b32 a11, v227
    v_accvgpr_read_b32 v224, a24
    v_accvgpr_read_b32 v225, a25
    v_accvgpr_read_b32 v226, a26
    v_accvgpr_read_b32 v227, a27
    v_mul_f32 v224, v224, v220
    v_mul_f32 v225, v225, v220
    v_mul_f32 v226, v226, v220
    v_mul_f32 v227, v227, v220
    v_accvgpr_write_b32 a24, v224
    v_accvgpr_write_b32 a25, v225
    v_accvgpr_write_b32 a26, v226
    v_accvgpr_write_b32 a27, v227
    v_accvgpr_read_b32 v224, a40
    v_accvgpr_read_b32 v225, a41
    v_accvgpr_read_b32 v226, a42
    v_accvgpr_read_b32 v227, a43
    v_mul_f32 v224, v224, v220
    v_mul_f32 v225, v225, v220
    v_mul_f32 v226, v226, v220
    v_mul_f32 v227, v227, v220
    v_accvgpr_write_b32 a40, v224
    v_accvgpr_write_b32 a41, v225
    v_accvgpr_write_b32 a42, v226
    v_accvgpr_write_b32 a43, v227
    v_accvgpr_read_b32 v224, a56
    v_accvgpr_read_b32 v225, a57
    v_accvgpr_read_b32 v226, a58
    v_accvgpr_read_b32 v227, a59
    v_mul_f32 v224, v224, v220
    v_mul_f32 v225, v225, v220
    v_mul_f32 v226, v226, v220
    v_mul_f32 v227, v227, v220
    v_accvgpr_write_b32 a56, v224
    v_accvgpr_write_b32 a57, v225
    v_accvgpr_write_b32 a58, v226
    v_accvgpr_write_b32 a59, v227
    v_accvgpr_read_b32 v224, a72
    v_accvgpr_read_b32 v225, a73
    v_accvgpr_read_b32 v226, a74
    v_accvgpr_read_b32 v227, a75
    v_mul_f32 v224, v224, v220
    v_mul_f32 v225, v225, v220
    v_mul_f32 v226, v226, v220
    v_mul_f32 v227, v227, v220
    v_accvgpr_write_b32 a72, v224
    v_accvgpr_write_b32 a73, v225
    v_accvgpr_write_b32 a74, v226
    v_accvgpr_write_b32 a75, v227
    v_accvgpr_read_b32 v224, a88
    v_accvgpr_read_b32 v225, a89
    v_accvgpr_read_b32 v226, a90
    v_accvgpr_read_b32 v227, a91
    v_mul_f32 v224, v224, v220
    v_mul_f32 v225, v225, v220
    v_mul_f32 v226, v226, v220
    v_mul_f32 v227, v227, v220
    v_accvgpr_write_b32 a88, v224
    v_accvgpr_write_b32 a89, v225
    v_accvgpr_write_b32 a90, v226
    v_accvgpr_write_b32 a91, v227
    v_accvgpr_read_b32 v224, a104
    v_accvgpr_read_b32 v225, a105
    v_accvgpr_read_b32 v226, a106
    v_accvgpr_read_b32 v227, a107
    v_mul_f32 v224, v224, v220
    v_mul_f32 v225, v225, v220
    v_mul_f32 v226, v226, v220
    v_mul_f32 v227, v227, v220
    v_accvgpr_write_b32 a104, v224
    v_accvgpr_write_b32 a105, v225
    v_accvgpr_write_b32 a106, v226
    v_accvgpr_write_b32 a107, v227
    v_accvgpr_read_b32 v224, a120
    v_accvgpr_read_b32 v225, a121
    v_accvgpr_read_b32 v226, a122
    v_accvgpr_read_b32 v227, a123
    v_mul_f32 v224, v224, v220
    v_mul_f32 v225, v225, v220
    v_mul_f32 v226, v226, v220
    v_mul_f32 v227, v227, v220
    v_accvgpr_write_b32 a120, v224
    v_accvgpr_write_b32 a121, v225
    v_accvgpr_write_b32 a122, v226
    v_accvgpr_write_b32 a123, v227
    v_add_f32 v218, v218, v124
    v_add_f32 v218, v218, v125
    v_add_f32 v218, v218, v126
    v_add_f32 v218, v218, v127
    v_add_f32 v218, v218, v140
    v_add_f32 v218, v218, v141
    v_add_f32 v218, v218, v142
    v_add_f32 v218, v218, v143
    v_cvt_pk_bf16_f32 v188, v124, v125
    v_cvt_pk_bf16_f32 v189, v126, v127
    v_cvt_pk_bf16_f32 v190, v140, v141
    v_cvt_pk_bf16_f32 v191, v142, v143
    s_nop 1
    v_mfma_f32_16x16x32_bf16 a[8:11], v[196:199], v[188:191], a[8:11]
    v_mfma_f32_16x16x32_bf16 a[24:27], v[200:203], v[188:191], a[24:27]
    v_mfma_f32_16x16x32_bf16 a[40:43], v[204:207], v[188:191], a[40:43]
    v_mfma_f32_16x16x32_bf16 a[56:59], v[208:211], v[188:191], a[56:59]
    v_mfma_f32_16x16x32_bf16 a[72:75], v[228:231], v[188:191], a[72:75]
    v_mfma_f32_16x16x32_bf16 a[88:91], v[232:235], v[188:191], a[88:91]
    v_mfma_f32_16x16x32_bf16 a[104:107], v[236:239], v[188:191], a[104:107]
    v_mfma_f32_16x16x32_bf16 a[120:123], v[240:243], v[188:191], a[120:123]
    v_max3_f32 v224, v128, v129, v130
    v_max3_f32 v224, v224, v131, v144
    v_max3_f32 v224, v224, v145, v146
    v_max3_f32 v224, v224, v147, v215
    v_mov_b32 v225, v224
    s_nop 1
    v_permlane32_swap_b32 v224, v225
    v_max_f32 v224, v224, v225
    v_mov_b32 v225, v224
    s_nop 1
    v_permlane16_swap_b32 v224, v225
    v_max_f32 v224, v224, v225
    v_sub_f32 v220, v215, v224
    v_exp_f32 v220, v220
    v_mov_b32 v215, v224
    v_sub_f32 v128, v128, v224
    v_sub_f32 v129, v129, v224
    v_sub_f32 v130, v130, v224
    v_sub_f32 v131, v131, v224
    v_sub_f32 v144, v144, v224
    v_sub_f32 v145, v145, v224
    v_sub_f32 v146, v146, v224
    v_sub_f32 v147, v147, v224
    v_mul_f32 v219, v219, v220
    v_exp_f32 v128, v128
    v_exp_f32 v129, v129
    v_exp_f32 v130, v130
    v_exp_f32 v131, v131
    v_exp_f32 v144, v144
    v_exp_f32 v145, v145
    v_exp_f32 v146, v146
    v_exp_f32 v147, v147
    v_accvgpr_read_b32 v224, a12
    v_accvgpr_read_b32 v225, a13
    v_accvgpr_read_b32 v226, a14
    v_accvgpr_read_b32 v227, a15
    v_mul_f32 v224, v224, v220
    v_mul_f32 v225, v225, v220
    v_mul_f32 v226, v226, v220
    v_mul_f32 v227, v227, v220
    v_accvgpr_write_b32 a12, v224
    v_accvgpr_write_b32 a13, v225
    v_accvgpr_write_b32 a14, v226
    v_accvgpr_write_b32 a15, v227
    v_accvgpr_read_b32 v224, a28
    v_accvgpr_read_b32 v225, a29
    v_accvgpr_read_b32 v226, a30
    v_accvgpr_read_b32 v227, a31
    v_mul_f32 v224, v224, v220
    v_mul_f32 v225, v225, v220
    v_mul_f32 v226, v226, v220
    v_mul_f32 v227, v227, v220
    v_accvgpr_write_b32 a28, v224
    v_accvgpr_write_b32 a29, v225
    v_accvgpr_write_b32 a30, v226
    v_accvgpr_write_b32 a31, v227
    v_accvgpr_read_b32 v224, a44
    v_accvgpr_read_b32 v225, a45
    v_accvgpr_read_b32 v226, a46
    v_accvgpr_read_b32 v227, a47
    v_mul_f32 v224, v224, v220
    v_mul_f32 v225, v225, v220
    v_mul_f32 v226, v226, v220
    v_mul_f32 v227, v227, v220
    v_accvgpr_write_b32 a44, v224
    v_accvgpr_write_b32 a45, v225
    v_accvgpr_write_b32 a46, v226
    v_accvgpr_write_b32 a47, v227
    v_accvgpr_read_b32 v224, a60
    v_accvgpr_read_b32 v225, a61
    v_accvgpr_read_b32 v226, a62
    v_accvgpr_read_b32 v227, a63
    v_mul_f32 v224, v224, v220
    v_mul_f32 v225, v225, v220
    v_mul_f32 v226, v226, v220
    v_mul_f32 v227, v227, v220
    v_accvgpr_write_b32 a60, v224
    v_accvgpr_write_b32 a61, v225
    v_accvgpr_write_b32 a62, v226
    v_accvgpr_write_b32 a63, v227
    v_accvgpr_read_b32 v224, a76
    v_accvgpr_read_b32 v225, a77
    v_accvgpr_read_b32 v226, a78
    v_accvgpr_read_b32 v227, a79
    v_mul_f32 v224, v224, v220
    v_mul_f32 v225, v225, v220
    v_mul_f32 v226, v226, v220
    v_mul_f32 v227, v227, v220
    v_accvgpr_write_b32 a76, v224
    v_accvgpr_write_b32 a77, v225
    v_accvgpr_write_b32 a78, v226
    v_accvgpr_write_b32 a79, v227
    v_accvgpr_read_b32 v224, a92
    v_accvgpr_read_b32 v225, a93
    v_accvgpr_read_b32 v226, a94
    v_accvgpr_read_b32 v227, a95
    v_mul_f32 v224, v224, v220
    v_mul_f32 v225, v225, v220
    v_mul_f32 v226, v226, v220
    v_mul_f32 v227, v227, v220
    v_accvgpr_write_b32 a92, v224
    v_accvgpr_write_b32 a93, v225
    v_accvgpr_write_b32 a94, v226
    v_accvgpr_write_b32 a95, v227
    v_accvgpr_read_b32 v224, a108
    v_accvgpr_read_b32 v225, a109
    v_accvgpr_read_b32 v226, a110
    v_accvgpr_read_b32 v227, a111
    v_mul_f32 v224, v224, v220
    v_mul_f32 v225, v225, v220
    v_mul_f32 v226, v226, v220
    v_mul_f32 v227, v227, v220
    v_accvgpr_write_b32 a108, v224
    v_accvgpr_write_b32 a109, v225
    v_accvgpr_write_b32 a110, v226
    v_accvgpr_write_b32 a111, v227
    v_accvgpr_read_b32 v224, a124
    v_accvgpr_read_b32 v225, a125
    v_accvgpr_read_b32 v226, a126
    v_accvgpr_read_b32 v227, a127
    v_mul_f32 v224, v224, v220
    v_mul_f32 v225, v225, v220
    v_mul_f32 v226, v226, v220
    v_mul_f32 v227, v227, v220
    v_accvgpr_write_b32 a124, v224
    v_accvgpr_write_b32 a125, v225
    v_accvgpr_write_b32 a126, v226
    v_accvgpr_write_b32 a127, v227
    v_add_f32 v219, v219, v128
    v_add_f32 v219, v219, v129
    v_add_f32 v219, v219, v130
    v_add_f32 v219, v219, v131
    v_add_f32 v219, v219, v144
    v_add_f32 v219, v219, v145
    v_add_f32 v219, v219, v146
    v_add_f32 v219, v219, v147
    v_cvt_pk_bf16_f32 v192, v128, v129
    v_cvt_pk_bf16_f32 v193, v130, v131
    v_cvt_pk_bf16_f32 v194, v144, v145
    v_cvt_pk_bf16_f32 v195, v146, v147
    s_nop 1
    v_mfma_f32_16x16x32_bf16 a[12:15], v[196:199], v[192:195], a[12:15]
    v_mfma_f32_16x16x32_bf16 a[28:31], v[200:203], v[192:195], a[28:31]
    v_mfma_f32_16x16x32_bf16 a[44:47], v[204:207], v[192:195], a[44:47]
    v_mfma_f32_16x16x32_bf16 a[60:63], v[208:211], v[192:195], a[60:63]
    v_mfma_f32_16x16x32_bf16 a[76:79], v[228:231], v[192:195], a[76:79]
    v_mfma_f32_16x16x32_bf16 a[92:95], v[232:235], v[192:195], a[92:95]
    v_mfma_f32_16x16x32_bf16 a[108:111], v[236:239], v[192:195], a[108:111]
    v_mfma_f32_16x16x32_bf16 a[124:127], v[240:243], v[192:195], a[124:127]
    s_add_u32 s28, s28, 8192
    s_cmp_lt_u32 s28, 524288
    s_cbranch_scc1 L_slow_loop
    v_mov_b32 v224, v216
    s_nop 1
    v_permlane32_swap_b32 v216, v224
    v_add_f32 v216, v216, v224
    v_mov_b32 v224, v216
    s_nop 1
    v_permlane16_swap_b32 v216, v224
    v_add_f32 v216, v216, v224
    v_rcp_f32 v100, v216
    v_mov_b32 v224, v217
    s_nop 1
    v_permlane32_swap_b32 v217, v224
    v_add_f32 v217, v217, v224
    v_mov_b32 v224, v217
    s_nop 1
    v_permlane16_swap_b32 v217, v224
    v_add_f32 v217, v217, v224
    v_rcp_f32 v101, v217
    v_mov_b32 v224, v218
    s_nop 1
    v_permlane32_swap_b32 v218, v224
    v_add_f32 v218, v218, v224
    v_mov_b32 v224, v218
    s_nop 1
    v_permlane16_swap_b32 v218, v224
    v_add_f32 v218, v218, v224
    v_rcp_f32 v102, v218
    v_mov_b32 v224, v219
    s_nop 1
    v_permlane32_swap_b32 v219, v224
    v_add_f32 v219, v219, v224
    v_mov_b32 v224, v219
    s_nop 1
    v_permlane16_swap_b32 v219, v224
    v_add_f32 v219, v219, v224
    v_rcp_f32 v103, v219
    s_mov_b32 s36, 0
    v_accvgpr_read_b32 v120, a0
    v_accvgpr_read_b32 v121, a1
    v_accvgpr_read_b32 v122, a2
    v_accvgpr_read_b32 v123, a3
    v_accvgpr_read_b32 v124, a16
    v_accvgpr_read_b32 v125, a17
    v_accvgpr_read_b32 v126, a18
    v_accvgpr_read_b32 v127, a19
    v_mul_f32 v120, v120, v100
    v_mul_f32 v121, v121, v100
    v_mul_f32 v122, v122, v100
    v_mul_f32 v123, v123, v100
    v_mul_f32 v124, v124, v100
    v_mul_f32 v125, v125, v100
    v_mul_f32 v126, v126, v100
    v_mul_f32 v127, v127, v100
    v_cvt_pk_bf16_f32 v152, v120, v121
    v_cvt_pk_bf16_f32 v153, v122, v123
    v_cvt_pk_bf16_f32 v154, v124, v125
    v_cvt_pk_bf16_f32 v155, v126, v127
    buffer_store_dwordx4 v[152:155], v110, s[24:27], s36 offen offset:0 sc1
    v_accvgpr_read_b32 v128, a4
    v_accvgpr_read_b32 v129, a5
    v_accvgpr_read_b32 v130, a6
    v_accvgpr_read_b32 v131, a7
    v_accvgpr_read_b32 v132, a20
    v_accvgpr_read_b32 v133, a21
    v_accvgpr_read_b32 v134, a22
    v_accvgpr_read_b32 v135, a23
    v_mul_f32 v128, v128, v101
    v_mul_f32 v129, v129, v101
    v_mul_f32 v130, v130, v101
    v_mul_f32 v131, v131, v101
    v_mul_f32 v132, v132, v101
    v_mul_f32 v133, v133, v101
    v_mul_f32 v134, v134, v101
    v_mul_f32 v135, v135, v101
    v_cvt_pk_bf16_f32 v156, v128, v129
    v_cvt_pk_bf16_f32 v157, v130, v131
    v_cvt_pk_bf16_f32 v158, v132, v133
    v_cvt_pk_bf16_f32 v159, v134, v135
    buffer_store_dwordx4 v[156:159], v110, s[24:27], s36 offen offset:1024 sc1
    v_accvgpr_read_b32 v136, a8
    v_accvgpr_read_b32 v137, a9
    v_accvgpr_read_b32 v138, a10
    v_accvgpr_read_b32 v139, a11
    v_accvgpr_read_b32 v140, a24
    v_accvgpr_read_b32 v141, a25
    v_accvgpr_read_b32 v142, a26
    v_accvgpr_read_b32 v143, a27
    v_mul_f32 v136, v136, v102
    v_mul_f32 v137, v137, v102
    v_mul_f32 v138, v138, v102
    v_mul_f32 v139, v139, v102
    v_mul_f32 v140, v140, v102
    v_mul_f32 v141, v141, v102
    v_mul_f32 v142, v142, v102
    v_mul_f32 v143, v143, v102
    v_cvt_pk_bf16_f32 v160, v136, v137
    v_cvt_pk_bf16_f32 v161, v138, v139
    v_cvt_pk_bf16_f32 v162, v140, v141
    v_cvt_pk_bf16_f32 v163, v142, v143
    buffer_store_dwordx4 v[160:163], v110, s[24:27], s36 offen offset:2048 sc1
    v_accvgpr_read_b32 v144, a12
    v_accvgpr_read_b32 v145, a13
    v_accvgpr_read_b32 v146, a14
    v_accvgpr_read_b32 v147, a15
    v_accvgpr_read_b32 v148, a28
    v_accvgpr_read_b32 v149, a29
    v_accvgpr_read_b32 v150, a30
    v_accvgpr_read_b32 v151, a31
    v_mul_f32 v144, v144, v103
    v_mul_f32 v145, v145, v103
    v_mul_f32 v146, v146, v103
    v_mul_f32 v147, v147, v103
    v_mul_f32 v148, v148, v103
    v_mul_f32 v149, v149, v103
    v_mul_f32 v150, v150, v103
    v_mul_f32 v151, v151, v103
    v_cvt_pk_bf16_f32 v164, v144, v145
    v_cvt_pk_bf16_f32 v165, v146, v147
    v_cvt_pk_bf16_f32 v166, v148, v149
    v_cvt_pk_bf16_f32 v167, v150, v151
    buffer_store_dwordx4 v[164:167], v110, s[24:27], s36 offen offset:3072 sc1
    s_mov_b32 s36, 4096
    v_accvgpr_read_b32 v120, a32
    v_accvgpr_read_b32 v121, a33
    v_accvgpr_read_b32 v122, a34
    v_accvgpr_read_b32 v123, a35
    v_accvgpr_read_b32 v124, a48
    v_accvgpr_read_b32 v125, a49
    v_accvgpr_read_b32 v126, a50
    v_accvgpr_read_b32 v127, a51
    v_mul_f32 v120, v120, v100
    v_mul_f32 v121, v121, v100
    v_mul_f32 v122, v122, v100
    v_mul_f32 v123, v123, v100
    v_mul_f32 v124, v124, v100
    v_mul_f32 v125, v125, v100
    v_mul_f32 v126, v126, v100
    v_mul_f32 v127, v127, v100
    v_cvt_pk_bf16_f32 v152, v120, v121
    v_cvt_pk_bf16_f32 v153, v122, v123
    v_cvt_pk_bf16_f32 v154, v124, v125
    v_cvt_pk_bf16_f32 v155, v126, v127
    buffer_store_dwordx4 v[152:155], v110, s[24:27], s36 offen offset:0 sc1
    v_accvgpr_read_b32 v128, a36
    v_accvgpr_read_b32 v129, a37
    v_accvgpr_read_b32 v130, a38
    v_accvgpr_read_b32 v131, a39
    v_accvgpr_read_b32 v132, a52
    v_accvgpr_read_b32 v133, a53
    v_accvgpr_read_b32 v134, a54
    v_accvgpr_read_b32 v135, a55
    v_mul_f32 v128, v128, v101
    v_mul_f32 v129, v129, v101
    v_mul_f32 v130, v130, v101
    v_mul_f32 v131, v131, v101
    v_mul_f32 v132, v132, v101
    v_mul_f32 v133, v133, v101
    v_mul_f32 v134, v134, v101
    v_mul_f32 v135, v135, v101
    v_cvt_pk_bf16_f32 v156, v128, v129
    v_cvt_pk_bf16_f32 v157, v130, v131
    v_cvt_pk_bf16_f32 v158, v132, v133
    v_cvt_pk_bf16_f32 v159, v134, v135
    buffer_store_dwordx4 v[156:159], v110, s[24:27], s36 offen offset:1024 sc1
    v_accvgpr_read_b32 v136, a40
    v_accvgpr_read_b32 v137, a41
    v_accvgpr_read_b32 v138, a42
    v_accvgpr_read_b32 v139, a43
    v_accvgpr_read_b32 v140, a56
    v_accvgpr_read_b32 v141, a57
    v_accvgpr_read_b32 v142, a58
    v_accvgpr_read_b32 v143, a59
    v_mul_f32 v136, v136, v102
    v_mul_f32 v137, v137, v102
    v_mul_f32 v138, v138, v102
    v_mul_f32 v139, v139, v102
    v_mul_f32 v140, v140, v102
    v_mul_f32 v141, v141, v102
    v_mul_f32 v142, v142, v102
    v_mul_f32 v143, v143, v102
    v_cvt_pk_bf16_f32 v160, v136, v137
    v_cvt_pk_bf16_f32 v161, v138, v139
    v_cvt_pk_bf16_f32 v162, v140, v141
    v_cvt_pk_bf16_f32 v163, v142, v143
    buffer_store_dwordx4 v[160:163], v110, s[24:27], s36 offen offset:2048 sc1
    v_accvgpr_read_b32 v144, a44
    v_accvgpr_read_b32 v145, a45
    v_accvgpr_read_b32 v146, a46
    v_accvgpr_read_b32 v147, a47
    v_accvgpr_read_b32 v148, a60
    v_accvgpr_read_b32 v149, a61
    v_accvgpr_read_b32 v150, a62
    v_accvgpr_read_b32 v151, a63
    v_mul_f32 v144, v144, v103
    v_mul_f32 v145, v145, v103
    v_mul_f32 v146, v146, v103
    v_mul_f32 v147, v147, v103
    v_mul_f32 v148, v148, v103
    v_mul_f32 v149, v149, v103
    v_mul_f32 v150, v150, v103
    v_mul_f32 v151, v151, v103
    v_cvt_pk_bf16_f32 v164, v144, v145
    v_cvt_pk_bf16_f32 v165, v146, v147
    v_cvt_pk_bf16_f32 v166, v148, v149
    v_cvt_pk_bf16_f32 v167, v150, v151
    buffer_store_dwordx4 v[164:167], v110, s[24:27], s36 offen offset:3072 sc1
    s_mov_b32 s36, 8192
    v_accvgpr_read_b32 v120, a64
    v_accvgpr_read_b32 v121, a65
    v_accvgpr_read_b32 v122, a66
    v_accvgpr_read_b32 v123, a67
    v_accvgpr_read_b32 v124, a80
    v_accvgpr_read_b32 v125, a81
    v_accvgpr_read_b32 v126, a82
    v_accvgpr_read_b32 v127, a83
    v_mul_f32 v120, v120, v100
    v_mul_f32 v121, v121, v100
    v_mul_f32 v122, v122, v100
    v_mul_f32 v123, v123, v100
    v_mul_f32 v124, v124, v100
    v_mul_f32 v125, v125, v100
    v_mul_f32 v126, v126, v100
    v_mul_f32 v127, v127, v100
    v_cvt_pk_bf16_f32 v152, v120, v121
    v_cvt_pk_bf16_f32 v153, v122, v123
    v_cvt_pk_bf16_f32 v154, v124, v125
    v_cvt_pk_bf16_f32 v155, v126, v127
    buffer_store_dwordx4 v[152:155], v110, s[24:27], s36 offen offset:0 sc1
    v_accvgpr_read_b32 v128, a68
    v_accvgpr_read_b32 v129, a69
    v_accvgpr_read_b32 v130, a70
    v_accvgpr_read_b32 v131, a71
    v_accvgpr_read_b32 v132, a84
    v_accvgpr_read_b32 v133, a85
    v_accvgpr_read_b32 v134, a86
    v_accvgpr_read_b32 v135, a87
    v_mul_f32 v128, v128, v101
    v_mul_f32 v129, v129, v101
    v_mul_f32 v130, v130, v101
    v_mul_f32 v131, v131, v101
    v_mul_f32 v132, v132, v101
    v_mul_f32 v133, v133, v101
    v_mul_f32 v134, v134, v101
    v_mul_f32 v135, v135, v101
    v_cvt_pk_bf16_f32 v156, v128, v129
    v_cvt_pk_bf16_f32 v157, v130, v131
    v_cvt_pk_bf16_f32 v158, v132, v133
    v_cvt_pk_bf16_f32 v159, v134, v135
    buffer_store_dwordx4 v[156:159], v110, s[24:27], s36 offen offset:1024 sc1
    v_accvgpr_read_b32 v136, a72
    v_accvgpr_read_b32 v137, a73
    v_accvgpr_read_b32 v138, a74
    v_accvgpr_read_b32 v139, a75
    v_accvgpr_read_b32 v140, a88
    v_accvgpr_read_b32 v141, a89
    v_accvgpr_read_b32 v142, a90
    v_accvgpr_read_b32 v143, a91
    v_mul_f32 v136, v136, v102
    v_mul_f32 v137, v137, v102
    v_mul_f32 v138, v138, v102
    v_mul_f32 v139, v139, v102
    v_mul_f32 v140, v140, v102
    v_mul_f32 v141, v141, v102
    v_mul_f32 v142, v142, v102
    v_mul_f32 v143, v143, v102
    v_cvt_pk_bf16_f32 v160, v136, v137
    v_cvt_pk_bf16_f32 v161, v138, v139
    v_cvt_pk_bf16_f32 v162, v140, v141
    v_cvt_pk_bf16_f32 v163, v142, v143
    buffer_store_dwordx4 v[160:163], v110, s[24:27], s36 offen offset:2048 sc1
    v_accvgpr_read_b32 v144, a76
    v_accvgpr_read_b32 v145, a77
    v_accvgpr_read_b32 v146, a78
    v_accvgpr_read_b32 v147, a79
    v_accvgpr_read_b32 v148, a92
    v_accvgpr_read_b32 v149, a93
    v_accvgpr_read_b32 v150, a94
    v_accvgpr_read_b32 v151, a95
    v_mul_f32 v144, v144, v103
    v_mul_f32 v145, v145, v103
    v_mul_f32 v146, v146, v103
    v_mul_f32 v147, v147, v103
    v_mul_f32 v148, v148, v103
    v_mul_f32 v149, v149, v103
    v_mul_f32 v150, v150, v103
    v_mul_f32 v151, v151, v103
    v_cvt_pk_bf16_f32 v164, v144, v145
    v_cvt_pk_bf16_f32 v165, v146, v147
    v_cvt_pk_bf16_f32 v166, v148, v149
    v_cvt_pk_bf16_f32 v167, v150, v151
    buffer_store_dwordx4 v[164:167], v110, s[24:27], s36 offen offset:3072 sc1
    s_mov_b32 s36, 12288
    v_accvgpr_read_b32 v120, a96
    v_accvgpr_read_b32 v121, a97
    v_accvgpr_read_b32 v122, a98
    v_accvgpr_read_b32 v123, a99
    v_accvgpr_read_b32 v124, a112
    v_accvgpr_read_b32 v125, a113
    v_accvgpr_read_b32 v126, a114
    v_accvgpr_read_b32 v127, a115
    v_mul_f32 v120, v120, v100
    v_mul_f32 v121, v121, v100
    v_mul_f32 v122, v122, v100
    v_mul_f32 v123, v123, v100
    v_mul_f32 v124, v124, v100
    v_mul_f32 v125, v125, v100
    v_mul_f32 v126, v126, v100
    v_mul_f32 v127, v127, v100
    v_cvt_pk_bf16_f32 v152, v120, v121
    v_cvt_pk_bf16_f32 v153, v122, v123
    v_cvt_pk_bf16_f32 v154, v124, v125
    v_cvt_pk_bf16_f32 v155, v126, v127
    buffer_store_dwordx4 v[152:155], v110, s[24:27], s36 offen offset:0 sc1
    v_accvgpr_read_b32 v128, a100
    v_accvgpr_read_b32 v129, a101
    v_accvgpr_read_b32 v130, a102
    v_accvgpr_read_b32 v131, a103
    v_accvgpr_read_b32 v132, a116
    v_accvgpr_read_b32 v133, a117
    v_accvgpr_read_b32 v134, a118
    v_accvgpr_read_b32 v135, a119
    v_mul_f32 v128, v128, v101
    v_mul_f32 v129, v129, v101
    v_mul_f32 v130, v130, v101
    v_mul_f32 v131, v131, v101
    v_mul_f32 v132, v132, v101
    v_mul_f32 v133, v133, v101
    v_mul_f32 v134, v134, v101
    v_mul_f32 v135, v135, v101
    v_cvt_pk_bf16_f32 v156, v128, v129
    v_cvt_pk_bf16_f32 v157, v130, v131
    v_cvt_pk_bf16_f32 v158, v132, v133
    v_cvt_pk_bf16_f32 v159, v134, v135
    buffer_store_dwordx4 v[156:159], v110, s[24:27], s36 offen offset:1024 sc1
    v_accvgpr_read_b32 v136, a104
    v_accvgpr_read_b32 v137, a105
    v_accvgpr_read_b32 v138, a106
    v_accvgpr_read_b32 v139, a107
    v_accvgpr_read_b32 v140, a120
    v_accvgpr_read_b32 v141, a121
    v_accvgpr_read_b32 v142, a122
    v_accvgpr_read_b32 v143, a123
    v_mul_f32 v136, v136, v102
    v_mul_f32 v137, v137, v102
    v_mul_f32 v138, v138, v102
    v_mul_f32 v139, v139, v102
    v_mul_f32 v140, v140, v102
    v_mul_f32 v141, v141, v102
    v_mul_f32 v142, v142, v102
    v_mul_f32 v143, v143, v102
    v_cvt_pk_bf16_f32 v160, v136, v137
    v_cvt_pk_bf16_f32 v161, v138, v139
    v_cvt_pk_bf16_f32 v162, v140, v141
    v_cvt_pk_bf16_f32 v163, v142, v143
    buffer_store_dwordx4 v[160:163], v110, s[24:27], s36 offen offset:2048 sc1
    v_accvgpr_read_b32 v144, a108
    v_accvgpr_read_b32 v145, a109
    v_accvgpr_read_b32 v146, a110
    v_accvgpr_read_b32 v147, a111
    v_accvgpr_read_b32 v148, a124
    v_accvgpr_read_b32 v149, a125
    v_accvgpr_read_b32 v150, a126
    v_accvgpr_read_b32 v151, a127
    v_mul_f32 v144, v144, v103
    v_mul_f32 v145, v145, v103
    v_mul_f32 v146, v146, v103
    v_mul_f32 v147, v147, v103
    v_mul_f32 v148, v148, v103
    v_mul_f32 v149, v149, v103
    v_mul_f32 v150, v150, v103
    v_mul_f32 v151, v151, v103
    v_cvt_pk_bf16_f32 v164, v144, v145
    v_cvt_pk_bf16_f32 v165, v146, v147
    v_cvt_pk_bf16_f32 v166, v148, v149
    v_cvt_pk_bf16_f32 v167, v150, v151
    buffer_store_dwordx4 v[164:167], v110, s[24:27], s36 offen offset:3072 sc1
    s_mov_b32 s45, 61440
    buffer_load_dwordx4 a[0:3], v114, s[20:23], s45 offen offset:1024 sc1
    s_mov_b32 s45, 61440
    buffer_load_dwordx4 a[4:7], v114, s[20:23], s45 offen offset:2048 sc1
    s_mov_b32 s45, 61440
    buffer_load_dwordx4 a[8:11], v114, s[20:23], s45 offen offset:3072 sc1
    s_mov_b32 s45, 61440
    buffer_load_dwordx4 a[12:15], v115, s[20:23], s45 offen offset:0 sc1
    s_mov_b32 s45, 81920
    buffer_load_dwordx4 a[16:19], v114, s[20:23], s45 offen offset:0 sc1
    s_mov_b32 s45, 81920
    buffer_load_dwordx4 a[20:23], v114, s[20:23], s45 offen offset:1024 sc1
    s_mov_b32 s45, 81920
    buffer_load_dwordx4 a[24:27], v114, s[20:23], s45 offen offset:2048 sc1
    s_mov_b32 s45, 81920
    buffer_load_dwordx4 a[28:31], v114, s[20:23], s45 offen offset:3072 sc1
    s_mov_b32 s45, 81920
    buffer_load_dwordx4 a[32:35], v115, s[20:23], s45 offen offset:0 sc1
    s_mov_b32 s45, 102400
    buffer_load_dwordx4 a[36:39], v114, s[20:23], s45 offen offset:0 sc1
    s_mov_b32 s45, 102400
    buffer_load_dwordx4 a[40:43], v114, s[20:23], s45 offen offset:1024 sc1
    s_mov_b32 s45, 102400
    buffer_load_dwordx4 a[44:47], v114, s[20:23], s45 offen offset:2048 sc1
    s_mov_b32 s45, 102400
    buffer_load_dwordx4 a[48:51], v114, s[20:23], s45 offen offset:3072 sc1
    s_mov_b32 s45, 102400
    buffer_load_dwordx4 a[52:55], v115, s[20:23], s45 offen offset:0 sc1
    s_mov_b32 s45, 122880
    buffer_load_dwordx4 a[56:59], v114, s[20:23], s45 offen offset:0 sc1
    s_mov_b32 s45, 122880
    buffer_load_dwordx4 a[60:63], v114, s[20:23], s45 offen offset:1024 sc1
    s_mov_b32 s45, 122880
    buffer_load_dwordx4 a[64:67], v114, s[20:23], s45 offen offset:2048 sc1
    s_mov_b32 s45, 122880
    buffer_load_dwordx4 a[68:71], v114, s[20:23], s45 offen offset:3072 sc1
    s_mov_b32 s45, 122880
    buffer_load_dwordx4 a[72:75], v115, s[20:23], s45 offen offset:0 sc1
    s_mov_b32 s45, 143360
    buffer_load_dwordx4 a[76:79], v114, s[20:23], s45 offen offset:0 sc1
    s_mov_b32 s45, 143360
    buffer_load_dwordx4 a[80:83], v114, s[20:23], s45 offen offset:1024 sc1
    s_mov_b32 s45, 143360
    buffer_load_dwordx4 a[84:87], v114, s[20:23], s45 offen offset:2048 sc1
    s_mov_b32 s45, 143360
    buffer_load_dwordx4 a[88:91], v114, s[20:23], s45 offen offset:3072 sc1
    s_mov_b32 s45, 143360
    buffer_load_dwordx4 a[92:95], v115, s[20:23], s45 offen offset:0 sc1
    s_waitcnt vmcnt(0)
    s_branch L_published
L_spin_rows:
    s_mov_b32 s7, 32768
L_retry_rows:
    s_sleep 2
    buffer_load_dword v252, off, s[92:95], s74 sc1
    s_waitcnt vmcnt(0)
    v_cmp_gt_u32 vcc, 32, v252
    s_and_b64 vcc, vcc, exec
    s_cbranch_scc0 L_back_rows
    s_sub_u32 s7, s7, 1
    s_cbranch_scc0 L_retry_rows
    s_branch L_back_rows
L_spin_all:
    s_mov_b32 s7, 32768
L_retry_all:
    s_sleep 2
    buffer_load_dword v252, v253, s[92:95], 0 offen sc1
    s_waitcnt vmcnt(0)
    v_cmp_gt_u32 vcc, 32, v252
    s_and_b64 vcc, vcc, exec
    s_cbranch_scc0 L_back_all
    s_sub_u32 s7, s7, 1
    s_cbranch_scc0 L_retry_all
    s_branch L_back_all
L_rt_keys:
    s_lshl_b32 s40, s5, 13
    s_add_u32 s40, s40, 0x280008
    v_lshlrev_b32 v253, 4, v19
    buffer_load_dword v28, v253, s[76:79], s40 offen offset:0 sc1
    buffer_load_dword v29, v253, s[76:79], s40 offen offset:1024 sc1
    buffer_load_dword v30, v253, s[76:79], s40 offen offset:2048 sc1
    buffer_load_dword v31, v253, s[76:79], s40 offen offset:3072 sc1
    s_add_u32 s40, s40, 4096
    buffer_load_dword v32, v253, s[76:79], s40 offen offset:0 sc1
    buffer_load_dword v33, v253, s[76:79], s40 offen offset:1024 sc1
    buffer_load_dword v34, v253, s[76:79], s40 offen offset:2048 sc1
    buffer_load_dword v35, v253, s[76:79], s40 offen offset:3072 sc1
    s_branch L_rt_back_keys
L_rt_local:
    s_waitcnt vmcnt(11)
    s_mov_b32 s42, -1
    v_sub_u32 v20, s42, v28
    v_sub_u32 v21, s42, v29
    v_sub_u32 v22, s42, v30
    v_min3_u32 v20, v20, v21, v22
    v_sub_u32 v21, s42, v31
    v_sub_u32 v22, s42, v32
    v_min3_u32 v20, v20, v21, v22
    v_sub_u32 v21, s42, v33
    v_sub_u32 v22, s42, v34
    v_min3_u32 v20, v20, v21, v22
    v_sub_u32 v21, s42, v35
    v_min_u32 v20, v20, v21
    s_nop 1
    v_min_u32_dpp v20, v20, v20 row_shr:1 row_mask:0xf bank_mask:0xf
    s_nop 1
    v_min_u32_dpp v20, v20, v20 row_shr:2 row_mask:0xf bank_mask:0xf
    s_nop 1
    v_min_u32_dpp v20, v20, v20 row_shr:4 row_mask:0xf bank_mask:0xf
    s_nop 1
    v_min_u32_dpp v20, v20, v20 row_shr:8 row_mask:0xf bank_mask:0xf
    s_nop 1
    v_min_u32_dpp v20, v20, v20 row_bcast:15 row_mask:0xa bank_mask:0xf
    s_nop 1
    v_min_u32_dpp v20, v20, v20 row_bcast:31 row_mask:0xc bank_mask:0xf
    s_nop 0
    v_readlane_b32 s50, v20, 63
    s_sub_u32 s50, s42, s50
    s_sub_u32 s42, s50, 1
    v_sub_u32 v20, s42, v28
    v_sub_u32 v21, s42, v29
    v_sub_u32 v22, s42, v30
    v_min3_u32 v20, v20, v21, v22
    v_sub_u32 v21, s42, v31
    v_sub_u32 v22, s42, v32
    v_min3_u32 v20, v20, v21, v22
    v_sub_u32 v21, s42, v33
    v_sub_u32 v22, s42, v34
    v_min3_u32 v20, v20, v21, v22
    v_sub_u32 v21, s42, v35
    v_min_u32 v20, v20, v21
    s_nop 1
    v_min_u32_dpp v20, v20, v20 row_shr:1 row_mask:0xf bank_mask:0xf
    s_nop 1
    v_min_u32_dpp v20, v20, v20 row_shr:2 row_mask:0xf bank_mask:0xf
    s_nop 1
    v_min_u32_dpp v20, v20, v20 row_shr:4 row_mask:0xf bank_mask:0xf
    s_nop 1
    v_min_u32_dpp v20, v20, v20 row_shr:8 row_mask:0xf bank_mask:0xf
    s_nop 1
    v_min_u32_dpp v20, v20, v20 row_bcast:15 row_mask:0xa bank_mask:0xf
    s_nop 1
    v_min_u32_dpp v20, v20, v20 row_bcast:31 row_mask:0xc bank_mask:0xf
    s_nop 0
    v_readlane_b32 s51, v20, 63
    s_sub_u32 s51, s42, s51
    s_sub_u32 s42, s51, 1
    v_sub_u32 v20, s42, v28
    v_sub_u32 v21, s42, v29
    v_sub_u32 v22, s42, v30
    v_min3_u32 v20, v20, v21, v22
    v_sub_u32 v21, s42, v31
    v_sub_u32 v22, s42, v32
    v_min3_u32 v20, v20, v21, v22
    v_sub_u32 v21, s42, v33
    v_sub_u32 v22, s42, v34
    v_min3_u32 v20, v20, v21, v22
    v_sub_u32 v21, s42, v35
    v_min_u32 v20, v20, v21
    s_nop 1
    v_min_u32_dpp v20, v20, v20 row_shr:1 row_mask:0xf bank_mask:0xf
    s_nop 1
    v_min_u32_dpp v20, v20, v20 row_shr:2 row_mask:0xf bank_mask:0xf
    s_nop 1
    v_min_u32_dpp v20, v20, v20 row_shr:4 row_mask:0xf bank_mask:0xf
    s_nop 1
    v_min_u32_dpp v20, v20, v20 row_shr:8 row_mask:0xf bank_mask:0xf
    s_nop 1
    v_min_u32_dpp v20, v20, v20 row_bcast:15 row_mask:0xa bank_mask:0xf
    s_nop 1
    v_min_u32_dpp v20, v20, v20 row_bcast:31 row_mask:0xc bank_mask:0xf
    s_nop 0
    v_readlane_b32 s52, v20, 63
    s_sub_u32 s52, s42, s52
    s_sub_u32 s42, s52, 1
    v_sub_u32 v20, s42, v28
    v_sub_u32 v21, s42, v29
    v_sub_u32 v22, s42, v30
    v_min3_u32 v20, v20, v21, v22
    v_sub_u32 v21, s42, v31
    v_sub_u32 v22, s42, v32
    v_min3_u32 v20, v20, v21, v22
    v_sub_u32 v21, s42, v33
    v_sub_u32 v22, s42, v34
    v_min3_u32 v20, v20, v21, v22
    v_sub_u32 v21, s42, v35
    v_min_u32 v20, v20, v21
    s_nop 1
    v_min_u32_dpp v20, v20, v20 row_shr:1 row_mask:0xf bank_mask:0xf
    s_nop 1
    v_min_u32_dpp v20, v20, v20 row_shr:2 row_mask:0xf bank_mask:0xf
    s_nop 1
    v_min_u32_dpp v20, v20, v20 row_shr:4 row_mask:0xf bank_mask:0xf
    s_nop 1
    v_min_u32_dpp v20, v20, v20 row_shr:8 row_mask:0xf bank_mask:0xf
    s_nop 1
    v_min_u32_dpp v20, v20, v20 row_bcast:15 row_mask:0xa bank_mask:0xf
    s_nop 1
    v_min_u32_dpp v20, v20, v20 row_bcast:31 row_mask:0xc bank_mask:0xf
    s_nop 0
    v_readlane_b32 s53, v20, 63
    s_sub_u32 s53, s42, s53
    s_sub_u32 s42, s53, 1
    v_sub_u32 v20, s42, v28
    v_sub_u32 v21, s42, v29
    v_sub_u32 v22, s42, v30
    v_min3_u32 v20, v20, v21, v22
    v_sub_u32 v21, s42, v31
    v_sub_u32 v22, s42, v32
    v_min3_u32 v20, v20, v21, v22
    v_sub_u32 v21, s42, v33
    v_sub_u32 v22, s42, v34
    v_min3_u32 v20, v20, v21, v22
    v_sub_u32 v21, s42, v35
    v_min_u32 v20, v20, v21
    s_nop 1
    v_min_u32_dpp v20, v20, v20 row_shr:1 row_mask:0xf bank_mask:0xf
    s_nop 1
    v_min_u32_dpp v20, v20, v20 row_shr:2 row_mask:0xf bank_mask:0xf
    s_nop 1
    v_min_u32_dpp v20, v20, v20 row_shr:4 row_mask:0xf bank_mask:0xf
    s_nop 1
    v_min_u32_dpp v20, v20, v20 row_shr:8 row_mask:0xf bank_mask:0xf
    s_nop 1
    v_min_u32_dpp v20, v20, v20 row_bcast:15 row_mask:0xa bank_mask:0xf
    s_nop 1
    v_min_u32_dpp v20, v20, v20 row_bcast:31 row_mask:0xc bank_mask:0xf
    s_nop 0
    v_readlane_b32 s54, v20, 63
    s_sub_u32 s54, s42, s54
    s_sub_u32 s42, s54, 1
    v_sub_u32 v20, s42, v28
    v_sub_u32 v21, s42, v29
    v_sub_u32 v22, s42, v30
    v_min3_u32 v20, v20, v21, v22
    v_sub_u32 v21, s42, v31
    v_sub_u32 v22, s42, v32
    v_min3_u32 v20, v20, v21, v22
    v_sub_u32 v21, s42, v33
    v_sub_u32 v22, s42, v34
    v_min3_u32 v20, v20, v21, v22
    v_sub_u32 v21, s42, v35
    v_min_u32 v20, v20, v21
    s_nop 1
    v_min_u32_dpp v20, v20, v20 row_shr:1 row_mask:0xf bank_mask:0xf
    s_nop 1
    v_min_u32_dpp v20, v20, v20 row_shr:2 row_mask:0xf bank_mask:0xf
    s_nop 1
    v_min_u32_dpp v20, v20, v20 row_shr:4 row_mask:0xf bank_mask:0xf
    s_nop 1
    v_min_u32_dpp v20, v20, v20 row_shr:8 row_mask:0xf bank_mask:0xf
    s_nop 1
    v_min_u32_dpp v20, v20, v20 row_bcast:15 row_mask:0xa bank_mask:0xf
    s_nop 1
    v_min_u32_dpp v20, v20, v20 row_bcast:31 row_mask:0xc bank_mask:0xf
    s_nop 0
    v_readlane_b32 s55, v20, 63
    s_sub_u32 s55, s42, s55
    s_sub_u32 s42, s55, 1
    v_sub_u32 v20, s42, v28
    v_sub_u32 v21, s42, v29
    v_sub_u32 v22, s42, v30
    v_min3_u32 v20, v20, v21, v22
    v_sub_u32 v21, s42, v31
    v_sub_u32 v22, s42, v32
    v_min3_u32 v20, v20, v21, v22
    v_sub_u32 v21, s42, v33
    v_sub_u32 v22, s42, v34
    v_min3_u32 v20, v20, v21, v22
    v_sub_u32 v21, s42, v35
    v_min_u32 v20, v20, v21
    s_nop 1
    v_min_u32_dpp v20, v20, v20 row_shr:1 row_mask:0xf bank_mask:0xf
    s_nop 1
    v_min_u32_dpp v20, v20, v20 row_shr:2 row_mask:0xf bank_mask:0xf
    s_nop 1
    v_min_u32_dpp v20, v20, v20 row_shr:4 row_mask:0xf bank_mask:0xf
    s_nop 1
    v_min_u32_dpp v20, v20, v20 row_shr:8 row_mask:0xf bank_mask:0xf
    s_nop 1
    v_min_u32_dpp v20, v20, v20 row_bcast:15 row_mask:0xa bank_mask:0xf
    s_nop 1
    v_min_u32_dpp v20, v20, v20 row_bcast:31 row_mask:0xc bank_mask:0xf
    s_nop 0
    v_readlane_b32 s56, v20, 63
    s_sub_u32 s56, s42, s56
    s_sub_u32 s42, s56, 1
    v_sub_u32 v20, s42, v28
    v_sub_u32 v21, s42, v29
    v_sub_u32 v22, s42, v30
    v_min3_u32 v20, v20, v21, v22
    v_sub_u32 v21, s42, v31
    v_sub_u32 v22, s42, v32
    v_min3_u32 v20, v20, v21, v22
    v_sub_u32 v21, s42, v33
    v_sub_u32 v22, s42, v34
    v_min3_u32 v20, v20, v21, v22
    v_sub_u32 v21, s42, v35
    v_min_u32 v20, v20, v21
    s_nop 1
    v_min_u32_dpp v20, v20, v20 row_shr:1 row_mask:0xf bank_mask:0xf
    s_nop 1
    v_min_u32_dpp v20, v20, v20 row_shr:2 row_mask:0xf bank_mask:0xf
    s_nop 1
    v_min_u32_dpp v20, v20, v20 row_shr:4 row_mask:0xf bank_mask:0xf
    s_nop 1
    v_min_u32_dpp v20, v20, v20 row_shr:8 row_mask:0xf bank_mask:0xf
    s_nop 1
    v_min_u32_dpp v20, v20, v20 row_bcast:15 row_mask:0xa bank_mask:0xf
    s_nop 1
    v_min_u32_dpp v20, v20, v20 row_bcast:31 row_mask:0xc bank_mask:0xf
    s_nop 0
    v_readlane_b32 s57, v20, 63
    s_sub_u32 s57, s42, s57
    s_sub_u32 s42, s57, 1
    v_mov_b32 v20, s50
    v_writelane_b32 v20, s51, 1
    v_writelane_b32 v20, s52, 2
    v_writelane_b32 v20, s53, 3
    v_writelane_b32 v20, s54, 4
    v_writelane_b32 v20, s55, 5
    v_writelane_b32 v20, s56, 6
    v_writelane_b32 v20, s57, 7
    s_lshl_b32 s42, s5, 8
    s_add_u32 s42, s42, 86016
    v_lshl_add_u32 v21, v19, 2, s42
    ds_write_b32 v21, v20
    s_waitcnt lgkmcnt(0)
    s_branch L_rt_back_local
L_rt_merge:
    v_bfe_u32 v21, v19, 3, 2
    v_lshlrev_b32 v21, 8, v21
    v_and_b32 v20, 7, v19
    v_lshl_add_u32 v21, v20, 2, v21
    v_add_u32 v21, 86016, v21
    ds_read_b32 v20, v21
    s_waitcnt lgkmcnt(0)
    s_mov_b32 s42, -1
    v_sub_u32 v21, s42, v20
    s_nop 1
    v_min_u32_dpp v21, v21, v21 row_shr:1 row_mask:0xf bank_mask:0xf
    s_nop 1
    v_min_u32_dpp v21, v21, v21 row_shr:2 row_mask:0xf bank_mask:0xf
    s_nop 1
    v_min_u32_dpp v21, v21, v21 row_shr:4 row_mask:0xf bank_mask:0xf
    s_nop 1
    v_min_u32_dpp v21, v21, v21 row_shr:8 row_mask:0xf bank_mask:0xf
    s_nop 1
    v_min_u32_dpp v21, v21, v21 row_bcast:15 row_mask:0xa bank_mask:0xf
    s_nop 1
    v_min_u32_dpp v21, v21, v21 row_bcast:31 row_mask:0xc bank_mask:0xf
    s_nop 0
    v_readlane_b32 s50, v21, 63
    s_sub_u32 s50, s42, s50
    s_sub_u32 s42, s50, 1
    v_sub_u32 v21, s42, v20
    s_nop 1
    v_min_u32_dpp v21, v21, v21 row_shr:1 row_mask:0xf bank_mask:0xf
    s_nop 1
    v_min_u32_dpp v21, v21, v21 row_shr:2 row_mask:0xf bank_mask:0xf
    s_nop 1
    v_min_u32_dpp v21, v21, v21 row_shr:4 row_mask:0xf bank_mask:0xf
    s_nop 1
    v_min_u32_dpp v21, v21, v21 row_shr:8 row_mask:0xf bank_mask:0xf
    s_nop 1
    v_min_u32_dpp v21, v21, v21 row_bcast:15 row_mask:0xa bank_mask:0xf
    s_nop 1
    v_min_u32_dpp v21, v21, v21 row_bcast:31 row_mask:0xc bank_mask:0xf
    s_nop 0
    v_readlane_b32 s51, v21, 63
    s_sub_u32 s51, s42, s51
    s_sub_u32 s42, s51, 1
    v_sub_u32 v21, s42, v20
    s_nop 1
    v_min_u32_dpp v21, v21, v21 row_shr:1 row_mask:0xf bank_mask:0xf
    s_nop 1
    v_min_u32_dpp v21, v21, v21 row_shr:2 row_mask:0xf bank_mask:0xf
    s_nop 1
    v_min_u32_dpp v21, v21, v21 row_shr:4 row_mask:0xf bank_mask:0xf
    s_nop 1
    v_min_u32_dpp v21, v21, v21 row_shr:8 row_mask:0xf bank_mask:0xf
    s_nop 1
    v_min_u32_dpp v21, v21, v21 row_bcast:15 row_mask:0xa bank_mask:0xf
    s_nop 1
    v_min_u32_dpp v21, v21, v21 row_bcast:31 row_mask:0xc bank_mask:0xf
    s_nop 0
    v_readlane_b32 s52, v21, 63
    s_sub_u32 s52, s42, s52
    s_sub_u32 s42, s52, 1
    v_sub_u32 v21, s42, v20
    s_nop 1
    v_min_u32_dpp v21, v21, v21 row_shr:1 row_mask:0xf bank_mask:0xf
    s_nop 1
    v_min_u32_dpp v21, v21, v21 row_shr:2 row_mask:0xf bank_mask:0xf
    s_nop 1
    v_min_u32_dpp v21, v21, v21 row_shr:4 row_mask:0xf bank_mask:0xf
    s_nop 1
    v_min_u32_dpp v21, v21, v21 row_shr:8 row_mask:0xf bank_mask:0xf
    s_nop 1
    v_min_u32_dpp v21, v21, v21 row_bcast:15 row_mask:0xa bank_mask:0xf
    s_nop 1
    v_min_u32_dpp v21, v21, v21 row_bcast:31 row_mask:0xc bank_mask:0xf
    s_nop 0
    v_readlane_b32 s53, v21, 63
    s_sub_u32 s53, s42, s53
    s_sub_u32 s42, s53, 1
    v_sub_u32 v21, s42, v20
    s_nop 1
    v_min_u32_dpp v21, v21, v21 row_shr:1 row_mask:0xf bank_mask:0xf
    s_nop 1
    v_min_u32_dpp v21, v21, v21 row_shr:2 row_mask:0xf bank_mask:0xf
    s_nop 1
    v_min_u32_dpp v21, v21, v21 row_shr:4 row_mask:0xf bank_mask:0xf
    s_nop 1
    v_min_u32_dpp v21, v21, v21 row_shr:8 row_mask:0xf bank_mask:0xf
    s_nop 1
    v_min_u32_dpp v21, v21, v21 row_bcast:15 row_mask:0xa bank_mask:0xf
    s_nop 1
    v_min_u32_dpp v21, v21, v21 row_bcast:31 row_mask:0xc bank_mask:0xf
    s_nop 0
    v_readlane_b32 s54, v21, 63
    s_sub_u32 s54, s42, s54
    s_sub_u32 s42, s54, 1
    v_sub_u32 v21, s42, v20
    s_nop 1
    v_min_u32_dpp v21, v21, v21 row_shr:1 row_mask:0xf bank_mask:0xf
    s_nop 1
    v_min_u32_dpp v21, v21, v21 row_shr:2 row_mask:0xf bank_mask:0xf
    s_nop 1
    v_min_u32_dpp v21, v21, v21 row_shr:4 row_mask:0xf bank_mask:0xf
    s_nop 1
    v_min_u32_dpp v21, v21, v21 row_shr:8 row_mask:0xf bank_mask:0xf
    s_nop 1
    v_min_u32_dpp v21, v21, v21 row_bcast:15 row_mask:0xa bank_mask:0xf
    s_nop 1
    v_min_u32_dpp v21, v21, v21 row_bcast:31 row_mask:0xc bank_mask:0xf
    s_nop 0
    v_readlane_b32 s55, v21, 63
    s_sub_u32 s55, s42, s55
    s_sub_u32 s42, s55, 1
    v_sub_u32 v21, s42, v20
    s_nop 1
    v_min_u32_dpp v21, v21, v21 row_shr:1 row_mask:0xf bank_mask:0xf
    s_nop 1
    v_min_u32_dpp v21, v21, v21 row_shr:2 row_mask:0xf bank_mask:0xf
    s_nop 1
    v_min_u32_dpp v21, v21, v21 row_shr:4 row_mask:0xf bank_mask:0xf
    s_nop 1
    v_min_u32_dpp v21, v21, v21 row_shr:8 row_mask:0xf bank_mask:0xf
    s_nop 1
    v_min_u32_dpp v21, v21, v21 row_bcast:15 row_mask:0xa bank_mask:0xf
    s_nop 1
    v_min_u32_dpp v21, v21, v21 row_bcast:31 row_mask:0xc bank_mask:0xf
    s_nop 0
    v_readlane_b32 s56, v21, 63
    s_sub_u32 s56, s42, s56
    s_sub_u32 s42, s56, 1
    v_sub_u32 v21, s42, v20
    s_nop 1
    v_min_u32_dpp v21, v21, v21 row_shr:1 row_mask:0xf bank_mask:0xf
    s_nop 1
    v_min_u32_dpp v21, v21, v21 row_shr:2 row_mask:0xf bank_mask:0xf
    s_nop 1
    v_min_u32_dpp v21, v21, v21 row_shr:4 row_mask:0xf bank_mask:0xf
    s_nop 1
    v_min_u32_dpp v21, v21, v21 row_shr:8 row_mask:0xf bank_mask:0xf
    s_nop 1
    v_min_u32_dpp v21, v21, v21 row_bcast:15 row_mask:0xa bank_mask:0xf
    s_nop 1
    v_min_u32_dpp v21, v21, v21 row_bcast:31 row_mask:0xc bank_mask:0xf
    s_nop 0
    v_readlane_b32 s57, v21, 63
    s_sub_u32 s57, s42, s57
    s_sub_u32 s42, s57, 1
    v_mov_b32 v20, s50
    v_writelane_b32 v20, s51, 1
    v_writelane_b32 v20, s52, 2
    v_writelane_b32 v20, s53, 3
    v_writelane_b32 v20, s54, 4
    v_writelane_b32 v20, s55, 5
    v_writelane_b32 v20, s56, 6
    v_writelane_b32 v20, s57, 7
    v_lshlrev_b32 v21, 2, v19
    s_mov_b32 s42, 0x29b000
    s_mov_b64 exec, 0xff
    buffer_store_dword v20, v21, s[76:79], s42 offen sc1
    s_mov_b64 exec, -1
    s_branch L_rt_back_merge
L_site0:
    s_mov_b32 s43, m0
    s_mov_b32 m0, s38
    s_add_u32 s38, s38, 1024
    buffer_load_dwordx4 v24, s[16:19], s37 offen lds
    s_mov_b32 m0, s43
    s_add_u32 s37, s37, 221184
    s_cmp_eq_u32 s35, 9
    s_cselect_b32 s36, 4, s36
    s_branch L_site_back0
L_site1:
    s_mov_b32 s43, m0
    s_mov_b32 m0, s38
    s_add_u32 s38, s38, 1024
    buffer_load_dwordx4 v24, s[16:19], s37 offen lds
    s_mov_b32 m0, s43
    s_add_u32 s37, s37, 221184
    s_cmp_eq_u32 s35, 9
    s_cselect_b32 s36, 4, s36
    s_branch L_site_back1
L_once_pack:
    s_mov_b64 exec, 1
    buffer_store_dword v27, off, s[76:79], s75 sc1
    s_mov_b64 exec, -1
    s_branch L_once_back_pack
L_site2:
    s_mov_b32 s43, m0
    s_mov_b32 m0, s38
    s_add_u32 s38, s38, 1024
    buffer_load_dwordx4 v24, s[16:19], s37 offen lds
    s_mov_b32 m0, s43
    s_add_u32 s37, s37, 221184
    s_cmp_eq_u32 s35, 9
    s_cselect_b32 s36, 4, s36
    s_branch L_site_back2
L_site3:
    s_mov_b32 s43, m0
    s_mov_b32 m0, s38
    s_add_u32 s38, s38, 1024
    buffer_load_dwordx4 v24, s[16:19], s37 offen lds
    s_mov_b32 m0, s43
    s_add_u32 s37, s37, 221184
    s_cmp_eq_u32 s35, 9
    s_cselect_b32 s36, 4, s36
    s_branch L_site_back3
L_spin_pack:
    s_mov_b32 s7, 32768
L_retry_pack:
    s_sleep 2
    buffer_load_dwordx4 v[28:31], v32, s[76:79], 0 offen sc1
    s_waitcnt vmcnt(0)
    v_min3_u32 v28, v28, v29, v30
    v_min_u32 v28, v28, v31
    v_cmp_gt_u32 vcc, 1, v28
    s_and_b64 vcc, vcc, exec
    s_cbranch_scc0 L_back_pack
    s_sub_u32 s7, s7, 1
    s_cbranch_scc0 L_retry_pack
    s_branch L_back_pack
L_spin_sel:
    s_mov_b32 s7, 32768
L_retry_sel:
    s_sleep 2
    buffer_load_dword v249, v21, s[76:79], 0 offen sc1
    s_waitcnt vmcnt(0)
    v_cmp_eq_u32 vcc, 0, v249
    s_and_b64 vcc, vcc, exec
    s_cbranch_scc0 L_back_sel
    s_sub_u32 s7, s7, 1
    s_cbranch_scc0 L_retry_sel
    s_branch L_back_sel
L_spin_ffn:
    s_mov_b32 s7, 32768
L_retry_ffn:
    s_sleep 2
    buffer_load_dwordx4 v[252:255], v20, s[76:79], 0 offen sc1
    s_waitcnt vmcnt(0)
    v_min3_u32 v252, v252, v253, v254
    v_min_u32 v252, v252, v255
    v_cmp_gt_u32 vcc, 2, v252
    s_and_b64 vcc, vcc, exec
    s_cbranch_scc0 L_back_ffn
    s_sub_u32 s7, s7, 1
    s_cbranch_scc0 L_retry_ffn
    s_branch L_back_ffn
L_spin_o:
    s_mov_b32 s7, 32768
L_retry_o:
    s_sleep 2
    buffer_load_dwordx4 v[252:255], v1, s[76:79], 0 offen sc1
    s_waitcnt vmcnt(0)
    v_min3_u32 v252, v252, v253, v254
    v_min_u32 v252, v252, v255
    v_cmp_gt_u32 vcc, 1, v252
    s_and_b64 vcc, vcc, exec
    s_cbranch_scc0 L_back_o
    s_sub_u32 s7, s7, 1
    s_cbranch_scc0 L_retry_o
    s_branch L_back_o
L_spin_upd:
    s_mov_b32 s7, 32768
L_retry_upd:
    s_sleep 2
    buffer_load_dwordx2 v[20:21], v11, s[76:79], 0 offen offset:0 sc1
    buffer_load_dwordx2 v[246:247], v11, s[76:79], 0 offen offset:32 sc1
    buffer_load_dwordx2 v[248:249], v11, s[76:79], 0 offen offset:64 sc1
    buffer_load_dwordx2 v[252:253], v11, s[76:79], 0 offen offset:96 sc1
    buffer_load_dwordx2 v[254:255], v11, s[76:79], 0 offen offset:128 sc1
    s_waitcnt vmcnt(0)
    v_max3_u32 v1, v20, v21, v246
    v_max3_u32 v1, v1, v247, v248
    v_max3_u32 v1, v1, v249, v252
    v_max3_u32 v1, v1, v253, v254
    v_max_u32 v1, v1, v255
    v_cmp_eq_u32 vcc, -1, v1
    s_and_b64 vcc, vcc, exec
    s_cbranch_scc0 L_back_upd
    s_sub_u32 s7, s7, 1
    s_cbranch_scc0 L_retry_upd
    s_branch L_back_upd
L_spin_half:
    s_mov_b32 s7, 32768
L_retry_half:
    s_sleep 2
    buffer_load_dword v1, off, s[76:79], s37 sc1
    s_waitcnt vmcnt(0)
    v_cmp_ne_u32 vcc, 3, v1
    s_and_b64 vcc, vcc, exec
    s_cbranch_scc0 L_back_half
    s_sub_u32 s7, s7, 1
    s_cbranch_scc0 L_retry_half
    s_branch L_back_half
L_code_end:
    s_endpgm

.section .rodata,"a"
.p2align 6
.amdhsa_kernel recurrent_scan__mha_block_cached__moe_arch_mod__prompt_kernel
  .amdhsa_next_free_vgpr 512
  .amdhsa_next_free_sgpr 102
  .amdhsa_accum_offset 256
  .amdhsa_group_segment_fixed_size 0
  .amdhsa_kernarg_size 104
  .amdhsa_user_sgpr_count 2
  .amdhsa_user_sgpr_kernarg_segment_ptr 1
  .amdhsa_system_sgpr_workgroup_id_x 1
  .amdhsa_float_denorm_mode_32 3
.end_amdhsa_kernel
```

```asm
; @launch grid=(256,1,1) block=(256,1,1) lds=163840
.amdgcn_target "amdgcn-amd-amdhsa--gfx950"
.text
.globl recurrent_scan__mha_block_cached__moe_arch_mod__prompt_kernel
.p2align 8
.type recurrent_scan__mha_block_cached__moe_arch_mod__prompt_kernel,@function
recurrent_scan__mha_block_cached__moe_arch_mod__prompt_kernel:
    s_cmp_ge_u32 s2, 256
    s_cbranch_scc1 L_end
    s_load_dwordx16 s[48:63], s[0:1], 0
    s_load_dwordx8 s[64:71], s[0:1], 64
    s_load_dwordx2 s[72:73], s[0:1], 96
    s_getpc_b64 s[40:41]
L_touch:
    s_bfe_u32 s42, s2, 0x20003
    s_lshl_b32 s42, s42, 8
    v_add_u32 v252, s42, v0
    v_min_u32 v252, (L_code_end - L_touch) / 128, v252
    v_lshlrev_b32 v252, 7, v252
    global_load_dword a120, v252, s[40:41]
    v_lshrrev_b32 v116, 6, v0
    v_and_b32 v19, 63, v0
    s_and_b32 s40, s2, 7
    v_readfirstlane_b32 s5, v116
    s_lshl_b32 s40, s40, 2
    s_bfe_u32 s41, s2, 0x20003
    s_add_u32 s3, s40, s41
    s_lshr_b32 s4, s2, 5
    s_lshl_b32 s74, s4, 5
    s_add_u32 s6, s74, s3
    v_lshrrev_b32 v118, 4, v19
    v_and_b32 v117, 15, v19
    v_lshlrev_b32 v119, 1, v118
    v_xor_b32 v119, v117, v119
    s_lshl_b32 s42, s5, 4
    v_add_u32 v120, s42, v118
    v_lshlrev_b32 v121, 4, v119
    v_xor_b32 v122, 0x80, v121
    v_lshl_add_u32 v123, v120, 13, v121
    v_lshl_add_u32 v116, v120, 13, v122
    v_add_u32 v44, 0, v123
    v_add_u32 v45, 31744, v123
    v_add_u32 v46, 63488, v116
    v_add_u32 v47, 95232, v116
    v_lshl_add_u32 v17, v120, 8, v121
    v_lshl_add_u32 v18, v120, 8, v122
    v_xor_b32 v117, v117, v118
    v_xor_b32 v121, 0, v117
    v_lshlrev_b32 v121, 4, v121
    v_lshl_add_u32 v13, v120, 8, v121
    v_xor_b32 v121, 4, v117
    v_lshlrev_b32 v121, 4, v121
    v_lshl_add_u32 v14, v120, 8, v121
    v_xor_b32 v121, 8, v117
    v_lshlrev_b32 v121, 4, v121
    v_lshl_add_u32 v15, v120, 8, v121
    v_xor_b32 v121, 12, v117
    v_lshlrev_b32 v121, 4, v121
    v_lshl_add_u32 v16, v120, 8, v121
    v_lshrrev_b32 v116, 3, v19
    v_and_b32 v117, 7, v19
    v_xor_b32 v117, v117, v118
    v_mul_u32_u24 v116, 1280, v116
    s_mul_i32 s42, s5, 81920
    v_lshl_add_u32 v119, v117, 4, v116
    v_xor_b32 v117, 4, v117
    v_lshl_add_u32 v120, v117, 4, v116
    v_add_u32 v119, s42, v119
    v_add_u32 v120, s42, v120
    v_add_u32 v36, 0, v119
    v_add_u32 v37, 9216, v120
    v_add_u32 v38, 18432, v119
    v_add_u32 v39, 27648, v120
    v_add_u32 v40, 40960, v119
    v_add_u32 v41, 50176, v120
    v_add_u32 v42, 59392, v119
    v_add_u32 v43, 68608, v120
    s_lshl_b32 s43, s6, 2
    s_add_u32 s43, s43, s5
    s_lshl_b32 s43, s43, 1
    s_mul_i32 s38, s5, 24576
    s_lshl_b32 s40, s5, 12
    s_add_u32 s39, s40, 98304
    s_mov_b32 s34, s39
    s_mov_b32 s28, 0
    s_mov_b32 s29, 0
    s_and_b32 s40, s3, 31
    s_mul_i32 s40, s40, 10
    s_lshr_b32 s40, s40, 5
    s_lshl_b32 s36, s40, 7
    s_waitcnt lgkmcnt(0)
    s_mov_b32 s88, s48
    s_mov_b32 s89, s49
    s_mov_b32 s90, 0x280000
    s_mov_b32 s91, 0x20000
    s_mov_b32 s92, s60
    s_mov_b32 s93, s61
    s_mov_b32 s94, 0x500
    s_mov_b32 s95, 0x20000
    s_lshl_b32 s40, s3, 8
    s_add_u32 s20, s54, s40
    s_addc_u32 s21, s55, 0
    s_mov_b32 s22, 0x4fe100
    s_mov_b32 s23, 0x20000
    s_mul_i32 s40, s4, 327680
    s_add_u32 s16, s48, s40
    s_addc_u32 s17, s49, 0
    s_mov_b32 s18, 0x50000
    s_mov_b32 s19, 0x20000
    s_add_u32 m0, s39, 0
    s_mov_b32 s37, 0
    buffer_load_dwordx4 v44, s[20:23], s37 offen offset:0 lds
    buffer_load_dwordx4 v45, s[20:23], s37 offen offset:1024 lds
    buffer_load_dwordx4 v46, s[20:23], s37 offen offset:2048 lds
    buffer_load_dwordx4 v47, s[20:23], s37 offen offset:3072 lds
    s_add_u32 m0, s38, 0
    s_mov_b32 s36, 0
    buffer_load_dwordx4 v36, s[16:19], s36 offen offset:0 lds
    buffer_load_dwordx4 v37, s[16:19], s36 offen offset:1024 lds
    buffer_load_dwordx4 v38, s[16:19], s36 offen offset:2048 lds
    buffer_load_dwordx4 v39, s[16:19], s36 offen offset:3072 lds
    s_add_u32 m0, s38, 4096
    s_nop 0
    buffer_load_dwordx4 v40, s[16:19], s36 offen offset:0 lds
    buffer_load_dwordx4 v41, s[16:19], s36 offen offset:1024 lds
    buffer_load_dwordx4 v42, s[16:19], s36 offen offset:2048 lds
    buffer_load_dwordx4 v43, s[16:19], s36 offen offset:3072 lds
    v_lshrrev_b32 v108, 5, v19
    v_add_u32 v108, s43, v108
    v_and_b32 v110, 31, v19
    v_lshlrev_b32 v110, 3, v110
    v_mul_u32_u24 v109, 1280, v108
    v_add_u32 v109, v109, v110
    buffer_load_dwordx2 v[60:61], v109, s[88:91], 0 offen offset:0
    buffer_load_dwordx2 v[62:63], v109, s[88:91], 0 offen offset:256
    buffer_load_dwordx2 v[64:65], v109, s[88:91], 0 offen offset:512
    buffer_load_dwordx2 v[66:67], v109, s[88:91], 0 offen offset:768
    buffer_load_dwordx2 v[68:69], v109, s[88:91], 0 offen offset:1024
    buffer_load_dwordx2 v[70:71], v110, s[92:95], 0 offen offset:0
    buffer_load_dwordx2 v[72:73], v110, s[92:95], 0 offen offset:256
    buffer_load_dwordx2 v[74:75], v110, s[92:95], 0 offen offset:512
    buffer_load_dwordx2 v[76:77], v110, s[92:95], 0 offen offset:768
    buffer_load_dwordx2 v[78:79], v110, s[92:95], 0 offen offset:1024
    s_lshl_b32 s40, s3, 19
    s_add_u32 s8, s50, s40
    s_addc_u32 s9, s51, 0
    s_mov_b32 s10, 0x80000
    s_mov_b32 s11, 0x20000
    s_add_u32 s12, s52, s40
    s_addc_u32 s13, s53, 0
    s_mov_b32 s14, 0x80000
    s_mov_b32 s15, 0x20000
    s_and_b32 s40, s5, 1
    s_lshl_b32 s40, s40, 12
    s_cmp_ge_u32 s5, 2
    s_cselect_b32 s30, 32, 8
    s_cselect_b32 s31, 40, 16
    s_cselect_b32 s32, 0, 56
    s_cselect_b32 s33, 48, 24
    s_lshl_b32 s30, s30, 10
    s_add_u32 s30, s30, s40
    s_lshl_b32 s31, s31, 10
    s_add_u32 s31, s31, s40
    s_lshl_b32 s32, s32, 10
    s_add_u32 s32, s32, s40
    s_lshl_b32 s33, s33, 10
    s_add_u32 s33, s33, s40
    s_mov_b32 s44, 0x3e0293ee
    s_mov_b32 s45, 4096
    s_mov_b32 s76, s72
    s_mov_b32 s77, s73
    s_mov_b32 s78, 0x2500000
    s_mov_b32 s79, 0x20000
    s_mov_b32 s92, s70
    s_mov_b32 s93, s71
    s_mov_b32 s94, 0x100
    s_mov_b32 s95, 0x20000
    s_lshl_b32 s41, s4, 2
    s_add_u32 s41, s41, s5
    s_lshl_b32 s40, s41, 5
    s_add_u32 s40, s40, s3
    s_lshl_b32 s40, s40, 14
    s_add_u32 s40, s40, 0x400000
    s_add_u32 s24, s72, s40
    s_addc_u32 s25, s73, 0
    s_mov_b32 s26, 0x4000
    s_mov_b32 s27, 0x20000
    s_and_b32 s42, s3, 3
    s_lshl_b32 s42, s42, 2
    s_lshr_b32 s40, s6, 2
    s_lshl_b32 s40, s40, 7
    s_add_u32 s40, s40, s42
    s_add_u32 s75, s40, 0x290000
    s_lshr_b32 s40, s3, 2
    s_lshl_b32 s40, s40, 7
    s_add_u32 s40, s40, s42
    s_lshl_b32 s42, s41, 10
    s_add_u32 s40, s40, s42
    s_add_u32 s58, s40, 0x292000
    s_cmp_eq_u32 s5, 0
    s_cselect_b32 s59, 5, 8
    s_lshl_b32 s41, s41, 10
    s_add_u32 s46, s41, 0x280000
    v_lshrrev_b32 v116, 4, v19
    v_and_b32 v117, 15, v19
    v_lshlrev_b32 v59, 4, v117
    v_xor_b32 v118, v116, v117
    v_lshlrev_b32 v119, 8, v117
    v_add_u32 v119, 98304, v119
    s_add_u32 s41, s5, 0
    s_and_b32 s41, s41, 3
    s_lshl_b32 s41, s41, 2
    v_xor_b32 v120, s41, v118
    v_lshl_add_u32 v1, v120, 4, v119
    s_add_u32 s41, s5, 1
    s_and_b32 s41, s41, 3
    s_lshl_b32 s41, s41, 2
    v_xor_b32 v120, s41, v118
    v_lshl_add_u32 v2, v120, 4, v119
    s_add_u32 s41, s5, 2
    s_and_b32 s41, s41, 3
    s_lshl_b32 s41, s41, 2
    v_xor_b32 v120, s41, v118
    v_lshl_add_u32 v3, v120, 4, v119
    s_add_u32 s41, s5, 3
    s_and_b32 s41, s41, 3
    s_lshl_b32 s41, s41, 2
    v_xor_b32 v120, s41, v118
    v_lshl_add_u32 v4, v120, 4, v119
    v_lshrrev_b32 v118, 1, v117
    v_xor_b32 v118, v116, v118
    v_lshlrev_b32 v119, 7, v117
    v_add_u32 v119, s38, v119
    v_xor_b32 v120, 0, v118
    v_lshl_add_u32 v48, v120, 4, v119
    v_xor_b32 v120, 4, v118
    v_lshl_add_u32 v49, v120, 4, v119
    v_bfe_u32 v118, v19, 2, 2
    v_bfe_u32 v119, v19, 2, 3
    v_and_b32 v120, 3, v19
    v_lshlrev_b32 v120, 3, v120
    v_lshl_add_u32 v121, v116, 2, v118
    v_lshl_add_u32 v121, v121, 8, v120
    v_lshl_add_u32 v122, v116, 3, v118
    v_lshl_add_u32 v122, v122, 8, v120
    v_add_u32 v122, 98304, v122
    v_xor_b32 v123, 0, v119
    v_lshl_add_u32 v5, v123, 5, v121
    v_xor_b32 v123, 1, v119
    v_lshl_add_u32 v6, v123, 5, v121
    v_xor_b32 v123, 2, v119
    v_lshl_add_u32 v7, v123, 5, v121
    v_xor_b32 v123, 3, v119
    v_lshl_add_u32 v8, v123, 5, v121
    v_xor_b32 v123, 4, v119
    v_lshl_add_u32 v9, v123, 5, v121
    v_xor_b32 v123, 5, v119
    v_lshl_add_u32 v10, v123, 5, v121
    v_xor_b32 v123, 6, v119
    v_lshl_add_u32 v11, v123, 5, v121
    v_xor_b32 v123, 7, v119
    v_lshl_add_u32 v12, v123, 5, v121
    s_lshl_b32 s42, s5, 1
    s_add_u32 s41, s42, 0
    s_and_b32 s41, s41, 7
    v_xor_b32 v123, s41, v119
    v_lshl_add_u32 v50, v123, 5, v122
    s_add_u32 s41, s42, 1
    s_and_b32 s41, s41, 7
    v_xor_b32 v123, s41, v119
    v_lshl_add_u32 v51, v123, 5, v122
    s_add_u32 s41, s42, 2
    s_and_b32 s41, s41, 7
    v_xor_b32 v123, s41, v119
    v_lshl_add_u32 v52, v123, 5, v122
    s_add_u32 s41, s42, 3
    s_and_b32 s41, s41, 7
    v_xor_b32 v123, s41, v119
    v_lshl_add_u32 v53, v123, 5, v122
    s_add_u32 s41, s42, 4
    s_and_b32 s41, s41, 7
    v_xor_b32 v123, s41, v119
    v_lshl_add_u32 v54, v123, 5, v122
    s_add_u32 s41, s42, 5
    s_and_b32 s41, s41, 7
    v_xor_b32 v123, s41, v119
    v_lshl_add_u32 v55, v123, 5, v122
    s_add_u32 s41, s42, 6
    s_and_b32 s41, s41, 7
    v_xor_b32 v123, s41, v119
    v_lshl_add_u32 v56, v123, 5, v122
    s_add_u32 s41, s42, 7
    s_and_b32 s41, s41, 7
    v_xor_b32 v123, s41, v119
    v_lshl_add_u32 v57, v123, 5, v122
    s_lshl_b32 s41, s5, 7
    s_add_u32 s41, s41, 86016
    v_lshl_add_u32 v58, v116, 4, s41
    v_mov_b32 v32, 0x3f803f80
    v_mov_b32 v33, 0x3f803f80
    v_mov_b32 v34, 0x3f803f80
    v_mov_b32 v35, 0x3f803f80
    v_and_b32 v120, 1, v19
    v_cmp_eq_u32 vcc, 0, v120
    v_mov_b32 v121, 0x44444444
    v_mov_b32 v122, 0xeeeeeeee
    v_cndmask_b32 v248, v122, v121, vcc
    v_and_b32 v120, 2, v19
    v_cmp_eq_u32 vcc, 0, v120
    v_mov_b32 v27, 1
    v_mov_b32 v28, 0
    v_cndmask_b32 v244, 0, v32, vcc
    v_cndmask_b32 v245, 0, v32, vcc
    v_cndmask_b32 v246, 0, v32, vcc
    v_cndmask_b32 v247, 0, v32, vcc
    v_accvgpr_write_b32 a224, 0
    v_accvgpr_write_b32 a225, 0
    v_accvgpr_write_b32 a226, 0
    v_accvgpr_write_b32 a227, 0
    v_accvgpr_write_b32 a228, 0
    v_accvgpr_write_b32 a229, 0
    v_accvgpr_write_b32 a230, 0
    v_accvgpr_write_b32 a231, 0
    v_accvgpr_write_b32 a232, 0
    v_accvgpr_write_b32 a233, 0
    v_accvgpr_write_b32 a234, 0
    v_accvgpr_write_b32 a235, 0
    v_accvgpr_write_b32 a236, 0
    v_accvgpr_write_b32 a237, 0
    v_accvgpr_write_b32 a238, 0
    v_accvgpr_write_b32 a239, 0
    s_mul_i32 s47, s5, 5120
    s_mov_b32 s96, s56
    s_mov_b32 s97, s57
    s_mov_b32 s98, 0x500000
    s_mov_b32 s99, 0x20000
    s_lshr_b32 s40, s6, 1
    s_and_b32 s41, s6, 1
    s_lshl_b32 s41, s41, 2
    s_add_u32 s41, s41, s5
    s_add_u32 s47, s47, 65536
    s_mul_i32 s42, s40, 40960
    s_mul_i32 s43, s41, 160
    s_add_u32 s42, s42, s43
    v_add_u32 v25, 0, v19
    v_mul_u32_u24 v26, 6554, v25
    v_lshrrev_b32 v26, 16, v26
    v_mul_u32_u24 v20, 1120, v26
    v_lshl_add_u32 v20, v25, 4, v20
    v_add_u32 v20, s42, v20
    v_add_u32 v25, 64, v19
    v_mul_u32_u24 v26, 6554, v25
    v_lshrrev_b32 v26, 16, v26
    v_mul_u32_u24 v21, 1120, v26
    v_lshl_add_u32 v21, v25, 4, v21
    v_add_u32 v21, s42, v21
    v_add_u32 v25, 128, v19
    v_mul_u32_u24 v26, 6554, v25
    v_lshrrev_b32 v26, 16, v26
    v_mul_u32_u24 v22, 1120, v26
    v_lshl_add_u32 v22, v25, 4, v22
    v_add_u32 v22, s42, v22
    v_add_u32 v25, 192, v19
    v_mul_u32_u24 v26, 6554, v25
    v_lshrrev_b32 v26, 16, v26
    v_mul_u32_u24 v23, 1120, v26
    v_lshl_add_u32 v23, v25, 4, v23
    v_add_u32 v23, s42, v23
    v_add_u32 v25, 256, v19
    v_mul_u32_u24 v26, 6554, v25
    v_lshrrev_b32 v26, 16, v26
    v_mul_u32_u24 v24, 1120, v26
    v_lshl_add_u32 v24, v25, 4, v24
    v_add_u32 v24, s42, v24
    v_lshrrev_b32 v25, 2, v19
    v_mul_u32_u24 v25, 160, v25
    v_and_b32 v26, 3, v19
    v_lshl_add_u32 v25, v26, 3, v25
    v_add_u32 v25, s47, v25
    s_lshl_b32 s42, s41, 7
    s_add_u32 s42, s42, s40
    s_mul_i32 s42, s42, 5120
    s_add_u32 s42, s42, 0x1400000
    v_lshlrev_b32 v26, 4, v19
    v_add_u32 v26, s42, v26
    s_add_u32 m0, s39, 16384
    s_mov_b32 s37, 524288
    buffer_load_dwordx4 v44, s[20:23], s37 offen offset:0 lds
    buffer_load_dwordx4 v45, s[20:23], s37 offen offset:1024 lds
    buffer_load_dwordx4 v46, s[20:23], s37 offen offset:2048 lds
    buffer_load_dwordx4 v47, s[20:23], s37 offen offset:3072 lds
    s_add_u32 m0, s38, 8192
    s_mov_b32 s36, 128
    buffer_load_dwordx4 v36, s[16:19], s36 offen offset:0 lds
    buffer_load_dwordx4 v37, s[16:19], s36 offen offset:1024 lds
    buffer_load_dwordx4 v38, s[16:19], s36 offen offset:2048 lds
    buffer_load_dwordx4 v39, s[16:19], s36 offen offset:3072 lds
    s_add_u32 m0, s38, 12288
    s_nop 0
    buffer_load_dwordx4 v40, s[16:19], s36 offen offset:0 lds
    buffer_load_dwordx4 v41, s[16:19], s36 offen offset:1024 lds
    buffer_load_dwordx4 v42, s[16:19], s36 offen offset:2048 lds
    buffer_load_dwordx4 v43, s[16:19], s36 offen offset:3072 lds
    s_add_u32 m0, s39, 32768
    s_mov_b32 s37, 1048576
    buffer_load_dwordx4 v44, s[20:23], s37 offen offset:0 lds
    buffer_load_dwordx4 v45, s[20:23], s37 offen offset:1024 lds
    buffer_load_dwordx4 v46, s[20:23], s37 offen offset:2048 lds
    buffer_load_dwordx4 v47, s[20:23], s37 offen offset:3072 lds
    s_waitcnt vmcnt(26)
    s_barrier
    ds_read_b64_tr_b16 a[0:1], v50 offset:0
    ds_read_b64_tr_b16 a[2:3], v50 offset:1024
    ds_read_b128 a[32:35], v48 offset:0
    ds_read_b128 a[36:39], v48 offset:2048
    ds_read_b128 a[40:43], v48 offset:4096
    ds_read_b128 a[44:47], v48 offset:6144
    ds_read_b64_tr_b16 a[4:5], v51 offset:0
    ds_read_b64_tr_b16 a[6:7], v51 offset:1024
    ds_read_b64_tr_b16 a[8:9], v52 offset:0
    ds_read_b64_tr_b16 a[10:11], v52 offset:1024
    ds_read_b64_tr_b16 a[12:13], v53 offset:0
    ds_read_b64_tr_b16 a[14:15], v53 offset:1024
    ds_read_b64_tr_b16 a[16:17], v54 offset:0
    ds_read_b64_tr_b16 a[18:19], v54 offset:1024
    ds_read_b64_tr_b16 a[20:21], v55 offset:0
    ds_read_b64_tr_b16 a[22:23], v55 offset:1024
    ds_read_b64_tr_b16 a[24:25], v56 offset:0
    ds_read_b64_tr_b16 a[26:27], v56 offset:1024
    ds_read_b64_tr_b16 a[28:29], v57 offset:0
    ds_read_b64_tr_b16 a[30:31], v57 offset:1024
    s_waitcnt lgkmcnt(0)
    v_mfma_f32_16x16x32_bf16 v[100:103], a[0:3], v[32:35], 0
    s_waitcnt vmcnt(16)
    ds_read_b64_tr_b16 a[48:49], v50 offset:8192
    v_mfma_f32_16x16x32_bf16 v[104:107], a[4:7], v[32:35], 0
    s_add_u32 m0, s38, 16384
    s_mov_b32 s36, 256
    ds_read_b64_tr_b16 a[50:51], v50 offset:9216
    v_mfma_f32_16x16x32_bf16 v[116:119], a[0:3], a[32:35], 0
    s_lshl_b32 s40, s6, 7
    buffer_load_dwordx4 v36, s[16:19], s36 offen offset:0 lds
    v_mfma_f32_16x16x32_bf16 v[148:151], a[0:3], a[36:39], 0
    s_add_u32 s41, s40, 0x292000
    ds_read_b128 a[80:83], v49 offset:0
    v_mfma_f32_16x16x32_bf16 v[180:183], a[0:3], a[40:43], 0
    s_add_u32 s40, s40, 0x290000
    ds_read_b128 a[84:87], v49 offset:2048
    v_mfma_f32_16x16x32_bf16 v[212:215], a[0:3], a[44:47], 0
    s_cmp_lt_u32 s6, 64
    s_cselect_b32 s40, s40, 0x2500000
    buffer_load_dwordx4 v37, s[16:19], s36 offen offset:1024 lds
    v_mfma_f32_16x16x32_bf16 v[216:219], a[4:7], a[44:47], 0
    s_cmp_eq_u32 s5, 1
    s_cselect_b32 s40, s40, 0x2500000
    ds_read_b128 a[88:91], v49 offset:4096
    v_mfma_f32_16x16x32_bf16 v[184:187], a[4:7], a[40:43], 0
    s_cmp_eq_u32 s5, 0
    s_cselect_b32 s40, s41, s40
    ds_read_b128 a[92:95], v49 offset:6144
    v_mfma_f32_16x16x32_bf16 v[152:155], a[4:7], a[36:39], 0
    s_add_u32 s41, s41, 0xe000
    ds_read_b64_tr_b16 a[52:53], v51 offset:8192
    v_mfma_f32_16x16x32_bf16 v[120:123], a[4:7], a[32:35], 0
    s_cmp_eq_u32 s5, 3
    s_cselect_b32 s40, s41, s40
    buffer_load_dwordx4 v38, s[16:19], s36 offen offset:2048 lds
    v_mfma_f32_16x16x32_bf16 v[124:127], a[8:11], a[32:35], 0
    s_lshl_b32 s41, s6, 2
    ds_read_b64_tr_b16 a[54:55], v51 offset:9216
    v_mfma_f32_16x16x32_bf16 v[156:159], a[8:11], a[36:39], 0
    s_add_u32 s41, s41, s5
    ds_read_b64_tr_b16 a[56:57], v52 offset:8192
    v_mfma_f32_16x16x32_bf16 v[188:191], a[8:11], a[40:43], 0
    s_cmp_eq_u32 s41, 962
    s_cselect_b32 s40, 0x29b000, s40
    ds_read_b64_tr_b16 a[58:59], v52 offset:9216
    v_mfma_f32_16x16x32_bf16 v[220:223], a[8:11], a[44:47], 0
    s_lshl_b32 s41, s6, 7
    buffer_load_dwordx4 v39, s[16:19], s36 offen offset:3072 lds
    v_mfma_f32_16x16x32_bf16 v[224:227], a[12:15], a[44:47], 0
    s_add_u32 s41, s41, 0x29c000
    ds_read_b64_tr_b16 a[60:61], v53 offset:8192
    v_mfma_f32_16x16x32_bf16 v[192:195], a[12:15], a[40:43], 0
    s_xor_b32 s42, s5, 2
    ds_read_b64_tr_b16 a[62:63], v53 offset:9216
    v_mfma_f32_16x16x32_bf16 v[160:163], a[12:15], a[36:39], 0
    s_add_u32 m0, s38, 20480
    ds_read_b64_tr_b16 a[64:65], v54 offset:8192
    v_mfma_f32_16x16x32_bf16 v[128:131], a[12:15], a[32:35], 0
    s_lshl_b32 s42, s42, 8
    buffer_load_dwordx4 v40, s[16:19], s36 offen offset:0 lds
    v_mfma_f32_16x16x32_bf16 v[132:135], a[16:19], a[32:35], 0
    s_add_u32 s42, s42, s6
    ds_read_b64_tr_b16 a[66:67], v54 offset:9216
    v_mfma_f32_16x16x32_bf16 v[164:167], a[16:19], a[36:39], 0
    s_cmp_lt_u32 s42, 80
    s_cselect_b32 s40, s41, s40
    s_cselect_b32 s41, -1, 0
    ds_read_b64_tr_b16 a[68:69], v55 offset:8192
    v_mov_b32 v28, s41
    v_lshlrev_b32 v29, 2, v19
    v_mfma_f32_16x16x32_bf16 v[196:199], a[16:19], a[40:43], 0
    buffer_load_dwordx4 v41, s[16:19], s36 offen offset:1024 lds
    s_mov_b32 exec_hi, 0
    buffer_store_dword v28, v29, s[76:79], s40 offen sc1
    s_mov_b32 exec_hi, -1
    v_lshlrev_b32 v80, 16, v60
    v_and_b32 v81, 0xffff0000, v60
    v_lshlrev_b32 v82, 16, v61
    v_and_b32 v83, 0xffff0000, v61
    v_lshlrev_b32 v84, 16, v62
    v_and_b32 v85, 0xffff0000, v62
    v_mfma_f32_16x16x32_bf16 v[228:231], a[16:19], a[44:47], 0
    ds_read_b64_tr_b16 a[70:71], v55 offset:9216
    v_lshlrev_b32 v86, 16, v63
    v_mfma_f32_16x16x32_bf16 v[232:235], a[20:23], a[44:47], 0
    ds_read_b64_tr_b16 a[72:73], v56 offset:8192
    v_and_b32 v87, 0xffff0000, v63
    v_lshlrev_b32 v88, 16, v64
    v_mfma_f32_16x16x32_bf16 v[200:203], a[20:23], a[40:43], 0
    ds_read_b64_tr_b16 a[74:75], v56 offset:9216
    v_and_b32 v89, 0xffff0000, v64
    v_mfma_f32_16x16x32_bf16 v[168:171], a[20:23], a[36:39], 0
    buffer_load_dwordx4 v42, s[16:19], s36 offen offset:2048 lds
    v_lshlrev_b32 v90, 16, v65
    v_mfma_f32_16x16x32_bf16 v[136:139], a[20:23], a[32:35], 0
    ds_read_b64_tr_b16 a[76:77], v57 offset:8192
    v_and_b32 v91, 0xffff0000, v65
    v_lshlrev_b32 v92, 16, v66
    v_mfma_f32_16x16x32_bf16 v[140:143], a[24:27], a[32:35], 0
    ds_read_b64_tr_b16 a[78:79], v57 offset:9216
    v_and_b32 v93, 0xffff0000, v66
    v_mfma_f32_16x16x32_bf16 v[172:175], a[24:27], a[36:39], 0
    v_lshlrev_b32 v94, 16, v67
    v_and_b32 v95, 0xffff0000, v67
    v_mfma_f32_16x16x32_bf16 v[204:207], a[24:27], a[40:43], 0
    buffer_load_dwordx4 v43, s[16:19], s36 offen offset:3072 lds
    v_lshlrev_b32 v96, 16, v68
    v_mfma_f32_16x16x32_bf16 v[236:239], a[24:27], a[44:47], 0
    v_and_b32 v97, 0xffff0000, v68
    v_lshlrev_b32 v98, 16, v69
    v_mfma_f32_16x16x32_bf16 v[240:243], a[28:31], a[44:47], 0
    v_and_b32 v99, 0xffff0000, v69
    v_add_f32 v109, v80, v81
    v_mfma_f32_16x16x32_bf16 v[208:211], a[28:31], a[40:43], 0
    v_add_f32 v110, v82, v83
    v_add_f32 v109, v109, v84
    v_mfma_f32_16x16x32_bf16 v[176:179], a[28:31], a[36:39], 0
    v_add_f32 v110, v110, v85
    v_add_f32 v109, v109, v86
    v_mfma_f32_16x16x32_bf16 v[144:147], a[28:31], a[32:35], 0
    v_add_f32 v110, v110, v87
    v_add_f32 v109, v109, v88
    s_waitcnt vmcnt(13) lgkmcnt(0)
    s_barrier
    v_mfma_f32_16x16x32_bf16 v[100:103], a[48:51], v[32:35], v[100:103]
    ds_read_b64_tr_b16 a[0:1], v50 offset:16384
    v_add_f32 v110, v110, v89
    v_mfma_f32_16x16x32_bf16 v[104:107], a[52:55], v[32:35], v[104:107]
    s_add_u32 m0, s39, 0
    s_mov_b32 s37, 1572864
    ds_read_b64_tr_b16 a[2:3], v50 offset:17408
    v_add_f32 v109, v109, v90
    v_mfma_f32_16x16x32_bf16 v[116:119], a[48:51], a[80:83], v[116:119]
    buffer_load_dwordx4 v44, s[20:23], s37 offen offset:0 lds
    v_mfma_f32_16x16x32_bf16 v[148:151], a[48:51], a[84:87], v[148:151]
    ds_read_b128 a[32:35], v48 offset:8192
    v_add_f32 v110, v110, v91
    v_mfma_f32_16x16x32_bf16 v[180:183], a[48:51], a[88:91], v[180:183]
    ds_read_b128 a[36:39], v48 offset:10240
    v_add_f32 v109, v109, v92
    v_mfma_f32_16x16x32_bf16 v[212:215], a[48:51], a[92:95], v[212:215]
    ds_read_b128 a[40:43], v48 offset:12288
    v_add_f32 v110, v110, v93
    v_mfma_f32_16x16x32_bf16 v[216:219], a[52:55], a[92:95], v[216:219]
    ds_read_b128 a[44:47], v48 offset:14336
    v_add_f32 v109, v109, v94
    v_mfma_f32_16x16x32_bf16 v[184:187], a[52:55], a[88:91], v[184:187]
    buffer_load_dwordx4 v45, s[20:23], s37 offen offset:1024 lds
    v_add_f32 v110, v110, v95
    v_mfma_f32_16x16x32_bf16 v[152:155], a[52:55], a[84:87], v[152:155]
    ds_read_b64_tr_b16 a[4:5], v51 offset:16384
    v_add_f32 v109, v109, v96
    v_add_f32 v110, v110, v97
    v_mfma_f32_16x16x32_bf16 v[120:123], a[52:55], a[80:83], v[120:123]
    ds_read_b64_tr_b16 a[6:7], v51 offset:17408
    v_add_f32 v109, v109, v98
    v_mfma_f32_16x16x32_bf16 v[124:127], a[56:59], a[80:83], v[124:127]
    ds_read_b64_tr_b16 a[8:9], v52 offset:16384
    v_add_f32 v110, v110, v99
    v_mfma_f32_16x16x32_bf16 v[156:159], a[56:59], a[84:87], v[156:159]
    ds_read_b64_tr_b16 a[10:11], v52 offset:17408
    v_add_f32 v109, v109, v110
    v_mfma_f32_16x16x32_bf16 v[188:191], a[56:59], a[88:91], v[188:191]
    buffer_load_dwordx4 v46, s[20:23], s37 offen offset:2048 lds
    v_add_f32_dpp v109, v109, v109 quad_perm:[1,0,3,2] row_mask:0xf bank_mask:0xf
    v_mfma_f32_16x16x32_bf16 v[220:223], a[56:59], a[92:95], v[220:223]
    ds_read_b64_tr_b16 a[12:13], v53 offset:16384
    v_add_f32_dpp v109, v109, v109 quad_perm:[2,3,0,1] row_mask:0xf bank_mask:0xf
    v_mfma_f32_16x16x32_bf16 v[224:227], a[60:63], a[92:95], v[224:227]
    ds_read_b64_tr_b16 a[14:15], v53 offset:17408
    v_add_f32_dpp v109, v109, v109 row_half_mirror row_mask:0xf bank_mask:0xf
    v_mfma_f32_16x16x32_bf16 v[192:195], a[60:63], a[88:91], v[192:195]
    ds_read_b64_tr_b16 a[16:17], v54 offset:16384
    v_add_f32_dpp v109, v109, v109 row_mirror row_mask:0xf bank_mask:0xf
    v_mov_b32 v110, v109
    v_mfma_f32_16x16x32_bf16 v[160:163], a[60:63], a[84:87], v[160:163]
    ds_read_b64_tr_b16 a[18:19], v54 offset:17408
    v_permlane16_swap_b32 v109, v110
    v_add_f32 v109, v109, v110
    v_mul_f32 v111, 0x3acccccd, v109
    v_mfma_f32_16x16x32_bf16 v[128:131], a[60:63], a[80:83], v[128:131]
    buffer_load_dwordx4 v47, s[20:23], s37 offen offset:3072 lds
    v_sub_f32 v60, v80, v111
    v_mfma_f32_16x16x32_bf16 v[132:135], a[64:67], a[80:83], v[132:135]
    ds_read_b64_tr_b16 a[20:21], v55 offset:16384
    v_mul_f32 v109, v60, v60
    v_mfma_f32_16x16x32_bf16 v[164:167], a[64:67], a[84:87], v[164:167]
    ds_read_b64_tr_b16 a[22:23], v55 offset:17408
    v_sub_f32 v61, v81, v111
    v_mul_f32 v112, v61, v61
    v_mfma_f32_16x16x32_bf16 v[196:199], a[64:67], a[88:91], v[196:199]
    ds_read_b64_tr_b16 a[24:25], v56 offset:16384
    v_sub_f32 v60, v82, v111
    v_mfma_f32_16x16x32_bf16 v[228:231], a[64:67], a[92:95], v[228:231]
    s_add_u32 m0, s38, 0
    s_mov_b32 s36, 384
    ds_read_b64_tr_b16 a[26:27], v56 offset:17408
    v_fmac_f32 v109, v60, v60
    v_mfma_f32_16x16x32_bf16 v[232:235], a[68:71], a[92:95], v[232:235]
    buffer_load_dwordx4 v36, s[16:19], s36 offen offset:0 lds
    v_sub_f32 v61, v83, v111
    v_fmac_f32 v112, v61, v61
    v_mfma_f32_16x16x32_bf16 v[200:203], a[68:71], a[88:91], v[200:203]
    ds_read_b64_tr_b16 a[28:29], v57 offset:16384
    v_sub_f32 v60, v84, v111
    v_mfma_f32_16x16x32_bf16 v[168:171], a[68:71], a[84:87], v[168:171]
    ds_read_b64_tr_b16 a[30:31], v57 offset:17408
    v_fmac_f32 v109, v60, v60
    v_mfma_f32_16x16x32_bf16 v[136:139], a[68:71], a[80:83], v[136:139]
    v_sub_f32 v61, v85, v111
    v_fmac_f32 v112, v61, v61
    v_mfma_f32_16x16x32_bf16 v[140:143], a[72:75], a[80:83], v[140:143]
    v_sub_f32 v60, v86, v111
    v_fmac_f32 v109, v60, v60
    v_mfma_f32_16x16x32_bf16 v[172:175], a[72:75], a[84:87], v[172:175]
    buffer_load_dwordx4 v37, s[16:19], s36 offen offset:1024 lds
    v_sub_f32 v61, v87, v111
    v_mfma_f32_16x16x32_bf16 v[204:207], a[72:75], a[88:91], v[204:207]
    v_fmac_f32 v112, v61, v61
    v_sub_f32 v60, v88, v111
    v_mfma_f32_16x16x32_bf16 v[236:239], a[72:75], a[92:95], v[236:239]
    v_fmac_f32 v109, v60, v60
    v_sub_f32 v61, v89, v111
    v_mfma_f32_16x16x32_bf16 v[240:243], a[76:79], a[92:95], v[240:243]
    v_fmac_f32 v112, v61, v61
    v_sub_f32 v60, v90, v111
    v_mfma_f32_16x16x32_bf16 v[208:211], a[76:79], a[88:91], v[208:211]
    v_fmac_f32 v109, v60, v60
    v_sub_f32 v61, v91, v111
    v_mfma_f32_16x16x32_bf16 v[176:179], a[76:79], a[84:87], v[176:179]
    v_fmac_f32 v112, v61, v61
    v_sub_f32 v60, v92, v111
    v_mfma_f32_16x16x32_bf16 v[144:147], a[76:79], a[80:83], v[144:147]
    v_fmac_f32 v109, v60, v60
    v_sub_f32 v61, v93, v111
    s_waitcnt lgkmcnt(0)
    v_mfma_f32_16x16x32_bf16 v[100:103], a[0:3], v[32:35], v[100:103]
    ds_read_b64_tr_b16 a[48:49], v50 offset:24576
    v_fmac_f32 v112, v61, v61
    v_mfma_f32_16x16x32_bf16 v[104:107], a[4:7], v[32:35], v[104:107]
    ds_read_b64_tr_b16 a[50:51], v50 offset:25600
    v_sub_f32 v60, v94, v111
    v_mfma_f32_16x16x32_bf16 v[116:119], a[0:3], a[32:35], v[116:119]
    buffer_load_dwordx4 v38, s[16:19], s36 offen offset:2048 lds
    v_mfma_f32_16x16x32_bf16 v[148:151], a[0:3], a[36:39], v[148:151]
    ds_read_b128 a[80:83], v49 offset:8192
    v_fmac_f32 v109, v60, v60
    v_mfma_f32_16x16x32_bf16 v[180:183], a[0:3], a[40:43], v[180:183]
    ds_read_b128 a[84:87], v49 offset:10240
    v_sub_f32 v61, v95, v111
    v_mfma_f32_16x16x32_bf16 v[212:215], a[0:3], a[44:47], v[212:215]
    ds_read_b128 a[88:91], v49 offset:12288
    v_fmac_f32 v112, v61, v61
    v_mfma_f32_16x16x32_bf16 v[216:219], a[4:7], a[44:47], v[216:219]
    ds_read_b128 a[92:95], v49 offset:14336
    v_sub_f32 v60, v96, v111
    v_mfma_f32_16x16x32_bf16 v[184:187], a[4:7], a[40:43], v[184:187]
    buffer_load_dwordx4 v39, s[16:19], s36 offen offset:3072 lds
    v_fmac_f32 v109, v60, v60
    v_mfma_f32_16x16x32_bf16 v[152:155], a[4:7], a[36:39], v[152:155]
    ds_read_b64_tr_b16 a[52:53], v51 offset:24576
    v_sub_f32 v61, v97, v111
    v_mfma_f32_16x16x32_bf16 v[120:123], a[4:7], a[32:35], v[120:123]
    ds_read_b64_tr_b16 a[54:55], v51 offset:25600
    v_fmac_f32 v112, v61, v61
    v_mfma_f32_16x16x32_bf16 v[124:127], a[8:11], a[32:35], v[124:127]
    ds_read_b64_tr_b16 a[56:57], v52 offset:24576
    v_sub_f32 v60, v98, v111
    v_mfma_f32_16x16x32_bf16 v[156:159], a[8:11], a[36:39], v[156:159]
    s_add_u32 m0, s38, 4096
    ds_read_b64_tr_b16 a[58:59], v52 offset:25600
    v_fmac_f32 v109, v60, v60
    v_sub_f32 v61, v99, v111
    v_mfma_f32_16x16x32_bf16 v[188:191], a[8:11], a[40:43], v[188:191]
    buffer_load_dwordx4 v40, s[16:19], s36 offen offset:0 lds
    v_fmac_f32 v112, v61, v61
    v_mfma_f32_16x16x32_bf16 v[220:223], a[8:11], a[44:47], v[220:223]
    ds_read_b64_tr_b16 a[60:61], v53 offset:24576
    v_add_f32 v109, v109, v112
    v_mfma_f32_16x16x32_bf16 v[224:227], a[12:15], a[44:47], v[224:227]
    ds_read_b64_tr_b16 a[62:63], v53 offset:25600
    v_add_f32_dpp v109, v109, v109 quad_perm:[1,0,3,2] row_mask:0xf bank_mask:0xf
    v_mfma_f32_16x16x32_bf16 v[192:195], a[12:15], a[40:43], v[192:195]
    ds_read_b64_tr_b16 a[64:65], v54 offset:24576
    v_add_f32_dpp v109, v109, v109 quad_perm:[2,3,0,1] row_mask:0xf bank_mask:0xf
    v_mfma_f32_16x16x32_bf16 v[160:163], a[12:15], a[36:39], v[160:163]
    ds_read_b64_tr_b16 a[66:67], v54 offset:25600
    v_add_f32_dpp v109, v109, v109 row_half_mirror row_mask:0xf bank_mask:0xf
    v_mfma_f32_16x16x32_bf16 v[128:131], a[12:15], a[32:35], v[128:131]
    buffer_load_dwordx4 v41, s[16:19], s36 offen offset:1024 lds
    v_add_f32_dpp v109, v109, v109 row_mirror row_mask:0xf bank_mask:0xf
    v_mov_b32 v110, v109
    v_mfma_f32_16x16x32_bf16 v[132:135], a[16:19], a[32:35], v[132:135]
    ds_read_b64_tr_b16 a[68:69], v55 offset:24576
    v_permlane16_swap_b32 v109, v110
    v_add_f32 v109, v109, v110
    v_mfma_f32_16x16x32_bf16 v[164:167], a[16:19], a[36:39], v[164:167]
    ds_read_b64_tr_b16 a[70:71], v55 offset:25600
    v_mul_f32 v109, 0x3acccccd, v109
    v_cvt_pk_bf16_f32 v110, v111, v109
    v_mfma_f32_16x16x32_bf16 v[196:199], a[16:19], a[40:43], v[196:199]
    ds_read_b64_tr_b16 a[72:73], v56 offset:24576
    v_lshlrev_b32 v111, 16, v110
    v_mfma_f32_16x16x32_bf16 v[228:231], a[16:19], a[44:47], v[228:231]
    ds_read_b64_tr_b16 a[74:75], v56 offset:25600
    v_and_b32 v109, 0xffff0000, v110
    v_mfma_f32_16x16x32_bf16 v[232:235], a[20:23], a[44:47], v[232:235]
    buffer_load_dwordx4 v42, s[16:19], s36 offen offset:2048 lds
    v_add_f32 v109, 0x3727c5ac, v109
    v_cvt_pk_bf16_f32 v109, v109, v109
    v_mfma_f32_16x16x32_bf16 v[200:203], a[20:23], a[40:43], v[200:203]
    ds_read_b64_tr_b16 a[76:77], v57 offset:24576
    v_lshlrev_b32 v109, 16, v109
    v_mfma_f32_16x16x32_bf16 v[168:171], a[20:23], a[36:39], v[168:171]
    ds_read_b64_tr_b16 a[78:79], v57 offset:25600
    v_sqrt_f32 v109, v109
    v_mfma_f32_16x16x32_bf16 v[136:139], a[20:23], a[32:35], v[136:139]
    v_sub_f32 v80, v80, v111
    v_sub_f32 v81, v81, v111
    v_mfma_f32_16x16x32_bf16 v[140:143], a[24:27], a[32:35], v[140:143]
    v_sub_f32 v82, v82, v111
    v_sub_f32 v83, v83, v111
    v_mfma_f32_16x16x32_bf16 v[172:175], a[24:27], a[36:39], v[172:175]
    buffer_load_dwordx4 v43, s[16:19], s36 offen offset:3072 lds
    v_sub_f32 v84, v84, v111
    v_mfma_f32_16x16x32_bf16 v[204:207], a[24:27], a[40:43], v[204:207]
    v_sub_f32 v85, v85, v111
    v_sub_f32 v86, v86, v111
    v_mfma_f32_16x16x32_bf16 v[236:239], a[24:27], a[44:47], v[236:239]
    v_sub_f32 v87, v87, v111
    v_sub_f32 v88, v88, v111
    v_mfma_f32_16x16x32_bf16 v[240:243], a[28:31], a[44:47], v[240:243]
    v_sub_f32 v89, v89, v111
    v_sub_f32 v90, v90, v111
    v_mfma_f32_16x16x32_bf16 v[208:211], a[28:31], a[40:43], v[208:211]
    v_sub_f32 v91, v91, v111
    v_sub_f32 v92, v92, v111
    v_mfma_f32_16x16x32_bf16 v[176:179], a[28:31], a[36:39], v[176:179]
    v_sub_f32 v93, v93, v111
    v_sub_f32 v94, v94, v111
    v_mfma_f32_16x16x32_bf16 v[144:147], a[28:31], a[32:35], v[144:147]
    v_sub_f32 v95, v95, v111
    v_sub_f32 v96, v96, v111
    s_waitcnt vmcnt(12) lgkmcnt(0)
    s_barrier
    v_mfma_f32_16x16x32_bf16 v[100:103], a[48:51], v[32:35], v[100:103]
    ds_read_b64_tr_b16 a[0:1], v50 offset:32768
    v_sub_f32 v97, v97, v111
    v_mfma_f32_16x16x32_bf16 v[104:107], a[52:55], v[32:35], v[104:107]
    s_add_u32 m0, s39, 16384
    s_mov_b32 s37, 2097152
    ds_read_b64_tr_b16 a[2:3], v50 offset:33792
    v_sub_f32 v98, v98, v111
    v_mfma_f32_16x16x32_bf16 v[116:119], a[48:51], a[80:83], v[116:119]
    buffer_load_dwordx4 v44, s[20:23], s37 offen offset:0 lds
    v_mfma_f32_16x16x32_bf16 v[148:151], a[48:51], a[84:87], v[148:151]
    ds_read_b128 a[32:35], v48 offset:16384
    v_sub_f32 v99, v99, v111
    v_mfma_f32_16x16x32_bf16 v[180:183], a[48:51], a[88:91], v[180:183]
    ds_read_b128 a[36:39], v48 offset:18432
    v_cvt_pk_bf16_f32 v109, v109, v109
    v_mfma_f32_16x16x32_bf16 v[212:215], a[48:51], a[92:95], v[212:215]
    ds_read_b128 a[40:43], v48 offset:20480
    v_lshlrev_b32 v109, 16, v109
    v_mfma_f32_16x16x32_bf16 v[216:219], a[52:55], a[92:95], v[216:219]
    ds_read_b128 a[44:47], v48 offset:22528
    v_rcp_f32 v112, v109
    v_mfma_f32_16x16x32_bf16 v[184:187], a[52:55], a[88:91], v[184:187]
    buffer_load_dwordx4 v45, s[20:23], s37 offen offset:1024 lds
    v_cvt_pk_bf16_f32 v60, v80, v81
    v_mfma_f32_16x16x32_bf16 v[152:155], a[52:55], a[84:87], v[152:155]
    ds_read_b64_tr_b16 a[4:5], v51 offset:32768
    v_cvt_pk_bf16_f32 v61, v82, v83
    v_mfma_f32_16x16x32_bf16 v[120:123], a[52:55], a[80:83], v[120:123]
    ds_read_b64_tr_b16 a[6:7], v51 offset:33792
    v_cvt_pk_bf16_f32 v62, v84, v85
    v_mfma_f32_16x16x32_bf16 v[124:127], a[56:59], a[80:83], v[124:127]
    ds_read_b64_tr_b16 a[8:9], v52 offset:32768
    v_cvt_pk_bf16_f32 v63, v86, v87
    v_mfma_f32_16x16x32_bf16 v[156:159], a[56:59], a[84:87], v[156:159]
    ds_read_b64_tr_b16 a[10:11], v52 offset:33792
    v_cvt_pk_bf16_f32 v64, v88, v89
    v_cvt_pk_bf16_f32 v65, v90, v91
    v_mfma_f32_16x16x32_bf16 v[188:191], a[56:59], a[88:91], v[188:191]
    buffer_load_dwordx4 v46, s[20:23], s37 offen offset:2048 lds
    v_cvt_pk_bf16_f32 v66, v92, v93
    v_mfma_f32_16x16x32_bf16 v[220:223], a[56:59], a[92:95], v[220:223]
    ds_read_b64_tr_b16 a[12:13], v53 offset:32768
    v_cvt_pk_bf16_f32 v67, v94, v95
    v_mfma_f32_16x16x32_bf16 v[224:227], a[60:63], a[92:95], v[224:227]
    ds_read_b64_tr_b16 a[14:15], v53 offset:33792
    v_cvt_pk_bf16_f32 v68, v96, v97
    v_cvt_pk_bf16_f32 v69, v98, v99
    v_mfma_f32_16x16x32_bf16 v[192:195], a[60:63], a[88:91], v[192:195]
    ds_read_b64_tr_b16 a[16:17], v54 offset:32768
    v_lshlrev_b32 v80, 16, v60
    v_mfma_f32_16x16x32_bf16 v[160:163], a[60:63], a[84:87], v[160:163]
    ds_read_b64_tr_b16 a[18:19], v54 offset:33792
    v_and_b32 v81, 0xffff0000, v60
    v_lshlrev_b32 v82, 16, v61
    v_mfma_f32_16x16x32_bf16 v[128:131], a[60:63], a[80:83], v[128:131]
    buffer_load_dwordx4 v47, s[20:23], s37 offen offset:3072 lds
    v_and_b32 v83, 0xffff0000, v61
    v_mfma_f32_16x16x32_bf16 v[132:135], a[64:67], a[80:83], v[132:135]
    ds_read_b64_tr_b16 a[20:21], v55 offset:32768
    v_lshlrev_b32 v84, 16, v62
    v_mfma_f32_16x16x32_bf16 v[164:167], a[64:67], a[84:87], v[164:167]
    ds_read_b64_tr_b16 a[22:23], v55 offset:33792
    v_and_b32 v85, 0xffff0000, v62
    v_lshlrev_b32 v86, 16, v63
    v_mfma_f32_16x16x32_bf16 v[196:199], a[64:67], a[88:91], v[196:199]
    ds_read_b64_tr_b16 a[24:25], v56 offset:32768
    v_and_b32 v87, 0xffff0000, v63
    v_mfma_f32_16x16x32_bf16 v[228:231], a[64:67], a[92:95], v[228:231]
    s_add_u32 m0, s38, 8192
    s_mov_b32 s36, 512
    ds_read_b64_tr_b16 a[26:27], v56 offset:33792
    v_lshlrev_b32 v88, 16, v64
    v_mfma_f32_16x16x32_bf16 v[232:235], a[68:71], a[92:95], v[232:235]
    buffer_load_dwordx4 v36, s[16:19], s36 offen offset:0 lds
    v_and_b32 v89, 0xffff0000, v64
    v_lshlrev_b32 v90, 16, v65
    v_mfma_f32_16x16x32_bf16 v[200:203], a[68:71], a[88:91], v[200:203]
    ds_read_b64_tr_b16 a[28:29], v57 offset:32768
    v_and_b32 v91, 0xffff0000, v65
    v_mfma_f32_16x16x32_bf16 v[168:171], a[68:71], a[84:87], v[168:171]
    ds_read_b64_tr_b16 a[30:31], v57 offset:33792
    v_lshlrev_b32 v92, 16, v66
    v_mfma_f32_16x16x32_bf16 v[136:139], a[68:71], a[80:83], v[136:139]
    v_and_b32 v93, 0xffff0000, v66
    v_lshlrev_b32 v94, 16, v67
    v_mfma_f32_16x16x32_bf16 v[140:143], a[72:75], a[80:83], v[140:143]
    v_and_b32 v95, 0xffff0000, v67
    v_lshlrev_b32 v96, 16, v68
    v_mfma_f32_16x16x32_bf16 v[172:175], a[72:75], a[84:87], v[172:175]
    buffer_load_dwordx4 v37, s[16:19], s36 offen offset:1024 lds
    v_and_b32 v97, 0xffff0000, v68
    v_mfma_f32_16x16x32_bf16 v[204:207], a[72:75], a[88:91], v[204:207]
    v_lshlrev_b32 v98, 16, v69
    v_and_b32 v99, 0xffff0000, v69
    v_mfma_f32_16x16x32_bf16 v[236:239], a[72:75], a[92:95], v[236:239]
    v_mul_f32 v80, v80, v112
    v_mul_f32 v81, v81, v112
    v_mfma_f32_16x16x32_bf16 v[240:243], a[76:79], a[92:95], v[240:243]
    v_mul_f32 v82, v82, v112
    v_mul_f32 v83, v83, v112
    v_mfma_f32_16x16x32_bf16 v[208:211], a[76:79], a[88:91], v[208:211]
    v_mul_f32 v84, v84, v112
    v_mul_f32 v85, v85, v112
    v_mfma_f32_16x16x32_bf16 v[176:179], a[76:79], a[84:87], v[176:179]
    v_mul_f32 v86, v86, v112
    v_mul_f32 v87, v87, v112
    v_mfma_f32_16x16x32_bf16 v[144:147], a[76:79], a[80:83], v[144:147]
    v_mul_f32 v88, v88, v112
    v_mul_f32 v89, v89, v112
    s_waitcnt lgkmcnt(0)
    v_mfma_f32_16x16x32_bf16 v[100:103], a[0:3], v[32:35], v[100:103]
    ds_read_b64_tr_b16 a[48:49], v50 offset:40960
    v_mul_f32 v90, v90, v112
    v_mfma_f32_16x16x32_bf16 v[104:107], a[4:7], v[32:35], v[104:107]
    ds_read_b64_tr_b16 a[50:51], v50 offset:41984
    v_mul_f32 v91, v91, v112
    v_mfma_f32_16x16x32_bf16 v[116:119], a[0:3], a[32:35], v[116:119]
    buffer_load_dwordx4 v38, s[16:19], s36 offen offset:2048 lds
    v_mfma_f32_16x16x32_bf16 v[148:151], a[0:3], a[36:39], v[148:151]
    ds_read_b128 a[80:83], v49 offset:16384
    v_mul_f32 v92, v92, v112
    v_mfma_f32_16x16x32_bf16 v[180:183], a[0:3], a[40:43], v[180:183]
    ds_read_b128 a[84:87], v49 offset:18432
    v_mul_f32 v93, v93, v112
    v_mfma_f32_16x16x32_bf16 v[212:215], a[0:3], a[44:47], v[212:215]
    ds_read_b128 a[88:91], v49 offset:20480
    v_mul_f32 v94, v94, v112
    v_mfma_f32_16x16x32_bf16 v[216:219], a[4:7], a[44:47], v[216:219]
    ds_read_b128 a[92:95], v49 offset:22528
    v_mul_f32 v95, v95, v112
    v_mfma_f32_16x16x32_bf16 v[184:187], a[4:7], a[40:43], v[184:187]
    buffer_load_dwordx4 v39, s[16:19], s36 offen offset:3072 lds
    v_mul_f32 v96, v96, v112
    v_mfma_f32_16x16x32_bf16 v[152:155], a[4:7], a[36:39], v[152:155]
    ds_read_b64_tr_b16 a[52:53], v51 offset:40960
    v_mul_f32 v97, v97, v112
    v_mfma_f32_16x16x32_bf16 v[120:123], a[4:7], a[32:35], v[120:123]
    ds_read_b64_tr_b16 a[54:55], v51 offset:41984
    v_mul_f32 v98, v98, v112
    v_mfma_f32_16x16x32_bf16 v[124:127], a[8:11], a[32:35], v[124:127]
    ds_read_b64_tr_b16 a[56:57], v52 offset:40960
    v_mul_f32 v99, v99, v112
    v_mfma_f32_16x16x32_bf16 v[156:159], a[8:11], a[36:39], v[156:159]
    s_add_u32 m0, s38, 12288
    ds_read_b64_tr_b16 a[58:59], v52 offset:41984
    v_cvt_pk_bf16_f32 v60, v80, v81
    v_cvt_pk_bf16_f32 v61, v82, v83
    v_mfma_f32_16x16x32_bf16 v[188:191], a[8:11], a[40:43], v[188:191]
    buffer_load_dwordx4 v40, s[16:19], s36 offen offset:0 lds
    v_cvt_pk_bf16_f32 v62, v84, v85
    v_mfma_f32_16x16x32_bf16 v[220:223], a[8:11], a[44:47], v[220:223]
    ds_read_b64_tr_b16 a[60:61], v53 offset:40960
    v_cvt_pk_bf16_f32 v63, v86, v87
    v_mfma_f32_16x16x32_bf16 v[224:227], a[12:15], a[44:47], v[224:227]
    ds_read_b64_tr_b16 a[62:63], v53 offset:41984
    v_cvt_pk_bf16_f32 v64, v88, v89
    v_cvt_pk_bf16_f32 v65, v90, v91
    v_mfma_f32_16x16x32_bf16 v[192:195], a[12:15], a[40:43], v[192:195]
    ds_read_b64_tr_b16 a[64:65], v54 offset:40960
    v_cvt_pk_bf16_f32 v66, v92, v93
    v_mfma_f32_16x16x32_bf16 v[160:163], a[12:15], a[36:39], v[160:163]
    ds_read_b64_tr_b16 a[66:67], v54 offset:41984
    v_cvt_pk_bf16_f32 v67, v94, v95
    v_cvt_pk_bf16_f32 v68, v96, v97
    v_mfma_f32_16x16x32_bf16 v[128:131], a[12:15], a[32:35], v[128:131]
    buffer_load_dwordx4 v41, s[16:19], s36 offen offset:1024 lds
    v_cvt_pk_bf16_f32 v69, v98, v99
    v_mfma_f32_16x16x32_bf16 v[132:135], a[16:19], a[32:35], v[132:135]
    ds_read_b64_tr_b16 a[68:69], v55 offset:40960
    v_mov_b32 v109, 0
    v_mfma_f32_16x16x32_bf16 v[164:167], a[16:19], a[36:39], v[164:167]
    ds_read_b64_tr_b16 a[70:71], v55 offset:41984
    v_dot2c_f32_bf16 v109, v60, v70
    v_dot2c_f32_bf16 v109, v61, v71
    v_dot2c_f32_bf16 v109, v62, v72
    v_dot2c_f32_bf16 v109, v63, v73
    v_dot2c_f32_bf16 v109, v64, v74
    v_dot2c_f32_bf16 v109, v65, v75
    v_dot2c_f32_bf16 v109, v66, v76
    v_dot2c_f32_bf16 v109, v67, v77
    v_dot2c_f32_bf16 v109, v68, v78
    v_dot2c_f32_bf16 v109, v69, v79
    s_nop 2
    v_mfma_f32_16x16x32_bf16 v[196:199], a[16:19], a[40:43], v[196:199]
    ds_read_b64_tr_b16 a[72:73], v56 offset:40960
    v_add_f32_dpp v109, v109, v109 quad_perm:[1,0,3,2] row_mask:0xf bank_mask:0xf
    v_mfma_f32_16x16x32_bf16 v[228:231], a[16:19], a[44:47], v[228:231]
    ds_read_b64_tr_b16 a[74:75], v56 offset:41984
    v_add_f32_dpp v109, v109, v109 quad_perm:[2,3,0,1] row_mask:0xf bank_mask:0xf
    v_mfma_f32_16x16x32_bf16 v[232:235], a[20:23], a[44:47], v[232:235]
    buffer_load_dwordx4 v42, s[16:19], s36 offen offset:2048 lds
    v_add_f32_dpp v109, v109, v109 row_half_mirror row_mask:0xf bank_mask:0xf
    v_mfma_f32_16x16x32_bf16 v[200:203], a[20:23], a[40:43], v[200:203]
    ds_read_b64_tr_b16 a[76:77], v57 offset:40960
    v_add_f32_dpp v109, v109, v109 row_mirror row_mask:0xf bank_mask:0xf
    v_mov_b32 v110, v109
    v_mfma_f32_16x16x32_bf16 v[168:171], a[20:23], a[36:39], v[168:171]
    ds_read_b64_tr_b16 a[78:79], v57 offset:41984
    v_permlane16_swap_b32 v109, v110
    v_add_f32 v109, v109, v110
    v_mfma_f32_16x16x32_bf16 v[136:139], a[20:23], a[32:35], v[136:139]
    v_cvt_pk_bf16_f32 v109, v109, v109
    v_lshlrev_b32 v109, 16, v109
    v_mfma_f32_16x16x32_bf16 v[140:143], a[24:27], a[32:35], v[140:143]
    v_ashrrev_i32 v110, 31, v109
    v_or_b32 v110, 0x80000000, v110
    v_mfma_f32_16x16x32_bf16 v[172:175], a[24:27], a[36:39], v[172:175]
    buffer_load_dwordx4 v43, s[16:19], s36 offen offset:3072 lds
    v_xor_b32 v109, v109, v110
    v_mfma_f32_16x16x32_bf16 v[204:207], a[24:27], a[40:43], v[204:207]
    v_and_b32 v109, 0xffff0000, v109
    v_sub_u32 v110, 0xffff, v108
    v_mfma_f32_16x16x32_bf16 v[236:239], a[24:27], a[44:47], v[236:239]
    v_or_b32 v62, v109, v110
    v_mov_b32 v60, v111
    v_mfma_f32_16x16x32_bf16 v[240:243], a[28:31], a[44:47], v[240:243]
    v_mov_b32 v61, v112
    v_mov_b32 v63, 0
    v_mfma_f32_16x16x32_bf16 v[208:211], a[28:31], a[40:43], v[208:211]
    v_lshlrev_b32 v110, 4, v108
    v_mfma_f32_16x16x32_bf16 v[176:179], a[28:31], a[36:39], v[176:179]
    s_mov_b32 s40, 0x280000
    s_mov_b32 exec_lo, 1
    s_mov_b32 exec_hi, 1
    buffer_store_dwordx4 v[60:63], v110, s[76:79], s40 offen sc1
    s_mov_b64 exec, -1
    v_mfma_f32_16x16x32_bf16 v[144:147], a[28:31], a[32:35], v[144:147]
    s_waitcnt vmcnt(13) lgkmcnt(0)
    s_barrier
    v_mfma_f32_16x16x32_bf16 v[100:103], a[48:51], v[32:35], v[100:103]
    ds_read_b64_tr_b16 a[0:1], v50 offset:0
    v_mfma_f32_16x16x32_bf16 v[104:107], a[52:55], v[32:35], v[104:107]
    s_add_u32 m0, s39, 32768
    s_mov_b32 s37, 2621440
    ds_read_b64_tr_b16 a[2:3], v50 offset:1024
    v_mfma_f32_16x16x32_bf16 v[116:119], a[48:51], a[80:83], v[116:119]
    buffer_load_dwordx4 v44, s[20:23], s37 offen offset:0 lds
    v_mfma_f32_16x16x32_bf16 v[148:151], a[48:51], a[84:87], v[148:151]
    ds_read_b128 a[32:35], v48 offset:0
    v_mfma_f32_16x16x32_bf16 v[180:183], a[48:51], a[88:91], v[180:183]
    ds_read_b128 a[36:39], v48 offset:2048
    v_mfma_f32_16x16x32_bf16 v[212:215], a[48:51], a[92:95], v[212:215]
    ds_read_b128 a[40:43], v48 offset:4096
    v_mfma_f32_16x16x32_bf16 v[216:219], a[52:55], a[92:95], v[216:219]
    ds_read_b128 a[44:47], v48 offset:6144
    v_mfma_f32_16x16x32_bf16 v[184:187], a[52:55], a[88:91], v[184:187]
    buffer_load_dwordx4 v45, s[20:23], s37 offen offset:1024 lds
    v_mfma_f32_16x16x32_bf16 v[152:155], a[52:55], a[84:87], v[152:155]
    ds_read_b64_tr_b16 a[4:5], v51 offset:0
    v_mfma_f32_16x16x32_bf16 v[120:123], a[52:55], a[80:83], v[120:123]
    ds_read_b64_tr_b16 a[6:7], v51 offset:1024
    v_mfma_f32_16x16x32_bf16 v[124:127], a[56:59], a[80:83], v[124:127]
    ds_read_b64_tr_b16 a[8:9], v52 offset:0
    v_mfma_f32_16x16x32_bf16 v[156:159], a[56:59], a[84:87], v[156:159]
    ds_read_b64_tr_b16 a[10:11], v52 offset:1024
    v_mfma_f32_16x16x32_bf16 v[188:191], a[56:59], a[88:91], v[188:191]
    buffer_load_dwordx4 v46, s[20:23], s37 offen offset:2048 lds
    v_mfma_f32_16x16x32_bf16 v[220:223], a[56:59], a[92:95], v[220:223]
    ds_read_b64_tr_b16 a[12:13], v53 offset:0
    v_mfma_f32_16x16x32_bf16 v[224:227], a[60:63], a[92:95], v[224:227]
    ds_read_b64_tr_b16 a[14:15], v53 offset:1024
    v_mfma_f32_16x16x32_bf16 v[192:195], a[60:63], a[88:91], v[192:195]
    ds_read_b64_tr_b16 a[16:17], v54 offset:0
    v_mfma_f32_16x16x32_bf16 v[160:163], a[60:63], a[84:87], v[160:163]
    ds_read_b64_tr_b16 a[18:19], v54 offset:1024
    v_mfma_f32_16x16x32_bf16 v[128:131], a[60:63], a[80:83], v[128:131]
    buffer_load_dwordx4 v47, s[20:23], s37 offen offset:3072 lds
    v_mfma_f32_16x16x32_bf16 v[132:135], a[64:67], a[80:83], v[132:135]
    ds_read_b64_tr_b16 a[20:21], v55 offset:0
    v_mfma_f32_16x16x32_bf16 v[164:167], a[64:67], a[84:87], v[164:167]
    ds_read_b64_tr_b16 a[22:23], v55 offset:1024
    v_mfma_f32_16x16x32_bf16 v[196:199], a[64:67], a[88:91], v[196:199]
    ds_read_b64_tr_b16 a[24:25], v56 offset:0
    v_mfma_f32_16x16x32_bf16 v[228:231], a[64:67], a[92:95], v[228:231]
    s_add_u32 m0, s38, 16384
    s_mov_b32 s36, 640
    ds_read_b64_tr_b16 a[26:27], v56 offset:1024
    v_mfma_f32_16x16x32_bf16 v[232:235], a[68:71], a[92:95], v[232:235]
    buffer_load_dwordx4 v36, s[16:19], s36 offen offset:0 lds
    v_mfma_f32_16x16x32_bf16 v[200:203], a[68:71], a[88:91], v[200:203]
    ds_read_b64_tr_b16 a[28:29], v57 offset:0
    v_mfma_f32_16x16x32_bf16 v[168:171], a[68:71], a[84:87], v[168:171]
    ds_read_b64_tr_b16 a[30:31], v57 offset:1024
    v_mfma_f32_16x16x32_bf16 v[136:139], a[68:71], a[80:83], v[136:139]
    v_mfma_f32_16x16x32_bf16 v[140:143], a[72:75], a[80:83], v[140:143]
    v_mfma_f32_16x16x32_bf16 v[172:175], a[72:75], a[84:87], v[172:175]
    buffer_load_dwordx4 v37, s[16:19], s36 offen offset:1024 lds
    v_mfma_f32_16x16x32_bf16 v[204:207], a[72:75], a[88:91], v[204:207]
    v_mfma_f32_16x16x32_bf16 v[236:239], a[72:75], a[92:95], v[236:239]
    v_mfma_f32_16x16x32_bf16 v[240:243], a[76:79], a[92:95], v[240:243]
    v_mfma_f32_16x16x32_bf16 v[208:211], a[76:79], a[88:91], v[208:211]
    v_mfma_f32_16x16x32_bf16 v[176:179], a[76:79], a[84:87], v[176:179]
    v_mfma_f32_16x16x32_bf16 v[144:147], a[76:79], a[80:83], v[144:147]
    s_waitcnt lgkmcnt(0)
    v_mfma_f32_16x16x32_bf16 v[100:103], a[0:3], v[32:35], v[100:103]
    ds_read_b64_tr_b16 a[48:49], v50 offset:8192
    v_mfma_f32_16x16x32_bf16 v[104:107], a[4:7], v[32:35], v[104:107]
    ds_read_b64_tr_b16 a[50:51], v50 offset:9216
    v_mfma_f32_16x16x32_bf16 v[116:119], a[0:3], a[32:35], v[116:119]
    buffer_load_dwordx4 v38, s[16:19], s36 offen offset:2048 lds
    v_mfma_f32_16x16x32_bf16 v[148:151], a[0:3], a[36:39], v[148:151]
    ds_read_b128 a[80:83], v49 offset:0
    v_mfma_f32_16x16x32_bf16 v[180:183], a[0:3], a[40:43], v[180:183]
    ds_read_b128 a[84:87], v49 offset:2048
    v_mfma_f32_16x16x32_bf16 v[212:215], a[0:3], a[44:47], v[212:215]
    ds_read_b128 a[88:91], v49 offset:4096
    v_mfma_f32_16x16x32_bf16 v[216:219], a[4:7], a[44:47], v[216:219]
    ds_read_b128 a[92:95], v49 offset:6144
    v_mfma_f32_16x16x32_bf16 v[184:187], a[4:7], a[40:43], v[184:187]
    buffer_load_dwordx4 v39, s[16:19], s36 offen offset:3072 lds
    v_mfma_f32_16x16x32_bf16 v[152:155], a[4:7], a[36:39], v[152:155]
    ds_read_b64_tr_b16 a[52:53], v51 offset:8192
    v_mfma_f32_16x16x32_bf16 v[120:123], a[4:7], a[32:35], v[120:123]
    ds_read_b64_tr_b16 a[54:55], v51 offset:9216
    v_mfma_f32_16x16x32_bf16 v[124:127], a[8:11], a[32:35], v[124:127]
    ds_read_b64_tr_b16 a[56:57], v52 offset:8192
    v_mfma_f32_16x16x32_bf16 v[156:159], a[8:11], a[36:39], v[156:159]
    s_add_u32 m0, s38, 20480
    ds_read_b64_tr_b16 a[58:59], v52 offset:9216
    v_mfma_f32_16x16x32_bf16 v[188:191], a[8:11], a[40:43], v[188:191]
    buffer_load_dwordx4 v40, s[16:19], s36 offen offset:0 lds
    v_mfma_f32_16x16x32_bf16 v[220:223], a[8:11], a[44:47], v[220:223]
    ds_read_b64_tr_b16 a[60:61], v53 offset:8192
    v_mfma_f32_16x16x32_bf16 v[224:227], a[12:15], a[44:47], v[224:227]
    ds_read_b64_tr_b16 a[62:63], v53 offset:9216
    v_mfma_f32_16x16x32_bf16 v[192:195], a[12:15], a[40:43], v[192:195]
    ds_read_b64_tr_b16 a[64:65], v54 offset:8192
    v_mfma_f32_16x16x32_bf16 v[160:163], a[12:15], a[36:39], v[160:163]
    ds_read_b64_tr_b16 a[66:67], v54 offset:9216
    v_mfma_f32_16x16x32_bf16 v[128:131], a[12:15], a[32:35], v[128:131]
    buffer_load_dwordx4 v41, s[16:19], s36 offen offset:1024 lds
    v_mfma_f32_16x16x32_bf16 v[132:135], a[16:19], a[32:35], v[132:135]
    ds_read_b64_tr_b16 a[68:69], v55 offset:8192
    v_mfma_f32_16x16x32_bf16 v[164:167], a[16:19], a[36:39], v[164:167]
    ds_read_b64_tr_b16 a[70:71], v55 offset:9216
    v_mfma_f32_16x16x32_bf16 v[196:199], a[16:19], a[40:43], v[196:199]
    ds_read_b64_tr_b16 a[72:73], v56 offset:8192
    v_mfma_f32_16x16x32_bf16 v[228:231], a[16:19], a[44:47], v[228:231]
    ds_read_b64_tr_b16 a[74:75], v56 offset:9216
    v_mfma_f32_16x16x32_bf16 v[232:235], a[20:23], a[44:47], v[232:235]
    buffer_load_dwordx4 v42, s[16:19], s36 offen offset:2048 lds
    v_mfma_f32_16x16x32_bf16 v[200:203], a[20:23], a[40:43], v[200:203]
    ds_read_b64_tr_b16 a[76:77], v57 offset:8192
    v_mfma_f32_16x16x32_bf16 v[168:171], a[20:23], a[36:39], v[168:171]
    ds_read_b64_tr_b16 a[78:79], v57 offset:9216
    v_mfma_f32_16x16x32_bf16 v[136:139], a[20:23], a[32:35], v[136:139]
    v_mfma_f32_16x16x32_bf16 v[140:143], a[24:27], a[32:35], v[140:143]
    v_mfma_f32_16x16x32_bf16 v[172:175], a[24:27], a[36:39], v[172:175]
    buffer_load_dwordx4 v43, s[16:19], s36 offen offset:3072 lds
    v_mfma_f32_16x16x32_bf16 v[204:207], a[24:27], a[40:43], v[204:207]
    v_mfma_f32_16x16x32_bf16 v[236:239], a[24:27], a[44:47], v[236:239]
    v_mfma_f32_16x16x32_bf16 v[240:243], a[28:31], a[44:47], v[240:243]
    v_mfma_f32_16x16x32_bf16 v[208:211], a[28:31], a[40:43], v[208:211]
    v_mfma_f32_16x16x32_bf16 v[176:179], a[28:31], a[36:39], v[176:179]
    v_mfma_f32_16x16x32_bf16 v[144:147], a[28:31], a[32:35], v[144:147]
    s_waitcnt vmcnt(13) lgkmcnt(0)
    s_barrier
    v_mfma_f32_16x16x32_bf16 v[100:103], a[48:51], v[32:35], v[100:103]
    ds_read_b64_tr_b16 a[0:1], v50 offset:16384
    v_mfma_f32_16x16x32_bf16 v[104:107], a[52:55], v[32:35], v[104:107]
    s_add_u32 m0, s39, 0
    s_mov_b32 s37, 3145728
    ds_read_b64_tr_b16 a[2:3], v50 offset:17408
    v_mfma_f32_16x16x32_bf16 v[116:119], a[48:51], a[80:83], v[116:119]
    buffer_load_dwordx4 v44, s[20:23], s37 offen offset:0 lds
    v_mfma_f32_16x16x32_bf16 v[148:151], a[48:51], a[84:87], v[148:151]
    ds_read_b128 a[32:35], v48 offset:8192
    v_mfma_f32_16x16x32_bf16 v[180:183], a[48:51], a[88:91], v[180:183]
    ds_read_b128 a[36:39], v48 offset:10240
    v_mfma_f32_16x16x32_bf16 v[212:215], a[48:51], a[92:95], v[212:215]
    ds_read_b128 a[40:43], v48 offset:12288
    v_mfma_f32_16x16x32_bf16 v[216:219], a[52:55], a[92:95], v[216:219]
    ds_read_b128 a[44:47], v48 offset:14336
    v_mfma_f32_16x16x32_bf16 v[184:187], a[52:55], a[88:91], v[184:187]
    buffer_load_dwordx4 v45, s[20:23], s37 offen offset:1024 lds
    v_mfma_f32_16x16x32_bf16 v[152:155], a[52:55], a[84:87], v[152:155]
    ds_read_b64_tr_b16 a[4:5], v51 offset:16384
    v_mfma_f32_16x16x32_bf16 v[120:123], a[52:55], a[80:83], v[120:123]
    ds_read_b64_tr_b16 a[6:7], v51 offset:17408
    v_mfma_f32_16x16x32_bf16 v[124:127], a[56:59], a[80:83], v[124:127]
    ds_read_b64_tr_b16 a[8:9], v52 offset:16384
    v_mfma_f32_16x16x32_bf16 v[156:159], a[56:59], a[84:87], v[156:159]
    ds_read_b64_tr_b16 a[10:11], v52 offset:17408
    v_mfma_f32_16x16x32_bf16 v[188:191], a[56:59], a[88:91], v[188:191]
    buffer_load_dwordx4 v46, s[20:23], s37 offen offset:2048 lds
    v_mfma_f32_16x16x32_bf16 v[220:223], a[56:59], a[92:95], v[220:223]
    ds_read_b64_tr_b16 a[12:13], v53 offset:16384
    v_mfma_f32_16x16x32_bf16 v[224:227], a[60:63], a[92:95], v[224:227]
    ds_read_b64_tr_b16 a[14:15], v53 offset:17408
    v_mfma_f32_16x16x32_bf16 v[192:195], a[60:63], a[88:91], v[192:195]
    ds_read_b64_tr_b16 a[16:17], v54 offset:16384
    v_mfma_f32_16x16x32_bf16 v[160:163], a[60:63], a[84:87], v[160:163]
    ds_read_b64_tr_b16 a[18:19], v54 offset:17408
    v_mfma_f32_16x16x32_bf16 v[128:131], a[60:63], a[80:83], v[128:131]
    buffer_load_dwordx4 v47, s[20:23], s37 offen offset:3072 lds
    v_mfma_f32_16x16x32_bf16 v[132:135], a[64:67], a[80:83], v[132:135]
    ds_read_b64_tr_b16 a[20:21], v55 offset:16384
    v_mfma_f32_16x16x32_bf16 v[164:167], a[64:67], a[84:87], v[164:167]
    ds_read_b64_tr_b16 a[22:23], v55 offset:17408
    v_mfma_f32_16x16x32_bf16 v[196:199], a[64:67], a[88:91], v[196:199]
    ds_read_b64_tr_b16 a[24:25], v56 offset:16384
    v_mfma_f32_16x16x32_bf16 v[228:231], a[64:67], a[92:95], v[228:231]
    s_add_u32 m0, s38, 0
    s_mov_b32 s36, 768
    ds_read_b64_tr_b16 a[26:27], v56 offset:17408
    v_mfma_f32_16x16x32_bf16 v[232:235], a[68:71], a[92:95], v[232:235]
    buffer_load_dwordx4 v36, s[16:19], s36 offen offset:0 lds
    v_mfma_f32_16x16x32_bf16 v[200:203], a[68:71], a[88:91], v[200:203]
    ds_read_b64_tr_b16 a[28:29], v57 offset:16384
    v_mfma_f32_16x16x32_bf16 v[168:171], a[68:71], a[84:87], v[168:171]
    ds_read_b64_tr_b16 a[30:31], v57 offset:17408
    v_mfma_f32_16x16x32_bf16 v[136:139], a[68:71], a[80:83], v[136:139]
    v_mfma_f32_16x16x32_bf16 v[140:143], a[72:75], a[80:83], v[140:143]
    v_mfma_f32_16x16x32_bf16 v[172:175], a[72:75], a[84:87], v[172:175]
    buffer_load_dwordx4 v37, s[16:19], s36 offen offset:1024 lds
    v_mfma_f32_16x16x32_bf16 v[204:207], a[72:75], a[88:91], v[204:207]
    v_mfma_f32_16x16x32_bf16 v[236:239], a[72:75], a[92:95], v[236:239]
    v_mfma_f32_16x16x32_bf16 v[240:243], a[76:79], a[92:95], v[240:243]
    v_mfma_f32_16x16x32_bf16 v[208:211], a[76:79], a[88:91], v[208:211]
    v_mfma_f32_16x16x32_bf16 v[176:179], a[76:79], a[84:87], v[176:179]
    v_mfma_f32_16x16x32_bf16 v[144:147], a[76:79], a[80:83], v[144:147]
    s_waitcnt lgkmcnt(0)
    v_mfma_f32_16x16x32_bf16 v[100:103], a[0:3], v[32:35], v[100:103]
    ds_read_b64_tr_b16 a[48:49], v50 offset:24576
    v_mfma_f32_16x16x32_bf16 v[104:107], a[4:7], v[32:35], v[104:107]
    ds_read_b64_tr_b16 a[50:51], v50 offset:25600
    v_mfma_f32_16x16x32_bf16 v[116:119], a[0:3], a[32:35], v[116:119]
    buffer_load_dwordx4 v38, s[16:19], s36 offen offset:2048 lds
    v_mfma_f32_16x16x32_bf16 v[148:151], a[0:3], a[36:39], v[148:151]
    ds_read_b128 a[80:83], v49 offset:8192
    v_mfma_f32_16x16x32_bf16 v[180:183], a[0:3], a[40:43], v[180:183]
    ds_read_b128 a[84:87], v49 offset:10240
    v_mfma_f32_16x16x32_bf16 v[212:215], a[0:3], a[44:47], v[212:215]
    ds_read_b128 a[88:91], v49 offset:12288
    v_mfma_f32_16x16x32_bf16 v[216:219], a[4:7], a[44:47], v[216:219]
    ds_read_b128 a[92:95], v49 offset:14336
    v_mfma_f32_16x16x32_bf16 v[184:187], a[4:7], a[40:43], v[184:187]
    buffer_load_dwordx4 v39, s[16:19], s36 offen offset:3072 lds
    v_mfma_f32_16x16x32_bf16 v[152:155], a[4:7], a[36:39], v[152:155]
    ds_read_b64_tr_b16 a[52:53], v51 offset:24576
    v_mfma_f32_16x16x32_bf16 v[120:123], a[4:7], a[32:35], v[120:123]
    ds_read_b64_tr_b16 a[54:55], v51 offset:25600
    v_mfma_f32_16x16x32_bf16 v[124:127], a[8:11], a[32:35], v[124:127]
    ds_read_b64_tr_b16 a[56:57], v52 offset:24576
    v_mfma_f32_16x16x32_bf16 v[156:159], a[8:11], a[36:39], v[156:159]
    s_add_u32 m0, s38, 4096
    ds_read_b64_tr_b16 a[58:59], v52 offset:25600
    v_mfma_f32_16x16x32_bf16 v[188:191], a[8:11], a[40:43], v[188:191]
    buffer_load_dwordx4 v40, s[16:19], s36 offen offset:0 lds
    v_mfma_f32_16x16x32_bf16 v[220:223], a[8:11], a[44:47], v[220:223]
    ds_read_b64_tr_b16 a[60:61], v53 offset:24576
    v_mfma_f32_16x16x32_bf16 v[224:227], a[12:15], a[44:47], v[224:227]
    ds_read_b64_tr_b16 a[62:63], v53 offset:25600
    v_mfma_f32_16x16x32_bf16 v[192:195], a[12:15], a[40:43], v[192:195]
    ds_read_b64_tr_b16 a[64:65], v54 offset:24576
    v_mfma_f32_16x16x32_bf16 v[160:163], a[12:15], a[36:39], v[160:163]
    ds_read_b64_tr_b16 a[66:67], v54 offset:25600
    v_mfma_f32_16x16x32_bf16 v[128:131], a[12:15], a[32:35], v[128:131]
    buffer_load_dwordx4 v41, s[16:19], s36 offen offset:1024 lds
    v_mfma_f32_16x16x32_bf16 v[132:135], a[16:19], a[32:35], v[132:135]
    ds_read_b64_tr_b16 a[68:69], v55 offset:24576
    v_mfma_f32_16x16x32_bf16 v[164:167], a[16:19], a[36:39], v[164:167]
    ds_read_b64_tr_b16 a[70:71], v55 offset:25600
    v_mfma_f32_16x16x32_bf16 v[196:199], a[16:19], a[40:43], v[196:199]
    ds_read_b64_tr_b16 a[72:73], v56 offset:24576
    v_mfma_f32_16x16x32_bf16 v[228:231], a[16:19], a[44:47], v[228:231]
    ds_read_b64_tr_b16 a[74:75], v56 offset:25600
    v_mfma_f32_16x16x32_bf16 v[232:235], a[20:23], a[44:47], v[232:235]
    buffer_load_dwordx4 v42, s[16:19], s36 offen offset:2048 lds
    v_mfma_f32_16x16x32_bf16 v[200:203], a[20:23], a[40:43], v[200:203]
    ds_read_b64_tr_b16 a[76:77], v57 offset:24576
    v_mfma_f32_16x16x32_bf16 v[168:171], a[20:23], a[36:39], v[168:171]
    ds_read_b64_tr_b16 a[78:79], v57 offset:25600
    v_mfma_f32_16x16x32_bf16 v[136:139], a[20:23], a[32:35], v[136:139]
    v_mfma_f32_16x16x32_bf16 v[140:143], a[24:27], a[32:35], v[140:143]
    v_mfma_f32_16x16x32_bf16 v[172:175], a[24:27], a[36:39], v[172:175]
    buffer_load_dwordx4 v43, s[16:19], s36 offen offset:3072 lds
    v_mfma_f32_16x16x32_bf16 v[204:207], a[24:27], a[40:43], v[204:207]
    v_mfma_f32_16x16x32_bf16 v[236:239], a[24:27], a[44:47], v[236:239]
    v_mfma_f32_16x16x32_bf16 v[240:243], a[28:31], a[44:47], v[240:243]
    v_mfma_f32_16x16x32_bf16 v[208:211], a[28:31], a[40:43], v[208:211]
    v_mfma_f32_16x16x32_bf16 v[176:179], a[28:31], a[36:39], v[176:179]
    v_mfma_f32_16x16x32_bf16 v[144:147], a[28:31], a[32:35], v[144:147]
    s_waitcnt vmcnt(12) lgkmcnt(0)
    s_barrier
    s_cmp_lg_u32 s5, 0
    s_cbranch_scc1 L_signalled
    s_mov_b64 exec, 1
    buffer_atomic_add v27, off, s[92:95], s74 sc1
    s_mov_b64 exec, -1
L_signalled:
    v_mfma_f32_16x16x32_bf16 v[100:103], a[48:51], v[32:35], v[100:103]
    ds_read_b64_tr_b16 a[0:1], v50 offset:32768
    v_mfma_f32_16x16x32_bf16 v[104:107], a[52:55], v[32:35], v[104:107]
    s_add_u32 m0, s39, 16384
    s_mov_b32 s37, 3670016
    ds_read_b64_tr_b16 a[2:3], v50 offset:33792
    v_mfma_f32_16x16x32_bf16 v[116:119], a[48:51], a[80:83], v[116:119]
    buffer_load_dwordx4 v44, s[20:23], s37 offen offset:0 lds
    v_mfma_f32_16x16x32_bf16 v[148:151], a[48:51], a[84:87], v[148:151]
    ds_read_b128 a[32:35], v48 offset:16384
    v_mfma_f32_16x16x32_bf16 v[180:183], a[48:51], a[88:91], v[180:183]
    ds_read_b128 a[36:39], v48 offset:18432
    v_mfma_f32_16x16x32_bf16 v[212:215], a[48:51], a[92:95], v[212:215]
    buffer_load_dwordx4 v45, s[20:23], s37 offen offset:1024 lds
    v_mfma_f32_16x16x32_bf16 v[216:219], a[52:55], a[92:95], v[216:219]
    ds_read_b128 a[40:43], v48 offset:20480
    v_mfma_f32_16x16x32_bf16 v[184:187], a[52:55], a[88:91], v[184:187]
    ds_read_b128 a[44:47], v48 offset:22528
    v_mfma_f32_16x16x32_bf16 v[152:155], a[52:55], a[84:87], v[152:155]
    ds_read_b64_tr_b16 a[4:5], v51 offset:32768
    v_mfma_f32_16x16x32_bf16 v[120:123], a[52:55], a[80:83], v[120:123]
    buffer_load_dwordx4 v46, s[20:23], s37 offen offset:2048 lds
    v_mfma_f32_16x16x32_bf16 v[124:127], a[56:59], a[80:83], v[124:127]
    ds_read_b64_tr_b16 a[6:7], v51 offset:33792
    v_mfma_f32_16x16x32_bf16 v[156:159], a[56:59], a[84:87], v[156:159]
    ds_read_b64_tr_b16 a[8:9], v52 offset:32768
    v_mfma_f32_16x16x32_bf16 v[188:191], a[56:59], a[88:91], v[188:191]
    ds_read_b64_tr_b16 a[10:11], v52 offset:33792
    v_mfma_f32_16x16x32_bf16 v[220:223], a[56:59], a[92:95], v[220:223]
    buffer_load_dwordx4 v47, s[20:23], s37 offen offset:3072 lds
    v_mfma_f32_16x16x32_bf16 v[224:227], a[60:63], a[92:95], v[224:227]
    ds_read_b64_tr_b16 a[12:13], v53 offset:32768
    v_mfma_f32_16x16x32_bf16 v[192:195], a[60:63], a[88:91], v[192:195]
    ds_read_b64_tr_b16 a[14:15], v53 offset:33792
    v_mfma_f32_16x16x32_bf16 v[160:163], a[60:63], a[84:87], v[160:163]
    s_add_u32 m0, s38, 8192
    s_mov_b32 s36, 896
    ds_read_b64_tr_b16 a[16:17], v54 offset:32768
    v_mfma_f32_16x16x32_bf16 v[128:131], a[60:63], a[80:83], v[128:131]
    buffer_load_dwordx4 v36, s[16:19], s36 offen offset:0 lds
    v_mfma_f32_16x16x32_bf16 v[132:135], a[64:67], a[80:83], v[132:135]
    ds_read_b64_tr_b16 a[18:19], v54 offset:33792
    v_mfma_f32_16x16x32_bf16 v[164:167], a[64:67], a[84:87], v[164:167]
    ds_read_b64_tr_b16 a[20:21], v55 offset:32768
    v_mfma_f32_16x16x32_bf16 v[196:199], a[64:67], a[88:91], v[196:199]
    buffer_load_dwordx4 v37, s[16:19], s36 offen offset:1024 lds
    v_mfma_f32_16x16x32_bf16 v[228:231], a[64:67], a[92:95], v[228:231]
    ds_read_b64_tr_b16 a[22:23], v55 offset:33792
    v_mfma_f32_16x16x32_bf16 v[232:235], a[68:71], a[92:95], v[232:235]
    ds_read_b64_tr_b16 a[24:25], v56 offset:32768
    v_mfma_f32_16x16x32_bf16 v[200:203], a[68:71], a[88:91], v[200:203]
    ds_read_b64_tr_b16 a[26:27], v56 offset:33792
    v_mfma_f32_16x16x32_bf16 v[168:171], a[68:71], a[84:87], v[168:171]
    buffer_load_dwordx4 v38, s[16:19], s36 offen offset:2048 lds
    v_mfma_f32_16x16x32_bf16 v[136:139], a[68:71], a[80:83], v[136:139]
    ds_read_b64_tr_b16 a[28:29], v57 offset:32768
    v_mfma_f32_16x16x32_bf16 v[140:143], a[72:75], a[80:83], v[140:143]
    ds_read_b64_tr_b16 a[30:31], v57 offset:33792
    v_mfma_f32_16x16x32_bf16 v[172:175], a[72:75], a[84:87], v[172:175]
    v_mfma_f32_16x16x32_bf16 v[204:207], a[72:75], a[88:91], v[204:207]
    buffer_load_dwordx4 v39, s[16:19], s36 offen offset:3072 lds
    v_mfma_f32_16x16x32_bf16 v[236:239], a[72:75], a[92:95], v[236:239]
    v_mfma_f32_16x16x32_bf16 v[240:243], a[76:79], a[92:95], v[240:243]
    v_mfma_f32_16x16x32_bf16 v[208:211], a[76:79], a[88:91], v[208:211]
    v_mfma_f32_16x16x32_bf16 v[176:179], a[76:79], a[84:87], v[176:179]
    v_mfma_f32_16x16x32_bf16 v[144:147], a[76:79], a[80:83], v[144:147]
    s_waitcnt lgkmcnt(0)
    v_mfma_f32_16x16x32_bf16 v[100:103], a[0:3], v[32:35], v[100:103]
    ds_read_b64_tr_b16 a[48:49], v50 offset:40960
    v_mfma_f32_16x16x32_bf16 v[104:107], a[4:7], v[32:35], v[104:107]
    s_add_u32 m0, s38, 12288
    ds_read_b64_tr_b16 a[50:51], v50 offset:41984
    v_mfma_f32_16x16x32_bf16 v[116:119], a[0:3], a[32:35], v[116:119]
    buffer_load_dwordx4 v40, s[16:19], s36 offen offset:0 lds
    v_mfma_f32_16x16x32_bf16 v[148:151], a[0:3], a[36:39], v[148:151]
    ds_read_b128 a[80:83], v49 offset:16384
    v_mfma_f32_16x16x32_bf16 v[180:183], a[0:3], a[40:43], v[180:183]
    ds_read_b128 a[84:87], v49 offset:18432
    v_mfma_f32_16x16x32_bf16 v[212:215], a[0:3], a[44:47], v[212:215]
    buffer_load_dwordx4 v41, s[16:19], s36 offen offset:1024 lds
    v_mfma_f32_16x16x32_bf16 v[216:219], a[4:7], a[44:47], v[216:219]
    ds_read_b128 a[88:91], v49 offset:20480
    v_mfma_f32_16x16x32_bf16 v[184:187], a[4:7], a[40:43], v[184:187]
    ds_read_b128 a[92:95], v49 offset:22528
    v_mfma_f32_16x16x32_bf16 v[152:155], a[4:7], a[36:39], v[152:155]
    ds_read_b64_tr_b16 a[52:53], v51 offset:40960
    v_mfma_f32_16x16x32_bf16 v[120:123], a[4:7], a[32:35], v[120:123]
    buffer_load_dwordx4 v42, s[16:19], s36 offen offset:2048 lds
    v_mfma_f32_16x16x32_bf16 v[124:127], a[8:11], a[32:35], v[124:127]
    ds_read_b64_tr_b16 a[54:55], v51 offset:41984
    v_mfma_f32_16x16x32_bf16 v[156:159], a[8:11], a[36:39], v[156:159]
    ds_read_b64_tr_b16 a[56:57], v52 offset:40960
    v_mfma_f32_16x16x32_bf16 v[188:191], a[8:11], a[40:43], v[188:191]
    ds_read_b64_tr_b16 a[58:59], v52 offset:41984
    v_mfma_f32_16x16x32_bf16 v[220:223], a[8:11], a[44:47], v[220:223]
    buffer_load_dwordx4 v43, s[16:19], s36 offen offset:3072 lds
    v_mfma_f32_16x16x32_bf16 v[224:227], a[12:15], a[44:47], v[224:227]
    ds_read_b64_tr_b16 a[60:61], v53 offset:40960
    v_mfma_f32_16x16x32_bf16 v[192:195], a[12:15], a[40:43], v[192:195]
    ds_read_b64_tr_b16 a[62:63], v53 offset:41984
    v_mfma_f32_16x16x32_bf16 v[160:163], a[12:15], a[36:39], v[160:163]
    s_add_u32 m0, s34, 49152
    ds_read_b64_tr_b16 a[64:65], v54 offset:40960
    v_mfma_f32_16x16x32_bf16 v[128:131], a[12:15], a[32:35], v[128:131]
    buffer_load_dwordx4 v13, s[8:11], s28 offen offset:0 lds
    v_mfma_f32_16x16x32_bf16 v[132:135], a[16:19], a[32:35], v[132:135]
    ds_read_b64_tr_b16 a[66:67], v54 offset:41984
    v_mfma_f32_16x16x32_bf16 v[164:167], a[16:19], a[36:39], v[164:167]
    ds_read_b64_tr_b16 a[68:69], v55 offset:40960
    v_mfma_f32_16x16x32_bf16 v[196:199], a[16:19], a[40:43], v[196:199]
    buffer_load_dwordx4 v14, s[8:11], s28 offen offset:1024 lds
    v_mfma_f32_16x16x32_bf16 v[228:231], a[16:19], a[44:47], v[228:231]
    ds_read_b64_tr_b16 a[70:71], v55 offset:41984
    v_mfma_f32_16x16x32_bf16 v[232:235], a[20:23], a[44:47], v[232:235]
    ds_read_b64_tr_b16 a[72:73], v56 offset:40960
    v_mfma_f32_16x16x32_bf16 v[200:203], a[20:23], a[40:43], v[200:203]
    ds_read_b64_tr_b16 a[74:75], v56 offset:41984
    v_mfma_f32_16x16x32_bf16 v[168:171], a[20:23], a[36:39], v[168:171]
    buffer_load_dwordx4 v15, s[8:11], s28 offen offset:2048 lds
    v_mfma_f32_16x16x32_bf16 v[136:139], a[20:23], a[32:35], v[136:139]
    ds_read_b64_tr_b16 a[76:77], v57 offset:40960
    v_mfma_f32_16x16x32_bf16 v[140:143], a[24:27], a[32:35], v[140:143]
    ds_read_b64_tr_b16 a[78:79], v57 offset:41984
    v_mfma_f32_16x16x32_bf16 v[172:175], a[24:27], a[36:39], v[172:175]
    v_mfma_f32_16x16x32_bf16 v[204:207], a[24:27], a[40:43], v[204:207]
    buffer_load_dwordx4 v16, s[8:11], s28 offen offset:3072 lds
    v_mfma_f32_16x16x32_bf16 v[236:239], a[24:27], a[44:47], v[236:239]
    v_mfma_f32_16x16x32_bf16 v[240:243], a[28:31], a[44:47], v[240:243]
    v_mfma_f32_16x16x32_bf16 v[208:211], a[28:31], a[40:43], v[208:211]
    v_mfma_f32_16x16x32_bf16 v[176:179], a[28:31], a[36:39], v[176:179]
    v_mfma_f32_16x16x32_bf16 v[144:147], a[28:31], a[32:35], v[144:147]
    s_add_u32 s28, s28, 16384
    s_waitcnt vmcnt(16) lgkmcnt(0)
    s_barrier
    v_mfma_f32_16x16x32_bf16 v[100:103], a[48:51], v[32:35], v[100:103]
    ds_read_b64_tr_b16 a[0:1], v50 offset:0
    v_mfma_f32_16x16x32_bf16 v[104:107], a[52:55], v[32:35], v[104:107]
    s_add_u32 m0, s39, 32768
    s_mov_b32 s37, 4194304
    ds_read_b64_tr_b16 a[2:3], v50 offset:1024
    v_mfma_f32_16x16x32_bf16 v[116:119], a[48:51], a[80:83], v[116:119]
    buffer_load_dwordx4 v44, s[20:23], s37 offen offset:0 lds
    v_mfma_f32_16x16x32_bf16 v[148:151], a[48:51], a[84:87], v[148:151]
    ds_read_b128 a[32:35], v48 offset:0
    v_mfma_f32_16x16x32_bf16 v[180:183], a[48:51], a[88:91], v[180:183]
    ds_read_b128 a[36:39], v48 offset:2048
    v_mfma_f32_16x16x32_bf16 v[212:215], a[48:51], a[92:95], v[212:215]
    ds_read_b128 a[40:43], v48 offset:4096
    v_mfma_f32_16x16x32_bf16 v[216:219], a[52:55], a[92:95], v[216:219]
    ds_read_b128 a[44:47], v48 offset:6144
    v_mfma_f32_16x16x32_bf16 v[184:187], a[52:55], a[88:91], v[184:187]
    buffer_load_dwordx4 v45, s[20:23], s37 offen offset:1024 lds
    v_mfma_f32_16x16x32_bf16 v[152:155], a[52:55], a[84:87], v[152:155]
    ds_read_b64_tr_b16 a[4:5], v51 offset:0
    v_mfma_f32_16x16x32_bf16 v[120:123], a[52:55], a[80:83], v[120:123]
    ds_read_b64_tr_b16 a[6:7], v51 offset:1024
    v_mfma_f32_16x16x32_bf16 v[124:127], a[56:59], a[80:83], v[124:127]
    ds_read_b64_tr_b16 a[8:9], v52 offset:0
    v_mfma_f32_16x16x32_bf16 v[156:159], a[56:59], a[84:87], v[156:159]
    ds_read_b64_tr_b16 a[10:11], v52 offset:1024
    v_mfma_f32_16x16x32_bf16 v[188:191], a[56:59], a[88:91], v[188:191]
    buffer_load_dwordx4 v46, s[20:23], s37 offen offset:2048 lds
    v_mfma_f32_16x16x32_bf16 v[220:223], a[56:59], a[92:95], v[220:223]
    ds_read_b64_tr_b16 a[12:13], v53 offset:0
    v_mfma_f32_16x16x32_bf16 v[224:227], a[60:63], a[92:95], v[224:227]
    ds_read_b64_tr_b16 a[14:15], v53 offset:1024
    v_mfma_f32_16x16x32_bf16 v[192:195], a[60:63], a[88:91], v[192:195]
    ds_read_b64_tr_b16 a[16:17], v54 offset:0
    v_mfma_f32_16x16x32_bf16 v[160:163], a[60:63], a[84:87], v[160:163]
    ds_read_b64_tr_b16 a[18:19], v54 offset:1024
    v_mfma_f32_16x16x32_bf16 v[128:131], a[60:63], a[80:83], v[128:131]
    buffer_load_dwordx4 v47, s[20:23], s37 offen offset:3072 lds
    v_mfma_f32_16x16x32_bf16 v[132:135], a[64:67], a[80:83], v[132:135]
    ds_read_b64_tr_b16 a[20:21], v55 offset:0
    v_mfma_f32_16x16x32_bf16 v[164:167], a[64:67], a[84:87], v[164:167]
    ds_read_b64_tr_b16 a[22:23], v55 offset:1024
    v_mfma_f32_16x16x32_bf16 v[196:199], a[64:67], a[88:91], v[196:199]
    ds_read_b64_tr_b16 a[24:25], v56 offset:0
    v_mfma_f32_16x16x32_bf16 v[228:231], a[64:67], a[92:95], v[228:231]
    s_add_u32 m0, s38, 16384
    s_mov_b32 s36, 1024
    ds_read_b64_tr_b16 a[26:27], v56 offset:1024
    v_mfma_f32_16x16x32_bf16 v[232:235], a[68:71], a[92:95], v[232:235]
    buffer_load_dwordx4 v36, s[16:19], s36 offen offset:0 lds
    v_mfma_f32_16x16x32_bf16 v[200:203], a[68:71], a[88:91], v[200:203]
    ds_read_b64_tr_b16 a[28:29], v57 offset:0
    v_mfma_f32_16x16x32_bf16 v[168:171], a[68:71], a[84:87], v[168:171]
    ds_read_b64_tr_b16 a[30:31], v57 offset:1024
    v_mfma_f32_16x16x32_bf16 v[136:139], a[68:71], a[80:83], v[136:139]
    v_mfma_f32_16x16x32_bf16 v[140:143], a[72:75], a[80:83], v[140:143]
    v_mfma_f32_16x16x32_bf16 v[172:175], a[72:75], a[84:87], v[172:175]
    buffer_load_dwordx4 v37, s[16:19], s36 offen offset:1024 lds
    v_mfma_f32_16x16x32_bf16 v[204:207], a[72:75], a[88:91], v[204:207]
    v_mfma_f32_16x16x32_bf16 v[236:239], a[72:75], a[92:95], v[236:239]
    v_mfma_f32_16x16x32_bf16 v[240:243], a[76:79], a[92:95], v[240:243]
    v_mfma_f32_16x16x32_bf16 v[208:211], a[76:79], a[88:91], v[208:211]
    v_mfma_f32_16x16x32_bf16 v[176:179], a[76:79], a[84:87], v[176:179]
    v_mfma_f32_16x16x32_bf16 v[144:147], a[76:79], a[80:83], v[144:147]
    s_waitcnt lgkmcnt(0)
    v_mfma_f32_16x16x32_bf16 v[100:103], a[0:3], v[32:35], v[100:103]
    ds_read_b64_tr_b16 a[48:49], v50 offset:8192
    v_mfma_f32_16x16x32_bf16 v[104:107], a[4:7], v[32:35], v[104:107]
    ds_read_b64_tr_b16 a[50:51], v50 offset:9216
    v_mfma_f32_16x16x32_bf16 v[116:119], a[0:3], a[32:35], v[116:119]
    buffer_load_dwordx4 v38, s[16:19], s36 offen offset:2048 lds
    v_mfma_f32_16x16x32_bf16 v[148:151], a[0:3], a[36:39], v[148:151]
    ds_read_b128 a[80:83], v49 offset:0
    v_mfma_f32_16x16x32_bf16 v[180:183], a[0:3], a[40:43], v[180:183]
    ds_read_b128 a[84:87], v49 offset:2048
    v_mfma_f32_16x16x32_bf16 v[212:215], a[0:3], a[44:47], v[212:215]
    ds_read_b128 a[88:91], v49 offset:4096
    v_mfma_f32_16x16x32_bf16 v[216:219], a[4:7], a[44:47], v[216:219]
    ds_read_b128 a[92:95], v49 offset:6144
    v_mfma_f32_16x16x32_bf16 v[184:187], a[4:7], a[40:43], v[184:187]
    buffer_load_dwordx4 v39, s[16:19], s36 offen offset:3072 lds
    v_mfma_f32_16x16x32_bf16 v[152:155], a[4:7], a[36:39], v[152:155]
    ds_read_b64_tr_b16 a[52:53], v51 offset:8192
    v_mfma_f32_16x16x32_bf16 v[120:123], a[4:7], a[32:35], v[120:123]
    ds_read_b64_tr_b16 a[54:55], v51 offset:9216
    v_mfma_f32_16x16x32_bf16 v[124:127], a[8:11], a[32:35], v[124:127]
    ds_read_b64_tr_b16 a[56:57], v52 offset:8192
    v_mfma_f32_16x16x32_bf16 v[156:159], a[8:11], a[36:39], v[156:159]
    s_add_u32 m0, s38, 20480
    ds_read_b64_tr_b16 a[58:59], v52 offset:9216
    v_mfma_f32_16x16x32_bf16 v[188:191], a[8:11], a[40:43], v[188:191]
    buffer_load_dwordx4 v40, s[16:19], s36 offen offset:0 lds
    v_mfma_f32_16x16x32_bf16 v[220:223], a[8:11], a[44:47], v[220:223]
    ds_read_b64_tr_b16 a[60:61], v53 offset:8192
    v_mfma_f32_16x16x32_bf16 v[224:227], a[12:15], a[44:47], v[224:227]
    ds_read_b64_tr_b16 a[62:63], v53 offset:9216
    v_mfma_f32_16x16x32_bf16 v[192:195], a[12:15], a[40:43], v[192:195]
    ds_read_b64_tr_b16 a[64:65], v54 offset:8192
    v_mfma_f32_16x16x32_bf16 v[160:163], a[12:15], a[36:39], v[160:163]
    ds_read_b64_tr_b16 a[66:67], v54 offset:9216
    v_mfma_f32_16x16x32_bf16 v[128:131], a[12:15], a[32:35], v[128:131]
    buffer_load_dwordx4 v41, s[16:19], s36 offen offset:1024 lds
    v_mfma_f32_16x16x32_bf16 v[132:135], a[16:19], a[32:35], v[132:135]
    ds_read_b64_tr_b16 a[68:69], v55 offset:8192
    v_mfma_f32_16x16x32_bf16 v[164:167], a[16:19], a[36:39], v[164:167]
    ds_read_b64_tr_b16 a[70:71], v55 offset:9216
    v_mfma_f32_16x16x32_bf16 v[196:199], a[16:19], a[40:43], v[196:199]
    ds_read_b64_tr_b16 a[72:73], v56 offset:8192
    v_mfma_f32_16x16x32_bf16 v[228:231], a[16:19], a[44:47], v[228:231]
    ds_read_b64_tr_b16 a[74:75], v56 offset:9216
    v_mfma_f32_16x16x32_bf16 v[232:235], a[20:23], a[44:47], v[232:235]
    buffer_load_dwordx4 v42, s[16:19], s36 offen offset:2048 lds
    v_mfma_f32_16x16x32_bf16 v[200:203], a[20:23], a[40:43], v[200:203]
    ds_read_b64_tr_b16 a[76:77], v57 offset:8192
    v_mfma_f32_16x16x32_bf16 v[168:171], a[20:23], a[36:39], v[168:171]
    ds_read_b64_tr_b16 a[78:79], v57 offset:9216
    v_mfma_f32_16x16x32_bf16 v[136:139], a[20:23], a[32:35], v[136:139]
    v_mfma_f32_16x16x32_bf16 v[140:143], a[24:27], a[32:35], v[140:143]
    v_mfma_f32_16x16x32_bf16 v[172:175], a[24:27], a[36:39], v[172:175]
    buffer_load_dwordx4 v43, s[16:19], s36 offen offset:3072 lds
    v_mfma_f32_16x16x32_bf16 v[204:207], a[24:27], a[40:43], v[204:207]
    v_mfma_f32_16x16x32_bf16 v[236:239], a[24:27], a[44:47], v[236:239]
    v_mfma_f32_16x16x32_bf16 v[240:243], a[28:31], a[44:47], v[240:243]
    v_mfma_f32_16x16x32_bf16 v[208:211], a[28:31], a[40:43], v[208:211]
    v_mfma_f32_16x16x32_bf16 v[176:179], a[28:31], a[36:39], v[176:179]
    v_mfma_f32_16x16x32_bf16 v[144:147], a[28:31], a[32:35], v[144:147]
    s_waitcnt vmcnt(16) lgkmcnt(0)
    s_barrier
    v_mfma_f32_16x16x32_bf16 v[100:103], a[48:51], v[32:35], v[100:103]
    ds_read_b64_tr_b16 a[0:1], v50 offset:16384
    v_mfma_f32_16x16x32_bf16 v[104:107], a[52:55], v[32:35], v[104:107]
    s_add_u32 m0, s39, 0
    s_mov_b32 s37, 4718592
    ds_read_b64_tr_b16 a[2:3], v50 offset:17408
    v_mfma_f32_16x16x32_bf16 v[116:119], a[48:51], a[80:83], v[116:119]
    buffer_load_dwordx4 v44, s[20:23], s37 offen offset:0 lds
    v_mfma_f32_16x16x32_bf16 v[148:151], a[48:51], a[84:87], v[148:151]
    ds_read_b128 a[32:35], v48 offset:8192
    v_mfma_f32_16x16x32_bf16 v[180:183], a[48:51], a[88:91], v[180:183]
    ds_read_b128 a[36:39], v48 offset:10240
    v_mfma_f32_16x16x32_bf16 v[212:215], a[48:51], a[92:95], v[212:215]
    ds_read_b128 a[40:43], v48 offset:12288
    v_mfma_f32_16x16x32_bf16 v[216:219], a[52:55], a[92:95], v[216:219]
    ds_read_b128 a[44:47], v48 offset:14336
    v_mfma_f32_16x16x32_bf16 v[184:187], a[52:55], a[88:91], v[184:187]
    buffer_load_dwordx4 v45, s[20:23], s37 offen offset:1024 lds
    v_mfma_f32_16x16x32_bf16 v[152:155], a[52:55], a[84:87], v[152:155]
    ds_read_b64_tr_b16 a[4:5], v51 offset:16384
    v_mfma_f32_16x16x32_bf16 v[120:123], a[52:55], a[80:83], v[120:123]
    ds_read_b64_tr_b16 a[6:7], v51 offset:17408
    v_mfma_f32_16x16x32_bf16 v[124:127], a[56:59], a[80:83], v[124:127]
    ds_read_b64_tr_b16 a[8:9], v52 offset:16384
    v_mfma_f32_16x16x32_bf16 v[156:159], a[56:59], a[84:87], v[156:159]
    ds_read_b64_tr_b16 a[10:11], v52 offset:17408
    v_mfma_f32_16x16x32_bf16 v[188:191], a[56:59], a[88:91], v[188:191]
    buffer_load_dwordx4 v46, s[20:23], s37 offen offset:2048 lds
    v_mfma_f32_16x16x32_bf16 v[220:223], a[56:59], a[92:95], v[220:223]
    ds_read_b64_tr_b16 a[12:13], v53 offset:16384
    v_mfma_f32_16x16x32_bf16 v[224:227], a[60:63], a[92:95], v[224:227]
    ds_read_b64_tr_b16 a[14:15], v53 offset:17408
    v_mfma_f32_16x16x32_bf16 v[192:195], a[60:63], a[88:91], v[192:195]
    ds_read_b64_tr_b16 a[16:17], v54 offset:16384
    v_mfma_f32_16x16x32_bf16 v[160:163], a[60:63], a[84:87], v[160:163]
    ds_read_b64_tr_b16 a[18:19], v54 offset:17408
    v_mfma_f32_16x16x32_bf16 v[128:131], a[60:63], a[80:83], v[128:131]
    buffer_load_dwordx4 v47, s[20:23], s37 offen offset:3072 lds
    v_mfma_f32_16x16x32_bf16 v[132:135], a[64:67], a[80:83], v[132:135]
    ds_read_b64_tr_b16 a[20:21], v55 offset:16384
    v_mfma_f32_16x16x32_bf16 v[164:167], a[64:67], a[84:87], v[164:167]
    ds_read_b64_tr_b16 a[22:23], v55 offset:17408
    v_mfma_f32_16x16x32_bf16 v[196:199], a[64:67], a[88:91], v[196:199]
    ds_read_b64_tr_b16 a[24:25], v56 offset:16384
    v_mfma_f32_16x16x32_bf16 v[228:231], a[64:67], a[92:95], v[228:231]
    s_add_u32 m0, s38, 0
    s_mov_b32 s36, 1152
    ds_read_b64_tr_b16 a[26:27], v56 offset:17408
    v_mfma_f32_16x16x32_bf16 v[232:235], a[68:71], a[92:95], v[232:235]
    buffer_load_dword v252, off, s[92:95], s74 sc1
    buffer_load_dwordx4 v36, s[16:19], s36 offen offset:0 lds
    v_mfma_f32_16x16x32_bf16 v[200:203], a[68:71], a[88:91], v[200:203]
    ds_read_b64_tr_b16 a[28:29], v57 offset:16384
    v_mfma_f32_16x16x32_bf16 v[168:171], a[68:71], a[84:87], v[168:171]
    ds_read_b64_tr_b16 a[30:31], v57 offset:17408
    v_mfma_f32_16x16x32_bf16 v[136:139], a[68:71], a[80:83], v[136:139]
    v_mfma_f32_16x16x32_bf16 v[140:143], a[72:75], a[80:83], v[140:143]
    v_mfma_f32_16x16x32_bf16 v[172:175], a[72:75], a[84:87], v[172:175]
    buffer_load_dwordx4 v37, s[16:19], s36 offen offset:1024 lds
    v_mfma_f32_16x16x32_bf16 v[204:207], a[72:75], a[88:91], v[204:207]
    v_mfma_f32_16x16x32_bf16 v[236:239], a[72:75], a[92:95], v[236:239]
    v_mfma_f32_16x16x32_bf16 v[240:243], a[76:79], a[92:95], v[240:243]
    v_mfma_f32_16x16x32_bf16 v[208:211], a[76:79], a[88:91], v[208:211]
    v_mfma_f32_16x16x32_bf16 v[176:179], a[76:79], a[84:87], v[176:179]
    v_mfma_f32_16x16x32_bf16 v[144:147], a[76:79], a[80:83], v[144:147]
    s_waitcnt lgkmcnt(0)
    v_mfma_f32_16x16x32_bf16 v[100:103], a[0:3], v[32:35], v[100:103]
    ds_read_b64_tr_b16 a[48:49], v50 offset:24576
    v_mfma_f32_16x16x32_bf16 v[104:107], a[4:7], v[32:35], v[104:107]
    ds_read_b64_tr_b16 a[50:51], v50 offset:25600
    v_mfma_f32_16x16x32_bf16 v[116:119], a[0:3], a[32:35], v[116:119]
    buffer_load_dwordx4 v38, s[16:19], s36 offen offset:2048 lds
    v_mfma_f32_16x16x32_bf16 v[148:151], a[0:3], a[36:39], v[148:151]
    ds_read_b128 a[80:83], v49 offset:8192
    v_mfma_f32_16x16x32_bf16 v[180:183], a[0:3], a[40:43], v[180:183]
    ds_read_b128 a[84:87], v49 offset:10240
    v_mfma_f32_16x16x32_bf16 v[212:215], a[0:3], a[44:47], v[212:215]
    ds_read_b128 a[88:91], v49 offset:12288
    v_mfma_f32_16x16x32_bf16 v[216:219], a[4:7], a[44:47], v[216:219]
    ds_read_b128 a[92:95], v49 offset:14336
    v_mfma_f32_16x16x32_bf16 v[184:187], a[4:7], a[40:43], v[184:187]
    buffer_load_dwordx4 v39, s[16:19], s36 offen offset:3072 lds
    v_mfma_f32_16x16x32_bf16 v[152:155], a[4:7], a[36:39], v[152:155]
    ds_read_b64_tr_b16 a[52:53], v51 offset:24576
    v_mfma_f32_16x16x32_bf16 v[120:123], a[4:7], a[32:35], v[120:123]
    ds_read_b64_tr_b16 a[54:55], v51 offset:25600
    v_mfma_f32_16x16x32_bf16 v[124:127], a[8:11], a[32:35], v[124:127]
    ds_read_b64_tr_b16 a[56:57], v52 offset:24576
    v_mfma_f32_16x16x32_bf16 v[156:159], a[8:11], a[36:39], v[156:159]
    s_add_u32 m0, s38, 4096
    ds_read_b64_tr_b16 a[58:59], v52 offset:25600
    v_mfma_f32_16x16x32_bf16 v[188:191], a[8:11], a[40:43], v[188:191]
    buffer_load_dwordx4 v40, s[16:19], s36 offen offset:0 lds
    v_mfma_f32_16x16x32_bf16 v[220:223], a[8:11], a[44:47], v[220:223]
    ds_read_b64_tr_b16 a[60:61], v53 offset:24576
    v_mfma_f32_16x16x32_bf16 v[224:227], a[12:15], a[44:47], v[224:227]
    ds_read_b64_tr_b16 a[62:63], v53 offset:25600
    v_mfma_f32_16x16x32_bf16 v[192:195], a[12:15], a[40:43], v[192:195]
    ds_read_b64_tr_b16 a[64:65], v54 offset:24576
    v_mfma_f32_16x16x32_bf16 v[160:163], a[12:15], a[36:39], v[160:163]
    ds_read_b64_tr_b16 a[66:67], v54 offset:25600
    v_mfma_f32_16x16x32_bf16 v[128:131], a[12:15], a[32:35], v[128:131]
    buffer_load_dwordx4 v41, s[16:19], s36 offen offset:1024 lds
    v_mfma_f32_16x16x32_bf16 v[132:135], a[16:19], a[32:35], v[132:135]
    ds_read_b64_tr_b16 a[68:69], v55 offset:24576
    v_mfma_f32_16x16x32_bf16 v[164:167], a[16:19], a[36:39], v[164:167]
    ds_read_b64_tr_b16 a[70:71], v55 offset:25600
    v_mfma_f32_16x16x32_bf16 v[196:199], a[16:19], a[40:43], v[196:199]
    ds_read_b64_tr_b16 a[72:73], v56 offset:24576
    v_mfma_f32_16x16x32_bf16 v[228:231], a[16:19], a[44:47], v[228:231]
    ds_read_b64_tr_b16 a[74:75], v56 offset:25600
    v_mfma_f32_16x16x32_bf16 v[232:235], a[20:23], a[44:47], v[232:235]
    buffer_load_dwordx4 v42, s[16:19], s36 offen offset:2048 lds
    v_mfma_f32_16x16x32_bf16 v[200:203], a[20:23], a[40:43], v[200:203]
    ds_read_b64_tr_b16 a[76:77], v57 offset:24576
    v_mfma_f32_16x16x32_bf16 v[168:171], a[20:23], a[36:39], v[168:171]
    ds_read_b64_tr_b16 a[78:79], v57 offset:25600
    v_mfma_f32_16x16x32_bf16 v[136:139], a[20:23], a[32:35], v[136:139]
    v_mfma_f32_16x16x32_bf16 v[140:143], a[24:27], a[32:35], v[140:143]
    v_mfma_f32_16x16x32_bf16 v[172:175], a[24:27], a[36:39], v[172:175]
    buffer_load_dwordx4 v43, s[16:19], s36 offen offset:3072 lds
    v_mfma_f32_16x16x32_bf16 v[204:207], a[24:27], a[40:43], v[204:207]
    v_mfma_f32_16x16x32_bf16 v[236:239], a[24:27], a[44:47], v[236:239]
    v_mfma_f32_16x16x32_bf16 v[240:243], a[28:31], a[44:47], v[240:243]
    v_mfma_f32_16x16x32_bf16 v[208:211], a[28:31], a[40:43], v[208:211]
    v_mfma_f32_16x16x32_bf16 v[176:179], a[28:31], a[36:39], v[176:179]
    v_mfma_f32_16x16x32_bf16 v[144:147], a[28:31], a[32:35], v[144:147]
    s_waitcnt vmcnt(13) lgkmcnt(0)
    s_barrier
    v_mfma_f32_16x16x32_bf16 v[100:103], a[48:51], v[32:35], v[100:103]
    ds_read_b64_tr_b16 a[0:1], v50 offset:32768
    v_mfma_f32_16x16x32_bf16 v[104:107], a[52:55], v[32:35], v[104:107]
    s_add_u32 m0, s34, 16384
    ds_read_b64_tr_b16 a[2:3], v50 offset:33792
    v_mfma_f32_16x16x32_bf16 v[116:119], a[48:51], a[80:83], v[116:119]
    buffer_load_dwordx4 v13, s[8:11], s28 offen offset:0 lds
    v_mfma_f32_16x16x32_bf16 v[148:151], a[48:51], a[84:87], v[148:151]
    ds_read_b128 a[32:35], v48 offset:16384
    v_mfma_f32_16x16x32_bf16 v[180:183], a[48:51], a[88:91], v[180:183]
    ds_read_b128 a[36:39], v48 offset:18432
    v_mfma_f32_16x16x32_bf16 v[212:215], a[48:51], a[92:95], v[212:215]
    ds_read_b128 a[40:43], v48 offset:20480
    v_mfma_f32_16x16x32_bf16 v[216:219], a[52:55], a[92:95], v[216:219]
    ds_read_b128 a[44:47], v48 offset:22528
    v_mfma_f32_16x16x32_bf16 v[184:187], a[52:55], a[88:91], v[184:187]
    ds_read_b64_tr_b16 a[4:5], v51 offset:32768
    v_mfma_f32_16x16x32_bf16 v[152:155], a[52:55], a[84:87], v[152:155]
    ds_read_b64_tr_b16 a[6:7], v51 offset:33792
    v_mfma_f32_16x16x32_bf16 v[120:123], a[52:55], a[80:83], v[120:123]
    ds_read_b64_tr_b16 a[8:9], v52 offset:32768
    v_mfma_f32_16x16x32_bf16 v[124:127], a[56:59], a[80:83], v[124:127]
    ds_read_b64_tr_b16 a[10:11], v52 offset:33792
    v_mfma_f32_16x16x32_bf16 v[156:159], a[56:59], a[84:87], v[156:159]
    ds_read_b64_tr_b16 a[12:13], v53 offset:32768
    v_mfma_f32_16x16x32_bf16 v[188:191], a[56:59], a[88:91], v[188:191]
    ds_read_b64_tr_b16 a[14:15], v53 offset:33792
    v_mfma_f32_16x16x32_bf16 v[220:223], a[56:59], a[92:95], v[220:223]
    ds_read_b64_tr_b16 a[16:17], v54 offset:32768
    v_mfma_f32_16x16x32_bf16 v[224:227], a[60:63], a[92:95], v[224:227]
    ds_read_b64_tr_b16 a[18:19], v54 offset:33792
    v_mfma_f32_16x16x32_bf16 v[192:195], a[60:63], a[88:91], v[192:195]
    ds_read_b64_tr_b16 a[20:21], v55 offset:32768
    v_mfma_f32_16x16x32_bf16 v[160:163], a[60:63], a[84:87], v[160:163]
    ds_read_b64_tr_b16 a[22:23], v55 offset:33792
    v_mfma_f32_16x16x32_bf16 v[128:131], a[60:63], a[80:83], v[128:131]
    buffer_load_dwordx4 v14, s[8:11], s28 offen offset:1024 lds
    v_mfma_f32_16x16x32_bf16 v[132:135], a[64:67], a[80:83], v[132:135]
    ds_read_b64_tr_b16 a[24:25], v56 offset:32768
    v_mfma_f32_16x16x32_bf16 v[164:167], a[64:67], a[84:87], v[164:167]
    ds_read_b64_tr_b16 a[26:27], v56 offset:33792
    v_mfma_f32_16x16x32_bf16 v[196:199], a[64:67], a[88:91], v[196:199]
    ds_read_b64_tr_b16 a[28:29], v57 offset:32768
    v_mfma_f32_16x16x32_bf16 v[228:231], a[64:67], a[92:95], v[228:231]
    s_waitcnt vmcnt(10)
    v_cmp_gt_u32 vcc, 32, v252
    s_and_b64 vcc, vcc, exec
    s_cbranch_scc1 L_spin_rows
L_back_rows:
    buffer_load_dwordx2 v[108:109], v59, s[76:79], s46 offen offset:0 sc1
    buffer_load_dwordx2 v[110:111], v59, s[76:79], s46 offen offset:256 sc1
    buffer_load_dwordx2 v[112:113], v59, s[76:79], s46 offen offset:512 sc1
    buffer_load_dwordx2 v[114:115], v59, s[76:79], s46 offen offset:768 sc1
    ds_read_b64_tr_b16 a[30:31], v57 offset:33792
    v_mfma_f32_16x16x32_bf16 v[232:235], a[68:71], a[92:95], v[232:235]
    v_mfma_f32_16x16x32_bf16 v[200:203], a[68:71], a[88:91], v[200:203]
    v_mfma_f32_16x16x32_bf16 v[168:171], a[68:71], a[84:87], v[168:171]
    v_mfma_f32_16x16x32_bf16 v[136:139], a[68:71], a[80:83], v[136:139]
    v_mfma_f32_16x16x32_bf16 v[140:143], a[72:75], a[80:83], v[140:143]
    v_mfma_f32_16x16x32_bf16 v[172:175], a[72:75], a[84:87], v[172:175]
    v_mfma_f32_16x16x32_bf16 v[204:207], a[72:75], a[88:91], v[204:207]
    v_mfma_f32_16x16x32_bf16 v[236:239], a[72:75], a[92:95], v[236:239]
    v_mfma_f32_16x16x32_bf16 v[240:243], a[76:79], a[92:95], v[240:243]
    v_mfma_f32_16x16x32_bf16 v[208:211], a[76:79], a[88:91], v[208:211]
    v_mfma_f32_16x16x32_bf16 v[176:179], a[76:79], a[84:87], v[176:179]
    v_mfma_f32_16x16x32_bf16 v[144:147], a[76:79], a[80:83], v[144:147]
    s_waitcnt lgkmcnt(0)
    v_mfma_f32_16x16x32_bf16 v[100:103], a[0:3], v[32:35], v[100:103]
    ds_read_b64_tr_b16 a[48:49], v50 offset:40960
    v_mfma_f32_16x16x32_bf16 v[104:107], a[4:7], v[32:35], v[104:107]
    ds_read_b64_tr_b16 a[50:51], v50 offset:41984
    v_mfma_f32_16x16x32_bf16 v[116:119], a[0:3], a[32:35], v[116:119]
    buffer_load_dwordx4 v15, s[8:11], s28 offen offset:2048 lds
    v_mfma_f32_16x16x32_bf16 v[148:151], a[0:3], a[36:39], v[148:151]
    ds_read_b128 a[80:83], v49 offset:16384
    v_mfma_f32_16x16x32_bf16 v[180:183], a[0:3], a[40:43], v[180:183]
    ds_read_b128 a[84:87], v49 offset:18432
    v_mfma_f32_16x16x32_bf16 v[212:215], a[0:3], a[44:47], v[212:215]
    ds_read_b128 a[88:91], v49 offset:20480
    v_mfma_f32_16x16x32_bf16 v[216:219], a[4:7], a[44:47], v[216:219]
    ds_read_b128 a[92:95], v49 offset:22528
    v_mfma_f32_16x16x32_bf16 v[184:187], a[4:7], a[40:43], v[184:187]
    ds_read_b64_tr_b16 a[52:53], v51 offset:40960
    v_mfma_f32_16x16x32_bf16 v[152:155], a[4:7], a[36:39], v[152:155]
    ds_read_b64_tr_b16 a[54:55], v51 offset:41984
    v_mfma_f32_16x16x32_bf16 v[120:123], a[4:7], a[32:35], v[120:123]
    ds_read_b64_tr_b16 a[56:57], v52 offset:40960
    v_mfma_f32_16x16x32_bf16 v[124:127], a[8:11], a[32:35], v[124:127]
    ds_read_b64_tr_b16 a[58:59], v52 offset:41984
    v_mfma_f32_16x16x32_bf16 v[156:159], a[8:11], a[36:39], v[156:159]
    ds_read_b64_tr_b16 a[60:61], v53 offset:40960
    v_mfma_f32_16x16x32_bf16 v[188:191], a[8:11], a[40:43], v[188:191]
    ds_read_b64_tr_b16 a[62:63], v53 offset:41984
    v_mfma_f32_16x16x32_bf16 v[220:223], a[8:11], a[44:47], v[220:223]
    ds_read_b64_tr_b16 a[64:65], v54 offset:40960
    v_mfma_f32_16x16x32_bf16 v[224:227], a[12:15], a[44:47], v[224:227]
    ds_read_b64_tr_b16 a[66:67], v54 offset:41984
    v_mfma_f32_16x16x32_bf16 v[192:195], a[12:15], a[40:43], v[192:195]
    ds_read_b64_tr_b16 a[68:69], v55 offset:40960
    v_mfma_f32_16x16x32_bf16 v[160:163], a[12:15], a[36:39], v[160:163]
    ds_read_b64_tr_b16 a[70:71], v55 offset:41984
    v_mfma_f32_16x16x32_bf16 v[128:131], a[12:15], a[32:35], v[128:131]
    buffer_load_dwordx4 v16, s[8:11], s28 offen offset:3072 lds
    v_mfma_f32_16x16x32_bf16 v[132:135], a[16:19], a[32:35], v[132:135]
    ds_read_b64_tr_b16 a[72:73], v56 offset:40960
    v_mfma_f32_16x16x32_bf16 v[164:167], a[16:19], a[36:39], v[164:167]
    ds_read_b64_tr_b16 a[74:75], v56 offset:41984
    v_mfma_f32_16x16x32_bf16 v[196:199], a[16:19], a[40:43], v[196:199]
    ds_read_b64_tr_b16 a[76:77], v57 offset:40960
    v_mfma_f32_16x16x32_bf16 v[228:231], a[16:19], a[44:47], v[228:231]
    ds_read_b64_tr_b16 a[78:79], v57 offset:41984
    v_mfma_f32_16x16x32_bf16 v[232:235], a[20:23], a[44:47], v[232:235]
    v_mfma_f32_16x16x32_bf16 v[200:203], a[20:23], a[40:43], v[200:203]
    v_mfma_f32_16x16x32_bf16 v[168:171], a[20:23], a[36:39], v[168:171]
    v_mfma_f32_16x16x32_bf16 v[136:139], a[20:23], a[32:35], v[136:139]
    v_mfma_f32_16x16x32_bf16 v[140:143], a[24:27], a[32:35], v[140:143]
    v_mfma_f32_16x16x32_bf16 v[172:175], a[24:27], a[36:39], v[172:175]
    v_mfma_f32_16x16x32_bf16 v[204:207], a[24:27], a[40:43], v[204:207]
    v_mfma_f32_16x16x32_bf16 v[236:239], a[24:27], a[44:47], v[236:239]
    v_mfma_f32_16x16x32_bf16 v[240:243], a[28:31], a[44:47], v[240:243]
    v_mfma_f32_16x16x32_bf16 v[208:211], a[28:31], a[40:43], v[208:211]
    v_mfma_f32_16x16x32_bf16 v[176:179], a[28:31], a[36:39], v[176:179]
    v_mfma_f32_16x16x32_bf16 v[144:147], a[28:31], a[32:35], v[144:147]
    s_add_u32 s28, s28, 16384
    s_waitcnt vmcnt(8) lgkmcnt(0)
    s_barrier
    v_mfma_f32_16x16x32_bf16 v[100:103], a[48:51], v[32:35], v[100:103]
    ds_read_b64_tr_b16 a[0:1], v50 offset:0
    v_mfma_f32_16x16x32_bf16 v[104:107], a[52:55], v[32:35], v[104:107]
    s_add_u32 m0, s34, 32768
    ds_read_b64_tr_b16 a[2:3], v50 offset:1024
    v_mfma_f32_16x16x32_bf16 v[116:119], a[48:51], a[80:83], v[116:119]
    buffer_load_dwordx4 v13, s[8:11], s28 offen offset:0 lds
    v_mfma_f32_16x16x32_bf16 v[148:151], a[48:51], a[84:87], v[148:151]
    ds_read_b128 a[32:35], v48 offset:0
    v_mfma_f32_16x16x32_bf16 v[180:183], a[48:51], a[88:91], v[180:183]
    ds_read_b128 a[36:39], v48 offset:2048
    v_mfma_f32_16x16x32_bf16 v[212:215], a[48:51], a[92:95], v[212:215]
    ds_read_b128 a[40:43], v48 offset:4096
    v_mfma_f32_16x16x32_bf16 v[216:219], a[52:55], a[92:95], v[216:219]
    ds_read_b128 a[44:47], v48 offset:6144
    v_mfma_f32_16x16x32_bf16 v[184:187], a[52:55], a[88:91], v[184:187]
    ds_read_b64_tr_b16 a[4:5], v51 offset:0
    v_mfma_f32_16x16x32_bf16 v[152:155], a[52:55], a[84:87], v[152:155]
    ds_read_b64_tr_b16 a[6:7], v51 offset:1024
    v_mfma_f32_16x16x32_bf16 v[120:123], a[52:55], a[80:83], v[120:123]
    buffer_load_dwordx4 v14, s[8:11], s28 offen offset:1024 lds
    v_mfma_f32_16x16x32_bf16 v[124:127], a[56:59], a[80:83], v[124:127]
    ds_read_b64_tr_b16 a[8:9], v52 offset:0
    v_mfma_f32_16x16x32_bf16 v[156:159], a[56:59], a[84:87], v[156:159]
    ds_read_b64_tr_b16 a[10:11], v52 offset:1024
    v_mfma_f32_16x16x32_bf16 v[188:191], a[56:59], a[88:91], v[188:191]
    ds_read_b64_tr_b16 a[12:13], v53 offset:0
    v_mfma_f32_16x16x32_bf16 v[220:223], a[56:59], a[92:95], v[220:223]
    ds_read_b64_tr_b16 a[14:15], v53 offset:1024
    v_mfma_f32_16x16x32_bf16 v[224:227], a[60:63], a[92:95], v[224:227]
    ds_read_b64_tr_b16 a[16:17], v54 offset:0
    v_mfma_f32_16x16x32_bf16 v[192:195], a[60:63], a[88:91], v[192:195]
    ds_read_b64_tr_b16 a[18:19], v54 offset:1024
    v_mfma_f32_16x16x32_bf16 v[160:163], a[60:63], a[84:87], v[160:163]
    ds_read_b64_tr_b16 a[20:21], v55 offset:0
    v_mfma_f32_16x16x32_bf16 v[128:131], a[60:63], a[80:83], v[128:131]
    buffer_load_dwordx4 v15, s[8:11], s28 offen offset:2048 lds
    v_mfma_f32_16x16x32_bf16 v[132:135], a[64:67], a[80:83], v[132:135]
    ds_read_b64_tr_b16 a[22:23], v55 offset:1024
    v_mfma_f32_16x16x32_bf16 v[164:167], a[64:67], a[84:87], v[164:167]
    ds_read_b64_tr_b16 a[24:25], v56 offset:0
    v_mfma_f32_16x16x32_bf16 v[196:199], a[64:67], a[88:91], v[196:199]
    ds_read_b64_tr_b16 a[26:27], v56 offset:1024
    v_mfma_f32_16x16x32_bf16 v[228:231], a[64:67], a[92:95], v[228:231]
    ds_read_b64_tr_b16 a[28:29], v57 offset:0
    v_mfma_f32_16x16x32_bf16 v[232:235], a[68:71], a[92:95], v[232:235]
    ds_read_b64_tr_b16 a[30:31], v57 offset:1024
    v_mfma_f32_16x16x32_bf16 v[200:203], a[68:71], a[88:91], v[200:203]
    v_mfma_f32_16x16x32_bf16 v[168:171], a[68:71], a[84:87], v[168:171]
    buffer_load_dwordx4 v16, s[8:11], s28 offen offset:3072 lds
    v_mfma_f32_16x16x32_bf16 v[136:139], a[68:71], a[80:83], v[136:139]
    v_mfma_f32_16x16x32_bf16 v[140:143], a[72:75], a[80:83], v[140:143]
    v_mfma_f32_16x16x32_bf16 v[172:175], a[72:75], a[84:87], v[172:175]
    v_mfma_f32_16x16x32_bf16 v[204:207], a[72:75], a[88:91], v[204:207]
    v_mfma_f32_16x16x32_bf16 v[236:239], a[72:75], a[92:95], v[236:239]
    v_mfma_f32_16x16x32_bf16 v[240:243], a[76:79], a[92:95], v[240:243]
    v_mfma_f32_16x16x32_bf16 v[208:211], a[76:79], a[88:91], v[208:211]
    v_mfma_f32_16x16x32_bf16 v[176:179], a[76:79], a[84:87], v[176:179]
    v_mfma_f32_16x16x32_bf16 v[144:147], a[76:79], a[80:83], v[144:147]
    s_waitcnt lgkmcnt(0)
    v_mfma_f32_16x16x32_bf16 v[100:103], a[0:3], v[32:35], v[100:103]
    ds_read_b64_tr_b16 a[48:49], v50 offset:8192
    v_mfma_f32_16x16x32_bf16 v[104:107], a[4:7], v[32:35], v[104:107]
    s_add_u32 s28, s28, 16384
    s_mov_b32 m0, s30
    ds_read_b64_tr_b16 a[50:51], v50 offset:9216
    v_mfma_f32_16x16x32_bf16 v[116:119], a[0:3], a[32:35], v[116:119]
    buffer_load_dwordx4 v17, s[12:15], s29 offen offset:0 lds
    v_mfma_f32_16x16x32_bf16 v[148:151], a[0:3], a[36:39], v[148:151]
    ds_read_b64_tr_b16 a[52:53], v51 offset:8192
    v_mfma_f32_16x16x32_bf16 v[180:183], a[0:3], a[40:43], v[180:183]
    ds_read_b64_tr_b16 a[54:55], v51 offset:9216
    v_mfma_f32_16x16x32_bf16 v[212:215], a[0:3], a[44:47], v[212:215]
    ds_read_b128 a[80:83], v49 offset:0
    v_mfma_f32_16x16x32_bf16 v[216:219], a[4:7], a[44:47], v[216:219]
    ds_read_b128 a[84:87], v49 offset:2048
    v_mfma_f32_16x16x32_bf16 v[184:187], a[4:7], a[40:43], v[184:187]
    ds_read_b128 a[88:91], v49 offset:4096
    v_mfma_f32_16x16x32_bf16 v[152:155], a[4:7], a[36:39], v[152:155]
    ds_read_b128 a[92:95], v49 offset:6144
    v_mfma_f32_16x16x32_bf16 v[120:123], a[4:7], a[32:35], v[120:123]
    buffer_load_dwordx4 v18, s[12:15], s29 offen offset:1024 lds
    v_mfma_f32_16x16x32_bf16 v[124:127], a[8:11], a[32:35], v[124:127]
    ds_read_b64_tr_b16 a[56:57], v52 offset:8192
    v_mfma_f32_16x16x32_bf16 v[156:159], a[8:11], a[36:39], v[156:159]
    ds_read_b64_tr_b16 a[58:59], v52 offset:9216
    v_mfma_f32_16x16x32_bf16 v[188:191], a[8:11], a[40:43], v[188:191]
    ds_read_b64_tr_b16 a[60:61], v53 offset:8192
    v_mfma_f32_16x16x32_bf16 v[220:223], a[8:11], a[44:47], v[220:223]
    ds_read_b64_tr_b16 a[62:63], v53 offset:9216
    v_mfma_f32_16x16x32_bf16 v[224:227], a[12:15], a[44:47], v[224:227]
    ds_read_b64_tr_b16 a[64:65], v54 offset:8192
    v_mfma_f32_16x16x32_bf16 v[192:195], a[12:15], a[40:43], v[192:195]
    s_waitcnt lgkmcnt(9)
    ds_read_b64_tr_b16 a[66:67], v54 offset:9216
    v_mfma_f32_16x16x32_bf16 v[100:103], a[48:51], v[32:35], v[100:103]
    ds_read_b64_tr_b16 a[68:69], v55 offset:8192
    v_mfma_f32_16x16x32_bf16 v[104:107], a[52:55], v[32:35], v[104:107]
    buffer_load_dwordx4 v17, s[12:15], s29 offen offset:2048 lds
    v_mfma_f32_16x16x32_bf16 v[160:163], a[12:15], a[36:39], v[160:163]
    ds_read_b64_tr_b16 a[70:71], v55 offset:9216
    v_mfma_f32_16x16x32_bf16 v[128:131], a[12:15], a[32:35], v[128:131]
    ds_read_b64_tr_b16 a[72:73], v56 offset:8192
    v_mfma_f32_16x16x32_bf16 v[132:135], a[16:19], a[32:35], v[132:135]
    ds_read_b64_tr_b16 a[74:75], v56 offset:9216
    v_mfma_f32_16x16x32_bf16 v[164:167], a[16:19], a[36:39], v[164:167]
    ds_read_b64_tr_b16 a[76:77], v57 offset:8192
    v_mfma_f32_16x16x32_bf16 v[196:199], a[16:19], a[40:43], v[196:199]
    ds_read_b64_tr_b16 a[78:79], v57 offset:9216
    v_mfma_f32_16x16x32_bf16 v[228:231], a[16:19], a[44:47], v[228:231]
    ds_write_b128 v58, v[100:103] offset:0
    v_mfma_f32_16x16x32_bf16 v[232:235], a[20:23], a[44:47], v[232:235]
    buffer_load_dwordx4 v18, s[12:15], s29 offen offset:3072 lds
    v_mfma_f32_16x16x32_bf16 v[200:203], a[20:23], a[40:43], v[200:203]
    ds_write_b128 v58, v[104:107] offset:64
    v_mfma_f32_16x16x32_bf16 v[168:171], a[20:23], a[36:39], v[168:171]
    ds_write_b128 v58, v[100:103] offset:512
    v_mfma_f32_16x16x32_bf16 v[136:139], a[20:23], a[32:35], v[136:139]
    ds_write_b128 v58, v[104:107] offset:576
    v_mfma_f32_16x16x32_bf16 v[140:143], a[24:27], a[32:35], v[140:143]
    v_mfma_f32_16x16x32_bf16 v[172:175], a[24:27], a[36:39], v[172:175]
    v_mfma_f32_16x16x32_bf16 v[204:207], a[24:27], a[40:43], v[204:207]
    v_mfma_f32_16x16x32_bf16 v[236:239], a[24:27], a[44:47], v[236:239]
    v_mfma_f32_16x16x32_bf16 v[240:243], a[28:31], a[44:47], v[240:243]
    v_mfma_f32_16x16x32_bf16 v[208:211], a[28:31], a[40:43], v[208:211]
    v_mfma_f32_16x16x32_bf16 v[176:179], a[28:31], a[36:39], v[176:179]
    v_mfma_f32_16x16x32_bf16 v[144:147], a[28:31], a[32:35], v[144:147]
    s_add_u32 s29, s29, 16384
    s_waitcnt vmcnt(10) lgkmcnt(0)
    s_barrier
    v_mfma_f32_16x16x32_bf16 v[116:119], a[48:51], a[80:83], v[116:119]
    ds_read_b128 v[68:71], v58 offset:0
    v_mfma_f32_16x16x32_bf16 v[120:123], a[52:55], a[80:83], v[120:123]
    ds_read_b128 v[72:75], v58 offset:64
    v_mul_f32 v109, s44, v109
    v_mfma_f32_16x16x32_bf16 v[124:127], a[56:59], a[80:83], v[124:127]
    ds_read_b128 v[76:79], v58 offset:128
    v_mul_f32 v111, s44, v111
    v_mfma_f32_16x16x32_bf16 v[128:131], a[60:63], a[80:83], v[128:131]
    ds_read_b128 v[80:83], v58 offset:192
    v_mul_f32 v113, s44, v113
    v_mfma_f32_16x16x32_bf16 v[132:135], a[64:67], a[80:83], v[132:135]
    ds_read_b128 v[84:87], v58 offset:256
    v_mfma_f32_16x16x32_bf16 v[136:139], a[68:71], a[80:83], v[136:139]
    ds_read_b128 v[88:91], v58 offset:320
    v_mul_f32 v115, s44, v115
    v_mfma_f32_16x16x32_bf16 v[140:143], a[72:75], a[80:83], v[140:143]
    ds_read_b128 v[92:95], v58 offset:384
    v_and_b32 v253, 7, v19
    v_mfma_f32_16x16x32_bf16 v[144:147], a[76:79], a[80:83], v[144:147]
    ds_read_b128 v[96:99], v58 offset:448
    v_lshlrev_b32 v253, 5, v253
    v_mfma_f32_16x16x32_bf16 v[148:151], a[48:51], a[84:87], v[148:151]
    ds_read_b128 a[128:131], v1 offset:49152
    v_mfma_f32_16x16x32_bf16 v[152:155], a[52:55], a[84:87], v[152:155]
    ds_read_b128 a[132:135], v2 offset:49152
    v_mfma_f32_16x16x32_bf16 v[156:159], a[56:59], a[84:87], v[156:159]
    ds_read_b128 a[136:139], v3 offset:49152
    v_mfma_f32_16x16x32_bf16 v[160:163], a[60:63], a[84:87], v[160:163]
    ds_read_b128 a[140:143], v4 offset:49152
    v_mfma_f32_16x16x32_bf16 v[164:167], a[64:67], a[84:87], v[164:167]
    ds_read_b128 a[144:147], v1 offset:53248
    v_mfma_f32_16x16x32_bf16 v[168:171], a[68:71], a[84:87], v[168:171]
    ds_read_b128 a[148:151], v2 offset:53248
    v_mfma_f32_16x16x32_bf16 v[172:175], a[72:75], a[84:87], v[172:175]
    ds_read_b128 a[152:155], v3 offset:53248
    v_mfma_f32_16x16x32_bf16 v[176:179], a[76:79], a[84:87], v[176:179]
    ds_read_b128 a[156:159], v4 offset:53248
    buffer_load_dword v252, v253, s[92:95], 0 offen sc1
    s_waitcnt lgkmcnt(8)
    v_pk_fma_f32 v[116:117], v[108:109], v[68:69], v[116:117] op_sel_hi:[0,1,1] neg_lo:[1,0,0] neg_hi:[1,0,0]
    v_pk_fma_f32 v[118:119], v[108:109], v[70:71], v[118:119] op_sel_hi:[0,1,1] neg_lo:[1,0,0] neg_hi:[1,0,0]
    v_pk_fma_f32 v[120:121], v[108:109], v[72:73], v[120:121] op_sel_hi:[0,1,1] neg_lo:[1,0,0] neg_hi:[1,0,0]
    v_pk_fma_f32 v[122:123], v[108:109], v[74:75], v[122:123] op_sel_hi:[0,1,1] neg_lo:[1,0,0] neg_hi:[1,0,0]
    v_pk_fma_f32 v[124:125], v[108:109], v[76:77], v[124:125] op_sel_hi:[0,1,1] neg_lo:[1,0,0] neg_hi:[1,0,0]
    v_pk_fma_f32 v[126:127], v[108:109], v[78:79], v[126:127] op_sel_hi:[0,1,1] neg_lo:[1,0,0] neg_hi:[1,0,0]
    v_pk_fma_f32 v[128:129], v[108:109], v[80:81], v[128:129] op_sel_hi:[0,1,1] neg_lo:[1,0,0] neg_hi:[1,0,0]
    v_pk_fma_f32 v[130:131], v[108:109], v[82:83], v[130:131] op_sel_hi:[0,1,1] neg_lo:[1,0,0] neg_hi:[1,0,0]
    v_pk_fma_f32 v[132:133], v[108:109], v[84:85], v[132:133] op_sel_hi:[0,1,1] neg_lo:[1,0,0] neg_hi:[1,0,0]
    v_pk_fma_f32 v[134:135], v[108:109], v[86:87], v[134:135] op_sel_hi:[0,1,1] neg_lo:[1,0,0] neg_hi:[1,0,0]
    v_pk_fma_f32 v[136:137], v[108:109], v[88:89], v[136:137] op_sel_hi:[0,1,1] neg_lo:[1,0,0] neg_hi:[1,0,0]
    v_pk_fma_f32 v[138:139], v[108:109], v[90:91], v[138:139] op_sel_hi:[0,1,1] neg_lo:[1,0,0] neg_hi:[1,0,0]
    v_pk_fma_f32 v[140:141], v[108:109], v[92:93], v[140:141] op_sel_hi:[0,1,1] neg_lo:[1,0,0] neg_hi:[1,0,0]
    v_pk_fma_f32 v[142:143], v[108:109], v[94:95], v[142:143] op_sel_hi:[0,1,1] neg_lo:[1,0,0] neg_hi:[1,0,0]
    v_pk_fma_f32 v[144:145], v[108:109], v[96:97], v[144:145] op_sel_hi:[0,1,1] neg_lo:[1,0,0] neg_hi:[1,0,0]
    v_pk_fma_f32 v[146:147], v[108:109], v[98:99], v[146:147] op_sel_hi:[0,1,1] neg_lo:[1,0,0] neg_hi:[1,0,0]
    v_pk_mul_f32 v[116:117], v[116:117], v[108:109] op_sel:[0,1] op_sel_hi:[1,1]
    v_pk_mul_f32 v[118:119], v[118:119], v[108:109] op_sel:[0,1] op_sel_hi:[1,1]
    v_pk_mul_f32 v[120:121], v[120:121], v[108:109] op_sel:[0,1] op_sel_hi:[1,1]
    v_pk_mul_f32 v[122:123], v[122:123], v[108:109] op_sel:[0,1] op_sel_hi:[1,1]
    v_pk_mul_f32 v[124:125], v[124:125], v[108:109] op_sel:[0,1] op_sel_hi:[1,1]
    v_pk_mul_f32 v[126:127], v[126:127], v[108:109] op_sel:[0,1] op_sel_hi:[1,1]
    v_pk_mul_f32 v[128:129], v[128:129], v[108:109] op_sel:[0,1] op_sel_hi:[1,1]
    v_pk_mul_f32 v[130:131], v[130:131], v[108:109] op_sel:[0,1] op_sel_hi:[1,1]
    v_pk_mul_f32 v[132:133], v[132:133], v[108:109] op_sel:[0,1] op_sel_hi:[1,1]
    v_pk_mul_f32 v[134:135], v[134:135], v[108:109] op_sel:[0,1] op_sel_hi:[1,1]
    v_pk_mul_f32 v[136:137], v[136:137], v[108:109] op_sel:[0,1] op_sel_hi:[1,1]
    v_pk_mul_f32 v[138:139], v[138:139], v[108:109] op_sel:[0,1] op_sel_hi:[1,1]
    v_pk_mul_f32 v[140:141], v[140:141], v[108:109] op_sel:[0,1] op_sel_hi:[1,1]
    v_pk_mul_f32 v[142:143], v[142:143], v[108:109] op_sel:[0,1] op_sel_hi:[1,1]
    v_pk_mul_f32 v[144:145], v[144:145], v[108:109] op_sel:[0,1] op_sel_hi:[1,1]
    v_pk_mul_f32 v[146:147], v[146:147], v[108:109] op_sel:[0,1] op_sel_hi:[1,1]
    v_mfma_f32_16x16x32_bf16 v[180:183], a[48:51], a[88:91], v[180:183]
    ds_read_b128 a[160:163], v1 offset:57344
    v_cvt_pk_bf16_f32 v36, v116, v117
    v_cvt_pk_bf16_f32 v37, v118, v119
    v_cvt_pk_bf16_f32 v38, v120, v121
    v_cvt_pk_bf16_f32 v39, v122, v123
    v_mfma_f32_16x16x32_bf16 v[184:187], a[52:55], a[88:91], v[184:187]
    ds_read_b128 a[164:167], v2 offset:57344
    v_cvt_pk_bf16_f32 v40, v124, v125
    v_cvt_pk_bf16_f32 v41, v126, v127
    v_cvt_pk_bf16_f32 v42, v128, v129
    v_cvt_pk_bf16_f32 v43, v130, v131
    v_mfma_f32_16x16x32_bf16 v[188:191], a[56:59], a[88:91], v[188:191]
    ds_read_b128 a[168:171], v3 offset:57344
    v_cvt_pk_bf16_f32 v44, v132, v133
    v_cvt_pk_bf16_f32 v45, v134, v135
    v_cvt_pk_bf16_f32 v46, v136, v137
    v_cvt_pk_bf16_f32 v47, v138, v139
    v_mfma_f32_16x16x32_bf16 v[192:195], a[60:63], a[88:91], v[192:195]
    ds_read_b128 a[172:175], v4 offset:57344
    v_cvt_pk_bf16_f32 v48, v140, v141
    v_cvt_pk_bf16_f32 v49, v142, v143
    v_cvt_pk_bf16_f32 v50, v144, v145
    v_cvt_pk_bf16_f32 v51, v146, v147
    v_mfma_f32_16x16x32_bf16 v[196:199], a[64:67], a[88:91], v[196:199]
    ds_read_b128 a[176:179], v1 offset:61440
    v_permlane32_swap_b32 v36, v38
    v_permlane32_swap_b32 v37, v39
    v_permlane32_swap_b32 v40, v42
    v_permlane32_swap_b32 v41, v43
    v_mfma_f32_16x16x32_bf16 v[200:203], a[68:71], a[88:91], v[200:203]
    ds_read_b128 a[180:183], v2 offset:61440
    v_permlane32_swap_b32 v44, v46
    v_permlane32_swap_b32 v45, v47
    v_permlane32_swap_b32 v48, v50
    v_permlane32_swap_b32 v49, v51
    v_mfma_f32_16x16x32_bf16 v[204:207], a[72:75], a[88:91], v[204:207]
    ds_read_b128 a[184:187], v3 offset:61440
    v_permlane16_swap_b32 v36, v38
    v_permlane16_swap_b32 v37, v39
    v_permlane16_swap_b32 v40, v42
    v_permlane16_swap_b32 v41, v43
    v_mfma_f32_16x16x32_bf16 v[208:211], a[76:79], a[88:91], v[208:211]
    ds_read_b128 a[188:191], v4 offset:61440
    v_permlane16_swap_b32 v44, v46
    v_permlane16_swap_b32 v45, v47
    v_permlane16_swap_b32 v48, v50
    v_permlane16_swap_b32 v49, v51
    v_pk_fma_f32 v[148:149], v[110:111], v[68:69], v[148:149] op_sel_hi:[0,1,1] neg_lo:[1,0,0] neg_hi:[1,0,0]
    v_pk_fma_f32 v[150:151], v[110:111], v[70:71], v[150:151] op_sel_hi:[0,1,1] neg_lo:[1,0,0] neg_hi:[1,0,0]
    v_pk_fma_f32 v[152:153], v[110:111], v[72:73], v[152:153] op_sel_hi:[0,1,1] neg_lo:[1,0,0] neg_hi:[1,0,0]
    v_pk_fma_f32 v[154:155], v[110:111], v[74:75], v[154:155] op_sel_hi:[0,1,1] neg_lo:[1,0,0] neg_hi:[1,0,0]
    v_pk_fma_f32 v[156:157], v[110:111], v[76:77], v[156:157] op_sel_hi:[0,1,1] neg_lo:[1,0,0] neg_hi:[1,0,0]
    v_pk_fma_f32 v[158:159], v[110:111], v[78:79], v[158:159] op_sel_hi:[0,1,1] neg_lo:[1,0,0] neg_hi:[1,0,0]
    v_pk_fma_f32 v[160:161], v[110:111], v[80:81], v[160:161] op_sel_hi:[0,1,1] neg_lo:[1,0,0] neg_hi:[1,0,0]
    v_pk_fma_f32 v[162:163], v[110:111], v[82:83], v[162:163] op_sel_hi:[0,1,1] neg_lo:[1,0,0] neg_hi:[1,0,0]
    v_pk_fma_f32 v[164:165], v[110:111], v[84:85], v[164:165] op_sel_hi:[0,1,1] neg_lo:[1,0,0] neg_hi:[1,0,0]
    v_pk_fma_f32 v[166:167], v[110:111], v[86:87], v[166:167] op_sel_hi:[0,1,1] neg_lo:[1,0,0] neg_hi:[1,0,0]
    v_pk_fma_f32 v[168:169], v[110:111], v[88:89], v[168:169] op_sel_hi:[0,1,1] neg_lo:[1,0,0] neg_hi:[1,0,0]
    v_pk_fma_f32 v[170:171], v[110:111], v[90:91], v[170:171] op_sel_hi:[0,1,1] neg_lo:[1,0,0] neg_hi:[1,0,0]
    v_pk_fma_f32 v[172:173], v[110:111], v[92:93], v[172:173] op_sel_hi:[0,1,1] neg_lo:[1,0,0] neg_hi:[1,0,0]
    v_pk_fma_f32 v[174:175], v[110:111], v[94:95], v[174:175] op_sel_hi:[0,1,1] neg_lo:[1,0,0] neg_hi:[1,0,0]
    v_pk_fma_f32 v[176:177], v[110:111], v[96:97], v[176:177] op_sel_hi:[0,1,1] neg_lo:[1,0,0] neg_hi:[1,0,0]
    v_pk_fma_f32 v[178:179], v[110:111], v[98:99], v[178:179] op_sel_hi:[0,1,1] neg_lo:[1,0,0] neg_hi:[1,0,0]
    v_pk_mul_f32 v[148:149], v[148:149], v[110:111] op_sel:[0,1] op_sel_hi:[1,1]
    v_pk_mul_f32 v[150:151], v[150:151], v[110:111] op_sel:[0,1] op_sel_hi:[1,1]
    v_pk_mul_f32 v[152:153], v[152:153], v[110:111] op_sel:[0,1] op_sel_hi:[1,1]
    v_pk_mul_f32 v[154:155], v[154:155], v[110:111] op_sel:[0,1] op_sel_hi:[1,1]
    v_pk_mul_f32 v[156:157], v[156:157], v[110:111] op_sel:[0,1] op_sel_hi:[1,1]
    v_pk_mul_f32 v[158:159], v[158:159], v[110:111] op_sel:[0,1] op_sel_hi:[1,1]
    v_pk_mul_f32 v[160:161], v[160:161], v[110:111] op_sel:[0,1] op_sel_hi:[1,1]
    v_pk_mul_f32 v[162:163], v[162:163], v[110:111] op_sel:[0,1] op_sel_hi:[1,1]
    v_pk_mul_f32 v[164:165], v[164:165], v[110:111] op_sel:[0,1] op_sel_hi:[1,1]
    v_pk_mul_f32 v[166:167], v[166:167], v[110:111] op_sel:[0,1] op_sel_hi:[1,1]
    v_pk_mul_f32 v[168:169], v[168:169], v[110:111] op_sel:[0,1] op_sel_hi:[1,1]
    v_pk_mul_f32 v[170:171], v[170:171], v[110:111] op_sel:[0,1] op_sel_hi:[1,1]
    v_pk_mul_f32 v[172:173], v[172:173], v[110:111] op_sel:[0,1] op_sel_hi:[1,1]
    v_pk_mul_f32 v[174:175], v[174:175], v[110:111] op_sel:[0,1] op_sel_hi:[1,1]
    v_pk_mul_f32 v[176:177], v[176:177], v[110:111] op_sel:[0,1] op_sel_hi:[1,1]
    v_pk_mul_f32 v[178:179], v[178:179], v[110:111] op_sel:[0,1] op_sel_hi:[1,1]
    v_mfma_f32_16x16x32_bf16 v[212:215], a[48:51], a[92:95], v[212:215]
    s_add_u32 m0, s47, 0
    s_nop 0
    buffer_load_dwordx4 v20, s[96:99], 0 offen lds
    v_cvt_pk_bf16_f32 v52, v148, v149
    v_cvt_pk_bf16_f32 v53, v150, v151
    v_cvt_pk_bf16_f32 v54, v152, v153
    v_cvt_pk_bf16_f32 v55, v154, v155
    v_mfma_f32_16x16x32_bf16 v[216:219], a[52:55], a[92:95], v[216:219]
    s_add_u32 m0, s47, 1024
    s_nop 0
    buffer_load_dwordx4 v21, s[96:99], 0 offen lds
    v_cvt_pk_bf16_f32 v56, v156, v157
    v_cvt_pk_bf16_f32 v57, v158, v159
    v_cvt_pk_bf16_f32 v58, v160, v161
    v_cvt_pk_bf16_f32 v59, v162, v163
    v_mfma_f32_16x16x32_bf16 v[220:223], a[56:59], a[92:95], v[220:223]
    s_add_u32 m0, s47, 2048
    s_nop 0
    buffer_load_dwordx4 v22, s[96:99], 0 offen lds
    v_cvt_pk_bf16_f32 v60, v164, v165
    v_cvt_pk_bf16_f32 v61, v166, v167
    v_cvt_pk_bf16_f32 v62, v168, v169
    v_cvt_pk_bf16_f32 v63, v170, v171
    v_mfma_f32_16x16x32_bf16 v[224:227], a[60:63], a[92:95], v[224:227]
    s_add_u32 m0, s47, 3072
    s_nop 0
    buffer_load_dwordx4 v23, s[96:99], 0 offen lds
    v_cvt_pk_bf16_f32 v64, v172, v173
    v_cvt_pk_bf16_f32 v65, v174, v175
    v_cvt_pk_bf16_f32 v66, v176, v177
    v_cvt_pk_bf16_f32 v67, v178, v179
    v_mfma_f32_16x16x32_bf16 v[228:231], a[64:67], a[92:95], v[228:231]
    s_add_u32 m0, s47, 4096
    s_nop 0
    buffer_load_dwordx4 v24, s[96:99], 0 offen lds
    v_permlane32_swap_b32 v52, v54
    v_permlane32_swap_b32 v53, v55
    v_permlane32_swap_b32 v56, v58
    v_permlane32_swap_b32 v57, v59
    v_mfma_f32_16x16x32_bf16 v[232:235], a[68:71], a[92:95], v[232:235]
    v_permlane32_swap_b32 v60, v62
    v_permlane32_swap_b32 v61, v63
    v_permlane32_swap_b32 v64, v66
    v_permlane32_swap_b32 v65, v67
    v_mfma_f32_16x16x32_bf16 v[236:239], a[72:75], a[92:95], v[236:239]
    v_permlane16_swap_b32 v52, v54
    v_permlane16_swap_b32 v53, v55
    v_permlane16_swap_b32 v56, v58
    v_permlane16_swap_b32 v57, v59
    v_mfma_f32_16x16x32_bf16 v[240:243], a[76:79], a[92:95], v[240:243]
    v_permlane16_swap_b32 v60, v62
    v_permlane16_swap_b32 v61, v63
    v_permlane16_swap_b32 v64, v66
    v_permlane16_swap_b32 v65, v67
    v_pk_fma_f32 v[180:181], v[112:113], v[68:69], v[180:181] op_sel_hi:[0,1,1] neg_lo:[1,0,0] neg_hi:[1,0,0]
    v_pk_fma_f32 v[182:183], v[112:113], v[70:71], v[182:183] op_sel_hi:[0,1,1] neg_lo:[1,0,0] neg_hi:[1,0,0]
    v_pk_fma_f32 v[184:185], v[112:113], v[72:73], v[184:185] op_sel_hi:[0,1,1] neg_lo:[1,0,0] neg_hi:[1,0,0]
    v_pk_fma_f32 v[186:187], v[112:113], v[74:75], v[186:187] op_sel_hi:[0,1,1] neg_lo:[1,0,0] neg_hi:[1,0,0]
    v_pk_fma_f32 v[188:189], v[112:113], v[76:77], v[188:189] op_sel_hi:[0,1,1] neg_lo:[1,0,0] neg_hi:[1,0,0]
    v_pk_fma_f32 v[190:191], v[112:113], v[78:79], v[190:191] op_sel_hi:[0,1,1] neg_lo:[1,0,0] neg_hi:[1,0,0]
    v_pk_fma_f32 v[192:193], v[112:113], v[80:81], v[192:193] op_sel_hi:[0,1,1] neg_lo:[1,0,0] neg_hi:[1,0,0]
    v_pk_fma_f32 v[194:195], v[112:113], v[82:83], v[194:195] op_sel_hi:[0,1,1] neg_lo:[1,0,0] neg_hi:[1,0,0]
    v_pk_fma_f32 v[196:197], v[112:113], v[84:85], v[196:197] op_sel_hi:[0,1,1] neg_lo:[1,0,0] neg_hi:[1,0,0]
    v_pk_fma_f32 v[198:199], v[112:113], v[86:87], v[198:199] op_sel_hi:[0,1,1] neg_lo:[1,0,0] neg_hi:[1,0,0]
    v_pk_fma_f32 v[200:201], v[112:113], v[88:89], v[200:201] op_sel_hi:[0,1,1] neg_lo:[1,0,0] neg_hi:[1,0,0]
    v_pk_fma_f32 v[202:203], v[112:113], v[90:91], v[202:203] op_sel_hi:[0,1,1] neg_lo:[1,0,0] neg_hi:[1,0,0]
    v_pk_fma_f32 v[204:205], v[112:113], v[92:93], v[204:205] op_sel_hi:[0,1,1] neg_lo:[1,0,0] neg_hi:[1,0,0]
    v_pk_fma_f32 v[206:207], v[112:113], v[94:95], v[206:207] op_sel_hi:[0,1,1] neg_lo:[1,0,0] neg_hi:[1,0,0]
    v_pk_fma_f32 v[208:209], v[112:113], v[96:97], v[208:209] op_sel_hi:[0,1,1] neg_lo:[1,0,0] neg_hi:[1,0,0]
    v_pk_fma_f32 v[210:211], v[112:113], v[98:99], v[210:211] op_sel_hi:[0,1,1] neg_lo:[1,0,0] neg_hi:[1,0,0]
    v_pk_mul_f32 v[180:181], v[180:181], v[112:113] op_sel:[0,1] op_sel_hi:[1,1]
    v_pk_mul_f32 v[182:183], v[182:183], v[112:113] op_sel:[0,1] op_sel_hi:[1,1]
    v_pk_mul_f32 v[184:185], v[184:185], v[112:113] op_sel:[0,1] op_sel_hi:[1,1]
    v_pk_mul_f32 v[186:187], v[186:187], v[112:113] op_sel:[0,1] op_sel_hi:[1,1]
    v_pk_mul_f32 v[188:189], v[188:189], v[112:113] op_sel:[0,1] op_sel_hi:[1,1]
    v_pk_mul_f32 v[190:191], v[190:191], v[112:113] op_sel:[0,1] op_sel_hi:[1,1]
    v_pk_mul_f32 v[192:193], v[192:193], v[112:113] op_sel:[0,1] op_sel_hi:[1,1]
    v_pk_mul_f32 v[194:195], v[194:195], v[112:113] op_sel:[0,1] op_sel_hi:[1,1]
    v_pk_mul_f32 v[196:197], v[196:197], v[112:113] op_sel:[0,1] op_sel_hi:[1,1]
    v_pk_mul_f32 v[198:199], v[198:199], v[112:113] op_sel:[0,1] op_sel_hi:[1,1]
    v_pk_mul_f32 v[200:201], v[200:201], v[112:113] op_sel:[0,1] op_sel_hi:[1,1]
    v_pk_mul_f32 v[202:203], v[202:203], v[112:113] op_sel:[0,1] op_sel_hi:[1,1]
    v_pk_mul_f32 v[204:205], v[204:205], v[112:113] op_sel:[0,1] op_sel_hi:[1,1]
    v_pk_mul_f32 v[206:207], v[206:207], v[112:113] op_sel:[0,1] op_sel_hi:[1,1]
    v_pk_mul_f32 v[208:209], v[208:209], v[112:113] op_sel:[0,1] op_sel_hi:[1,1]
    v_pk_mul_f32 v[210:211], v[210:211], v[112:113] op_sel:[0,1] op_sel_hi:[1,1]
    v_pk_fma_f32 v[212:213], v[114:115], v[68:69], v[212:213] op_sel_hi:[0,1,1] neg_lo:[1,0,0] neg_hi:[1,0,0]
    v_pk_fma_f32 v[214:215], v[114:115], v[70:71], v[214:215] op_sel_hi:[0,1,1] neg_lo:[1,0,0] neg_hi:[1,0,0]
    v_pk_fma_f32 v[216:217], v[114:115], v[72:73], v[216:217] op_sel_hi:[0,1,1] neg_lo:[1,0,0] neg_hi:[1,0,0]
    v_pk_fma_f32 v[218:219], v[114:115], v[74:75], v[218:219] op_sel_hi:[0,1,1] neg_lo:[1,0,0] neg_hi:[1,0,0]
    v_pk_fma_f32 v[220:221], v[114:115], v[76:77], v[220:221] op_sel_hi:[0,1,1] neg_lo:[1,0,0] neg_hi:[1,0,0]
    v_pk_fma_f32 v[222:223], v[114:115], v[78:79], v[222:223] op_sel_hi:[0,1,1] neg_lo:[1,0,0] neg_hi:[1,0,0]
    v_pk_fma_f32 v[224:225], v[114:115], v[80:81], v[224:225] op_sel_hi:[0,1,1] neg_lo:[1,0,0] neg_hi:[1,0,0]
    v_pk_fma_f32 v[226:227], v[114:115], v[82:83], v[226:227] op_sel_hi:[0,1,1] neg_lo:[1,0,0] neg_hi:[1,0,0]
    v_pk_fma_f32 v[228:229], v[114:115], v[84:85], v[228:229] op_sel_hi:[0,1,1] neg_lo:[1,0,0] neg_hi:[1,0,0]
    v_pk_fma_f32 v[230:231], v[114:115], v[86:87], v[230:231] op_sel_hi:[0,1,1] neg_lo:[1,0,0] neg_hi:[1,0,0]
    v_pk_fma_f32 v[232:233], v[114:115], v[88:89], v[232:233] op_sel_hi:[0,1,1] neg_lo:[1,0,0] neg_hi:[1,0,0]
    v_pk_fma_f32 v[234:235], v[114:115], v[90:91], v[234:235] op_sel_hi:[0,1,1] neg_lo:[1,0,0] neg_hi:[1,0,0]
    v_pk_fma_f32 v[236:237], v[114:115], v[92:93], v[236:237] op_sel_hi:[0,1,1] neg_lo:[1,0,0] neg_hi:[1,0,0]
    v_pk_fma_f32 v[238:239], v[114:115], v[94:95], v[238:239] op_sel_hi:[0,1,1] neg_lo:[1,0,0] neg_hi:[1,0,0]
    v_pk_fma_f32 v[240:241], v[114:115], v[96:97], v[240:241] op_sel_hi:[0,1,1] neg_lo:[1,0,0] neg_hi:[1,0,0]
    v_pk_fma_f32 v[242:243], v[114:115], v[98:99], v[242:243] op_sel_hi:[0,1,1] neg_lo:[1,0,0] neg_hi:[1,0,0]
    s_waitcnt lgkmcnt(0)
    v_mfma_f32_16x16x32_bf16 v[116:119], a[128:131], v[36:39], 0
    v_cvt_pk_bf16_f32 v68, v180, v181
    v_cvt_pk_bf16_f32 v69, v182, v183
    v_cvt_pk_bf16_f32 v70, v184, v185
    v_cvt_pk_bf16_f32 v71, v186, v187
    v_mfma_f32_16x16x32_bf16 v[116:119], a[132:135], v[40:43], v[116:119]
    v_cvt_pk_bf16_f32 v72, v188, v189
    v_cvt_pk_bf16_f32 v73, v190, v191
    v_cvt_pk_bf16_f32 v74, v192, v193
    v_cvt_pk_bf16_f32 v75, v194, v195
    v_mfma_f32_16x16x32_bf16 v[116:119], a[136:139], v[44:47], v[116:119]
    v_cvt_pk_bf16_f32 v76, v196, v197
    v_cvt_pk_bf16_f32 v77, v198, v199
    v_cvt_pk_bf16_f32 v78, v200, v201
    v_cvt_pk_bf16_f32 v79, v202, v203
    v_mfma_f32_16x16x32_bf16 v[116:119], a[140:143], v[48:51], v[116:119]
    v_cvt_pk_bf16_f32 v80, v204, v205
    v_cvt_pk_bf16_f32 v81, v206, v207
    v_cvt_pk_bf16_f32 v82, v208, v209
    v_cvt_pk_bf16_f32 v83, v210, v211
    v_mfma_f32_16x16x32_bf16 v[132:135], a[144:147], v[36:39], 0
    v_permlane32_swap_b32 v68, v70
    v_permlane32_swap_b32 v69, v71
    v_permlane32_swap_b32 v72, v74
    v_permlane32_swap_b32 v73, v75
    v_mfma_f32_16x16x32_bf16 v[132:135], a[148:151], v[40:43], v[132:135]
    v_permlane32_swap_b32 v76, v78
    v_permlane32_swap_b32 v77, v79
    v_permlane32_swap_b32 v80, v82
    v_permlane32_swap_b32 v81, v83
    v_mfma_f32_16x16x32_bf16 v[132:135], a[152:155], v[44:47], v[132:135]
    v_permlane16_swap_b32 v68, v70
    v_permlane16_swap_b32 v69, v71
    v_permlane16_swap_b32 v72, v74
    v_permlane16_swap_b32 v73, v75
    v_mfma_f32_16x16x32_bf16 v[132:135], a[156:159], v[48:51], v[132:135]
    v_permlane16_swap_b32 v76, v78
    v_permlane16_swap_b32 v77, v79
    v_permlane16_swap_b32 v80, v82
    v_permlane16_swap_b32 v81, v83
    v_pk_mul_f32 v[212:213], v[212:213], v[114:115] op_sel:[0,1] op_sel_hi:[1,1]
    v_pk_mul_f32 v[214:215], v[214:215], v[114:115] op_sel:[0,1] op_sel_hi:[1,1]
    v_pk_mul_f32 v[216:217], v[216:217], v[114:115] op_sel:[0,1] op_sel_hi:[1,1]
    v_pk_mul_f32 v[218:219], v[218:219], v[114:115] op_sel:[0,1] op_sel_hi:[1,1]
    v_pk_mul_f32 v[220:221], v[220:221], v[114:115] op_sel:[0,1] op_sel_hi:[1,1]
    v_pk_mul_f32 v[222:223], v[222:223], v[114:115] op_sel:[0,1] op_sel_hi:[1,1]
    v_pk_mul_f32 v[224:225], v[224:225], v[114:115] op_sel:[0,1] op_sel_hi:[1,1]
    v_pk_mul_f32 v[226:227], v[226:227], v[114:115] op_sel:[0,1] op_sel_hi:[1,1]
    v_pk_mul_f32 v[228:229], v[228:229], v[114:115] op_sel:[0,1] op_sel_hi:[1,1]
    v_pk_mul_f32 v[230:231], v[230:231], v[114:115] op_sel:[0,1] op_sel_hi:[1,1]
    v_pk_mul_f32 v[232:233], v[232:233], v[114:115] op_sel:[0,1] op_sel_hi:[1,1]
    v_pk_mul_f32 v[234:235], v[234:235], v[114:115] op_sel:[0,1] op_sel_hi:[1,1]
    v_pk_mul_f32 v[236:237], v[236:237], v[114:115] op_sel:[0,1] op_sel_hi:[1,1]
    v_pk_mul_f32 v[238:239], v[238:239], v[114:115] op_sel:[0,1] op_sel_hi:[1,1]
    v_pk_mul_f32 v[240:241], v[240:241], v[114:115] op_sel:[0,1] op_sel_hi:[1,1]
    v_pk_mul_f32 v[242:243], v[242:243], v[114:115] op_sel:[0,1] op_sel_hi:[1,1]
    v_mfma_f32_16x16x32_bf16 v[120:123], a[140:143], v[64:67], 0
    v_cvt_pk_bf16_f32 v84, v212, v213
    v_cvt_pk_bf16_f32 v85, v214, v215
    v_cvt_pk_bf16_f32 v86, v216, v217
    v_cvt_pk_bf16_f32 v87, v218, v219
    v_mfma_f32_16x16x32_bf16 v[120:123], a[136:139], v[60:63], v[120:123]
    v_cvt_pk_bf16_f32 v88, v220, v221
    v_cvt_pk_bf16_f32 v89, v222, v223
    v_cvt_pk_bf16_f32 v90, v224, v225
    v_cvt_pk_bf16_f32 v91, v226, v227
    v_mfma_f32_16x16x32_bf16 v[120:123], a[132:135], v[56:59], v[120:123]
    v_cvt_pk_bf16_f32 v92, v228, v229
    v_cvt_pk_bf16_f32 v93, v230, v231
    v_cvt_pk_bf16_f32 v94, v232, v233
    v_cvt_pk_bf16_f32 v95, v234, v235
    v_mfma_f32_16x16x32_bf16 v[120:123], a[128:131], v[52:55], v[120:123]
    v_cvt_pk_bf16_f32 v96, v236, v237
    v_cvt_pk_bf16_f32 v97, v238, v239
    v_cvt_pk_bf16_f32 v98, v240, v241
    v_cvt_pk_bf16_f32 v99, v242, v243
    v_mfma_f32_16x16x32_bf16 v[136:139], a[156:159], v[64:67], 0
    v_permlane32_swap_b32 v84, v86
    v_permlane32_swap_b32 v85, v87
    v_permlane32_swap_b32 v88, v90
    v_permlane32_swap_b32 v89, v91
    v_mfma_f32_16x16x32_bf16 v[136:139], a[152:155], v[60:63], v[136:139]
    v_permlane32_swap_b32 v92, v94
    v_permlane32_swap_b32 v93, v95
    v_permlane32_swap_b32 v96, v98
    v_permlane32_swap_b32 v97, v99
    v_mfma_f32_16x16x32_bf16 v[136:139], a[148:151], v[56:59], v[136:139]
    v_permlane16_swap_b32 v84, v86
    v_permlane16_swap_b32 v85, v87
    v_permlane16_swap_b32 v88, v90
    v_permlane16_swap_b32 v89, v91
    v_mfma_f32_16x16x32_bf16 v[136:139], a[144:147], v[52:55], v[136:139]
    v_permlane16_swap_b32 v92, v94
    v_permlane16_swap_b32 v93, v95
    v_permlane16_swap_b32 v96, v98
    v_permlane16_swap_b32 v97, v99
    v_mfma_f32_16x16x32_bf16 v[124:127], a[128:131], v[68:71], 0
    v_max3_f32 v28, v116, v117, v118
    v_max3_f32 v30, v120, v121, v122
    v_mfma_f32_16x16x32_bf16 v[124:127], a[132:135], v[72:75], v[124:127]
    v_max3_f32 v29, v119, v132, v133
    v_max3_f32 v31, v123, v136, v137
    v_max3_f32 v28, v28, v134, v135
    v_mfma_f32_16x16x32_bf16 v[124:127], a[136:139], v[76:79], v[124:127]
    v_max3_f32 v30, v30, v138, v139
    v_max_f32 v28, v28, v29
    v_max_f32 v30, v30, v31
    v_mfma_f32_16x16x32_bf16 v[124:127], a[140:143], v[80:83], v[124:127]
    v_mov_b32 v29, v28
    v_mov_b32 v31, v30
    s_nop 0
    v_permlane32_swap_b32 v28, v29
    v_mfma_f32_16x16x32_bf16 v[140:143], a[144:147], v[68:71], 0
    v_permlane32_swap_b32 v30, v31
    v_max_f32 v28, v28, v29
    v_mfma_f32_16x16x32_bf16 v[140:143], a[148:151], v[72:75], v[140:143]
    v_max_f32 v30, v30, v31
    v_mov_b32 v29, v28
    v_mov_b32 v31, v30
    v_mfma_f32_16x16x32_bf16 v[140:143], a[152:155], v[76:79], v[140:143]
    v_permlane16_swap_b32 v28, v29
    v_permlane16_swap_b32 v30, v31
    v_max_f32 v28, v28, v29
    v_mfma_f32_16x16x32_bf16 v[140:143], a[156:159], v[80:83], v[140:143]
    v_max_f32 v30, v30, v31
    v_sub_f32 v100, 0, v28
    v_sub_f32 v104, 0, v30
    v_mfma_f32_16x16x32_bf16 v[128:131], a[140:143], v[96:99], 0
    v_sub_f32 v101, 0, v28
    v_sub_f32 v105, 0, v30
    v_mfma_f32_16x16x32_bf16 v[128:131], a[136:139], v[92:95], v[128:131]
    v_sub_f32 v102, 0, v28
    v_sub_f32 v106, 0, v30
    v_sub_f32 v103, 0, v28
    v_mfma_f32_16x16x32_bf16 v[128:131], a[132:135], v[88:91], v[128:131]
    v_sub_f32 v107, 0, v30
    v_sub_f32 v116, v116, v28
    v_sub_f32 v120, v120, v30
    v_mfma_f32_16x16x32_bf16 v[128:131], a[128:131], v[84:87], v[128:131]
    v_sub_f32 v117, v117, v28
    v_sub_f32 v121, v121, v30
    v_sub_f32 v118, v118, v28
    v_mfma_f32_16x16x32_bf16 v[144:147], a[156:159], v[96:99], 0
    v_sub_f32 v122, v122, v30
    v_sub_f32 v119, v119, v28
    v_mfma_f32_16x16x32_bf16 v[144:147], a[152:155], v[92:95], v[144:147]
    v_sub_f32 v123, v123, v30
    v_sub_f32 v132, v132, v28
    v_sub_f32 v136, v136, v30
    v_mfma_f32_16x16x32_bf16 v[144:147], a[148:151], v[88:91], v[144:147]
    v_sub_f32 v133, v133, v28
    v_sub_f32 v137, v137, v30
    v_sub_f32 v134, v134, v28
    v_mfma_f32_16x16x32_bf16 v[144:147], a[144:147], v[84:87], v[144:147]
    v_sub_f32 v138, v138, v30
    v_sub_f32 v135, v135, v28
    v_sub_f32 v139, v139, v30
    s_waitcnt vmcnt(14)
    s_barrier
    v_mfma_f32_16x16x32_bf16 v[148:151], a[160:163], v[36:39], v[100:103]
    s_add_u32 m0, s34, 0
    s_nop 3
    v_mfma_f32_16x16x32_bf16 v[148:151], a[164:167], v[40:43], v[148:151]
    ds_read_b128 a[128:131], v1 offset:16384
    v_max3_f32 v32, v124, v125, v126
    v_max3_f32 v34, v128, v129, v130
    v_mfma_f32_16x16x32_bf16 v[148:151], a[168:171], v[44:47], v[148:151]
    ds_read_b128 a[132:135], v2 offset:16384
    v_max3_f32 v33, v127, v140, v141
    v_max3_f32 v35, v131, v144, v145
    v_max3_f32 v32, v32, v142, v143
    v_mfma_f32_16x16x32_bf16 v[148:151], a[172:175], v[48:51], v[148:151]
    buffer_load_dwordx4 v13, s[8:11], s28 offen offset:0 lds
    v_max3_f32 v34, v34, v146, v147
    v_max_f32 v32, v32, v33
    v_max_f32 v34, v34, v35
    v_mfma_f32_16x16x32_bf16 v[152:155], a[172:175], v[64:67], v[104:107]
    v_mov_b32 v33, v32
    v_mov_b32 v35, v34
    s_nop 0
    v_permlane32_swap_b32 v32, v33
    v_mfma_f32_16x16x32_bf16 v[152:155], a[168:171], v[60:63], v[152:155]
    v_permlane32_swap_b32 v34, v35
    v_max_f32 v32, v32, v33
    v_max_f32 v34, v34, v35
    v_mfma_f32_16x16x32_bf16 v[152:155], a[164:167], v[56:59], v[152:155]
    v_mov_b32 v33, v32
    v_mov_b32 v35, v34
    s_nop 0
    v_permlane16_swap_b32 v32, v33
    v_mfma_f32_16x16x32_bf16 v[152:155], a[160:163], v[52:55], v[152:155]
    v_permlane16_swap_b32 v34, v35
    v_max_f32 v32, v32, v33
    v_max_f32 v34, v34, v35
    v_mfma_f32_16x16x32_bf16 v[164:167], a[176:179], v[36:39], v[100:103]
    v_sub_f32 v108, 0, v32
    v_sub_f32 v112, 0, v34
    v_sub_f32 v109, 0, v32
    v_mfma_f32_16x16x32_bf16 v[164:167], a[180:183], v[40:43], v[164:167]
    v_sub_f32 v113, 0, v34
    v_sub_f32 v110, 0, v32
    v_sub_f32 v114, 0, v34
    v_mfma_f32_16x16x32_bf16 v[164:167], a[184:187], v[44:47], v[164:167]
    v_sub_f32 v111, 0, v32
    v_sub_f32 v115, 0, v34
    v_sub_f32 v124, v124, v32
    v_mfma_f32_16x16x32_bf16 v[164:167], a[188:191], v[48:51], v[164:167]
    v_sub_f32 v128, v128, v34
    v_sub_f32 v125, v125, v32
    v_sub_f32 v129, v129, v34
    v_mfma_f32_16x16x32_bf16 v[168:171], a[188:191], v[64:67], v[104:107]
    v_sub_f32 v126, v126, v32
    v_sub_f32 v130, v130, v34
    v_sub_f32 v127, v127, v32
    v_mfma_f32_16x16x32_bf16 v[168:171], a[184:187], v[60:63], v[168:171]
    v_sub_f32 v131, v131, v34
    v_sub_f32 v140, v140, v32
    v_sub_f32 v144, v144, v34
    v_mfma_f32_16x16x32_bf16 v[168:171], a[180:183], v[56:59], v[168:171]
    v_sub_f32 v141, v141, v32
    v_sub_f32 v145, v145, v34
    v_sub_f32 v142, v142, v32
    v_mfma_f32_16x16x32_bf16 v[168:171], a[176:179], v[52:55], v[168:171]
    v_sub_f32 v146, v146, v34
    v_sub_f32 v143, v143, v32
    v_sub_f32 v147, v147, v34
    s_nop 0
    v_mfma_f32_16x16x32_bf16 v[156:159], a[160:163], v[68:71], v[108:111]
    ds_read_b128 a[136:139], v3 offset:16384
    v_mfma_f32_16x16x32_bf16 v[156:159], a[164:167], v[72:75], v[156:159]
    ds_read_b128 a[140:143], v4 offset:16384
    v_mfma_f32_16x16x32_bf16 v[156:159], a[168:171], v[76:79], v[156:159]
    buffer_load_dwordx4 v14, s[8:11], s28 offen offset:1024 lds
    v_mfma_f32_16x16x32_bf16 v[156:159], a[172:175], v[80:83], v[156:159]
    v_mfma_f32_16x16x32_bf16 v[160:163], a[172:175], v[96:99], v[112:115]
    v_mfma_f32_16x16x32_bf16 v[160:163], a[168:171], v[92:95], v[160:163]
    v_mfma_f32_16x16x32_bf16 v[160:163], a[164:167], v[88:91], v[160:163]
    v_mfma_f32_16x16x32_bf16 v[160:163], a[160:163], v[84:87], v[160:163]
    s_waitcnt lgkmcnt(2)
    v_mfma_f32_16x16x32_bf16 v[172:175], a[176:179], v[68:71], v[108:111]
    s_waitcnt vmcnt(7)
    ds_read_b128 a[144:147], v1 offset:20480
    v_exp_f32 v116, v116
    v_mfma_f32_16x16x32_bf16 v[172:175], a[180:183], v[72:75], v[172:175]
    ds_read_b128 a[148:151], v2 offset:20480
    v_exp_f32 v117, v117
    v_mfma_f32_16x16x32_bf16 v[172:175], a[184:187], v[76:79], v[172:175]
    v_cvt_pk_bf16_f32 v180, v116, v117
    v_exp_f32 v118, v118
    v_mfma_f32_16x16x32_bf16 v[172:175], a[188:191], v[80:83], v[172:175]
    v_exp_f32 v119, v119
    v_mfma_f32_16x16x32_bf16 v[176:179], a[188:191], v[96:99], v[112:115]
    v_cvt_pk_bf16_f32 v181, v118, v119
    v_exp_f32 v120, v120
    v_mfma_f32_16x16x32_bf16 v[176:179], a[184:187], v[92:95], v[176:179]
    v_exp_f32 v121, v121
    v_mfma_f32_16x16x32_bf16 v[176:179], a[180:183], v[88:91], v[176:179]
    buffer_load_dwordx4 v15, s[8:11], s28 offen offset:2048 lds
    v_cvt_pk_bf16_f32 v188, v120, v121
    v_exp_f32 v122, v122
    v_mfma_f32_16x16x32_bf16 v[176:179], a[176:179], v[84:87], v[176:179]
    s_waitcnt lgkmcnt(2)
    v_exp_f32 v123, v123
    v_mfma_f32_16x16x32_bf16 v[116:119], a[128:131], v[36:39], v[100:103]
    ds_read_b128 a[152:155], v3 offset:20480
    v_cvt_pk_bf16_f32 v189, v122, v123
    v_exp_f32 v124, v124
    v_mfma_f32_16x16x32_bf16 v[116:119], a[132:135], v[40:43], v[116:119]
    ds_read_b128 a[156:159], v4 offset:20480
    v_exp_f32 v125, v125
    v_mfma_f32_16x16x32_bf16 v[116:119], a[136:139], v[44:47], v[116:119]
    v_cvt_pk_bf16_f32 v196, v124, v125
    v_exp_f32 v126, v126
    v_cmp_gt_u32 vcc, 32, v252
    s_and_b64 vcc, vcc, exec
    s_cbranch_scc1 L_spin_all
L_back_all:
    v_mfma_f32_16x16x32_bf16 v[116:119], a[140:143], v[48:51], v[116:119]
    s_cmp_eq_u32 s6, 240
    s_cbranch_scc1 L_rt_keys
L_rt_back_keys:
    v_exp_f32 v127, v127
    v_mfma_f32_16x16x32_bf16 v[120:123], a[140:143], v[64:67], v[104:107]
    v_cvt_pk_bf16_f32 v197, v126, v127
    v_exp_f32 v128, v128
    v_mfma_f32_16x16x32_bf16 v[120:123], a[136:139], v[60:63], v[120:123]
    v_exp_f32 v129, v129
    v_mfma_f32_16x16x32_bf16 v[120:123], a[132:135], v[56:59], v[120:123]
    buffer_load_dwordx4 v16, s[8:11], s28 offen offset:3072 lds
    v_cvt_pk_bf16_f32 v204, v128, v129
    v_exp_f32 v130, v130
    v_mfma_f32_16x16x32_bf16 v[120:123], a[128:131], v[52:55], v[120:123]
    s_waitcnt lgkmcnt(2)
    v_exp_f32 v131, v131
    v_mfma_f32_16x16x32_bf16 v[124:127], a[128:131], v[68:71], v[108:111]
    ds_read_b128 a[160:163], v1 offset:24576
    v_cvt_pk_bf16_f32 v205, v130, v131
    v_exp_f32 v132, v132
    v_mfma_f32_16x16x32_bf16 v[124:127], a[132:135], v[72:75], v[124:127]
    ds_read_b128 a[164:167], v2 offset:24576
    v_exp_f32 v133, v133
    v_mfma_f32_16x16x32_bf16 v[124:127], a[136:139], v[76:79], v[124:127]
    v_cvt_pk_bf16_f32 v182, v132, v133
    v_exp_f32 v134, v134
    v_mfma_f32_16x16x32_bf16 v[124:127], a[140:143], v[80:83], v[124:127]
    v_exp_f32 v135, v135
    v_mfma_f32_16x16x32_bf16 v[128:131], a[140:143], v[96:99], v[112:115]
    v_cvt_pk_bf16_f32 v183, v134, v135
    v_exp_f32 v136, v136
    v_mfma_f32_16x16x32_bf16 v[128:131], a[136:139], v[92:95], v[128:131]
    s_add_u32 s28, s28, 16384
    s_mov_b32 m0, s31
    v_exp_f32 v137, v137
    v_mfma_f32_16x16x32_bf16 v[128:131], a[132:135], v[88:91], v[128:131]
    buffer_load_dwordx4 v17, s[12:15], s29 offen offset:0 lds
    v_cvt_pk_bf16_f32 v190, v136, v137
    v_exp_f32 v138, v138
    v_mfma_f32_16x16x32_bf16 v[128:131], a[128:131], v[84:87], v[128:131]
    s_waitcnt lgkmcnt(2)
    v_exp_f32 v139, v139
    v_mfma_f32_16x16x32_bf16 v[132:135], a[144:147], v[36:39], v[100:103]
    ds_read_b128 a[168:171], v3 offset:24576
    v_cvt_pk_bf16_f32 v191, v138, v139
    v_exp_f32 v140, v140
    v_mfma_f32_16x16x32_bf16 v[132:135], a[148:151], v[40:43], v[132:135]
    ds_read_b128 a[172:175], v4 offset:24576
    v_exp_f32 v141, v141
    v_mfma_f32_16x16x32_bf16 v[132:135], a[152:155], v[44:47], v[132:135]
    v_cvt_pk_bf16_f32 v198, v140, v141
    v_exp_f32 v142, v142
    v_mfma_f32_16x16x32_bf16 v[132:135], a[156:159], v[48:51], v[132:135]
    v_exp_f32 v143, v143
    v_mfma_f32_16x16x32_bf16 v[136:139], a[156:159], v[64:67], v[104:107]
    v_cvt_pk_bf16_f32 v199, v142, v143
    v_exp_f32 v144, v144
    v_mfma_f32_16x16x32_bf16 v[136:139], a[152:155], v[60:63], v[136:139]
    v_exp_f32 v145, v145
    v_mfma_f32_16x16x32_bf16 v[136:139], a[148:151], v[56:59], v[136:139]
    buffer_load_dwordx4 v18, s[12:15], s29 offen offset:1024 lds
    v_cvt_pk_bf16_f32 v206, v144, v145
    v_exp_f32 v146, v146
    v_mfma_f32_16x16x32_bf16 v[136:139], a[144:147], v[52:55], v[136:139]
    s_waitcnt lgkmcnt(2)
    v_exp_f32 v147, v147
    v_mfma_f32_16x16x32_bf16 v[140:143], a[144:147], v[68:71], v[108:111]
    ds_read_b128 a[176:179], v1 offset:28672
    v_cvt_pk_bf16_f32 v207, v146, v147
    v_exp_f32 v148, v148
    v_mfma_f32_16x16x32_bf16 v[140:143], a[148:151], v[72:75], v[140:143]
    ds_read_b128 a[180:183], v2 offset:28672
    v_exp_f32 v149, v149
    v_mfma_f32_16x16x32_bf16 v[140:143], a[152:155], v[76:79], v[140:143]
    v_cvt_pk_bf16_f32 v184, v148, v149
    v_exp_f32 v150, v150
    v_mfma_f32_16x16x32_bf16 v[140:143], a[156:159], v[80:83], v[140:143]
    v_exp_f32 v151, v151
    v_mfma_f32_16x16x32_bf16 v[144:147], a[156:159], v[96:99], v[112:115]
    v_cvt_pk_bf16_f32 v185, v150, v151
    v_exp_f32 v152, v152
    v_mfma_f32_16x16x32_bf16 v[144:147], a[152:155], v[92:95], v[144:147]
    v_exp_f32 v153, v153
    v_mfma_f32_16x16x32_bf16 v[144:147], a[148:151], v[88:91], v[144:147]
    buffer_load_dwordx4 v17, s[12:15], s29 offen offset:2048 lds
    v_cvt_pk_bf16_f32 v192, v152, v153
    v_exp_f32 v154, v154
    v_mfma_f32_16x16x32_bf16 v[144:147], a[144:147], v[84:87], v[144:147]
    s_waitcnt lgkmcnt(2)
    v_exp_f32 v155, v155
    v_mfma_f32_16x16x32_bf16 v[148:151], a[160:163], v[36:39], v[100:103]
    ds_read_b128 a[184:187], v3 offset:28672
    v_cvt_pk_bf16_f32 v193, v154, v155
    v_exp_f32 v156, v156
    v_mfma_f32_16x16x32_bf16 v[148:151], a[164:167], v[40:43], v[148:151]
    ds_read_b128 a[188:191], v4 offset:28672
    v_exp_f32 v157, v157
    v_mfma_f32_16x16x32_bf16 v[148:151], a[168:171], v[44:47], v[148:151]
    v_cvt_pk_bf16_f32 v200, v156, v157
    v_exp_f32 v158, v158
    v_mfma_f32_16x16x32_bf16 v[148:151], a[172:175], v[48:51], v[148:151]
    v_exp_f32 v159, v159
    v_mfma_f32_16x16x32_bf16 v[152:155], a[172:175], v[64:67], v[104:107]
    v_cvt_pk_bf16_f32 v201, v158, v159
    v_exp_f32 v160, v160
    v_mfma_f32_16x16x32_bf16 v[152:155], a[168:171], v[60:63], v[152:155]
    v_exp_f32 v161, v161
    v_mfma_f32_16x16x32_bf16 v[152:155], a[164:167], v[56:59], v[152:155]
    buffer_load_dwordx4 v18, s[12:15], s29 offen offset:3072 lds
    v_cvt_pk_bf16_f32 v208, v160, v161
    v_exp_f32 v162, v162
    v_mfma_f32_16x16x32_bf16 v[152:155], a[160:163], v[52:55], v[152:155]
    s_waitcnt vmcnt(14) lgkmcnt(2)
    s_barrier
    s_add_u32 s29, s29, 16384
    v_exp_f32 v163, v163
    v_mfma_f32_16x16x32_bf16 v[156:159], a[160:163], v[68:71], v[108:111]
    s_waitcnt vmcnt(8)
    ds_read_b64_tr_b16 a[192:193], v5 offset:8192
    v_cvt_pk_bf16_f32 v209, v162, v163
    v_exp_f32 v164, v164
    v_mfma_f32_16x16x32_bf16 v[156:159], a[164:167], v[72:75], v[156:159]
    ds_read_b64_tr_b16 a[194:195], v5 offset:12288
    v_exp_f32 v165, v165
    v_mfma_f32_16x16x32_bf16 v[156:159], a[168:171], v[76:79], v[156:159]
    ds_read_b128 a[128:131], v1 offset:32768
    ds_read_b64_tr_b16 a[240:241], v25 offset:0
    v_cvt_pk_bf16_f32 v186, v164, v165
    v_exp_f32 v166, v166
    v_mfma_f32_16x16x32_bf16 v[156:159], a[172:175], v[80:83], v[156:159]
    ds_read_b64_tr_b16 a[196:197], v5 offset:32768
    v_exp_f32 v167, v167
    v_mfma_f32_16x16x32_bf16 v[160:163], a[172:175], v[96:99], v[112:115]
    ds_read_b64_tr_b16 a[198:199], v5 offset:36864
    ds_read_b64_tr_b16 a[242:243], v25 offset:2560
    v_cvt_pk_bf16_f32 v187, v166, v167
    v_exp_f32 v168, v168
    v_mfma_f32_16x16x32_bf16 v[160:163], a[168:171], v[92:95], v[160:163]
    s_add_u32 m0, s34, 49152
    ds_read_b128 a[132:135], v2 offset:32768
    ds_read_b64_tr_b16 a[244:245], v25 offset:32
    v_exp_f32 v169, v169
    v_mfma_f32_16x16x32_bf16 v[160:163], a[164:167], v[88:91], v[160:163]
    buffer_load_dwordx4 v13, s[8:11], s28 offen offset:0 lds
    v_cvt_pk_bf16_f32 v194, v168, v169
    v_exp_f32 v170, v170
    v_mfma_f32_16x16x32_bf16 v[160:163], a[160:163], v[84:87], v[160:163]
    s_waitcnt lgkmcnt(6)
    ds_read_b64_tr_b16 a[246:247], v25 offset:2592
    v_exp_f32 v171, v171
    v_mfma_f32_16x16x32_bf16 v[164:167], a[176:179], v[36:39], v[100:103]
    ds_read_b64_tr_b16 a[200:201], v6 offset:8192
    ds_read_b64_tr_b16 a[248:249], v25 offset:64
    v_cvt_pk_bf16_f32 v195, v170, v171
    v_exp_f32 v172, v172
    v_mfma_f32_16x16x32_bf16 v[164:167], a[180:183], v[40:43], v[164:167]
    ds_read_b64_tr_b16 a[202:203], v6 offset:12288
    v_exp_f32 v173, v173
    v_mfma_f32_16x16x32_bf16 v[164:167], a[184:187], v[44:47], v[164:167]
    ds_read_b128 a[136:139], v3 offset:32768
    ds_read_b64_tr_b16 a[250:251], v25 offset:2624
    v_cvt_pk_bf16_f32 v202, v172, v173
    v_exp_f32 v174, v174
    v_mfma_f32_16x16x32_bf16 v[164:167], a[188:191], v[48:51], v[164:167]
    ds_read_b64_tr_b16 a[204:205], v6 offset:32768
    ds_read_b64_tr_b16 a[252:253], v25 offset:96
    v_exp_f32 v175, v175
    v_mfma_f32_16x16x32_bf16 v[168:171], a[188:191], v[64:67], v[104:107]
    ds_read_b64_tr_b16 a[206:207], v6 offset:36864
    v_cvt_pk_bf16_f32 v203, v174, v175
    v_exp_f32 v176, v176
    v_mfma_f32_16x16x32_bf16 v[168:171], a[184:187], v[60:63], v[168:171]
    ds_read_b128 a[140:143], v4 offset:32768
    ds_read_b64_tr_b16 a[254:255], v25 offset:2656
    v_exp_f32 v177, v177
    v_mfma_f32_16x16x32_bf16 v[168:171], a[180:183], v[56:59], v[168:171]
    buffer_load_dwordx4 v14, s[8:11], s28 offen offset:1024 lds
    ds_read_b64_tr_b16 v[252:253], v25 offset:128
    v_cvt_pk_bf16_f32 v210, v176, v177
    v_exp_f32 v178, v178
    v_mfma_f32_16x16x32_bf16 v[168:171], a[176:179], v[52:55], v[168:171]
    s_waitcnt lgkmcnt(6)
    ds_read_b64_tr_b16 v[254:255], v25 offset:2688
    v_exp_f32 v179, v179
    v_mfma_f32_16x16x32_bf16 v[172:175], a[176:179], v[68:71], v[108:111]
    s_mov_b32 s16, s62
    v_exp_f32 v116, v116
    v_mfma_f32_16x16x32_bf16 v[172:175], a[180:183], v[72:75], v[172:175]
    s_mov_b32 s17, s63
    ds_read_b64_tr_b16 a[208:209], v7 offset:8192
    v_cvt_pk_bf16_f32 v211, v178, v179
    v_mfma_f32_16x16x32_bf16 v[172:175], a[184:187], v[76:79], v[172:175]
    s_mov_b32 s18, 0x21c000
    v_exp_f32 v117, v117
    v_mfma_f32_16x16x32_bf16 v[172:175], a[188:191], v[80:83], v[172:175]
    s_mov_b32 s19, 0x20000
    ds_read_b64_tr_b16 a[210:211], v7 offset:12288
    v_mfma_f32_16x16x32_bf16 v[176:179], a[188:191], v[96:99], v[112:115]
    s_mov_b32 s20, s64
    v_exp_f32 v118, v118
    v_mfma_f32_16x16x32_bf16 v[176:179], a[184:187], v[92:95], v[176:179]
    s_mov_b32 s21, s65
    ds_read_b128 a[144:147], v1 offset:36864
    v_cvt_pk_bf16_f32 v212, v116, v117
    v_mfma_f32_16x16x32_bf16 v[176:179], a[180:183], v[88:91], v[176:179]
    s_mov_b32 s22, 0x21c000
    v_exp_f32 v119, v119
    v_mfma_f32_16x16x32_bf16 v[176:179], a[176:179], v[84:87], v[176:179]
    s_mov_b32 s23, 0x20000
    ds_read_b64_tr_b16 a[212:213], v7 offset:32768
    v_mfma_f32_16x16x32_bf16 a[0:3], a[192:195], v[180:183], 0
    s_mov_b32 s96, s66
    v_exp_f32 v120, v120
    v_mfma_f32_16x16x32_bf16 a[0:3], a[196:199], v[184:187], a[0:3]
    s_mov_b32 s97, s67
    ds_read_b64_tr_b16 a[214:215], v7 offset:36864
    v_cvt_pk_bf16_f32 v213, v118, v119
    v_mfma_f32_16x16x32_bf16 a[4:7], a[196:199], v[192:195], 0
    s_mov_b32 s98, 0x21c000
    v_exp_f32 v121, v121
    v_mfma_f32_16x16x32_bf16 a[4:7], a[192:195], v[188:191], a[4:7]
    s_mov_b32 s99, 0x20000
    ds_read_b128 a[148:151], v2 offset:36864
    v_cvt_pk_bf16_f32 v220, v120, v121
    v_mfma_f32_16x16x32_bf16 a[8:11], a[192:195], v[196:199], 0
    v_exp_f32 v122, v122
    v_mfma_f32_16x16x32_bf16 a[8:11], a[196:199], v[200:203], a[8:11]
    buffer_load_dwordx4 v15, s[8:11], s28 offen offset:2048 lds
    v_mfma_f32_16x16x32_bf16 a[12:15], a[196:199], v[208:211], 0
    v_exp_f32 v123, v123
    v_mfma_f32_16x16x32_bf16 a[12:15], a[192:195], v[204:207], a[12:15]
    s_waitcnt lgkmcnt(6)
    v_mul_u32_u24 v24, 3456, v19
    v_mfma_f32_16x16x32_bf16 v[116:119], a[128:131], v[36:39], v[100:103]
    s_lshl_b32 s40, s6, 4
    v_exp_f32 v124, v124
    v_mfma_f32_16x16x32_bf16 v[116:119], a[132:135], v[40:43], v[116:119]
    ds_read_b64_tr_b16 a[216:217], v8 offset:8192
    v_cvt_pk_bf16_f32 v221, v122, v123
    v_mfma_f32_16x16x32_bf16 v[116:119], a[136:139], v[44:47], v[116:119]
    v_exp_f32 v125, v125
    v_mfma_f32_16x16x32_bf16 v[116:119], a[140:143], v[48:51], v[116:119]
    ds_read_b64_tr_b16 a[218:219], v8 offset:12288
    v_add_u32 v24, s40, v24
    v_mfma_f32_16x16x32_bf16 v[120:123], a[140:143], v[64:67], v[104:107]
    s_cmp_ge_u32 s5, 2
    s_cselect_b32 s16, s20, s16
    s_cselect_b32 s17, s21, s17
    v_exp_f32 v126, v126
    v_mfma_f32_16x16x32_bf16 v[120:123], a[136:139], v[60:63], v[120:123]
    s_cmp_ge_u32 s6, 216
    s_cselect_b32 s18, 0, s18
    ds_read_b128 a[152:155], v3 offset:36864
    v_cvt_pk_bf16_f32 v228, v124, v125
    v_mfma_f32_16x16x32_bf16 v[120:123], a[132:135], v[56:59], v[120:123]
    s_and_b32 s40, s5, 1
    v_exp_f32 v127, v127
    v_mfma_f32_16x16x32_bf16 v[120:123], a[128:131], v[52:55], v[120:123]
    s_mul_i32 s37, s40, 1105920
    ds_read_b64_tr_b16 a[220:221], v8 offset:32768
    v_mfma_f32_16x16x32_bf16 a[16:19], a[200:203], v[180:183], 0
    s_mul_i32 s38, s5, 5120
    v_exp_f32 v128, v128
    v_mfma_f32_16x16x32_bf16 a[16:19], a[204:207], v[184:187], a[16:19]
    s_add_u32 s38, s38, 65536
    ds_read_b64_tr_b16 a[222:223], v8 offset:36864
    v_cvt_pk_bf16_f32 v229, v126, v127
    v_mfma_f32_16x16x32_bf16 a[20:23], a[204:207], v[192:195], 0
    s_mov_b32 s36, 4
    buffer_store_dwordx4 a[240:243], v26, s[76:79], 0 offen offset:0 sc1
    v_exp_f32 v129, v129
    v_mfma_f32_16x16x32_bf16 a[20:23], a[200:203], v[188:191], a[20:23]
    ds_read_b128 a[156:159], v4 offset:36864
    v_mfma_f32_16x16x32_bf16 a[24:27], a[200:203], v[196:199], 0
    v_exp_f32 v130, v130
    v_mfma_f32_16x16x32_bf16 a[24:27], a[204:207], v[200:203], a[24:27]
    v_cvt_pk_bf16_f32 v236, v128, v129
    v_mfma_f32_16x16x32_bf16 a[28:31], a[204:207], v[208:211], 0
    v_exp_f32 v131, v131
    v_mfma_f32_16x16x32_bf16 a[28:31], a[200:203], v[204:207], a[28:31]
    buffer_load_dwordx4 v16, s[8:11], s28 offen offset:3072 lds
    v_smfmac_f32_16x16x64_bf16 a[224:227], v[244:247], v[180:187], v248
    s_waitcnt lgkmcnt(6)
    buffer_store_dwordx4 a[244:247], v26, s[76:79], 0 offen offset:1024 sc1
    v_mfma_f32_16x16x32_bf16 v[124:127], a[128:131], v[68:71], v[108:111]
    v_exp_f32 v132, v132
    v_mfma_f32_16x16x32_bf16 v[124:127], a[132:135], v[72:75], v[124:127]
    ds_read_b64_tr_b16 a[192:193], v9 offset:8192
    v_cvt_pk_bf16_f32 v237, v130, v131
    v_mfma_f32_16x16x32_bf16 v[124:127], a[136:139], v[76:79], v[124:127]
    v_exp_f32 v133, v133
    v_mfma_f32_16x16x32_bf16 v[124:127], a[140:143], v[80:83], v[124:127]
    ds_read_b64_tr_b16 a[194:195], v9 offset:12288
    v_mfma_f32_16x16x32_bf16 v[128:131], a[140:143], v[96:99], v[112:115]
    v_exp_f32 v134, v134
    v_mfma_f32_16x16x32_bf16 v[128:131], a[136:139], v[92:95], v[128:131]
    ds_read_b128 a[160:163], v1 offset:40960
    v_cvt_pk_bf16_f32 v214, v132, v133
    v_mfma_f32_16x16x32_bf16 v[128:131], a[132:135], v[88:91], v[128:131]
    v_exp_f32 v135, v135
    v_mfma_f32_16x16x32_bf16 v[128:131], a[128:131], v[84:87], v[128:131]
    ds_read_b64_tr_b16 a[196:197], v9 offset:32768
    v_mfma_f32_16x16x32_bf16 a[32:35], a[208:211], v[180:183], 0
    v_exp_f32 v136, v136
    v_mfma_f32_16x16x32_bf16 a[32:35], a[212:215], v[184:187], a[32:35]
    ds_read_b64_tr_b16 a[198:199], v9 offset:36864
    v_cvt_pk_bf16_f32 v215, v134, v135
    v_mfma_f32_16x16x32_bf16 a[36:39], a[212:215], v[192:195], 0
    v_exp_f32 v137, v137
    v_mfma_f32_16x16x32_bf16 a[36:39], a[208:211], v[188:191], a[36:39]
    ds_read_b128 a[164:167], v2 offset:40960
    v_cvt_pk_bf16_f32 v222, v136, v137
    v_mfma_f32_16x16x32_bf16 a[40:43], a[208:211], v[196:199], 0
    s_add_u32 s28, s28, 16384
    s_mov_b32 m0, s32
    buffer_store_dwordx4 a[248:251], v26, s[76:79], 0 offen offset:2048 sc1
    v_exp_f32 v138, v138
    v_mfma_f32_16x16x32_bf16 a[40:43], a[212:215], v[200:203], a[40:43]
    buffer_load_dwordx4 v17, s[12:15], s29 offen offset:0 lds
    v_mfma_f32_16x16x32_bf16 a[44:47], a[212:215], v[208:211], 0
    v_exp_f32 v139, v139
    v_mfma_f32_16x16x32_bf16 a[44:47], a[208:211], v[204:207], a[44:47]
    s_waitcnt lgkmcnt(6)
    buffer_store_dwordx4 a[252:255], v26, s[76:79], 0 offen offset:3072 sc1
    v_mfma_f32_16x16x32_bf16 v[132:135], a[144:147], v[36:39], v[100:103]
    v_exp_f32 v140, v140
    v_mfma_f32_16x16x32_bf16 v[132:135], a[148:151], v[40:43], v[132:135]
    ds_read_b64_tr_b16 a[200:201], v10 offset:8192
    v_cvt_pk_bf16_f32 v223, v138, v139
    v_mfma_f32_16x16x32_bf16 v[132:135], a[152:155], v[44:47], v[132:135]
    v_exp_f32 v141, v141
    v_mfma_f32_16x16x32_bf16 v[132:135], a[156:159], v[48:51], v[132:135]
    ds_read_b64_tr_b16 a[202:203], v10 offset:12288
    v_mfma_f32_16x16x32_bf16 v[136:139], a[156:159], v[64:67], v[104:107]
    v_exp_f32 v142, v142
    v_mfma_f32_16x16x32_bf16 v[136:139], a[152:155], v[60:63], v[136:139]
    ds_read_b128 a[168:171], v3 offset:40960
    v_cvt_pk_bf16_f32 v230, v140, v141
    v_mfma_f32_16x16x32_bf16 v[136:139], a[148:151], v[56:59], v[136:139]
    v_exp_f32 v143, v143
    v_mfma_f32_16x16x32_bf16 v[136:139], a[144:147], v[52:55], v[136:139]
    ds_read_b64_tr_b16 a[204:205], v10 offset:32768
    v_mfma_f32_16x16x32_bf16 a[48:51], a[216:219], v[180:183], 0
    v_exp_f32 v144, v144
    v_mfma_f32_16x16x32_bf16 a[48:51], a[220:223], v[184:187], a[48:51]
    ds_read_b64_tr_b16 a[206:207], v10 offset:36864
    v_cvt_pk_bf16_f32 v231, v142, v143
    v_mfma_f32_16x16x32_bf16 a[52:55], a[220:223], v[192:195], 0
    v_exp_f32 v145, v145
    v_mfma_f32_16x16x32_bf16 a[52:55], a[216:219], v[188:191], a[52:55]
    ds_read_b128 a[172:175], v4 offset:40960
    v_mfma_f32_16x16x32_bf16 a[56:59], a[216:219], v[196:199], 0
    v_exp_f32 v146, v146
    v_mfma_f32_16x16x32_bf16 a[56:59], a[220:223], v[200:203], a[56:59]
    v_cvt_pk_bf16_f32 v238, v144, v145
    v_mfma_f32_16x16x32_bf16 a[60:63], a[220:223], v[208:211], 0
    v_exp_f32 v147, v147
    v_mfma_f32_16x16x32_bf16 a[60:63], a[216:219], v[204:207], a[60:63]
    buffer_load_dwordx4 v18, s[12:15], s29 offen offset:1024 lds
    v_smfmac_f32_16x16x64_bf16 a[228:231], v[244:247], v[188:195], v248
    s_waitcnt lgkmcnt(6)
    buffer_store_dwordx4 v[252:255], v26, s[76:79], s45 offen offset:0 sc1
    v_mfma_f32_16x16x32_bf16 v[140:143], a[144:147], v[68:71], v[108:111]
    s_cmp_eq_u32 s6, 240
    s_cbranch_scc1 L_rt_local
L_rt_back_local:
    v_exp_f32 v148, v148
    v_mfma_f32_16x16x32_bf16 v[140:143], a[148:151], v[72:75], v[140:143]
    ds_read_b64_tr_b16 a[208:209], v11 offset:8192
    v_cvt_pk_bf16_f32 v239, v146, v147
    v_mfma_f32_16x16x32_bf16 v[140:143], a[152:155], v[76:79], v[140:143]
    v_exp_f32 v149, v149
    v_mfma_f32_16x16x32_bf16 v[140:143], a[156:159], v[80:83], v[140:143]
    ds_read_b64_tr_b16 a[210:211], v11 offset:12288
    v_mfma_f32_16x16x32_bf16 v[144:147], a[156:159], v[96:99], v[112:115]
    v_exp_f32 v150, v150
    v_mfma_f32_16x16x32_bf16 v[144:147], a[152:155], v[92:95], v[144:147]
    ds_read_b128 a[176:179], v1 offset:45056
    v_cvt_pk_bf16_f32 v216, v148, v149
    v_mfma_f32_16x16x32_bf16 v[144:147], a[148:151], v[88:91], v[144:147]
    v_exp_f32 v151, v151
    v_mfma_f32_16x16x32_bf16 v[144:147], a[144:147], v[84:87], v[144:147]
    ds_read_b64_tr_b16 a[212:213], v11 offset:32768
    v_mfma_f32_16x16x32_bf16 a[64:67], a[192:195], v[180:183], 0
    v_exp_f32 v152, v152
    v_mfma_f32_16x16x32_bf16 a[64:67], a[196:199], v[184:187], a[64:67]
    ds_read_b64_tr_b16 a[214:215], v11 offset:36864
    v_cvt_pk_bf16_f32 v217, v150, v151
    v_mfma_f32_16x16x32_bf16 a[68:71], a[196:199], v[192:195], 0
    v_exp_f32 v153, v153
    v_mfma_f32_16x16x32_bf16 a[68:71], a[192:195], v[188:191], a[68:71]
    ds_read_b128 a[180:183], v2 offset:45056
    v_cvt_pk_bf16_f32 v224, v152, v153
    v_mfma_f32_16x16x32_bf16 a[72:75], a[192:195], v[196:199], 0
    v_exp_f32 v154, v154
    v_mfma_f32_16x16x32_bf16 a[72:75], a[196:199], v[200:203], a[72:75]
    buffer_load_dwordx4 v17, s[12:15], s29 offen offset:2048 lds
    v_mfma_f32_16x16x32_bf16 a[76:79], a[196:199], v[208:211], 0
    v_exp_f32 v155, v155
    v_mfma_f32_16x16x32_bf16 a[76:79], a[192:195], v[204:207], a[76:79]
    s_waitcnt lgkmcnt(6)
    v_mfma_f32_16x16x32_bf16 v[148:151], a[160:163], v[36:39], v[100:103]
    v_exp_f32 v156, v156
    v_mfma_f32_16x16x32_bf16 v[148:151], a[164:167], v[40:43], v[148:151]
    ds_read_b64_tr_b16 a[216:217], v12 offset:8192
    v_cvt_pk_bf16_f32 v225, v154, v155
    v_mfma_f32_16x16x32_bf16 v[148:151], a[168:171], v[44:47], v[148:151]
    v_exp_f32 v157, v157
    v_mfma_f32_16x16x32_bf16 v[148:151], a[172:175], v[48:51], v[148:151]
    ds_read_b64_tr_b16 a[218:219], v12 offset:12288
    v_mfma_f32_16x16x32_bf16 v[152:155], a[172:175], v[64:67], v[104:107]
    v_exp_f32 v158, v158
    v_mfma_f32_16x16x32_bf16 v[152:155], a[168:171], v[60:63], v[152:155]
    ds_read_b128 a[184:187], v3 offset:45056
    v_cvt_pk_bf16_f32 v232, v156, v157
    v_mfma_f32_16x16x32_bf16 v[152:155], a[164:167], v[56:59], v[152:155]
    v_exp_f32 v159, v159
    v_mfma_f32_16x16x32_bf16 v[152:155], a[160:163], v[52:55], v[152:155]
    ds_read_b64_tr_b16 a[220:221], v12 offset:32768
    v_mfma_f32_16x16x32_bf16 a[80:83], a[200:203], v[180:183], 0
    v_exp_f32 v160, v160
    v_mfma_f32_16x16x32_bf16 a[80:83], a[204:207], v[184:187], a[80:83]
    ds_read_b64_tr_b16 a[222:223], v12 offset:36864
    v_cvt_pk_bf16_f32 v233, v158, v159
    v_mfma_f32_16x16x32_bf16 a[84:87], a[204:207], v[192:195], 0
    v_exp_f32 v161, v161
    v_mfma_f32_16x16x32_bf16 a[84:87], a[200:203], v[188:191], a[84:87]
    ds_read_b128 a[188:191], v4 offset:45056
    v_mfma_f32_16x16x32_bf16 a[88:91], a[200:203], v[196:199], 0
    v_exp_f32 v162, v162
    v_mfma_f32_16x16x32_bf16 a[88:91], a[204:207], v[200:203], a[88:91]
    v_cvt_pk_bf16_f32 v240, v160, v161
    v_mfma_f32_16x16x32_bf16 a[92:95], a[204:207], v[208:211], 0
    v_exp_f32 v163, v163
    v_mfma_f32_16x16x32_bf16 a[92:95], a[200:203], v[204:207], a[92:95]
    buffer_load_dwordx4 v18, s[12:15], s29 offen offset:3072 lds
    v_smfmac_f32_16x16x64_bf16 a[232:235], v[244:247], v[196:203], v248
    s_waitcnt vmcnt(13) lgkmcnt(6)
    s_barrier
    s_add_u32 s29, s29, 16384
    v_mfma_f32_16x16x32_bf16 v[156:159], a[160:163], v[68:71], v[108:111]
    v_exp_f32 v164, v164
    v_mfma_f32_16x16x32_bf16 v[156:159], a[164:167], v[72:75], v[156:159]
    ds_read_b64_tr_b16 a[192:193], v5 offset:16384
    v_cvt_pk_bf16_f32 v241, v162, v163
    v_mfma_f32_16x16x32_bf16 v[156:159], a[168:171], v[76:79], v[156:159]
    v_exp_f32 v165, v165
    v_mfma_f32_16x16x32_bf16 v[156:159], a[172:175], v[80:83], v[156:159]
    ds_read_b64_tr_b16 a[194:195], v5 offset:20480
    v_mfma_f32_16x16x32_bf16 v[160:163], a[172:175], v[96:99], v[112:115]
    v_exp_f32 v166, v166
    v_mfma_f32_16x16x32_bf16 v[160:163], a[168:171], v[92:95], v[160:163]
    ds_read_b128 a[128:131], v1 offset:0
    v_cvt_pk_bf16_f32 v218, v164, v165
    v_mfma_f32_16x16x32_bf16 v[160:163], a[164:167], v[88:91], v[160:163]
    v_exp_f32 v167, v167
    v_mfma_f32_16x16x32_bf16 v[160:163], a[160:163], v[84:87], v[160:163]
    ds_read_b64_tr_b16 a[196:197], v5 offset:40960
    v_mfma_f32_16x16x32_bf16 a[96:99], a[208:211], v[180:183], 0
    v_exp_f32 v168, v168
    v_mfma_f32_16x16x32_bf16 a[96:99], a[212:215], v[184:187], a[96:99]
    ds_read_b64_tr_b16 a[198:199], v5 offset:45056
    v_cvt_pk_bf16_f32 v219, v166, v167
    v_mfma_f32_16x16x32_bf16 a[100:103], a[212:215], v[192:195], 0
    v_exp_f32 v169, v169
    v_mfma_f32_16x16x32_bf16 a[100:103], a[208:211], v[188:191], a[100:103]
    ds_read_b128 a[132:135], v2 offset:0
    v_cvt_pk_bf16_f32 v226, v168, v169
    v_mfma_f32_16x16x32_bf16 a[104:107], a[208:211], v[196:199], 0
    s_add_u32 m0, s34, 16384
    v_exp_f32 v170, v170
    v_mfma_f32_16x16x32_bf16 a[104:107], a[212:215], v[200:203], a[104:107]
    buffer_load_dwordx4 v13, s[8:11], s28 offen offset:0 lds
    v_mfma_f32_16x16x32_bf16 a[108:111], a[212:215], v[208:211], 0
    v_exp_f32 v171, v171
    v_mfma_f32_16x16x32_bf16 a[108:111], a[208:211], v[204:207], a[108:111]
    s_waitcnt lgkmcnt(6)
    v_mfma_f32_16x16x32_bf16 v[164:167], a[176:179], v[36:39], v[100:103]
    s_cmp_eq_u32 s6, 240
    s_cbranch_scc1 L_rt_merge
L_rt_back_merge:
    v_exp_f32 v172, v172
    v_mfma_f32_16x16x32_bf16 v[164:167], a[180:183], v[40:43], v[164:167]
    ds_read_b64_tr_b16 a[200:201], v6 offset:16384
    v_cvt_pk_bf16_f32 v227, v170, v171
    v_mfma_f32_16x16x32_bf16 v[164:167], a[184:187], v[44:47], v[164:167]
    v_exp_f32 v173, v173
    v_mfma_f32_16x16x32_bf16 v[164:167], a[188:191], v[48:51], v[164:167]
    ds_read_b64_tr_b16 a[202:203], v6 offset:20480
    v_mfma_f32_16x16x32_bf16 v[168:171], a[188:191], v[64:67], v[104:107]
    v_exp_f32 v174, v174
    v_mfma_f32_16x16x32_bf16 v[168:171], a[184:187], v[60:63], v[168:171]
    ds_read_b128 a[136:139], v3 offset:0
    v_cvt_pk_bf16_f32 v234, v172, v173
    v_mfma_f32_16x16x32_bf16 v[168:171], a[180:183], v[56:59], v[168:171]
    v_exp_f32 v175, v175
    v_mfma_f32_16x16x32_bf16 v[168:171], a[176:179], v[52:55], v[168:171]
    ds_read_b64_tr_b16 a[204:205], v6 offset:40960
    v_mfma_f32_16x16x32_bf16 a[112:115], a[216:219], v[180:183], 0
    v_exp_f32 v176, v176
    v_mfma_f32_16x16x32_bf16 a[112:115], a[220:223], v[184:187], a[112:115]
    ds_read_b64_tr_b16 a[206:207], v6 offset:45056
    v_cvt_pk_bf16_f32 v235, v174, v175
    v_mfma_f32_16x16x32_bf16 a[116:119], a[220:223], v[192:195], 0
    v_exp_f32 v177, v177
    v_mfma_f32_16x16x32_bf16 a[116:119], a[216:219], v[188:191], a[116:119]
    ds_read_b128 a[140:143], v4 offset:0
    v_mfma_f32_16x16x32_bf16 a[120:123], a[216:219], v[196:199], 0
    v_exp_f32 v178, v178
    v_mfma_f32_16x16x32_bf16 a[120:123], a[220:223], v[200:203], a[120:123]
    v_cvt_pk_bf16_f32 v242, v176, v177
    v_mfma_f32_16x16x32_bf16 a[124:127], a[220:223], v[208:211], 0
    v_exp_f32 v179, v179
    v_mfma_f32_16x16x32_bf16 a[124:127], a[216:219], v[204:207], a[124:127]
    buffer_load_dwordx4 v14, s[8:11], s28 offen offset:1024 lds
    v_smfmac_f32_16x16x64_bf16 a[236:239], v[244:247], v[204:211], v248
    s_waitcnt lgkmcnt(6)
    s_mov_b32 s35, 5
.p2align 6
L_attn_loop:
    v_mfma_f32_16x16x32_bf16 v[172:175], a[176:179], v[68:71], v[108:111]
    v_exp_f32 v116, v116
    v_mfma_f32_16x16x32_bf16 v[172:175], a[180:183], v[72:75], v[172:175]
    ds_read_b64_tr_b16 a[208:209], v7 offset:16384
    v_cvt_pk_bf16_f32 v243, v178, v179
    v_mfma_f32_16x16x32_bf16 v[172:175], a[184:187], v[76:79], v[172:175]
    v_exp_f32 v117, v117
    v_mfma_f32_16x16x32_bf16 v[172:175], a[188:191], v[80:83], v[172:175]
    ds_read_b64_tr_b16 a[210:211], v7 offset:20480
    v_mfma_f32_16x16x32_bf16 v[176:179], a[188:191], v[96:99], v[112:115]
    v_exp_f32 v118, v118
    v_mfma_f32_16x16x32_bf16 v[176:179], a[184:187], v[92:95], v[176:179]
    ds_read_b128 a[144:147], v1 offset:4096
    v_cvt_pk_bf16_f32 v180, v116, v117
    v_mfma_f32_16x16x32_bf16 v[176:179], a[180:183], v[88:91], v[176:179]
    v_exp_f32 v119, v119
    v_mfma_f32_16x16x32_bf16 v[176:179], a[176:179], v[84:87], v[176:179]
    ds_read_b64_tr_b16 a[212:213], v7 offset:40960
    v_mfma_f32_16x16x32_bf16 a[0:3], a[192:195], v[212:215], a[0:3]
    v_exp_f32 v120, v120
    v_mfma_f32_16x16x32_bf16 a[0:3], a[196:199], v[216:219], a[0:3]
    ds_read_b64_tr_b16 a[214:215], v7 offset:45056
    v_cvt_pk_bf16_f32 v181, v118, v119
    v_mfma_f32_16x16x32_bf16 a[4:7], a[196:199], v[224:227], a[4:7]
    v_exp_f32 v121, v121
    v_mfma_f32_16x16x32_bf16 a[4:7], a[192:195], v[220:223], a[4:7]
    ds_read_b128 a[148:151], v2 offset:4096
    v_cvt_pk_bf16_f32 v188, v120, v121
    v_mfma_f32_16x16x32_bf16 a[8:11], a[192:195], v[228:231], a[8:11]
    v_exp_f32 v122, v122
    v_mfma_f32_16x16x32_bf16 a[8:11], a[196:199], v[232:235], a[8:11]
    buffer_load_dwordx4 v15, s[8:11], s28 offen offset:2048 lds
    v_mfma_f32_16x16x32_bf16 a[12:15], a[196:199], v[240:243], a[12:15]
    v_exp_f32 v123, v123
    v_mfma_f32_16x16x32_bf16 a[12:15], a[192:195], v[236:239], a[12:15]
    s_waitcnt lgkmcnt(6)
    v_mfma_f32_16x16x32_bf16 v[116:119], a[128:131], v[36:39], v[100:103]
    v_exp_f32 v124, v124
    v_mfma_f32_16x16x32_bf16 v[116:119], a[132:135], v[40:43], v[116:119]
    ds_read_b64_tr_b16 a[216:217], v8 offset:16384
    v_cvt_pk_bf16_f32 v189, v122, v123
    v_mfma_f32_16x16x32_bf16 v[116:119], a[136:139], v[44:47], v[116:119]
    v_exp_f32 v125, v125
    v_mfma_f32_16x16x32_bf16 v[116:119], a[140:143], v[48:51], v[116:119]
    ds_read_b64_tr_b16 a[218:219], v8 offset:20480
    v_mfma_f32_16x16x32_bf16 v[120:123], a[140:143], v[64:67], v[104:107]
    v_exp_f32 v126, v126
    v_mfma_f32_16x16x32_bf16 v[120:123], a[136:139], v[60:63], v[120:123]
    ds_read_b128 a[152:155], v3 offset:4096
    v_cvt_pk_bf16_f32 v196, v124, v125
    v_mfma_f32_16x16x32_bf16 v[120:123], a[132:135], v[56:59], v[120:123]
    v_exp_f32 v127, v127
    v_mfma_f32_16x16x32_bf16 v[120:123], a[128:131], v[52:55], v[120:123]
    ds_read_b64_tr_b16 a[220:221], v8 offset:40960
    v_mfma_f32_16x16x32_bf16 a[16:19], a[200:203], v[212:215], a[16:19]
    v_exp_f32 v128, v128
    v_mfma_f32_16x16x32_bf16 a[16:19], a[204:207], v[216:219], a[16:19]
    ds_read_b64_tr_b16 a[222:223], v8 offset:45056
    v_cvt_pk_bf16_f32 v197, v126, v127
    v_mfma_f32_16x16x32_bf16 a[20:23], a[204:207], v[224:227], a[20:23]
    v_exp_f32 v129, v129
    v_mfma_f32_16x16x32_bf16 a[20:23], a[200:203], v[220:223], a[20:23]
    ds_read_b128 a[156:159], v4 offset:4096
    v_mfma_f32_16x16x32_bf16 a[24:27], a[200:203], v[228:231], a[24:27]
    v_exp_f32 v130, v130
    v_mfma_f32_16x16x32_bf16 a[24:27], a[204:207], v[232:235], a[24:27]
    v_cvt_pk_bf16_f32 v204, v128, v129
    v_mfma_f32_16x16x32_bf16 a[28:31], a[204:207], v[240:243], a[28:31]
    v_exp_f32 v131, v131
    v_mfma_f32_16x16x32_bf16 a[28:31], a[200:203], v[236:239], a[28:31]
    buffer_load_dwordx4 v16, s[8:11], s28 offen offset:3072 lds
    v_smfmac_f32_16x16x64_bf16 a[224:227], v[244:247], v[212:219], v248
    s_waitcnt lgkmcnt(6)
    v_mfma_f32_16x16x32_bf16 v[124:127], a[128:131], v[68:71], v[108:111]
    s_cmp_eq_u32 s36, 0
    s_cbranch_scc1 L_site0
L_site_back0:
    v_exp_f32 v132, v132
    v_mfma_f32_16x16x32_bf16 v[124:127], a[132:135], v[72:75], v[124:127]
    ds_read_b64_tr_b16 a[192:193], v9 offset:16384
    v_cvt_pk_bf16_f32 v205, v130, v131
    v_mfma_f32_16x16x32_bf16 v[124:127], a[136:139], v[76:79], v[124:127]
    v_exp_f32 v133, v133
    v_mfma_f32_16x16x32_bf16 v[124:127], a[140:143], v[80:83], v[124:127]
    ds_read_b64_tr_b16 a[194:195], v9 offset:20480
    v_mfma_f32_16x16x32_bf16 v[128:131], a[140:143], v[96:99], v[112:115]
    v_exp_f32 v134, v134
    v_mfma_f32_16x16x32_bf16 v[128:131], a[136:139], v[92:95], v[128:131]
    ds_read_b128 a[160:163], v1 offset:8192
    v_cvt_pk_bf16_f32 v182, v132, v133
    v_mfma_f32_16x16x32_bf16 v[128:131], a[132:135], v[88:91], v[128:131]
    v_exp_f32 v135, v135
    v_mfma_f32_16x16x32_bf16 v[128:131], a[128:131], v[84:87], v[128:131]
    ds_read_b64_tr_b16 a[196:197], v9 offset:40960
    v_mfma_f32_16x16x32_bf16 a[32:35], a[208:211], v[212:215], a[32:35]
    v_exp_f32 v136, v136
    v_mfma_f32_16x16x32_bf16 a[32:35], a[212:215], v[216:219], a[32:35]
    ds_read_b64_tr_b16 a[198:199], v9 offset:45056
    v_cvt_pk_bf16_f32 v183, v134, v135
    v_mfma_f32_16x16x32_bf16 a[36:39], a[212:215], v[224:227], a[36:39]
    v_exp_f32 v137, v137
    v_mfma_f32_16x16x32_bf16 a[36:39], a[208:211], v[220:223], a[36:39]
    ds_read_b128 a[164:167], v2 offset:8192
    v_cvt_pk_bf16_f32 v190, v136, v137
    v_mfma_f32_16x16x32_bf16 a[40:43], a[208:211], v[228:231], a[40:43]
    s_add_u32 s28, s28, 16384
    s_mov_b32 m0, s33
    v_exp_f32 v138, v138
    v_mfma_f32_16x16x32_bf16 a[40:43], a[212:215], v[232:235], a[40:43]
    buffer_load_dwordx4 v17, s[12:15], s29 offen offset:0 lds
    v_mfma_f32_16x16x32_bf16 a[44:47], a[212:215], v[240:243], a[44:47]
    v_exp_f32 v139, v139
    v_mfma_f32_16x16x32_bf16 a[44:47], a[208:211], v[236:239], a[44:47]
    s_waitcnt lgkmcnt(6)
    v_mfma_f32_16x16x32_bf16 v[132:135], a[144:147], v[36:39], v[100:103]
    v_exp_f32 v140, v140
    v_mfma_f32_16x16x32_bf16 v[132:135], a[148:151], v[40:43], v[132:135]
    ds_read_b64_tr_b16 a[200:201], v10 offset:16384
    v_cvt_pk_bf16_f32 v191, v138, v139
    v_mfma_f32_16x16x32_bf16 v[132:135], a[152:155], v[44:47], v[132:135]
    v_exp_f32 v141, v141
    v_mfma_f32_16x16x32_bf16 v[132:135], a[156:159], v[48:51], v[132:135]
    ds_read_b64_tr_b16 a[202:203], v10 offset:20480
    v_mfma_f32_16x16x32_bf16 v[136:139], a[156:159], v[64:67], v[104:107]
    v_exp_f32 v142, v142
    v_mfma_f32_16x16x32_bf16 v[136:139], a[152:155], v[60:63], v[136:139]
    ds_read_b128 a[168:171], v3 offset:8192
    v_cvt_pk_bf16_f32 v198, v140, v141
    v_mfma_f32_16x16x32_bf16 v[136:139], a[148:151], v[56:59], v[136:139]
    v_exp_f32 v143, v143
    v_mfma_f32_16x16x32_bf16 v[136:139], a[144:147], v[52:55], v[136:139]
    ds_read_b64_tr_b16 a[204:205], v10 offset:40960
    v_mfma_f32_16x16x32_bf16 a[48:51], a[216:219], v[212:215], a[48:51]
    v_exp_f32 v144, v144
    v_mfma_f32_16x16x32_bf16 a[48:51], a[220:223], v[216:219], a[48:51]
    ds_read_b64_tr_b16 a[206:207], v10 offset:45056
    v_cvt_pk_bf16_f32 v199, v142, v143
    v_mfma_f32_16x16x32_bf16 a[52:55], a[220:223], v[224:227], a[52:55]
    v_exp_f32 v145, v145
    v_mfma_f32_16x16x32_bf16 a[52:55], a[216:219], v[220:223], a[52:55]
    ds_read_b128 a[172:175], v4 offset:8192
    v_mfma_f32_16x16x32_bf16 a[56:59], a[216:219], v[228:231], a[56:59]
    v_exp_f32 v146, v146
    v_mfma_f32_16x16x32_bf16 a[56:59], a[220:223], v[232:235], a[56:59]
    v_cvt_pk_bf16_f32 v206, v144, v145
    v_mfma_f32_16x16x32_bf16 a[60:63], a[220:223], v[240:243], a[60:63]
    v_exp_f32 v147, v147
    v_mfma_f32_16x16x32_bf16 a[60:63], a[216:219], v[236:239], a[60:63]
    buffer_load_dwordx4 v18, s[12:15], s29 offen offset:1024 lds
    v_smfmac_f32_16x16x64_bf16 a[228:231], v[244:247], v[220:227], v248
    s_waitcnt lgkmcnt(6)
    v_mfma_f32_16x16x32_bf16 v[140:143], a[144:147], v[68:71], v[108:111]
    v_exp_f32 v148, v148
    v_mfma_f32_16x16x32_bf16 v[140:143], a[148:151], v[72:75], v[140:143]
    ds_read_b64_tr_b16 a[208:209], v11 offset:16384
    v_cvt_pk_bf16_f32 v207, v146, v147
    v_mfma_f32_16x16x32_bf16 v[140:143], a[152:155], v[76:79], v[140:143]
    v_exp_f32 v149, v149
    v_mfma_f32_16x16x32_bf16 v[140:143], a[156:159], v[80:83], v[140:143]
    ds_read_b64_tr_b16 a[210:211], v11 offset:20480
    v_mfma_f32_16x16x32_bf16 v[144:147], a[156:159], v[96:99], v[112:115]
    v_exp_f32 v150, v150
    v_mfma_f32_16x16x32_bf16 v[144:147], a[152:155], v[92:95], v[144:147]
    ds_read_b128 a[176:179], v1 offset:12288
    v_cvt_pk_bf16_f32 v184, v148, v149
    v_mfma_f32_16x16x32_bf16 v[144:147], a[148:151], v[88:91], v[144:147]
    v_exp_f32 v151, v151
    v_mfma_f32_16x16x32_bf16 v[144:147], a[144:147], v[84:87], v[144:147]
    ds_read_b64_tr_b16 a[212:213], v11 offset:40960
    v_mfma_f32_16x16x32_bf16 a[64:67], a[192:195], v[212:215], a[64:67]
    v_exp_f32 v152, v152
    v_mfma_f32_16x16x32_bf16 a[64:67], a[196:199], v[216:219], a[64:67]
    ds_read_b64_tr_b16 a[214:215], v11 offset:45056
    v_cvt_pk_bf16_f32 v185, v150, v151
    v_mfma_f32_16x16x32_bf16 a[68:71], a[196:199], v[224:227], a[68:71]
    v_exp_f32 v153, v153
    v_mfma_f32_16x16x32_bf16 a[68:71], a[192:195], v[220:223], a[68:71]
    ds_read_b128 a[180:183], v2 offset:12288
    v_cvt_pk_bf16_f32 v192, v152, v153
    v_mfma_f32_16x16x32_bf16 a[72:75], a[192:195], v[228:231], a[72:75]
    v_exp_f32 v154, v154
    v_mfma_f32_16x16x32_bf16 a[72:75], a[196:199], v[232:235], a[72:75]
    buffer_load_dwordx4 v17, s[12:15], s29 offen offset:2048 lds
    v_mfma_f32_16x16x32_bf16 a[76:79], a[196:199], v[240:243], a[76:79]
    v_exp_f32 v155, v155
    v_mfma_f32_16x16x32_bf16 a[76:79], a[192:195], v[236:239], a[76:79]
    s_waitcnt lgkmcnt(6)
    v_mfma_f32_16x16x32_bf16 v[148:151], a[160:163], v[36:39], v[100:103]
    v_exp_f32 v156, v156
    v_mfma_f32_16x16x32_bf16 v[148:151], a[164:167], v[40:43], v[148:151]
    ds_read_b64_tr_b16 a[216:217], v12 offset:16384
    v_cvt_pk_bf16_f32 v193, v154, v155
    v_mfma_f32_16x16x32_bf16 v[148:151], a[168:171], v[44:47], v[148:151]
    v_exp_f32 v157, v157
    v_mfma_f32_16x16x32_bf16 v[148:151], a[172:175], v[48:51], v[148:151]
    ds_read_b64_tr_b16 a[218:219], v12 offset:20480
    v_mfma_f32_16x16x32_bf16 v[152:155], a[172:175], v[64:67], v[104:107]
    v_exp_f32 v158, v158
    v_mfma_f32_16x16x32_bf16 v[152:155], a[168:171], v[60:63], v[152:155]
    ds_read_b128 a[184:187], v3 offset:12288
    v_cvt_pk_bf16_f32 v200, v156, v157
    v_mfma_f32_16x16x32_bf16 v[152:155], a[164:167], v[56:59], v[152:155]
    v_exp_f32 v159, v159
    v_mfma_f32_16x16x32_bf16 v[152:155], a[160:163], v[52:55], v[152:155]
    ds_read_b64_tr_b16 a[220:221], v12 offset:40960
    v_mfma_f32_16x16x32_bf16 a[80:83], a[200:203], v[212:215], a[80:83]
    v_exp_f32 v160, v160
    v_mfma_f32_16x16x32_bf16 a[80:83], a[204:207], v[216:219], a[80:83]
    ds_read_b64_tr_b16 a[222:223], v12 offset:45056
    v_cvt_pk_bf16_f32 v201, v158, v159
    v_mfma_f32_16x16x32_bf16 a[84:87], a[204:207], v[224:227], a[84:87]
    v_exp_f32 v161, v161
    v_mfma_f32_16x16x32_bf16 a[84:87], a[200:203], v[220:223], a[84:87]
    ds_read_b128 a[188:191], v4 offset:12288
    v_mfma_f32_16x16x32_bf16 a[88:91], a[200:203], v[228:231], a[88:91]
    v_exp_f32 v162, v162
    v_mfma_f32_16x16x32_bf16 a[88:91], a[204:207], v[232:235], a[88:91]
    v_cvt_pk_bf16_f32 v208, v160, v161
    v_mfma_f32_16x16x32_bf16 a[92:95], a[204:207], v[240:243], a[92:95]
    v_exp_f32 v163, v163
    v_mfma_f32_16x16x32_bf16 a[92:95], a[200:203], v[236:239], a[92:95]
    buffer_load_dwordx4 v18, s[12:15], s29 offen offset:3072 lds
    v_smfmac_f32_16x16x64_bf16 a[232:235], v[244:247], v[228:235], v248
    s_waitcnt vmcnt(8) lgkmcnt(6)
    s_barrier
    s_add_u32 s29, s29, 16384
    v_mfma_f32_16x16x32_bf16 v[156:159], a[160:163], v[68:71], v[108:111]
    v_exp_f32 v164, v164
    v_mfma_f32_16x16x32_bf16 v[156:159], a[164:167], v[72:75], v[156:159]
    ds_read_b64_tr_b16 a[192:193], v5 offset:57344
    v_cvt_pk_bf16_f32 v209, v162, v163
    v_mfma_f32_16x16x32_bf16 v[156:159], a[168:171], v[76:79], v[156:159]
    v_exp_f32 v165, v165
    v_mfma_f32_16x16x32_bf16 v[156:159], a[172:175], v[80:83], v[156:159]
    ds_read_b64_tr_b16 a[194:195], v5 offset:61440
    v_mfma_f32_16x16x32_bf16 v[160:163], a[172:175], v[96:99], v[112:115]
    v_exp_f32 v166, v166
    v_mfma_f32_16x16x32_bf16 v[160:163], a[168:171], v[92:95], v[160:163]
    ds_read_b128 a[128:131], v1 offset:49152
    v_cvt_pk_bf16_f32 v186, v164, v165
    v_mfma_f32_16x16x32_bf16 v[160:163], a[164:167], v[88:91], v[160:163]
    v_exp_f32 v167, v167
    v_mfma_f32_16x16x32_bf16 v[160:163], a[160:163], v[84:87], v[160:163]
    ds_read_b64_tr_b16 a[196:197], v5 offset:0
    v_mfma_f32_16x16x32_bf16 a[96:99], a[208:211], v[212:215], a[96:99]
    v_exp_f32 v168, v168
    v_mfma_f32_16x16x32_bf16 a[96:99], a[212:215], v[216:219], a[96:99]
    ds_read_b64_tr_b16 a[198:199], v5 offset:4096
    v_cvt_pk_bf16_f32 v187, v166, v167
    v_mfma_f32_16x16x32_bf16 a[100:103], a[212:215], v[224:227], a[100:103]
    v_exp_f32 v169, v169
    v_mfma_f32_16x16x32_bf16 a[100:103], a[208:211], v[220:223], a[100:103]
    ds_read_b128 a[132:135], v2 offset:49152
    v_cvt_pk_bf16_f32 v194, v168, v169
    v_mfma_f32_16x16x32_bf16 a[104:107], a[208:211], v[228:231], a[104:107]
    s_add_u32 m0, s34, 32768
    v_exp_f32 v170, v170
    v_mfma_f32_16x16x32_bf16 a[104:107], a[212:215], v[232:235], a[104:107]
    buffer_load_dwordx4 v13, s[8:11], s28 offen offset:0 lds
    v_mfma_f32_16x16x32_bf16 a[108:111], a[212:215], v[240:243], a[108:111]
    v_exp_f32 v171, v171
    v_mfma_f32_16x16x32_bf16 a[108:111], a[208:211], v[236:239], a[108:111]
    s_waitcnt lgkmcnt(6)
    v_mfma_f32_16x16x32_bf16 v[164:167], a[176:179], v[36:39], v[100:103]
    v_exp_f32 v172, v172
    v_mfma_f32_16x16x32_bf16 v[164:167], a[180:183], v[40:43], v[164:167]
    ds_read_b64_tr_b16 a[200:201], v6 offset:57344
    v_cvt_pk_bf16_f32 v195, v170, v171
    v_mfma_f32_16x16x32_bf16 v[164:167], a[184:187], v[44:47], v[164:167]
    v_exp_f32 v173, v173
    v_mfma_f32_16x16x32_bf16 v[164:167], a[188:191], v[48:51], v[164:167]
    ds_read_b64_tr_b16 a[202:203], v6 offset:61440
    v_mfma_f32_16x16x32_bf16 v[168:171], a[188:191], v[64:67], v[104:107]
    v_exp_f32 v174, v174
    v_mfma_f32_16x16x32_bf16 v[168:171], a[184:187], v[60:63], v[168:171]
    ds_read_b128 a[136:139], v3 offset:49152
    v_cvt_pk_bf16_f32 v202, v172, v173
    v_mfma_f32_16x16x32_bf16 v[168:171], a[180:183], v[56:59], v[168:171]
    v_exp_f32 v175, v175
    v_mfma_f32_16x16x32_bf16 v[168:171], a[176:179], v[52:55], v[168:171]
    ds_read_b64_tr_b16 a[204:205], v6 offset:0
    v_mfma_f32_16x16x32_bf16 a[112:115], a[216:219], v[212:215], a[112:115]
    v_exp_f32 v176, v176
    v_mfma_f32_16x16x32_bf16 a[112:115], a[220:223], v[216:219], a[112:115]
    ds_read_b64_tr_b16 a[206:207], v6 offset:4096
    v_cvt_pk_bf16_f32 v203, v174, v175
    v_mfma_f32_16x16x32_bf16 a[116:119], a[220:223], v[224:227], a[116:119]
    v_exp_f32 v177, v177
    v_mfma_f32_16x16x32_bf16 a[116:119], a[216:219], v[220:223], a[116:119]
    ds_read_b128 a[140:143], v4 offset:49152
    v_mfma_f32_16x16x32_bf16 a[120:123], a[216:219], v[228:231], a[120:123]
    v_exp_f32 v178, v178
    v_mfma_f32_16x16x32_bf16 a[120:123], a[220:223], v[232:235], a[120:123]
    v_cvt_pk_bf16_f32 v210, v176, v177
    v_mfma_f32_16x16x32_bf16 a[124:127], a[220:223], v[240:243], a[124:127]
    v_exp_f32 v179, v179
    v_mfma_f32_16x16x32_bf16 a[124:127], a[216:219], v[236:239], a[124:127]
    buffer_load_dwordx4 v14, s[8:11], s28 offen offset:1024 lds
    v_smfmac_f32_16x16x64_bf16 a[236:239], v[244:247], v[236:243], v248
    s_waitcnt lgkmcnt(6)
    v_mfma_f32_16x16x32_bf16 v[172:175], a[176:179], v[68:71], v[108:111]
    v_exp_f32 v116, v116
    v_mfma_f32_16x16x32_bf16 v[172:175], a[180:183], v[72:75], v[172:175]
    ds_read_b64_tr_b16 a[208:209], v7 offset:57344
    v_cvt_pk_bf16_f32 v211, v178, v179
    v_mfma_f32_16x16x32_bf16 v[172:175], a[184:187], v[76:79], v[172:175]
    v_exp_f32 v117, v117
    v_mfma_f32_16x16x32_bf16 v[172:175], a[188:191], v[80:83], v[172:175]
    ds_read_b64_tr_b16 a[210:211], v7 offset:61440
    v_mfma_f32_16x16x32_bf16 v[176:179], a[188:191], v[96:99], v[112:115]
    v_exp_f32 v118, v118
    v_mfma_f32_16x16x32_bf16 v[176:179], a[184:187], v[92:95], v[176:179]
    ds_read_b128 a[144:147], v1 offset:53248
    v_cvt_pk_bf16_f32 v212, v116, v117
    v_mfma_f32_16x16x32_bf16 v[176:179], a[180:183], v[88:91], v[176:179]
    v_exp_f32 v119, v119
    v_mfma_f32_16x16x32_bf16 v[176:179], a[176:179], v[84:87], v[176:179]
    ds_read_b64_tr_b16 a[212:213], v7 offset:0
    v_mfma_f32_16x16x32_bf16 a[0:3], a[192:195], v[180:183], a[0:3]
    v_exp_f32 v120, v120
    v_mfma_f32_16x16x32_bf16 a[0:3], a[196:199], v[184:187], a[0:3]
    ds_read_b64_tr_b16 a[214:215], v7 offset:4096
    v_cvt_pk_bf16_f32 v213, v118, v119
    v_mfma_f32_16x16x32_bf16 a[4:7], a[196:199], v[192:195], a[4:7]
    v_exp_f32 v121, v121
    v_mfma_f32_16x16x32_bf16 a[4:7], a[192:195], v[188:191], a[4:7]
    ds_read_b128 a[148:151], v2 offset:53248
    v_cvt_pk_bf16_f32 v220, v120, v121
    v_mfma_f32_16x16x32_bf16 a[8:11], a[192:195], v[196:199], a[8:11]
    v_exp_f32 v122, v122
    v_mfma_f32_16x16x32_bf16 a[8:11], a[196:199], v[200:203], a[8:11]
    buffer_load_dwordx4 v15, s[8:11], s28 offen offset:2048 lds
    v_mfma_f32_16x16x32_bf16 a[12:15], a[196:199], v[208:211], a[12:15]
    v_exp_f32 v123, v123
    v_mfma_f32_16x16x32_bf16 a[12:15], a[192:195], v[204:207], a[12:15]
    s_waitcnt lgkmcnt(6)
    v_mfma_f32_16x16x32_bf16 v[116:119], a[128:131], v[36:39], v[100:103]
    v_exp_f32 v124, v124
    v_mfma_f32_16x16x32_bf16 v[116:119], a[132:135], v[40:43], v[116:119]
    ds_read_b64_tr_b16 a[216:217], v8 offset:57344
    v_cvt_pk_bf16_f32 v221, v122, v123
    v_mfma_f32_16x16x32_bf16 v[116:119], a[136:139], v[44:47], v[116:119]
    v_exp_f32 v125, v125
    v_mfma_f32_16x16x32_bf16 v[116:119], a[140:143], v[48:51], v[116:119]
    ds_read_b64_tr_b16 a[218:219], v8 offset:61440
    v_mfma_f32_16x16x32_bf16 v[120:123], a[140:143], v[64:67], v[104:107]
    v_exp_f32 v126, v126
    v_mfma_f32_16x16x32_bf16 v[120:123], a[136:139], v[60:63], v[120:123]
    ds_read_b128 a[152:155], v3 offset:53248
    v_cvt_pk_bf16_f32 v228, v124, v125
    v_mfma_f32_16x16x32_bf16 v[120:123], a[132:135], v[56:59], v[120:123]
    v_exp_f32 v127, v127
    v_mfma_f32_16x16x32_bf16 v[120:123], a[128:131], v[52:55], v[120:123]
    ds_read_b64_tr_b16 a[220:221], v8 offset:0
    v_mfma_f32_16x16x32_bf16 a[16:19], a[200:203], v[180:183], a[16:19]
    v_exp_f32 v128, v128
    v_mfma_f32_16x16x32_bf16 a[16:19], a[204:207], v[184:187], a[16:19]
    ds_read_b64_tr_b16 a[222:223], v8 offset:4096
    v_cvt_pk_bf16_f32 v229, v126, v127
    v_mfma_f32_16x16x32_bf16 a[20:23], a[204:207], v[192:195], a[20:23]
    v_exp_f32 v129, v129
    v_mfma_f32_16x16x32_bf16 a[20:23], a[200:203], v[188:191], a[20:23]
    ds_read_b128 a[156:159], v4 offset:53248
    v_mfma_f32_16x16x32_bf16 a[24:27], a[200:203], v[196:199], a[24:27]
    v_exp_f32 v130, v130
    v_mfma_f32_16x16x32_bf16 a[24:27], a[204:207], v[200:203], a[24:27]
    v_cvt_pk_bf16_f32 v236, v128, v129
    v_mfma_f32_16x16x32_bf16 a[28:31], a[204:207], v[208:211], a[28:31]
    v_exp_f32 v131, v131
    v_mfma_f32_16x16x32_bf16 a[28:31], a[200:203], v[204:207], a[28:31]
    buffer_load_dwordx4 v16, s[8:11], s28 offen offset:3072 lds
    v_smfmac_f32_16x16x64_bf16 a[224:227], v[244:247], v[180:187], v248
    s_waitcnt lgkmcnt(6)
    v_mfma_f32_16x16x32_bf16 v[124:127], a[128:131], v[68:71], v[108:111]
    s_cmp_eq_u32 s36, 1
    s_cbranch_scc1 L_site1
L_site_back1:
    v_exp_f32 v132, v132
    v_mfma_f32_16x16x32_bf16 v[124:127], a[132:135], v[72:75], v[124:127]
    ds_read_b64_tr_b16 a[192:193], v9 offset:57344
    v_cvt_pk_bf16_f32 v237, v130, v131
    v_mfma_f32_16x16x32_bf16 v[124:127], a[136:139], v[76:79], v[124:127]
    v_exp_f32 v133, v133
    v_mfma_f32_16x16x32_bf16 v[124:127], a[140:143], v[80:83], v[124:127]
    ds_read_b64_tr_b16 a[194:195], v9 offset:61440
    v_mfma_f32_16x16x32_bf16 v[128:131], a[140:143], v[96:99], v[112:115]
    v_exp_f32 v134, v134
    v_mfma_f32_16x16x32_bf16 v[128:131], a[136:139], v[92:95], v[128:131]
    ds_read_b128 a[160:163], v1 offset:57344
    v_cvt_pk_bf16_f32 v214, v132, v133
    v_mfma_f32_16x16x32_bf16 v[128:131], a[132:135], v[88:91], v[128:131]
    v_exp_f32 v135, v135
    v_mfma_f32_16x16x32_bf16 v[128:131], a[128:131], v[84:87], v[128:131]
    ds_read_b64_tr_b16 a[196:197], v9 offset:0
    v_mfma_f32_16x16x32_bf16 a[32:35], a[208:211], v[180:183], a[32:35]
    v_exp_f32 v136, v136
    v_mfma_f32_16x16x32_bf16 a[32:35], a[212:215], v[184:187], a[32:35]
    ds_read_b64_tr_b16 a[198:199], v9 offset:4096
    v_cvt_pk_bf16_f32 v215, v134, v135
    v_mfma_f32_16x16x32_bf16 a[36:39], a[212:215], v[192:195], a[36:39]
    v_exp_f32 v137, v137
    v_mfma_f32_16x16x32_bf16 a[36:39], a[208:211], v[188:191], a[36:39]
    ds_read_b128 a[164:167], v2 offset:57344
    v_cvt_pk_bf16_f32 v222, v136, v137
    v_mfma_f32_16x16x32_bf16 a[40:43], a[208:211], v[196:199], a[40:43]
    s_add_u32 s28, s28, 16384
    s_mov_b32 m0, s30
    v_exp_f32 v138, v138
    v_mfma_f32_16x16x32_bf16 a[40:43], a[212:215], v[200:203], a[40:43]
    buffer_load_dwordx4 v17, s[12:15], s29 offen offset:0 lds
    v_mfma_f32_16x16x32_bf16 a[44:47], a[212:215], v[208:211], a[44:47]
    v_exp_f32 v139, v139
    v_mfma_f32_16x16x32_bf16 a[44:47], a[208:211], v[204:207], a[44:47]
    s_waitcnt lgkmcnt(6)
    v_mfma_f32_16x16x32_bf16 v[132:135], a[144:147], v[36:39], v[100:103]
    v_exp_f32 v140, v140
    v_mfma_f32_16x16x32_bf16 v[132:135], a[148:151], v[40:43], v[132:135]
    ds_read_b64_tr_b16 a[200:201], v10 offset:57344
    v_cvt_pk_bf16_f32 v223, v138, v139
    v_mfma_f32_16x16x32_bf16 v[132:135], a[152:155], v[44:47], v[132:135]
    v_exp_f32 v141, v141
    v_mfma_f32_16x16x32_bf16 v[132:135], a[156:159], v[48:51], v[132:135]
    ds_read_b64_tr_b16 a[202:203], v10 offset:61440
    v_mfma_f32_16x16x32_bf16 v[136:139], a[156:159], v[64:67], v[104:107]
    v_exp_f32 v142, v142
    v_mfma_f32_16x16x32_bf16 v[136:139], a[152:155], v[60:63], v[136:139]
    ds_read_b128 a[168:171], v3 offset:57344
    v_cvt_pk_bf16_f32 v230, v140, v141
    v_mfma_f32_16x16x32_bf16 v[136:139], a[148:151], v[56:59], v[136:139]
    v_exp_f32 v143, v143
    v_mfma_f32_16x16x32_bf16 v[136:139], a[144:147], v[52:55], v[136:139]
    ds_read_b64_tr_b16 a[204:205], v10 offset:0
    v_mfma_f32_16x16x32_bf16 a[48:51], a[216:219], v[180:183], a[48:51]
    v_exp_f32 v144, v144
    v_mfma_f32_16x16x32_bf16 a[48:51], a[220:223], v[184:187], a[48:51]
    ds_read_b64_tr_b16 a[206:207], v10 offset:4096
    v_cvt_pk_bf16_f32 v231, v142, v143
    v_mfma_f32_16x16x32_bf16 a[52:55], a[220:223], v[192:195], a[52:55]
    v_exp_f32 v145, v145
    v_mfma_f32_16x16x32_bf16 a[52:55], a[216:219], v[188:191], a[52:55]
    ds_read_b128 a[172:175], v4 offset:57344
    v_mfma_f32_16x16x32_bf16 a[56:59], a[216:219], v[196:199], a[56:59]
    v_exp_f32 v146, v146
    v_mfma_f32_16x16x32_bf16 a[56:59], a[220:223], v[200:203], a[56:59]
    v_cvt_pk_bf16_f32 v238, v144, v145
    v_mfma_f32_16x16x32_bf16 a[60:63], a[220:223], v[208:211], a[60:63]
    v_exp_f32 v147, v147
    v_mfma_f32_16x16x32_bf16 a[60:63], a[216:219], v[204:207], a[60:63]
    buffer_load_dwordx4 v18, s[12:15], s29 offen offset:1024 lds
    v_smfmac_f32_16x16x64_bf16 a[228:231], v[244:247], v[188:195], v248
    s_waitcnt lgkmcnt(6)
    v_mfma_f32_16x16x32_bf16 v[140:143], a[144:147], v[68:71], v[108:111]
    v_exp_f32 v148, v148
    v_mfma_f32_16x16x32_bf16 v[140:143], a[148:151], v[72:75], v[140:143]
    ds_read_b64_tr_b16 a[208:209], v11 offset:57344
    v_cvt_pk_bf16_f32 v239, v146, v147
    v_mfma_f32_16x16x32_bf16 v[140:143], a[152:155], v[76:79], v[140:143]
    v_exp_f32 v149, v149
    v_mfma_f32_16x16x32_bf16 v[140:143], a[156:159], v[80:83], v[140:143]
    ds_read_b64_tr_b16 a[210:211], v11 offset:61440
    v_mfma_f32_16x16x32_bf16 v[144:147], a[156:159], v[96:99], v[112:115]
    v_exp_f32 v150, v150
    v_mfma_f32_16x16x32_bf16 v[144:147], a[152:155], v[92:95], v[144:147]
    ds_read_b128 a[176:179], v1 offset:61440
    v_cvt_pk_bf16_f32 v216, v148, v149
    v_mfma_f32_16x16x32_bf16 v[144:147], a[148:151], v[88:91], v[144:147]
    v_exp_f32 v151, v151
    v_mfma_f32_16x16x32_bf16 v[144:147], a[144:147], v[84:87], v[144:147]
    ds_read_b64_tr_b16 a[212:213], v11 offset:0
    v_mfma_f32_16x16x32_bf16 a[64:67], a[192:195], v[180:183], a[64:67]
    v_exp_f32 v152, v152
    v_mfma_f32_16x16x32_bf16 a[64:67], a[196:199], v[184:187], a[64:67]
    ds_read_b64_tr_b16 a[214:215], v11 offset:4096
    v_cvt_pk_bf16_f32 v217, v150, v151
    v_mfma_f32_16x16x32_bf16 a[68:71], a[196:199], v[192:195], a[68:71]
    v_exp_f32 v153, v153
    v_mfma_f32_16x16x32_bf16 a[68:71], a[192:195], v[188:191], a[68:71]
    ds_read_b128 a[180:183], v2 offset:61440
    v_cvt_pk_bf16_f32 v224, v152, v153
    v_mfma_f32_16x16x32_bf16 a[72:75], a[192:195], v[196:199], a[72:75]
    v_exp_f32 v154, v154
    v_mfma_f32_16x16x32_bf16 a[72:75], a[196:199], v[200:203], a[72:75]
    buffer_load_dwordx4 v17, s[12:15], s29 offen offset:2048 lds
    v_mfma_f32_16x16x32_bf16 a[76:79], a[196:199], v[208:211], a[76:79]
    v_exp_f32 v155, v155
    v_mfma_f32_16x16x32_bf16 a[76:79], a[192:195], v[204:207], a[76:79]
    s_waitcnt lgkmcnt(6)
    v_mfma_f32_16x16x32_bf16 v[148:151], a[160:163], v[36:39], v[100:103]
    v_exp_f32 v156, v156
    v_mfma_f32_16x16x32_bf16 v[148:151], a[164:167], v[40:43], v[148:151]
    ds_read_b64_tr_b16 a[216:217], v12 offset:57344
    v_cvt_pk_bf16_f32 v225, v154, v155
    v_mfma_f32_16x16x32_bf16 v[148:151], a[168:171], v[44:47], v[148:151]
    v_exp_f32 v157, v157
    v_mfma_f32_16x16x32_bf16 v[148:151], a[172:175], v[48:51], v[148:151]
    ds_read_b64_tr_b16 a[218:219], v12 offset:61440
    v_mfma_f32_16x16x32_bf16 v[152:155], a[172:175], v[64:67], v[104:107]
    v_exp_f32 v158, v158
    v_mfma_f32_16x16x32_bf16 v[152:155], a[168:171], v[60:63], v[152:155]
    ds_read_b128 a[184:187], v3 offset:61440
    v_cvt_pk_bf16_f32 v232, v156, v157
    v_mfma_f32_16x16x32_bf16 v[152:155], a[164:167], v[56:59], v[152:155]
    v_exp_f32 v159, v159
    v_mfma_f32_16x16x32_bf16 v[152:155], a[160:163], v[52:55], v[152:155]
    ds_read_b64_tr_b16 a[220:221], v12 offset:0
    v_mfma_f32_16x16x32_bf16 a[80:83], a[200:203], v[180:183], a[80:83]
    v_exp_f32 v160, v160
    v_mfma_f32_16x16x32_bf16 a[80:83], a[204:207], v[184:187], a[80:83]
    ds_read_b64_tr_b16 a[222:223], v12 offset:4096
    v_cvt_pk_bf16_f32 v233, v158, v159
    v_mfma_f32_16x16x32_bf16 a[84:87], a[204:207], v[192:195], a[84:87]
    v_exp_f32 v161, v161
    v_mfma_f32_16x16x32_bf16 a[84:87], a[200:203], v[188:191], a[84:87]
    ds_read_b128 a[188:191], v4 offset:61440
    v_mfma_f32_16x16x32_bf16 a[88:91], a[200:203], v[196:199], a[88:91]
    v_exp_f32 v162, v162
    v_mfma_f32_16x16x32_bf16 a[88:91], a[204:207], v[200:203], a[88:91]
    v_cvt_pk_bf16_f32 v240, v160, v161
    v_mfma_f32_16x16x32_bf16 a[92:95], a[204:207], v[208:211], a[92:95]
    v_exp_f32 v163, v163
    v_mfma_f32_16x16x32_bf16 a[92:95], a[200:203], v[204:207], a[92:95]
    buffer_load_dwordx4 v18, s[12:15], s29 offen offset:3072 lds
    v_smfmac_f32_16x16x64_bf16 a[232:235], v[244:247], v[196:203], v248
    s_waitcnt vmcnt(8) lgkmcnt(6)
    s_barrier
    s_add_u32 s29, s29, 16384
    v_mfma_f32_16x16x32_bf16 v[156:159], a[160:163], v[68:71], v[108:111]
    v_exp_f32 v164, v164
    v_mfma_f32_16x16x32_bf16 v[156:159], a[164:167], v[72:75], v[156:159]
    ds_read_b64_tr_b16 a[192:193], v5 offset:24576
    v_cvt_pk_bf16_f32 v241, v162, v163
    v_mfma_f32_16x16x32_bf16 v[156:159], a[168:171], v[76:79], v[156:159]
    v_exp_f32 v165, v165
    v_mfma_f32_16x16x32_bf16 v[156:159], a[172:175], v[80:83], v[156:159]
    ds_read_b64_tr_b16 a[194:195], v5 offset:28672
    v_mfma_f32_16x16x32_bf16 v[160:163], a[172:175], v[96:99], v[112:115]
    v_exp_f32 v166, v166
    v_mfma_f32_16x16x32_bf16 v[160:163], a[168:171], v[92:95], v[160:163]
    ds_read_b128 a[128:131], v1 offset:16384
    v_cvt_pk_bf16_f32 v218, v164, v165
    v_mfma_f32_16x16x32_bf16 v[160:163], a[164:167], v[88:91], v[160:163]
    v_exp_f32 v167, v167
    v_mfma_f32_16x16x32_bf16 v[160:163], a[160:163], v[84:87], v[160:163]
    ds_read_b64_tr_b16 a[196:197], v5 offset:49152
    v_mfma_f32_16x16x32_bf16 a[96:99], a[208:211], v[180:183], a[96:99]
    v_exp_f32 v168, v168
    v_mfma_f32_16x16x32_bf16 a[96:99], a[212:215], v[184:187], a[96:99]
    ds_read_b64_tr_b16 a[198:199], v5 offset:53248
    v_cvt_pk_bf16_f32 v219, v166, v167
    v_mfma_f32_16x16x32_bf16 a[100:103], a[212:215], v[192:195], a[100:103]
    v_exp_f32 v169, v169
    v_mfma_f32_16x16x32_bf16 a[100:103], a[208:211], v[188:191], a[100:103]
    ds_read_b128 a[132:135], v2 offset:16384
    v_cvt_pk_bf16_f32 v226, v168, v169
    v_mfma_f32_16x16x32_bf16 a[104:107], a[208:211], v[196:199], a[104:107]
    s_add_u32 m0, s34, 0
    v_exp_f32 v170, v170
    v_mfma_f32_16x16x32_bf16 a[104:107], a[212:215], v[200:203], a[104:107]
    buffer_load_dwordx4 v13, s[8:11], s28 offen offset:0 lds
    v_mfma_f32_16x16x32_bf16 a[108:111], a[212:215], v[208:211], a[108:111]
    v_exp_f32 v171, v171
    v_mfma_f32_16x16x32_bf16 a[108:111], a[208:211], v[204:207], a[108:111]
    s_waitcnt lgkmcnt(6)
    v_mfma_f32_16x16x32_bf16 v[164:167], a[176:179], v[36:39], v[100:103]
    s_cmp_eq_u32 s59, s35
    s_cbranch_scc1 L_once_pack
L_once_back_pack:
    v_exp_f32 v172, v172
    v_mfma_f32_16x16x32_bf16 v[164:167], a[180:183], v[40:43], v[164:167]
    ds_read_b64_tr_b16 a[200:201], v6 offset:24576
    v_cvt_pk_bf16_f32 v227, v170, v171
    v_mfma_f32_16x16x32_bf16 v[164:167], a[184:187], v[44:47], v[164:167]
    v_exp_f32 v173, v173
    v_mfma_f32_16x16x32_bf16 v[164:167], a[188:191], v[48:51], v[164:167]
    ds_read_b64_tr_b16 a[202:203], v6 offset:28672
    v_mfma_f32_16x16x32_bf16 v[168:171], a[188:191], v[64:67], v[104:107]
    v_exp_f32 v174, v174
    v_mfma_f32_16x16x32_bf16 v[168:171], a[184:187], v[60:63], v[168:171]
    ds_read_b128 a[136:139], v3 offset:16384
    v_cvt_pk_bf16_f32 v234, v172, v173
    v_mfma_f32_16x16x32_bf16 v[168:171], a[180:183], v[56:59], v[168:171]
    v_exp_f32 v175, v175
    v_mfma_f32_16x16x32_bf16 v[168:171], a[176:179], v[52:55], v[168:171]
    ds_read_b64_tr_b16 a[204:205], v6 offset:49152
    v_mfma_f32_16x16x32_bf16 a[112:115], a[216:219], v[180:183], a[112:115]
    v_exp_f32 v176, v176
    v_mfma_f32_16x16x32_bf16 a[112:115], a[220:223], v[184:187], a[112:115]
    ds_read_b64_tr_b16 a[206:207], v6 offset:53248
    v_cvt_pk_bf16_f32 v235, v174, v175
    v_mfma_f32_16x16x32_bf16 a[116:119], a[220:223], v[192:195], a[116:119]
    v_exp_f32 v177, v177
    v_mfma_f32_16x16x32_bf16 a[116:119], a[216:219], v[188:191], a[116:119]
    ds_read_b128 a[140:143], v4 offset:16384
    v_mfma_f32_16x16x32_bf16 a[120:123], a[216:219], v[196:199], a[120:123]
    v_exp_f32 v178, v178
    v_mfma_f32_16x16x32_bf16 a[120:123], a[220:223], v[200:203], a[120:123]
    v_cvt_pk_bf16_f32 v242, v176, v177
    v_mfma_f32_16x16x32_bf16 a[124:127], a[220:223], v[208:211], a[124:127]
    v_exp_f32 v179, v179
    v_mfma_f32_16x16x32_bf16 a[124:127], a[216:219], v[204:207], a[124:127]
    buffer_load_dwordx4 v14, s[8:11], s28 offen offset:1024 lds
    v_smfmac_f32_16x16x64_bf16 a[236:239], v[244:247], v[204:211], v248
    s_waitcnt lgkmcnt(6)
    v_mfma_f32_16x16x32_bf16 v[172:175], a[176:179], v[68:71], v[108:111]
    v_exp_f32 v116, v116
    v_mfma_f32_16x16x32_bf16 v[172:175], a[180:183], v[72:75], v[172:175]
    ds_read_b64_tr_b16 a[208:209], v7 offset:24576
    v_cvt_pk_bf16_f32 v243, v178, v179
    v_mfma_f32_16x16x32_bf16 v[172:175], a[184:187], v[76:79], v[172:175]
    v_exp_f32 v117, v117
    v_mfma_f32_16x16x32_bf16 v[172:175], a[188:191], v[80:83], v[172:175]
    ds_read_b64_tr_b16 a[210:211], v7 offset:28672
    v_mfma_f32_16x16x32_bf16 v[176:179], a[188:191], v[96:99], v[112:115]
    v_exp_f32 v118, v118
    v_mfma_f32_16x16x32_bf16 v[176:179], a[184:187], v[92:95], v[176:179]
    ds_read_b128 a[144:147], v1 offset:20480
    v_cvt_pk_bf16_f32 v180, v116, v117
    v_mfma_f32_16x16x32_bf16 v[176:179], a[180:183], v[88:91], v[176:179]
    v_exp_f32 v119, v119
    v_mfma_f32_16x16x32_bf16 v[176:179], a[176:179], v[84:87], v[176:179]
    ds_read_b64_tr_b16 a[212:213], v7 offset:49152
    v_mfma_f32_16x16x32_bf16 a[0:3], a[192:195], v[212:215], a[0:3]
    v_exp_f32 v120, v120
    v_mfma_f32_16x16x32_bf16 a[0:3], a[196:199], v[216:219], a[0:3]
    ds_read_b64_tr_b16 a[214:215], v7 offset:53248
    v_cvt_pk_bf16_f32 v181, v118, v119
    v_mfma_f32_16x16x32_bf16 a[4:7], a[196:199], v[224:227], a[4:7]
    v_exp_f32 v121, v121
    v_mfma_f32_16x16x32_bf16 a[4:7], a[192:195], v[220:223], a[4:7]
    ds_read_b128 a[148:151], v2 offset:20480
    v_cvt_pk_bf16_f32 v188, v120, v121
    v_mfma_f32_16x16x32_bf16 a[8:11], a[192:195], v[228:231], a[8:11]
    v_exp_f32 v122, v122
    v_mfma_f32_16x16x32_bf16 a[8:11], a[196:199], v[232:235], a[8:11]
    buffer_load_dwordx4 v15, s[8:11], s28 offen offset:2048 lds
    v_mfma_f32_16x16x32_bf16 a[12:15], a[196:199], v[240:243], a[12:15]
    v_exp_f32 v123, v123
    v_mfma_f32_16x16x32_bf16 a[12:15], a[192:195], v[236:239], a[12:15]
    s_waitcnt lgkmcnt(6)
    v_mfma_f32_16x16x32_bf16 v[116:119], a[128:131], v[36:39], v[100:103]
    v_exp_f32 v124, v124
    v_mfma_f32_16x16x32_bf16 v[116:119], a[132:135], v[40:43], v[116:119]
    ds_read_b64_tr_b16 a[216:217], v8 offset:24576
    v_cvt_pk_bf16_f32 v189, v122, v123
    v_mfma_f32_16x16x32_bf16 v[116:119], a[136:139], v[44:47], v[116:119]
    v_exp_f32 v125, v125
    v_mfma_f32_16x16x32_bf16 v[116:119], a[140:143], v[48:51], v[116:119]
    ds_read_b64_tr_b16 a[218:219], v8 offset:28672
    v_mfma_f32_16x16x32_bf16 v[120:123], a[140:143], v[64:67], v[104:107]
    v_exp_f32 v126, v126
    v_mfma_f32_16x16x32_bf16 v[120:123], a[136:139], v[60:63], v[120:123]
    ds_read_b128 a[152:155], v3 offset:20480
    v_cvt_pk_bf16_f32 v196, v124, v125
    v_mfma_f32_16x16x32_bf16 v[120:123], a[132:135], v[56:59], v[120:123]
    v_exp_f32 v127, v127
    v_mfma_f32_16x16x32_bf16 v[120:123], a[128:131], v[52:55], v[120:123]
    ds_read_b64_tr_b16 a[220:221], v8 offset:49152
    v_mfma_f32_16x16x32_bf16 a[16:19], a[200:203], v[212:215], a[16:19]
    v_exp_f32 v128, v128
    v_mfma_f32_16x16x32_bf16 a[16:19], a[204:207], v[216:219], a[16:19]
    ds_read_b64_tr_b16 a[222:223], v8 offset:53248
    v_cvt_pk_bf16_f32 v197, v126, v127
    v_mfma_f32_16x16x32_bf16 a[20:23], a[204:207], v[224:227], a[20:23]
    v_exp_f32 v129, v129
    v_mfma_f32_16x16x32_bf16 a[20:23], a[200:203], v[220:223], a[20:23]
    ds_read_b128 a[156:159], v4 offset:20480
    v_mfma_f32_16x16x32_bf16 a[24:27], a[200:203], v[228:231], a[24:27]
    v_exp_f32 v130, v130
    v_mfma_f32_16x16x32_bf16 a[24:27], a[204:207], v[232:235], a[24:27]
    v_cvt_pk_bf16_f32 v204, v128, v129
    v_mfma_f32_16x16x32_bf16 a[28:31], a[204:207], v[240:243], a[28:31]
    v_exp_f32 v131, v131
    v_mfma_f32_16x16x32_bf16 a[28:31], a[200:203], v[236:239], a[28:31]
    buffer_load_dwordx4 v16, s[8:11], s28 offen offset:3072 lds
    v_smfmac_f32_16x16x64_bf16 a[224:227], v[244:247], v[212:219], v248
    s_waitcnt lgkmcnt(6)
    v_mfma_f32_16x16x32_bf16 v[124:127], a[128:131], v[68:71], v[108:111]
    s_cmp_eq_u32 s36, 2
    s_cbranch_scc1 L_site2
L_site_back2:
    v_exp_f32 v132, v132
    v_mfma_f32_16x16x32_bf16 v[124:127], a[132:135], v[72:75], v[124:127]
    ds_read_b64_tr_b16 a[192:193], v9 offset:24576
    v_cvt_pk_bf16_f32 v205, v130, v131
    v_mfma_f32_16x16x32_bf16 v[124:127], a[136:139], v[76:79], v[124:127]
    v_exp_f32 v133, v133
    v_mfma_f32_16x16x32_bf16 v[124:127], a[140:143], v[80:83], v[124:127]
    ds_read_b64_tr_b16 a[194:195], v9 offset:28672
    v_mfma_f32_16x16x32_bf16 v[128:131], a[140:143], v[96:99], v[112:115]
    v_exp_f32 v134, v134
    v_mfma_f32_16x16x32_bf16 v[128:131], a[136:139], v[92:95], v[128:131]
    ds_read_b128 a[160:163], v1 offset:24576
    v_cvt_pk_bf16_f32 v182, v132, v133
    v_mfma_f32_16x16x32_bf16 v[128:131], a[132:135], v[88:91], v[128:131]
    v_exp_f32 v135, v135
    v_mfma_f32_16x16x32_bf16 v[128:131], a[128:131], v[84:87], v[128:131]
    ds_read_b64_tr_b16 a[196:197], v9 offset:49152
    v_mfma_f32_16x16x32_bf16 a[32:35], a[208:211], v[212:215], a[32:35]
    v_exp_f32 v136, v136
    v_mfma_f32_16x16x32_bf16 a[32:35], a[212:215], v[216:219], a[32:35]
    ds_read_b64_tr_b16 a[198:199], v9 offset:53248
    v_cvt_pk_bf16_f32 v183, v134, v135
    v_mfma_f32_16x16x32_bf16 a[36:39], a[212:215], v[224:227], a[36:39]
    v_exp_f32 v137, v137
    v_mfma_f32_16x16x32_bf16 a[36:39], a[208:211], v[220:223], a[36:39]
    ds_read_b128 a[164:167], v2 offset:24576
    v_cvt_pk_bf16_f32 v190, v136, v137
    v_mfma_f32_16x16x32_bf16 a[40:43], a[208:211], v[228:231], a[40:43]
    s_add_u32 s28, s28, 16384
    s_mov_b32 m0, s31
    v_exp_f32 v138, v138
    v_mfma_f32_16x16x32_bf16 a[40:43], a[212:215], v[232:235], a[40:43]
    buffer_load_dwordx4 v17, s[12:15], s29 offen offset:0 lds
    v_mfma_f32_16x16x32_bf16 a[44:47], a[212:215], v[240:243], a[44:47]
    v_exp_f32 v139, v139
    v_mfma_f32_16x16x32_bf16 a[44:47], a[208:211], v[236:239], a[44:47]
    s_waitcnt lgkmcnt(6)
    v_mfma_f32_16x16x32_bf16 v[132:135], a[144:147], v[36:39], v[100:103]
    v_exp_f32 v140, v140
    v_mfma_f32_16x16x32_bf16 v[132:135], a[148:151], v[40:43], v[132:135]
    ds_read_b64_tr_b16 a[200:201], v10 offset:24576
    v_cvt_pk_bf16_f32 v191, v138, v139
    v_mfma_f32_16x16x32_bf16 v[132:135], a[152:155], v[44:47], v[132:135]
    v_exp_f32 v141, v141
    v_mfma_f32_16x16x32_bf16 v[132:135], a[156:159], v[48:51], v[132:135]
    ds_read_b64_tr_b16 a[202:203], v10 offset:28672
    v_mfma_f32_16x16x32_bf16 v[136:139], a[156:159], v[64:67], v[104:107]
    v_exp_f32 v142, v142
    v_mfma_f32_16x16x32_bf16 v[136:139], a[152:155], v[60:63], v[136:139]
    ds_read_b128 a[168:171], v3 offset:24576
    v_cvt_pk_bf16_f32 v198, v140, v141
    v_mfma_f32_16x16x32_bf16 v[136:139], a[148:151], v[56:59], v[136:139]
    v_exp_f32 v143, v143
    v_mfma_f32_16x16x32_bf16 v[136:139], a[144:147], v[52:55], v[136:139]
    ds_read_b64_tr_b16 a[204:205], v10 offset:49152
    v_mfma_f32_16x16x32_bf16 a[48:51], a[216:219], v[212:215], a[48:51]
    v_exp_f32 v144, v144
    v_mfma_f32_16x16x32_bf16 a[48:51], a[220:223], v[216:219], a[48:51]
    ds_read_b64_tr_b16 a[206:207], v10 offset:53248
    v_cvt_pk_bf16_f32 v199, v142, v143
    v_mfma_f32_16x16x32_bf16 a[52:55], a[220:223], v[224:227], a[52:55]
    v_exp_f32 v145, v145
    v_mfma_f32_16x16x32_bf16 a[52:55], a[216:219], v[220:223], a[52:55]
    ds_read_b128 a[172:175], v4 offset:24576
    v_mfma_f32_16x16x32_bf16 a[56:59], a[216:219], v[228:231], a[56:59]
    v_exp_f32 v146, v146
    v_mfma_f32_16x16x32_bf16 a[56:59], a[220:223], v[232:235], a[56:59]
    v_cvt_pk_bf16_f32 v206, v144, v145
    v_mfma_f32_16x16x32_bf16 a[60:63], a[220:223], v[240:243], a[60:63]
    v_exp_f32 v147, v147
    v_mfma_f32_16x16x32_bf16 a[60:63], a[216:219], v[236:239], a[60:63]
    buffer_load_dwordx4 v18, s[12:15], s29 offen offset:1024 lds
    v_smfmac_f32_16x16x64_bf16 a[228:231], v[244:247], v[220:227], v248
    s_waitcnt lgkmcnt(6)
    v_mfma_f32_16x16x32_bf16 v[140:143], a[144:147], v[68:71], v[108:111]
    v_exp_f32 v148, v148
    v_mfma_f32_16x16x32_bf16 v[140:143], a[148:151], v[72:75], v[140:143]
    ds_read_b64_tr_b16 a[208:209], v11 offset:24576
    v_cvt_pk_bf16_f32 v207, v146, v147
    v_mfma_f32_16x16x32_bf16 v[140:143], a[152:155], v[76:79], v[140:143]
    v_exp_f32 v149, v149
    v_mfma_f32_16x16x32_bf16 v[140:143], a[156:159], v[80:83], v[140:143]
    ds_read_b64_tr_b16 a[210:211], v11 offset:28672
    v_mfma_f32_16x16x32_bf16 v[144:147], a[156:159], v[96:99], v[112:115]
    v_exp_f32 v150, v150
    v_mfma_f32_16x16x32_bf16 v[144:147], a[152:155], v[92:95], v[144:147]
    ds_read_b128 a[176:179], v1 offset:28672
    v_cvt_pk_bf16_f32 v184, v148, v149
    v_mfma_f32_16x16x32_bf16 v[144:147], a[148:151], v[88:91], v[144:147]
    v_exp_f32 v151, v151
    v_mfma_f32_16x16x32_bf16 v[144:147], a[144:147], v[84:87], v[144:147]
    ds_read_b64_tr_b16 a[212:213], v11 offset:49152
    v_mfma_f32_16x16x32_bf16 a[64:67], a[192:195], v[212:215], a[64:67]
    v_exp_f32 v152, v152
    v_mfma_f32_16x16x32_bf16 a[64:67], a[196:199], v[216:219], a[64:67]
    ds_read_b64_tr_b16 a[214:215], v11 offset:53248
    v_cvt_pk_bf16_f32 v185, v150, v151
    v_mfma_f32_16x16x32_bf16 a[68:71], a[196:199], v[224:227], a[68:71]
    v_exp_f32 v153, v153
    v_mfma_f32_16x16x32_bf16 a[68:71], a[192:195], v[220:223], a[68:71]
    ds_read_b128 a[180:183], v2 offset:28672
    v_cvt_pk_bf16_f32 v192, v152, v153
    v_mfma_f32_16x16x32_bf16 a[72:75], a[192:195], v[228:231], a[72:75]
    v_exp_f32 v154, v154
    v_mfma_f32_16x16x32_bf16 a[72:75], a[196:199], v[232:235], a[72:75]
    buffer_load_dwordx4 v17, s[12:15], s29 offen offset:2048 lds
    v_mfma_f32_16x16x32_bf16 a[76:79], a[196:199], v[240:243], a[76:79]
    v_exp_f32 v155, v155
    v_mfma_f32_16x16x32_bf16 a[76:79], a[192:195], v[236:239], a[76:79]
    s_waitcnt lgkmcnt(6)
    v_mfma_f32_16x16x32_bf16 v[148:151], a[160:163], v[36:39], v[100:103]
    v_exp_f32 v156, v156
    v_mfma_f32_16x16x32_bf16 v[148:151], a[164:167], v[40:43], v[148:151]
    ds_read_b64_tr_b16 a[216:217], v12 offset:24576
    v_cvt_pk_bf16_f32 v193, v154, v155
    v_mfma_f32_16x16x32_bf16 v[148:151], a[168:171], v[44:47], v[148:151]
    v_exp_f32 v157, v157
    v_mfma_f32_16x16x32_bf16 v[148:151], a[172:175], v[48:51], v[148:151]
    ds_read_b64_tr_b16 a[218:219], v12 offset:28672
    v_mfma_f32_16x16x32_bf16 v[152:155], a[172:175], v[64:67], v[104:107]
    v_exp_f32 v158, v158
    v_mfma_f32_16x16x32_bf16 v[152:155], a[168:171], v[60:63], v[152:155]
    ds_read_b128 a[184:187], v3 offset:28672
    v_cvt_pk_bf16_f32 v200, v156, v157
    v_mfma_f32_16x16x32_bf16 v[152:155], a[164:167], v[56:59], v[152:155]
    v_exp_f32 v159, v159
    v_mfma_f32_16x16x32_bf16 v[152:155], a[160:163], v[52:55], v[152:155]
    ds_read_b64_tr_b16 a[220:221], v12 offset:49152
    v_mfma_f32_16x16x32_bf16 a[80:83], a[200:203], v[212:215], a[80:83]
    v_exp_f32 v160, v160
    v_mfma_f32_16x16x32_bf16 a[80:83], a[204:207], v[216:219], a[80:83]
    ds_read_b64_tr_b16 a[222:223], v12 offset:53248
    v_cvt_pk_bf16_f32 v201, v158, v159
    v_mfma_f32_16x16x32_bf16 a[84:87], a[204:207], v[224:227], a[84:87]
    v_exp_f32 v161, v161
    v_mfma_f32_16x16x32_bf16 a[84:87], a[200:203], v[220:223], a[84:87]
    ds_read_b128 a[188:191], v4 offset:28672
    v_mfma_f32_16x16x32_bf16 a[88:91], a[200:203], v[228:231], a[88:91]
    v_exp_f32 v162, v162
    v_mfma_f32_16x16x32_bf16 a[88:91], a[204:207], v[232:235], a[88:91]
    v_cvt_pk_bf16_f32 v208, v160, v161
    v_mfma_f32_16x16x32_bf16 a[92:95], a[204:207], v[240:243], a[92:95]
    v_exp_f32 v163, v163
    v_mfma_f32_16x16x32_bf16 a[92:95], a[200:203], v[236:239], a[92:95]
    buffer_load_dwordx4 v18, s[12:15], s29 offen offset:3072 lds
    v_smfmac_f32_16x16x64_bf16 a[232:235], v[244:247], v[228:235], v248
    s_waitcnt vmcnt(8) lgkmcnt(6)
    s_barrier
    s_add_u32 s29, s29, 16384
    v_mfma_f32_16x16x32_bf16 v[156:159], a[160:163], v[68:71], v[108:111]
    v_exp_f32 v164, v164
    v_mfma_f32_16x16x32_bf16 v[156:159], a[164:167], v[72:75], v[156:159]
    ds_read_b64_tr_b16 a[192:193], v5 offset:8192
    v_cvt_pk_bf16_f32 v209, v162, v163
    v_mfma_f32_16x16x32_bf16 v[156:159], a[168:171], v[76:79], v[156:159]
    v_exp_f32 v165, v165
    v_mfma_f32_16x16x32_bf16 v[156:159], a[172:175], v[80:83], v[156:159]
    ds_read_b64_tr_b16 a[194:195], v5 offset:12288
    v_mfma_f32_16x16x32_bf16 v[160:163], a[172:175], v[96:99], v[112:115]
    v_exp_f32 v166, v166
    v_mfma_f32_16x16x32_bf16 v[160:163], a[168:171], v[92:95], v[160:163]
    ds_read_b128 a[128:131], v1 offset:32768
    v_cvt_pk_bf16_f32 v186, v164, v165
    v_mfma_f32_16x16x32_bf16 v[160:163], a[164:167], v[88:91], v[160:163]
    v_exp_f32 v167, v167
    v_mfma_f32_16x16x32_bf16 v[160:163], a[160:163], v[84:87], v[160:163]
    ds_read_b64_tr_b16 a[196:197], v5 offset:32768
    v_mfma_f32_16x16x32_bf16 a[96:99], a[208:211], v[212:215], a[96:99]
    v_exp_f32 v168, v168
    v_mfma_f32_16x16x32_bf16 a[96:99], a[212:215], v[216:219], a[96:99]
    ds_read_b64_tr_b16 a[198:199], v5 offset:36864
    v_cvt_pk_bf16_f32 v187, v166, v167
    v_mfma_f32_16x16x32_bf16 a[100:103], a[212:215], v[224:227], a[100:103]
    v_exp_f32 v169, v169
    v_mfma_f32_16x16x32_bf16 a[100:103], a[208:211], v[220:223], a[100:103]
    ds_read_b128 a[132:135], v2 offset:32768
    v_cvt_pk_bf16_f32 v194, v168, v169
    v_mfma_f32_16x16x32_bf16 a[104:107], a[208:211], v[228:231], a[104:107]
    s_add_u32 m0, s34, 49152
    v_exp_f32 v170, v170
    v_mfma_f32_16x16x32_bf16 a[104:107], a[212:215], v[232:235], a[104:107]
    buffer_load_dwordx4 v13, s[8:11], s28 offen offset:0 lds
    v_mfma_f32_16x16x32_bf16 a[108:111], a[212:215], v[240:243], a[108:111]
    v_exp_f32 v171, v171
    v_mfma_f32_16x16x32_bf16 a[108:111], a[208:211], v[236:239], a[108:111]
    s_waitcnt lgkmcnt(6)
    v_mfma_f32_16x16x32_bf16 v[164:167], a[176:179], v[36:39], v[100:103]
    v_exp_f32 v172, v172
    v_mfma_f32_16x16x32_bf16 v[164:167], a[180:183], v[40:43], v[164:167]
    ds_read_b64_tr_b16 a[200:201], v6 offset:8192
    v_cvt_pk_bf16_f32 v195, v170, v171
    v_mfma_f32_16x16x32_bf16 v[164:167], a[184:187], v[44:47], v[164:167]
    v_exp_f32 v173, v173
    v_mfma_f32_16x16x32_bf16 v[164:167], a[188:191], v[48:51], v[164:167]
    ds_read_b64_tr_b16 a[202:203], v6 offset:12288
    v_mfma_f32_16x16x32_bf16 v[168:171], a[188:191], v[64:67], v[104:107]
    v_exp_f32 v174, v174
    v_mfma_f32_16x16x32_bf16 v[168:171], a[184:187], v[60:63], v[168:171]
    ds_read_b128 a[136:139], v3 offset:32768
    v_cvt_pk_bf16_f32 v202, v172, v173
    v_mfma_f32_16x16x32_bf16 v[168:171], a[180:183], v[56:59], v[168:171]
    v_exp_f32 v175, v175
    v_mfma_f32_16x16x32_bf16 v[168:171], a[176:179], v[52:55], v[168:171]
    ds_read_b64_tr_b16 a[204:205], v6 offset:32768
    v_mfma_f32_16x16x32_bf16 a[112:115], a[216:219], v[212:215], a[112:115]
    v_exp_f32 v176, v176
    v_mfma_f32_16x16x32_bf16 a[112:115], a[220:223], v[216:219], a[112:115]
    ds_read_b64_tr_b16 a[206:207], v6 offset:36864
    v_cvt_pk_bf16_f32 v203, v174, v175
    v_mfma_f32_16x16x32_bf16 a[116:119], a[220:223], v[224:227], a[116:119]
    v_exp_f32 v177, v177
    v_mfma_f32_16x16x32_bf16 a[116:119], a[216:219], v[220:223], a[116:119]
    ds_read_b128 a[140:143], v4 offset:32768
    v_mfma_f32_16x16x32_bf16 a[120:123], a[216:219], v[228:231], a[120:123]
    v_exp_f32 v178, v178
    v_mfma_f32_16x16x32_bf16 a[120:123], a[220:223], v[232:235], a[120:123]
    v_cvt_pk_bf16_f32 v210, v176, v177
    v_mfma_f32_16x16x32_bf16 a[124:127], a[220:223], v[240:243], a[124:127]
    v_exp_f32 v179, v179
    v_mfma_f32_16x16x32_bf16 a[124:127], a[216:219], v[236:239], a[124:127]
    buffer_load_dwordx4 v14, s[8:11], s28 offen offset:1024 lds
    v_smfmac_f32_16x16x64_bf16 a[236:239], v[244:247], v[236:243], v248
    s_waitcnt lgkmcnt(6)
    v_mfma_f32_16x16x32_bf16 v[172:175], a[176:179], v[68:71], v[108:111]
    v_exp_f32 v116, v116
    v_mfma_f32_16x16x32_bf16 v[172:175], a[180:183], v[72:75], v[172:175]
    ds_read_b64_tr_b16 a[208:209], v7 offset:8192
    v_cvt_pk_bf16_f32 v211, v178, v179
    v_mfma_f32_16x16x32_bf16 v[172:175], a[184:187], v[76:79], v[172:175]
    v_exp_f32 v117, v117
    v_mfma_f32_16x16x32_bf16 v[172:175], a[188:191], v[80:83], v[172:175]
    ds_read_b64_tr_b16 a[210:211], v7 offset:12288
    v_mfma_f32_16x16x32_bf16 v[176:179], a[188:191], v[96:99], v[112:115]
    v_exp_f32 v118, v118
    v_mfma_f32_16x16x32_bf16 v[176:179], a[184:187], v[92:95], v[176:179]
    ds_read_b128 a[144:147], v1 offset:36864
    v_cvt_pk_bf16_f32 v212, v116, v117
    v_mfma_f32_16x16x32_bf16 v[176:179], a[180:183], v[88:91], v[176:179]
    v_exp_f32 v119, v119
    v_mfma_f32_16x16x32_bf16 v[176:179], a[176:179], v[84:87], v[176:179]
    ds_read_b64_tr_b16 a[212:213], v7 offset:32768
    v_mfma_f32_16x16x32_bf16 a[0:3], a[192:195], v[180:183], a[0:3]
    v_exp_f32 v120, v120
    v_mfma_f32_16x16x32_bf16 a[0:3], a[196:199], v[184:187], a[0:3]
    ds_read_b64_tr_b16 a[214:215], v7 offset:36864
    v_cvt_pk_bf16_f32 v213, v118, v119
    v_mfma_f32_16x16x32_bf16 a[4:7], a[196:199], v[192:195], a[4:7]
    v_exp_f32 v121, v121
    v_mfma_f32_16x16x32_bf16 a[4:7], a[192:195], v[188:191], a[4:7]
    ds_read_b128 a[148:151], v2 offset:36864
    v_cvt_pk_bf16_f32 v220, v120, v121
    v_mfma_f32_16x16x32_bf16 a[8:11], a[192:195], v[196:199], a[8:11]
    v_exp_f32 v122, v122
    v_mfma_f32_16x16x32_bf16 a[8:11], a[196:199], v[200:203], a[8:11]
    buffer_load_dwordx4 v15, s[8:11], s28 offen offset:2048 lds
    v_mfma_f32_16x16x32_bf16 a[12:15], a[196:199], v[208:211], a[12:15]
    v_exp_f32 v123, v123
    v_mfma_f32_16x16x32_bf16 a[12:15], a[192:195], v[204:207], a[12:15]
    s_waitcnt lgkmcnt(6)
    v_mfma_f32_16x16x32_bf16 v[116:119], a[128:131], v[36:39], v[100:103]
    v_exp_f32 v124, v124
    v_mfma_f32_16x16x32_bf16 v[116:119], a[132:135], v[40:43], v[116:119]
    ds_read_b64_tr_b16 a[216:217], v8 offset:8192
    v_cvt_pk_bf16_f32 v221, v122, v123
    v_mfma_f32_16x16x32_bf16 v[116:119], a[136:139], v[44:47], v[116:119]
    v_exp_f32 v125, v125
    v_mfma_f32_16x16x32_bf16 v[116:119], a[140:143], v[48:51], v[116:119]
    ds_read_b64_tr_b16 a[218:219], v8 offset:12288
    v_mfma_f32_16x16x32_bf16 v[120:123], a[140:143], v[64:67], v[104:107]
    v_exp_f32 v126, v126
    v_mfma_f32_16x16x32_bf16 v[120:123], a[136:139], v[60:63], v[120:123]
    ds_read_b128 a[152:155], v3 offset:36864
    v_cvt_pk_bf16_f32 v228, v124, v125
    v_mfma_f32_16x16x32_bf16 v[120:123], a[132:135], v[56:59], v[120:123]
    v_exp_f32 v127, v127
    v_mfma_f32_16x16x32_bf16 v[120:123], a[128:131], v[52:55], v[120:123]
    ds_read_b64_tr_b16 a[220:221], v8 offset:32768
    v_mfma_f32_16x16x32_bf16 a[16:19], a[200:203], v[180:183], a[16:19]
    v_exp_f32 v128, v128
    v_mfma_f32_16x16x32_bf16 a[16:19], a[204:207], v[184:187], a[16:19]
    ds_read_b64_tr_b16 a[222:223], v8 offset:36864
    v_cvt_pk_bf16_f32 v229, v126, v127
    v_mfma_f32_16x16x32_bf16 a[20:23], a[204:207], v[192:195], a[20:23]
    v_exp_f32 v129, v129
    v_mfma_f32_16x16x32_bf16 a[20:23], a[200:203], v[188:191], a[20:23]
    ds_read_b128 a[156:159], v4 offset:36864
    v_mfma_f32_16x16x32_bf16 a[24:27], a[200:203], v[196:199], a[24:27]
    v_exp_f32 v130, v130
    v_mfma_f32_16x16x32_bf16 a[24:27], a[204:207], v[200:203], a[24:27]
    v_cvt_pk_bf16_f32 v236, v128, v129
    v_mfma_f32_16x16x32_bf16 a[28:31], a[204:207], v[208:211], a[28:31]
    v_exp_f32 v131, v131
    v_mfma_f32_16x16x32_bf16 a[28:31], a[200:203], v[204:207], a[28:31]
    buffer_load_dwordx4 v16, s[8:11], s28 offen offset:3072 lds
    v_smfmac_f32_16x16x64_bf16 a[224:227], v[244:247], v[180:187], v248
    s_waitcnt lgkmcnt(6)
    v_mfma_f32_16x16x32_bf16 v[124:127], a[128:131], v[68:71], v[108:111]
    s_cmp_eq_u32 s36, 3
    s_cbranch_scc1 L_site3
L_site_back3:
    v_exp_f32 v132, v132
    v_mfma_f32_16x16x32_bf16 v[124:127], a[132:135], v[72:75], v[124:127]
    ds_read_b64_tr_b16 a[192:193], v9 offset:8192
    v_cvt_pk_bf16_f32 v237, v130, v131
    v_mfma_f32_16x16x32_bf16 v[124:127], a[136:139], v[76:79], v[124:127]
    v_exp_f32 v133, v133
    v_mfma_f32_16x16x32_bf16 v[124:127], a[140:143], v[80:83], v[124:127]
    ds_read_b64_tr_b16 a[194:195], v9 offset:12288
    v_mfma_f32_16x16x32_bf16 v[128:131], a[140:143], v[96:99], v[112:115]
    v_exp_f32 v134, v134
    v_mfma_f32_16x16x32_bf16 v[128:131], a[136:139], v[92:95], v[128:131]
    ds_read_b128 a[160:163], v1 offset:40960
    v_cvt_pk_bf16_f32 v214, v132, v133
    v_mfma_f32_16x16x32_bf16 v[128:131], a[132:135], v[88:91], v[128:131]
    v_exp_f32 v135, v135
    v_mfma_f32_16x16x32_bf16 v[128:131], a[128:131], v[84:87], v[128:131]
    ds_read_b64_tr_b16 a[196:197], v9 offset:32768
    v_mfma_f32_16x16x32_bf16 a[32:35], a[208:211], v[180:183], a[32:35]
    v_exp_f32 v136, v136
    v_mfma_f32_16x16x32_bf16 a[32:35], a[212:215], v[184:187], a[32:35]
    ds_read_b64_tr_b16 a[198:199], v9 offset:36864
    v_cvt_pk_bf16_f32 v215, v134, v135
    v_mfma_f32_16x16x32_bf16 a[36:39], a[212:215], v[192:195], a[36:39]
    v_exp_f32 v137, v137
    v_mfma_f32_16x16x32_bf16 a[36:39], a[208:211], v[188:191], a[36:39]
    ds_read_b128 a[164:167], v2 offset:40960
    v_cvt_pk_bf16_f32 v222, v136, v137
    v_mfma_f32_16x16x32_bf16 a[40:43], a[208:211], v[196:199], a[40:43]
    s_add_u32 s28, s28, 16384
    s_mov_b32 m0, s32
    v_exp_f32 v138, v138
    v_mfma_f32_16x16x32_bf16 a[40:43], a[212:215], v[200:203], a[40:43]
    buffer_load_dwordx4 v17, s[12:15], s29 offen offset:0 lds
    v_mfma_f32_16x16x32_bf16 a[44:47], a[212:215], v[208:211], a[44:47]
    v_exp_f32 v139, v139
    v_mfma_f32_16x16x32_bf16 a[44:47], a[208:211], v[204:207], a[44:47]
    s_waitcnt lgkmcnt(6)
    v_mfma_f32_16x16x32_bf16 v[132:135], a[144:147], v[36:39], v[100:103]
    v_exp_f32 v140, v140
    v_mfma_f32_16x16x32_bf16 v[132:135], a[148:151], v[40:43], v[132:135]
    ds_read_b64_tr_b16 a[200:201], v10 offset:8192
    v_cvt_pk_bf16_f32 v223, v138, v139
    v_mfma_f32_16x16x32_bf16 v[132:135], a[152:155], v[44:47], v[132:135]
    v_exp_f32 v141, v141
    v_mfma_f32_16x16x32_bf16 v[132:135], a[156:159], v[48:51], v[132:135]
    ds_read_b64_tr_b16 a[202:203], v10 offset:12288
    v_mfma_f32_16x16x32_bf16 v[136:139], a[156:159], v[64:67], v[104:107]
    v_exp_f32 v142, v142
    v_mfma_f32_16x16x32_bf16 v[136:139], a[152:155], v[60:63], v[136:139]
    ds_read_b128 a[168:171], v3 offset:40960
    v_cvt_pk_bf16_f32 v230, v140, v141
    v_mfma_f32_16x16x32_bf16 v[136:139], a[148:151], v[56:59], v[136:139]
    v_exp_f32 v143, v143
    v_mfma_f32_16x16x32_bf16 v[136:139], a[144:147], v[52:55], v[136:139]
    ds_read_b64_tr_b16 a[204:205], v10 offset:32768
    v_mfma_f32_16x16x32_bf16 a[48:51], a[216:219], v[180:183], a[48:51]
    v_exp_f32 v144, v144
    v_mfma_f32_16x16x32_bf16 a[48:51], a[220:223], v[184:187], a[48:51]
    ds_read_b64_tr_b16 a[206:207], v10 offset:36864
    v_cvt_pk_bf16_f32 v231, v142, v143
    v_mfma_f32_16x16x32_bf16 a[52:55], a[220:223], v[192:195], a[52:55]
    v_exp_f32 v145, v145
    v_mfma_f32_16x16x32_bf16 a[52:55], a[216:219], v[188:191], a[52:55]
    ds_read_b128 a[172:175], v4 offset:40960
    v_mfma_f32_16x16x32_bf16 a[56:59], a[216:219], v[196:199], a[56:59]
    v_exp_f32 v146, v146
    v_mfma_f32_16x16x32_bf16 a[56:59], a[220:223], v[200:203], a[56:59]
    v_cvt_pk_bf16_f32 v238, v144, v145
    v_mfma_f32_16x16x32_bf16 a[60:63], a[220:223], v[208:211], a[60:63]
    v_exp_f32 v147, v147
    v_mfma_f32_16x16x32_bf16 a[60:63], a[216:219], v[204:207], a[60:63]
    buffer_load_dwordx4 v18, s[12:15], s29 offen offset:1024 lds
    v_smfmac_f32_16x16x64_bf16 a[228:231], v[244:247], v[188:195], v248
    s_waitcnt lgkmcnt(6)
    v_mfma_f32_16x16x32_bf16 v[140:143], a[144:147], v[68:71], v[108:111]
    v_exp_f32 v148, v148
    v_mfma_f32_16x16x32_bf16 v[140:143], a[148:151], v[72:75], v[140:143]
    ds_read_b64_tr_b16 a[208:209], v11 offset:8192
    v_cvt_pk_bf16_f32 v239, v146, v147
    v_mfma_f32_16x16x32_bf16 v[140:143], a[152:155], v[76:79], v[140:143]
    v_exp_f32 v149, v149
    v_mfma_f32_16x16x32_bf16 v[140:143], a[156:159], v[80:83], v[140:143]
    ds_read_b64_tr_b16 a[210:211], v11 offset:12288
    v_mfma_f32_16x16x32_bf16 v[144:147], a[156:159], v[96:99], v[112:115]
    v_exp_f32 v150, v150
    v_mfma_f32_16x16x32_bf16 v[144:147], a[152:155], v[92:95], v[144:147]
    ds_read_b128 a[176:179], v1 offset:45056
    v_cvt_pk_bf16_f32 v216, v148, v149
    v_mfma_f32_16x16x32_bf16 v[144:147], a[148:151], v[88:91], v[144:147]
    v_exp_f32 v151, v151
    v_mfma_f32_16x16x32_bf16 v[144:147], a[144:147], v[84:87], v[144:147]
    ds_read_b64_tr_b16 a[212:213], v11 offset:32768
    v_mfma_f32_16x16x32_bf16 a[64:67], a[192:195], v[180:183], a[64:67]
    v_exp_f32 v152, v152
    v_mfma_f32_16x16x32_bf16 a[64:67], a[196:199], v[184:187], a[64:67]
    ds_read_b64_tr_b16 a[214:215], v11 offset:36864
    v_cvt_pk_bf16_f32 v217, v150, v151
    v_mfma_f32_16x16x32_bf16 a[68:71], a[196:199], v[192:195], a[68:71]
    v_exp_f32 v153, v153
    v_mfma_f32_16x16x32_bf16 a[68:71], a[192:195], v[188:191], a[68:71]
    ds_read_b128 a[180:183], v2 offset:45056
    v_cvt_pk_bf16_f32 v224, v152, v153
    v_mfma_f32_16x16x32_bf16 a[72:75], a[192:195], v[196:199], a[72:75]
    v_exp_f32 v154, v154
    v_mfma_f32_16x16x32_bf16 a[72:75], a[196:199], v[200:203], a[72:75]
    buffer_load_dwordx4 v17, s[12:15], s29 offen offset:2048 lds
    v_mfma_f32_16x16x32_bf16 a[76:79], a[196:199], v[208:211], a[76:79]
    v_exp_f32 v155, v155
    v_mfma_f32_16x16x32_bf16 a[76:79], a[192:195], v[204:207], a[76:79]
    s_waitcnt lgkmcnt(6)
    v_mfma_f32_16x16x32_bf16 v[148:151], a[160:163], v[36:39], v[100:103]
    v_exp_f32 v156, v156
    v_mfma_f32_16x16x32_bf16 v[148:151], a[164:167], v[40:43], v[148:151]
    ds_read_b64_tr_b16 a[216:217], v12 offset:8192
    v_cvt_pk_bf16_f32 v225, v154, v155
    v_mfma_f32_16x16x32_bf16 v[148:151], a[168:171], v[44:47], v[148:151]
    v_exp_f32 v157, v157
    v_mfma_f32_16x16x32_bf16 v[148:151], a[172:175], v[48:51], v[148:151]
    ds_read_b64_tr_b16 a[218:219], v12 offset:12288
    v_mfma_f32_16x16x32_bf16 v[152:155], a[172:175], v[64:67], v[104:107]
    v_exp_f32 v158, v158
    v_mfma_f32_16x16x32_bf16 v[152:155], a[168:171], v[60:63], v[152:155]
    ds_read_b128 a[184:187], v3 offset:45056
    v_cvt_pk_bf16_f32 v232, v156, v157
    v_mfma_f32_16x16x32_bf16 v[152:155], a[164:167], v[56:59], v[152:155]
    v_exp_f32 v159, v159
    v_mfma_f32_16x16x32_bf16 v[152:155], a[160:163], v[52:55], v[152:155]
    ds_read_b64_tr_b16 a[220:221], v12 offset:32768
    v_mfma_f32_16x16x32_bf16 a[80:83], a[200:203], v[180:183], a[80:83]
    v_exp_f32 v160, v160
    v_mfma_f32_16x16x32_bf16 a[80:83], a[204:207], v[184:187], a[80:83]
    ds_read_b64_tr_b16 a[222:223], v12 offset:36864
    v_cvt_pk_bf16_f32 v233, v158, v159
    v_mfma_f32_16x16x32_bf16 a[84:87], a[204:207], v[192:195], a[84:87]
    v_exp_f32 v161, v161
    v_mfma_f32_16x16x32_bf16 a[84:87], a[200:203], v[188:191], a[84:87]
    ds_read_b128 a[188:191], v4 offset:45056
    v_mfma_f32_16x16x32_bf16 a[88:91], a[200:203], v[196:199], a[88:91]
    v_exp_f32 v162, v162
    v_mfma_f32_16x16x32_bf16 a[88:91], a[204:207], v[200:203], a[88:91]
    v_cvt_pk_bf16_f32 v240, v160, v161
    v_mfma_f32_16x16x32_bf16 a[92:95], a[204:207], v[208:211], a[92:95]
    v_exp_f32 v163, v163
    v_mfma_f32_16x16x32_bf16 a[92:95], a[200:203], v[204:207], a[92:95]
    buffer_load_dwordx4 v18, s[12:15], s29 offen offset:3072 lds
    v_smfmac_f32_16x16x64_bf16 a[232:235], v[244:247], v[196:203], v248
    s_waitcnt vmcnt(8) lgkmcnt(6)
    s_barrier
    s_add_u32 s29, s29, 16384
    v_mfma_f32_16x16x32_bf16 v[156:159], a[160:163], v[68:71], v[108:111]
    v_exp_f32 v164, v164
    v_mfma_f32_16x16x32_bf16 v[156:159], a[164:167], v[72:75], v[156:159]
    ds_read_b64_tr_b16 a[192:193], v5 offset:16384
    v_cvt_pk_bf16_f32 v241, v162, v163
    v_mfma_f32_16x16x32_bf16 v[156:159], a[168:171], v[76:79], v[156:159]
    v_exp_f32 v165, v165
    v_mfma_f32_16x16x32_bf16 v[156:159], a[172:175], v[80:83], v[156:159]
    ds_read_b64_tr_b16 a[194:195], v5 offset:20480
    v_mfma_f32_16x16x32_bf16 v[160:163], a[172:175], v[96:99], v[112:115]
    v_exp_f32 v166, v166
    v_mfma_f32_16x16x32_bf16 v[160:163], a[168:171], v[92:95], v[160:163]
    ds_read_b128 a[128:131], v1 offset:0
    v_cvt_pk_bf16_f32 v218, v164, v165
    v_mfma_f32_16x16x32_bf16 v[160:163], a[164:167], v[88:91], v[160:163]
    v_exp_f32 v167, v167
    v_mfma_f32_16x16x32_bf16 v[160:163], a[160:163], v[84:87], v[160:163]
    ds_read_b64_tr_b16 a[196:197], v5 offset:40960
    v_mfma_f32_16x16x32_bf16 a[96:99], a[208:211], v[180:183], a[96:99]
    v_exp_f32 v168, v168
    v_mfma_f32_16x16x32_bf16 a[96:99], a[212:215], v[184:187], a[96:99]
    ds_read_b64_tr_b16 a[198:199], v5 offset:45056
    v_cvt_pk_bf16_f32 v219, v166, v167
    v_mfma_f32_16x16x32_bf16 a[100:103], a[212:215], v[192:195], a[100:103]
    v_exp_f32 v169, v169
    v_mfma_f32_16x16x32_bf16 a[100:103], a[208:211], v[188:191], a[100:103]
    ds_read_b128 a[132:135], v2 offset:0
    v_cvt_pk_bf16_f32 v226, v168, v169
    v_mfma_f32_16x16x32_bf16 a[104:107], a[208:211], v[196:199], a[104:107]
    s_add_u32 m0, s34, 16384
    v_exp_f32 v170, v170
    v_mfma_f32_16x16x32_bf16 a[104:107], a[212:215], v[200:203], a[104:107]
    buffer_load_dwordx4 v13, s[8:11], s28 offen offset:0 lds
    v_mfma_f32_16x16x32_bf16 a[108:111], a[212:215], v[208:211], a[108:111]
    v_exp_f32 v171, v171
    v_mfma_f32_16x16x32_bf16 a[108:111], a[208:211], v[204:207], a[108:111]
    s_waitcnt lgkmcnt(6)
    v_mfma_f32_16x16x32_bf16 v[164:167], a[176:179], v[36:39], v[100:103]
    s_mov_b32 s36, s5
    v_exp_f32 v172, v172
    v_mfma_f32_16x16x32_bf16 v[164:167], a[180:183], v[40:43], v[164:167]
    ds_read_b64_tr_b16 a[200:201], v6 offset:16384
    v_cvt_pk_bf16_f32 v227, v170, v171
    v_mfma_f32_16x16x32_bf16 v[164:167], a[184:187], v[44:47], v[164:167]
    v_exp_f32 v173, v173
    v_mfma_f32_16x16x32_bf16 v[164:167], a[188:191], v[48:51], v[164:167]
    ds_read_b64_tr_b16 a[202:203], v6 offset:20480
    v_mfma_f32_16x16x32_bf16 v[168:171], a[188:191], v[64:67], v[104:107]
    v_exp_f32 v174, v174
    v_mfma_f32_16x16x32_bf16 v[168:171], a[184:187], v[60:63], v[168:171]
    ds_read_b128 a[136:139], v3 offset:0
    v_cvt_pk_bf16_f32 v234, v172, v173
    v_mfma_f32_16x16x32_bf16 v[168:171], a[180:183], v[56:59], v[168:171]
    v_exp_f32 v175, v175
    v_mfma_f32_16x16x32_bf16 v[168:171], a[176:179], v[52:55], v[168:171]
    ds_read_b64_tr_b16 a[204:205], v6 offset:40960
    v_mfma_f32_16x16x32_bf16 a[112:115], a[216:219], v[180:183], a[112:115]
    v_exp_f32 v176, v176
    v_mfma_f32_16x16x32_bf16 a[112:115], a[220:223], v[184:187], a[112:115]
    ds_read_b64_tr_b16 a[206:207], v6 offset:45056
    v_cvt_pk_bf16_f32 v235, v174, v175
    v_mfma_f32_16x16x32_bf16 a[116:119], a[220:223], v[192:195], a[116:119]
    v_exp_f32 v177, v177
    v_mfma_f32_16x16x32_bf16 a[116:119], a[216:219], v[188:191], a[116:119]
    ds_read_b128 a[140:143], v4 offset:0
    v_mfma_f32_16x16x32_bf16 a[120:123], a[216:219], v[196:199], a[120:123]
    v_exp_f32 v178, v178
    v_mfma_f32_16x16x32_bf16 a[120:123], a[220:223], v[200:203], a[120:123]
    v_cvt_pk_bf16_f32 v242, v176, v177
    v_mfma_f32_16x16x32_bf16 a[124:127], a[220:223], v[208:211], a[124:127]
    v_exp_f32 v179, v179
    v_mfma_f32_16x16x32_bf16 a[124:127], a[216:219], v[204:207], a[124:127]
    buffer_load_dwordx4 v14, s[8:11], s28 offen offset:1024 lds
    v_smfmac_f32_16x16x64_bf16 a[236:239], v[244:247], v[204:211], v248
    s_waitcnt lgkmcnt(6)
    s_sub_u32 s35, s35, 1
    s_cbranch_scc0 L_attn_loop
    v_mfma_f32_16x16x32_bf16 v[172:175], a[176:179], v[68:71], v[108:111]
    s_bfe_u32 s47, s2, 0x10003
    v_exp_f32 v116, v116
    v_mfma_f32_16x16x32_bf16 v[172:175], a[180:183], v[72:75], v[172:175]
    s_bfe_u32 s40, s2, 0x20001
    ds_read_b64_tr_b16 a[208:209], v7 offset:16384
    v_cvt_pk_bf16_f32 v243, v178, v179
    v_mfma_f32_16x16x32_bf16 v[172:175], a[184:187], v[76:79], v[172:175]
    s_lshl_b32 s40, s40, 3
    v_exp_f32 v117, v117
    v_mfma_f32_16x16x32_bf16 v[172:175], a[188:191], v[80:83], v[172:175]
    s_bfe_u32 s41, s2, 0x30003
    ds_read_b64_tr_b16 a[210:211], v7 offset:20480
    v_and_b32 v21, 7, v19
    v_mfma_f32_16x16x32_bf16 v[176:179], a[188:191], v[96:99], v[112:115]
    s_add_u32 s87, s40, s41
    v_exp_f32 v118, v118
    v_mfma_f32_16x16x32_bf16 v[176:179], a[184:187], v[92:95], v[176:179]
    s_and_b32 s40, s2, 1
    ds_read_b128 a[144:147], v1 offset:4096
    v_cvt_pk_bf16_f32 v180, v116, v117
    v_mfma_f32_16x16x32_bf16 v[176:179], a[180:183], v[88:91], v[176:179]
    s_lshl_b32 s40, s40, 2
    v_exp_f32 v119, v119
    v_mfma_f32_16x16x32_bf16 v[176:179], a[176:179], v[84:87], v[176:179]
    s_lshr_b32 s41, s2, 6
    ds_read_b64_tr_b16 a[212:213], v7 offset:40960
    v_lshlrev_b32 v21, 2, v21
    v_mfma_f32_16x16x32_bf16 a[0:3], a[192:195], v[212:215], a[0:3]
    s_add_u32 s100, s40, s41
    v_exp_f32 v120, v120
    v_mfma_f32_16x16x32_bf16 a[0:3], a[196:199], v[216:219], a[0:3]
    s_add_u32 s16, s72, 0x1a00000
    s_addc_u32 s17, s73, 0
    ds_read_b64_tr_b16 a[214:215], v7 offset:45056
    v_cvt_pk_bf16_f32 v181, v118, v119
    v_mfma_f32_16x16x32_bf16 a[4:7], a[196:199], v[224:227], a[4:7]
    s_mov_b32 s18, 0x438000
    v_exp_f32 v121, v121
    v_mfma_f32_16x16x32_bf16 a[4:7], a[192:195], v[220:223], a[4:7]
    s_mov_b32 s19, 0x20000
    ds_read_b128 a[148:151], v2 offset:4096
    v_cvt_pk_bf16_f32 v188, v120, v121
    v_mfma_f32_16x16x32_bf16 a[8:11], a[192:195], v[228:231], a[8:11]
    v_exp_f32 v122, v122
    v_mfma_f32_16x16x32_bf16 a[8:11], a[196:199], v[232:235], a[8:11]
    buffer_load_dwordx4 v15, s[8:11], s28 offen offset:2048 lds
    v_add_u32 v21, 0x29b000, v21
    v_mfma_f32_16x16x32_bf16 a[12:15], a[196:199], v[240:243], a[12:15]
    v_exp_f32 v123, v123
    v_mfma_f32_16x16x32_bf16 a[12:15], a[192:195], v[236:239], a[12:15]
    s_waitcnt lgkmcnt(6)
    buffer_load_dword v249, v21, s[76:79], 0 offen sc1
    v_mfma_f32_16x16x32_bf16 v[116:119], a[128:131], v[36:39], v[100:103]
    v_exp_f32 v124, v124
    v_mfma_f32_16x16x32_bf16 v[116:119], a[132:135], v[40:43], v[116:119]
    ds_read_b64_tr_b16 a[216:217], v8 offset:16384
    v_cvt_pk_bf16_f32 v189, v122, v123
    v_mfma_f32_16x16x32_bf16 v[116:119], a[136:139], v[44:47], v[116:119]
    v_exp_f32 v125, v125
    v_mfma_f32_16x16x32_bf16 v[116:119], a[140:143], v[48:51], v[116:119]
    ds_read_b64_tr_b16 a[218:219], v8 offset:20480
    v_lshlrev_b32 v32, 7, v19
    v_mfma_f32_16x16x32_bf16 v[120:123], a[140:143], v[64:67], v[104:107]
    v_exp_f32 v126, v126
    v_mfma_f32_16x16x32_bf16 v[120:123], a[136:139], v[60:63], v[120:123]
    ds_read_b128 a[152:155], v3 offset:4096
    v_cvt_pk_bf16_f32 v196, v124, v125
    v_mfma_f32_16x16x32_bf16 v[120:123], a[132:135], v[56:59], v[120:123]
    v_exp_f32 v127, v127
    v_mfma_f32_16x16x32_bf16 v[120:123], a[128:131], v[52:55], v[120:123]
    ds_read_b64_tr_b16 a[220:221], v8 offset:40960
    v_add_u32 v32, 0x290000, v32
    v_mfma_f32_16x16x32_bf16 a[16:19], a[200:203], v[212:215], a[16:19]
    v_exp_f32 v128, v128
    v_mfma_f32_16x16x32_bf16 a[16:19], a[204:207], v[216:219], a[16:19]
    ds_read_b64_tr_b16 a[222:223], v8 offset:45056
    v_cvt_pk_bf16_f32 v197, v126, v127
    v_mfma_f32_16x16x32_bf16 a[20:23], a[204:207], v[224:227], a[20:23]
    v_exp_f32 v129, v129
    v_mfma_f32_16x16x32_bf16 a[20:23], a[200:203], v[220:223], a[20:23]
    ds_read_b128 a[156:159], v4 offset:4096
    v_mfma_f32_16x16x32_bf16 a[24:27], a[200:203], v[228:231], a[24:27]
    v_exp_f32 v130, v130
    v_mfma_f32_16x16x32_bf16 a[24:27], a[204:207], v[232:235], a[24:27]
    v_cvt_pk_bf16_f32 v204, v128, v129
    v_mfma_f32_16x16x32_bf16 a[28:31], a[204:207], v[240:243], a[28:31]
    v_exp_f32 v131, v131
    v_mfma_f32_16x16x32_bf16 a[28:31], a[200:203], v[236:239], a[28:31]
    buffer_load_dwordx4 v16, s[8:11], s28 offen offset:3072 lds
    v_smfmac_f32_16x16x64_bf16 a[224:227], v[244:247], v[212:219], v248
    s_waitcnt lgkmcnt(6)
    buffer_load_dwordx4 v[28:31], v32, s[76:79], 0 offen sc1
    v_mfma_f32_16x16x32_bf16 v[124:127], a[128:131], v[68:71], v[108:111]
    v_exp_f32 v132, v132
    v_mfma_f32_16x16x32_bf16 v[124:127], a[132:135], v[72:75], v[124:127]
    ds_read_b64_tr_b16 a[192:193], v9 offset:16384
    v_cvt_pk_bf16_f32 v205, v130, v131
    v_mfma_f32_16x16x32_bf16 v[124:127], a[136:139], v[76:79], v[124:127]
    v_exp_f32 v133, v133
    v_mfma_f32_16x16x32_bf16 v[124:127], a[140:143], v[80:83], v[124:127]
    ds_read_b64_tr_b16 a[194:195], v9 offset:20480
    v_mov_b32 v24, 0x3f803f80
    v_mfma_f32_16x16x32_bf16 v[128:131], a[140:143], v[96:99], v[112:115]
    v_exp_f32 v134, v134
    v_mfma_f32_16x16x32_bf16 v[128:131], a[136:139], v[92:95], v[128:131]
    ds_read_b128 a[160:163], v1 offset:8192
    v_cvt_pk_bf16_f32 v182, v132, v133
    v_mfma_f32_16x16x32_bf16 v[128:131], a[132:135], v[88:91], v[128:131]
    v_exp_f32 v135, v135
    v_accvgpr_write_b32 a240, v24
    v_mfma_f32_16x16x32_bf16 v[128:131], a[128:131], v[84:87], v[128:131]
    ds_read_b64_tr_b16 a[196:197], v9 offset:40960
    v_accvgpr_write_b32 a241, v24
    v_mfma_f32_16x16x32_bf16 a[32:35], a[208:211], v[212:215], a[32:35]
    v_exp_f32 v136, v136
    v_mfma_f32_16x16x32_bf16 a[32:35], a[212:215], v[216:219], a[32:35]
    ds_read_b64_tr_b16 a[198:199], v9 offset:45056
    v_cvt_pk_bf16_f32 v183, v134, v135
    v_lshlrev_b32 v25, 4, v19
    v_mfma_f32_16x16x32_bf16 a[36:39], a[212:215], v[224:227], a[36:39]
    s_mul_i32 s40, s5, 3072
    v_exp_f32 v137, v137
    v_mfma_f32_16x16x32_bf16 a[36:39], a[208:211], v[220:223], a[36:39]
    s_mul_i32 s41, s6, 10240
    ds_read_b128 a[164:167], v2 offset:8192
    v_cvt_pk_bf16_f32 v190, v136, v137
    v_mfma_f32_16x16x32_bf16 a[40:43], a[208:211], v[228:231], a[40:43]
    s_add_u32 s28, s28, 16384
    s_mov_b32 m0, s33
    v_exp_f32 v138, v138
    v_accvgpr_write_b32 a242, v24
    v_mfma_f32_16x16x32_bf16 a[40:43], a[212:215], v[232:235], a[40:43]
    s_add_u32 s41, s41, s40
    buffer_load_dwordx4 v17, s[12:15], s29 offen offset:0 lds
    v_mfma_f32_16x16x32_bf16 a[44:47], a[212:215], v[240:243], a[44:47]
    v_exp_f32 v139, v139
    v_mfma_f32_16x16x32_bf16 a[44:47], a[208:211], v[236:239], a[44:47]
    s_waitcnt lgkmcnt(6)
    v_accvgpr_write_b32 a243, v24
    v_accvgpr_write_b32 a244, v24
    v_mfma_f32_16x16x32_bf16 v[132:135], a[144:147], v[36:39], v[100:103]
    v_exp_f32 v140, v140
    v_mfma_f32_16x16x32_bf16 v[132:135], a[148:151], v[40:43], v[132:135]
    ds_read_b64_tr_b16 a[200:201], v10 offset:16384
    v_cvt_pk_bf16_f32 v191, v138, v139
    v_mfma_f32_16x16x32_bf16 v[132:135], a[152:155], v[44:47], v[132:135]
    v_exp_f32 v141, v141
    v_mfma_f32_16x16x32_bf16 v[132:135], a[156:159], v[48:51], v[132:135]
    ds_read_b64_tr_b16 a[202:203], v10 offset:20480
    v_accvgpr_write_b32 a245, v24
    v_mfma_f32_16x16x32_bf16 v[136:139], a[156:159], v[64:67], v[104:107]
    v_exp_f32 v142, v142
    v_mfma_f32_16x16x32_bf16 v[136:139], a[152:155], v[60:63], v[136:139]
    ds_read_b128 a[168:171], v3 offset:8192
    v_cvt_pk_bf16_f32 v198, v140, v141
    v_mfma_f32_16x16x32_bf16 v[136:139], a[148:151], v[56:59], v[136:139]
    v_exp_f32 v143, v143
    v_mfma_f32_16x16x32_bf16 v[136:139], a[144:147], v[52:55], v[136:139]
    ds_read_b64_tr_b16 a[204:205], v10 offset:40960
    v_accvgpr_write_b32 a246, v24
    v_mfma_f32_16x16x32_bf16 a[48:51], a[216:219], v[212:215], a[48:51]
    v_exp_f32 v144, v144
    v_mfma_f32_16x16x32_bf16 a[48:51], a[220:223], v[216:219], a[48:51]
    ds_read_b64_tr_b16 a[206:207], v10 offset:45056
    v_cvt_pk_bf16_f32 v199, v142, v143
    v_mfma_f32_16x16x32_bf16 a[52:55], a[220:223], v[224:227], a[52:55]
    v_exp_f32 v145, v145
    v_mfma_f32_16x16x32_bf16 a[52:55], a[216:219], v[220:223], a[52:55]
    ds_read_b128 a[172:175], v4 offset:8192
    v_accvgpr_write_b32 a247, v24
    v_mfma_f32_16x16x32_bf16 a[56:59], a[216:219], v[228:231], a[56:59]
    v_exp_f32 v146, v146
    v_mfma_f32_16x16x32_bf16 a[56:59], a[220:223], v[232:235], a[56:59]
    v_cvt_pk_bf16_f32 v206, v144, v145
    v_accvgpr_write_b32 a248, v24
    v_mfma_f32_16x16x32_bf16 a[60:63], a[220:223], v[240:243], a[60:63]
    v_exp_f32 v147, v147
    v_mfma_f32_16x16x32_bf16 a[60:63], a[216:219], v[236:239], a[60:63]
    buffer_load_dwordx4 v18, s[12:15], s29 offen offset:1024 lds
    v_smfmac_f32_16x16x64_bf16 a[228:231], v[244:247], v[220:227], v248
    s_waitcnt lgkmcnt(6)
    v_accvgpr_write_b32 a249, v24
    v_accvgpr_write_b32 a250, v24
    v_mfma_f32_16x16x32_bf16 v[140:143], a[144:147], v[68:71], v[108:111]
    v_exp_f32 v148, v148
    v_mfma_f32_16x16x32_bf16 v[140:143], a[148:151], v[72:75], v[140:143]
    ds_read_b64_tr_b16 a[208:209], v11 offset:16384
    v_cvt_pk_bf16_f32 v207, v146, v147
    v_mfma_f32_16x16x32_bf16 v[140:143], a[152:155], v[76:79], v[140:143]
    v_exp_f32 v149, v149
    v_mfma_f32_16x16x32_bf16 v[140:143], a[156:159], v[80:83], v[140:143]
    ds_read_b64_tr_b16 a[210:211], v11 offset:20480
    v_accvgpr_write_b32 a251, v24
    v_mfma_f32_16x16x32_bf16 v[144:147], a[156:159], v[96:99], v[112:115]
    v_exp_f32 v150, v150
    v_mfma_f32_16x16x32_bf16 v[144:147], a[152:155], v[92:95], v[144:147]
    ds_read_b128 a[176:179], v1 offset:12288
    v_cvt_pk_bf16_f32 v184, v148, v149
    v_mfma_f32_16x16x32_bf16 v[144:147], a[148:151], v[88:91], v[144:147]
    v_exp_f32 v151, v151
    v_mfma_f32_16x16x32_bf16 v[144:147], a[144:147], v[84:87], v[144:147]
    ds_read_b64_tr_b16 a[212:213], v11 offset:40960
    v_accvgpr_write_b32 a252, v24
    v_mfma_f32_16x16x32_bf16 a[64:67], a[192:195], v[212:215], a[64:67]
    v_exp_f32 v152, v152
    v_mfma_f32_16x16x32_bf16 a[64:67], a[196:199], v[216:219], a[64:67]
    ds_read_b64_tr_b16 a[214:215], v11 offset:45056
    v_cvt_pk_bf16_f32 v185, v150, v151
    v_mfma_f32_16x16x32_bf16 a[68:71], a[196:199], v[224:227], a[68:71]
    v_exp_f32 v153, v153
    v_mfma_f32_16x16x32_bf16 a[68:71], a[192:195], v[220:223], a[68:71]
    ds_read_b128 a[180:183], v2 offset:12288
    v_cvt_pk_bf16_f32 v192, v152, v153
    v_mfma_f32_16x16x32_bf16 a[72:75], a[192:195], v[228:231], a[72:75]
    v_exp_f32 v154, v154
    v_mfma_f32_16x16x32_bf16 a[72:75], a[196:199], v[232:235], a[72:75]
    buffer_load_dwordx4 v17, s[12:15], s29 offen offset:2048 lds
    s_mov_b32 s43, m0
    s_add_u32 m0, s40, 86016
    s_nop 0
    buffer_load_dwordx4 v25, s[96:99], s41 offen offset:0 lds
    s_mov_b32 m0, s43
    v_accvgpr_write_b32 a253, v24
    v_mfma_f32_16x16x32_bf16 a[76:79], a[196:199], v[240:243], a[76:79]
    v_exp_f32 v155, v155
    v_mfma_f32_16x16x32_bf16 a[76:79], a[192:195], v[236:239], a[76:79]
    s_waitcnt lgkmcnt(6)
    v_accvgpr_write_b32 a254, v24
    v_accvgpr_write_b32 a255, v24
    v_mfma_f32_16x16x32_bf16 v[148:151], a[160:163], v[36:39], v[100:103]
    v_exp_f32 v156, v156
    v_mfma_f32_16x16x32_bf16 v[148:151], a[164:167], v[40:43], v[148:151]
    ds_read_b64_tr_b16 a[216:217], v12 offset:16384
    v_cvt_pk_bf16_f32 v193, v154, v155
    v_mfma_f32_16x16x32_bf16 v[148:151], a[168:171], v[44:47], v[148:151]
    v_exp_f32 v157, v157
    v_mfma_f32_16x16x32_bf16 v[148:151], a[172:175], v[48:51], v[148:151]
    ds_read_b64_tr_b16 a[218:219], v12 offset:20480
    v_mov_b32 v252, v24
    v_mfma_f32_16x16x32_bf16 v[152:155], a[172:175], v[64:67], v[104:107]
    v_exp_f32 v158, v158
    v_mfma_f32_16x16x32_bf16 v[152:155], a[168:171], v[60:63], v[152:155]
    ds_read_b128 a[184:187], v3 offset:12288
    v_cvt_pk_bf16_f32 v200, v156, v157
    v_mfma_f32_16x16x32_bf16 v[152:155], a[164:167], v[56:59], v[152:155]
    v_exp_f32 v159, v159
    v_mfma_f32_16x16x32_bf16 v[152:155], a[160:163], v[52:55], v[152:155]
    ds_read_b64_tr_b16 a[220:221], v12 offset:40960
    s_mov_b32 s43, m0
    s_add_u32 m0, s40, 86016
    s_nop 0
    buffer_load_dwordx4 v25, s[96:99], s41 offen offset:1024 lds
    s_mov_b32 m0, s43
    v_mov_b32 v253, v24
    v_mfma_f32_16x16x32_bf16 a[80:83], a[200:203], v[212:215], a[80:83]
    v_exp_f32 v160, v160
    v_mfma_f32_16x16x32_bf16 a[80:83], a[204:207], v[216:219], a[80:83]
    ds_read_b64_tr_b16 a[222:223], v12 offset:45056
    v_cvt_pk_bf16_f32 v201, v158, v159
    v_mfma_f32_16x16x32_bf16 a[84:87], a[204:207], v[224:227], a[84:87]
    v_exp_f32 v161, v161
    v_mfma_f32_16x16x32_bf16 a[84:87], a[200:203], v[220:223], a[84:87]
    ds_read_b128 a[188:191], v4 offset:12288
    v_mov_b32 v254, v24
    v_mfma_f32_16x16x32_bf16 a[88:91], a[200:203], v[228:231], a[88:91]
    v_exp_f32 v162, v162
    v_mfma_f32_16x16x32_bf16 a[88:91], a[204:207], v[232:235], a[88:91]
    v_cvt_pk_bf16_f32 v208, v160, v161
    v_mov_b32 v255, v24
    v_mfma_f32_16x16x32_bf16 a[92:95], a[204:207], v[240:243], a[92:95]
    v_exp_f32 v163, v163
    v_mfma_f32_16x16x32_bf16 a[92:95], a[200:203], v[236:239], a[92:95]
    buffer_load_dwordx4 v18, s[12:15], s29 offen offset:3072 lds
    v_smfmac_f32_16x16x64_bf16 a[232:235], v[244:247], v[228:235], v248
    s_waitcnt vmcnt(12) lgkmcnt(6)
    s_barrier
    s_add_u32 s29, s29, 16384
    s_mov_b32 s43, m0
    s_add_u32 m0, s40, 86016
    s_nop 0
    buffer_load_dwordx4 v25, s[96:99], s41 offen offset:2048 lds
    s_mov_b32 m0, s43
    v_mfma_f32_16x16x32_bf16 v[156:159], a[160:163], v[68:71], v[108:111]
    s_waitcnt vmcnt(7)
    v_exp_f32 v164, v164
    v_mfma_f32_16x16x32_bf16 v[156:159], a[164:167], v[72:75], v[156:159]
    ds_read_b64_tr_b16 a[192:193], v5 offset:57344
    v_cvt_pk_bf16_f32 v209, v162, v163
    v_mfma_f32_16x16x32_bf16 v[156:159], a[168:171], v[76:79], v[156:159]
    v_exp_f32 v165, v165
    v_mfma_f32_16x16x32_bf16 v[156:159], a[172:175], v[80:83], v[156:159]
    ds_read_b64_tr_b16 a[194:195], v5 offset:61440
    v_cmp_eq_u32 vcc, 0, v249
    s_and_b64 vcc, vcc, exec
    s_cbranch_scc1 L_spin_sel
L_back_sel:
    v_mfma_f32_16x16x32_bf16 v[160:163], a[172:175], v[96:99], v[112:115]
    v_exp_f32 v166, v166
    v_mfma_f32_16x16x32_bf16 v[160:163], a[168:171], v[92:95], v[160:163]
    ds_read_b128 a[128:131], v1 offset:49152
    v_cvt_pk_bf16_f32 v186, v164, v165
    v_mfma_f32_16x16x32_bf16 v[160:163], a[164:167], v[88:91], v[160:163]
    v_exp_f32 v167, v167
    v_mfma_f32_16x16x32_bf16 v[160:163], a[160:163], v[84:87], v[160:163]
    ds_read_b64_tr_b16 a[196:197], v5 offset:0
    v_min3_u32 v28, v28, v29, v30
    v_mfma_f32_16x16x32_bf16 a[96:99], a[208:211], v[212:215], a[96:99]
    v_exp_f32 v168, v168
    v_mfma_f32_16x16x32_bf16 a[96:99], a[212:215], v[216:219], a[96:99]
    ds_read_b64_tr_b16 a[198:199], v5 offset:4096
    v_cvt_pk_bf16_f32 v187, v166, v167
    v_mfma_f32_16x16x32_bf16 a[100:103], a[212:215], v[224:227], a[100:103]
    v_exp_f32 v169, v169
    v_mfma_f32_16x16x32_bf16 a[100:103], a[208:211], v[220:223], a[100:103]
    ds_read_b128 a[132:135], v2 offset:49152
    v_cvt_pk_bf16_f32 v194, v168, v169
    v_mfma_f32_16x16x32_bf16 a[104:107], a[208:211], v[228:231], a[104:107]
    s_add_u32 m0, s34, 32768
    v_exp_f32 v170, v170
    v_mfma_f32_16x16x32_bf16 a[104:107], a[212:215], v[232:235], a[104:107]
    buffer_load_dwordx4 v13, s[8:11], s28 offen offset:0 lds
    v_mfma_f32_16x16x32_bf16 a[108:111], a[212:215], v[240:243], a[108:111]
    v_exp_f32 v171, v171
    v_mfma_f32_16x16x32_bf16 a[108:111], a[208:211], v[236:239], a[108:111]
    s_waitcnt lgkmcnt(6)
    v_min_u32 v28, v28, v31
    v_cmp_gt_u32 vcc, 1, v28
    s_and_b64 vcc, vcc, exec
    s_cbranch_scc1 L_spin_pack
L_back_pack:
    v_mfma_f32_16x16x32_bf16 v[164:167], a[176:179], v[36:39], v[100:103]
    v_exp_f32 v172, v172
    v_mfma_f32_16x16x32_bf16 v[164:167], a[180:183], v[40:43], v[164:167]
    ds_read_b64_tr_b16 a[200:201], v6 offset:57344
    v_cvt_pk_bf16_f32 v195, v170, v171
    v_mfma_f32_16x16x32_bf16 v[164:167], a[184:187], v[44:47], v[164:167]
    v_exp_f32 v173, v173
    v_mfma_f32_16x16x32_bf16 v[164:167], a[188:191], v[48:51], v[164:167]
    ds_read_b64_tr_b16 a[202:203], v6 offset:61440
    v_mfma_f32_16x16x32_bf16 v[168:171], a[188:191], v[64:67], v[104:107]
    v_exp_f32 v174, v174
    v_mfma_f32_16x16x32_bf16 v[168:171], a[184:187], v[60:63], v[168:171]
    ds_read_b128 a[136:139], v3 offset:49152
    v_cvt_pk_bf16_f32 v202, v172, v173
    v_mfma_f32_16x16x32_bf16 v[168:171], a[180:183], v[56:59], v[168:171]
    v_exp_f32 v175, v175
    v_mfma_f32_16x16x32_bf16 v[168:171], a[176:179], v[52:55], v[168:171]
    ds_read_b64_tr_b16 a[204:205], v6 offset:0
    v_mfma_f32_16x16x32_bf16 a[112:115], a[216:219], v[212:215], a[112:115]
    v_exp_f32 v176, v176
    v_mfma_f32_16x16x32_bf16 a[112:115], a[220:223], v[216:219], a[112:115]
    ds_read_b64_tr_b16 a[206:207], v6 offset:4096
    v_cvt_pk_bf16_f32 v203, v174, v175
    v_mfma_f32_16x16x32_bf16 a[116:119], a[220:223], v[224:227], a[116:119]
    v_exp_f32 v177, v177
    v_mfma_f32_16x16x32_bf16 a[116:119], a[216:219], v[220:223], a[116:119]
    ds_read_b128 a[140:143], v4 offset:49152
    v_mfma_f32_16x16x32_bf16 a[120:123], a[216:219], v[228:231], a[120:123]
    v_exp_f32 v178, v178
    v_mfma_f32_16x16x32_bf16 a[120:123], a[220:223], v[232:235], a[120:123]
    v_cvt_pk_bf16_f32 v210, v176, v177
    v_mfma_f32_16x16x32_bf16 a[124:127], a[220:223], v[240:243], a[124:127]
    v_exp_f32 v179, v179
    v_mfma_f32_16x16x32_bf16 a[124:127], a[216:219], v[236:239], a[124:127]
    buffer_load_dwordx4 v14, s[8:11], s28 offen offset:1024 lds
    v_smfmac_f32_16x16x64_bf16 a[236:239], v[244:247], v[236:243], v248
    s_waitcnt lgkmcnt(6)
    v_mfma_f32_16x16x32_bf16 v[172:175], a[176:179], v[68:71], v[108:111]
    v_exp_f32 v116, v116
    v_mfma_f32_16x16x32_bf16 v[172:175], a[180:183], v[72:75], v[172:175]
    ds_read_b64_tr_b16 a[208:209], v7 offset:57344
    v_cvt_pk_bf16_f32 v211, v178, v179
    v_mfma_f32_16x16x32_bf16 v[172:175], a[184:187], v[76:79], v[172:175]
    v_exp_f32 v117, v117
    v_mfma_f32_16x16x32_bf16 v[172:175], a[188:191], v[80:83], v[172:175]
    ds_read_b64_tr_b16 a[210:211], v7 offset:61440
    v_mov_b32 v22, v249
    v_mfma_f32_16x16x32_bf16 v[176:179], a[188:191], v[96:99], v[112:115]
    v_exp_f32 v118, v118
    v_mfma_f32_16x16x32_bf16 v[176:179], a[184:187], v[92:95], v[176:179]
    ds_read_b128 a[144:147], v1 offset:53248
    v_cvt_pk_bf16_f32 v212, v116, v117
    v_mfma_f32_16x16x32_bf16 v[176:179], a[180:183], v[88:91], v[176:179]
    v_exp_f32 v119, v119
    v_mfma_f32_16x16x32_bf16 v[176:179], a[176:179], v[84:87], v[176:179]
    ds_read_b64_tr_b16 a[212:213], v7 offset:0
    v_not_b32 v22, v22
    v_mfma_f32_16x16x32_bf16 a[0:3], a[192:195], v[180:183], a[0:3]
    v_exp_f32 v120, v120
    v_mfma_f32_16x16x32_bf16 a[0:3], a[196:199], v[184:187], a[0:3]
    ds_read_b64_tr_b16 a[214:215], v7 offset:4096
    v_cvt_pk_bf16_f32 v213, v118, v119
    v_mfma_f32_16x16x32_bf16 a[4:7], a[196:199], v[192:195], a[4:7]
    v_exp_f32 v121, v121
    v_mfma_f32_16x16x32_bf16 a[4:7], a[192:195], v[188:191], a[4:7]
    ds_read_b128 a[148:151], v2 offset:53248
    v_cvt_pk_bf16_f32 v220, v120, v121
    v_mfma_f32_16x16x32_bf16 a[8:11], a[192:195], v[196:199], a[8:11]
    v_exp_f32 v122, v122
    v_and_b32 v22, 0x7ff, v22
    v_mfma_f32_16x16x32_bf16 a[8:11], a[196:199], v[200:203], a[8:11]
    buffer_load_dwordx4 v15, s[8:11], s28 offen offset:2048 lds
    v_mfma_f32_16x16x32_bf16 a[12:15], a[196:199], v[208:211], a[12:15]
    v_exp_f32 v123, v123
    v_mfma_f32_16x16x32_bf16 a[12:15], a[192:195], v[204:207], a[12:15]
    s_waitcnt lgkmcnt(6)
    v_lshrrev_b32 v24, 4, v19
    v_lshlrev_b32 v23, 4, v22
    v_mfma_f32_16x16x32_bf16 v[116:119], a[128:131], v[36:39], v[100:103]
    v_exp_f32 v124, v124
    v_mfma_f32_16x16x32_bf16 v[116:119], a[132:135], v[40:43], v[116:119]
    ds_read_b64_tr_b16 a[216:217], v8 offset:57344
    v_cvt_pk_bf16_f32 v221, v122, v123
    v_mfma_f32_16x16x32_bf16 v[116:119], a[136:139], v[44:47], v[116:119]
    v_exp_f32 v125, v125
    v_mfma_f32_16x16x32_bf16 v[116:119], a[140:143], v[48:51], v[116:119]
    ds_read_b64_tr_b16 a[218:219], v8 offset:61440
    v_mul_u32_u24 v22, 1280, v22
    v_mfma_f32_16x16x32_bf16 v[120:123], a[140:143], v[64:67], v[104:107]
    v_exp_f32 v126, v126
    v_mfma_f32_16x16x32_bf16 v[120:123], a[136:139], v[60:63], v[120:123]
    ds_read_b128 a[152:155], v3 offset:53248
    v_cvt_pk_bf16_f32 v228, v124, v125
    v_mfma_f32_16x16x32_bf16 v[120:123], a[132:135], v[56:59], v[120:123]
    v_exp_f32 v127, v127
    v_mfma_f32_16x16x32_bf16 v[120:123], a[128:131], v[52:55], v[120:123]
    ds_read_b64_tr_b16 a[220:221], v8 offset:0
    v_lshl_add_u32 v22, v24, 4, v22
    v_mfma_f32_16x16x32_bf16 a[16:19], a[200:203], v[180:183], a[16:19]
    s_mul_i32 s40, s5, 320
    v_exp_f32 v128, v128
    v_mfma_f32_16x16x32_bf16 a[16:19], a[204:207], v[184:187], a[16:19]
    s_mov_b32 s41, 0x280000
    ds_read_b64_tr_b16 a[222:223], v8 offset:4096
    v_cvt_pk_bf16_f32 v229, v126, v127
    v_mfma_f32_16x16x32_bf16 a[20:23], a[204:207], v[192:195], a[20:23]
    v_exp_f32 v129, v129
    v_mfma_f32_16x16x32_bf16 a[20:23], a[200:203], v[188:191], a[20:23]
    ds_read_b128 a[156:159], v4 offset:53248
    v_mfma_f32_16x16x32_bf16 a[24:27], a[200:203], v[196:199], a[24:27]
    v_exp_f32 v130, v130
    v_mfma_f32_16x16x32_bf16 a[24:27], a[204:207], v[200:203], a[24:27]
    v_cvt_pk_bf16_f32 v236, v128, v129
    v_mfma_f32_16x16x32_bf16 a[28:31], a[204:207], v[208:211], a[28:31]
    v_exp_f32 v131, v131
    v_mfma_f32_16x16x32_bf16 a[28:31], a[200:203], v[204:207], a[28:31]
    buffer_load_dwordx4 v16, s[8:11], s28 offen offset:3072 lds
    v_smfmac_f32_16x16x64_bf16 a[224:227], v[244:247], v[180:187], v248
    s_waitcnt lgkmcnt(6)
    buffer_load_dwordx2 v[20:21], v23, s[76:79], s41 offen sc1
    v_mfma_f32_16x16x32_bf16 v[124:127], a[128:131], v[68:71], v[108:111]
    v_exp_f32 v132, v132
    v_mfma_f32_16x16x32_bf16 v[124:127], a[132:135], v[72:75], v[124:127]
    ds_read_b64_tr_b16 a[192:193], v9 offset:57344
    v_cvt_pk_bf16_f32 v237, v130, v131
    v_mfma_f32_16x16x32_bf16 v[124:127], a[136:139], v[76:79], v[124:127]
    v_exp_f32 v133, v133
    v_mfma_f32_16x16x32_bf16 v[124:127], a[140:143], v[80:83], v[124:127]
    ds_read_b64_tr_b16 a[194:195], v9 offset:61440
    v_mfma_f32_16x16x32_bf16 v[128:131], a[140:143], v[96:99], v[112:115]
    v_exp_f32 v134, v134
    v_mfma_f32_16x16x32_bf16 v[128:131], a[136:139], v[92:95], v[128:131]
    ds_read_b128 a[160:163], v1 offset:57344
    v_cvt_pk_bf16_f32 v214, v132, v133
    v_mfma_f32_16x16x32_bf16 v[128:131], a[132:135], v[88:91], v[128:131]
    v_exp_f32 v135, v135
    v_mfma_f32_16x16x32_bf16 v[128:131], a[128:131], v[84:87], v[128:131]
    ds_read_b64_tr_b16 a[196:197], v9 offset:0
    v_mfma_f32_16x16x32_bf16 a[32:35], a[208:211], v[180:183], a[32:35]
    v_exp_f32 v136, v136
    v_mfma_f32_16x16x32_bf16 a[32:35], a[212:215], v[184:187], a[32:35]
    ds_read_b64_tr_b16 a[198:199], v9 offset:4096
    v_cvt_pk_bf16_f32 v215, v134, v135
    v_mfma_f32_16x16x32_bf16 a[36:39], a[212:215], v[192:195], a[36:39]
    v_exp_f32 v137, v137
    v_mfma_f32_16x16x32_bf16 a[36:39], a[208:211], v[188:191], a[36:39]
    ds_read_b128 a[164:167], v2 offset:57344
    v_cvt_pk_bf16_f32 v222, v136, v137
    v_mfma_f32_16x16x32_bf16 a[40:43], a[208:211], v[196:199], a[40:43]
    s_add_u32 s28, s28, 16384
    s_mov_b32 m0, s30
    v_exp_f32 v138, v138
    v_mfma_f32_16x16x32_bf16 a[40:43], a[212:215], v[200:203], a[40:43]
    buffer_load_dwordx4 v17, s[12:15], s29 offen offset:0 lds
    v_mfma_f32_16x16x32_bf16 a[44:47], a[212:215], v[208:211], a[44:47]
    s_mov_b32 exec_lo, 0x00ff00ff
    s_mov_b32 exec_hi, 0x00ff00ff
    buffer_load_dwordx4 a[240:243], v22, s[88:91], s40 offen offset:0
    s_mov_b64 exec, -1
    v_exp_f32 v139, v139
    v_mfma_f32_16x16x32_bf16 a[44:47], a[208:211], v[204:207], a[44:47]
    s_waitcnt lgkmcnt(6)
    s_mov_b32 exec_lo, 0x00ff00ff
    s_mov_b32 exec_hi, 0x00ff00ff
    buffer_load_dwordx4 a[244:247], v22, s[88:91], s40 offen offset:64
    s_mov_b64 exec, -1
    v_mfma_f32_16x16x32_bf16 v[132:135], a[144:147], v[36:39], v[100:103]
    v_exp_f32 v140, v140
    v_mfma_f32_16x16x32_bf16 v[132:135], a[148:151], v[40:43], v[132:135]
    ds_read_b64_tr_b16 a[200:201], v10 offset:57344
    v_cvt_pk_bf16_f32 v223, v138, v139
    v_mfma_f32_16x16x32_bf16 v[132:135], a[152:155], v[44:47], v[132:135]
    v_exp_f32 v141, v141
    v_mfma_f32_16x16x32_bf16 v[132:135], a[156:159], v[48:51], v[132:135]
    ds_read_b64_tr_b16 a[202:203], v10 offset:61440
    v_mfma_f32_16x16x32_bf16 v[136:139], a[156:159], v[64:67], v[104:107]
    v_exp_f32 v142, v142
    v_mfma_f32_16x16x32_bf16 v[136:139], a[152:155], v[60:63], v[136:139]
    ds_read_b128 a[168:171], v3 offset:57344
    v_cvt_pk_bf16_f32 v230, v140, v141
    v_mfma_f32_16x16x32_bf16 v[136:139], a[148:151], v[56:59], v[136:139]
    v_exp_f32 v143, v143
    v_mfma_f32_16x16x32_bf16 v[136:139], a[144:147], v[52:55], v[136:139]
    ds_read_b64_tr_b16 a[204:205], v10 offset:0
    s_mov_b32 exec_lo, 0x00ff00ff
    s_mov_b32 exec_hi, 0x00ff00ff
    buffer_load_dwordx4 a[248:251], v22, s[88:91], s40 offen offset:128
    s_mov_b64 exec, -1
    v_mfma_f32_16x16x32_bf16 a[48:51], a[216:219], v[180:183], a[48:51]
    v_exp_f32 v144, v144
    v_mfma_f32_16x16x32_bf16 a[48:51], a[220:223], v[184:187], a[48:51]
    ds_read_b64_tr_b16 a[206:207], v10 offset:4096
    v_cvt_pk_bf16_f32 v231, v142, v143
    v_mfma_f32_16x16x32_bf16 a[52:55], a[220:223], v[192:195], a[52:55]
    v_exp_f32 v145, v145
    v_mfma_f32_16x16x32_bf16 a[52:55], a[216:219], v[188:191], a[52:55]
    ds_read_b128 a[172:175], v4 offset:57344
    v_mfma_f32_16x16x32_bf16 a[56:59], a[216:219], v[196:199], a[56:59]
    s_mov_b32 exec_lo, 0x00ff00ff
    s_mov_b32 exec_hi, 0x00ff00ff
    buffer_load_dwordx4 a[252:255], v22, s[88:91], s40 offen offset:192
    s_mov_b64 exec, -1
    v_exp_f32 v146, v146
    v_mfma_f32_16x16x32_bf16 a[56:59], a[220:223], v[200:203], a[56:59]
    v_cvt_pk_bf16_f32 v238, v144, v145
    v_mfma_f32_16x16x32_bf16 a[60:63], a[220:223], v[208:211], a[60:63]
    v_exp_f32 v147, v147
    v_mfma_f32_16x16x32_bf16 a[60:63], a[216:219], v[204:207], a[60:63]
    buffer_load_dwordx4 v18, s[12:15], s29 offen offset:1024 lds
    v_smfmac_f32_16x16x64_bf16 a[228:231], v[244:247], v[188:195], v248
    s_waitcnt lgkmcnt(6)
    s_mov_b32 exec_lo, 0x00ff00ff
    s_mov_b32 exec_hi, 0x00ff00ff
    buffer_load_dwordx4 v[252:255], v22, s[88:91], s40 offen offset:256
    s_mov_b64 exec, -1
    v_mfma_f32_16x16x32_bf16 v[140:143], a[144:147], v[68:71], v[108:111]
    v_exp_f32 v148, v148
    v_mfma_f32_16x16x32_bf16 v[140:143], a[148:151], v[72:75], v[140:143]
    ds_read_b64_tr_b16 a[208:209], v11 offset:57344
    v_cvt_pk_bf16_f32 v239, v146, v147
    v_mfma_f32_16x16x32_bf16 v[140:143], a[152:155], v[76:79], v[140:143]
    v_exp_f32 v149, v149
    v_lshrrev_b32 v22, 4, v19
    v_mfma_f32_16x16x32_bf16 v[140:143], a[156:159], v[80:83], v[140:143]
    ds_read_b64_tr_b16 a[210:211], v11 offset:61440
    v_bfe_u32 v24, v19, 2, 2
    v_mfma_f32_16x16x32_bf16 v[144:147], a[156:159], v[96:99], v[112:115]
    v_exp_f32 v150, v150
    v_mfma_f32_16x16x32_bf16 v[144:147], a[152:155], v[92:95], v[144:147]
    ds_read_b128 a[176:179], v1 offset:61440
    v_cvt_pk_bf16_f32 v216, v148, v149
    v_mfma_f32_16x16x32_bf16 v[144:147], a[148:151], v[88:91], v[144:147]
    v_exp_f32 v151, v151
    v_lshl_add_u32 v22, v22, 3, v24
    v_mfma_f32_16x16x32_bf16 v[144:147], a[144:147], v[84:87], v[144:147]
    ds_read_b64_tr_b16 a[212:213], v11 offset:0
    v_and_b32 v24, 1, v19
    v_mfma_f32_16x16x32_bf16 a[64:67], a[192:195], v[180:183], a[64:67]
    v_exp_f32 v152, v152
    v_mfma_f32_16x16x32_bf16 a[64:67], a[196:199], v[184:187], a[64:67]
    ds_read_b64_tr_b16 a[214:215], v11 offset:4096
    v_cvt_pk_bf16_f32 v217, v150, v151
    v_mfma_f32_16x16x32_bf16 a[68:71], a[196:199], v[192:195], a[68:71]
    v_exp_f32 v153, v153
    v_mfma_f32_16x16x32_bf16 a[68:71], a[192:195], v[188:191], a[68:71]
    ds_read_b128 a[180:183], v2 offset:61440
    v_cvt_pk_bf16_f32 v224, v152, v153
    v_lshl_add_u32 v22, v22, 1, v24
    v_mfma_f32_16x16x32_bf16 a[72:75], a[192:195], v[196:199], a[72:75]
    v_exp_f32 v154, v154
    v_mfma_f32_16x16x32_bf16 a[72:75], a[196:199], v[200:203], a[72:75]
    buffer_load_dwordx4 v17, s[12:15], s29 offen offset:2048 lds
    v_bfe_u32 v24, v19, 1, 1
    v_mfma_f32_16x16x32_bf16 a[76:79], a[196:199], v[208:211], a[76:79]
    v_exp_f32 v155, v155
    v_mfma_f32_16x16x32_bf16 a[76:79], a[192:195], v[204:207], a[76:79]
    s_waitcnt lgkmcnt(6)
    v_mul_u32_u24 v24, 10240, v24
    v_lshl_add_u32 v22, v22, 3, v24
    v_mfma_f32_16x16x32_bf16 v[148:151], a[160:163], v[36:39], v[100:103]
    s_mul_i32 s42, s5, 2560
    v_exp_f32 v156, v156
    v_mfma_f32_16x16x32_bf16 v[148:151], a[164:167], v[40:43], v[148:151]
    s_add_u32 s42, s42, 65536
    ds_read_b64_tr_b16 a[216:217], v12 offset:57344
    v_cvt_pk_bf16_f32 v225, v154, v155
    v_mfma_f32_16x16x32_bf16 v[148:151], a[168:171], v[44:47], v[148:151]
    v_exp_f32 v157, v157
    v_mfma_f32_16x16x32_bf16 v[148:151], a[172:175], v[48:51], v[148:151]
    ds_read_b64_tr_b16 a[218:219], v12 offset:61440
    v_add_u32 v22, s42, v22
    v_mfma_f32_16x16x32_bf16 v[152:155], a[172:175], v[64:67], v[104:107]
    s_mov_b32 s42, 65536
    v_exp_f32 v158, v158
    v_mfma_f32_16x16x32_bf16 v[152:155], a[168:171], v[60:63], v[152:155]
    ds_read_b128 a[184:187], v3 offset:61440
    v_cvt_pk_bf16_f32 v232, v156, v157
    v_mfma_f32_16x16x32_bf16 v[152:155], a[164:167], v[56:59], v[152:155]
    v_exp_f32 v159, v159
    v_mfma_f32_16x16x32_bf16 v[152:155], a[160:163], v[52:55], v[152:155]
    ds_read_b64_tr_b16 a[220:221], v12 offset:0
    v_lshl_add_u32 v23, v19, 4, s42
    v_mfma_f32_16x16x32_bf16 a[80:83], a[200:203], v[180:183], a[80:83]
    v_exp_f32 v160, v160
    v_mfma_f32_16x16x32_bf16 a[80:83], a[204:207], v[184:187], a[80:83]
    ds_read_b64_tr_b16 a[222:223], v12 offset:4096
    v_cvt_pk_bf16_f32 v233, v158, v159
    v_mfma_f32_16x16x32_bf16 a[84:87], a[204:207], v[192:195], a[84:87]
    v_exp_f32 v161, v161
    v_mfma_f32_16x16x32_bf16 a[84:87], a[200:203], v[188:191], a[84:87]
    ds_read_b128 a[188:191], v4 offset:61440
    v_readlane_b32 s50, v249, 0
    v_mfma_f32_16x16x32_bf16 a[88:91], a[200:203], v[196:199], a[88:91]
    v_exp_f32 v162, v162
    v_mfma_f32_16x16x32_bf16 a[88:91], a[204:207], v[200:203], a[88:91]
    v_cvt_pk_bf16_f32 v240, v160, v161
    v_readlane_b32 s51, v249, 1
    v_mfma_f32_16x16x32_bf16 a[92:95], a[204:207], v[208:211], a[92:95]
    v_exp_f32 v163, v163
    v_mfma_f32_16x16x32_bf16 a[92:95], a[200:203], v[204:207], a[92:95]
    buffer_load_dwordx4 v18, s[12:15], s29 offen offset:3072 lds
    v_smfmac_f32_16x16x64_bf16 a[232:235], v[244:247], v[196:203], v248
    s_waitcnt vmcnt(15) lgkmcnt(6)
    s_barrier
    s_add_u32 s29, s29, 16384
    v_readlane_b32 s52, v249, 2
    v_mfma_f32_16x16x32_bf16 v[156:159], a[160:163], v[68:71], v[108:111]
    v_exp_f32 v164, v164
    v_mfma_f32_16x16x32_bf16 v[156:159], a[164:167], v[72:75], v[156:159]
    ds_read_b64_tr_b16 a[192:193], v5 offset:24576
    v_cvt_pk_bf16_f32 v241, v162, v163
    v_mfma_f32_16x16x32_bf16 v[156:159], a[168:171], v[76:79], v[156:159]
    v_exp_f32 v165, v165
    v_mfma_f32_16x16x32_bf16 v[156:159], a[172:175], v[80:83], v[156:159]
    ds_read_b64_tr_b16 a[194:195], v5 offset:28672
    v_readlane_b32 s53, v249, 3
    v_mfma_f32_16x16x32_bf16 v[160:163], a[172:175], v[96:99], v[112:115]
    v_exp_f32 v166, v166
    v_mfma_f32_16x16x32_bf16 v[160:163], a[168:171], v[92:95], v[160:163]
    ds_read_b128 a[128:131], v1 offset:16384
    v_cvt_pk_bf16_f32 v218, v164, v165
    v_mfma_f32_16x16x32_bf16 v[160:163], a[164:167], v[88:91], v[160:163]
    v_exp_f32 v167, v167
    v_mfma_f32_16x16x32_bf16 v[160:163], a[160:163], v[84:87], v[160:163]
    ds_read_b64_tr_b16 a[196:197], v5 offset:49152
    v_readlane_b32 s54, v249, 4
    v_mfma_f32_16x16x32_bf16 a[96:99], a[208:211], v[180:183], a[96:99]
    v_exp_f32 v168, v168
    v_mfma_f32_16x16x32_bf16 a[96:99], a[212:215], v[184:187], a[96:99]
    ds_read_b64_tr_b16 a[198:199], v5 offset:53248
    v_cvt_pk_bf16_f32 v219, v166, v167
    v_mfma_f32_16x16x32_bf16 a[100:103], a[212:215], v[192:195], a[100:103]
    v_exp_f32 v169, v169
    v_mfma_f32_16x16x32_bf16 a[100:103], a[208:211], v[188:191], a[100:103]
    ds_read_b128 a[132:135], v2 offset:16384
    v_cvt_pk_bf16_f32 v226, v168, v169
    v_readlane_b32 s55, v249, 5
    v_mfma_f32_16x16x32_bf16 a[104:107], a[208:211], v[196:199], a[104:107]
    s_add_u32 m0, s34, 0
    v_exp_f32 v170, v170
    v_mfma_f32_16x16x32_bf16 a[104:107], a[212:215], v[200:203], a[104:107]
    buffer_load_dwordx4 v13, s[8:11], s28 offen offset:0 lds
    v_readlane_b32 s56, v249, 6
    v_mfma_f32_16x16x32_bf16 a[108:111], a[212:215], v[208:211], a[108:111]
    v_exp_f32 v171, v171
    v_mfma_f32_16x16x32_bf16 a[108:111], a[208:211], v[204:207], a[108:111]
    s_waitcnt lgkmcnt(6)
    v_readlane_b32 s57, v249, 7
    v_mfma_f32_16x16x32_bf16 v[164:167], a[176:179], v[36:39], v[100:103]
    v_exp_f32 v172, v172
    v_mfma_f32_16x16x32_bf16 v[164:167], a[180:183], v[40:43], v[164:167]
    ds_read_b64_tr_b16 a[200:201], v6 offset:24576
    v_cvt_pk_bf16_f32 v227, v170, v171
    v_mfma_f32_16x16x32_bf16 v[164:167], a[184:187], v[44:47], v[164:167]
    v_exp_f32 v173, v173
    v_mfma_f32_16x16x32_bf16 v[164:167], a[188:191], v[48:51], v[164:167]
    ds_read_b64_tr_b16 a[202:203], v6 offset:28672
    v_mfma_f32_16x16x32_bf16 v[168:171], a[188:191], v[64:67], v[104:107]
    v_exp_f32 v174, v174
    v_mfma_f32_16x16x32_bf16 v[168:171], a[184:187], v[60:63], v[168:171]
    ds_read_b128 a[136:139], v3 offset:16384
    v_cvt_pk_bf16_f32 v234, v172, v173
    v_mfma_f32_16x16x32_bf16 v[168:171], a[180:183], v[56:59], v[168:171]
    v_exp_f32 v175, v175
    v_mfma_f32_16x16x32_bf16 v[168:171], a[176:179], v[52:55], v[168:171]
    ds_read_b64_tr_b16 a[204:205], v6 offset:49152
    ds_read_b64_tr_b16 v[24:25], v22 offset:0
    v_mfma_f32_16x16x32_bf16 a[112:115], a[216:219], v[180:183], a[112:115]
    v_exp_f32 v176, v176
    v_mfma_f32_16x16x32_bf16 a[112:115], a[220:223], v[184:187], a[112:115]
    ds_read_b64_tr_b16 a[206:207], v6 offset:53248
    v_cvt_pk_bf16_f32 v235, v174, v175
    v_mfma_f32_16x16x32_bf16 a[116:119], a[220:223], v[192:195], a[116:119]
    v_exp_f32 v177, v177
    v_mfma_f32_16x16x32_bf16 a[116:119], a[216:219], v[188:191], a[116:119]
    ds_read_b128 a[140:143], v4 offset:16384
    ds_read_b64_tr_b16 v[26:27], v22 offset:64
    v_mfma_f32_16x16x32_bf16 a[120:123], a[216:219], v[196:199], a[120:123]
    v_exp_f32 v178, v178
    v_mfma_f32_16x16x32_bf16 a[120:123], a[220:223], v[200:203], a[120:123]
    ds_read_b64_tr_b16 v[28:29], v22 offset:512
    v_cvt_pk_bf16_f32 v242, v176, v177
    v_mfma_f32_16x16x32_bf16 a[124:127], a[220:223], v[208:211], a[124:127]
    v_exp_f32 v179, v179
    v_mfma_f32_16x16x32_bf16 a[124:127], a[216:219], v[204:207], a[124:127]
    buffer_load_dwordx4 v14, s[8:11], s28 offen offset:1024 lds
    v_smfmac_f32_16x16x64_bf16 a[236:239], v[244:247], v[204:211], v248
    s_waitcnt lgkmcnt(6)
    ds_read_b64_tr_b16 v[30:31], v22 offset:576
    v_mfma_f32_16x16x32_bf16 v[172:175], a[176:179], v[68:71], v[108:111]
    v_exp_f32 v116, v116
    v_mfma_f32_16x16x32_bf16 v[172:175], a[180:183], v[72:75], v[172:175]
    ds_read_b64_tr_b16 a[208:209], v7 offset:24576
    v_cvt_pk_bf16_f32 v243, v178, v179
    v_mfma_f32_16x16x32_bf16 v[172:175], a[184:187], v[76:79], v[172:175]
    v_exp_f32 v117, v117
    v_mfma_f32_16x16x32_bf16 v[172:175], a[188:191], v[80:83], v[172:175]
    ds_read_b64_tr_b16 a[210:211], v7 offset:28672
    v_mfma_f32_16x16x32_bf16 v[176:179], a[188:191], v[96:99], v[112:115]
    v_exp_f32 v118, v118
    v_mfma_f32_16x16x32_bf16 v[176:179], a[184:187], v[92:95], v[176:179]
    ds_read_b128 a[144:147], v1 offset:20480
    v_cvt_pk_bf16_f32 v180, v116, v117
    v_mfma_f32_16x16x32_bf16 v[176:179], a[180:183], v[88:91], v[176:179]
    v_exp_f32 v119, v119
    v_mfma_f32_16x16x32_bf16 v[176:179], a[176:179], v[84:87], v[176:179]
    ds_read_b64_tr_b16 a[212:213], v7 offset:49152
    v_mfma_f32_16x16x32_bf16 a[0:3], a[192:195], v[212:215], a[0:3]
    v_exp_f32 v120, v120
    v_mfma_f32_16x16x32_bf16 a[0:3], a[196:199], v[216:219], a[0:3]
    ds_read_b64_tr_b16 a[214:215], v7 offset:53248
    v_cvt_pk_bf16_f32 v181, v118, v119
    v_mfma_f32_16x16x32_bf16 a[4:7], a[196:199], v[224:227], a[4:7]
    v_exp_f32 v121, v121
    v_mfma_f32_16x16x32_bf16 a[4:7], a[192:195], v[220:223], a[4:7]
    ds_read_b128 a[148:151], v2 offset:20480
    v_cvt_pk_bf16_f32 v188, v120, v121
    v_mfma_f32_16x16x32_bf16 a[8:11], a[192:195], v[228:231], a[8:11]
    v_exp_f32 v122, v122
    v_mfma_f32_16x16x32_bf16 a[8:11], a[196:199], v[232:235], a[8:11]
    buffer_load_dwordx4 v15, s[8:11], s28 offen offset:2048 lds
    v_mfma_f32_16x16x32_bf16 a[12:15], a[196:199], v[240:243], a[12:15]
    v_exp_f32 v123, v123
    v_mfma_f32_16x16x32_bf16 a[12:15], a[192:195], v[236:239], a[12:15]
    s_waitcnt lgkmcnt(6)
    v_mfma_f32_16x16x32_bf16 v[116:119], a[128:131], v[36:39], v[100:103]
    s_waitcnt vmcnt(5)
    v_exp_f32 v124, v124
    v_mfma_f32_16x16x32_bf16 v[32:35], v[24:27], a[240:243], 0
    v_mfma_f32_16x16x32_bf16 v[32:35], v[28:31], a[244:247], v[32:35]
    ds_read_b64_tr_b16 v[24:25], v22 offset:1024
    v_mfma_f32_16x16x32_bf16 v[116:119], a[132:135], v[40:43], v[116:119]
    ds_read_b64_tr_b16 a[216:217], v8 offset:24576
    v_cvt_pk_bf16_f32 v189, v122, v123
    v_mfma_f32_16x16x32_bf16 v[116:119], a[136:139], v[44:47], v[116:119]
    v_exp_f32 v125, v125
    v_mfma_f32_16x16x32_bf16 v[116:119], a[140:143], v[48:51], v[116:119]
    ds_read_b64_tr_b16 a[218:219], v8 offset:28672
    v_mfma_f32_16x16x32_bf16 v[120:123], a[140:143], v[64:67], v[104:107]
    v_exp_f32 v126, v126
    v_mfma_f32_16x16x32_bf16 v[120:123], a[136:139], v[60:63], v[120:123]
    ds_read_b128 a[152:155], v3 offset:20480
    v_cvt_pk_bf16_f32 v196, v124, v125
    v_mfma_f32_16x16x32_bf16 v[120:123], a[132:135], v[56:59], v[120:123]
    v_exp_f32 v127, v127
    v_mfma_f32_16x16x32_bf16 v[120:123], a[128:131], v[52:55], v[120:123]
    ds_read_b64_tr_b16 a[220:221], v8 offset:49152
    v_mfma_f32_16x16x32_bf16 a[16:19], a[200:203], v[212:215], a[16:19]
    v_exp_f32 v128, v128
    v_mfma_f32_16x16x32_bf16 a[16:19], a[204:207], v[216:219], a[16:19]
    ds_read_b64_tr_b16 a[222:223], v8 offset:53248
    v_cvt_pk_bf16_f32 v197, v126, v127
    v_mfma_f32_16x16x32_bf16 a[20:23], a[204:207], v[224:227], a[20:23]
    v_exp_f32 v129, v129
    v_mfma_f32_16x16x32_bf16 a[20:23], a[200:203], v[220:223], a[20:23]
    ds_read_b128 a[156:159], v4 offset:20480
    v_mfma_f32_16x16x32_bf16 a[24:27], a[200:203], v[228:231], a[24:27]
    v_exp_f32 v130, v130
    v_mfma_f32_16x16x32_bf16 a[24:27], a[204:207], v[232:235], a[24:27]
    ds_read_b64_tr_b16 v[26:27], v22 offset:1088
    v_cvt_pk_bf16_f32 v204, v128, v129
    v_mfma_f32_16x16x32_bf16 a[28:31], a[204:207], v[240:243], a[28:31]
    v_exp_f32 v131, v131
    v_mfma_f32_16x16x32_bf16 a[28:31], a[200:203], v[236:239], a[28:31]
    buffer_load_dwordx4 v16, s[8:11], s28 offen offset:3072 lds
    v_smfmac_f32_16x16x64_bf16 a[224:227], v[244:247], v[212:219], v248
    s_waitcnt lgkmcnt(6)
    ds_read_b64_tr_b16 v[28:29], v22 offset:1536
    ds_read_b64_tr_b16 v[30:31], v22 offset:1600
    v_mfma_f32_16x16x32_bf16 v[124:127], a[128:131], v[68:71], v[108:111]
    s_mul_i32 s40, s5, 2560
    v_exp_f32 v132, v132
    v_mfma_f32_16x16x32_bf16 v[124:127], a[132:135], v[72:75], v[124:127]
    ds_read_b64_tr_b16 a[192:193], v9 offset:24576
    v_cvt_pk_bf16_f32 v205, v130, v131
    v_mfma_f32_16x16x32_bf16 v[124:127], a[136:139], v[76:79], v[124:127]
    v_exp_f32 v133, v133
    v_add_u32 v0, s40, v23
    v_mfma_f32_16x16x32_bf16 v[124:127], a[140:143], v[80:83], v[124:127]
    ds_read_b64_tr_b16 a[194:195], v9 offset:28672
    v_mfma_f32_16x16x32_bf16 v[128:131], a[140:143], v[96:99], v[112:115]
    v_exp_f32 v134, v134
    v_mfma_f32_16x16x32_bf16 v[128:131], a[136:139], v[92:95], v[128:131]
    ds_read_b128 a[160:163], v1 offset:24576
    v_cvt_pk_bf16_f32 v182, v132, v133
    v_mfma_f32_16x16x32_bf16 v[128:131], a[132:135], v[88:91], v[128:131]
    v_exp_f32 v135, v135
    v_mfma_f32_16x16x32_bf16 v[128:131], a[128:131], v[84:87], v[128:131]
    ds_read_b64_tr_b16 a[196:197], v9 offset:49152
    v_mfma_f32_16x16x32_bf16 a[32:35], a[208:211], v[212:215], a[32:35]
    v_exp_f32 v136, v136
    v_mfma_f32_16x16x32_bf16 a[32:35], a[212:215], v[216:219], a[32:35]
    s_waitcnt lgkmcnt(4)
    ds_read_b64_tr_b16 a[198:199], v9 offset:53248
    v_cvt_pk_bf16_f32 v183, v134, v135
    v_mfma_f32_16x16x32_bf16 v[32:35], v[24:27], a[248:251], v[32:35]
    v_mfma_f32_16x16x32_bf16 v[32:35], v[28:31], a[252:255], v[32:35]
    ds_read_b64_tr_b16 v[24:25], v22 offset:2048
    v_mfma_f32_16x16x32_bf16 a[36:39], a[212:215], v[224:227], a[36:39]
    v_exp_f32 v137, v137
    v_mfma_f32_16x16x32_bf16 a[36:39], a[208:211], v[220:223], a[36:39]
    ds_read_b128 a[164:167], v2 offset:24576
    v_cvt_pk_bf16_f32 v190, v136, v137
    v_mfma_f32_16x16x32_bf16 a[40:43], a[208:211], v[228:231], a[40:43]
    s_add_u32 s28, s28, 16384
    s_mov_b32 m0, s31
    v_exp_f32 v138, v138
    v_mfma_f32_16x16x32_bf16 a[40:43], a[212:215], v[232:235], a[40:43]
    buffer_load_dwordx4 v17, s[12:15], s29 offen offset:0 lds
    v_mfma_f32_16x16x32_bf16 a[44:47], a[212:215], v[240:243], a[44:47]
    v_exp_f32 v139, v139
    v_mfma_f32_16x16x32_bf16 a[44:47], a[208:211], v[236:239], a[44:47]
    s_waitcnt lgkmcnt(6)
    ds_read_b64_tr_b16 v[26:27], v22 offset:2112
    v_mfma_f32_16x16x32_bf16 v[132:135], a[144:147], v[36:39], v[100:103]
    v_exp_f32 v140, v140
    v_mfma_f32_16x16x32_bf16 v[132:135], a[148:151], v[40:43], v[132:135]
    ds_read_b64_tr_b16 a[200:201], v10 offset:24576
    v_cvt_pk_bf16_f32 v191, v138, v139
    v_mfma_f32_16x16x32_bf16 v[132:135], a[152:155], v[44:47], v[132:135]
    v_exp_f32 v141, v141
    v_mfma_f32_16x16x32_bf16 v[132:135], a[156:159], v[48:51], v[132:135]
    ds_read_b64_tr_b16 a[202:203], v10 offset:28672
    v_mfma_f32_16x16x32_bf16 v[136:139], a[156:159], v[64:67], v[104:107]
    v_exp_f32 v142, v142
    v_mfma_f32_16x16x32_bf16 v[136:139], a[152:155], v[60:63], v[136:139]
    ds_read_b128 a[168:171], v3 offset:24576
    v_cvt_pk_bf16_f32 v198, v140, v141
    v_mfma_f32_16x16x32_bf16 v[136:139], a[148:151], v[56:59], v[136:139]
    v_exp_f32 v143, v143
    v_mfma_f32_16x16x32_bf16 v[136:139], a[144:147], v[52:55], v[136:139]
    ds_read_b64_tr_b16 a[204:205], v10 offset:49152
    v_mfma_f32_16x16x32_bf16 a[48:51], a[216:219], v[212:215], a[48:51]
    s_waitcnt lgkmcnt(4)
    v_exp_f32 v144, v144
    v_mfma_f32_16x16x32_bf16 v[32:35], v[24:27], v[252:255], v[32:35]
    v_mfma_f32_16x16x32_bf16 a[48:51], a[220:223], v[216:219], a[48:51]
    ds_read_b64_tr_b16 a[206:207], v10 offset:53248
    v_cvt_pk_bf16_f32 v199, v142, v143
    v_mfma_f32_16x16x32_bf16 a[52:55], a[220:223], v[224:227], a[52:55]
    v_exp_f32 v145, v145
    v_mfma_f32_16x16x32_bf16 a[52:55], a[216:219], v[220:223], a[52:55]
    ds_read_b128 a[172:175], v4 offset:24576
    v_mfma_f32_16x16x32_bf16 a[56:59], a[216:219], v[228:231], a[56:59]
    v_exp_f32 v146, v146
    v_mfma_f32_16x16x32_bf16 a[56:59], a[220:223], v[232:235], a[56:59]
    v_cvt_pk_bf16_f32 v206, v144, v145
    v_mfma_f32_16x16x32_bf16 a[60:63], a[220:223], v[240:243], a[60:63]
    v_exp_f32 v147, v147
    v_mfma_f32_16x16x32_bf16 a[60:63], a[216:219], v[236:239], a[60:63]
    buffer_load_dwordx4 v18, s[12:15], s29 offen offset:1024 lds
    v_smfmac_f32_16x16x64_bf16 a[228:231], v[244:247], v[220:227], v248
    s_waitcnt lgkmcnt(6)
    v_mfma_f32_16x16x32_bf16 v[140:143], a[144:147], v[68:71], v[108:111]
    v_exp_f32 v148, v148
    v_mfma_f32_16x16x32_bf16 v[140:143], a[148:151], v[72:75], v[140:143]
    ds_read_b64_tr_b16 a[208:209], v11 offset:24576
    v_cvt_pk_bf16_f32 v207, v146, v147
    v_mfma_f32_16x16x32_bf16 v[140:143], a[152:155], v[76:79], v[140:143]
    v_exp_f32 v149, v149
    v_mfma_f32_16x16x32_bf16 v[140:143], a[156:159], v[80:83], v[140:143]
    ds_read_b64_tr_b16 a[210:211], v11 offset:28672
    v_mfma_f32_16x16x32_bf16 v[144:147], a[156:159], v[96:99], v[112:115]
    v_exp_f32 v150, v150
    v_mfma_f32_16x16x32_bf16 v[144:147], a[152:155], v[92:95], v[144:147]
    ds_read_b128 a[176:179], v1 offset:28672
    v_cvt_pk_bf16_f32 v184, v148, v149
    v_mfma_f32_16x16x32_bf16 v[144:147], a[148:151], v[88:91], v[144:147]
    v_exp_f32 v151, v151
    v_mfma_f32_16x16x32_bf16 v[144:147], a[144:147], v[84:87], v[144:147]
    ds_read_b64_tr_b16 a[212:213], v11 offset:49152
    ds_write_b128 v0, v[32:35]
    v_bfe_u32 v22, v19, 2, 3
    v_mfma_f32_16x16x32_bf16 a[64:67], a[192:195], v[212:215], a[64:67]
    v_exp_f32 v152, v152
    v_mul_u32_u24 v22, 160, v22
    v_mfma_f32_16x16x32_bf16 a[64:67], a[196:199], v[216:219], a[64:67]
    ds_read_b64_tr_b16 a[214:215], v11 offset:53248
    v_cvt_pk_bf16_f32 v185, v150, v151
    v_mfma_f32_16x16x32_bf16 a[68:71], a[196:199], v[224:227], a[68:71]
    v_exp_f32 v153, v153
    v_and_b32 v28, 3, v19
    v_mfma_f32_16x16x32_bf16 a[68:71], a[192:195], v[220:223], a[68:71]
    ds_read_b128 a[180:183], v2 offset:28672
    v_cvt_pk_bf16_f32 v192, v152, v153
    v_add_u32 v22, v22, v28
    v_mfma_f32_16x16x32_bf16 a[72:75], a[192:195], v[228:231], a[72:75]
    s_mul_i32 s42, s5, 320
    v_exp_f32 v154, v154
    v_mfma_f32_16x16x32_bf16 a[72:75], a[196:199], v[232:235], a[72:75]
    s_add_u32 s42, s42, 86016
    buffer_load_dwordx4 v17, s[12:15], s29 offen offset:2048 lds
    v_mfma_f32_16x16x32_bf16 a[76:79], a[196:199], v[240:243], a[76:79]
    v_exp_f32 v155, v155
    v_mfma_f32_16x16x32_bf16 a[76:79], a[192:195], v[236:239], a[76:79]
    s_waitcnt lgkmcnt(6)
    v_lshl_add_u32 v22, v22, 3, s42
    v_mfma_f32_16x16x32_bf16 v[148:151], a[160:163], v[36:39], v[100:103]
    v_exp_f32 v156, v156
    v_mfma_f32_16x16x32_bf16 v[148:151], a[164:167], v[40:43], v[148:151]
    ds_read_b64_tr_b16 a[216:217], v12 offset:24576
    v_cvt_pk_bf16_f32 v193, v154, v155
    v_mfma_f32_16x16x32_bf16 v[148:151], a[168:171], v[44:47], v[148:151]
    v_exp_f32 v157, v157
    v_mfma_f32_16x16x32_bf16 v[148:151], a[172:175], v[48:51], v[148:151]
    ds_read_b64_tr_b16 a[218:219], v12 offset:28672
    v_mfma_f32_16x16x32_bf16 v[152:155], a[172:175], v[64:67], v[104:107]
    v_exp_f32 v158, v158
    v_mfma_f32_16x16x32_bf16 v[152:155], a[168:171], v[60:63], v[152:155]
    ds_read_b128 a[184:187], v3 offset:28672
    v_cvt_pk_bf16_f32 v200, v156, v157
    v_mfma_f32_16x16x32_bf16 v[152:155], a[164:167], v[56:59], v[152:155]
    v_exp_f32 v159, v159
    v_mfma_f32_16x16x32_bf16 v[152:155], a[160:163], v[52:55], v[152:155]
    ds_read_b64_tr_b16 a[220:221], v12 offset:49152
    v_mfma_f32_16x16x32_bf16 a[80:83], a[200:203], v[212:215], a[80:83]
    v_exp_f32 v160, v160
    v_mfma_f32_16x16x32_bf16 a[80:83], a[204:207], v[216:219], a[80:83]
    ds_read_b64_tr_b16 a[222:223], v12 offset:53248
    v_cvt_pk_bf16_f32 v201, v158, v159
    v_mfma_f32_16x16x32_bf16 a[84:87], a[204:207], v[224:227], a[84:87]
    v_exp_f32 v161, v161
    v_mfma_f32_16x16x32_bf16 a[84:87], a[200:203], v[220:223], a[84:87]
    ds_read_b128 a[188:191], v4 offset:28672
    v_mfma_f32_16x16x32_bf16 a[88:91], a[200:203], v[228:231], a[88:91]
    v_exp_f32 v162, v162
    v_mfma_f32_16x16x32_bf16 a[88:91], a[204:207], v[232:235], a[88:91]
    v_cvt_pk_bf16_f32 v208, v160, v161
    v_mfma_f32_16x16x32_bf16 a[92:95], a[204:207], v[240:243], a[92:95]
    v_exp_f32 v163, v163
    v_mfma_f32_16x16x32_bf16 a[92:95], a[200:203], v[236:239], a[92:95]
    buffer_load_dwordx4 v18, s[12:15], s29 offen offset:3072 lds
    v_smfmac_f32_16x16x64_bf16 a[232:235], v[244:247], v[228:235], v248
    s_waitcnt vmcnt(8) lgkmcnt(6)
    s_barrier
    s_add_u32 s29, s29, 16384
    v_mfma_f32_16x16x32_bf16 v[156:159], a[160:163], v[68:71], v[108:111]
    v_exp_f32 v164, v164
    v_mfma_f32_16x16x32_bf16 v[156:159], a[164:167], v[72:75], v[156:159]
    ds_read_b64_tr_b16 a[192:193], v5 offset:8192
    v_cvt_pk_bf16_f32 v209, v162, v163
    v_mfma_f32_16x16x32_bf16 v[156:159], a[168:171], v[76:79], v[156:159]
    v_exp_f32 v165, v165
    v_mfma_f32_16x16x32_bf16 v[156:159], a[172:175], v[80:83], v[156:159]
    ds_read_b64_tr_b16 a[194:195], v5 offset:12288
    ds_read_b128 v[24:27], v23 offset:0
    v_mfma_f32_16x16x32_bf16 v[160:163], a[172:175], v[96:99], v[112:115]
    v_exp_f32 v166, v166
    v_mfma_f32_16x16x32_bf16 v[160:163], a[168:171], v[92:95], v[160:163]
    ds_read_b128 a[128:131], v1 offset:32768
    v_cvt_pk_bf16_f32 v186, v164, v165
    v_mfma_f32_16x16x32_bf16 v[160:163], a[164:167], v[88:91], v[160:163]
    v_exp_f32 v167, v167
    v_mfma_f32_16x16x32_bf16 v[160:163], a[160:163], v[84:87], v[160:163]
    ds_read_b64_tr_b16 a[196:197], v5 offset:32768
    ds_read_b128 v[28:31], v23 offset:2560
    v_mfma_f32_16x16x32_bf16 a[96:99], a[208:211], v[212:215], a[96:99]
    v_exp_f32 v168, v168
    v_mfma_f32_16x16x32_bf16 a[96:99], a[212:215], v[216:219], a[96:99]
    ds_read_b64_tr_b16 a[198:199], v5 offset:36864
    v_cvt_pk_bf16_f32 v187, v166, v167
    v_mfma_f32_16x16x32_bf16 a[100:103], a[212:215], v[224:227], a[100:103]
    v_exp_f32 v169, v169
    v_mfma_f32_16x16x32_bf16 a[100:103], a[208:211], v[220:223], a[100:103]
    ds_read_b128 a[132:135], v2 offset:32768
    v_cvt_pk_bf16_f32 v194, v168, v169
    v_mfma_f32_16x16x32_bf16 a[104:107], a[208:211], v[228:231], a[104:107]
    s_mov_b32 m0, s32
    v_exp_f32 v170, v170
    v_mfma_f32_16x16x32_bf16 a[104:107], a[212:215], v[232:235], a[104:107]
    buffer_load_dwordx4 v17, s[12:15], s29 offen offset:0 lds
    v_mfma_f32_16x16x32_bf16 a[108:111], a[212:215], v[240:243], a[108:111]
    v_exp_f32 v171, v171
    v_mfma_f32_16x16x32_bf16 a[108:111], a[208:211], v[236:239], a[108:111]
    s_waitcnt lgkmcnt(6)
    ds_read_b128 v[32:35], v23 offset:5120
    ds_read_b128 v[252:255], v23 offset:7680
    v_mfma_f32_16x16x32_bf16 v[164:167], a[176:179], v[36:39], v[100:103]
    v_exp_f32 v172, v172
    v_mfma_f32_16x16x32_bf16 v[164:167], a[180:183], v[40:43], v[164:167]
    ds_read_b64_tr_b16 a[200:201], v6 offset:8192
    v_cvt_pk_bf16_f32 v195, v170, v171
    v_mfma_f32_16x16x32_bf16 v[164:167], a[184:187], v[44:47], v[164:167]
    v_exp_f32 v173, v173
    v_mfma_f32_16x16x32_bf16 v[164:167], a[188:191], v[48:51], v[164:167]
    ds_read_b64_tr_b16 a[202:203], v6 offset:12288
    v_mfma_f32_16x16x32_bf16 v[168:171], a[188:191], v[64:67], v[104:107]
    v_exp_f32 v174, v174
    v_mfma_f32_16x16x32_bf16 v[168:171], a[184:187], v[60:63], v[168:171]
    ds_read_b128 a[136:139], v3 offset:32768
    v_cvt_pk_bf16_f32 v202, v172, v173
    v_mfma_f32_16x16x32_bf16 v[168:171], a[180:183], v[56:59], v[168:171]
    v_exp_f32 v175, v175
    v_mfma_f32_16x16x32_bf16 v[168:171], a[176:179], v[52:55], v[168:171]
    ds_read_b64_tr_b16 a[204:205], v6 offset:32768
    ds_read_b64_tr_b16 a[240:241], v22 offset:0
    v_mfma_f32_16x16x32_bf16 a[112:115], a[216:219], v[212:215], a[112:115]
    v_exp_f32 v176, v176
    v_mfma_f32_16x16x32_bf16 a[112:115], a[220:223], v[216:219], a[112:115]
    ds_read_b64_tr_b16 a[206:207], v6 offset:36864
    v_cvt_pk_bf16_f32 v203, v174, v175
    v_mfma_f32_16x16x32_bf16 a[116:119], a[220:223], v[224:227], a[116:119]
    v_exp_f32 v177, v177
    v_mfma_f32_16x16x32_bf16 a[116:119], a[216:219], v[220:223], a[116:119]
    ds_read_b128 a[140:143], v4 offset:32768
    ds_read_b64_tr_b16 a[242:243], v22 offset:32
    v_mfma_f32_16x16x32_bf16 a[120:123], a[216:219], v[228:231], a[120:123]
    v_exp_f32 v178, v178
    v_mfma_f32_16x16x32_bf16 a[120:123], a[220:223], v[232:235], a[120:123]
    ds_read_b64_tr_b16 a[244:245], v22 offset:64
    v_cvt_pk_bf16_f32 v210, v176, v177
    v_mfma_f32_16x16x32_bf16 a[124:127], a[220:223], v[240:243], a[124:127]
    v_exp_f32 v179, v179
    v_mfma_f32_16x16x32_bf16 a[124:127], a[216:219], v[236:239], a[124:127]
    buffer_load_dwordx4 v18, s[12:15], s29 offen offset:1024 lds
    v_smfmac_f32_16x16x64_bf16 a[236:239], v[244:247], v[236:243], v248
    s_waitcnt lgkmcnt(6)
    ds_read_b64_tr_b16 a[246:247], v22 offset:96
    v_mfma_f32_16x16x32_bf16 v[172:175], a[176:179], v[68:71], v[108:111]
    v_exp_f32 v116, v116
    v_mfma_f32_16x16x32_bf16 v[172:175], a[180:183], v[72:75], v[172:175]
    ds_read_b64_tr_b16 a[208:209], v7 offset:8192
    v_cvt_pk_bf16_f32 v211, v178, v179
    v_add_f32 v24, v24, v28
    v_mfma_f32_16x16x32_bf16 v[172:175], a[184:187], v[76:79], v[172:175]
    v_exp_f32 v117, v117
    v_add_f32 v25, v25, v29
    v_mfma_f32_16x16x32_bf16 v[172:175], a[188:191], v[80:83], v[172:175]
    ds_read_b64_tr_b16 a[210:211], v7 offset:12288
    v_add_f32 v26, v26, v30
    v_mfma_f32_16x16x32_bf16 v[176:179], a[188:191], v[96:99], v[112:115]
    v_exp_f32 v118, v118
    v_mfma_f32_16x16x32_bf16 v[176:179], a[184:187], v[92:95], v[176:179]
    ds_read_b128 a[144:147], v1 offset:36864
    v_cvt_pk_bf16_f32 v212, v116, v117
    v_add_f32 v27, v27, v31
    v_mfma_f32_16x16x32_bf16 v[176:179], a[180:183], v[88:91], v[176:179]
    v_exp_f32 v119, v119
    v_add_f32 v24, v24, v32
    v_mfma_f32_16x16x32_bf16 v[176:179], a[176:179], v[84:87], v[176:179]
    ds_read_b64_tr_b16 a[212:213], v7 offset:32768
    v_add_f32 v25, v25, v33
    v_mfma_f32_16x16x32_bf16 a[0:3], a[192:195], v[180:183], a[0:3]
    v_exp_f32 v120, v120
    v_mfma_f32_16x16x32_bf16 a[0:3], a[196:199], v[184:187], a[0:3]
    ds_read_b64_tr_b16 a[214:215], v7 offset:36864
    v_cvt_pk_bf16_f32 v213, v118, v119
    v_add_f32 v26, v26, v34
    v_mfma_f32_16x16x32_bf16 a[4:7], a[196:199], v[192:195], a[4:7]
    v_exp_f32 v121, v121
    v_add_f32 v27, v27, v35
    v_mfma_f32_16x16x32_bf16 a[4:7], a[192:195], v[188:191], a[4:7]
    ds_read_b128 a[148:151], v2 offset:36864
    v_cvt_pk_bf16_f32 v220, v120, v121
    v_add_f32 v24, v24, v252
    v_mfma_f32_16x16x32_bf16 a[8:11], a[192:195], v[196:199], a[8:11]
    v_exp_f32 v122, v122
    v_mfma_f32_16x16x32_bf16 a[8:11], a[196:199], v[200:203], a[8:11]
    buffer_load_dwordx4 v17, s[12:15], s29 offen offset:2048 lds
    v_add_f32 v25, v25, v253
    v_mfma_f32_16x16x32_bf16 a[12:15], a[196:199], v[208:211], a[12:15]
    v_exp_f32 v123, v123
    v_add_f32 v26, v26, v254
    v_mfma_f32_16x16x32_bf16 a[12:15], a[192:195], v[204:207], a[12:15]
    s_waitcnt lgkmcnt(6)
    ds_read_b64_tr_b16 a[248:249], v22 offset:128
    v_add_f32 v27, v27, v255
    v_mfma_f32_16x16x32_bf16 v[116:119], a[128:131], v[36:39], v[100:103]
    v_exp_f32 v124, v124
    v_mfma_f32_16x16x32_bf16 v[116:119], a[132:135], v[40:43], v[116:119]
    ds_read_b64_tr_b16 a[216:217], v8 offset:8192
    v_cvt_pk_bf16_f32 v221, v122, v123
    v_mov_b32_dpp v28, v24 row_newbcast:8 row_mask:0xf bank_mask:0xf
    v_mfma_f32_16x16x32_bf16 v[116:119], a[136:139], v[44:47], v[116:119]
    v_exp_f32 v125, v125
    v_mov_b32_dpp v29, v25 row_newbcast:8 row_mask:0xf bank_mask:0xf
    v_mfma_f32_16x16x32_bf16 v[116:119], a[140:143], v[48:51], v[116:119]
    ds_read_b64_tr_b16 a[218:219], v8 offset:12288
    v_mov_b32_dpp v30, v26 row_newbcast:8 row_mask:0xf bank_mask:0xf
    v_mfma_f32_16x16x32_bf16 v[120:123], a[140:143], v[64:67], v[104:107]
    v_exp_f32 v126, v126
    v_mfma_f32_16x16x32_bf16 v[120:123], a[136:139], v[60:63], v[120:123]
    ds_read_b128 a[152:155], v3 offset:36864
    v_cvt_pk_bf16_f32 v228, v124, v125
    v_mov_b32_dpp v31, v27 row_newbcast:8 row_mask:0xf bank_mask:0xf
    v_mfma_f32_16x16x32_bf16 v[120:123], a[132:135], v[56:59], v[120:123]
    v_exp_f32 v127, v127
    v_mfma_f32_16x16x32_bf16 v[120:123], a[128:131], v[52:55], v[120:123]
    ds_read_b64_tr_b16 a[220:221], v8 offset:32768
    v_fma_f32 v24, -v20, v28, v24
    v_mfma_f32_16x16x32_bf16 a[16:19], a[200:203], v[180:183], a[16:19]
    v_exp_f32 v128, v128
    v_fma_f32 v25, -v20, v29, v25
    v_mfma_f32_16x16x32_bf16 a[16:19], a[204:207], v[184:187], a[16:19]
    ds_read_b64_tr_b16 a[222:223], v8 offset:36864
    v_cvt_pk_bf16_f32 v229, v126, v127
    v_fma_f32 v26, -v20, v30, v26
    v_mfma_f32_16x16x32_bf16 a[20:23], a[204:207], v[192:195], a[20:23]
    v_exp_f32 v129, v129
    v_mfma_f32_16x16x32_bf16 a[20:23], a[200:203], v[188:191], a[20:23]
    ds_read_b128 a[156:159], v4 offset:36864
    v_fma_f32 v27, -v20, v31, v27
    v_mfma_f32_16x16x32_bf16 a[24:27], a[200:203], v[196:199], a[24:27]
    v_exp_f32 v130, v130
    v_mul_f32 v24, v24, v21
    v_mfma_f32_16x16x32_bf16 a[24:27], a[204:207], v[200:203], a[24:27]
    v_cvt_pk_bf16_f32 v236, v128, v129
    v_mul_f32 v25, v25, v21
    v_mfma_f32_16x16x32_bf16 a[28:31], a[204:207], v[208:211], a[28:31]
    v_exp_f32 v131, v131
    v_mfma_f32_16x16x32_bf16 a[28:31], a[200:203], v[204:207], a[28:31]
    buffer_load_dwordx4 v18, s[12:15], s29 offen offset:3072 lds
    v_mul_f32 v26, v26, v21
    v_smfmac_f32_16x16x64_bf16 a[224:227], v[244:247], v[180:187], v248
    s_waitcnt lgkmcnt(6)
    s_add_u32 s29, s29, 16384
    ds_read_b64_tr_b16 a[250:251], v22 offset:160
    ds_read_b64_tr_b16 a[252:253], v22 offset:192
    ds_read_b64_tr_b16 a[254:255], v22 offset:224
    v_mul_f32 v27, v27, v21
    v_cvt_pk_bf16_f32 v28, v24, v25
    v_mfma_f32_16x16x32_bf16 v[124:127], a[128:131], v[68:71], v[108:111]
    v_exp_f32 v132, v132
    v_mfma_f32_16x16x32_bf16 v[124:127], a[132:135], v[72:75], v[124:127]
    ds_read_b64_tr_b16 a[192:193], v9 offset:8192
    v_cvt_pk_bf16_f32 v237, v130, v131
    v_mfma_f32_16x16x32_bf16 v[124:127], a[136:139], v[76:79], v[124:127]
    v_exp_f32 v133, v133
    v_cvt_pk_bf16_f32 v29, v26, v27
    v_mfma_f32_16x16x32_bf16 v[124:127], a[140:143], v[80:83], v[124:127]
    ds_read_b64_tr_b16 a[194:195], v9 offset:12288
    v_lshlrev_b32 v24, 16, v28
    v_mfma_f32_16x16x32_bf16 v[128:131], a[140:143], v[96:99], v[112:115]
    v_exp_f32 v134, v134
    v_mfma_f32_16x16x32_bf16 v[128:131], a[136:139], v[92:95], v[128:131]
    ds_read_b128 a[160:163], v1 offset:40960
    v_cvt_pk_bf16_f32 v214, v132, v133
    v_and_b32 v25, 0xffff0000, v28
    v_mfma_f32_16x16x32_bf16 v[128:131], a[132:135], v[88:91], v[128:131]
    v_exp_f32 v135, v135
    v_lshlrev_b32 v26, 16, v29
    v_mfma_f32_16x16x32_bf16 v[128:131], a[128:131], v[84:87], v[128:131]
    ds_read_b64_tr_b16 a[196:197], v9 offset:32768
    v_and_b32 v27, 0xffff0000, v29
    v_mfma_f32_16x16x32_bf16 a[32:35], a[208:211], v[180:183], a[32:35]
    v_exp_f32 v136, v136
    v_mfma_f32_16x16x32_bf16 a[32:35], a[212:215], v[184:187], a[32:35]
    ds_read_b64_tr_b16 a[198:199], v9 offset:36864
    v_cvt_pk_bf16_f32 v215, v134, v135
    v_mov_b32 v32, v24
    v_mfma_f32_16x16x32_bf16 a[36:39], a[212:215], v[192:195], a[36:39]
    v_exp_f32 v137, v137
    v_mov_b32 v33, v25
    v_mfma_f32_16x16x32_bf16 a[36:39], a[208:211], v[188:191], a[36:39]
    ds_read_b128 a[164:167], v2 offset:40960
    v_mov_b32 v34, v26
    v_mfma_f32_16x16x32_bf16 a[40:43], a[208:211], v[196:199], a[40:43]
    v_exp_f32 v138, v138
    v_mfma_f32_16x16x32_bf16 a[40:43], a[212:215], v[200:203], a[40:43]
    v_cvt_pk_bf16_f32 v222, v136, v137
    v_mov_b32 v35, v27
    v_mfma_f32_16x16x32_bf16 a[44:47], a[212:215], v[208:211], a[44:47]
    v_exp_f32 v139, v139
    v_permlane32_swap_b32 v24, v32
    v_mfma_f32_16x16x32_bf16 a[44:47], a[208:211], v[204:207], a[44:47]
    s_waitcnt lgkmcnt(6)
    v_permlane32_swap_b32 v25, v33
    v_mfma_f32_16x16x32_bf16 v[132:135], a[144:147], v[36:39], v[100:103]
    s_mul_i32 s46, s5, 10240
    v_exp_f32 v140, v140
    v_mfma_f32_16x16x32_bf16 v[132:135], a[148:151], v[40:43], v[132:135]
    s_lshl_b32 s40, s100, 1
    ds_read_b64_tr_b16 a[200:201], v10 offset:8192
    v_cvt_pk_bf16_f32 v223, v138, v139
    v_permlane32_swap_b32 v26, v34
    v_mfma_f32_16x16x32_bf16 v[132:135], a[152:155], v[44:47], v[132:135]
    s_add_u32 s40, s40, s47
    v_exp_f32 v141, v141
    v_permlane32_swap_b32 v27, v35
    v_mfma_f32_16x16x32_bf16 v[132:135], a[156:159], v[48:51], v[132:135]
    s_mul_i32 s40, s40, 327680
    ds_read_b64_tr_b16 a[202:203], v10 offset:12288
    v_mul_f32 v28, 0xbfb8aa3b, v24
    v_mfma_f32_16x16x32_bf16 v[136:139], a[156:159], v[64:67], v[104:107]
    s_add_u32 s40, s40, 0x1400000
    v_exp_f32 v142, v142
    v_mfma_f32_16x16x32_bf16 v[136:139], a[152:155], v[60:63], v[136:139]
    s_add_u32 s20, s72, s40
    s_addc_u32 s21, s73, 0
    ds_read_b128 a[168:171], v3 offset:40960
    v_cvt_pk_bf16_f32 v230, v140, v141
    v_mul_f32 v29, 0xbfb8aa3b, v25
    v_mfma_f32_16x16x32_bf16 v[136:139], a[148:151], v[56:59], v[136:139]
    s_mov_b32 s22, 0x50000
    v_exp_f32 v143, v143
    v_mfma_f32_16x16x32_bf16 v[136:139], a[144:147], v[52:55], v[136:139]
    s_mov_b32 s23, 0x20000
    ds_read_b64_tr_b16 a[204:205], v10 offset:32768
    v_mul_f32 v30, 0xbfb8aa3b, v26
    v_mfma_f32_16x16x32_bf16 a[48:51], a[216:219], v[180:183], a[48:51]
    s_mul_i32 s40, s5, 5120
    v_exp_f32 v144, v144
    v_mul_f32 v31, 0xbfb8aa3b, v27
    v_mfma_f32_16x16x32_bf16 a[48:51], a[220:223], v[184:187], a[48:51]
    ds_read_b64_tr_b16 a[206:207], v10 offset:36864
    v_cvt_pk_bf16_f32 v231, v142, v143
    v_exp_f32 v28, v28
    v_mfma_f32_16x16x32_bf16 a[52:55], a[220:223], v[192:195], a[52:55]
    v_exp_f32 v145, v145
    v_mfma_f32_16x16x32_bf16 a[52:55], a[216:219], v[188:191], a[52:55]
    ds_read_b128 a[172:175], v4 offset:40960
    v_exp_f32 v29, v29
    v_mfma_f32_16x16x32_bf16 a[56:59], a[216:219], v[196:199], a[56:59]
    v_exp_f32 v146, v146
    v_exp_f32 v30, v30
    v_mfma_f32_16x16x32_bf16 a[56:59], a[220:223], v[200:203], a[56:59]
    v_cvt_pk_bf16_f32 v238, v144, v145
    v_lshl_add_u32 v254, v19, 4, s40
    v_mfma_f32_16x16x32_bf16 a[60:63], a[220:223], v[208:211], a[60:63]
    v_exp_f32 v147, v147
    v_exp_f32 v31, v31
    v_mfma_f32_16x16x32_bf16 a[60:63], a[216:219], v[204:207], a[60:63]
    v_add_f32 v28, 1.0, v28
    v_add_f32 v29, 1.0, v29
    v_smfmac_f32_16x16x64_bf16 a[228:231], v[244:247], v[188:195], v248
    s_waitcnt lgkmcnt(6)
    v_add_f32 v30, 1.0, v30
    v_add_f32 v31, 1.0, v31
    v_mfma_f32_16x16x32_bf16 v[140:143], a[144:147], v[68:71], v[108:111]
    v_exp_f32 v148, v148
    v_mfma_f32_16x16x32_bf16 v[140:143], a[148:151], v[72:75], v[140:143]
    ds_read_b64_tr_b16 a[208:209], v11 offset:8192
    v_cvt_pk_bf16_f32 v239, v146, v147
    v_mfma_f32_16x16x32_bf16 v[140:143], a[152:155], v[76:79], v[140:143]
    v_exp_f32 v149, v149
    v_mfma_f32_16x16x32_bf16 v[140:143], a[156:159], v[80:83], v[140:143]
    ds_read_b64_tr_b16 a[210:211], v11 offset:12288
    v_rcp_f32 v28, v28
    v_mfma_f32_16x16x32_bf16 v[144:147], a[156:159], v[96:99], v[112:115]
    v_exp_f32 v150, v150
    v_mfma_f32_16x16x32_bf16 v[144:147], a[152:155], v[92:95], v[144:147]
    ds_read_b128 a[176:179], v1 offset:45056
    v_cvt_pk_bf16_f32 v216, v148, v149
    v_rcp_f32 v29, v29
    v_mfma_f32_16x16x32_bf16 v[144:147], a[148:151], v[88:91], v[144:147]
    v_exp_f32 v151, v151
    v_rcp_f32 v30, v30
    v_mfma_f32_16x16x32_bf16 v[144:147], a[144:147], v[84:87], v[144:147]
    ds_read_b64_tr_b16 a[212:213], v11 offset:32768
    v_rcp_f32 v31, v31
    v_mfma_f32_16x16x32_bf16 a[64:67], a[192:195], v[180:183], a[64:67]
    v_exp_f32 v152, v152
    v_mfma_f32_16x16x32_bf16 a[64:67], a[196:199], v[184:187], a[64:67]
    ds_read_b64_tr_b16 a[214:215], v11 offset:36864
    v_cvt_pk_bf16_f32 v217, v150, v151
    v_mul_f32 v24, v24, v28
    v_mfma_f32_16x16x32_bf16 a[68:71], a[196:199], v[192:195], a[68:71]
    v_exp_f32 v153, v153
    v_mul_f32 v25, v25, v29
    v_mfma_f32_16x16x32_bf16 a[68:71], a[192:195], v[188:191], a[68:71]
    ds_read_b128 a[180:183], v2 offset:45056
    v_mul_f32 v26, v26, v30
    v_mfma_f32_16x16x32_bf16 a[72:75], a[192:195], v[196:199], a[72:75]
    v_exp_f32 v154, v154
    v_mfma_f32_16x16x32_bf16 a[72:75], a[196:199], v[200:203], a[72:75]
    v_cvt_pk_bf16_f32 v224, v152, v153
    v_mul_f32 v27, v27, v31
    v_mfma_f32_16x16x32_bf16 a[76:79], a[196:199], v[208:211], a[76:79]
    v_exp_f32 v155, v155
    v_cvt_pk_bf16_f32 v28, v24, v25
    v_mfma_f32_16x16x32_bf16 a[76:79], a[192:195], v[204:207], a[76:79]
    s_waitcnt lgkmcnt(6)
    v_cvt_pk_bf16_f32 v29, v26, v27
    v_lshlrev_b32 v24, 16, v28
    v_mfma_f32_16x16x32_bf16 v[148:151], a[160:163], v[36:39], v[100:103]
    v_exp_f32 v156, v156
    v_mfma_f32_16x16x32_bf16 v[148:151], a[164:167], v[40:43], v[148:151]
    ds_read_b64_tr_b16 a[216:217], v12 offset:8192
    v_cvt_pk_bf16_f32 v225, v154, v155
    v_mfma_f32_16x16x32_bf16 v[148:151], a[168:171], v[44:47], v[148:151]
    v_exp_f32 v157, v157
    v_and_b32 v25, 0xffff0000, v28
    v_mfma_f32_16x16x32_bf16 v[148:151], a[172:175], v[48:51], v[148:151]
    ds_read_b64_tr_b16 a[218:219], v12 offset:12288
    v_lshlrev_b32 v26, 16, v29
    v_mfma_f32_16x16x32_bf16 v[152:155], a[172:175], v[64:67], v[104:107]
    v_exp_f32 v158, v158
    v_mfma_f32_16x16x32_bf16 v[152:155], a[168:171], v[60:63], v[152:155]
    ds_read_b128 a[184:187], v3 offset:45056
    v_cvt_pk_bf16_f32 v232, v156, v157
    v_and_b32 v27, 0xffff0000, v29
    v_mfma_f32_16x16x32_bf16 v[152:155], a[164:167], v[56:59], v[152:155]
    v_exp_f32 v159, v159
    v_mfma_f32_16x16x32_bf16 v[152:155], a[160:163], v[52:55], v[152:155]
    ds_read_b64_tr_b16 a[220:221], v12 offset:32768
    v_mul_f32 v24, v24, v32
    v_mfma_f32_16x16x32_bf16 a[80:83], a[200:203], v[180:183], a[80:83]
    v_exp_f32 v160, v160
    v_mul_f32 v25, v25, v33
    v_mfma_f32_16x16x32_bf16 a[80:83], a[204:207], v[184:187], a[80:83]
    ds_read_b64_tr_b16 a[222:223], v12 offset:36864
    v_cvt_pk_bf16_f32 v233, v158, v159
    v_mul_f32 v26, v26, v34
    v_mfma_f32_16x16x32_bf16 a[84:87], a[204:207], v[192:195], a[84:87]
    v_exp_f32 v161, v161
    v_mfma_f32_16x16x32_bf16 a[84:87], a[200:203], v[188:191], a[84:87]
    ds_read_b128 a[188:191], v4 offset:45056
    v_mul_f32 v27, v27, v35
    v_mfma_f32_16x16x32_bf16 a[88:91], a[200:203], v[196:199], a[88:91]
    v_exp_f32 v162, v162
    v_cmp_gt_u32 vcc, 32, v19
    v_mfma_f32_16x16x32_bf16 a[88:91], a[204:207], v[200:203], a[88:91]
    v_cvt_pk_bf16_f32 v240, v160, v161
    v_cvt_pk_bf16_f32 v252, v24, v25
    v_mfma_f32_16x16x32_bf16 a[92:95], a[204:207], v[208:211], a[92:95]
    v_exp_f32 v163, v163
    v_mfma_f32_16x16x32_bf16 a[92:95], a[200:203], v[204:207], a[92:95]
    v_cvt_pk_bf16_f32 v253, v26, v27
    v_cndmask_b32 v252, 0, v252, vcc
    v_smfmac_f32_16x16x64_bf16 a[232:235], v[244:247], v[196:203], v248
    s_waitcnt vmcnt(4) lgkmcnt(0)
    s_barrier
    v_cndmask_b32 v253, 0, v253, vcc
    v_and_b32 v23, 7, v19
    v_mfma_f32_16x16x32_bf16 v[156:159], a[160:163], v[68:71], v[108:111]
    v_exp_f32 v164, v164
    v_mfma_f32_16x16x32_bf16 v[156:159], a[164:167], v[72:75], v[156:159]
    ds_read_b64_tr_b16 a[192:193], v5 offset:16384
    v_cvt_pk_bf16_f32 v241, v162, v163
    v_mfma_f32_16x16x32_bf16 v[156:159], a[168:171], v[76:79], v[156:159]
    v_exp_f32 v165, v165
    v_mfma_f32_16x16x32_bf16 v[156:159], a[172:175], v[80:83], v[156:159]
    ds_read_b64_tr_b16 a[194:195], v5 offset:20480
    v_mul_u32_u24 v23, 34560, v23
    v_mfma_f32_16x16x32_bf16 v[160:163], a[172:175], v[96:99], v[112:115]
    v_exp_f32 v166, v166
    v_mfma_f32_16x16x32_bf16 v[160:163], a[168:171], v[92:95], v[160:163]
    ds_read_b128 a[128:131], v1 offset:0
    v_cvt_pk_bf16_f32 v218, v164, v165
    v_lshrrev_b32 v0, 4, v19
    v_mfma_f32_16x16x32_bf16 v[160:163], a[164:167], v[88:91], v[160:163]
    v_exp_f32 v167, v167
    v_add_u32 v23, v23, v0
    v_mfma_f32_16x16x32_bf16 v[160:163], a[160:163], v[84:87], v[160:163]
    ds_read_b64_tr_b16 a[196:197], v5 offset:40960
    v_and_b32 v0, 8, v19
    v_mfma_f32_16x16x32_bf16 a[96:99], a[208:211], v[180:183], a[96:99]
    v_exp_f32 v168, v168
    v_mfma_f32_16x16x32_bf16 a[96:99], a[212:215], v[184:187], a[96:99]
    ds_read_b64_tr_b16 a[198:199], v5 offset:45056
    v_cvt_pk_bf16_f32 v219, v166, v167
    v_lshrrev_b32 v0, 1, v0
    v_mfma_f32_16x16x32_bf16 a[100:103], a[212:215], v[192:195], a[100:103]
    v_exp_f32 v169, v169
    v_add_lshl_u32 v23, v23, v0, 4
    v_mfma_f32_16x16x32_bf16 a[100:103], a[208:211], v[188:191], a[100:103]
    s_mul_i32 s42, s5, 1080
    ds_read_b128 a[132:135], v2 offset:0
    v_cvt_pk_bf16_f32 v226, v168, v169
    v_mfma_f32_16x16x32_bf16 a[104:107], a[208:211], v[196:199], a[104:107]
    s_add_u32 s42, s42, s6
    v_exp_f32 v170, v170
    v_mfma_f32_16x16x32_bf16 a[104:107], a[212:215], v[200:203], a[104:107]
    s_lshl_b32 s42, s42, 7
    s_mov_b32 m0, s33
    s_nop 0
    buffer_load_dwordx4 v17, s[12:15], s29 offen offset:0 lds
    v_mfma_f32_16x16x32_bf16 a[108:111], a[212:215], v[208:211], a[108:111]
    s_cmp_lt_u32 s6, 216
    s_cselect_b32 s42, s42, 0x438000
    v_exp_f32 v171, v171
    v_mfma_f32_16x16x32_bf16 a[108:111], a[208:211], v[204:207], a[108:111]
    s_waitcnt lgkmcnt(6)
    s_add_u32 m0, s46, 122880
    s_mov_b32 s45, 245760
    buffer_load_dwordx4 v254, s[20:23], s45 offen sc1 lds
    v_mfma_f32_16x16x32_bf16 v[164:167], a[176:179], v[36:39], v[100:103]
    v_exp_f32 v172, v172
    v_mfma_f32_16x16x16_bf16 v[24:27], a[240:241], v[252:253], 0
    v_mfma_f32_16x16x16_bf16 v[28:31], a[242:243], v[252:253], 0
    s_add_u32 m0, s46, 123904
    s_mov_b32 s45, 246784
    buffer_load_dwordx4 v254, s[20:23], s45 offen sc1 lds
    v_mfma_f32_16x16x32_bf16 v[164:167], a[180:183], v[40:43], v[164:167]
    ds_read_b64_tr_b16 a[200:201], v6 offset:16384
    v_cvt_pk_bf16_f32 v227, v170, v171
    v_mfma_f32_16x16x32_bf16 v[164:167], a[184:187], v[44:47], v[164:167]
    v_exp_f32 v173, v173
    v_mfma_f32_16x16x32_bf16 v[164:167], a[188:191], v[48:51], v[164:167]
    ds_read_b64_tr_b16 a[202:203], v6 offset:20480
    v_mfma_f32_16x16x32_bf16 v[168:171], a[188:191], v[64:67], v[104:107]
    v_exp_f32 v174, v174
    v_mfma_f32_16x16x32_bf16 v[168:171], a[184:187], v[60:63], v[168:171]
    ds_read_b128 a[136:139], v3 offset:0
    v_cvt_pk_bf16_f32 v234, v172, v173
    v_mfma_f32_16x16x32_bf16 v[168:171], a[180:183], v[56:59], v[168:171]
    v_exp_f32 v175, v175
    v_mfma_f32_16x16x32_bf16 v[168:171], a[176:179], v[52:55], v[168:171]
    ds_read_b64_tr_b16 a[204:205], v6 offset:40960
    v_mov_b32_dpp v24, v28 row_shr:8 row_mask:0xf bank_mask:0xc
    v_mfma_f32_16x16x32_bf16 a[112:115], a[216:219], v[180:183], a[112:115]
    v_exp_f32 v176, v176
    v_mfma_f32_16x16x32_bf16 a[112:115], a[220:223], v[184:187], a[112:115]
    ds_read_b64_tr_b16 a[206:207], v6 offset:45056
    v_cvt_pk_bf16_f32 v235, v174, v175
    v_mfma_f32_16x16x32_bf16 a[116:119], a[220:223], v[192:195], a[116:119]
    v_exp_f32 v177, v177
    v_mov_b32_dpp v25, v29 row_shr:8 row_mask:0xf bank_mask:0xc
    v_mfma_f32_16x16x32_bf16 a[116:119], a[216:219], v[188:191], a[116:119]
    ds_read_b128 a[140:143], v4 offset:0
    v_mov_b32_dpp v26, v30 row_shr:8 row_mask:0xf bank_mask:0xc
    v_mfma_f32_16x16x32_bf16 a[120:123], a[216:219], v[196:199], a[120:123]
    v_exp_f32 v178, v178
    v_mov_b32_dpp v27, v31 row_shr:8 row_mask:0xf bank_mask:0xc
    v_mfma_f32_16x16x32_bf16 a[120:123], a[220:223], v[200:203], a[120:123]
    buffer_store_dwordx4 v[24:27], v23, s[16:19], s42 offen sc1
    v_cvt_pk_bf16_f32 v242, v176, v177
    v_mfma_f32_16x16x32_bf16 a[124:127], a[220:223], v[208:211], a[124:127]
    s_add_u32 s42, s42, 27648
    v_exp_f32 v179, v179
    v_mfma_f32_16x16x32_bf16 a[124:127], a[216:219], v[204:207], a[124:127]
    s_mov_b32 m0, s33
    s_nop 0
    buffer_load_dwordx4 v18, s[12:15], s29 offen offset:1024 lds
    v_smfmac_f32_16x16x64_bf16 a[236:239], v[244:247], v[204:211], v248
    s_waitcnt lgkmcnt(6)
    ds_read_b64_tr_b16 a[240:241], v22 offset:256
    ds_read_b64_tr_b16 a[242:243], v22 offset:288
    v_mfma_f32_16x16x32_bf16 v[172:175], a[176:179], v[68:71], v[108:111]
    v_exp_f32 v116, v116
    v_mfma_f32_16x16x16_bf16 v[32:35], a[244:245], v[252:253], 0
    v_mfma_f32_16x16x16_bf16 v[28:31], a[246:247], v[252:253], 0
    s_add_u32 m0, s46, 124928
    s_mov_b32 s45, 247808
    buffer_load_dwordx4 v254, s[20:23], s45 offen sc1 lds
    v_mfma_f32_16x16x32_bf16 v[172:175], a[180:183], v[72:75], v[172:175]
    ds_read_b64_tr_b16 a[208:209], v7 offset:16384
    v_cvt_pk_bf16_f32 v243, v178, v179
    v_mfma_f32_16x16x32_bf16 v[172:175], a[184:187], v[76:79], v[172:175]
    v_exp_f32 v117, v117
    v_mfma_f32_16x16x32_bf16 v[172:175], a[188:191], v[80:83], v[172:175]
    ds_read_b64_tr_b16 a[210:211], v7 offset:20480
    v_mfma_f32_16x16x32_bf16 v[176:179], a[188:191], v[96:99], v[112:115]
    v_exp_f32 v118, v118
    v_mfma_f32_16x16x32_bf16 v[176:179], a[184:187], v[92:95], v[176:179]
    ds_read_b128 a[144:147], v1 offset:4096
    v_cvt_pk_bf16_f32 v180, v116, v117
    v_mfma_f32_16x16x32_bf16 v[176:179], a[180:183], v[88:91], v[176:179]
    v_exp_f32 v119, v119
    v_mfma_f32_16x16x32_bf16 v[176:179], a[176:179], v[84:87], v[176:179]
    ds_read_b64_tr_b16 a[212:213], v7 offset:40960
    v_mov_b32_dpp v32, v28 row_shr:8 row_mask:0xf bank_mask:0xc
    v_mfma_f32_16x16x32_bf16 a[0:3], a[192:195], v[212:215], a[0:3]
    v_exp_f32 v120, v120
    v_mfma_f32_16x16x32_bf16 a[0:3], a[196:199], v[216:219], a[0:3]
    ds_read_b64_tr_b16 a[214:215], v7 offset:45056
    v_cvt_pk_bf16_f32 v181, v118, v119
    v_mfma_f32_16x16x32_bf16 a[4:7], a[196:199], v[224:227], a[4:7]
    v_exp_f32 v121, v121
    v_mfma_f32_16x16x32_bf16 a[4:7], a[192:195], v[220:223], a[4:7]
    ds_read_b128 a[148:151], v2 offset:4096
    v_cvt_pk_bf16_f32 v188, v120, v121
    v_mov_b32_dpp v33, v29 row_shr:8 row_mask:0xf bank_mask:0xc
    v_mfma_f32_16x16x32_bf16 a[8:11], a[192:195], v[228:231], a[8:11]
    v_exp_f32 v122, v122
    v_mov_b32_dpp v34, v30 row_shr:8 row_mask:0xf bank_mask:0xc
    v_mfma_f32_16x16x32_bf16 a[8:11], a[196:199], v[232:235], a[8:11]
    s_mov_b32 m0, s33
    s_nop 0
    buffer_load_dwordx4 v17, s[12:15], s29 offen offset:2048 lds
    v_mov_b32_dpp v35, v31 row_shr:8 row_mask:0xf bank_mask:0xc
    v_mfma_f32_16x16x32_bf16 a[12:15], a[196:199], v[240:243], a[12:15]
    buffer_store_dwordx4 v[32:35], v23, s[16:19], s42 offen sc1
    v_exp_f32 v123, v123
    v_mfma_f32_16x16x32_bf16 a[12:15], a[192:195], v[236:239], a[12:15]
    s_waitcnt lgkmcnt(6)
    s_add_u32 s42, s42, 27648
    s_add_u32 m0, s46, 125952
    s_mov_b32 s45, 248832
    buffer_load_dwordx4 v254, s[20:23], s45 offen sc1 lds
    v_mfma_f32_16x16x32_bf16 v[116:119], a[128:131], v[36:39], v[100:103]
    v_exp_f32 v124, v124
    v_mfma_f32_16x16x16_bf16 v[24:27], a[248:249], v[252:253], 0
    v_mfma_f32_16x16x16_bf16 v[28:31], a[250:251], v[252:253], 0
    s_add_u32 m0, s46, 126976
    s_mov_b32 s45, 249856
    buffer_load_dwordx4 v254, s[20:23], s45 offen sc1 lds
    v_mfma_f32_16x16x32_bf16 v[116:119], a[132:135], v[40:43], v[116:119]
    ds_read_b64_tr_b16 a[216:217], v8 offset:16384
    v_cvt_pk_bf16_f32 v189, v122, v123
    v_mfma_f32_16x16x32_bf16 v[116:119], a[136:139], v[44:47], v[116:119]
    v_exp_f32 v125, v125
    v_mfma_f32_16x16x32_bf16 v[116:119], a[140:143], v[48:51], v[116:119]
    ds_read_b64_tr_b16 a[218:219], v8 offset:20480
    v_mfma_f32_16x16x32_bf16 v[120:123], a[140:143], v[64:67], v[104:107]
    v_exp_f32 v126, v126
    v_mfma_f32_16x16x32_bf16 v[120:123], a[136:139], v[60:63], v[120:123]
    ds_read_b128 a[152:155], v3 offset:4096
    v_cvt_pk_bf16_f32 v196, v124, v125
    v_mfma_f32_16x16x32_bf16 v[120:123], a[132:135], v[56:59], v[120:123]
    v_exp_f32 v127, v127
    v_mfma_f32_16x16x32_bf16 v[120:123], a[128:131], v[52:55], v[120:123]
    ds_read_b64_tr_b16 a[220:221], v8 offset:40960
    v_mov_b32_dpp v24, v28 row_shr:8 row_mask:0xf bank_mask:0xc
    v_mfma_f32_16x16x32_bf16 a[16:19], a[200:203], v[212:215], a[16:19]
    v_exp_f32 v128, v128
    v_mfma_f32_16x16x32_bf16 a[16:19], a[204:207], v[216:219], a[16:19]
    ds_read_b64_tr_b16 a[222:223], v8 offset:45056
    v_cvt_pk_bf16_f32 v197, v126, v127
    v_mfma_f32_16x16x32_bf16 a[20:23], a[204:207], v[224:227], a[20:23]
    v_exp_f32 v129, v129
    v_mfma_f32_16x16x32_bf16 a[20:23], a[200:203], v[220:223], a[20:23]
    ds_read_b128 a[156:159], v4 offset:4096
    v_mov_b32_dpp v25, v29 row_shr:8 row_mask:0xf bank_mask:0xc
    v_mfma_f32_16x16x32_bf16 a[24:27], a[200:203], v[228:231], a[24:27]
    v_exp_f32 v130, v130
    v_mfma_f32_16x16x32_bf16 a[24:27], a[204:207], v[232:235], a[24:27]
    v_cvt_pk_bf16_f32 v204, v128, v129
    v_mov_b32_dpp v26, v30 row_shr:8 row_mask:0xf bank_mask:0xc
    v_mfma_f32_16x16x32_bf16 a[28:31], a[204:207], v[240:243], a[28:31]
    v_exp_f32 v131, v131
    v_mov_b32_dpp v27, v31 row_shr:8 row_mask:0xf bank_mask:0xc
    v_mfma_f32_16x16x32_bf16 a[28:31], a[200:203], v[236:239], a[28:31]
    s_mov_b32 m0, s33
    s_nop 0
    buffer_load_dwordx4 v18, s[12:15], s29 offen offset:3072 lds
    buffer_store_dwordx4 v[24:27], v23, s[16:19], s42 offen sc1
    v_smfmac_f32_16x16x64_bf16 a[224:227], v[244:247], v[212:219], v248
    s_waitcnt lgkmcnt(6)
    s_add_u32 s29, s29, 16384
    s_add_u32 s42, s42, 27648
    s_add_u32 m0, s46, 128000
    s_mov_b32 s45, 266240
    buffer_load_dwordx4 v254, s[20:23], s45 offen sc1 lds
    v_mfma_f32_16x16x32_bf16 v[124:127], a[128:131], v[68:71], v[108:111]
    v_exp_f32 v132, v132
    v_mfma_f32_16x16x16_bf16 v[32:35], a[252:253], v[252:253], 0
    v_mfma_f32_16x16x16_bf16 v[28:31], a[254:255], v[252:253], 0
    s_add_u32 m0, s46, 129024
    s_mov_b32 s45, 267264
    buffer_load_dwordx4 v254, s[20:23], s45 offen sc1 lds
    v_mfma_f32_16x16x32_bf16 v[124:127], a[132:135], v[72:75], v[124:127]
    ds_read_b64_tr_b16 a[192:193], v9 offset:16384
    v_cvt_pk_bf16_f32 v205, v130, v131
    v_mfma_f32_16x16x32_bf16 v[124:127], a[136:139], v[76:79], v[124:127]
    v_exp_f32 v133, v133
    v_mfma_f32_16x16x32_bf16 v[124:127], a[140:143], v[80:83], v[124:127]
    ds_read_b64_tr_b16 a[194:195], v9 offset:20480
    v_mfma_f32_16x16x32_bf16 v[128:131], a[140:143], v[96:99], v[112:115]
    v_exp_f32 v134, v134
    v_mfma_f32_16x16x32_bf16 v[128:131], a[136:139], v[92:95], v[128:131]
    ds_read_b128 a[160:163], v1 offset:8192
    v_cvt_pk_bf16_f32 v182, v132, v133
    v_mfma_f32_16x16x32_bf16 v[128:131], a[132:135], v[88:91], v[128:131]
    v_exp_f32 v135, v135
    v_mfma_f32_16x16x32_bf16 v[128:131], a[128:131], v[84:87], v[128:131]
    ds_read_b64_tr_b16 a[196:197], v9 offset:40960
    v_mov_b32_dpp v32, v28 row_shr:8 row_mask:0xf bank_mask:0xc
    v_mfma_f32_16x16x32_bf16 a[32:35], a[208:211], v[212:215], a[32:35]
    v_exp_f32 v136, v136
    v_mfma_f32_16x16x32_bf16 a[32:35], a[212:215], v[216:219], a[32:35]
    ds_read_b64_tr_b16 a[198:199], v9 offset:45056
    v_cvt_pk_bf16_f32 v183, v134, v135
    v_mfma_f32_16x16x32_bf16 a[36:39], a[212:215], v[224:227], a[36:39]
    v_exp_f32 v137, v137
    v_mfma_f32_16x16x32_bf16 a[36:39], a[208:211], v[220:223], a[36:39]
    ds_read_b128 a[164:167], v2 offset:8192
    v_mov_b32_dpp v33, v29 row_shr:8 row_mask:0xf bank_mask:0xc
    v_mfma_f32_16x16x32_bf16 a[40:43], a[208:211], v[228:231], a[40:43]
    v_exp_f32 v138, v138
    v_mov_b32_dpp v34, v30 row_shr:8 row_mask:0xf bank_mask:0xc
    v_mfma_f32_16x16x32_bf16 a[40:43], a[212:215], v[232:235], a[40:43]
    v_cvt_pk_bf16_f32 v190, v136, v137
    v_mov_b32_dpp v35, v31 row_shr:8 row_mask:0xf bank_mask:0xc
    v_mfma_f32_16x16x32_bf16 a[44:47], a[212:215], v[240:243], a[44:47]
    buffer_store_dwordx4 v[32:35], v23, s[16:19], s42 offen sc1
    v_exp_f32 v139, v139
    v_mfma_f32_16x16x32_bf16 a[44:47], a[208:211], v[236:239], a[44:47]
    s_waitcnt lgkmcnt(6)
    s_add_u32 s42, s42, 27648
    s_add_u32 m0, s46, 130048
    s_mov_b32 s45, 268288
    buffer_load_dwordx4 v254, s[20:23], s45 offen sc1 lds
    v_mfma_f32_16x16x32_bf16 v[132:135], a[144:147], v[36:39], v[100:103]
    v_exp_f32 v140, v140
    v_mfma_f32_16x16x16_bf16 v[24:27], a[240:241], v[252:253], 0
    v_mfma_f32_16x16x16_bf16 v[28:31], a[242:243], v[252:253], 0
    s_add_u32 m0, s46, 131072
    s_mov_b32 s45, 269312
    buffer_load_dwordx4 v254, s[20:23], s45 offen sc1 lds
    v_mfma_f32_16x16x32_bf16 v[132:135], a[148:151], v[40:43], v[132:135]
    ds_read_b64_tr_b16 a[200:201], v10 offset:16384
    v_cvt_pk_bf16_f32 v191, v138, v139
    v_mfma_f32_16x16x32_bf16 v[132:135], a[152:155], v[44:47], v[132:135]
    v_exp_f32 v141, v141
    v_mfma_f32_16x16x32_bf16 v[132:135], a[156:159], v[48:51], v[132:135]
    ds_read_b64_tr_b16 a[202:203], v10 offset:20480
    v_mfma_f32_16x16x32_bf16 v[136:139], a[156:159], v[64:67], v[104:107]
    v_exp_f32 v142, v142
    v_mfma_f32_16x16x32_bf16 v[136:139], a[152:155], v[60:63], v[136:139]
    ds_read_b128 a[168:171], v3 offset:8192
    v_cvt_pk_bf16_f32 v198, v140, v141
    v_mfma_f32_16x16x32_bf16 v[136:139], a[148:151], v[56:59], v[136:139]
    v_exp_f32 v143, v143
    v_mfma_f32_16x16x32_bf16 v[136:139], a[144:147], v[52:55], v[136:139]
    ds_read_b64_tr_b16 a[204:205], v10 offset:40960
    v_mov_b32_dpp v24, v28 row_shr:8 row_mask:0xf bank_mask:0xc
    v_mfma_f32_16x16x32_bf16 a[48:51], a[216:219], v[212:215], a[48:51]
    v_exp_f32 v144, v144
    v_mfma_f32_16x16x32_bf16 a[48:51], a[220:223], v[216:219], a[48:51]
    ds_read_b64_tr_b16 a[206:207], v10 offset:45056
    v_cvt_pk_bf16_f32 v199, v142, v143
    v_mfma_f32_16x16x32_bf16 a[52:55], a[220:223], v[224:227], a[52:55]
    v_exp_f32 v145, v145
    v_mfma_f32_16x16x32_bf16 a[52:55], a[216:219], v[220:223], a[52:55]
    ds_read_b128 a[172:175], v4 offset:8192
    v_mov_b32_dpp v25, v29 row_shr:8 row_mask:0xf bank_mask:0xc
    v_mfma_f32_16x16x32_bf16 a[56:59], a[216:219], v[228:231], a[56:59]
    v_exp_f32 v146, v146
    v_mfma_f32_16x16x32_bf16 a[56:59], a[220:223], v[232:235], a[56:59]
    v_cvt_pk_bf16_f32 v206, v144, v145
    v_mov_b32_dpp v26, v30 row_shr:8 row_mask:0xf bank_mask:0xc
    v_mfma_f32_16x16x32_bf16 a[60:63], a[220:223], v[240:243], a[60:63]
    v_exp_f32 v147, v147
    v_mov_b32_dpp v27, v31 row_shr:8 row_mask:0xf bank_mask:0xc
    v_mfma_f32_16x16x32_bf16 a[60:63], a[216:219], v[236:239], a[60:63]
    buffer_store_dwordx4 v[24:27], v23, s[16:19], s42 offen sc1
    v_smfmac_f32_16x16x64_bf16 a[228:231], v[244:247], v[220:227], v248
    s_waitcnt lgkmcnt(6)
    s_add_u32 s42, s42, 27648
    s_add_u32 m0, s46, 132096
    s_mov_b32 s45, 270336
    buffer_load_dwordx4 v254, s[20:23], s45 offen sc1 lds
    v_mfma_f32_16x16x32_bf16 v[140:143], a[144:147], v[68:71], v[108:111]
    v_exp_f32 v148, v148
    v_mfma_f32_16x16x32_bf16 v[140:143], a[148:151], v[72:75], v[140:143]
    ds_read_b64_tr_b16 a[208:209], v11 offset:16384
    v_cvt_pk_bf16_f32 v207, v146, v147
    v_mfma_f32_16x16x32_bf16 v[140:143], a[152:155], v[76:79], v[140:143]
    v_exp_f32 v149, v149
    v_mfma_f32_16x16x32_bf16 v[140:143], a[156:159], v[80:83], v[140:143]
    ds_read_b64_tr_b16 a[210:211], v11 offset:20480
    v_mfma_f32_16x16x32_bf16 v[144:147], a[156:159], v[96:99], v[112:115]
    v_exp_f32 v150, v150
    v_mfma_f32_16x16x32_bf16 v[144:147], a[152:155], v[92:95], v[144:147]
    ds_read_b128 a[176:179], v1 offset:12288
    v_cvt_pk_bf16_f32 v184, v148, v149
    v_mfma_f32_16x16x32_bf16 v[144:147], a[148:151], v[88:91], v[144:147]
    v_exp_f32 v151, v151
    v_mfma_f32_16x16x32_bf16 v[144:147], a[144:147], v[84:87], v[144:147]
    ds_read_b64_tr_b16 a[212:213], v11 offset:40960
    v_mfma_f32_16x16x32_bf16 a[64:67], a[192:195], v[212:215], a[64:67]
    v_exp_f32 v152, v152
    v_mfma_f32_16x16x32_bf16 a[64:67], a[196:199], v[216:219], a[64:67]
    ds_read_b64_tr_b16 a[214:215], v11 offset:45056
    v_cvt_pk_bf16_f32 v185, v150, v151
    v_mfma_f32_16x16x32_bf16 a[68:71], a[196:199], v[224:227], a[68:71]
    v_exp_f32 v153, v153
    v_mfma_f32_16x16x32_bf16 a[68:71], a[192:195], v[220:223], a[68:71]
    ds_read_b128 a[180:183], v2 offset:12288
    v_mfma_f32_16x16x32_bf16 a[72:75], a[192:195], v[228:231], a[72:75]
    v_exp_f32 v154, v154
    v_mfma_f32_16x16x32_bf16 a[72:75], a[196:199], v[232:235], a[72:75]
    v_cvt_pk_bf16_f32 v192, v152, v153
    v_mfma_f32_16x16x32_bf16 a[76:79], a[196:199], v[240:243], a[76:79]
    v_exp_f32 v155, v155
    v_mfma_f32_16x16x32_bf16 a[76:79], a[192:195], v[236:239], a[76:79]
    s_waitcnt lgkmcnt(6)
    v_mfma_f32_16x16x32_bf16 v[148:151], a[160:163], v[36:39], v[100:103]
    v_exp_f32 v156, v156
    v_mfma_f32_16x16x32_bf16 v[148:151], a[164:167], v[40:43], v[148:151]
    ds_read_b64_tr_b16 a[216:217], v12 offset:16384
    v_cvt_pk_bf16_f32 v193, v154, v155
    v_mfma_f32_16x16x32_bf16 v[148:151], a[168:171], v[44:47], v[148:151]
    v_exp_f32 v157, v157
    v_mfma_f32_16x16x32_bf16 v[148:151], a[172:175], v[48:51], v[148:151]
    ds_read_b64_tr_b16 a[218:219], v12 offset:20480
    v_mfma_f32_16x16x32_bf16 v[152:155], a[172:175], v[64:67], v[104:107]
    v_exp_f32 v158, v158
    v_mfma_f32_16x16x32_bf16 v[152:155], a[168:171], v[60:63], v[152:155]
    ds_read_b128 a[184:187], v3 offset:12288
    v_cvt_pk_bf16_f32 v200, v156, v157
    v_mfma_f32_16x16x32_bf16 v[152:155], a[164:167], v[56:59], v[152:155]
    v_exp_f32 v159, v159
    v_mfma_f32_16x16x32_bf16 v[152:155], a[160:163], v[52:55], v[152:155]
    ds_read_b64_tr_b16 a[220:221], v12 offset:40960
    v_mfma_f32_16x16x32_bf16 a[80:83], a[200:203], v[212:215], a[80:83]
    v_exp_f32 v160, v160
    v_mfma_f32_16x16x32_bf16 a[80:83], a[204:207], v[216:219], a[80:83]
    ds_read_b64_tr_b16 a[222:223], v12 offset:45056
    v_cvt_pk_bf16_f32 v201, v158, v159
    v_mfma_f32_16x16x32_bf16 a[84:87], a[204:207], v[224:227], a[84:87]
    v_exp_f32 v161, v161
    v_mfma_f32_16x16x32_bf16 a[84:87], a[200:203], v[220:223], a[84:87]
    ds_read_b128 a[188:191], v4 offset:12288
    v_mfma_f32_16x16x32_bf16 a[88:91], a[200:203], v[228:231], a[88:91]
    v_exp_f32 v162, v162
    v_mfma_f32_16x16x32_bf16 a[88:91], a[204:207], v[232:235], a[88:91]
    v_cvt_pk_bf16_f32 v208, v160, v161
    v_mfma_f32_16x16x32_bf16 a[92:95], a[204:207], v[240:243], a[92:95]
    v_exp_f32 v163, v163
    v_mfma_f32_16x16x32_bf16 a[92:95], a[200:203], v[236:239], a[92:95]
    v_smfmac_f32_16x16x64_bf16 a[232:235], v[244:247], v[228:235], v248
    s_waitcnt vmcnt(19) lgkmcnt(0)
    s_barrier
    v_mfma_f32_16x16x32_bf16 v[156:159], a[160:163], v[68:71], v[108:111]
    v_exp_f32 v164, v164
    v_mfma_f32_16x16x32_bf16 v[156:159], a[164:167], v[72:75], v[156:159]
    ds_read_b64_tr_b16 a[192:193], v5 offset:57344
    v_cvt_pk_bf16_f32 v209, v162, v163
    v_mfma_f32_16x16x32_bf16 v[156:159], a[168:171], v[76:79], v[156:159]
    v_exp_f32 v165, v165
    v_mfma_f32_16x16x32_bf16 v[156:159], a[172:175], v[80:83], v[156:159]
    ds_read_b64_tr_b16 a[194:195], v5 offset:61440
    v_mfma_f32_16x16x32_bf16 v[160:163], a[172:175], v[96:99], v[112:115]
    v_exp_f32 v166, v166
    v_mfma_f32_16x16x32_bf16 v[160:163], a[168:171], v[92:95], v[160:163]
    ds_read_b64_tr_b16 a[196:197], v5 offset:0
    v_cvt_pk_bf16_f32 v186, v164, v165
    v_mfma_f32_16x16x32_bf16 v[160:163], a[164:167], v[88:91], v[160:163]
    s_add_u32 m0, s46, 81920
    s_mov_b32 s45, 286720
    buffer_load_dwordx4 v254, s[20:23], s45 offen sc1 lds
    v_exp_f32 v167, v167
    v_mfma_f32_16x16x32_bf16 v[160:163], a[160:163], v[84:87], v[160:163]
    ds_read_b64_tr_b16 a[198:199], v5 offset:4096
    v_mfma_f32_16x16x32_bf16 a[96:99], a[208:211], v[212:215], a[96:99]
    v_exp_f32 v168, v168
    v_mfma_f32_16x16x32_bf16 a[96:99], a[212:215], v[216:219], a[96:99]
    v_cvt_pk_bf16_f32 v187, v166, v167
    v_mfma_f32_16x16x32_bf16 a[100:103], a[212:215], v[224:227], a[100:103]
    v_exp_f32 v169, v169
    v_mfma_f32_16x16x32_bf16 a[100:103], a[208:211], v[220:223], a[100:103]
    s_add_u32 m0, s46, 82944
    s_mov_b32 s45, 287744
    buffer_load_dwordx4 v254, s[20:23], s45 offen sc1 lds
    v_mfma_f32_16x16x32_bf16 a[104:107], a[208:211], v[228:231], a[104:107]
    v_exp_f32 v170, v170
    v_mfma_f32_16x16x32_bf16 a[104:107], a[212:215], v[232:235], a[104:107]
    v_cvt_pk_bf16_f32 v194, v168, v169
    v_mfma_f32_16x16x32_bf16 a[108:111], a[212:215], v[240:243], a[108:111]
    v_exp_f32 v171, v171
    v_mfma_f32_16x16x32_bf16 a[108:111], a[208:211], v[236:239], a[108:111]
    s_waitcnt lgkmcnt(4)
    s_add_u32 m0, s46, 83968
    s_mov_b32 s45, 288768
    buffer_load_dwordx4 v254, s[20:23], s45 offen sc1 lds
    v_mfma_f32_16x16x32_bf16 v[164:167], a[176:179], v[36:39], v[100:103]
    v_exp_f32 v172, v172
    v_mfma_f32_16x16x32_bf16 v[164:167], a[180:183], v[40:43], v[164:167]
    ds_read_b64_tr_b16 a[200:201], v6 offset:57344
    v_cvt_pk_bf16_f32 v195, v170, v171
    v_mfma_f32_16x16x32_bf16 v[164:167], a[184:187], v[44:47], v[164:167]
    v_exp_f32 v173, v173
    v_mfma_f32_16x16x32_bf16 v[164:167], a[188:191], v[48:51], v[164:167]
    ds_read_b64_tr_b16 a[202:203], v6 offset:61440
    v_mfma_f32_16x16x32_bf16 v[168:171], a[188:191], v[64:67], v[104:107]
    v_exp_f32 v174, v174
    v_mfma_f32_16x16x32_bf16 v[168:171], a[184:187], v[60:63], v[168:171]
    ds_read_b64_tr_b16 a[204:205], v6 offset:0
    v_cvt_pk_bf16_f32 v202, v172, v173
    v_mfma_f32_16x16x32_bf16 v[168:171], a[180:183], v[56:59], v[168:171]
    v_exp_f32 v175, v175
    v_mfma_f32_16x16x32_bf16 v[168:171], a[176:179], v[52:55], v[168:171]
    ds_read_b64_tr_b16 a[206:207], v6 offset:4096
    v_mfma_f32_16x16x32_bf16 a[112:115], a[216:219], v[212:215], a[112:115]
    v_exp_f32 v176, v176
    v_mfma_f32_16x16x32_bf16 a[112:115], a[220:223], v[216:219], a[112:115]
    v_cvt_pk_bf16_f32 v203, v174, v175
    v_mfma_f32_16x16x32_bf16 a[116:119], a[220:223], v[224:227], a[116:119]
    s_add_u32 m0, s46, 84992
    s_mov_b32 s45, 289792
    buffer_load_dwordx4 v254, s[20:23], s45 offen sc1 lds
    v_exp_f32 v177, v177
    v_mfma_f32_16x16x32_bf16 a[116:119], a[216:219], v[220:223], a[116:119]
    s_add_u32 m0, s46, 86016
    s_mov_b32 s45, 290816
    buffer_load_dwordx4 v254, s[20:23], s45 offen sc1 lds
    v_mfma_f32_16x16x32_bf16 a[120:123], a[216:219], v[228:231], a[120:123]
    v_exp_f32 v178, v178
    v_mfma_f32_16x16x32_bf16 a[120:123], a[220:223], v[232:235], a[120:123]
    v_cvt_pk_bf16_f32 v210, v176, v177
    v_mfma_f32_16x16x32_bf16 a[124:127], a[220:223], v[240:243], a[124:127]
    v_exp_f32 v179, v179
    v_mfma_f32_16x16x32_bf16 a[124:127], a[216:219], v[236:239], a[124:127]
    v_smfmac_f32_16x16x64_bf16 a[236:239], v[244:247], v[236:243], v248
    s_waitcnt lgkmcnt(4)
    v_mfma_f32_16x16x32_bf16 v[172:175], a[176:179], v[68:71], v[108:111]
    v_exp_f32 v116, v116
    v_mfma_f32_16x16x32_bf16 v[172:175], a[180:183], v[72:75], v[172:175]
    ds_read_b64_tr_b16 a[208:209], v7 offset:57344
    v_cvt_pk_bf16_f32 v211, v178, v179
    v_mfma_f32_16x16x32_bf16 v[172:175], a[184:187], v[76:79], v[172:175]
    v_exp_f32 v117, v117
    v_mfma_f32_16x16x32_bf16 v[172:175], a[188:191], v[80:83], v[172:175]
    ds_read_b64_tr_b16 a[210:211], v7 offset:61440
    v_mfma_f32_16x16x32_bf16 v[176:179], a[188:191], v[96:99], v[112:115]
    v_exp_f32 v118, v118
    v_mfma_f32_16x16x32_bf16 v[176:179], a[184:187], v[92:95], v[176:179]
    ds_read_b64_tr_b16 a[212:213], v7 offset:0
    v_cvt_pk_bf16_f32 v212, v116, v117
    v_mfma_f32_16x16x32_bf16 v[176:179], a[180:183], v[88:91], v[176:179]
    v_exp_f32 v119, v119
    v_mfma_f32_16x16x32_bf16 v[176:179], a[176:179], v[84:87], v[176:179]
    ds_read_b64_tr_b16 a[214:215], v7 offset:4096
    v_mfma_f32_16x16x32_bf16 a[0:3], a[192:195], v[180:183], a[0:3]
    v_exp_f32 v120, v120
    v_mfma_f32_16x16x32_bf16 a[0:3], a[196:199], v[184:187], a[0:3]
    s_add_u32 m0, s46, 87040
    s_mov_b32 s45, 307200
    buffer_load_dwordx4 v254, s[20:23], s45 offen sc1 lds
    v_cvt_pk_bf16_f32 v213, v118, v119
    v_mfma_f32_16x16x32_bf16 a[4:7], a[196:199], v[192:195], a[4:7]
    v_exp_f32 v121, v121
    v_mfma_f32_16x16x32_bf16 a[4:7], a[192:195], v[188:191], a[4:7]
    s_add_u32 m0, s46, 88064
    s_mov_b32 s45, 308224
    buffer_load_dwordx4 v254, s[20:23], s45 offen sc1 lds
    v_mfma_f32_16x16x32_bf16 a[8:11], a[192:195], v[196:199], a[8:11]
    v_exp_f32 v122, v122
    v_mfma_f32_16x16x32_bf16 a[8:11], a[196:199], v[200:203], a[8:11]
    v_cvt_pk_bf16_f32 v220, v120, v121
    v_mfma_f32_16x16x32_bf16 a[12:15], a[196:199], v[208:211], a[12:15]
    v_exp_f32 v123, v123
    v_mfma_f32_16x16x32_bf16 a[12:15], a[192:195], v[204:207], a[12:15]
    s_waitcnt lgkmcnt(4)
    s_add_u32 m0, s46, 89088
    s_mov_b32 s45, 309248
    buffer_load_dwordx4 v254, s[20:23], s45 offen sc1 lds
    v_mfma_f32_16x16x32_bf16 a[16:19], a[200:203], v[180:183], a[16:19]
    ds_read_b64_tr_b16 a[216:217], v8 offset:57344
    v_cvt_pk_bf16_f32 v221, v122, v123
    v_exp_f32 v124, v124
    v_mfma_f32_16x16x32_bf16 a[16:19], a[204:207], v[184:187], a[16:19]
    ds_read_b64_tr_b16 a[218:219], v8 offset:61440
    v_exp_f32 v125, v125
    v_mfma_f32_16x16x32_bf16 a[20:23], a[204:207], v[192:195], a[20:23]
    ds_read_b64_tr_b16 a[220:221], v8 offset:0
    v_cvt_pk_bf16_f32 v228, v124, v125
    v_exp_f32 v126, v126
    v_mov_b32 v114, v254
    v_mfma_f32_16x16x32_bf16 a[20:23], a[200:203], v[188:191], a[20:23]
    ds_read_b64_tr_b16 a[222:223], v8 offset:4096
    v_exp_f32 v127, v127
    v_mfma_f32_16x16x32_bf16 a[24:27], a[200:203], v[196:199], a[24:27]
    v_cvt_pk_bf16_f32 v229, v126, v127
    v_exp_f32 v128, v128
    v_mfma_f32_16x16x32_bf16 a[24:27], a[204:207], v[200:203], a[24:27]
    v_exp_f32 v129, v129
    v_add_u32 v115, 4096, v254
    v_mfma_f32_16x16x32_bf16 a[28:31], a[204:207], v[208:211], a[28:31]
    v_cvt_pk_bf16_f32 v236, v128, v129
    v_exp_f32 v130, v130
    v_mfma_f32_16x16x32_bf16 a[28:31], a[200:203], v[204:207], a[28:31]
    v_exp_f32 v131, v131
    v_smfmac_f32_16x16x64_bf16 a[224:227], v[244:247], v[180:187], v248
    s_waitcnt lgkmcnt(4)
    s_add_u32 m0, s46, 90112
    s_mov_b32 s45, 310272
    buffer_load_dwordx4 v254, s[20:23], s45 offen sc1 lds
    v_mov_b32 v0, 2
    v_mfma_f32_16x16x32_bf16 a[32:35], a[208:211], v[180:183], a[32:35]
    ds_read_b64_tr_b16 a[192:193], v9 offset:57344
    v_cvt_pk_bf16_f32 v237, v130, v131
    v_exp_f32 v132, v132
    v_mfma_f32_16x16x32_bf16 a[32:35], a[212:215], v[184:187], a[32:35]
    ds_read_b64_tr_b16 a[194:195], v9 offset:61440
    v_exp_f32 v133, v133
    v_mfma_f32_16x16x32_bf16 a[36:39], a[212:215], v[192:195], a[36:39]
    ds_read_b64_tr_b16 a[196:197], v9 offset:0
    v_cvt_pk_bf16_f32 v214, v132, v133
    v_exp_f32 v134, v134
    v_mfma_f32_16x16x32_bf16 a[36:39], a[208:211], v[188:191], a[36:39]
    ds_read_b64_tr_b16 a[198:199], v9 offset:4096
    v_exp_f32 v135, v135
    v_mfma_f32_16x16x32_bf16 a[40:43], a[208:211], v[196:199], a[40:43]
    v_cvt_pk_bf16_f32 v215, v134, v135
    v_exp_f32 v136, v136
    v_mfma_f32_16x16x32_bf16 a[40:43], a[212:215], v[200:203], a[40:43]
    v_exp_f32 v137, v137
    v_mfma_f32_16x16x32_bf16 a[44:47], a[212:215], v[208:211], a[44:47]
    v_cvt_pk_bf16_f32 v222, v136, v137
    v_exp_f32 v138, v138
    v_mfma_f32_16x16x32_bf16 a[44:47], a[208:211], v[204:207], a[44:47]
    s_waitcnt lgkmcnt(4)
    s_add_u32 m0, s46, 91136
    s_mov_b32 s45, 311296
    buffer_load_dwordx4 v254, s[20:23], s45 offen sc1 lds
    v_exp_f32 v139, v139
    v_mfma_f32_16x16x32_bf16 a[48:51], a[216:219], v[180:183], a[48:51]
    s_mov_b32 s45, 0
    ds_read_b64_tr_b16 a[200:201], v10 offset:57344
    v_cvt_pk_bf16_f32 v223, v138, v139
    v_exp_f32 v140, v140
    v_mfma_f32_16x16x32_bf16 a[48:51], a[220:223], v[184:187], a[48:51]
    ds_read_b64_tr_b16 a[202:203], v10 offset:61440
    v_exp_f32 v141, v141
    v_mfma_f32_16x16x32_bf16 a[52:55], a[220:223], v[192:195], a[52:55]
    ds_read_b64_tr_b16 a[204:205], v10 offset:0
    buffer_load_dwordx4 a[128:131], v114, s[20:23], s45 offen offset:0 sc1
    v_cvt_pk_bf16_f32 v230, v140, v141
    v_exp_f32 v142, v142
    v_mfma_f32_16x16x32_bf16 a[52:55], a[216:219], v[188:191], a[52:55]
    s_mov_b32 s45, 0
    ds_read_b64_tr_b16 a[206:207], v10 offset:4096
    v_exp_f32 v143, v143
    v_mfma_f32_16x16x32_bf16 a[56:59], a[216:219], v[196:199], a[56:59]
    v_cvt_pk_bf16_f32 v231, v142, v143
    v_exp_f32 v144, v144
    v_mfma_f32_16x16x32_bf16 a[56:59], a[220:223], v[200:203], a[56:59]
    buffer_load_dwordx4 a[132:135], v114, s[20:23], s45 offen offset:1024 sc1
    v_exp_f32 v145, v145
    v_mfma_f32_16x16x32_bf16 a[60:63], a[220:223], v[208:211], a[60:63]
    s_mov_b32 s45, 0
    v_cvt_pk_bf16_f32 v238, v144, v145
    v_exp_f32 v146, v146
    v_mfma_f32_16x16x32_bf16 a[60:63], a[216:219], v[204:207], a[60:63]
    v_exp_f32 v147, v147
    v_smfmac_f32_16x16x64_bf16 a[228:231], v[244:247], v[188:195], v248
    s_waitcnt lgkmcnt(4)
    buffer_load_dwordx4 a[136:139], v114, s[20:23], s45 offen offset:2048 sc1
    v_mfma_f32_16x16x32_bf16 a[64:67], a[192:195], v[180:183], a[64:67]
    s_mov_b32 s45, 0
    ds_read_b64_tr_b16 a[208:209], v11 offset:57344
    v_cvt_pk_bf16_f32 v239, v146, v147
    v_exp_f32 v148, v148
    v_mfma_f32_16x16x32_bf16 a[64:67], a[196:199], v[184:187], a[64:67]
    ds_read_b64_tr_b16 a[210:211], v11 offset:61440
    buffer_load_dwordx4 a[140:143], v114, s[20:23], s45 offen offset:3072 sc1
    v_exp_f32 v149, v149
    v_mfma_f32_16x16x32_bf16 a[68:71], a[196:199], v[192:195], a[68:71]
    s_mov_b32 s45, 0
    ds_read_b64_tr_b16 a[212:213], v11 offset:0
    v_cvt_pk_bf16_f32 v216, v148, v149
    v_exp_f32 v150, v150
    v_mfma_f32_16x16x32_bf16 a[68:71], a[192:195], v[188:191], a[68:71]
    ds_read_b64_tr_b16 a[214:215], v11 offset:4096
    v_exp_f32 v151, v151
    v_mfma_f32_16x16x32_bf16 a[72:75], a[192:195], v[196:199], a[72:75]
    buffer_load_dwordx4 a[144:147], v115, s[20:23], s45 offen offset:0 sc1
    v_cvt_pk_bf16_f32 v217, v150, v151
    v_exp_f32 v152, v152
    v_mfma_f32_16x16x32_bf16 a[72:75], a[196:199], v[200:203], a[72:75]
    s_mov_b32 s45, 20480
    v_exp_f32 v153, v153
    v_mfma_f32_16x16x32_bf16 a[76:79], a[196:199], v[208:211], a[76:79]
    buffer_load_dwordx4 a[148:151], v114, s[20:23], s45 offen offset:0 sc1
    v_cvt_pk_bf16_f32 v224, v152, v153
    v_exp_f32 v154, v154
    v_mfma_f32_16x16x32_bf16 a[76:79], a[192:195], v[204:207], a[76:79]
    s_waitcnt lgkmcnt(4)
    v_exp_f32 v155, v155
    v_mfma_f32_16x16x32_bf16 a[80:83], a[200:203], v[180:183], a[80:83]
    s_mov_b32 s45, 20480
    ds_read_b64_tr_b16 a[216:217], v12 offset:57344
    v_cvt_pk_bf16_f32 v225, v154, v155
    v_exp_f32 v156, v156
    v_mfma_f32_16x16x32_bf16 a[80:83], a[204:207], v[184:187], a[80:83]
    ds_read_b64_tr_b16 a[218:219], v12 offset:61440
    buffer_load_dwordx4 a[152:155], v114, s[20:23], s45 offen offset:1024 sc1
    v_exp_f32 v157, v157
    v_mfma_f32_16x16x32_bf16 a[84:87], a[204:207], v[192:195], a[84:87]
    s_mov_b32 s45, 20480
    ds_read_b64_tr_b16 a[220:221], v12 offset:0
    v_cvt_pk_bf16_f32 v232, v156, v157
    v_exp_f32 v158, v158
    v_mfma_f32_16x16x32_bf16 a[84:87], a[200:203], v[188:191], a[84:87]
    ds_read_b64_tr_b16 a[222:223], v12 offset:4096
    v_exp_f32 v159, v159
    v_mfma_f32_16x16x32_bf16 a[88:91], a[200:203], v[196:199], a[88:91]
    buffer_load_dwordx4 a[156:159], v114, s[20:23], s45 offen offset:2048 sc1
    v_cvt_pk_bf16_f32 v233, v158, v159
    v_exp_f32 v160, v160
    v_mfma_f32_16x16x32_bf16 a[88:91], a[204:207], v[200:203], a[88:91]
    s_mov_b32 s45, 20480
    v_exp_f32 v161, v161
    v_mfma_f32_16x16x32_bf16 a[92:95], a[204:207], v[208:211], a[92:95]
    v_cvt_pk_bf16_f32 v240, v160, v161
    v_exp_f32 v162, v162
    v_mfma_f32_16x16x32_bf16 a[92:95], a[200:203], v[204:207], a[92:95]
    buffer_load_dwordx4 a[160:163], v114, s[20:23], s45 offen offset:3072 sc1
    v_exp_f32 v163, v163
    v_smfmac_f32_16x16x64_bf16 a[232:235], v[244:247], v[196:203], v248
    s_waitcnt vmcnt(20) lgkmcnt(0)
    s_barrier
    v_mfma_f32_16x16x32_bf16 a[96:99], a[208:211], v[180:183], a[96:99]
    s_mov_b32 s45, 20480
    ds_read_b64_tr_b16 a[192:193], v5 offset:24576
    buffer_load_dwordx4 a[164:167], v115, s[20:23], s45 offen offset:0 sc1
    v_cvt_pk_bf16_f32 v241, v162, v163
    v_exp_f32 v164, v164
    v_mfma_f32_16x16x32_bf16 a[96:99], a[212:215], v[184:187], a[96:99]
    s_mov_b32 s45, 40960
    ds_read_b64_tr_b16 a[194:195], v5 offset:28672
    v_exp_f32 v165, v165
    v_mfma_f32_16x16x32_bf16 a[100:103], a[212:215], v[192:195], a[100:103]
    ds_read_b64_tr_b16 a[196:197], v5 offset:49152
    v_cvt_pk_bf16_f32 v218, v164, v165
    v_exp_f32 v166, v166
    v_mfma_f32_16x16x32_bf16 a[100:103], a[208:211], v[188:191], a[100:103]
    ds_read_b64_tr_b16 a[198:199], v5 offset:53248
    buffer_load_dwordx4 a[168:171], v114, s[20:23], s45 offen offset:0 sc1
    v_exp_f32 v167, v167
    v_mfma_f32_16x16x32_bf16 a[104:107], a[208:211], v[196:199], a[104:107]
    s_mov_b32 s45, 40960
    v_cvt_pk_bf16_f32 v219, v166, v167
    v_exp_f32 v168, v168
    v_mfma_f32_16x16x32_bf16 a[104:107], a[212:215], v[200:203], a[104:107]
    buffer_load_dwordx4 a[172:175], v114, s[20:23], s45 offen offset:1024 sc1
    v_exp_f32 v169, v169
    v_mfma_f32_16x16x32_bf16 a[108:111], a[212:215], v[208:211], a[108:111]
    s_mov_b32 s45, 40960
    v_cvt_pk_bf16_f32 v226, v168, v169
    v_exp_f32 v170, v170
    v_mfma_f32_16x16x32_bf16 a[108:111], a[208:211], v[204:207], a[108:111]
    s_waitcnt lgkmcnt(4)
    s_cmp_lg_u32 s5, 0
    s_cbranch_scc1 L_ffn_flagged
    s_mov_b64 exec, 1
    buffer_store_dword v0, off, s[76:79], s75 sc1
    s_mov_b64 exec, -1
L_ffn_flagged:
    v_exp_f32 v171, v171
    v_mfma_f32_16x16x32_bf16 a[112:115], a[216:219], v[180:183], a[112:115]
    ds_read_b64_tr_b16 a[200:201], v6 offset:24576
    buffer_load_dwordx4 a[176:179], v114, s[20:23], s45 offen offset:2048 sc1
    v_cvt_pk_bf16_f32 v227, v170, v171
    v_exp_f32 v172, v172
    v_mfma_f32_16x16x32_bf16 a[112:115], a[220:223], v[184:187], a[112:115]
    s_mov_b32 s45, 40960
    ds_read_b64_tr_b16 a[202:203], v6 offset:28672
    v_exp_f32 v173, v173
    v_mfma_f32_16x16x32_bf16 a[116:119], a[220:223], v[192:195], a[116:119]
    ds_read_b64_tr_b16 a[204:205], v6 offset:49152
    v_cvt_pk_bf16_f32 v234, v172, v173
    v_exp_f32 v174, v174
    v_mfma_f32_16x16x32_bf16 a[116:119], a[216:219], v[188:191], a[116:119]
    ds_read_b64_tr_b16 a[206:207], v6 offset:53248
    buffer_load_dwordx4 a[180:183], v114, s[20:23], s45 offen offset:3072 sc1
    v_exp_f32 v175, v175
    v_mfma_f32_16x16x32_bf16 a[120:123], a[216:219], v[196:199], a[120:123]
    s_mov_b32 s45, 40960
    v_cvt_pk_bf16_f32 v235, v174, v175
    v_exp_f32 v176, v176
    v_mfma_f32_16x16x32_bf16 a[120:123], a[220:223], v[200:203], a[120:123]
    v_exp_f32 v177, v177
    v_mfma_f32_16x16x32_bf16 a[124:127], a[220:223], v[208:211], a[124:127]
    buffer_load_dwordx4 a[184:187], v115, s[20:23], s45 offen offset:0 sc1
    v_cvt_pk_bf16_f32 v242, v176, v177
    v_exp_f32 v178, v178
    v_mfma_f32_16x16x32_bf16 a[124:127], a[216:219], v[204:207], a[124:127]
    s_mov_b32 s45, 61440
    v_exp_f32 v179, v179
    v_smfmac_f32_16x16x64_bf16 a[236:239], v[244:247], v[204:211], v248
    s_waitcnt lgkmcnt(4)
    buffer_load_dwordx4 a[188:191], v114, s[20:23], s45 offen offset:0 sc1
    v_mfma_f32_16x16x32_bf16 a[0:3], a[192:195], v[212:215], a[0:3]
    s_lshl_b32 s40, s87, 2
    ds_read_b64_tr_b16 a[208:209], v7 offset:24576
    v_cvt_pk_bf16_f32 v243, v178, v179
    v_mfma_f32_16x16x32_bf16 a[0:3], a[196:199], v[216:219], a[0:3]
    s_add_u32 s40, s40, s5
    ds_read_b64_tr_b16 a[210:211], v7 offset:28672
    v_smfmac_f32_16x16x64_bf16 a[224:227], v[244:247], v[212:219], v248
    s_lshl_b32 s40, s40, 4
    ds_read_b64_tr_b16 a[212:213], v7 offset:49152
    v_and_b32 v35, 15, v19
    v_smfmac_f32_16x16x64_bf16 a[228:231], v[244:247], v[220:227], v248
    ds_read_b64_tr_b16 a[214:215], v7 offset:53248
    v_add_u32 v35, s40, v35
    v_smfmac_f32_16x16x64_bf16 a[232:235], v[244:247], v[228:235], v248
    v_mul_u32_u24 v34, 1280, v35
    v_lshrrev_b32 v116, 4, v19
    v_smfmac_f32_16x16x64_bf16 a[236:239], v[244:247], v[236:243], v248
    v_lshl_add_u32 v34, v116, 3, v34
    v_mfma_f32_16x16x32_bf16 a[4:7], a[196:199], v[224:227], a[4:7]
    s_mul_i32 s40, s100, 160
    v_add_u32 v34, s40, v34
    v_lshlrev_b32 v116, 4, v35
    v_mfma_f32_16x16x32_bf16 a[4:7], a[192:195], v[220:223], a[4:7]
    s_mov_b32 s40, 0x280000
    buffer_load_dwordx2 v[32:33], v116, s[76:79], s40 offen sc1
    v_mfma_f32_16x16x32_bf16 a[8:11], a[192:195], v[228:231], a[8:11]
    buffer_load_dwordx2 v[22:23], v34, s[88:91], 0 offen offset:0
    v_mfma_f32_16x16x32_bf16 a[8:11], a[196:199], v[232:235], a[8:11]
    buffer_load_dwordx2 v[24:25], v34, s[88:91], 0 offen offset:32
    v_mfma_f32_16x16x32_bf16 a[12:15], a[196:199], v[240:243], a[12:15]
    buffer_load_dwordx2 v[26:27], v34, s[88:91], 0 offen offset:64
    v_mfma_f32_16x16x32_bf16 a[12:15], a[192:195], v[236:239], a[12:15]
    s_waitcnt lgkmcnt(4)
    buffer_load_dwordx2 v[28:29], v34, s[88:91], 0 offen offset:96
    v_mfma_f32_16x16x32_bf16 a[16:19], a[200:203], v[212:215], a[16:19]
    ds_read_b64_tr_b16 a[216:217], v8 offset:24576
    v_accvgpr_read_b32 v100, a224
    v_mfma_f32_16x16x32_bf16 a[16:19], a[204:207], v[216:219], a[16:19]
    ds_read_b64_tr_b16 a[218:219], v8 offset:28672
    v_accvgpr_read_b32 v104, a225
    v_accvgpr_read_b32 v101, a228
    v_accvgpr_read_b32 v105, a229
    v_mfma_f32_16x16x32_bf16 a[20:23], a[204:207], v[224:227], a[20:23]
    ds_read_b64_tr_b16 a[220:221], v8 offset:49152
    v_accvgpr_read_b32 v102, a232
    v_accvgpr_read_b32 v106, a233
    v_mfma_f32_16x16x32_bf16 a[20:23], a[200:203], v[220:223], a[20:23]
    ds_read_b64_tr_b16 a[222:223], v8 offset:53248
    v_accvgpr_read_b32 v103, a236
    v_accvgpr_read_b32 v107, a237
    v_add_f32 v100, v100, v104
    v_mfma_f32_16x16x32_bf16 a[24:27], a[200:203], v[228:231], a[24:27]
    buffer_load_dwordx2 v[30:31], v34, s[88:91], 0 offen offset:128
    v_add_f32 v101, v101, v105
    v_add_f32 v102, v102, v106
    v_add_f32 v103, v103, v107
    v_mfma_f32_16x16x32_bf16 a[24:27], a[204:207], v[232:235], a[24:27]
    v_lshlrev_b32 v20, 7, v19
    v_add_u32 v20, 0x290000, v20
    v_maximum3_f32 v108, v100, v101, v102
    v_maximum3_f32 v108, v108, v103, v103
    v_mfma_f32_16x16x32_bf16 a[28:31], a[204:207], v[240:243], a[28:31]
    s_cmp_lg_u32 s5, 0
    s_cbranch_scc1 L_no_yflag
    buffer_load_dwordx4 v[252:255], v20, s[76:79], 0 offen sc1
L_no_yflag:
    v_mul_f32 v108, 0x4d800000, v108
    v_mov_b32 v109, 0
    v_lshlrev_b32 v110, 4, v19
    v_mfma_f32_16x16x32_bf16 a[28:31], a[200:203], v[236:239], a[28:31]
    s_waitcnt lgkmcnt(4)
    v_rcp_f32 v100, v100
    v_rcp_f32 v101, v101
    v_rcp_f32 v102, v102
    v_rcp_f32 v103, v103
    v_mfma_f32_16x16x32_bf16 a[32:35], a[208:211], v[212:215], a[32:35]
    s_mov_b32 s36, 0
    ds_read_b64_tr_b16 a[192:193], v9 offset:24576
    v_accvgpr_read_b32 v120, a0
    v_accvgpr_read_b32 v121, a1
    v_accvgpr_read_b32 v122, a2
    v_accvgpr_read_b32 v123, a3
    v_mfma_f32_16x16x32_bf16 a[32:35], a[212:215], v[216:219], a[32:35]
    ds_read_b64_tr_b16 a[194:195], v9 offset:28672
    v_accvgpr_read_b32 v124, a16
    v_accvgpr_read_b32 v125, a17
    v_accvgpr_read_b32 v126, a18
    v_accvgpr_read_b32 v127, a19
    v_maximum3_f32 v108, v108, |v120|, |v121|
    v_maximum3_f32 v109, v109, |v122|, |v123|
    v_mfma_f32_16x16x32_bf16 a[36:39], a[212:215], v[224:227], a[36:39]
    ds_read_b64_tr_b16 a[196:197], v9 offset:49152
    v_maximum3_f32 v108, v108, |v124|, |v125|
    v_maximum3_f32 v109, v109, |v126|, |v127|
    v_mul_f32 v120, v120, v100
    v_mul_f32 v121, v121, v100
    v_mul_f32 v122, v122, v100
    v_mul_f32 v123, v123, v100
    v_mfma_f32_16x16x32_bf16 a[36:39], a[208:211], v[220:223], a[36:39]
    ds_read_b64_tr_b16 a[198:199], v9 offset:53248
    v_mul_f32 v124, v124, v100
    v_mul_f32 v125, v125, v100
    v_mul_f32 v126, v126, v100
    v_mul_f32 v127, v127, v100
    v_cvt_pk_bf16_f32 v152, v120, v121
    v_cvt_pk_bf16_f32 v153, v122, v123
    v_cvt_pk_bf16_f32 v154, v124, v125
    v_mfma_f32_16x16x32_bf16 a[40:43], a[208:211], v[228:231], a[40:43]
    v_cvt_pk_bf16_f32 v155, v126, v127
    v_mfma_f32_16x16x32_bf16 a[40:43], a[212:215], v[232:235], a[40:43]
    buffer_store_dwordx4 v[152:155], v110, s[24:27], s36 offen offset:0 sc1
    v_accvgpr_read_b32 v128, a4
    v_accvgpr_read_b32 v129, a5
    v_accvgpr_read_b32 v130, a6
    v_accvgpr_read_b32 v131, a7
    v_accvgpr_read_b32 v132, a20
    v_accvgpr_read_b32 v133, a21
    v_accvgpr_read_b32 v134, a22
    v_accvgpr_read_b32 v135, a23
    v_maximum3_f32 v108, v108, |v128|, |v129|
    v_maximum3_f32 v109, v109, |v130|, |v131|
    v_mfma_f32_16x16x32_bf16 a[44:47], a[212:215], v[240:243], a[44:47]
    v_maximum3_f32 v108, v108, |v132|, |v133|
    v_maximum3_f32 v109, v109, |v134|, |v135|
    v_mul_f32 v128, v128, v101
    v_mul_f32 v129, v129, v101
    v_mul_f32 v130, v130, v101
    v_mul_f32 v131, v131, v101
    v_mul_f32 v132, v132, v101
    v_mfma_f32_16x16x32_bf16 a[44:47], a[208:211], v[236:239], a[44:47]
    s_waitcnt lgkmcnt(4)
    v_mul_f32 v133, v133, v101
    v_mul_f32 v134, v134, v101
    v_mul_f32 v135, v135, v101
    v_cvt_pk_bf16_f32 v156, v128, v129
    v_cvt_pk_bf16_f32 v157, v130, v131
    v_cvt_pk_bf16_f32 v158, v132, v133
    v_mfma_f32_16x16x32_bf16 a[48:51], a[216:219], v[212:215], a[48:51]
    ds_read_b64_tr_b16 a[200:201], v10 offset:24576
    v_cvt_pk_bf16_f32 v159, v134, v135
    v_mfma_f32_16x16x32_bf16 a[48:51], a[220:223], v[216:219], a[48:51]
    ds_read_b64_tr_b16 a[202:203], v10 offset:28672
    buffer_store_dwordx4 v[156:159], v110, s[24:27], s36 offen offset:1024 sc1
    v_accvgpr_read_b32 v136, a8
    v_accvgpr_read_b32 v137, a9
    v_accvgpr_read_b32 v138, a10
    v_accvgpr_read_b32 v139, a11
    v_accvgpr_read_b32 v140, a24
    v_accvgpr_read_b32 v141, a25
    v_accvgpr_read_b32 v142, a26
    v_accvgpr_read_b32 v143, a27
    v_maximum3_f32 v108, v108, |v136|, |v137|
    v_maximum3_f32 v109, v109, |v138|, |v139|
    v_maximum3_f32 v108, v108, |v140|, |v141|
    v_mfma_f32_16x16x32_bf16 a[52:55], a[220:223], v[224:227], a[52:55]
    ds_read_b64_tr_b16 a[204:205], v10 offset:49152
    v_maximum3_f32 v109, v109, |v142|, |v143|
    v_mul_f32 v136, v136, v102
    v_mul_f32 v137, v137, v102
    v_mul_f32 v138, v138, v102
    v_mul_f32 v139, v139, v102
    v_mul_f32 v140, v140, v102
    v_mfma_f32_16x16x32_bf16 a[52:55], a[216:219], v[220:223], a[52:55]
    ds_read_b64_tr_b16 a[206:207], v10 offset:53248
    v_mul_f32 v141, v141, v102
    v_mul_f32 v142, v142, v102
    v_mul_f32 v143, v143, v102
    v_cvt_pk_bf16_f32 v160, v136, v137
    v_cvt_pk_bf16_f32 v161, v138, v139
    v_cvt_pk_bf16_f32 v162, v140, v141
    v_mfma_f32_16x16x32_bf16 a[56:59], a[216:219], v[228:231], a[56:59]
    v_cvt_pk_bf16_f32 v163, v142, v143
    v_mfma_f32_16x16x32_bf16 a[56:59], a[220:223], v[232:235], a[56:59]
    buffer_store_dwordx4 v[160:163], v110, s[24:27], s36 offen offset:2048 sc1
    v_accvgpr_read_b32 v144, a12
    v_accvgpr_read_b32 v145, a13
    v_accvgpr_read_b32 v146, a14
    v_accvgpr_read_b32 v147, a15
    v_accvgpr_read_b32 v148, a28
    v_accvgpr_read_b32 v149, a29
    v_accvgpr_read_b32 v150, a30
    v_accvgpr_read_b32 v151, a31
    v_maximum3_f32 v108, v108, |v144|, |v145|
    v_maximum3_f32 v109, v109, |v146|, |v147|
    v_maximum3_f32 v108, v108, |v148|, |v149|
    v_mfma_f32_16x16x32_bf16 a[60:63], a[220:223], v[240:243], a[60:63]
    v_maximum3_f32 v109, v109, |v150|, |v151|
    v_mul_f32 v144, v144, v103
    v_mul_f32 v145, v145, v103
    v_mul_f32 v146, v146, v103
    v_mul_f32 v147, v147, v103
    v_mul_f32 v148, v148, v103
    v_mfma_f32_16x16x32_bf16 a[60:63], a[216:219], v[236:239], a[60:63]
    s_waitcnt lgkmcnt(4)
    v_mul_f32 v149, v149, v103
    v_mul_f32 v150, v150, v103
    v_mul_f32 v151, v151, v103
    v_cvt_pk_bf16_f32 v164, v144, v145
    v_cvt_pk_bf16_f32 v165, v146, v147
    v_cvt_pk_bf16_f32 v166, v148, v149
    v_cvt_pk_bf16_f32 v167, v150, v151
    buffer_store_dwordx4 v[164:167], v110, s[24:27], s36 offen offset:3072 sc1
    v_mfma_f32_16x16x32_bf16 a[64:67], a[192:195], v[212:215], a[64:67]
    s_mov_b32 s36, 4096
    ds_read_b64_tr_b16 a[208:209], v11 offset:24576
    v_accvgpr_read_b32 v120, a32
    v_accvgpr_read_b32 v121, a33
    v_accvgpr_read_b32 v122, a34
    v_accvgpr_read_b32 v123, a35
    v_accvgpr_read_b32 v124, a48
    v_mfma_f32_16x16x32_bf16 a[64:67], a[196:199], v[216:219], a[64:67]
    ds_read_b64_tr_b16 a[210:211], v11 offset:28672
    v_accvgpr_read_b32 v125, a49
    v_accvgpr_read_b32 v126, a50
    v_accvgpr_read_b32 v127, a51
    v_maximum3_f32 v108, v108, |v120|, |v121|
    v_maximum3_f32 v109, v109, |v122|, |v123|
    v_maximum3_f32 v108, v108, |v124|, |v125|
    v_maximum3_f32 v109, v109, |v126|, |v127|
    v_mfma_f32_16x16x32_bf16 a[68:71], a[196:199], v[224:227], a[68:71]
    ds_read_b64_tr_b16 a[212:213], v11 offset:49152
    v_mul_f32 v120, v120, v100
    v_mul_f32 v121, v121, v100
    v_mul_f32 v122, v122, v100
    v_mul_f32 v123, v123, v100
    v_mul_f32 v124, v124, v100
    v_mul_f32 v125, v125, v100
    v_mul_f32 v126, v126, v100
    v_mfma_f32_16x16x32_bf16 a[68:71], a[192:195], v[220:223], a[68:71]
    ds_read_b64_tr_b16 a[214:215], v11 offset:53248
    v_mul_f32 v127, v127, v100
    v_cvt_pk_bf16_f32 v152, v120, v121
    v_cvt_pk_bf16_f32 v153, v122, v123
    v_cvt_pk_bf16_f32 v154, v124, v125
    v_cvt_pk_bf16_f32 v155, v126, v127
    v_mfma_f32_16x16x32_bf16 a[72:75], a[192:195], v[228:231], a[72:75]
    buffer_store_dwordx4 v[152:155], v110, s[24:27], s36 offen offset:0 sc1
    v_mfma_f32_16x16x32_bf16 a[72:75], a[196:199], v[232:235], a[72:75]
    s_mov_b32 s45, 61440
    buffer_load_dwordx4 a[0:3], v114, s[20:23], s45 offen offset:1024 sc1
    v_mfma_f32_16x16x32_bf16 a[76:79], a[196:199], v[240:243], a[76:79]
    s_mov_b32 s45, 61440
    buffer_load_dwordx4 a[4:7], v114, s[20:23], s45 offen offset:2048 sc1
    v_accvgpr_read_b32 v128, a36
    v_accvgpr_read_b32 v129, a37
    v_accvgpr_read_b32 v130, a38
    v_accvgpr_read_b32 v131, a39
    v_accvgpr_read_b32 v132, a52
    v_accvgpr_read_b32 v133, a53
    v_accvgpr_read_b32 v134, a54
    v_accvgpr_read_b32 v135, a55
    v_maximum3_f32 v108, v108, |v128|, |v129|
    v_maximum3_f32 v109, v109, |v130|, |v131|
    v_maximum3_f32 v108, v108, |v132|, |v133|
    v_maximum3_f32 v109, v109, |v134|, |v135|
    v_mul_f32 v128, v128, v101
    v_mul_f32 v129, v129, v101
    v_mul_f32 v130, v130, v101
    v_mul_f32 v131, v131, v101
    v_mul_f32 v132, v132, v101
    v_mul_f32 v133, v133, v101
    v_mul_f32 v134, v134, v101
    v_mul_f32 v135, v135, v101
    v_mfma_f32_16x16x32_bf16 a[76:79], a[192:195], v[236:239], a[76:79]
    s_waitcnt lgkmcnt(4)
    v_cvt_pk_bf16_f32 v156, v128, v129
    v_cvt_pk_bf16_f32 v157, v130, v131
    v_cvt_pk_bf16_f32 v158, v132, v133
    v_cvt_pk_bf16_f32 v159, v134, v135
    v_mfma_f32_16x16x32_bf16 a[80:83], a[200:203], v[212:215], a[80:83]
    ds_read_b64_tr_b16 a[216:217], v12 offset:24576
    buffer_store_dwordx4 v[156:159], v110, s[24:27], s36 offen offset:1024 sc1
    v_mfma_f32_16x16x32_bf16 a[80:83], a[204:207], v[216:219], a[80:83]
    s_mov_b32 s45, 61440
    ds_read_b64_tr_b16 a[218:219], v12 offset:28672
    buffer_load_dwordx4 a[8:11], v114, s[20:23], s45 offen offset:3072 sc1
    v_mfma_f32_16x16x32_bf16 a[84:87], a[204:207], v[224:227], a[84:87]
    s_mov_b32 s45, 61440
    ds_read_b64_tr_b16 a[220:221], v12 offset:49152
    buffer_load_dwordx4 a[12:15], v115, s[20:23], s45 offen offset:0 sc1
    v_accvgpr_read_b32 v136, a40
    v_accvgpr_read_b32 v137, a41
    v_accvgpr_read_b32 v138, a42
    v_accvgpr_read_b32 v139, a43
    v_accvgpr_read_b32 v140, a56
    v_accvgpr_read_b32 v141, a57
    v_accvgpr_read_b32 v142, a58
    v_accvgpr_read_b32 v143, a59
    v_maximum3_f32 v108, v108, |v136|, |v137|
    v_maximum3_f32 v109, v109, |v138|, |v139|
    v_maximum3_f32 v108, v108, |v140|, |v141|
    v_maximum3_f32 v109, v109, |v142|, |v143|
    v_mul_f32 v136, v136, v102
    v_mul_f32 v137, v137, v102
    v_mul_f32 v138, v138, v102
    v_mul_f32 v139, v139, v102
    v_mul_f32 v140, v140, v102
    v_mul_f32 v141, v141, v102
    v_mul_f32 v142, v142, v102
    v_mul_f32 v143, v143, v102
    v_mfma_f32_16x16x32_bf16 a[84:87], a[200:203], v[220:223], a[84:87]
    ds_read_b64_tr_b16 a[222:223], v12 offset:53248
    v_cvt_pk_bf16_f32 v160, v136, v137
    v_cvt_pk_bf16_f32 v161, v138, v139
    v_cvt_pk_bf16_f32 v162, v140, v141
    v_cvt_pk_bf16_f32 v163, v142, v143
    v_mfma_f32_16x16x32_bf16 a[88:91], a[200:203], v[228:231], a[88:91]
    buffer_store_dwordx4 v[160:163], v110, s[24:27], s36 offen offset:2048 sc1
    v_mfma_f32_16x16x32_bf16 a[88:91], a[204:207], v[232:235], a[88:91]
    s_mov_b32 s45, 81920
    buffer_load_dwordx4 a[16:19], v114, s[20:23], s45 offen offset:0 sc1
    v_mfma_f32_16x16x32_bf16 a[92:95], a[204:207], v[240:243], a[92:95]
    s_mov_b32 s45, 81920
    buffer_load_dwordx4 a[20:23], v114, s[20:23], s45 offen offset:1024 sc1
    v_accvgpr_read_b32 v144, a44
    v_accvgpr_read_b32 v145, a45
    v_accvgpr_read_b32 v146, a46
    v_accvgpr_read_b32 v147, a47
    v_accvgpr_read_b32 v148, a60
    v_accvgpr_read_b32 v149, a61
    v_accvgpr_read_b32 v150, a62
    v_accvgpr_read_b32 v151, a63
    v_maximum3_f32 v108, v108, |v144|, |v145|
    v_maximum3_f32 v109, v109, |v146|, |v147|
    v_maximum3_f32 v108, v108, |v148|, |v149|
    v_maximum3_f32 v109, v109, |v150|, |v151|
    v_mul_f32 v144, v144, v103
    v_mul_f32 v145, v145, v103
    v_mul_f32 v146, v146, v103
    v_mul_f32 v147, v147, v103
    v_mul_f32 v148, v148, v103
    v_mul_f32 v149, v149, v103
    v_mul_f32 v150, v150, v103
    v_mul_f32 v151, v151, v103
    v_mfma_f32_16x16x32_bf16 a[92:95], a[200:203], v[236:239], a[92:95]
    s_waitcnt lgkmcnt(4)
    v_cvt_pk_bf16_f32 v164, v144, v145
    v_cvt_pk_bf16_f32 v165, v146, v147
    v_cvt_pk_bf16_f32 v166, v148, v149
    v_cvt_pk_bf16_f32 v167, v150, v151
    buffer_store_dwordx4 v[164:167], v110, s[24:27], s36 offen offset:3072 sc1
    s_mov_b32 s45, 81920
    buffer_load_dwordx4 a[24:27], v114, s[20:23], s45 offen offset:2048 sc1
    s_mov_b32 s45, 81920
    buffer_load_dwordx4 a[28:31], v114, s[20:23], s45 offen offset:3072 sc1
    v_mfma_f32_16x16x32_bf16 a[96:99], a[208:211], v[212:215], a[96:99]
    s_mov_b32 s36, 8192
    v_accvgpr_read_b32 v120, a64
    v_accvgpr_read_b32 v121, a65
    v_accvgpr_read_b32 v122, a66
    v_accvgpr_read_b32 v123, a67
    v_accvgpr_read_b32 v124, a80
    v_mfma_f32_16x16x32_bf16 a[96:99], a[212:215], v[216:219], a[96:99]
    v_accvgpr_read_b32 v125, a81
    v_accvgpr_read_b32 v126, a82
    v_accvgpr_read_b32 v127, a83
    v_maximum3_f32 v108, v108, |v120|, |v121|
    v_maximum3_f32 v109, v109, |v122|, |v123|
    v_maximum3_f32 v108, v108, |v124|, |v125|
    v_maximum3_f32 v109, v109, |v126|, |v127|
    v_mfma_f32_16x16x32_bf16 a[100:103], a[212:215], v[224:227], a[100:103]
    v_mul_f32 v120, v120, v100
    v_mul_f32 v121, v121, v100
    v_mul_f32 v122, v122, v100
    v_mul_f32 v123, v123, v100
    v_mul_f32 v124, v124, v100
    v_mul_f32 v125, v125, v100
    v_mul_f32 v126, v126, v100
    v_mfma_f32_16x16x32_bf16 a[100:103], a[208:211], v[220:223], a[100:103]
    v_mul_f32 v127, v127, v100
    v_cvt_pk_bf16_f32 v152, v120, v121
    v_cvt_pk_bf16_f32 v153, v122, v123
    v_cvt_pk_bf16_f32 v154, v124, v125
    v_cvt_pk_bf16_f32 v155, v126, v127
    v_mfma_f32_16x16x32_bf16 a[104:107], a[208:211], v[228:231], a[104:107]
    buffer_store_dwordx4 v[152:155], v110, s[24:27], s36 offen offset:0 sc1
    v_mfma_f32_16x16x32_bf16 a[104:107], a[212:215], v[232:235], a[104:107]
    s_mov_b32 s45, 81920
    buffer_load_dwordx4 a[32:35], v115, s[20:23], s45 offen offset:0 sc1
    v_mfma_f32_16x16x32_bf16 a[108:111], a[212:215], v[240:243], a[108:111]
    s_mov_b32 s45, 102400
    buffer_load_dwordx4 a[36:39], v114, s[20:23], s45 offen offset:0 sc1
    v_accvgpr_read_b32 v128, a68
    v_accvgpr_read_b32 v129, a69
    v_accvgpr_read_b32 v130, a70
    v_accvgpr_read_b32 v131, a71
    v_accvgpr_read_b32 v132, a84
    v_accvgpr_read_b32 v133, a85
    v_accvgpr_read_b32 v134, a86
    v_accvgpr_read_b32 v135, a87
    v_maximum3_f32 v108, v108, |v128|, |v129|
    v_maximum3_f32 v109, v109, |v130|, |v131|
    v_maximum3_f32 v108, v108, |v132|, |v133|
    v_maximum3_f32 v109, v109, |v134|, |v135|
    v_mul_f32 v128, v128, v101
    v_mul_f32 v129, v129, v101
    v_mul_f32 v130, v130, v101
    v_mul_f32 v131, v131, v101
    v_mul_f32 v132, v132, v101
    v_mul_f32 v133, v133, v101
    v_mul_f32 v134, v134, v101
    v_mul_f32 v135, v135, v101
    v_mfma_f32_16x16x32_bf16 a[108:111], a[208:211], v[236:239], a[108:111]
    s_waitcnt lgkmcnt(0)
    v_cvt_pk_bf16_f32 v156, v128, v129
    v_cvt_pk_bf16_f32 v157, v130, v131
    v_cvt_pk_bf16_f32 v158, v132, v133
    v_cvt_pk_bf16_f32 v159, v134, v135
    v_mfma_f32_16x16x32_bf16 a[112:115], a[216:219], v[212:215], a[112:115]
    buffer_store_dwordx4 v[156:159], v110, s[24:27], s36 offen offset:1024 sc1
    v_mfma_f32_16x16x32_bf16 a[112:115], a[220:223], v[216:219], a[112:115]
    s_mov_b32 s45, 102400
    buffer_load_dwordx4 a[40:43], v114, s[20:23], s45 offen offset:1024 sc1
    v_mfma_f32_16x16x32_bf16 a[116:119], a[220:223], v[224:227], a[116:119]
    s_mov_b32 s45, 102400
    buffer_load_dwordx4 a[44:47], v114, s[20:23], s45 offen offset:2048 sc1
    v_accvgpr_read_b32 v136, a72
    v_accvgpr_read_b32 v137, a73
    v_accvgpr_read_b32 v138, a74
    v_accvgpr_read_b32 v139, a75
    v_accvgpr_read_b32 v140, a88
    v_accvgpr_read_b32 v141, a89
    v_accvgpr_read_b32 v142, a90
    v_accvgpr_read_b32 v143, a91
    v_maximum3_f32 v108, v108, |v136|, |v137|
    v_maximum3_f32 v109, v109, |v138|, |v139|
    v_maximum3_f32 v108, v108, |v140|, |v141|
    v_maximum3_f32 v109, v109, |v142|, |v143|
    v_mul_f32 v136, v136, v102
    v_mul_f32 v137, v137, v102
    v_mul_f32 v138, v138, v102
    v_mul_f32 v139, v139, v102
    v_mul_f32 v140, v140, v102
    v_mul_f32 v141, v141, v102
    v_mul_f32 v142, v142, v102
    v_mul_f32 v143, v143, v102
    v_mfma_f32_16x16x32_bf16 a[116:119], a[216:219], v[220:223], a[116:119]
    v_cvt_pk_bf16_f32 v160, v136, v137
    v_cvt_pk_bf16_f32 v161, v138, v139
    v_cvt_pk_bf16_f32 v162, v140, v141
    v_cvt_pk_bf16_f32 v163, v142, v143
    v_mfma_f32_16x16x32_bf16 a[120:123], a[216:219], v[228:231], a[120:123]
    buffer_store_dwordx4 v[160:163], v110, s[24:27], s36 offen offset:2048 sc1
    v_mfma_f32_16x16x32_bf16 a[120:123], a[220:223], v[232:235], a[120:123]
    s_mov_b32 s45, 102400
    buffer_load_dwordx4 a[48:51], v114, s[20:23], s45 offen offset:3072 sc1
    v_mfma_f32_16x16x32_bf16 a[124:127], a[220:223], v[240:243], a[124:127]
    s_mov_b32 s45, 102400
    buffer_load_dwordx4 a[52:55], v115, s[20:23], s45 offen offset:0 sc1
    v_accvgpr_read_b32 v144, a76
    v_accvgpr_read_b32 v145, a77
    v_accvgpr_read_b32 v146, a78
    v_accvgpr_read_b32 v147, a79
    v_accvgpr_read_b32 v148, a92
    v_accvgpr_read_b32 v149, a93
    v_accvgpr_read_b32 v150, a94
    v_accvgpr_read_b32 v151, a95
    v_maximum3_f32 v108, v108, |v144|, |v145|
    v_maximum3_f32 v109, v109, |v146|, |v147|
    v_maximum3_f32 v108, v108, |v148|, |v149|
    v_maximum3_f32 v109, v109, |v150|, |v151|
    v_mul_f32 v144, v144, v103
    v_mul_f32 v145, v145, v103
    v_mul_f32 v146, v146, v103
    v_mul_f32 v147, v147, v103
    v_mul_f32 v148, v148, v103
    v_mul_f32 v149, v149, v103
    v_mul_f32 v150, v150, v103
    v_mul_f32 v151, v151, v103
    v_mfma_f32_16x16x32_bf16 a[124:127], a[216:219], v[236:239], a[124:127]
    v_cvt_pk_bf16_f32 v164, v144, v145
    v_cvt_pk_bf16_f32 v165, v146, v147
    v_cvt_pk_bf16_f32 v166, v148, v149
    v_cvt_pk_bf16_f32 v167, v150, v151
    buffer_store_dwordx4 v[164:167], v110, s[24:27], s36 offen offset:3072 sc1
    s_mov_b32 s45, 122880
    buffer_load_dwordx4 a[56:59], v114, s[20:23], s45 offen offset:0 sc1
    s_mov_b32 s45, 122880
    buffer_load_dwordx4 a[60:63], v114, s[20:23], s45 offen offset:1024 sc1
    s_mov_b32 s36, 12288
    v_accvgpr_read_b32 v120, a96
    v_accvgpr_read_b32 v121, a97
    v_accvgpr_read_b32 v122, a98
    v_accvgpr_read_b32 v123, a99
    v_accvgpr_read_b32 v124, a112
    v_accvgpr_read_b32 v125, a113
    v_accvgpr_read_b32 v126, a114
    v_accvgpr_read_b32 v127, a115
    v_maximum3_f32 v108, v108, |v120|, |v121|
    v_maximum3_f32 v109, v109, |v122|, |v123|
    v_maximum3_f32 v108, v108, |v124|, |v125|
    v_maximum3_f32 v109, v109, |v126|, |v127|
    v_mul_f32 v120, v120, v100
    v_mul_f32 v121, v121, v100
    v_mul_f32 v122, v122, v100
    v_mul_f32 v123, v123, v100
    v_mul_f32 v124, v124, v100
    v_mul_f32 v125, v125, v100
    v_mul_f32 v126, v126, v100
    v_mul_f32 v127, v127, v100
    v_cvt_pk_bf16_f32 v152, v120, v121
    v_cvt_pk_bf16_f32 v153, v122, v123
    v_cvt_pk_bf16_f32 v154, v124, v125
    v_cvt_pk_bf16_f32 v155, v126, v127
    buffer_store_dwordx4 v[152:155], v110, s[24:27], s36 offen offset:0 sc1
    s_mov_b32 s45, 122880
    buffer_load_dwordx4 a[64:67], v114, s[20:23], s45 offen offset:2048 sc1
    s_mov_b32 s45, 122880
    buffer_load_dwordx4 a[68:71], v114, s[20:23], s45 offen offset:3072 sc1
    v_accvgpr_read_b32 v128, a100
    v_accvgpr_read_b32 v129, a101
    v_accvgpr_read_b32 v130, a102
    v_accvgpr_read_b32 v131, a103
    v_accvgpr_read_b32 v132, a116
    v_accvgpr_read_b32 v133, a117
    v_accvgpr_read_b32 v134, a118
    v_accvgpr_read_b32 v135, a119
    v_maximum3_f32 v108, v108, |v128|, |v129|
    v_maximum3_f32 v109, v109, |v130|, |v131|
    v_maximum3_f32 v108, v108, |v132|, |v133|
    v_maximum3_f32 v109, v109, |v134|, |v135|
    v_mul_f32 v128, v128, v101
    v_mul_f32 v129, v129, v101
    v_mul_f32 v130, v130, v101
    v_mul_f32 v131, v131, v101
    v_mul_f32 v132, v132, v101
    v_mul_f32 v133, v133, v101
    v_mul_f32 v134, v134, v101
    v_mul_f32 v135, v135, v101
    v_cvt_pk_bf16_f32 v156, v128, v129
    v_cvt_pk_bf16_f32 v157, v130, v131
    v_cvt_pk_bf16_f32 v158, v132, v133
    v_cvt_pk_bf16_f32 v159, v134, v135
    buffer_store_dwordx4 v[156:159], v110, s[24:27], s36 offen offset:1024 sc1
    s_mov_b32 s45, 122880
    buffer_load_dwordx4 a[72:75], v115, s[20:23], s45 offen offset:0 sc1
    s_mov_b32 s45, 143360
    buffer_load_dwordx4 a[76:79], v114, s[20:23], s45 offen offset:0 sc1
    v_accvgpr_read_b32 v136, a104
    v_accvgpr_read_b32 v137, a105
    v_accvgpr_read_b32 v138, a106
    v_accvgpr_read_b32 v139, a107
    v_accvgpr_read_b32 v140, a120
    v_accvgpr_read_b32 v141, a121
    v_accvgpr_read_b32 v142, a122
    v_accvgpr_read_b32 v143, a123
    v_maximum3_f32 v108, v108, |v136|, |v137|
    v_maximum3_f32 v109, v109, |v138|, |v139|
    v_maximum3_f32 v108, v108, |v140|, |v141|
    v_maximum3_f32 v109, v109, |v142|, |v143|
    v_mul_f32 v136, v136, v102
    v_mul_f32 v137, v137, v102
    v_mul_f32 v138, v138, v102
    v_mul_f32 v139, v139, v102
    v_mul_f32 v140, v140, v102
    v_mul_f32 v141, v141, v102
    v_mul_f32 v142, v142, v102
    v_mul_f32 v143, v143, v102
    v_cvt_pk_bf16_f32 v160, v136, v137
    v_cvt_pk_bf16_f32 v161, v138, v139
    v_cvt_pk_bf16_f32 v162, v140, v141
    v_cvt_pk_bf16_f32 v163, v142, v143
    buffer_store_dwordx4 v[160:163], v110, s[24:27], s36 offen offset:2048 sc1
    s_mov_b32 s45, 143360
    buffer_load_dwordx4 a[80:83], v114, s[20:23], s45 offen offset:1024 sc1
    s_mov_b32 s45, 143360
    buffer_load_dwordx4 a[84:87], v114, s[20:23], s45 offen offset:2048 sc1
    v_accvgpr_read_b32 v144, a108
    v_accvgpr_read_b32 v145, a109
    v_accvgpr_read_b32 v146, a110
    v_accvgpr_read_b32 v147, a111
    v_accvgpr_read_b32 v148, a124
    v_accvgpr_read_b32 v149, a125
    v_accvgpr_read_b32 v150, a126
    v_accvgpr_read_b32 v151, a127
    v_maximum3_f32 v108, v108, |v144|, |v145|
    v_maximum3_f32 v109, v109, |v146|, |v147|
    v_maximum3_f32 v108, v108, |v148|, |v149|
    v_maximum3_f32 v109, v109, |v150|, |v151|
    v_mul_f32 v144, v144, v103
    v_mul_f32 v145, v145, v103
    v_mul_f32 v146, v146, v103
    v_mul_f32 v147, v147, v103
    v_mul_f32 v148, v148, v103
    v_mul_f32 v149, v149, v103
    v_mul_f32 v150, v150, v103
    v_mul_f32 v151, v151, v103
    v_cvt_pk_bf16_f32 v164, v144, v145
    v_cvt_pk_bf16_f32 v165, v146, v147
    v_cvt_pk_bf16_f32 v166, v148, v149
    v_cvt_pk_bf16_f32 v167, v150, v151
    buffer_store_dwordx4 v[164:167], v110, s[24:27], s36 offen offset:3072 sc1
    s_mov_b32 s45, 143360
    buffer_load_dwordx4 a[88:91], v114, s[20:23], s45 offen offset:3072 sc1
    s_mov_b32 s45, 143360
    buffer_load_dwordx4 a[92:95], v115, s[20:23], s45 offen offset:0 sc1
    v_maximum3_f32 v108, v108, v109, v109
    v_cmp_ngt_f32 vcc, 0x7f800000, v108
    s_and_b64 vcc, vcc, exec
    s_cbranch_scc1 L_slow
L_published:
    v_mov_b32 v16, v114
    v_mov_b32 v17, v115
    v_mov_b32 v3, v249
    v_mov_b32 v2, 1
    s_waitcnt vmcnt(40)
    v_lshlrev_b32 v166, 16, v22
    v_and_b32 v167, 0xffff0000, v22
    v_lshlrev_b32 v168, 16, v23
    v_and_b32 v169, 0xffff0000, v23
    v_lshlrev_b32 v170, 16, v24
    v_and_b32 v171, 0xffff0000, v24
    v_lshlrev_b32 v172, 16, v25
    v_and_b32 v173, 0xffff0000, v25
    v_lshlrev_b32 v174, 16, v26
    v_and_b32 v175, 0xffff0000, v26
    v_lshlrev_b32 v176, 16, v27
    v_and_b32 v177, 0xffff0000, v27
    v_lshlrev_b32 v178, 16, v28
    v_and_b32 v179, 0xffff0000, v28
    v_lshlrev_b32 v180, 16, v29
    v_and_b32 v181, 0xffff0000, v29
    v_lshlrev_b32 v182, 16, v30
    v_and_b32 v183, 0xffff0000, v30
    v_lshlrev_b32 v184, 16, v31
    v_and_b32 v185, 0xffff0000, v31
    v_pk_add_f32 v[166:167], v[166:167], v[32:33] op_sel_hi:[1,0] neg_lo:[0,1] neg_hi:[0,1]
    v_pk_add_f32 v[168:169], v[168:169], v[32:33] op_sel_hi:[1,0] neg_lo:[0,1] neg_hi:[0,1]
    v_pk_add_f32 v[170:171], v[170:171], v[32:33] op_sel_hi:[1,0] neg_lo:[0,1] neg_hi:[0,1]
    v_pk_add_f32 v[172:173], v[172:173], v[32:33] op_sel_hi:[1,0] neg_lo:[0,1] neg_hi:[0,1]
    v_pk_add_f32 v[174:175], v[174:175], v[32:33] op_sel_hi:[1,0] neg_lo:[0,1] neg_hi:[0,1]
    v_pk_add_f32 v[176:177], v[176:177], v[32:33] op_sel_hi:[1,0] neg_lo:[0,1] neg_hi:[0,1]
    v_pk_add_f32 v[178:179], v[178:179], v[32:33] op_sel_hi:[1,0] neg_lo:[0,1] neg_hi:[0,1]
    v_pk_add_f32 v[180:181], v[180:181], v[32:33] op_sel_hi:[1,0] neg_lo:[0,1] neg_hi:[0,1]
    v_pk_add_f32 v[182:183], v[182:183], v[32:33] op_sel_hi:[1,0] neg_lo:[0,1] neg_hi:[0,1]
    v_pk_add_f32 v[184:185], v[184:185], v[32:33] op_sel_hi:[1,0] neg_lo:[0,1] neg_hi:[0,1]
    v_cvt_pk_bf16_f32 v36, v166, v167
    v_cvt_pk_bf16_f32 v37, v168, v169
    v_cvt_pk_bf16_f32 v38, v170, v171
    v_cvt_pk_bf16_f32 v39, v172, v173
    v_cvt_pk_bf16_f32 v40, v174, v175
    v_cvt_pk_bf16_f32 v41, v176, v177
    v_cvt_pk_bf16_f32 v42, v178, v179
    v_cvt_pk_bf16_f32 v43, v180, v181
    v_cvt_pk_bf16_f32 v44, v182, v183
    v_cvt_pk_bf16_f32 v45, v184, v185
    v_lshlrev_b32 v166, 16, v36
    v_and_b32 v167, 0xffff0000, v36
    v_lshlrev_b32 v168, 16, v37
    v_and_b32 v169, 0xffff0000, v37
    v_lshlrev_b32 v170, 16, v38
    v_and_b32 v171, 0xffff0000, v38
    v_lshlrev_b32 v172, 16, v39
    v_and_b32 v173, 0xffff0000, v39
    v_lshlrev_b32 v174, 16, v40
    v_and_b32 v175, 0xffff0000, v40
    v_lshlrev_b32 v176, 16, v41
    v_and_b32 v177, 0xffff0000, v41
    v_lshlrev_b32 v178, 16, v42
    v_and_b32 v179, 0xffff0000, v42
    v_lshlrev_b32 v180, 16, v43
    v_and_b32 v181, 0xffff0000, v43
    v_lshlrev_b32 v182, 16, v44
    v_and_b32 v183, 0xffff0000, v44
    v_lshlrev_b32 v184, 16, v45
    v_and_b32 v185, 0xffff0000, v45
    v_pk_mul_f32 v[166:167], v[166:167], v[32:33] op_sel:[0,1] op_sel_hi:[1,1]
    v_pk_mul_f32 v[168:169], v[168:169], v[32:33] op_sel:[0,1] op_sel_hi:[1,1]
    v_pk_mul_f32 v[170:171], v[170:171], v[32:33] op_sel:[0,1] op_sel_hi:[1,1]
    v_pk_mul_f32 v[172:173], v[172:173], v[32:33] op_sel:[0,1] op_sel_hi:[1,1]
    v_pk_mul_f32 v[174:175], v[174:175], v[32:33] op_sel:[0,1] op_sel_hi:[1,1]
    v_pk_mul_f32 v[176:177], v[176:177], v[32:33] op_sel:[0,1] op_sel_hi:[1,1]
    v_pk_mul_f32 v[178:179], v[178:179], v[32:33] op_sel:[0,1] op_sel_hi:[1,1]
    v_pk_mul_f32 v[180:181], v[180:181], v[32:33] op_sel:[0,1] op_sel_hi:[1,1]
    v_pk_mul_f32 v[182:183], v[182:183], v[32:33] op_sel:[0,1] op_sel_hi:[1,1]
    v_pk_mul_f32 v[184:185], v[184:185], v[32:33] op_sel:[0,1] op_sel_hi:[1,1]
    v_cvt_pk_bf16_f32 v36, v166, v167
    v_cvt_pk_bf16_f32 v37, v168, v169
    v_cvt_pk_bf16_f32 v38, v170, v171
    v_cvt_pk_bf16_f32 v39, v172, v173
    v_cvt_pk_bf16_f32 v40, v174, v175
    v_cvt_pk_bf16_f32 v41, v176, v177
    v_cvt_pk_bf16_f32 v42, v178, v179
    v_cvt_pk_bf16_f32 v43, v180, v181
    v_cvt_pk_bf16_f32 v44, v182, v183
    v_cvt_pk_bf16_f32 v45, v184, v185
    s_lshr_b32 s40, s87, 1
    s_lshl_b32 s40, s40, 2
    s_add_u32 s40, s40, s47
    s_lshl_b32 s40, s40, 18
    s_add_u32 s40, s40, 0x400000
    s_add_u32 s8, s72, s40
    s_addc_u32 s9, s73, 0
    s_mov_b32 s10, 0xc0000
    s_mov_b32 s11, 0x20000
    s_mov_b32 s12, s68
    s_mov_b32 s13, s69
    s_mov_b32 s14, 0x280000
    s_mov_b32 s15, 0x20000
    s_xor_b32 s40, s47, 1
    s_lshl_b32 s30, s40, 19
    s_lshl_b32 s31, s47, 19
    s_add_u32 s40, s5, 0
    s_and_b32 s40, s40, 3
    s_lshl_b32 s41, s5, 2
    s_add_u32 s41, s41, s40
    s_lshl_b32 s41, s41, 10
    v_lshl_add_u32 v4, v19, 4, s41
    s_add_u32 s40, s5, 1
    s_and_b32 s40, s40, 3
    s_lshl_b32 s41, s5, 2
    s_add_u32 s41, s41, s40
    s_lshl_b32 s41, s41, 10
    v_lshl_add_u32 v5, v19, 4, s41
    s_add_u32 s40, s5, 2
    s_and_b32 s40, s40, 3
    s_lshl_b32 s41, s5, 2
    s_add_u32 s41, s41, s40
    s_lshl_b32 s41, s41, 10
    v_lshl_add_u32 v6, v19, 4, s41
    s_add_u32 s40, s5, 3
    s_and_b32 s40, s40, 3
    s_lshl_b32 s41, s5, 2
    s_add_u32 s41, s41, s40
    s_lshl_b32 s41, s41, 10
    v_lshl_add_u32 v7, v19, 4, s41
    s_add_u32 s40, s46, 122880
    v_lshl_add_u32 v8, v19, 4, s40
    s_add_u32 s40, s46, 81920
    v_lshl_add_u32 v9, v19, 4, s40
    s_lshl_b32 s40, s46, 1
    v_lshl_add_u32 v10, v19, 4, s40
    s_waitcnt vmcnt(2)
    s_mov_b64 exec, 1
    buffer_store_dword v2, off, s[76:79], s58 sc1
    s_mov_b64 exec, -1
    s_and_b32 s40, s87, 30
    s_lshl_b32 s40, s40, 1
    s_add_u32 s40, s40, s47
    s_lshl_b32 s40, s40, 9
    s_mov_b32 s45, 163840
    buffer_load_dwordx4 v[46:49], v16, s[20:23], s45 offen offset:0 sc1
    s_add_u32 s40, s40, 0x292000
    v_bfe_u32 v1, v19, 2, 1
    v_lshlrev_b32 v1, 3, v1
    v_and_or_b32 v1, v19, 3, v1
    buffer_load_dwordx4 v[50:53], v16, s[20:23], s45 offen offset:1024 sc1
    v_lshl_add_u32 v1, v1, 7, s40
    v_mov_b32 v2, 3
    v_mov_b32 v11, 0x2500000
    s_not_b32 s40, s50
    buffer_load_dwordx4 v[54:57], v16, s[20:23], s45 offen offset:2048 sc1
    s_and_b32 s40, s40, 0x7ff
    v_cmp_eq_u32 vcc, s40, v35
    v_mov_b32 v12, 0x29c000
    s_nop 0
    buffer_load_dwordx4 v[58:61], v16, s[20:23], s45 offen offset:3072 sc1
    v_cndmask_b32 v11, v11, v12, vcc
    s_not_b32 s40, s51
    s_and_b32 s40, s40, 0x7ff
    v_cmp_eq_u32 vcc, s40, v35
    buffer_load_dwordx4 v[62:65], v17, s[20:23], s45 offen offset:0 sc1
    v_mov_b32 v12, 0x29c500
    s_nop 0
    v_cndmask_b32 v11, v11, v12, vcc
    s_not_b32 s40, s52
    s_mov_b32 s45, 184320
    buffer_load_dwordx4 v[66:69], v16, s[20:23], s45 offen offset:0 sc1
    s_and_b32 s40, s40, 0x7ff
    v_cmp_eq_u32 vcc, s40, v35
    v_mov_b32 v12, 0x29ca00
    s_nop 0
    buffer_load_dwordx4 v[70:73], v16, s[20:23], s45 offen offset:1024 sc1
    v_cndmask_b32 v11, v11, v12, vcc
    s_not_b32 s40, s53
    s_and_b32 s40, s40, 0x7ff
    v_cmp_eq_u32 vcc, s40, v35
    buffer_load_dwordx4 v[74:77], v16, s[20:23], s45 offen offset:2048 sc1
    v_mov_b32 v12, 0x29cf00
    s_nop 0
    v_cndmask_b32 v11, v11, v12, vcc
    s_not_b32 s40, s54
    buffer_load_dwordx4 v[78:81], v16, s[20:23], s45 offen offset:3072 sc1
    s_and_b32 s40, s40, 0x7ff
    v_cmp_eq_u32 vcc, s40, v35
    v_mov_b32 v12, 0x29d400
    s_nop 0
    buffer_load_dwordx4 v[82:85], v17, s[20:23], s45 offen offset:0 sc1
    v_cndmask_b32 v11, v11, v12, vcc
    s_not_b32 s40, s55
    s_and_b32 s40, s40, 0x7ff
    v_cmp_eq_u32 vcc, s40, v35
    s_mov_b32 s45, 204800
    buffer_load_dwordx4 v[86:89], v16, s[20:23], s45 offen offset:0 sc1
    v_mov_b32 v12, 0x29d900
    s_nop 0
    v_cndmask_b32 v11, v11, v12, vcc
    s_not_b32 s40, s56
    buffer_load_dwordx4 v[90:93], v16, s[20:23], s45 offen offset:1024 sc1
    s_and_b32 s40, s40, 0x7ff
    v_cmp_eq_u32 vcc, s40, v35
    v_mov_b32 v12, 0x29de00
    s_nop 0
    buffer_load_dwordx4 v[94:97], v16, s[20:23], s45 offen offset:2048 sc1
    v_cndmask_b32 v11, v11, v12, vcc
    s_not_b32 s40, s57
    s_and_b32 s40, s40, 0x7ff
    v_cmp_eq_u32 vcc, s40, v35
    buffer_load_dwordx4 v[98:101], v16, s[20:23], s45 offen offset:3072 sc1
    v_mov_b32 v12, 0x29e300
    s_nop 0
    v_cndmask_b32 v11, v11, v12, vcc
    v_mul_u32_u24 v12, 1280, v35
    buffer_load_dwordx4 v[102:105], v17, s[20:23], s45 offen offset:0 sc1
    v_sub_u32 v12, v34, v12
    v_add_u32 v11, v11, v12
    s_mov_b32 s45, 225280
    buffer_load_dwordx4 v[106:109], v16, s[20:23], s45 offen offset:0 sc1
    buffer_load_dwordx4 v[110:113], v16, s[20:23], s45 offen offset:1024 sc1
    buffer_load_dwordx4 v[114:117], v16, s[20:23], s45 offen offset:2048 sc1
    buffer_load_dwordx4 v[118:121], v16, s[20:23], s45 offen offset:3072 sc1
    buffer_load_dwordx4 v[122:125], v17, s[20:23], s45 offen offset:0 sc1
    buffer_load_dwordx4 v[158:161], v1, s[76:79], 0 offen sc1
    s_cmp_lg_u32 s5, 0
    s_cbranch_scc1 L_back_o
    v_min3_u32 v252, v252, v253, v254
    v_min_u32 v252, v252, v255
    v_cmp_gt_u32 vcc, 2, v252
    s_and_b64 vcc, vcc, exec
    s_cbranch_scc1 L_spin_ffn
L_back_ffn:
    s_waitcnt vmcnt(0)
    v_min3_u32 v158, v158, v159, v160
    v_min_u32 v158, v158, v161
    v_cmp_gt_u32 vcc, 1, v158
    s_and_b64 vcc, vcc, exec
    s_cbranch_scc1 L_spin_o
L_back_o:
    s_barrier
    s_add_u32 s44, s30, 0
    buffer_load_dwordx4 a[96:99], v4, s[8:11], s44 offen sc1
    buffer_load_dwordx4 a[100:103], v5, s[8:11], s44 offen sc1
    buffer_load_dwordx4 a[104:107], v6, s[8:11], s44 offen sc1
    buffer_load_dwordx4 a[108:111], v7, s[8:11], s44 offen sc1
    s_add_u32 s44, s30, 16384
    buffer_load_dwordx4 a[112:115], v4, s[8:11], s44 offen sc1
    buffer_load_dwordx4 a[116:119], v5, s[8:11], s44 offen sc1
    buffer_load_dwordx4 a[120:123], v6, s[8:11], s44 offen sc1
    buffer_load_dwordx4 a[124:127], v7, s[8:11], s44 offen sc1
    s_add_u32 s44, s30, 32768
    buffer_load_dwordx4 a[192:195], v4, s[8:11], s44 offen sc1
    buffer_load_dwordx4 a[196:199], v5, s[8:11], s44 offen sc1
    buffer_load_dwordx4 a[200:203], v6, s[8:11], s44 offen sc1
    buffer_load_dwordx4 a[204:207], v7, s[8:11], s44 offen sc1
    s_add_u32 s44, s30, 49152
    buffer_load_dwordx4 a[208:211], v4, s[8:11], s44 offen sc1
    buffer_load_dwordx4 a[212:215], v5, s[8:11], s44 offen sc1
    buffer_load_dwordx4 a[216:219], v6, s[8:11], s44 offen sc1
    buffer_load_dwordx4 a[220:223], v7, s[8:11], s44 offen sc1
    s_mul_i32 s40, s6, 27648
    s_lshl_b32 s41, s5, 10
    s_add_u32 s40, s40, s41
    v_lshlrev_b32 v154, 4, v19
    buffer_load_dwordx4 v[126:129], v154, s[16:19], s40 offen sc1
    s_add_u32 s40, s40, 4096
    buffer_load_dwordx4 v[130:133], v154, s[16:19], s40 offen sc1
    s_add_u32 s40, s40, 4096
    buffer_load_dwordx4 v[134:137], v154, s[16:19], s40 offen sc1
    s_add_u32 s40, s40, 4096
    buffer_load_dwordx4 v[138:141], v154, s[16:19], s40 offen sc1
    s_add_u32 s40, s40, 4096
    buffer_load_dwordx4 v[142:145], v154, s[16:19], s40 offen sc1
    s_add_u32 s40, s40, 4096
    buffer_load_dwordx4 v[146:149], v154, s[16:19], s40 offen sc1
    s_add_u32 s40, s40, 4096
    s_cmp_eq_u32 s5, 3
    s_cselect_b32 s40, 0x438000, s40
    buffer_load_dwordx4 v[150:153], v154, s[16:19], s40 offen sc1
    s_waitcnt vmcnt(15)
    v_mfma_f32_16x16x32_bf16 v[166:169], a[128:131], a[96:99], 0
    v_mfma_f32_16x16x32_bf16 v[166:169], a[148:151], a[112:115], v[166:169]
    s_add_u32 s44, s30, 65536
    buffer_load_dwordx4 a[224:227], v4, s[8:11], s44 offen sc1
    v_mfma_f32_16x16x32_bf16 v[186:189], a[148:151], a[116:119], 0
    v_mfma_f32_16x16x32_bf16 v[186:189], a[128:131], a[100:103], v[186:189]
    v_mfma_f32_16x16x32_bf16 v[206:209], a[128:131], a[104:107], 0
    buffer_load_dwordx4 a[228:231], v5, s[8:11], s44 offen sc1
    v_mfma_f32_16x16x32_bf16 v[206:209], a[148:151], a[120:123], v[206:209]
    v_mfma_f32_16x16x32_bf16 v[226:229], a[148:151], a[124:127], 0
    v_mfma_f32_16x16x32_bf16 v[226:229], a[128:131], a[108:111], v[226:229]
    v_mfma_f32_16x16x32_bf16 v[170:173], a[132:135], a[96:99], 0
    buffer_load_dwordx4 a[232:235], v6, s[8:11], s44 offen sc1
    v_mfma_f32_16x16x32_bf16 v[170:173], a[152:155], a[112:115], v[170:173]
    v_mfma_f32_16x16x32_bf16 v[190:193], a[152:155], a[116:119], 0
    v_mfma_f32_16x16x32_bf16 v[190:193], a[132:135], a[100:103], v[190:193]
    v_mfma_f32_16x16x32_bf16 v[210:213], a[132:135], a[104:107], 0
    buffer_load_dwordx4 a[236:239], v7, s[8:11], s44 offen sc1
    v_mfma_f32_16x16x32_bf16 v[210:213], a[152:155], a[120:123], v[210:213]
    v_mfma_f32_16x16x32_bf16 v[230:233], a[152:155], a[124:127], 0
    v_mfma_f32_16x16x32_bf16 v[230:233], a[132:135], a[108:111], v[230:233]
    v_mfma_f32_16x16x32_bf16 v[174:177], a[136:139], a[96:99], 0
    s_add_u32 s44, s30, 81920
    buffer_load_dwordx4 a[240:243], v4, s[8:11], s44 offen sc1
    v_mfma_f32_16x16x32_bf16 v[174:177], a[156:159], a[112:115], v[174:177]
    v_mfma_f32_16x16x32_bf16 v[194:197], a[156:159], a[116:119], 0
    v_mfma_f32_16x16x32_bf16 v[194:197], a[136:139], a[100:103], v[194:197]
    buffer_load_dwordx4 a[244:247], v5, s[8:11], s44 offen sc1
    v_mfma_f32_16x16x32_bf16 v[214:217], a[136:139], a[104:107], 0
    v_mfma_f32_16x16x32_bf16 v[214:217], a[156:159], a[120:123], v[214:217]
    v_mfma_f32_16x16x32_bf16 v[234:237], a[156:159], a[124:127], 0
    v_mfma_f32_16x16x32_bf16 v[234:237], a[136:139], a[108:111], v[234:237]
    buffer_load_dwordx4 a[248:251], v6, s[8:11], s44 offen sc1
    v_mfma_f32_16x16x32_bf16 v[178:181], a[140:143], a[96:99], 0
    v_mfma_f32_16x16x32_bf16 v[178:181], a[160:163], a[112:115], v[178:181]
    v_mfma_f32_16x16x32_bf16 v[198:201], a[160:163], a[116:119], 0
    v_mfma_f32_16x16x32_bf16 v[198:201], a[140:143], a[100:103], v[198:201]
    buffer_load_dwordx4 a[252:255], v7, s[8:11], s44 offen sc1
    v_mfma_f32_16x16x32_bf16 v[218:221], a[140:143], a[104:107], 0
    v_mfma_f32_16x16x32_bf16 v[218:221], a[160:163], a[120:123], v[218:221]
    v_mfma_f32_16x16x32_bf16 v[238:241], a[160:163], a[124:127], 0
    v_mfma_f32_16x16x32_bf16 v[238:241], a[140:143], a[108:111], v[238:241]
    v_mfma_f32_16x16x32_bf16 v[182:185], a[144:147], a[96:99], 0
    v_mfma_f32_16x16x32_bf16 v[182:185], a[164:167], a[112:115], v[182:185]
    v_mfma_f32_16x16x32_bf16 v[202:205], a[164:167], a[116:119], 0
    v_mfma_f32_16x16x32_bf16 v[202:205], a[144:147], a[100:103], v[202:205]
    v_mfma_f32_16x16x32_bf16 v[222:225], a[144:147], a[104:107], 0
    v_mfma_f32_16x16x32_bf16 v[222:225], a[164:167], a[120:123], v[222:225]
    v_mfma_f32_16x16x32_bf16 v[242:245], a[164:167], a[124:127], 0
    v_mfma_f32_16x16x32_bf16 v[242:245], a[144:147], a[108:111], v[242:245]
    s_waitcnt vmcnt(15)
    v_mfma_f32_16x16x32_bf16 v[166:169], a[168:171], a[192:195], v[166:169]
    s_waitcnt vmcnt(8)
    v_mfma_f32_16x16x32_bf16 v[166:169], a[188:191], a[208:211], v[166:169]
    s_add_u32 s44, s30, 98304
    buffer_load_dwordx4 a[96:99], v4, s[8:11], s44 offen sc1
    v_add_f32 v126, v126, v130
    v_add_f32 v127, v127, v131
    v_mfma_f32_16x16x32_bf16 v[186:189], a[188:191], a[212:215], v[186:189]
    v_add_f32 v128, v128, v132
    v_mfma_f32_16x16x32_bf16 v[186:189], a[168:171], a[196:199], v[186:189]
    v_add_f32 v129, v129, v133
    v_add_f32 v126, v126, v134
    v_mfma_f32_16x16x32_bf16 v[206:209], a[168:171], a[200:203], v[206:209]
    buffer_load_dwordx4 a[100:103], v5, s[8:11], s44 offen sc1
    v_add_f32 v127, v127, v135
    v_add_f32 v128, v128, v136
    v_mfma_f32_16x16x32_bf16 v[206:209], a[188:191], a[216:219], v[206:209]
    v_add_f32 v129, v129, v137
    v_mfma_f32_16x16x32_bf16 v[226:229], a[188:191], a[220:223], v[226:229]
    v_add_f32 v126, v126, v138
    v_add_f32 v127, v127, v139
    v_mfma_f32_16x16x32_bf16 v[226:229], a[168:171], a[204:207], v[226:229]
    v_add_f32 v128, v128, v140
    v_add_f32 v129, v129, v141
    v_mfma_f32_16x16x32_bf16 v[170:173], a[172:175], a[192:195], v[170:173]
    buffer_load_dwordx4 a[104:107], v6, s[8:11], s44 offen sc1
    v_add_f32 v126, v126, v142
    v_mfma_f32_16x16x32_bf16 v[170:173], a[0:3], a[208:211], v[170:173]
    v_add_f32 v127, v127, v143
    v_add_f32 v128, v128, v144
    v_mfma_f32_16x16x32_bf16 v[190:193], a[0:3], a[212:215], v[190:193]
    v_add_f32 v129, v129, v145
    v_add_f32 v126, v126, v146
    v_mfma_f32_16x16x32_bf16 v[190:193], a[172:175], a[196:199], v[190:193]
    v_add_f32 v127, v127, v147
    v_mfma_f32_16x16x32_bf16 v[210:213], a[172:175], a[200:203], v[210:213]
    buffer_load_dwordx4 a[108:111], v7, s[8:11], s44 offen sc1
    v_add_f32 v128, v128, v148
    v_add_f32 v129, v129, v149
    v_mfma_f32_16x16x32_bf16 v[210:213], a[0:3], a[216:219], v[210:213]
    v_add_f32 v126, v126, v150
    v_mfma_f32_16x16x32_bf16 v[230:233], a[0:3], a[220:223], v[230:233]
    v_add_f32 v127, v127, v151
    v_add_f32 v128, v128, v152
    v_mfma_f32_16x16x32_bf16 v[230:233], a[172:175], a[204:207], v[230:233]
    v_add_f32 v129, v129, v153
    v_add_f32_dpp v126, v126, v126 row_ror:8 row_mask:0xf bank_mask:0xf
    v_mfma_f32_16x16x32_bf16 v[174:177], a[176:179], a[192:195], v[174:177]
    s_add_u32 s44, s30, 114688
    buffer_load_dwordx4 a[112:115], v4, s[8:11], s44 offen sc1
    v_add_f32_dpp v127, v127, v127 row_ror:8 row_mask:0xf bank_mask:0xf
    v_mfma_f32_16x16x32_bf16 v[174:177], a[4:7], a[208:211], v[174:177]
    v_add_f32_dpp v128, v128, v128 row_ror:8 row_mask:0xf bank_mask:0xf
    v_add_f32_dpp v129, v129, v129 row_ror:8 row_mask:0xf bank_mask:0xf
    v_mfma_f32_16x16x32_bf16 v[194:197], a[4:7], a[212:215], v[194:197]
    v_mov_b32 v130, v126
    v_mov_b32 v131, v127
    v_mfma_f32_16x16x32_bf16 v[194:197], a[176:179], a[196:199], v[194:197]
    buffer_load_dwordx4 a[116:119], v5, s[8:11], s44 offen sc1
    v_mov_b32 v132, v128
    v_mfma_f32_16x16x32_bf16 v[214:217], a[176:179], a[200:203], v[214:217]
    v_mov_b32 v133, v129
    v_permlane16_swap_b32 v126, v130
    v_mfma_f32_16x16x32_bf16 v[214:217], a[4:7], a[216:219], v[214:217]
    v_permlane16_swap_b32 v127, v131
    v_permlane16_swap_b32 v128, v132
    v_mfma_f32_16x16x32_bf16 v[234:237], a[4:7], a[220:223], v[234:237]
    v_permlane16_swap_b32 v129, v133
    v_mfma_f32_16x16x32_bf16 v[234:237], a[176:179], a[204:207], v[234:237]
    buffer_load_dwordx4 a[120:123], v6, s[8:11], s44 offen sc1
    v_add_f32 v126, v126, v130
    v_add_f32 v127, v127, v131
    v_mfma_f32_16x16x32_bf16 v[178:181], a[180:183], a[192:195], v[178:181]
    v_add_f32 v128, v128, v132
    v_mfma_f32_16x16x32_bf16 v[178:181], a[8:11], a[208:211], v[178:181]
    v_add_f32 v129, v129, v133
    v_mov_b32 v130, v126
    v_mfma_f32_16x16x32_bf16 v[198:201], a[8:11], a[212:215], v[198:201]
    v_mov_b32 v131, v127
    v_mov_b32 v132, v128
    v_mfma_f32_16x16x32_bf16 v[198:201], a[180:183], a[196:199], v[198:201]
    buffer_load_dwordx4 a[124:127], v7, s[8:11], s44 offen sc1
    v_mov_b32 v133, v129
    v_mfma_f32_16x16x32_bf16 v[218:221], a[180:183], a[200:203], v[218:221]
    v_permlane32_swap_b32 v126, v130
    v_permlane32_swap_b32 v127, v131
    v_mfma_f32_16x16x32_bf16 v[218:221], a[8:11], a[216:219], v[218:221]
    v_permlane32_swap_b32 v128, v132
    v_permlane32_swap_b32 v129, v133
    v_mfma_f32_16x16x32_bf16 v[238:241], a[8:11], a[220:223], v[238:241]
    v_add_f32 v126, v126, v130
    v_mfma_f32_16x16x32_bf16 v[238:241], a[180:183], a[204:207], v[238:241]
    v_add_f32 v127, v127, v131
    v_add_f32 v128, v128, v132
    v_mfma_f32_16x16x32_bf16 v[182:185], a[184:187], a[192:195], v[182:185]
    v_add_f32 v129, v129, v133
    v_and_b32 v154, 7, v19
    v_mfma_f32_16x16x32_bf16 v[182:185], a[12:15], a[208:211], v[182:185]
    v_lshlrev_b32 v154, 4, v154
    v_mfma_f32_16x16x32_bf16 v[202:205], a[12:15], a[212:215], v[202:205]
    v_add_u32 v154, 0, v154
    s_lshl_b32 s40, s5, 7
    v_mfma_f32_16x16x32_bf16 v[202:205], a[184:187], a[196:199], v[202:205]
    v_add_u32 v155, s40, v154
    ds_write_b128 v155, v[126:129]
    v_mfma_f32_16x16x32_bf16 v[222:225], a[184:187], a[200:203], v[222:225]
    v_mfma_f32_16x16x32_bf16 v[222:225], a[12:15], a[216:219], v[222:225]
    v_mfma_f32_16x16x32_bf16 v[242:245], a[12:15], a[220:223], v[242:245]
    v_mfma_f32_16x16x32_bf16 v[242:245], a[184:187], a[204:207], v[242:245]
    s_waitcnt vmcnt(8)
    v_mfma_f32_16x16x32_bf16 v[166:169], a[16:19], a[224:227], v[166:169]
    s_waitcnt lgkmcnt(0)
    v_mfma_f32_16x16x32_bf16 v[166:169], a[36:39], a[240:243], v[166:169]
    s_add_u32 s44, s30, 196608
    buffer_load_dwordx4 a[192:195], v4, s[8:11], s44 offen sc1
    s_barrier
    v_mfma_f32_16x16x32_bf16 v[186:189], a[36:39], a[244:247], v[186:189]
    ds_read_b128 v[126:129], v154 offset:0
    ds_read_b128 v[130:133], v154 offset:128
    v_mfma_f32_16x16x32_bf16 v[186:189], a[16:19], a[228:231], v[186:189]
    ds_read_b128 v[134:137], v154 offset:256
    v_mfma_f32_16x16x32_bf16 v[206:209], a[16:19], a[232:235], v[206:209]
    buffer_load_dwordx4 a[196:199], v5, s[8:11], s44 offen sc1
    ds_read_b128 v[138:141], v154 offset:384
    s_mul_i32 s42, s6, 3277
    v_mfma_f32_16x16x32_bf16 v[206:209], a[36:39], a[248:251], v[206:209]
    s_lshr_b32 s42, s42, 16
    v_mfma_f32_16x16x32_bf16 v[226:229], a[36:39], a[252:255], v[226:229]
    s_min_u32 s42, s42, 7
    v_mfma_f32_16x16x32_bf16 v[226:229], a[16:19], a[236:239], v[226:229]
    v_readlane_b32 s40, v3, s42
    s_and_b32 s40, s40, 0xffff0000
    v_mfma_f32_16x16x32_bf16 v[170:173], a[20:23], a[224:227], v[170:173]
    buffer_load_dwordx4 a[200:203], v6, s[8:11], s44 offen sc1
    s_ashr_i32 s41, s40, 31
    v_mfma_f32_16x16x32_bf16 v[170:173], a[40:43], a[240:243], v[170:173]
    s_andn2_b32 s41, 0x7fff0000, s41
    s_or_b32 s41, s41, 0x80000000
    v_mfma_f32_16x16x32_bf16 v[190:193], a[40:43], a[244:247], v[190:193]
    s_xor_b32 s40, s40, s41
    v_mfma_f32_16x16x32_bf16 v[190:193], a[20:23], a[228:231], v[190:193]
    v_mov_b32 v142, 0xbfb8aa3b
    v_mfma_f32_16x16x32_bf16 v[210:213], a[20:23], a[232:235], v[210:213]
    buffer_load_dwordx4 a[204:207], v7, s[8:11], s44 offen sc1
    v_mul_f32 v142, s40, v142
    v_exp_f32 v142, v142
    v_mfma_f32_16x16x32_bf16 v[210:213], a[40:43], a[248:251], v[210:213]
    s_nop 0
    v_mfma_f32_16x16x32_bf16 v[230:233], a[40:43], a[252:255], v[230:233]
    v_add_f32 v142, 1.0, v142
    v_rcp_f32 v142, v142
    v_mfma_f32_16x16x32_bf16 v[230:233], a[20:23], a[236:239], v[230:233]
    s_nop 0
    v_mfma_f32_16x16x32_bf16 v[174:177], a[24:27], a[224:227], v[174:177]
    s_add_u32 s44, s30, 212992
    buffer_load_dwordx4 a[208:211], v4, s[8:11], s44 offen sc1
    v_cvt_pk_bf16_f32 v142, v142, v142
    v_mfma_f32_16x16x32_bf16 v[174:177], a[44:47], a[240:243], v[174:177]
    v_lshlrev_b32 v142, 16, v142
    s_lshl_b32 s40, s6, 6
    v_mfma_f32_16x16x32_bf16 v[194:197], a[44:47], a[244:247], v[194:197]
    s_add_u32 s40, s40, 0x29c000
    v_mfma_f32_16x16x32_bf16 v[194:197], a[24:27], a[228:231], v[194:197]
    buffer_load_dwordx4 a[212:215], v5, s[8:11], s44 offen sc1
    s_lshl_b32 s41, s5, 8
    s_add_u32 s41, s41, s6
    v_mfma_f32_16x16x32_bf16 v[214:217], a[24:27], a[232:235], v[214:217]
    s_cmp_lt_u32 s41, 160
    s_cselect_b32 s40, s40, 0x2500000
    v_mfma_f32_16x16x32_bf16 v[214:217], a[44:47], a[248:251], v[214:217]
    v_lshlrev_b32 v143, 3, v19
    v_mfma_f32_16x16x32_bf16 v[234:237], a[44:47], a[252:255], v[234:237]
    s_waitcnt lgkmcnt(0)
    v_add_f32 v126, v126, v130
    v_mfma_f32_16x16x32_bf16 v[234:237], a[24:27], a[236:239], v[234:237]
    buffer_load_dwordx4 a[216:219], v6, s[8:11], s44 offen sc1
    v_add_f32 v127, v127, v131
    v_mfma_f32_16x16x32_bf16 v[178:181], a[28:31], a[224:227], v[178:181]
    v_add_f32 v128, v128, v132
    v_add_f32 v129, v129, v133
    v_mfma_f32_16x16x32_bf16 v[178:181], a[48:51], a[240:243], v[178:181]
    v_add_f32 v126, v126, v134
    v_mfma_f32_16x16x32_bf16 v[198:201], a[48:51], a[244:247], v[198:201]
    v_add_f32 v127, v127, v135
    v_mfma_f32_16x16x32_bf16 v[198:201], a[28:31], a[228:231], v[198:201]
    buffer_load_dwordx4 a[220:223], v7, s[8:11], s44 offen sc1
    v_add_f32 v128, v128, v136
    v_add_f32 v129, v129, v137
    v_mfma_f32_16x16x32_bf16 v[218:221], a[28:31], a[232:235], v[218:221]
    v_add_f32 v126, v126, v138
    v_mfma_f32_16x16x32_bf16 v[218:221], a[48:51], a[248:251], v[218:221]
    v_add_f32 v127, v127, v139
    v_add_f32 v128, v128, v140
    v_mfma_f32_16x16x32_bf16 v[238:241], a[48:51], a[252:255], v[238:241]
    v_add_f32 v129, v129, v141
    v_mfma_f32_16x16x32_bf16 v[238:241], a[28:31], a[236:239], v[238:241]
    v_cvt_pk_bf16_f32 v130, v126, v127
    v_mfma_f32_16x16x32_bf16 v[182:185], a[32:35], a[224:227], v[182:185]
    v_cvt_pk_bf16_f32 v131, v128, v129
    v_lshlrev_b32 v126, 16, v130
    v_mfma_f32_16x16x32_bf16 v[182:185], a[52:55], a[240:243], v[182:185]
    v_and_b32 v127, 0xffff0000, v130
    v_mfma_f32_16x16x32_bf16 v[202:205], a[52:55], a[244:247], v[202:205]
    v_lshlrev_b32 v128, 16, v131
    v_and_b32 v129, 0xffff0000, v131
    v_mfma_f32_16x16x32_bf16 v[202:205], a[32:35], a[228:231], v[202:205]
    v_mul_f32 v126, v126, v142
    v_mfma_f32_16x16x32_bf16 v[222:225], a[32:35], a[232:235], v[222:225]
    v_mul_f32 v127, v127, v142
    v_mfma_f32_16x16x32_bf16 v[222:225], a[52:55], a[248:251], v[222:225]
    v_mul_f32 v128, v128, v142
    v_mul_f32 v129, v129, v142
    v_mfma_f32_16x16x32_bf16 v[242:245], a[52:55], a[252:255], v[242:245]
    v_cvt_pk_bf16_f32 v130, v126, v127
    v_mfma_f32_16x16x32_bf16 v[242:245], a[32:35], a[236:239], v[242:245]
    v_cvt_pk_bf16_f32 v131, v128, v129
    s_mov_b64 exec, 0xff
    buffer_store_dwordx2 v[130:131], v143, s[76:79], s40 offen sc1
    s_mov_b64 exec, -1
    s_waitcnt vmcnt(9)
    v_mfma_f32_16x16x32_bf16 v[166:169], a[56:59], a[96:99], v[166:169]
    v_mfma_f32_16x16x32_bf16 v[166:169], a[76:79], a[112:115], v[166:169]
    s_add_u32 s44, s30, 131072
    buffer_load_dwordx4 a[224:227], v4, s[8:11], s44 offen sc1
    v_mfma_f32_16x16x32_bf16 v[186:189], a[76:79], a[116:119], v[186:189]
    ds_read_b128 v[126:129], v8 offset:0
    v_mfma_f32_16x16x32_bf16 v[186:189], a[56:59], a[100:103], v[186:189]
    v_mfma_f32_16x16x32_bf16 v[206:209], a[56:59], a[104:107], v[206:209]
    buffer_load_dwordx4 a[228:231], v5, s[8:11], s44 offen sc1
    v_mfma_f32_16x16x32_bf16 v[206:209], a[76:79], a[120:123], v[206:209]
    ds_read_b128 v[130:133], v8 offset:1024
    v_mfma_f32_16x16x32_bf16 v[226:229], a[76:79], a[124:127], v[226:229]
    v_mfma_f32_16x16x32_bf16 v[226:229], a[56:59], a[108:111], v[226:229]
    ds_read_b128 v[134:137], v8 offset:2048
    v_mfma_f32_16x16x32_bf16 v[170:173], a[60:63], a[96:99], v[170:173]
    buffer_load_dwordx4 a[232:235], v6, s[8:11], s44 offen sc1
    v_mfma_f32_16x16x32_bf16 v[170:173], a[80:83], a[112:115], v[170:173]
    v_mfma_f32_16x16x32_bf16 v[190:193], a[80:83], a[116:119], v[190:193]
    ds_read_b128 v[138:141], v8 offset:3072
    v_mfma_f32_16x16x32_bf16 v[190:193], a[60:63], a[100:103], v[190:193]
    v_mfma_f32_16x16x32_bf16 v[210:213], a[60:63], a[104:107], v[210:213]
    buffer_load_dwordx4 a[236:239], v7, s[8:11], s44 offen sc1
    v_mfma_f32_16x16x32_bf16 v[210:213], a[80:83], a[120:123], v[210:213]
    ds_read_b128 v[142:145], v8 offset:4096
    v_mfma_f32_16x16x32_bf16 v[230:233], a[80:83], a[124:127], v[230:233]
    v_mfma_f32_16x16x32_bf16 v[230:233], a[60:63], a[108:111], v[230:233]
    ds_read_b128 v[146:149], v8 offset:5120
    v_mfma_f32_16x16x32_bf16 v[174:177], a[64:67], a[96:99], v[174:177]
    s_add_u32 s44, s30, 147456
    buffer_load_dwordx4 a[240:243], v4, s[8:11], s44 offen sc1
    v_mfma_f32_16x16x32_bf16 v[174:177], a[84:87], a[112:115], v[174:177]
    v_mfma_f32_16x16x32_bf16 v[194:197], a[84:87], a[116:119], v[194:197]
    ds_read_b128 v[150:153], v8 offset:6144
    v_mfma_f32_16x16x32_bf16 v[194:197], a[64:67], a[100:103], v[194:197]
    buffer_load_dwordx4 a[244:247], v5, s[8:11], s44 offen sc1
    v_mfma_f32_16x16x32_bf16 v[214:217], a[64:67], a[104:107], v[214:217]
    v_mfma_f32_16x16x32_bf16 v[214:217], a[84:87], a[120:123], v[214:217]
    ds_read_b128 v[154:157], v8 offset:7168
    v_mfma_f32_16x16x32_bf16 v[234:237], a[84:87], a[124:127], v[234:237]
    v_mfma_f32_16x16x32_bf16 v[234:237], a[64:67], a[108:111], v[234:237]
    buffer_load_dwordx4 a[248:251], v6, s[8:11], s44 offen sc1
    v_mfma_f32_16x16x32_bf16 v[178:181], a[68:71], a[96:99], v[178:181]
    ds_read_b128 v[158:161], v8 offset:8192
    v_mfma_f32_16x16x32_bf16 v[178:181], a[88:91], a[112:115], v[178:181]
    v_mfma_f32_16x16x32_bf16 v[198:201], a[88:91], a[116:119], v[198:201]
    ds_read_b128 v[162:165], v8 offset:9216
    v_mfma_f32_16x16x32_bf16 v[198:201], a[68:71], a[100:103], v[198:201]
    buffer_load_dwordx4 a[252:255], v7, s[8:11], s44 offen sc1
    v_mfma_f32_16x16x32_bf16 v[218:221], a[68:71], a[104:107], v[218:221]
    v_mfma_f32_16x16x32_bf16 v[218:221], a[88:91], a[120:123], v[218:221]
    v_mfma_f32_16x16x32_bf16 v[238:241], a[88:91], a[124:127], v[238:241]
    v_mfma_f32_16x16x32_bf16 v[238:241], a[68:71], a[108:111], v[238:241]
    v_mfma_f32_16x16x32_bf16 v[182:185], a[72:75], a[96:99], v[182:185]
    v_mfma_f32_16x16x32_bf16 v[182:185], a[92:95], a[112:115], v[182:185]
    v_mfma_f32_16x16x32_bf16 v[202:205], a[92:95], a[116:119], v[202:205]
    v_mfma_f32_16x16x32_bf16 v[202:205], a[72:75], a[100:103], v[202:205]
    v_mfma_f32_16x16x32_bf16 v[222:225], a[72:75], a[104:107], v[222:225]
    v_mfma_f32_16x16x32_bf16 v[222:225], a[92:95], a[120:123], v[222:225]
    v_mfma_f32_16x16x32_bf16 v[242:245], a[92:95], a[124:127], v[242:245]
    v_mfma_f32_16x16x32_bf16 v[242:245], a[72:75], a[108:111], v[242:245]
    s_waitcnt vmcnt(9) lgkmcnt(0)
    v_mfma_f32_16x16x32_bf16 v[166:169], v[126:129], a[192:195], v[166:169]
    v_mfma_f32_16x16x32_bf16 v[166:169], v[146:149], a[208:211], v[166:169]
    s_add_u32 s44, s30, 229376
    buffer_load_dwordx4 a[96:99], v4, s[8:11], s44 offen sc1
    v_mfma_f32_16x16x32_bf16 v[186:189], v[146:149], a[212:215], v[186:189]
    v_mfma_f32_16x16x32_bf16 v[186:189], v[126:129], a[196:199], v[186:189]
    v_mfma_f32_16x16x32_bf16 v[206:209], v[126:129], a[200:203], v[206:209]
    buffer_load_dwordx4 a[100:103], v5, s[8:11], s44 offen sc1
    v_mfma_f32_16x16x32_bf16 v[206:209], v[146:149], a[216:219], v[206:209]
    v_mfma_f32_16x16x32_bf16 v[226:229], v[146:149], a[220:223], v[226:229]
    v_mfma_f32_16x16x32_bf16 v[226:229], v[126:129], a[204:207], v[226:229]
    v_mfma_f32_16x16x32_bf16 v[170:173], v[130:133], a[192:195], v[170:173]
    buffer_load_dwordx4 a[104:107], v6, s[8:11], s44 offen sc1
    v_mfma_f32_16x16x32_bf16 v[170:173], v[150:153], a[208:211], v[170:173]
    v_mfma_f32_16x16x32_bf16 v[190:193], v[150:153], a[212:215], v[190:193]
    v_mfma_f32_16x16x32_bf16 v[190:193], v[130:133], a[196:199], v[190:193]
    v_mfma_f32_16x16x32_bf16 v[210:213], v[130:133], a[200:203], v[210:213]
    buffer_load_dwordx4 a[108:111], v7, s[8:11], s44 offen sc1
    v_mfma_f32_16x16x32_bf16 v[210:213], v[150:153], a[216:219], v[210:213]
    v_mfma_f32_16x16x32_bf16 v[230:233], v[150:153], a[220:223], v[230:233]
    v_mfma_f32_16x16x32_bf16 v[230:233], v[130:133], a[204:207], v[230:233]
    v_mfma_f32_16x16x32_bf16 v[174:177], v[134:137], a[192:195], v[174:177]
    s_add_u32 s44, s30, 245760
    buffer_load_dwordx4 a[112:115], v4, s[8:11], s44 offen sc1
    v_mfma_f32_16x16x32_bf16 v[174:177], v[154:157], a[208:211], v[174:177]
    v_mfma_f32_16x16x32_bf16 v[194:197], v[154:157], a[212:215], v[194:197]
    v_mfma_f32_16x16x32_bf16 v[194:197], v[134:137], a[196:199], v[194:197]
    buffer_load_dwordx4 a[116:119], v5, s[8:11], s44 offen sc1
    v_mfma_f32_16x16x32_bf16 v[214:217], v[134:137], a[200:203], v[214:217]
    v_mfma_f32_16x16x32_bf16 v[214:217], v[154:157], a[216:219], v[214:217]
    v_mfma_f32_16x16x32_bf16 v[234:237], v[154:157], a[220:223], v[234:237]
    v_mfma_f32_16x16x32_bf16 v[234:237], v[134:137], a[204:207], v[234:237]
    buffer_load_dwordx4 a[120:123], v6, s[8:11], s44 offen sc1
    v_mfma_f32_16x16x32_bf16 v[178:181], v[138:141], a[192:195], v[178:181]
    v_mfma_f32_16x16x32_bf16 v[178:181], v[158:161], a[208:211], v[178:181]
    v_mfma_f32_16x16x32_bf16 v[198:201], v[158:161], a[212:215], v[198:201]
    v_mfma_f32_16x16x32_bf16 v[198:201], v[138:141], a[196:199], v[198:201]
    buffer_load_dwordx4 a[124:127], v7, s[8:11], s44 offen sc1
    v_mfma_f32_16x16x32_bf16 v[218:221], v[138:141], a[200:203], v[218:221]
    v_mfma_f32_16x16x32_bf16 v[218:221], v[158:161], a[216:219], v[218:221]
    v_mfma_f32_16x16x32_bf16 v[238:241], v[158:161], a[220:223], v[238:241]
    v_mfma_f32_16x16x32_bf16 v[238:241], v[138:141], a[204:207], v[238:241]
    v_mfma_f32_16x16x32_bf16 v[182:185], v[142:145], a[192:195], v[182:185]
    v_mfma_f32_16x16x32_bf16 v[182:185], v[162:165], a[208:211], v[182:185]
    v_mfma_f32_16x16x32_bf16 v[202:205], v[162:165], a[212:215], v[202:205]
    v_mfma_f32_16x16x32_bf16 v[202:205], v[142:145], a[196:199], v[202:205]
    v_mfma_f32_16x16x32_bf16 v[222:225], v[142:145], a[200:203], v[222:225]
    v_mfma_f32_16x16x32_bf16 v[222:225], v[162:165], a[216:219], v[222:225]
    v_mfma_f32_16x16x32_bf16 v[242:245], v[162:165], a[220:223], v[242:245]
    v_mfma_f32_16x16x32_bf16 v[242:245], v[142:145], a[204:207], v[242:245]
    s_waitcnt vmcnt(8)
    v_mfma_f32_16x16x32_bf16 v[166:169], v[46:49], a[224:227], v[166:169]
    v_mfma_f32_16x16x32_bf16 v[166:169], v[66:69], a[240:243], v[166:169]
    s_add_u32 s44, s30, 163840
    buffer_load_dwordx4 a[192:195], v4, s[8:11], s44 offen sc1
    s_lshl_b32 s36, s2, 5
    v_mfma_f32_16x16x32_bf16 v[186:189], v[66:69], a[244:247], v[186:189]
    ds_read_b128 v[126:129], v9 offset:0
    v_mfma_f32_16x16x32_bf16 v[186:189], v[46:49], a[228:231], v[186:189]
    s_add_u32 s36, s36, s5
    v_mfma_f32_16x16x32_bf16 v[206:209], v[46:49], a[232:235], v[206:209]
    buffer_load_dwordx4 a[196:199], v5, s[8:11], s44 offen sc1
    v_mfma_f32_16x16x32_bf16 v[206:209], v[66:69], a[248:251], v[206:209]
    ds_read_b128 v[130:133], v9 offset:1024
    s_lshl_b32 s36, s36, 2
    v_mfma_f32_16x16x32_bf16 v[226:229], v[66:69], a[252:255], v[226:229]
    s_add_u32 s36, s36, 0x2a0000
    v_mfma_f32_16x16x32_bf16 v[226:229], v[46:49], a[236:239], v[226:229]
    ds_read_b128 v[134:137], v9 offset:2048
    v_mfma_f32_16x16x32_bf16 v[170:173], v[50:53], a[224:227], v[170:173]
    buffer_load_dwordx4 a[200:203], v6, s[8:11], s44 offen sc1
    s_xor_b32 s37, s36, 1024
    v_mfma_f32_16x16x32_bf16 v[170:173], v[70:73], a[240:243], v[170:173]
    v_mfma_f32_16x16x32_bf16 v[190:193], v[70:73], a[244:247], v[190:193]
    ds_read_b128 v[138:141], v9 offset:3072
    s_sub_u32 s40, s5, 1
    v_mfma_f32_16x16x32_bf16 v[190:193], v[50:53], a[228:231], v[190:193]
    v_mfma_f32_16x16x32_bf16 v[210:213], v[50:53], a[232:235], v[210:213]
    buffer_load_dwordx4 a[204:207], v7, s[8:11], s44 offen sc1
    s_and_b32 s40, s40, 3
    v_mfma_f32_16x16x32_bf16 v[210:213], v[70:73], a[248:251], v[210:213]
    ds_read_b128 v[142:145], v9 offset:4096
    s_mul_i32 s40, s40, 20480
    v_mfma_f32_16x16x32_bf16 v[230:233], v[70:73], a[252:255], v[230:233]
    v_mfma_f32_16x16x32_bf16 v[230:233], v[50:53], a[236:239], v[230:233]
    ds_read_b128 v[146:149], v9 offset:5120
    v_lshl_add_u32 v13, v19, 4, s40
    v_mfma_f32_16x16x32_bf16 v[174:177], v[54:57], a[224:227], v[174:177]
    s_add_u32 s44, s30, 180224
    buffer_load_dwordx4 a[208:211], v4, s[8:11], s44 offen sc1
    v_mfma_f32_16x16x32_bf16 v[174:177], v[74:77], a[240:243], v[174:177]
    s_sub_u32 s40, s5, 2
    v_mfma_f32_16x16x32_bf16 v[194:197], v[74:77], a[244:247], v[194:197]
    ds_read_b128 v[150:153], v9 offset:6144
    v_mfma_f32_16x16x32_bf16 v[194:197], v[54:57], a[228:231], v[194:197]
    buffer_load_dwordx4 a[212:215], v5, s[8:11], s44 offen sc1
    s_and_b32 s40, s40, 3
    v_mfma_f32_16x16x32_bf16 v[214:217], v[54:57], a[232:235], v[214:217]
    s_mul_i32 s40, s40, 20480
    v_mfma_f32_16x16x32_bf16 v[214:217], v[74:77], a[248:251], v[214:217]
    ds_read_b128 v[154:157], v9 offset:7168
    v_mfma_f32_16x16x32_bf16 v[234:237], v[74:77], a[252:255], v[234:237]
    v_lshl_add_u32 v14, v19, 4, s40
    v_mfma_f32_16x16x32_bf16 v[234:237], v[54:57], a[236:239], v[234:237]
    buffer_load_dwordx4 a[216:219], v6, s[8:11], s44 offen sc1
    v_mfma_f32_16x16x32_bf16 v[178:181], v[58:61], a[224:227], v[178:181]
    ds_read_b128 v[158:161], v9 offset:8192
    s_sub_u32 s40, s5, 3
    v_mfma_f32_16x16x32_bf16 v[178:181], v[78:81], a[240:243], v[178:181]
    v_mfma_f32_16x16x32_bf16 v[198:201], v[78:81], a[244:247], v[198:201]
    ds_read_b128 v[162:165], v9 offset:9216
    s_and_b32 s40, s40, 3
    v_mfma_f32_16x16x32_bf16 v[198:201], v[58:61], a[228:231], v[198:201]
    buffer_load_dwordx4 a[220:223], v7, s[8:11], s44 offen sc1
    s_mul_i32 s40, s40, 20480
    v_mfma_f32_16x16x32_bf16 v[218:221], v[58:61], a[232:235], v[218:221]
    v_mfma_f32_16x16x32_bf16 v[218:221], v[78:81], a[248:251], v[218:221]
    v_lshl_add_u32 v15, v19, 4, s40
    v_mfma_f32_16x16x32_bf16 v[238:241], v[78:81], a[252:255], v[238:241]
    v_mfma_f32_16x16x32_bf16 v[238:241], v[58:61], a[236:239], v[238:241]
    s_lshl_b32 s40, s2, 2
    v_mfma_f32_16x16x32_bf16 v[182:185], v[62:65], a[224:227], v[182:185]
    v_mfma_f32_16x16x32_bf16 v[182:185], v[82:85], a[240:243], v[182:185]
    s_add_u32 s40, s40, s5
    v_mfma_f32_16x16x32_bf16 v[202:205], v[82:85], a[244:247], v[202:205]
    s_mul_i32 s40, s40, 5120
    v_mfma_f32_16x16x32_bf16 v[202:205], v[62:65], a[228:231], v[202:205]
    v_mfma_f32_16x16x32_bf16 v[222:225], v[62:65], a[232:235], v[222:225]
    s_add_u32 s40, s40, 0x2000000
    v_mfma_f32_16x16x32_bf16 v[222:225], v[82:85], a[248:251], v[222:225]
    v_mfma_f32_16x16x32_bf16 v[242:245], v[82:85], a[252:255], v[242:245]
    v_lshl_add_u32 v18, v19, 4, s40
    v_mfma_f32_16x16x32_bf16 v[242:245], v[62:65], a[236:239], v[242:245]
    s_mov_b32 s41, 4096
    s_waitcnt vmcnt(8) lgkmcnt(0)
    v_mfma_f32_16x16x32_bf16 v[166:169], v[126:129], a[96:99], v[166:169]
    v_mfma_f32_16x16x32_bf16 v[166:169], v[146:149], a[112:115], v[166:169]
    s_add_u32 s44, s31, 0
    buffer_load_dwordx4 a[224:227], v4, s[8:11], s44 offen sc1
    v_mfma_f32_16x16x32_bf16 v[186:189], v[146:149], a[116:119], v[186:189]
    v_mfma_f32_16x16x32_bf16 v[186:189], v[126:129], a[100:103], v[186:189]
    v_mfma_f32_16x16x32_bf16 v[206:209], v[126:129], a[104:107], v[206:209]
    buffer_load_dwordx4 a[228:231], v5, s[8:11], s44 offen sc1
    v_mfma_f32_16x16x32_bf16 v[206:209], v[146:149], a[120:123], v[206:209]
    v_mfma_f32_16x16x32_bf16 v[226:229], v[146:149], a[124:127], v[226:229]
    v_mfma_f32_16x16x32_bf16 v[226:229], v[126:129], a[108:111], v[226:229]
    v_mfma_f32_16x16x32_bf16 v[170:173], v[130:133], a[96:99], v[170:173]
    buffer_load_dwordx4 a[232:235], v6, s[8:11], s44 offen sc1
    v_mfma_f32_16x16x32_bf16 v[170:173], v[150:153], a[112:115], v[170:173]
    v_mfma_f32_16x16x32_bf16 v[190:193], v[150:153], a[116:119], v[190:193]
    v_mfma_f32_16x16x32_bf16 v[190:193], v[130:133], a[100:103], v[190:193]
    v_mfma_f32_16x16x32_bf16 v[210:213], v[130:133], a[104:107], v[210:213]
    buffer_load_dwordx4 a[236:239], v7, s[8:11], s44 offen sc1
    v_mfma_f32_16x16x32_bf16 v[210:213], v[150:153], a[120:123], v[210:213]
    v_mfma_f32_16x16x32_bf16 v[230:233], v[150:153], a[124:127], v[230:233]
    v_mfma_f32_16x16x32_bf16 v[230:233], v[130:133], a[108:111], v[230:233]
    v_mfma_f32_16x16x32_bf16 v[174:177], v[134:137], a[96:99], v[174:177]
    s_add_u32 s44, s31, 16384
    buffer_load_dwordx4 a[240:243], v4, s[8:11], s44 offen sc1
    v_mfma_f32_16x16x32_bf16 v[174:177], v[154:157], a[112:115], v[174:177]
    v_mfma_f32_16x16x32_bf16 v[194:197], v[154:157], a[116:119], v[194:197]
    v_mfma_f32_16x16x32_bf16 v[194:197], v[134:137], a[100:103], v[194:197]
    buffer_load_dwordx4 a[244:247], v5, s[8:11], s44 offen sc1
    v_mfma_f32_16x16x32_bf16 v[214:217], v[134:137], a[104:107], v[214:217]
    v_mfma_f32_16x16x32_bf16 v[214:217], v[154:157], a[120:123], v[214:217]
    v_mfma_f32_16x16x32_bf16 v[234:237], v[154:157], a[124:127], v[234:237]
    v_mfma_f32_16x16x32_bf16 v[234:237], v[134:137], a[108:111], v[234:237]
    buffer_load_dwordx4 a[248:251], v6, s[8:11], s44 offen sc1
    v_mfma_f32_16x16x32_bf16 v[178:181], v[138:141], a[96:99], v[178:181]
    v_mfma_f32_16x16x32_bf16 v[178:181], v[158:161], a[112:115], v[178:181]
    v_mfma_f32_16x16x32_bf16 v[198:201], v[158:161], a[116:119], v[198:201]
    v_mfma_f32_16x16x32_bf16 v[198:201], v[138:141], a[100:103], v[198:201]
    buffer_load_dwordx4 a[252:255], v7, s[8:11], s44 offen sc1
    v_mfma_f32_16x16x32_bf16 v[218:221], v[138:141], a[104:107], v[218:221]
    v_mfma_f32_16x16x32_bf16 v[218:221], v[158:161], a[120:123], v[218:221]
    v_mfma_f32_16x16x32_bf16 v[238:241], v[158:161], a[124:127], v[238:241]
    v_mfma_f32_16x16x32_bf16 v[238:241], v[138:141], a[108:111], v[238:241]
    v_mfma_f32_16x16x32_bf16 v[182:185], v[142:145], a[96:99], v[182:185]
    v_mfma_f32_16x16x32_bf16 v[182:185], v[162:165], a[112:115], v[182:185]
    v_mfma_f32_16x16x32_bf16 v[202:205], v[162:165], a[116:119], v[202:205]
    v_mfma_f32_16x16x32_bf16 v[202:205], v[142:145], a[100:103], v[202:205]
    v_mfma_f32_16x16x32_bf16 v[222:225], v[142:145], a[104:107], v[222:225]
    v_mfma_f32_16x16x32_bf16 v[222:225], v[162:165], a[120:123], v[222:225]
    v_mfma_f32_16x16x32_bf16 v[242:245], v[162:165], a[124:127], v[242:245]
    v_mfma_f32_16x16x32_bf16 v[242:245], v[142:145], a[108:111], v[242:245]
    s_waitcnt vmcnt(8)
    v_mfma_f32_16x16x32_bf16 v[186:189], v[86:89], a[196:199], v[186:189]
    v_mfma_f32_16x16x32_bf16 v[186:189], v[106:109], a[212:215], v[186:189]
    s_add_u32 s44, s31, 32768
    buffer_load_dwordx4 a[96:99], v4, s[8:11], s44 offen sc1
    v_mfma_f32_16x16x32_bf16 v[190:193], v[110:113], a[212:215], v[190:193]
    v_mfma_f32_16x16x32_bf16 v[190:193], v[90:93], a[196:199], v[190:193]
    v_mfma_f32_16x16x32_bf16 v[194:197], v[94:97], a[196:199], v[194:197]
    buffer_load_dwordx4 a[100:103], v5, s[8:11], s44 offen sc1
    v_mfma_f32_16x16x32_bf16 v[194:197], v[114:117], a[212:215], v[194:197]
    v_mfma_f32_16x16x32_bf16 v[198:201], v[118:121], a[212:215], v[198:201]
    v_mfma_f32_16x16x32_bf16 v[198:201], v[98:101], a[196:199], v[198:201]
    v_mfma_f32_16x16x32_bf16 v[202:205], v[102:105], a[196:199], v[202:205]
    buffer_load_dwordx4 a[104:107], v6, s[8:11], s44 offen sc1
    v_mfma_f32_16x16x32_bf16 v[202:205], v[122:125], a[212:215], v[202:205]
    ds_write_b128 v10, v[186:189] offset:0
    v_mfma_f32_16x16x32_bf16 v[206:209], v[106:109], a[216:219], v[206:209]
    v_mfma_f32_16x16x32_bf16 v[206:209], v[86:89], a[200:203], v[206:209]
    ds_write_b128 v10, v[190:193] offset:1024
    v_mfma_f32_16x16x32_bf16 v[210:213], v[90:93], a[200:203], v[210:213]
    buffer_load_dwordx4 a[108:111], v7, s[8:11], s44 offen sc1
    v_mfma_f32_16x16x32_bf16 v[210:213], v[110:113], a[216:219], v[210:213]
    ds_write_b128 v10, v[194:197] offset:2048
    v_mfma_f32_16x16x32_bf16 v[214:217], v[114:117], a[216:219], v[214:217]
    v_mfma_f32_16x16x32_bf16 v[214:217], v[94:97], a[200:203], v[214:217]
    ds_write_b128 v10, v[198:201] offset:3072
    v_mfma_f32_16x16x32_bf16 v[218:221], v[98:101], a[200:203], v[218:221]
    s_add_u32 s44, s31, 49152
    buffer_load_dwordx4 a[112:115], v4, s[8:11], s44 offen sc1
    v_mfma_f32_16x16x32_bf16 v[218:221], v[118:121], a[216:219], v[218:221]
    ds_write_b128 v10, v[202:205] offset:4096
    v_mfma_f32_16x16x32_bf16 v[222:225], v[122:125], a[216:219], v[222:225]
    v_mfma_f32_16x16x32_bf16 v[222:225], v[102:105], a[200:203], v[222:225]
    ds_write_b128 v10, v[206:209] offset:5120
    buffer_load_dwordx4 a[116:119], v5, s[8:11], s44 offen sc1
    v_mfma_f32_16x16x32_bf16 v[226:229], v[86:89], a[204:207], v[226:229]
    v_mfma_f32_16x16x32_bf16 v[226:229], v[106:109], a[220:223], v[226:229]
    ds_write_b128 v10, v[210:213] offset:6144
    v_mfma_f32_16x16x32_bf16 v[230:233], v[110:113], a[220:223], v[230:233]
    v_mfma_f32_16x16x32_bf16 v[230:233], v[90:93], a[204:207], v[230:233]
    ds_write_b128 v10, v[214:217] offset:7168
    buffer_load_dwordx4 a[120:123], v6, s[8:11], s44 offen sc1
    v_mfma_f32_16x16x32_bf16 v[234:237], v[94:97], a[204:207], v[234:237]
    v_mfma_f32_16x16x32_bf16 v[234:237], v[114:117], a[220:223], v[234:237]
    ds_write_b128 v10, v[218:221] offset:8192
    v_mfma_f32_16x16x32_bf16 v[238:241], v[118:121], a[220:223], v[238:241]
    v_mfma_f32_16x16x32_bf16 v[238:241], v[98:101], a[204:207], v[238:241]
    ds_write_b128 v10, v[222:225] offset:9216
    buffer_load_dwordx4 a[124:127], v7, s[8:11], s44 offen sc1
    v_mfma_f32_16x16x32_bf16 v[242:245], v[102:105], a[204:207], v[242:245]
    v_mfma_f32_16x16x32_bf16 v[242:245], v[122:125], a[220:223], v[242:245]
    ds_write_b128 v10, v[226:229] offset:10240
    v_mfma_f32_16x16x32_bf16 v[166:169], v[106:109], a[208:211], v[166:169]
    v_mfma_f32_16x16x32_bf16 v[166:169], v[86:89], a[192:195], v[166:169]
    ds_write_b128 v10, v[230:233] offset:11264
    v_mfma_f32_16x16x32_bf16 v[170:173], v[90:93], a[192:195], v[170:173]
    v_mfma_f32_16x16x32_bf16 v[170:173], v[110:113], a[208:211], v[170:173]
    ds_write_b128 v10, v[234:237] offset:12288
    v_mfma_f32_16x16x32_bf16 v[174:177], v[114:117], a[208:211], v[174:177]
    v_mfma_f32_16x16x32_bf16 v[174:177], v[94:97], a[192:195], v[174:177]
    ds_write_b128 v10, v[238:241] offset:13312
    v_mfma_f32_16x16x32_bf16 v[178:181], v[98:101], a[192:195], v[178:181]
    v_mfma_f32_16x16x32_bf16 v[178:181], v[118:121], a[208:211], v[178:181]
    ds_write_b128 v10, v[242:245] offset:14336
    v_mfma_f32_16x16x32_bf16 v[182:185], v[122:125], a[208:211], v[182:185]
    v_mfma_f32_16x16x32_bf16 v[182:185], v[102:105], a[192:195], v[182:185]
    s_waitcnt vmcnt(8)
    v_mfma_f32_16x16x32_bf16 v[186:189], a[128:131], a[228:231], 0
    s_nop 0
    v_mov_b32 v126, v166
    v_mfma_f32_16x16x32_bf16 v[186:189], a[148:151], a[244:247], v[186:189]
    s_add_u32 s44, s31, 65536
    buffer_load_dwordx4 a[192:195], v4, s[8:11], s44 offen sc1
    v_mov_b32 v127, v167
    v_mov_b32 v128, v168
    v_mov_b32 v129, v169
    v_mfma_f32_16x16x32_bf16 v[190:193], a[152:155], a[244:247], 0
    v_mov_b32 v130, v170
    v_mov_b32 v131, v171
    v_mov_b32 v132, v172
    v_mfma_f32_16x16x32_bf16 v[190:193], a[132:135], a[228:231], v[190:193]
    v_mov_b32 v133, v173
    s_waitcnt lgkmcnt(0)
    s_barrier
    v_mfma_f32_16x16x32_bf16 v[194:197], a[136:139], a[228:231], 0
    buffer_load_dwordx4 a[196:199], v5, s[8:11], s44 offen sc1
    ds_read_b128 v[146:149], v13 offset:0
    ds_read_b128 v[150:153], v13 offset:1024
    v_mfma_f32_16x16x32_bf16 v[194:197], a[156:159], a[244:247], v[194:197]
    ds_read_b128 v[154:157], v13 offset:2048
    ds_read_b128 v[158:161], v13 offset:3072
    ds_read_b128 v[162:165], v13 offset:4096
    v_mfma_f32_16x16x32_bf16 v[198:201], a[160:163], a[244:247], 0
    v_mov_b32 v134, v174
    v_mov_b32 v135, v175
    v_mov_b32 v136, v176
    v_mfma_f32_16x16x32_bf16 v[198:201], a[140:143], a[228:231], v[198:201]
    v_mov_b32 v137, v177
    v_mov_b32 v138, v178
    v_mov_b32 v139, v179
    v_mfma_f32_16x16x32_bf16 v[202:205], a[144:147], a[228:231], 0
    buffer_load_dwordx4 a[200:203], v6, s[8:11], s44 offen sc1
    v_mov_b32 v140, v180
    v_mov_b32 v141, v181
    v_mfma_f32_16x16x32_bf16 v[202:205], a[164:167], a[244:247], v[202:205]
    v_mov_b32 v142, v182
    v_mov_b32 v143, v183
    v_mov_b32 v144, v184
    v_mfma_f32_16x16x32_bf16 v[206:209], a[148:151], a[248:251], 0
    v_mov_b32 v145, v185
    s_waitcnt lgkmcnt(4)
    v_add_f32 v126, v126, v146
    v_mfma_f32_16x16x32_bf16 v[206:209], a[128:131], a[232:235], v[206:209]
    v_add_f32 v127, v127, v147
    v_add_f32 v128, v128, v148
    v_add_f32 v129, v129, v149
    v_mfma_f32_16x16x32_bf16 v[210:213], a[132:135], a[232:235], 0
    buffer_load_dwordx4 a[204:207], v7, s[8:11], s44 offen sc1
    ds_read_b128 v[146:149], v14 offset:5120
    s_waitcnt lgkmcnt(4)
    v_mfma_f32_16x16x32_bf16 v[210:213], a[152:155], a[248:251], v[210:213]
    v_add_f32 v130, v130, v150
    v_add_f32 v131, v131, v151
    v_add_f32 v132, v132, v152
    v_mfma_f32_16x16x32_bf16 v[214:217], a[156:159], a[248:251], 0
    v_add_f32 v133, v133, v153
    ds_read_b128 v[150:153], v14 offset:6144
    s_waitcnt lgkmcnt(4)
    v_mfma_f32_16x16x32_bf16 v[214:217], a[136:139], a[232:235], v[214:217]
    v_add_f32 v134, v134, v154
    v_add_f32 v135, v135, v155
    v_add_f32 v136, v136, v156
    v_mfma_f32_16x16x32_bf16 v[218:221], a[140:143], a[232:235], 0
    s_add_u32 s44, s31, 81920
    buffer_load_dwordx4 a[208:211], v4, s[8:11], s44 offen sc1
    v_add_f32 v137, v137, v157
    ds_read_b128 v[154:157], v14 offset:7168
    v_mfma_f32_16x16x32_bf16 v[218:221], a[160:163], a[248:251], v[218:221]
    s_waitcnt lgkmcnt(4)
    v_add_f32 v138, v138, v158
    v_add_f32 v139, v139, v159
    v_mfma_f32_16x16x32_bf16 v[222:225], a[164:167], a[248:251], 0
    v_add_f32 v140, v140, v160
    v_add_f32 v141, v141, v161
    ds_read_b128 v[158:161], v14 offset:8192
    v_mfma_f32_16x16x32_bf16 v[222:225], a[144:147], a[232:235], v[222:225]
    buffer_load_dwordx4 a[212:215], v5, s[8:11], s44 offen sc1
    s_waitcnt lgkmcnt(4)
    v_add_f32 v142, v142, v162
    v_add_f32 v143, v143, v163
    v_mfma_f32_16x16x32_bf16 v[226:229], a[128:131], a[236:239], 0
    v_add_f32 v144, v144, v164
    v_add_f32 v145, v145, v165
    v_mfma_f32_16x16x32_bf16 v[226:229], a[148:151], a[252:255], v[226:229]
    ds_read_b128 v[162:165], v14 offset:9216
    s_waitcnt lgkmcnt(4)
    v_add_f32 v126, v126, v146
    v_mfma_f32_16x16x32_bf16 v[230:233], a[152:155], a[252:255], 0
    v_add_f32 v127, v127, v147
    v_add_f32 v128, v128, v148
    v_add_f32 v129, v129, v149
    v_mfma_f32_16x16x32_bf16 v[230:233], a[132:135], a[236:239], v[230:233]
    buffer_load_dwordx4 a[216:219], v6, s[8:11], s44 offen sc1
    ds_read_b128 v[146:149], v15 offset:10240
    s_waitcnt lgkmcnt(4)
    v_add_f32 v130, v130, v150
    v_mfma_f32_16x16x32_bf16 v[234:237], a[136:139], a[236:239], 0
    v_add_f32 v131, v131, v151
    v_add_f32 v132, v132, v152
    v_mfma_f32_16x16x32_bf16 v[234:237], a[156:159], a[252:255], v[234:237]
    v_add_f32 v133, v133, v153
    ds_read_b128 v[150:153], v15 offset:11264
    s_waitcnt lgkmcnt(4)
    v_mfma_f32_16x16x32_bf16 v[238:241], a[160:163], a[252:255], 0
    v_add_f32 v134, v134, v154
    v_add_f32 v135, v135, v155
    v_add_f32 v136, v136, v156
    v_mfma_f32_16x16x32_bf16 v[238:241], a[140:143], a[236:239], v[238:241]
    buffer_load_dwordx4 a[220:223], v7, s[8:11], s44 offen sc1
    v_add_f32 v137, v137, v157
    ds_read_b128 v[154:157], v15 offset:12288
    s_waitcnt lgkmcnt(4)
    v_mfma_f32_16x16x32_bf16 v[242:245], a[144:147], a[236:239], 0
    v_add_f32 v138, v138, v158
    v_add_f32 v139, v139, v159
    v_mfma_f32_16x16x32_bf16 v[242:245], a[164:167], a[252:255], v[242:245]
    v_add_f32 v140, v140, v160
    v_add_f32 v141, v141, v161
    ds_read_b128 v[158:161], v15 offset:13312
    v_mfma_f32_16x16x32_bf16 v[166:169], a[148:151], a[240:243], 0
    s_waitcnt lgkmcnt(4)
    v_add_f32 v142, v142, v162
    v_add_f32 v143, v143, v163
    v_mfma_f32_16x16x32_bf16 v[166:169], a[128:131], a[224:227], v[166:169]
    v_add_f32 v144, v144, v164
    v_add_f32 v145, v145, v165
    ds_read_b128 v[162:165], v15 offset:14336
    v_mfma_f32_16x16x32_bf16 v[170:173], a[132:135], a[224:227], 0
    s_waitcnt lgkmcnt(4)
    v_add_f32 v126, v126, v146
    v_mfma_f32_16x16x32_bf16 v[170:173], a[152:155], a[240:243], v[170:173]
    v_add_f32 v127, v127, v147
    v_add_f32 v128, v128, v148
    v_add_f32 v129, v129, v149
    v_mfma_f32_16x16x32_bf16 v[174:177], a[156:159], a[240:243], 0
    s_waitcnt lgkmcnt(3)
    v_add_f32 v130, v130, v150
    v_add_f32 v131, v131, v151
    v_mfma_f32_16x16x32_bf16 v[174:177], a[136:139], a[224:227], v[174:177]
    v_add_f32 v132, v132, v152
    v_add_f32 v133, v133, v153
    s_waitcnt lgkmcnt(2)
    v_mfma_f32_16x16x32_bf16 v[178:181], a[140:143], a[224:227], 0
    v_add_f32 v134, v134, v154
    v_add_f32 v135, v135, v155
    v_mfma_f32_16x16x32_bf16 v[178:181], a[160:163], a[240:243], v[178:181]
    v_add_f32 v136, v136, v156
    v_add_f32 v137, v137, v157
    s_waitcnt lgkmcnt(1)
    v_mfma_f32_16x16x32_bf16 v[182:185], a[164:167], a[240:243], 0
    v_add_f32 v138, v138, v158
    v_add_f32 v139, v139, v159
    v_add_f32 v140, v140, v160
    v_mfma_f32_16x16x32_bf16 v[182:185], a[144:147], a[224:227], v[182:185]
    v_add_f32 v141, v141, v161
    s_waitcnt lgkmcnt(0)
    v_add_f32 v142, v142, v162
    s_waitcnt vmcnt(8)
    v_mfma_f32_16x16x32_bf16 v[166:169], a[168:171], a[96:99], v[166:169]
    v_mfma_f32_16x16x32_bf16 v[166:169], a[188:191], a[112:115], v[166:169]
    s_add_u32 s44, s31, 196608
    buffer_load_dwordx4 a[224:227], v4, s[8:11], s44 offen sc1
    v_mfma_f32_16x16x32_bf16 v[186:189], a[188:191], a[116:119], v[186:189]
    buffer_load_dwordx4 a[228:231], v5, s[8:11], s44 offen sc1
    v_mfma_f32_16x16x32_bf16 v[186:189], a[168:171], a[100:103], v[186:189]
    buffer_load_dwordx4 a[232:235], v6, s[8:11], s44 offen sc1
    v_add_f32 v143, v143, v163
    v_mfma_f32_16x16x32_bf16 v[206:209], a[168:171], a[104:107], v[206:209]
    buffer_load_dwordx4 a[236:239], v7, s[8:11], s44 offen sc1
    v_mfma_f32_16x16x32_bf16 v[206:209], a[188:191], a[120:123], v[206:209]
    v_mfma_f32_16x16x32_bf16 v[226:229], a[188:191], a[124:127], v[226:229]
    s_add_u32 s44, s31, 212992
    buffer_load_dwordx4 a[240:243], v4, s[8:11], s44 offen sc1
    v_add_f32 v144, v144, v164
    v_mfma_f32_16x16x32_bf16 v[226:229], a[168:171], a[108:111], v[226:229]
    buffer_load_dwordx4 a[244:247], v5, s[8:11], s44 offen sc1
    v_mfma_f32_16x16x32_bf16 v[170:173], a[172:175], a[96:99], v[170:173]
    buffer_load_dwordx4 a[248:251], v6, s[8:11], s44 offen sc1
    v_mfma_f32_16x16x32_bf16 v[170:173], a[0:3], a[112:115], v[170:173]
    buffer_load_dwordx4 a[252:255], v7, s[8:11], s44 offen sc1
    v_add_f32 v145, v145, v165
    v_mfma_f32_16x16x32_bf16 v[190:193], a[0:3], a[116:119], v[190:193]
    v_mfma_f32_16x16x32_bf16 v[190:193], a[172:175], a[100:103], v[190:193]
    v_mfma_f32_16x16x32_bf16 v[210:213], a[172:175], a[104:107], v[210:213]
    buffer_store_dwordx4 v[126:129], v18, s[76:79], 0 offen offset:0 sc1
    v_mfma_f32_16x16x32_bf16 v[210:213], a[0:3], a[120:123], v[210:213]
    v_mfma_f32_16x16x32_bf16 v[230:233], a[0:3], a[124:127], v[230:233]
    v_mfma_f32_16x16x32_bf16 v[230:233], a[172:175], a[108:111], v[230:233]
    v_mfma_f32_16x16x32_bf16 v[174:177], a[176:179], a[96:99], v[174:177]
    v_mfma_f32_16x16x32_bf16 v[174:177], a[4:7], a[112:115], v[174:177]
    v_mfma_f32_16x16x32_bf16 v[194:197], a[4:7], a[116:119], v[194:197]
    buffer_store_dwordx4 v[130:133], v18, s[76:79], 0 offen offset:1024 sc1
    v_mfma_f32_16x16x32_bf16 v[194:197], a[176:179], a[100:103], v[194:197]
    v_mfma_f32_16x16x32_bf16 v[214:217], a[176:179], a[104:107], v[214:217]
    v_mfma_f32_16x16x32_bf16 v[214:217], a[4:7], a[120:123], v[214:217]
    v_mfma_f32_16x16x32_bf16 v[234:237], a[4:7], a[124:127], v[234:237]
    v_mfma_f32_16x16x32_bf16 v[234:237], a[176:179], a[108:111], v[234:237]
    v_mfma_f32_16x16x32_bf16 v[178:181], a[180:183], a[96:99], v[178:181]
    buffer_store_dwordx4 v[134:137], v18, s[76:79], 0 offen offset:2048 sc1
    v_mfma_f32_16x16x32_bf16 v[178:181], a[8:11], a[112:115], v[178:181]
    v_mfma_f32_16x16x32_bf16 v[198:201], a[8:11], a[116:119], v[198:201]
    v_mfma_f32_16x16x32_bf16 v[198:201], a[180:183], a[100:103], v[198:201]
    v_mfma_f32_16x16x32_bf16 v[218:221], a[180:183], a[104:107], v[218:221]
    v_mfma_f32_16x16x32_bf16 v[218:221], a[8:11], a[120:123], v[218:221]
    v_mfma_f32_16x16x32_bf16 v[238:241], a[8:11], a[124:127], v[238:241]
    buffer_store_dwordx4 v[138:141], v18, s[76:79], 0 offen offset:3072 sc1
    v_mfma_f32_16x16x32_bf16 v[238:241], a[180:183], a[108:111], v[238:241]
    v_mfma_f32_16x16x32_bf16 v[182:185], a[184:187], a[96:99], v[182:185]
    v_mfma_f32_16x16x32_bf16 v[182:185], a[12:15], a[112:115], v[182:185]
    v_mfma_f32_16x16x32_bf16 v[202:205], a[12:15], a[116:119], v[202:205]
    v_mfma_f32_16x16x32_bf16 v[202:205], a[184:187], a[100:103], v[202:205]
    v_mfma_f32_16x16x32_bf16 v[222:225], a[184:187], a[104:107], v[222:225]
    buffer_store_dwordx4 v[142:145], v18, s[76:79], s41 offen offset:0 sc1
    v_mfma_f32_16x16x32_bf16 v[222:225], a[12:15], a[120:123], v[222:225]
    v_mfma_f32_16x16x32_bf16 v[242:245], a[12:15], a[124:127], v[242:245]
    v_mfma_f32_16x16x32_bf16 v[242:245], a[184:187], a[108:111], v[242:245]
    s_waitcnt vmcnt(13)
    v_mfma_f32_16x16x32_bf16 v[166:169], a[16:19], a[192:195], v[166:169]
    v_mfma_f32_16x16x32_bf16 v[166:169], a[36:39], a[208:211], v[166:169]
    s_add_u32 s44, s31, 98304
    buffer_load_dwordx4 a[96:99], v4, s[8:11], s44 offen sc1
    v_mfma_f32_16x16x32_bf16 v[186:189], a[36:39], a[212:215], v[186:189]
    v_mfma_f32_16x16x32_bf16 v[186:189], a[16:19], a[196:199], v[186:189]
    v_mfma_f32_16x16x32_bf16 v[206:209], a[16:19], a[200:203], v[206:209]
    buffer_load_dwordx4 a[100:103], v5, s[8:11], s44 offen sc1
    v_mfma_f32_16x16x32_bf16 v[206:209], a[36:39], a[216:219], v[206:209]
    v_mfma_f32_16x16x32_bf16 v[226:229], a[36:39], a[220:223], v[226:229]
    v_mfma_f32_16x16x32_bf16 v[226:229], a[16:19], a[204:207], v[226:229]
    v_mfma_f32_16x16x32_bf16 v[170:173], a[20:23], a[192:195], v[170:173]
    buffer_load_dwordx4 a[104:107], v6, s[8:11], s44 offen sc1
    v_mfma_f32_16x16x32_bf16 v[170:173], a[40:43], a[208:211], v[170:173]
    v_mfma_f32_16x16x32_bf16 v[190:193], a[40:43], a[212:215], v[190:193]
    v_mfma_f32_16x16x32_bf16 v[190:193], a[20:23], a[196:199], v[190:193]
    v_mfma_f32_16x16x32_bf16 v[210:213], a[20:23], a[200:203], v[210:213]
    buffer_load_dwordx4 a[108:111], v7, s[8:11], s44 offen sc1
    v_mfma_f32_16x16x32_bf16 v[210:213], a[40:43], a[216:219], v[210:213]
    v_mfma_f32_16x16x32_bf16 v[230:233], a[40:43], a[220:223], v[230:233]
    v_mfma_f32_16x16x32_bf16 v[230:233], a[20:23], a[204:207], v[230:233]
    ds_read_b128 v[126:129], v8 offset:0
    v_mfma_f32_16x16x32_bf16 v[174:177], a[24:27], a[192:195], v[174:177]
    s_add_u32 s44, s31, 114688
    buffer_load_dwordx4 a[112:115], v4, s[8:11], s44 offen sc1
    v_mfma_f32_16x16x32_bf16 v[174:177], a[44:47], a[208:211], v[174:177]
    v_mfma_f32_16x16x32_bf16 v[194:197], a[44:47], a[212:215], v[194:197]
    ds_read_b128 v[130:133], v8 offset:1024
    v_mfma_f32_16x16x32_bf16 v[194:197], a[24:27], a[196:199], v[194:197]
    buffer_load_dwordx4 a[116:119], v5, s[8:11], s44 offen sc1
    v_mfma_f32_16x16x32_bf16 v[214:217], a[24:27], a[200:203], v[214:217]
    v_mfma_f32_16x16x32_bf16 v[214:217], a[44:47], a[216:219], v[214:217]
    ds_read_b128 v[134:137], v8 offset:2048
    v_mfma_f32_16x16x32_bf16 v[234:237], a[44:47], a[220:223], v[234:237]
    v_mfma_f32_16x16x32_bf16 v[234:237], a[24:27], a[204:207], v[234:237]
    buffer_load_dwordx4 a[120:123], v6, s[8:11], s44 offen sc1
    v_mfma_f32_16x16x32_bf16 v[178:181], a[28:31], a[192:195], v[178:181]
    ds_read_b128 v[138:141], v8 offset:3072
    v_mfma_f32_16x16x32_bf16 v[178:181], a[48:51], a[208:211], v[178:181]
    v_mfma_f32_16x16x32_bf16 v[198:201], a[48:51], a[212:215], v[198:201]
    ds_read_b128 v[142:145], v8 offset:4096
    v_mfma_f32_16x16x32_bf16 v[198:201], a[28:31], a[196:199], v[198:201]
    buffer_load_dwordx4 a[124:127], v7, s[8:11], s44 offen sc1
    v_mfma_f32_16x16x32_bf16 v[218:221], a[28:31], a[200:203], v[218:221]
    v_mfma_f32_16x16x32_bf16 v[218:221], a[48:51], a[216:219], v[218:221]
    ds_read_b128 v[146:149], v8 offset:5120
    v_mfma_f32_16x16x32_bf16 v[238:241], a[48:51], a[220:223], v[238:241]
    v_mfma_f32_16x16x32_bf16 v[238:241], a[28:31], a[204:207], v[238:241]
    ds_read_b128 v[150:153], v8 offset:6144
    v_mfma_f32_16x16x32_bf16 v[182:185], a[32:35], a[192:195], v[182:185]
    v_mfma_f32_16x16x32_bf16 v[182:185], a[52:55], a[208:211], v[182:185]
    ds_read_b128 v[154:157], v8 offset:7168
    v_mfma_f32_16x16x32_bf16 v[202:205], a[52:55], a[212:215], v[202:205]
    v_mfma_f32_16x16x32_bf16 v[202:205], a[32:35], a[196:199], v[202:205]
    ds_read_b128 v[158:161], v8 offset:8192
    v_mfma_f32_16x16x32_bf16 v[222:225], a[32:35], a[200:203], v[222:225]
    v_mfma_f32_16x16x32_bf16 v[222:225], a[52:55], a[216:219], v[222:225]
    ds_read_b128 v[162:165], v8 offset:9216
    v_mfma_f32_16x16x32_bf16 v[242:245], a[52:55], a[220:223], v[242:245]
    buffer_load_dwordx2 v[20:21], v11, s[76:79], 0 offen offset:0 sc1
    buffer_load_dwordx2 v[246:247], v11, s[76:79], 0 offen offset:32 sc1
    buffer_load_dwordx2 v[248:249], v11, s[76:79], 0 offen offset:64 sc1
    buffer_load_dwordx2 v[252:253], v11, s[76:79], 0 offen offset:96 sc1
    buffer_load_dwordx2 v[254:255], v11, s[76:79], 0 offen offset:128 sc1
    v_mfma_f32_16x16x32_bf16 v[242:245], a[32:35], a[204:207], v[242:245]
    s_waitcnt vmcnt(18) lgkmcnt(0)
    v_mfma_f32_16x16x32_bf16 v[166:169], v[126:129], a[224:227], v[166:169]
    s_waitcnt vmcnt(13)
    s_mov_b64 exec, 1
    buffer_store_dword v2, off, s[76:79], s36 sc1
    s_mov_b64 exec, -1
    v_mfma_f32_16x16x32_bf16 v[166:169], v[146:149], a[240:243], v[166:169]
    s_add_u32 s44, s31, 229376
    buffer_load_dwordx4 a[192:195], v4, s[8:11], s44 offen sc1
    v_mfma_f32_16x16x32_bf16 v[186:189], v[146:149], a[244:247], v[186:189]
    v_mfma_f32_16x16x32_bf16 v[186:189], v[126:129], a[228:231], v[186:189]
    v_mfma_f32_16x16x32_bf16 v[206:209], v[126:129], a[232:235], v[206:209]
    buffer_load_dwordx4 a[196:199], v5, s[8:11], s44 offen sc1
    v_mfma_f32_16x16x32_bf16 v[206:209], v[146:149], a[248:251], v[206:209]
    v_mfma_f32_16x16x32_bf16 v[226:229], v[146:149], a[252:255], v[226:229]
    v_mfma_f32_16x16x32_bf16 v[226:229], v[126:129], a[236:239], v[226:229]
    v_mfma_f32_16x16x32_bf16 v[170:173], v[130:133], a[224:227], v[170:173]
    buffer_load_dwordx4 a[200:203], v6, s[8:11], s44 offen sc1
    v_mfma_f32_16x16x32_bf16 v[170:173], v[150:153], a[240:243], v[170:173]
    v_mfma_f32_16x16x32_bf16 v[190:193], v[150:153], a[244:247], v[190:193]
    v_mfma_f32_16x16x32_bf16 v[190:193], v[130:133], a[228:231], v[190:193]
    v_mfma_f32_16x16x32_bf16 v[210:213], v[130:133], a[232:235], v[210:213]
    buffer_load_dwordx4 a[204:207], v7, s[8:11], s44 offen sc1
    v_mfma_f32_16x16x32_bf16 v[210:213], v[150:153], a[248:251], v[210:213]
    v_mfma_f32_16x16x32_bf16 v[230:233], v[150:153], a[252:255], v[230:233]
    v_mfma_f32_16x16x32_bf16 v[230:233], v[130:133], a[236:239], v[230:233]
    v_mfma_f32_16x16x32_bf16 v[174:177], v[134:137], a[224:227], v[174:177]
    s_add_u32 s44, s31, 245760
    buffer_load_dwordx4 a[208:211], v4, s[8:11], s44 offen sc1
    v_mfma_f32_16x16x32_bf16 v[174:177], v[154:157], a[240:243], v[174:177]
    v_mfma_f32_16x16x32_bf16 v[194:197], v[154:157], a[244:247], v[194:197]
    v_mfma_f32_16x16x32_bf16 v[194:197], v[134:137], a[228:231], v[194:197]
    buffer_load_dwordx4 a[212:215], v5, s[8:11], s44 offen sc1
    v_mfma_f32_16x16x32_bf16 v[214:217], v[134:137], a[232:235], v[214:217]
    v_mfma_f32_16x16x32_bf16 v[214:217], v[154:157], a[248:251], v[214:217]
    v_mfma_f32_16x16x32_bf16 v[234:237], v[154:157], a[252:255], v[234:237]
    v_mfma_f32_16x16x32_bf16 v[234:237], v[134:137], a[236:239], v[234:237]
    buffer_load_dwordx4 a[216:219], v6, s[8:11], s44 offen sc1
    v_mfma_f32_16x16x32_bf16 v[178:181], v[138:141], a[224:227], v[178:181]
    v_mfma_f32_16x16x32_bf16 v[178:181], v[158:161], a[240:243], v[178:181]
    v_mfma_f32_16x16x32_bf16 v[198:201], v[158:161], a[244:247], v[198:201]
    v_mfma_f32_16x16x32_bf16 v[198:201], v[138:141], a[228:231], v[198:201]
    buffer_load_dwordx4 a[220:223], v7, s[8:11], s44 offen sc1
    v_mfma_f32_16x16x32_bf16 v[218:221], v[138:141], a[232:235], v[218:221]
    v_mfma_f32_16x16x32_bf16 v[218:221], v[158:161], a[248:251], v[218:221]
    v_mfma_f32_16x16x32_bf16 v[238:241], v[158:161], a[252:255], v[238:241]
    v_mfma_f32_16x16x32_bf16 v[238:241], v[138:141], a[236:239], v[238:241]
    v_mfma_f32_16x16x32_bf16 v[182:185], v[142:145], a[224:227], v[182:185]
    v_mfma_f32_16x16x32_bf16 v[182:185], v[162:165], a[240:243], v[182:185]
    v_mfma_f32_16x16x32_bf16 v[202:205], v[162:165], a[244:247], v[202:205]
    v_mfma_f32_16x16x32_bf16 v[202:205], v[142:145], a[228:231], v[202:205]
    v_mfma_f32_16x16x32_bf16 v[222:225], v[142:145], a[232:235], v[222:225]
    v_mfma_f32_16x16x32_bf16 v[222:225], v[162:165], a[248:251], v[222:225]
    v_mfma_f32_16x16x32_bf16 v[242:245], v[162:165], a[252:255], v[242:245]
    v_mfma_f32_16x16x32_bf16 v[242:245], v[142:145], a[236:239], v[242:245]
    s_waitcnt vmcnt(14)
    v_mfma_f32_16x16x32_bf16 v[166:169], a[56:59], a[96:99], v[166:169]
    v_mfma_f32_16x16x32_bf16 v[166:169], a[76:79], a[112:115], v[166:169]
    s_add_u32 s44, s31, 131072
    buffer_load_dwordx4 a[224:227], v4, s[8:11], s44 offen sc1
    v_mfma_f32_16x16x32_bf16 v[186:189], a[76:79], a[116:119], v[186:189]
    ds_read_b128 v[126:129], v9 offset:0
    v_mfma_f32_16x16x32_bf16 v[186:189], a[56:59], a[100:103], v[186:189]
    v_mfma_f32_16x16x32_bf16 v[206:209], a[56:59], a[104:107], v[206:209]
    buffer_load_dwordx4 a[228:231], v5, s[8:11], s44 offen sc1
    v_mfma_f32_16x16x32_bf16 v[206:209], a[76:79], a[120:123], v[206:209]
    ds_read_b128 v[130:133], v9 offset:1024
    v_mfma_f32_16x16x32_bf16 v[226:229], a[76:79], a[124:127], v[226:229]
    v_mfma_f32_16x16x32_bf16 v[226:229], a[56:59], a[108:111], v[226:229]
    ds_read_b128 v[134:137], v9 offset:2048
    v_mfma_f32_16x16x32_bf16 v[170:173], a[60:63], a[96:99], v[170:173]
    buffer_load_dwordx4 a[232:235], v6, s[8:11], s44 offen sc1
    v_mfma_f32_16x16x32_bf16 v[170:173], a[80:83], a[112:115], v[170:173]
    v_mfma_f32_16x16x32_bf16 v[190:193], a[80:83], a[116:119], v[190:193]
    ds_read_b128 v[138:141], v9 offset:3072
    v_mfma_f32_16x16x32_bf16 v[190:193], a[60:63], a[100:103], v[190:193]
    v_mfma_f32_16x16x32_bf16 v[210:213], a[60:63], a[104:107], v[210:213]
    buffer_load_dwordx4 a[236:239], v7, s[8:11], s44 offen sc1
    v_mfma_f32_16x16x32_bf16 v[210:213], a[80:83], a[120:123], v[210:213]
    ds_read_b128 v[142:145], v9 offset:4096
    v_mfma_f32_16x16x32_bf16 v[230:233], a[80:83], a[124:127], v[230:233]
    v_mfma_f32_16x16x32_bf16 v[230:233], a[60:63], a[108:111], v[230:233]
    ds_read_b128 v[146:149], v9 offset:5120
    v_mfma_f32_16x16x32_bf16 v[174:177], a[64:67], a[96:99], v[174:177]
    s_add_u32 s44, s31, 147456
    buffer_load_dwordx4 a[240:243], v4, s[8:11], s44 offen sc1
    v_mfma_f32_16x16x32_bf16 v[174:177], a[84:87], a[112:115], v[174:177]
    v_mfma_f32_16x16x32_bf16 v[194:197], a[84:87], a[116:119], v[194:197]
    ds_read_b128 v[150:153], v9 offset:6144
    v_mfma_f32_16x16x32_bf16 v[194:197], a[64:67], a[100:103], v[194:197]
    buffer_load_dwordx4 a[244:247], v5, s[8:11], s44 offen sc1
    v_mfma_f32_16x16x32_bf16 v[214:217], a[64:67], a[104:107], v[214:217]
    v_mfma_f32_16x16x32_bf16 v[214:217], a[84:87], a[120:123], v[214:217]
    ds_read_b128 v[154:157], v9 offset:7168
    v_mfma_f32_16x16x32_bf16 v[234:237], a[84:87], a[124:127], v[234:237]
    v_mfma_f32_16x16x32_bf16 v[234:237], a[64:67], a[108:111], v[234:237]
    buffer_load_dwordx4 a[248:251], v6, s[8:11], s44 offen sc1
    v_mfma_f32_16x16x32_bf16 v[178:181], a[68:71], a[96:99], v[178:181]
    ds_read_b128 v[158:161], v9 offset:8192
    v_mfma_f32_16x16x32_bf16 v[178:181], a[88:91], a[112:115], v[178:181]
    v_mfma_f32_16x16x32_bf16 v[198:201], a[88:91], a[116:119], v[198:201]
    ds_read_b128 v[162:165], v9 offset:9216
    v_mfma_f32_16x16x32_bf16 v[198:201], a[68:71], a[100:103], v[198:201]
    buffer_load_dwordx4 a[252:255], v7, s[8:11], s44 offen sc1
    v_mfma_f32_16x16x32_bf16 v[218:221], a[68:71], a[104:107], v[218:221]
    v_mfma_f32_16x16x32_bf16 v[218:221], a[88:91], a[120:123], v[218:221]
    v_mfma_f32_16x16x32_bf16 v[238:241], a[88:91], a[124:127], v[238:241]
    v_mfma_f32_16x16x32_bf16 v[238:241], a[68:71], a[108:111], v[238:241]
    v_mfma_f32_16x16x32_bf16 v[182:185], a[72:75], a[96:99], v[182:185]
    v_mfma_f32_16x16x32_bf16 v[182:185], a[92:95], a[112:115], v[182:185]
    v_mfma_f32_16x16x32_bf16 v[202:205], a[92:95], a[116:119], v[202:205]
    v_mfma_f32_16x16x32_bf16 v[202:205], a[72:75], a[100:103], v[202:205]
    v_mfma_f32_16x16x32_bf16 v[222:225], a[72:75], a[104:107], v[222:225]
    v_mfma_f32_16x16x32_bf16 v[222:225], a[92:95], a[120:123], v[222:225]
    v_mfma_f32_16x16x32_bf16 v[242:245], a[92:95], a[124:127], v[242:245]
    v_mfma_f32_16x16x32_bf16 v[242:245], a[72:75], a[108:111], v[242:245]
    s_waitcnt vmcnt(8) lgkmcnt(0)
    v_mfma_f32_16x16x32_bf16 v[166:169], v[126:129], a[192:195], v[166:169]
    v_max3_u32 v1, v20, v21, v246
    v_max3_u32 v1, v1, v247, v248
    v_max3_u32 v1, v1, v249, v252
    v_max3_u32 v1, v1, v253, v254
    v_max_u32 v1, v1, v255
    v_cmp_eq_u32 vcc, -1, v1
    s_and_b64 vcc, vcc, exec
    s_cbranch_scc1 L_spin_upd
L_back_upd:
    v_mfma_f32_16x16x32_bf16 v[166:169], v[146:149], a[208:211], v[166:169]
    s_add_u32 s44, s31, 163840
    buffer_load_dwordx4 a[96:99], v4, s[8:11], s44 offen sc1
    v_mfma_f32_16x16x32_bf16 v[186:189], v[146:149], a[212:215], v[186:189]
    v_mfma_f32_16x16x32_bf16 v[186:189], v[126:129], a[196:199], v[186:189]
    v_mfma_f32_16x16x32_bf16 v[206:209], v[126:129], a[200:203], v[206:209]
    buffer_load_dwordx4 a[100:103], v5, s[8:11], s44 offen sc1
    v_mfma_f32_16x16x32_bf16 v[206:209], v[146:149], a[216:219], v[206:209]
    v_mfma_f32_16x16x32_bf16 v[226:229], v[146:149], a[220:223], v[226:229]
    v_mfma_f32_16x16x32_bf16 v[226:229], v[126:129], a[204:207], v[226:229]
    v_mfma_f32_16x16x32_bf16 v[170:173], v[130:133], a[192:195], v[170:173]
    buffer_load_dwordx4 a[104:107], v6, s[8:11], s44 offen sc1
    v_mfma_f32_16x16x32_bf16 v[170:173], v[150:153], a[208:211], v[170:173]
    v_mfma_f32_16x16x32_bf16 v[190:193], v[150:153], a[212:215], v[190:193]
    v_mfma_f32_16x16x32_bf16 v[190:193], v[130:133], a[196:199], v[190:193]
    v_mfma_f32_16x16x32_bf16 v[210:213], v[130:133], a[200:203], v[210:213]
    buffer_load_dwordx4 a[108:111], v7, s[8:11], s44 offen sc1
    v_mfma_f32_16x16x32_bf16 v[210:213], v[150:153], a[216:219], v[210:213]
    v_mfma_f32_16x16x32_bf16 v[230:233], v[150:153], a[220:223], v[230:233]
    v_mfma_f32_16x16x32_bf16 v[230:233], v[130:133], a[204:207], v[230:233]
    v_mfma_f32_16x16x32_bf16 v[174:177], v[134:137], a[192:195], v[174:177]
    s_add_u32 s44, s31, 180224
    buffer_load_dwordx4 a[112:115], v4, s[8:11], s44 offen sc1
    v_mfma_f32_16x16x32_bf16 v[174:177], v[154:157], a[208:211], v[174:177]
    v_mfma_f32_16x16x32_bf16 v[194:197], v[154:157], a[212:215], v[194:197]
    v_mfma_f32_16x16x32_bf16 v[194:197], v[134:137], a[196:199], v[194:197]
    buffer_load_dwordx4 a[116:119], v5, s[8:11], s44 offen sc1
    v_mfma_f32_16x16x32_bf16 v[214:217], v[134:137], a[200:203], v[214:217]
    v_mfma_f32_16x16x32_bf16 v[214:217], v[154:157], a[216:219], v[214:217]
    v_mfma_f32_16x16x32_bf16 v[234:237], v[154:157], a[220:223], v[234:237]
    v_mfma_f32_16x16x32_bf16 v[234:237], v[134:137], a[204:207], v[234:237]
    buffer_load_dwordx4 a[120:123], v6, s[8:11], s44 offen sc1
    v_mfma_f32_16x16x32_bf16 v[178:181], v[138:141], a[192:195], v[178:181]
    v_mfma_f32_16x16x32_bf16 v[178:181], v[158:161], a[208:211], v[178:181]
    v_mfma_f32_16x16x32_bf16 v[198:201], v[158:161], a[212:215], v[198:201]
    v_mfma_f32_16x16x32_bf16 v[198:201], v[138:141], a[196:199], v[198:201]
    buffer_load_dwordx4 a[124:127], v7, s[8:11], s44 offen sc1
    v_mfma_f32_16x16x32_bf16 v[218:221], v[138:141], a[200:203], v[218:221]
    v_mfma_f32_16x16x32_bf16 v[218:221], v[158:161], a[216:219], v[218:221]
    v_mfma_f32_16x16x32_bf16 v[238:241], v[158:161], a[220:223], v[238:241]
    v_mfma_f32_16x16x32_bf16 v[238:241], v[138:141], a[204:207], v[238:241]
    v_mfma_f32_16x16x32_bf16 v[182:185], v[142:145], a[192:195], v[182:185]
    v_mfma_f32_16x16x32_bf16 v[182:185], v[162:165], a[208:211], v[182:185]
    v_mfma_f32_16x16x32_bf16 v[202:205], v[162:165], a[212:215], v[202:205]
    v_mfma_f32_16x16x32_bf16 v[202:205], v[142:145], a[196:199], v[202:205]
    v_mfma_f32_16x16x32_bf16 v[222:225], v[142:145], a[200:203], v[222:225]
    v_mfma_f32_16x16x32_bf16 v[222:225], v[162:165], a[216:219], v[222:225]
    v_mfma_f32_16x16x32_bf16 v[242:245], v[162:165], a[220:223], v[242:245]
    s_sub_u32 s40, s5, 1
    s_and_b32 s40, s40, 3
    s_mul_i32 s40, s40, 10240
    s_add_u32 s40, s40, 122880
    v_lshl_add_u32 v5, v19, 4, s40
    s_sub_u32 s40, s5, 2
    s_and_b32 s40, s40, 3
    s_mul_i32 s40, s40, 10240
    s_add_u32 s40, s40, 122880
    v_lshl_add_u32 v6, v19, 4, s40
    s_sub_u32 s40, s5, 3
    s_and_b32 s40, s40, 3
    s_mul_i32 s40, s40, 10240
    s_add_u32 s40, s40, 81920
    v_lshl_add_u32 v7, v19, 4, s40
    buffer_load_dword v1, off, s[76:79], s37 sc1
    v_mfma_f32_16x16x32_bf16 v[242:245], v[142:145], a[204:207], v[242:245]
    s_waitcnt vmcnt(9)
    v_mfma_f32_16x16x32_bf16 v[166:169], v[46:49], a[224:227], v[166:169]
    v_mfma_f32_16x16x32_bf16 v[166:169], v[66:69], a[240:243], v[166:169]
    v_lshlrev_b32 v126, 16, v36
    v_and_b32 v127, 0xffff0000, v36
    v_lshlrev_b32 v146, 16, v20
    v_and_b32 v147, 0xffff0000, v20
    v_mfma_f32_16x16x32_bf16 v[186:189], v[66:69], a[244:247], v[186:189]
    v_lshlrev_b32 v128, 16, v37
    v_and_b32 v129, 0xffff0000, v37
    v_lshlrev_b32 v148, 16, v21
    v_and_b32 v149, 0xffff0000, v21
    v_lshlrev_b32 v130, 16, v38
    v_mfma_f32_16x16x32_bf16 v[186:189], v[46:49], a[228:231], v[186:189]
    v_and_b32 v131, 0xffff0000, v38
    v_lshlrev_b32 v150, 16, v246
    v_and_b32 v151, 0xffff0000, v246
    v_lshlrev_b32 v132, 16, v39
    v_mfma_f32_16x16x32_bf16 v[206:209], v[46:49], a[232:235], v[206:209]
    v_and_b32 v133, 0xffff0000, v39
    v_lshlrev_b32 v152, 16, v247
    v_and_b32 v153, 0xffff0000, v247
    v_lshlrev_b32 v134, 16, v40
    v_and_b32 v135, 0xffff0000, v40
    v_mfma_f32_16x16x32_bf16 v[206:209], v[66:69], a[248:251], v[206:209]
    v_lshlrev_b32 v154, 16, v248
    v_and_b32 v155, 0xffff0000, v248
    v_lshlrev_b32 v136, 16, v41
    v_and_b32 v137, 0xffff0000, v41
    v_lshlrev_b32 v156, 16, v249
    v_mfma_f32_16x16x32_bf16 v[226:229], v[66:69], a[252:255], v[226:229]
    v_and_b32 v157, 0xffff0000, v249
    v_lshlrev_b32 v138, 16, v42
    v_and_b32 v139, 0xffff0000, v42
    v_lshlrev_b32 v158, 16, v252
    v_mfma_f32_16x16x32_bf16 v[226:229], v[46:49], a[236:239], v[226:229]
    v_and_b32 v159, 0xffff0000, v252
    v_lshlrev_b32 v140, 16, v43
    v_and_b32 v141, 0xffff0000, v43
    v_lshlrev_b32 v160, 16, v253
    v_and_b32 v161, 0xffff0000, v253
    v_mfma_f32_16x16x32_bf16 v[170:173], v[50:53], a[224:227], v[170:173]
    v_lshlrev_b32 v142, 16, v44
    v_and_b32 v143, 0xffff0000, v44
    v_lshlrev_b32 v162, 16, v254
    v_and_b32 v163, 0xffff0000, v254
    v_mfma_f32_16x16x32_bf16 v[170:173], v[70:73], a[240:243], v[170:173]
    v_lshlrev_b32 v144, 16, v45
    v_and_b32 v145, 0xffff0000, v45
    v_lshlrev_b32 v164, 16, v255
    v_and_b32 v165, 0xffff0000, v255
    v_add_f32 v126, v126, v146
    v_mfma_f32_16x16x32_bf16 v[190:193], v[70:73], a[244:247], v[190:193]
    v_add_f32 v127, v127, v147
    v_add_f32 v128, v128, v148
    v_add_f32 v129, v129, v149
    v_add_f32 v130, v130, v150
    v_add_f32 v131, v131, v151
    v_mfma_f32_16x16x32_bf16 v[190:193], v[50:53], a[228:231], v[190:193]
    v_add_f32 v132, v132, v152
    v_add_f32 v133, v133, v153
    v_add_f32 v134, v134, v154
    v_add_f32 v135, v135, v155
    v_mfma_f32_16x16x32_bf16 v[210:213], v[50:53], a[232:235], v[210:213]
    v_add_f32 v136, v136, v156
    v_add_f32 v137, v137, v157
    v_add_f32 v138, v138, v158
    v_add_f32 v139, v139, v159
    v_add_f32 v140, v140, v160
    v_mfma_f32_16x16x32_bf16 v[210:213], v[70:73], a[248:251], v[210:213]
    v_add_f32 v141, v141, v161
    v_add_f32 v142, v142, v162
    v_add_f32 v143, v143, v163
    v_add_f32 v144, v144, v164
    v_add_f32 v145, v145, v165
    v_mfma_f32_16x16x32_bf16 v[230:233], v[70:73], a[252:255], v[230:233]
    v_cvt_pk_bf16_f32 v146, v126, v127
    v_cvt_pk_bf16_f32 v147, v128, v129
    v_cvt_pk_bf16_f32 v148, v130, v131
    v_cvt_pk_bf16_f32 v149, v132, v133
    v_mfma_f32_16x16x32_bf16 v[230:233], v[50:53], a[236:239], v[230:233]
    v_cvt_pk_bf16_f32 v150, v134, v135
    v_cvt_pk_bf16_f32 v151, v136, v137
    v_cvt_pk_bf16_f32 v152, v138, v139
    v_cvt_pk_bf16_f32 v153, v140, v141
    v_cvt_pk_bf16_f32 v154, v142, v143
    v_mfma_f32_16x16x32_bf16 v[174:177], v[54:57], a[224:227], v[174:177]
    v_cvt_pk_bf16_f32 v155, v144, v145
    v_lshlrev_b32 v126, 16, v146
    v_and_b32 v127, 0xffff0000, v146
    v_lshlrev_b32 v128, 16, v147
    v_mfma_f32_16x16x32_bf16 v[174:177], v[74:77], a[240:243], v[174:177]
    v_and_b32 v129, 0xffff0000, v147
    v_lshlrev_b32 v130, 16, v148
    v_and_b32 v131, 0xffff0000, v148
    v_lshlrev_b32 v132, 16, v149
    v_and_b32 v133, 0xffff0000, v149
    v_mfma_f32_16x16x32_bf16 v[194:197], v[74:77], a[244:247], v[194:197]
    v_lshlrev_b32 v134, 16, v150
    v_and_b32 v135, 0xffff0000, v150
    v_lshlrev_b32 v136, 16, v151
    v_and_b32 v137, 0xffff0000, v151
    v_lshlrev_b32 v138, 16, v152
    v_mfma_f32_16x16x32_bf16 v[194:197], v[54:57], a[228:231], v[194:197]
    v_and_b32 v139, 0xffff0000, v152
    v_lshlrev_b32 v140, 16, v153
    v_and_b32 v141, 0xffff0000, v153
    v_lshlrev_b32 v142, 16, v154
    v_mfma_f32_16x16x32_bf16 v[214:217], v[54:57], a[232:235], v[214:217]
    v_and_b32 v143, 0xffff0000, v154
    v_lshlrev_b32 v144, 16, v155
    v_and_b32 v145, 0xffff0000, v155
    v_mul_f32 v146, 0xbfb8aa3b, v126
    v_mul_f32 v147, 0xbfb8aa3b, v127
    v_mfma_f32_16x16x32_bf16 v[214:217], v[74:77], a[248:251], v[214:217]
    v_mul_f32 v148, 0xbfb8aa3b, v128
    v_mul_f32 v149, 0xbfb8aa3b, v129
    v_mul_f32 v150, 0xbfb8aa3b, v130
    v_mul_f32 v151, 0xbfb8aa3b, v131
    v_mfma_f32_16x16x32_bf16 v[234:237], v[74:77], a[252:255], v[234:237]
    v_mul_f32 v152, 0xbfb8aa3b, v132
    v_mul_f32 v153, 0xbfb8aa3b, v133
    v_mul_f32 v154, 0xbfb8aa3b, v134
    v_mul_f32 v155, 0xbfb8aa3b, v135
    v_mul_f32 v156, 0xbfb8aa3b, v136
    v_mfma_f32_16x16x32_bf16 v[234:237], v[54:57], a[236:239], v[234:237]
    v_mul_f32 v157, 0xbfb8aa3b, v137
    v_mul_f32 v158, 0xbfb8aa3b, v138
    v_mul_f32 v159, 0xbfb8aa3b, v139
    v_mul_f32 v160, 0xbfb8aa3b, v140
    v_mul_f32 v161, 0xbfb8aa3b, v141
    v_mfma_f32_16x16x32_bf16 v[178:181], v[58:61], a[224:227], v[178:181]
    v_mul_f32 v162, 0xbfb8aa3b, v142
    v_mul_f32 v163, 0xbfb8aa3b, v143
    v_mul_f32 v164, 0xbfb8aa3b, v144
    v_mul_f32 v165, 0xbfb8aa3b, v145
    v_mfma_f32_16x16x32_bf16 v[178:181], v[78:81], a[240:243], v[178:181]
    v_exp_f32 v146, v146
    v_exp_f32 v147, v147
    v_exp_f32 v148, v148
    v_exp_f32 v149, v149
    v_exp_f32 v150, v150
    v_mfma_f32_16x16x32_bf16 v[198:201], v[78:81], a[244:247], v[198:201]
    v_exp_f32 v151, v151
    v_exp_f32 v152, v152
    v_exp_f32 v153, v153
    v_exp_f32 v154, v154
    v_exp_f32 v155, v155
    v_mfma_f32_16x16x32_bf16 v[198:201], v[58:61], a[228:231], v[198:201]
    v_exp_f32 v156, v156
    v_exp_f32 v157, v157
    v_exp_f32 v158, v158
    v_exp_f32 v159, v159
    v_mfma_f32_16x16x32_bf16 v[218:221], v[58:61], a[232:235], v[218:221]
    v_exp_f32 v160, v160
    v_exp_f32 v161, v161
    v_exp_f32 v162, v162
    v_exp_f32 v163, v163
    v_exp_f32 v164, v164
    v_mfma_f32_16x16x32_bf16 v[218:221], v[78:81], a[248:251], v[218:221]
    v_exp_f32 v165, v165
    v_add_f32 v146, 1.0, v146
    v_add_f32 v147, 1.0, v147
    v_add_f32 v148, 1.0, v148
    v_mfma_f32_16x16x32_bf16 v[238:241], v[78:81], a[252:255], v[238:241]
    v_add_f32 v149, 1.0, v149
    v_add_f32 v150, 1.0, v150
    v_add_f32 v151, 1.0, v151
    v_add_f32 v152, 1.0, v152
    v_add_f32 v153, 1.0, v153
    v_mfma_f32_16x16x32_bf16 v[238:241], v[58:61], a[236:239], v[238:241]
    v_add_f32 v154, 1.0, v154
    v_add_f32 v155, 1.0, v155
    v_add_f32 v156, 1.0, v156
    v_add_f32 v157, 1.0, v157
    v_add_f32 v158, 1.0, v158
    v_mfma_f32_16x16x32_bf16 v[182:185], v[62:65], a[224:227], v[182:185]
    v_add_f32 v159, 1.0, v159
    v_add_f32 v160, 1.0, v160
    v_add_f32 v161, 1.0, v161
    v_add_f32 v162, 1.0, v162
    v_mfma_f32_16x16x32_bf16 v[182:185], v[82:85], a[240:243], v[182:185]
    v_add_f32 v163, 1.0, v163
    v_add_f32 v164, 1.0, v164
    v_add_f32 v165, 1.0, v165
    v_rcp_f32 v146, v146
    v_rcp_f32 v147, v147
    v_mfma_f32_16x16x32_bf16 v[202:205], v[82:85], a[244:247], v[202:205]
    v_rcp_f32 v148, v148
    v_rcp_f32 v149, v149
    v_rcp_f32 v150, v150
    v_rcp_f32 v151, v151
    v_mfma_f32_16x16x32_bf16 v[202:205], v[62:65], a[228:231], v[202:205]
    v_rcp_f32 v152, v152
    v_rcp_f32 v153, v153
    v_rcp_f32 v154, v154
    v_rcp_f32 v155, v155
    v_rcp_f32 v156, v156
    v_mfma_f32_16x16x32_bf16 v[222:225], v[62:65], a[232:235], v[222:225]
    v_rcp_f32 v157, v157
    v_rcp_f32 v158, v158
    v_rcp_f32 v159, v159
    v_rcp_f32 v160, v160
    v_rcp_f32 v161, v161
    v_mfma_f32_16x16x32_bf16 v[222:225], v[82:85], a[248:251], v[222:225]
    v_rcp_f32 v162, v162
    v_rcp_f32 v163, v163
    v_rcp_f32 v164, v164
    v_rcp_f32 v165, v165
    v_mfma_f32_16x16x32_bf16 v[242:245], v[82:85], a[252:255], v[242:245]
    v_mul_f32 v126, v126, v146
    v_mul_f32 v127, v127, v147
    v_mul_f32 v128, v128, v148
    v_mul_f32 v129, v129, v149
    v_mul_f32 v130, v130, v150
    v_mfma_f32_16x16x32_bf16 v[242:245], v[62:65], a[236:239], v[242:245]
    v_mul_f32 v131, v131, v151
    v_mul_f32 v132, v132, v152
    v_mul_f32 v133, v133, v153
    v_mul_f32 v134, v134, v154
    v_mul_f32 v135, v135, v155
    s_waitcnt vmcnt(1)
    v_mfma_f32_16x16x32_bf16 v[186:189], v[86:89], a[100:103], v[186:189]
    s_waitcnt vmcnt(0)
    v_cmp_ne_u32 vcc, 3, v1
    s_and_b64 vcc, vcc, exec
    s_cbranch_scc1 L_spin_half
L_back_half:
    s_xor_b32 s40, s2, 8
    s_sub_u32 s40, s40, s2
    s_mul_i32 s40, s40, 20480
    v_add_u32 v18, s40, v18
    s_mov_b32 s41, 4096
    buffer_load_dwordx4 v[46:49], v18, s[76:79], 0 offen offset:0 sc1
    buffer_load_dwordx4 v[50:53], v18, s[76:79], 0 offen offset:1024 sc1
    buffer_load_dwordx4 v[54:57], v18, s[76:79], 0 offen offset:2048 sc1
    buffer_load_dwordx4 v[58:61], v18, s[76:79], 0 offen offset:3072 sc1
    buffer_load_dwordx4 v[62:65], v18, s[76:79], s41 offen offset:0 sc1
    v_mfma_f32_16x16x32_bf16 v[186:189], v[106:109], a[116:119], v[186:189]
    v_mul_f32 v136, v136, v156
    v_mfma_f32_16x16x32_bf16 v[190:193], v[110:113], a[116:119], v[190:193]
    v_mul_f32 v137, v137, v157
    v_mul_f32 v138, v138, v158
    v_mfma_f32_16x16x32_bf16 v[190:193], v[90:93], a[100:103], v[190:193]
    v_mul_f32 v139, v139, v159
    v_mfma_f32_16x16x32_bf16 v[194:197], v[94:97], a[100:103], v[194:197]
    v_mul_f32 v140, v140, v160
    v_mul_f32 v141, v141, v161
    v_mfma_f32_16x16x32_bf16 v[194:197], v[114:117], a[116:119], v[194:197]
    v_mul_f32 v142, v142, v162
    v_mfma_f32_16x16x32_bf16 v[198:201], v[118:121], a[116:119], v[198:201]
    v_mul_f32 v143, v143, v163
    v_mul_f32 v144, v144, v164
    v_mfma_f32_16x16x32_bf16 v[198:201], v[98:101], a[100:103], v[198:201]
    v_mul_f32 v145, v145, v165
    v_mfma_f32_16x16x32_bf16 v[202:205], v[102:105], a[100:103], v[202:205]
    v_cvt_pk_bf16_f32 v146, v126, v127
    v_cvt_pk_bf16_f32 v147, v128, v129
    v_mfma_f32_16x16x32_bf16 v[202:205], v[122:125], a[116:119], v[202:205]
    ds_write_b128 v8, v[186:189] offset:0
    v_cvt_pk_bf16_f32 v148, v130, v131
    v_mfma_f32_16x16x32_bf16 v[206:209], v[106:109], a[120:123], v[206:209]
    v_cvt_pk_bf16_f32 v149, v132, v133
    v_cvt_pk_bf16_f32 v150, v134, v135
    v_mfma_f32_16x16x32_bf16 v[206:209], v[86:89], a[104:107], v[206:209]
    ds_write_b128 v8, v[190:193] offset:1024
    v_cvt_pk_bf16_f32 v151, v136, v137
    v_mfma_f32_16x16x32_bf16 v[210:213], v[90:93], a[104:107], v[210:213]
    v_cvt_pk_bf16_f32 v152, v138, v139
    v_cvt_pk_bf16_f32 v153, v140, v141
    v_mfma_f32_16x16x32_bf16 v[210:213], v[110:113], a[120:123], v[210:213]
    ds_write_b128 v8, v[194:197] offset:2048
    v_cvt_pk_bf16_f32 v154, v142, v143
    v_cvt_pk_bf16_f32 v155, v144, v145
    v_mfma_f32_16x16x32_bf16 v[214:217], v[114:117], a[120:123], v[214:217]
    v_lshlrev_b32 v126, 16, v146
    v_mfma_f32_16x16x32_bf16 v[214:217], v[94:97], a[104:107], v[214:217]
    ds_write_b128 v8, v[198:201] offset:3072
    v_and_b32 v127, 0xffff0000, v146
    v_lshlrev_b32 v128, 16, v147
    v_mfma_f32_16x16x32_bf16 v[218:221], v[98:101], a[104:107], v[218:221]
    v_and_b32 v129, 0xffff0000, v147
    v_mfma_f32_16x16x32_bf16 v[218:221], v[118:121], a[120:123], v[218:221]
    ds_write_b128 v8, v[202:205] offset:4096
    v_lshlrev_b32 v130, 16, v148
    v_and_b32 v131, 0xffff0000, v148
    v_mfma_f32_16x16x32_bf16 v[222:225], v[122:125], a[120:123], v[222:225]
    v_lshlrev_b32 v132, 16, v149
    v_mfma_f32_16x16x32_bf16 v[222:225], v[102:105], a[104:107], v[222:225]
    ds_write_b128 v8, v[206:209] offset:5120
    v_and_b32 v133, 0xffff0000, v149
    v_lshlrev_b32 v134, 16, v150
    v_mfma_f32_16x16x32_bf16 v[226:229], v[86:89], a[108:111], v[226:229]
    v_and_b32 v135, 0xffff0000, v150
    v_mfma_f32_16x16x32_bf16 v[226:229], v[106:109], a[124:127], v[226:229]
    ds_write_b128 v8, v[210:213] offset:6144
    v_lshlrev_b32 v136, 16, v151
    v_and_b32 v137, 0xffff0000, v151
    v_mfma_f32_16x16x32_bf16 v[230:233], v[110:113], a[124:127], v[230:233]
    v_lshlrev_b32 v138, 16, v152
    v_mfma_f32_16x16x32_bf16 v[230:233], v[90:93], a[108:111], v[230:233]
    ds_write_b128 v8, v[214:217] offset:7168
    v_and_b32 v139, 0xffff0000, v152
    v_lshlrev_b32 v140, 16, v153
    v_mfma_f32_16x16x32_bf16 v[234:237], v[94:97], a[108:111], v[234:237]
    v_and_b32 v141, 0xffff0000, v153
    v_mfma_f32_16x16x32_bf16 v[234:237], v[114:117], a[124:127], v[234:237]
    ds_write_b128 v8, v[218:221] offset:8192
    v_lshlrev_b32 v142, 16, v154
    v_and_b32 v143, 0xffff0000, v154
    v_mfma_f32_16x16x32_bf16 v[238:241], v[118:121], a[124:127], v[238:241]
    v_lshlrev_b32 v144, 16, v155
    v_and_b32 v145, 0xffff0000, v155
    v_mfma_f32_16x16x32_bf16 v[238:241], v[98:101], a[108:111], v[238:241]
    ds_write_b128 v8, v[222:225] offset:9216
    v_lshlrev_b32 v146, 16, v22
    v_mfma_f32_16x16x32_bf16 v[242:245], v[102:105], a[108:111], v[242:245]
    v_and_b32 v147, 0xffff0000, v22
    v_lshlrev_b32 v148, 16, v23
    v_mfma_f32_16x16x32_bf16 v[242:245], v[122:125], a[124:127], v[242:245]
    ds_write_b128 v9, v[226:229] offset:0
    v_and_b32 v149, 0xffff0000, v23
    v_mfma_f32_16x16x32_bf16 v[166:169], v[106:109], a[112:115], v[166:169]
    v_lshlrev_b32 v150, 16, v24
    v_and_b32 v151, 0xffff0000, v24
    v_mfma_f32_16x16x32_bf16 v[166:169], v[86:89], a[96:99], v[166:169]
    ds_write_b128 v9, v[230:233] offset:1024
    v_lshlrev_b32 v152, 16, v25
    v_mfma_f32_16x16x32_bf16 v[170:173], v[90:93], a[96:99], v[170:173]
    v_and_b32 v153, 0xffff0000, v25
    v_lshlrev_b32 v154, 16, v26
    v_mfma_f32_16x16x32_bf16 v[170:173], v[110:113], a[112:115], v[170:173]
    ds_write_b128 v9, v[234:237] offset:2048
    v_and_b32 v155, 0xffff0000, v26
    v_mfma_f32_16x16x32_bf16 v[174:177], v[114:117], a[112:115], v[174:177]
    v_lshlrev_b32 v156, 16, v27
    v_and_b32 v157, 0xffff0000, v27
    v_mfma_f32_16x16x32_bf16 v[174:177], v[94:97], a[96:99], v[174:177]
    ds_write_b128 v9, v[238:241] offset:3072
    v_lshlrev_b32 v158, 16, v28
    v_mfma_f32_16x16x32_bf16 v[178:181], v[98:101], a[96:99], v[178:181]
    v_and_b32 v159, 0xffff0000, v28
    v_lshlrev_b32 v160, 16, v29
    v_mfma_f32_16x16x32_bf16 v[178:181], v[118:121], a[112:115], v[178:181]
    ds_write_b128 v9, v[242:245] offset:4096
    v_and_b32 v161, 0xffff0000, v29
    v_mfma_f32_16x16x32_bf16 v[182:185], v[122:125], a[112:115], v[182:185]
    v_lshlrev_b32 v162, 16, v30
    v_and_b32 v163, 0xffff0000, v30
    v_mfma_f32_16x16x32_bf16 v[182:185], v[102:105], a[96:99], v[182:185]
    v_lshlrev_b32 v164, 16, v31
    v_and_b32 v165, 0xffff0000, v31
    s_waitcnt lgkmcnt(0)
    s_barrier
    ds_read_b128 v[186:189], v5 offset:0
    ds_read_b128 v[190:193], v5 offset:1024
    ds_read_b128 v[194:197], v5 offset:2048
    ds_read_b128 v[198:201], v5 offset:3072
    ds_read_b128 v[202:205], v5 offset:4096
    ds_read_b128 v[206:209], v6 offset:5120
    ds_read_b128 v[210:213], v6 offset:6144
    ds_read_b128 v[214:217], v6 offset:7168
    ds_read_b128 v[218:221], v6 offset:8192
    ds_read_b128 v[222:225], v6 offset:9216
    ds_read_b128 v[226:229], v7 offset:0
    ds_read_b128 v[230:233], v7 offset:1024
    ds_read_b128 v[234:237], v7 offset:2048
    ds_read_b128 v[238:241], v7 offset:3072
    ds_read_b128 v[242:245], v7 offset:4096
    s_waitcnt lgkmcnt(10)
    v_pk_add_f32 v[166:167], v[166:167], v[186:187]
    v_pk_add_f32 v[168:169], v[168:169], v[188:189]
    v_pk_add_f32 v[170:171], v[170:171], v[190:191]
    v_pk_add_f32 v[172:173], v[172:173], v[192:193]
    v_pk_add_f32 v[174:175], v[174:175], v[194:195]
    v_pk_add_f32 v[176:177], v[176:177], v[196:197]
    v_pk_add_f32 v[178:179], v[178:179], v[198:199]
    v_pk_add_f32 v[180:181], v[180:181], v[200:201]
    v_pk_add_f32 v[182:183], v[182:183], v[202:203]
    v_pk_add_f32 v[184:185], v[184:185], v[204:205]
    s_waitcnt lgkmcnt(5)
    v_pk_add_f32 v[166:167], v[166:167], v[206:207]
    v_pk_add_f32 v[168:169], v[168:169], v[208:209]
    v_pk_add_f32 v[170:171], v[170:171], v[210:211]
    v_pk_add_f32 v[172:173], v[172:173], v[212:213]
    v_pk_add_f32 v[174:175], v[174:175], v[214:215]
    v_pk_add_f32 v[176:177], v[176:177], v[216:217]
    v_pk_add_f32 v[178:179], v[178:179], v[218:219]
    v_pk_add_f32 v[180:181], v[180:181], v[220:221]
    v_pk_add_f32 v[182:183], v[182:183], v[222:223]
    v_pk_add_f32 v[184:185], v[184:185], v[224:225]
    s_waitcnt lgkmcnt(0)
    v_pk_add_f32 v[166:167], v[166:167], v[226:227]
    v_pk_add_f32 v[168:169], v[168:169], v[228:229]
    v_pk_add_f32 v[170:171], v[170:171], v[230:231]
    v_pk_add_f32 v[172:173], v[172:173], v[232:233]
    v_pk_add_f32 v[174:175], v[174:175], v[234:235]
    v_pk_add_f32 v[176:177], v[176:177], v[236:237]
    v_pk_add_f32 v[178:179], v[178:179], v[238:239]
    v_pk_add_f32 v[180:181], v[180:181], v[240:241]
    v_pk_add_f32 v[182:183], v[182:183], v[242:243]
    v_pk_add_f32 v[184:185], v[184:185], v[244:245]
    s_waitcnt vmcnt(0)
    v_pk_add_f32 v[166:167], v[166:167], v[46:47]
    v_pk_add_f32 v[168:169], v[168:169], v[48:49]
    v_pk_add_f32 v[170:171], v[170:171], v[50:51]
    v_pk_add_f32 v[172:173], v[172:173], v[52:53]
    v_pk_add_f32 v[174:175], v[174:175], v[54:55]
    v_pk_add_f32 v[176:177], v[176:177], v[56:57]
    v_pk_add_f32 v[178:179], v[178:179], v[58:59]
    v_pk_add_f32 v[180:181], v[180:181], v[60:61]
    v_pk_add_f32 v[182:183], v[182:183], v[62:63]
    v_pk_add_f32 v[184:185], v[184:185], v[64:65]
    v_cvt_pk_bf16_f32 v66, v166, v167
    v_cvt_pk_bf16_f32 v67, v168, v169
    v_cvt_pk_bf16_f32 v68, v170, v171
    v_cvt_pk_bf16_f32 v69, v172, v173
    v_cvt_pk_bf16_f32 v70, v174, v175
    v_cvt_pk_bf16_f32 v71, v176, v177
    v_cvt_pk_bf16_f32 v72, v178, v179
    v_cvt_pk_bf16_f32 v73, v180, v181
    v_cvt_pk_bf16_f32 v74, v182, v183
    v_cvt_pk_bf16_f32 v75, v184, v185
    v_lshlrev_b32 v166, 16, v66
    v_and_b32 v167, 0xffff0000, v66
    v_lshlrev_b32 v168, 16, v67
    v_and_b32 v169, 0xffff0000, v67
    v_lshlrev_b32 v170, 16, v68
    v_and_b32 v171, 0xffff0000, v68
    v_lshlrev_b32 v172, 16, v69
    v_and_b32 v173, 0xffff0000, v69
    v_lshlrev_b32 v174, 16, v70
    v_and_b32 v175, 0xffff0000, v70
    v_lshlrev_b32 v176, 16, v71
    v_and_b32 v177, 0xffff0000, v71
    v_lshlrev_b32 v178, 16, v72
    v_and_b32 v179, 0xffff0000, v72
    v_lshlrev_b32 v180, 16, v73
    v_and_b32 v181, 0xffff0000, v73
    v_lshlrev_b32 v182, 16, v74
    v_and_b32 v183, 0xffff0000, v74
    v_lshlrev_b32 v184, 16, v75
    v_and_b32 v185, 0xffff0000, v75
    v_pk_mul_f32 v[166:167], v[166:167], v[126:127]
    v_pk_mul_f32 v[168:169], v[168:169], v[128:129]
    v_pk_mul_f32 v[170:171], v[170:171], v[130:131]
    v_pk_mul_f32 v[172:173], v[172:173], v[132:133]
    v_pk_mul_f32 v[174:175], v[174:175], v[134:135]
    v_pk_mul_f32 v[176:177], v[176:177], v[136:137]
    v_pk_mul_f32 v[178:179], v[178:179], v[138:139]
    v_pk_mul_f32 v[180:181], v[180:181], v[140:141]
    v_pk_mul_f32 v[182:183], v[182:183], v[142:143]
    v_pk_mul_f32 v[184:185], v[184:185], v[144:145]
    v_cvt_pk_bf16_f32 v66, v166, v167
    v_cvt_pk_bf16_f32 v67, v168, v169
    v_cvt_pk_bf16_f32 v68, v170, v171
    v_cvt_pk_bf16_f32 v69, v172, v173
    v_cvt_pk_bf16_f32 v70, v174, v175
    v_cvt_pk_bf16_f32 v71, v176, v177
    v_cvt_pk_bf16_f32 v72, v178, v179
    v_cvt_pk_bf16_f32 v73, v180, v181
    v_cvt_pk_bf16_f32 v74, v182, v183
    v_cvt_pk_bf16_f32 v75, v184, v185
    v_lshlrev_b32 v166, 16, v66
    v_and_b32 v167, 0xffff0000, v66
    v_lshlrev_b32 v168, 16, v67
    v_and_b32 v169, 0xffff0000, v67
    v_lshlrev_b32 v170, 16, v68
    v_and_b32 v171, 0xffff0000, v68
    v_lshlrev_b32 v172, 16, v69
    v_and_b32 v173, 0xffff0000, v69
    v_lshlrev_b32 v174, 16, v70
    v_and_b32 v175, 0xffff0000, v70
    v_lshlrev_b32 v176, 16, v71
    v_and_b32 v177, 0xffff0000, v71
    v_lshlrev_b32 v178, 16, v72
    v_and_b32 v179, 0xffff0000, v72
    v_lshlrev_b32 v180, 16, v73
    v_and_b32 v181, 0xffff0000, v73
    v_lshlrev_b32 v182, 16, v74
    v_and_b32 v183, 0xffff0000, v74
    v_lshlrev_b32 v184, 16, v75
    v_and_b32 v185, 0xffff0000, v75
    v_pk_add_f32 v[166:167], v[166:167], v[146:147]
    v_pk_add_f32 v[168:169], v[168:169], v[148:149]
    v_pk_add_f32 v[170:171], v[170:171], v[150:151]
    v_pk_add_f32 v[172:173], v[172:173], v[152:153]
    v_pk_add_f32 v[174:175], v[174:175], v[154:155]
    v_pk_add_f32 v[176:177], v[176:177], v[156:157]
    v_pk_add_f32 v[178:179], v[178:179], v[158:159]
    v_pk_add_f32 v[180:181], v[180:181], v[160:161]
    v_pk_add_f32 v[182:183], v[182:183], v[162:163]
    v_pk_add_f32 v[184:185], v[184:185], v[164:165]
    v_cvt_pk_bf16_f32 v66, v166, v167
    v_cvt_pk_bf16_f32 v67, v168, v169
    buffer_store_dwordx2 v[66:67], v34, s[12:15], 0 offen offset:0
    v_cvt_pk_bf16_f32 v68, v170, v171
    v_cvt_pk_bf16_f32 v69, v172, v173
    buffer_store_dwordx2 v[68:69], v34, s[12:15], 0 offen offset:32
    v_cvt_pk_bf16_f32 v70, v174, v175
    v_cvt_pk_bf16_f32 v71, v176, v177
    buffer_store_dwordx2 v[70:71], v34, s[12:15], 0 offen offset:64
    v_cvt_pk_bf16_f32 v72, v178, v179
    v_cvt_pk_bf16_f32 v73, v180, v181
    buffer_store_dwordx2 v[72:73], v34, s[12:15], 0 offen offset:96
    v_cvt_pk_bf16_f32 v74, v182, v183
    v_cvt_pk_bf16_f32 v75, v184, v185
    buffer_store_dwordx2 v[74:75], v34, s[12:15], 0 offen offset:128
L_end:
    s_endpgm
L_slow:
    s_lshl_b32 s40, s5, 12
    v_subrev_u32 v13, s40, v13
    v_subrev_u32 v14, s40, v14
    v_subrev_u32 v15, s40, v15
    v_subrev_u32 v16, s40, v16
    v_subrev_u32 v17, s40, v17
    v_subrev_u32 v18, s40, v18
    s_and_b32 s40, s5, 1
    s_lshr_b32 s41, s5, 1
    s_mul_i32 s41, s41, 3
    s_add_u32 s40, s40, s41
    s_add_u32 s40, s40, 1
    s_lshl_b32 s34, s40, 13
    s_sub_u32 s40, s34, 98304
    v_add_u32 v1, s40, v1
    v_add_u32 v2, s40, v2
    v_add_u32 v3, s40, v3
    v_add_u32 v4, s40, v4
    v_add_u32 v5, s34, v5
    v_add_u32 v6, s34, v6
    v_add_u32 v7, s34, v7
    v_add_u32 v8, s34, v8
    v_add_u32 v9, s34, v9
    v_add_u32 v10, s34, v10
    v_add_u32 v11, s34, v11
    v_add_u32 v12, s34, v12
    v_mov_b32 v212, 0xff800000
    v_mov_b32 v216, 0
    v_mov_b32 v213, 0xff800000
    v_mov_b32 v217, 0
    v_mov_b32 v214, 0xff800000
    v_mov_b32 v218, 0
    v_mov_b32 v215, 0xff800000
    v_mov_b32 v219, 0
    v_accvgpr_write_b32 a0, 0
    v_accvgpr_write_b32 a1, 0
    v_accvgpr_write_b32 a2, 0
    v_accvgpr_write_b32 a3, 0
    v_accvgpr_write_b32 a4, 0
    v_accvgpr_write_b32 a5, 0
    v_accvgpr_write_b32 a6, 0
    v_accvgpr_write_b32 a7, 0
    v_accvgpr_write_b32 a8, 0
    v_accvgpr_write_b32 a9, 0
    v_accvgpr_write_b32 a10, 0
    v_accvgpr_write_b32 a11, 0
    v_accvgpr_write_b32 a12, 0
    v_accvgpr_write_b32 a13, 0
    v_accvgpr_write_b32 a14, 0
    v_accvgpr_write_b32 a15, 0
    v_accvgpr_write_b32 a16, 0
    v_accvgpr_write_b32 a17, 0
    v_accvgpr_write_b32 a18, 0
    v_accvgpr_write_b32 a19, 0
    v_accvgpr_write_b32 a20, 0
    v_accvgpr_write_b32 a21, 0
    v_accvgpr_write_b32 a22, 0
    v_accvgpr_write_b32 a23, 0
    v_accvgpr_write_b32 a24, 0
    v_accvgpr_write_b32 a25, 0
    v_accvgpr_write_b32 a26, 0
    v_accvgpr_write_b32 a27, 0
    v_accvgpr_write_b32 a28, 0
    v_accvgpr_write_b32 a29, 0
    v_accvgpr_write_b32 a30, 0
    v_accvgpr_write_b32 a31, 0
    v_accvgpr_write_b32 a32, 0
    v_accvgpr_write_b32 a33, 0
    v_accvgpr_write_b32 a34, 0
    v_accvgpr_write_b32 a35, 0
    v_accvgpr_write_b32 a36, 0
    v_accvgpr_write_b32 a37, 0
    v_accvgpr_write_b32 a38, 0
    v_accvgpr_write_b32 a39, 0
    v_accvgpr_write_b32 a40, 0
    v_accvgpr_write_b32 a41, 0
    v_accvgpr_write_b32 a42, 0
    v_accvgpr_write_b32 a43, 0
    v_accvgpr_write_b32 a44, 0
    v_accvgpr_write_b32 a45, 0
    v_accvgpr_write_b32 a46, 0
    v_accvgpr_write_b32 a47, 0
    v_accvgpr_write_b32 a48, 0
    v_accvgpr_write_b32 a49, 0
    v_accvgpr_write_b32 a50, 0
    v_accvgpr_write_b32 a51, 0
    v_accvgpr_write_b32 a52, 0
    v_accvgpr_write_b32 a53, 0
    v_accvgpr_write_b32 a54, 0
    v_accvgpr_write_b32 a55, 0
    v_accvgpr_write_b32 a56, 0
    v_accvgpr_write_b32 a57, 0
    v_accvgpr_write_b32 a58, 0
    v_accvgpr_write_b32 a59, 0
    v_accvgpr_write_b32 a60, 0
    v_accvgpr_write_b32 a61, 0
    v_accvgpr_write_b32 a62, 0
    v_accvgpr_write_b32 a63, 0
    v_accvgpr_write_b32 a64, 0
    v_accvgpr_write_b32 a65, 0
    v_accvgpr_write_b32 a66, 0
    v_accvgpr_write_b32 a67, 0
    v_accvgpr_write_b32 a68, 0
    v_accvgpr_write_b32 a69, 0
    v_accvgpr_write_b32 a70, 0
    v_accvgpr_write_b32 a71, 0
    v_accvgpr_write_b32 a72, 0
    v_accvgpr_write_b32 a73, 0
    v_accvgpr_write_b32 a74, 0
    v_accvgpr_write_b32 a75, 0
    v_accvgpr_write_b32 a76, 0
    v_accvgpr_write_b32 a77, 0
    v_accvgpr_write_b32 a78, 0
    v_accvgpr_write_b32 a79, 0
    v_accvgpr_write_b32 a80, 0
    v_accvgpr_write_b32 a81, 0
    v_accvgpr_write_b32 a82, 0
    v_accvgpr_write_b32 a83, 0
    v_accvgpr_write_b32 a84, 0
    v_accvgpr_write_b32 a85, 0
    v_accvgpr_write_b32 a86, 0
    v_accvgpr_write_b32 a87, 0
    v_accvgpr_write_b32 a88, 0
    v_accvgpr_write_b32 a89, 0
    v_accvgpr_write_b32 a90, 0
    v_accvgpr_write_b32 a91, 0
    v_accvgpr_write_b32 a92, 0
    v_accvgpr_write_b32 a93, 0
    v_accvgpr_write_b32 a94, 0
    v_accvgpr_write_b32 a95, 0
    v_accvgpr_write_b32 a96, 0
    v_accvgpr_write_b32 a97, 0
    v_accvgpr_write_b32 a98, 0
    v_accvgpr_write_b32 a99, 0
    v_accvgpr_write_b32 a100, 0
    v_accvgpr_write_b32 a101, 0
    v_accvgpr_write_b32 a102, 0
    v_accvgpr_write_b32 a103, 0
    v_accvgpr_write_b32 a104, 0
    v_accvgpr_write_b32 a105, 0
    v_accvgpr_write_b32 a106, 0
    v_accvgpr_write_b32 a107, 0
    v_accvgpr_write_b32 a108, 0
    v_accvgpr_write_b32 a109, 0
    v_accvgpr_write_b32 a110, 0
    v_accvgpr_write_b32 a111, 0
    v_accvgpr_write_b32 a112, 0
    v_accvgpr_write_b32 a113, 0
    v_accvgpr_write_b32 a114, 0
    v_accvgpr_write_b32 a115, 0
    v_accvgpr_write_b32 a116, 0
    v_accvgpr_write_b32 a117, 0
    v_accvgpr_write_b32 a118, 0
    v_accvgpr_write_b32 a119, 0
    v_accvgpr_write_b32 a120, 0
    v_accvgpr_write_b32 a121, 0
    v_accvgpr_write_b32 a122, 0
    v_accvgpr_write_b32 a123, 0
    v_accvgpr_write_b32 a124, 0
    v_accvgpr_write_b32 a125, 0
    v_accvgpr_write_b32 a126, 0
    v_accvgpr_write_b32 a127, 0
    s_mov_b32 s28, 0
L_slow_loop:
    s_add_u32 m0, s34, 0
    s_add_u32 s40, s28, 0
    buffer_load_dwordx4 v13, s[8:11], s40 offen offset:0 lds
    buffer_load_dwordx4 v14, s[8:11], s40 offen offset:1024 lds
    buffer_load_dwordx4 v15, s[8:11], s40 offen offset:2048 lds
    buffer_load_dwordx4 v16, s[8:11], s40 offen offset:3072 lds
    s_add_u32 m0, s34, 4096
    s_add_u32 s40, s28, 4096
    buffer_load_dwordx4 v13, s[8:11], s40 offen offset:0 lds
    buffer_load_dwordx4 v14, s[8:11], s40 offen offset:1024 lds
    buffer_load_dwordx4 v15, s[8:11], s40 offen offset:2048 lds
    buffer_load_dwordx4 v16, s[8:11], s40 offen offset:3072 lds
    s_waitcnt vmcnt(0)
    ds_read_b128 v[148:151], v1 offset:0
    ds_read_b128 v[152:155], v2 offset:0
    ds_read_b128 v[156:159], v3 offset:0
    ds_read_b128 v[160:163], v4 offset:0
    ds_read_b128 v[164:167], v1 offset:4096
    ds_read_b128 v[168:171], v2 offset:4096
    ds_read_b128 v[172:175], v3 offset:4096
    ds_read_b128 v[176:179], v4 offset:4096
    s_waitcnt lgkmcnt(0)
    s_add_u32 m0, s34, 0
    s_add_u32 s40, s28, 0
    buffer_load_dwordx4 v17, s[12:15], s40 offen offset:0 lds
    buffer_load_dwordx4 v18, s[12:15], s40 offen offset:1024 lds
    buffer_load_dwordx4 v17, s[12:15], s40 offen offset:2048 lds
    buffer_load_dwordx4 v18, s[12:15], s40 offen offset:3072 lds
    s_add_u32 m0, s34, 4096
    s_add_u32 s40, s28, 4096
    buffer_load_dwordx4 v17, s[12:15], s40 offen offset:0 lds
    buffer_load_dwordx4 v18, s[12:15], s40 offen offset:1024 lds
    buffer_load_dwordx4 v17, s[12:15], s40 offen offset:2048 lds
    buffer_load_dwordx4 v18, s[12:15], s40 offen offset:3072 lds
    s_waitcnt vmcnt(0)
    ds_read_b64_tr_b16 v[196:197], v5 offset:0
    ds_read_b64_tr_b16 v[198:199], v5 offset:4096
    ds_read_b64_tr_b16 v[200:201], v6 offset:0
    ds_read_b64_tr_b16 v[202:203], v6 offset:4096
    ds_read_b64_tr_b16 v[204:205], v7 offset:0
    ds_read_b64_tr_b16 v[206:207], v7 offset:4096
    ds_read_b64_tr_b16 v[208:209], v8 offset:0
    ds_read_b64_tr_b16 v[210:211], v8 offset:4096
    ds_read_b64_tr_b16 v[228:229], v9 offset:0
    ds_read_b64_tr_b16 v[230:231], v9 offset:4096
    ds_read_b64_tr_b16 v[232:233], v10 offset:0
    ds_read_b64_tr_b16 v[234:235], v10 offset:4096
    ds_read_b64_tr_b16 v[236:237], v11 offset:0
    ds_read_b64_tr_b16 v[238:239], v11 offset:4096
    ds_read_b64_tr_b16 v[240:241], v12 offset:0
    ds_read_b64_tr_b16 v[242:243], v12 offset:4096
    v_mfma_f32_16x16x32_bf16 v[116:119], v[148:151], v[36:39], 0
    v_mfma_f32_16x16x32_bf16 v[116:119], v[152:155], v[40:43], v[116:119]
    v_mfma_f32_16x16x32_bf16 v[116:119], v[156:159], v[44:47], v[116:119]
    v_mfma_f32_16x16x32_bf16 v[116:119], v[160:163], v[48:51], v[116:119]
    v_mfma_f32_16x16x32_bf16 v[132:135], v[164:167], v[36:39], 0
    v_mfma_f32_16x16x32_bf16 v[132:135], v[168:171], v[40:43], v[132:135]
    v_mfma_f32_16x16x32_bf16 v[132:135], v[172:175], v[44:47], v[132:135]
    v_mfma_f32_16x16x32_bf16 v[132:135], v[176:179], v[48:51], v[132:135]
    v_mfma_f32_16x16x32_bf16 v[120:123], v[160:163], v[64:67], 0
    v_mfma_f32_16x16x32_bf16 v[120:123], v[156:159], v[60:63], v[120:123]
    v_mfma_f32_16x16x32_bf16 v[120:123], v[152:155], v[56:59], v[120:123]
    v_mfma_f32_16x16x32_bf16 v[120:123], v[148:151], v[52:55], v[120:123]
    v_mfma_f32_16x16x32_bf16 v[136:139], v[176:179], v[64:67], 0
    v_mfma_f32_16x16x32_bf16 v[136:139], v[172:175], v[60:63], v[136:139]
    v_mfma_f32_16x16x32_bf16 v[136:139], v[168:171], v[56:59], v[136:139]
    v_mfma_f32_16x16x32_bf16 v[136:139], v[164:167], v[52:55], v[136:139]
    v_mfma_f32_16x16x32_bf16 v[124:127], v[148:151], v[68:71], 0
    v_mfma_f32_16x16x32_bf16 v[124:127], v[152:155], v[72:75], v[124:127]
    v_mfma_f32_16x16x32_bf16 v[124:127], v[156:159], v[76:79], v[124:127]
    v_mfma_f32_16x16x32_bf16 v[124:127], v[160:163], v[80:83], v[124:127]
    v_mfma_f32_16x16x32_bf16 v[140:143], v[164:167], v[68:71], 0
    v_mfma_f32_16x16x32_bf16 v[140:143], v[168:171], v[72:75], v[140:143]
    v_mfma_f32_16x16x32_bf16 v[140:143], v[172:175], v[76:79], v[140:143]
    v_mfma_f32_16x16x32_bf16 v[140:143], v[176:179], v[80:83], v[140:143]
    v_mfma_f32_16x16x32_bf16 v[128:131], v[160:163], v[96:99], 0
    v_mfma_f32_16x16x32_bf16 v[128:131], v[156:159], v[92:95], v[128:131]
    v_mfma_f32_16x16x32_bf16 v[128:131], v[152:155], v[88:91], v[128:131]
    v_mfma_f32_16x16x32_bf16 v[128:131], v[148:151], v[84:87], v[128:131]
    v_mfma_f32_16x16x32_bf16 v[144:147], v[176:179], v[96:99], 0
    v_mfma_f32_16x16x32_bf16 v[144:147], v[172:175], v[92:95], v[144:147]
    v_mfma_f32_16x16x32_bf16 v[144:147], v[168:171], v[88:91], v[144:147]
    v_mfma_f32_16x16x32_bf16 v[144:147], v[164:167], v[84:87], v[144:147]
    s_waitcnt lgkmcnt(0)
    s_nop 7
    v_max3_f32 v224, v116, v117, v118
    v_max3_f32 v224, v224, v119, v132
    v_max3_f32 v224, v224, v133, v134
    v_max3_f32 v224, v224, v135, v212
    v_mov_b32 v225, v224
    s_nop 1
    v_permlane32_swap_b32 v224, v225
    v_max_f32 v224, v224, v225
    v_mov_b32 v225, v224
    s_nop 1
    v_permlane16_swap_b32 v224, v225
    v_max_f32 v224, v224, v225
    v_sub_f32 v220, v212, v224
    v_exp_f32 v220, v220
    v_mov_b32 v212, v224
    v_sub_f32 v116, v116, v224
    v_sub_f32 v117, v117, v224
    v_sub_f32 v118, v118, v224
    v_sub_f32 v119, v119, v224
    v_sub_f32 v132, v132, v224
    v_sub_f32 v133, v133, v224
    v_sub_f32 v134, v134, v224
    v_sub_f32 v135, v135, v224
    v_mul_f32 v216, v216, v220
    v_exp_f32 v116, v116
    v_exp_f32 v117, v117
    v_exp_f32 v118, v118
    v_exp_f32 v119, v119
    v_exp_f32 v132, v132
    v_exp_f32 v133, v133
    v_exp_f32 v134, v134
    v_exp_f32 v135, v135
    v_accvgpr_read_b32 v224, a0
    v_accvgpr_read_b32 v225, a1
    v_accvgpr_read_b32 v226, a2
    v_accvgpr_read_b32 v227, a3
    v_mul_f32 v224, v224, v220
    v_mul_f32 v225, v225, v220
    v_mul_f32 v226, v226, v220
    v_mul_f32 v227, v227, v220
    v_accvgpr_write_b32 a0, v224
    v_accvgpr_write_b32 a1, v225
    v_accvgpr_write_b32 a2, v226
    v_accvgpr_write_b32 a3, v227
    v_accvgpr_read_b32 v224, a16
    v_accvgpr_read_b32 v225, a17
    v_accvgpr_read_b32 v226, a18
    v_accvgpr_read_b32 v227, a19
    v_mul_f32 v224, v224, v220
    v_mul_f32 v225, v225, v220
    v_mul_f32 v226, v226, v220
    v_mul_f32 v227, v227, v220
    v_accvgpr_write_b32 a16, v224
    v_accvgpr_write_b32 a17, v225
    v_accvgpr_write_b32 a18, v226
    v_accvgpr_write_b32 a19, v227
    v_accvgpr_read_b32 v224, a32
    v_accvgpr_read_b32 v225, a33
    v_accvgpr_read_b32 v226, a34
    v_accvgpr_read_b32 v227, a35
    v_mul_f32 v224, v224, v220
    v_mul_f32 v225, v225, v220
    v_mul_f32 v226, v226, v220
    v_mul_f32 v227, v227, v220
    v_accvgpr_write_b32 a32, v224
    v_accvgpr_write_b32 a33, v225
    v_accvgpr_write_b32 a34, v226
    v_accvgpr_write_b32 a35, v227
    v_accvgpr_read_b32 v224, a48
    v_accvgpr_read_b32 v225, a49
    v_accvgpr_read_b32 v226, a50
    v_accvgpr_read_b32 v227, a51
    v_mul_f32 v224, v224, v220
    v_mul_f32 v225, v225, v220
    v_mul_f32 v226, v226, v220
    v_mul_f32 v227, v227, v220
    v_accvgpr_write_b32 a48, v224
    v_accvgpr_write_b32 a49, v225
    v_accvgpr_write_b32 a50, v226
    v_accvgpr_write_b32 a51, v227
    v_accvgpr_read_b32 v224, a64
    v_accvgpr_read_b32 v225, a65
    v_accvgpr_read_b32 v226, a66
    v_accvgpr_read_b32 v227, a67
    v_mul_f32 v224, v224, v220
    v_mul_f32 v225, v225, v220
    v_mul_f32 v226, v226, v220
    v_mul_f32 v227, v227, v220
    v_accvgpr_write_b32 a64, v224
    v_accvgpr_write_b32 a65, v225
    v_accvgpr_write_b32 a66, v226
    v_accvgpr_write_b32 a67, v227
    v_accvgpr_read_b32 v224, a80
    v_accvgpr_read_b32 v225, a81
    v_accvgpr_read_b32 v226, a82
    v_accvgpr_read_b32 v227, a83
    v_mul_f32 v224, v224, v220
    v_mul_f32 v225, v225, v220
    v_mul_f32 v226, v226, v220
    v_mul_f32 v227, v227, v220
    v_accvgpr_write_b32 a80, v224
    v_accvgpr_write_b32 a81, v225
    v_accvgpr_write_b32 a82, v226
    v_accvgpr_write_b32 a83, v227
    v_accvgpr_read_b32 v224, a96
    v_accvgpr_read_b32 v225, a97
    v_accvgpr_read_b32 v226, a98
    v_accvgpr_read_b32 v227, a99
    v_mul_f32 v224, v224, v220
    v_mul_f32 v225, v225, v220
    v_mul_f32 v226, v226, v220
    v_mul_f32 v227, v227, v220
    v_accvgpr_write_b32 a96, v224
    v_accvgpr_write_b32 a97, v225
    v_accvgpr_write_b32 a98, v226
    v_accvgpr_write_b32 a99, v227
    v_accvgpr_read_b32 v224, a112
    v_accvgpr_read_b32 v225, a113
    v_accvgpr_read_b32 v226, a114
    v_accvgpr_read_b32 v227, a115
    v_mul_f32 v224, v224, v220
    v_mul_f32 v225, v225, v220
    v_mul_f32 v226, v226, v220
    v_mul_f32 v227, v227, v220
    v_accvgpr_write_b32 a112, v224
    v_accvgpr_write_b32 a113, v225
    v_accvgpr_write_b32 a114, v226
    v_accvgpr_write_b32 a115, v227
    v_add_f32 v216, v216, v116
    v_add_f32 v216, v216, v117
    v_add_f32 v216, v216, v118
    v_add_f32 v216, v216, v119
    v_add_f32 v216, v216, v132
    v_add_f32 v216, v216, v133
    v_add_f32 v216, v216, v134
    v_add_f32 v216, v216, v135
    v_cvt_pk_bf16_f32 v180, v116, v117
    v_cvt_pk_bf16_f32 v181, v118, v119
    v_cvt_pk_bf16_f32 v182, v132, v133
    v_cvt_pk_bf16_f32 v183, v134, v135
    s_nop 1
    v_mfma_f32_16x16x32_bf16 a[0:3], v[196:199], v[180:183], a[0:3]
    v_mfma_f32_16x16x32_bf16 a[16:19], v[200:203], v[180:183], a[16:19]
    v_mfma_f32_16x16x32_bf16 a[32:35], v[204:207], v[180:183], a[32:35]
    v_mfma_f32_16x16x32_bf16 a[48:51], v[208:211], v[180:183], a[48:51]
    v_mfma_f32_16x16x32_bf16 a[64:67], v[228:231], v[180:183], a[64:67]
    v_mfma_f32_16x16x32_bf16 a[80:83], v[232:235], v[180:183], a[80:83]
    v_mfma_f32_16x16x32_bf16 a[96:99], v[236:239], v[180:183], a[96:99]
    v_mfma_f32_16x16x32_bf16 a[112:115], v[240:243], v[180:183], a[112:115]
    v_max3_f32 v224, v120, v121, v122
    v_max3_f32 v224, v224, v123, v136
    v_max3_f32 v224, v224, v137, v138
    v_max3_f32 v224, v224, v139, v213
    v_mov_b32 v225, v224
    s_nop 1
    v_permlane32_swap_b32 v224, v225
    v_max_f32 v224, v224, v225
    v_mov_b32 v225, v224
    s_nop 1
    v_permlane16_swap_b32 v224, v225
    v_max_f32 v224, v224, v225
    v_sub_f32 v220, v213, v224
    v_exp_f32 v220, v220
    v_mov_b32 v213, v224
    v_sub_f32 v120, v120, v224
    v_sub_f32 v121, v121, v224
    v_sub_f32 v122, v122, v224
    v_sub_f32 v123, v123, v224
    v_sub_f32 v136, v136, v224
    v_sub_f32 v137, v137, v224
    v_sub_f32 v138, v138, v224
    v_sub_f32 v139, v139, v224
    v_mul_f32 v217, v217, v220
    v_exp_f32 v120, v120
    v_exp_f32 v121, v121
    v_exp_f32 v122, v122
    v_exp_f32 v123, v123
    v_exp_f32 v136, v136
    v_exp_f32 v137, v137
    v_exp_f32 v138, v138
    v_exp_f32 v139, v139
    v_accvgpr_read_b32 v224, a4
    v_accvgpr_read_b32 v225, a5
    v_accvgpr_read_b32 v226, a6
    v_accvgpr_read_b32 v227, a7
    v_mul_f32 v224, v224, v220
    v_mul_f32 v225, v225, v220
    v_mul_f32 v226, v226, v220
    v_mul_f32 v227, v227, v220
    v_accvgpr_write_b32 a4, v224
    v_accvgpr_write_b32 a5, v225
    v_accvgpr_write_b32 a6, v226
    v_accvgpr_write_b32 a7, v227
    v_accvgpr_read_b32 v224, a20
    v_accvgpr_read_b32 v225, a21
    v_accvgpr_read_b32 v226, a22
    v_accvgpr_read_b32 v227, a23
    v_mul_f32 v224, v224, v220
    v_mul_f32 v225, v225, v220
    v_mul_f32 v226, v226, v220
    v_mul_f32 v227, v227, v220
    v_accvgpr_write_b32 a20, v224
    v_accvgpr_write_b32 a21, v225
    v_accvgpr_write_b32 a22, v226
    v_accvgpr_write_b32 a23, v227
    v_accvgpr_read_b32 v224, a36
    v_accvgpr_read_b32 v225, a37
    v_accvgpr_read_b32 v226, a38
    v_accvgpr_read_b32 v227, a39
    v_mul_f32 v224, v224, v220
    v_mul_f32 v225, v225, v220
    v_mul_f32 v226, v226, v220
    v_mul_f32 v227, v227, v220
    v_accvgpr_write_b32 a36, v224
    v_accvgpr_write_b32 a37, v225
    v_accvgpr_write_b32 a38, v226
    v_accvgpr_write_b32 a39, v227
    v_accvgpr_read_b32 v224, a52
    v_accvgpr_read_b32 v225, a53
    v_accvgpr_read_b32 v226, a54
    v_accvgpr_read_b32 v227, a55
    v_mul_f32 v224, v224, v220
    v_mul_f32 v225, v225, v220
    v_mul_f32 v226, v226, v220
    v_mul_f32 v227, v227, v220
    v_accvgpr_write_b32 a52, v224
    v_accvgpr_write_b32 a53, v225
    v_accvgpr_write_b32 a54, v226
    v_accvgpr_write_b32 a55, v227
    v_accvgpr_read_b32 v224, a68
    v_accvgpr_read_b32 v225, a69
    v_accvgpr_read_b32 v226, a70
    v_accvgpr_read_b32 v227, a71
    v_mul_f32 v224, v224, v220
    v_mul_f32 v225, v225, v220
    v_mul_f32 v226, v226, v220
    v_mul_f32 v227, v227, v220
    v_accvgpr_write_b32 a68, v224
    v_accvgpr_write_b32 a69, v225
    v_accvgpr_write_b32 a70, v226
    v_accvgpr_write_b32 a71, v227
    v_accvgpr_read_b32 v224, a84
    v_accvgpr_read_b32 v225, a85
    v_accvgpr_read_b32 v226, a86
    v_accvgpr_read_b32 v227, a87
    v_mul_f32 v224, v224, v220
    v_mul_f32 v225, v225, v220
    v_mul_f32 v226, v226, v220
    v_mul_f32 v227, v227, v220
    v_accvgpr_write_b32 a84, v224
    v_accvgpr_write_b32 a85, v225
    v_accvgpr_write_b32 a86, v226
    v_accvgpr_write_b32 a87, v227
    v_accvgpr_read_b32 v224, a100
    v_accvgpr_read_b32 v225, a101
    v_accvgpr_read_b32 v226, a102
    v_accvgpr_read_b32 v227, a103
    v_mul_f32 v224, v224, v220
    v_mul_f32 v225, v225, v220
    v_mul_f32 v226, v226, v220
    v_mul_f32 v227, v227, v220
    v_accvgpr_write_b32 a100, v224
    v_accvgpr_write_b32 a101, v225
    v_accvgpr_write_b32 a102, v226
    v_accvgpr_write_b32 a103, v227
    v_accvgpr_read_b32 v224, a116
    v_accvgpr_read_b32 v225, a117
    v_accvgpr_read_b32 v226, a118
    v_accvgpr_read_b32 v227, a119
    v_mul_f32 v224, v224, v220
    v_mul_f32 v225, v225, v220
    v_mul_f32 v226, v226, v220
    v_mul_f32 v227, v227, v220
    v_accvgpr_write_b32 a116, v224
    v_accvgpr_write_b32 a117, v225
    v_accvgpr_write_b32 a118, v226
    v_accvgpr_write_b32 a119, v227
    v_add_f32 v217, v217, v120
    v_add_f32 v217, v217, v121
    v_add_f32 v217, v217, v122
    v_add_f32 v217, v217, v123
    v_add_f32 v217, v217, v136
    v_add_f32 v217, v217, v137
    v_add_f32 v217, v217, v138
    v_add_f32 v217, v217, v139
    v_cvt_pk_bf16_f32 v184, v120, v121
    v_cvt_pk_bf16_f32 v185, v122, v123
    v_cvt_pk_bf16_f32 v186, v136, v137
    v_cvt_pk_bf16_f32 v187, v138, v139
    s_nop 1
    v_mfma_f32_16x16x32_bf16 a[4:7], v[196:199], v[184:187], a[4:7]
    v_mfma_f32_16x16x32_bf16 a[20:23], v[200:203], v[184:187], a[20:23]
    v_mfma_f32_16x16x32_bf16 a[36:39], v[204:207], v[184:187], a[36:39]
    v_mfma_f32_16x16x32_bf16 a[52:55], v[208:211], v[184:187], a[52:55]
    v_mfma_f32_16x16x32_bf16 a[68:71], v[228:231], v[184:187], a[68:71]
    v_mfma_f32_16x16x32_bf16 a[84:87], v[232:235], v[184:187], a[84:87]
    v_mfma_f32_16x16x32_bf16 a[100:103], v[236:239], v[184:187], a[100:103]
    v_mfma_f32_16x16x32_bf16 a[116:119], v[240:243], v[184:187], a[116:119]
    v_max3_f32 v224, v124, v125, v126
    v_max3_f32 v224, v224, v127, v140
    v_max3_f32 v224, v224, v141, v142
    v_max3_f32 v224, v224, v143, v214
    v_mov_b32 v225, v224
    s_nop 1
    v_permlane32_swap_b32 v224, v225
    v_max_f32 v224, v224, v225
    v_mov_b32 v225, v224
    s_nop 1
    v_permlane16_swap_b32 v224, v225
    v_max_f32 v224, v224, v225
    v_sub_f32 v220, v214, v224
    v_exp_f32 v220, v220
    v_mov_b32 v214, v224
    v_sub_f32 v124, v124, v224
    v_sub_f32 v125, v125, v224
    v_sub_f32 v126, v126, v224
    v_sub_f32 v127, v127, v224
    v_sub_f32 v140, v140, v224
    v_sub_f32 v141, v141, v224
    v_sub_f32 v142, v142, v224
    v_sub_f32 v143, v143, v224
    v_mul_f32 v218, v218, v220
    v_exp_f32 v124, v124
    v_exp_f32 v125, v125
    v_exp_f32 v126, v126
    v_exp_f32 v127, v127
    v_exp_f32 v140, v140
    v_exp_f32 v141, v141
    v_exp_f32 v142, v142
    v_exp_f32 v143, v143
    v_accvgpr_read_b32 v224, a8
    v_accvgpr_read_b32 v225, a9
    v_accvgpr_read_b32 v226, a10
    v_accvgpr_read_b32 v227, a11
    v_mul_f32 v224, v224, v220
    v_mul_f32 v225, v225, v220
    v_mul_f32 v226, v226, v220
    v_mul_f32 v227, v227, v220
    v_accvgpr_write_b32 a8, v224
    v_accvgpr_write_b32 a9, v225
    v_accvgpr_write_b32 a10, v226
    v_accvgpr_write_b32 a11, v227
    v_accvgpr_read_b32 v224, a24
    v_accvgpr_read_b32 v225, a25
    v_accvgpr_read_b32 v226, a26
    v_accvgpr_read_b32 v227, a27
    v_mul_f32 v224, v224, v220
    v_mul_f32 v225, v225, v220
    v_mul_f32 v226, v226, v220
    v_mul_f32 v227, v227, v220
    v_accvgpr_write_b32 a24, v224
    v_accvgpr_write_b32 a25, v225
    v_accvgpr_write_b32 a26, v226
    v_accvgpr_write_b32 a27, v227
    v_accvgpr_read_b32 v224, a40
    v_accvgpr_read_b32 v225, a41
    v_accvgpr_read_b32 v226, a42
    v_accvgpr_read_b32 v227, a43
    v_mul_f32 v224, v224, v220
    v_mul_f32 v225, v225, v220
    v_mul_f32 v226, v226, v220
    v_mul_f32 v227, v227, v220
    v_accvgpr_write_b32 a40, v224
    v_accvgpr_write_b32 a41, v225
    v_accvgpr_write_b32 a42, v226
    v_accvgpr_write_b32 a43, v227
    v_accvgpr_read_b32 v224, a56
    v_accvgpr_read_b32 v225, a57
    v_accvgpr_read_b32 v226, a58
    v_accvgpr_read_b32 v227, a59
    v_mul_f32 v224, v224, v220
    v_mul_f32 v225, v225, v220
    v_mul_f32 v226, v226, v220
    v_mul_f32 v227, v227, v220
    v_accvgpr_write_b32 a56, v224
    v_accvgpr_write_b32 a57, v225
    v_accvgpr_write_b32 a58, v226
    v_accvgpr_write_b32 a59, v227
    v_accvgpr_read_b32 v224, a72
    v_accvgpr_read_b32 v225, a73
    v_accvgpr_read_b32 v226, a74
    v_accvgpr_read_b32 v227, a75
    v_mul_f32 v224, v224, v220
    v_mul_f32 v225, v225, v220
    v_mul_f32 v226, v226, v220
    v_mul_f32 v227, v227, v220
    v_accvgpr_write_b32 a72, v224
    v_accvgpr_write_b32 a73, v225
    v_accvgpr_write_b32 a74, v226
    v_accvgpr_write_b32 a75, v227
    v_accvgpr_read_b32 v224, a88
    v_accvgpr_read_b32 v225, a89
    v_accvgpr_read_b32 v226, a90
    v_accvgpr_read_b32 v227, a91
    v_mul_f32 v224, v224, v220
    v_mul_f32 v225, v225, v220
    v_mul_f32 v226, v226, v220
    v_mul_f32 v227, v227, v220
    v_accvgpr_write_b32 a88, v224
    v_accvgpr_write_b32 a89, v225
    v_accvgpr_write_b32 a90, v226
    v_accvgpr_write_b32 a91, v227
    v_accvgpr_read_b32 v224, a104
    v_accvgpr_read_b32 v225, a105
    v_accvgpr_read_b32 v226, a106
    v_accvgpr_read_b32 v227, a107
    v_mul_f32 v224, v224, v220
    v_mul_f32 v225, v225, v220
    v_mul_f32 v226, v226, v220
    v_mul_f32 v227, v227, v220
    v_accvgpr_write_b32 a104, v224
    v_accvgpr_write_b32 a105, v225
    v_accvgpr_write_b32 a106, v226
    v_accvgpr_write_b32 a107, v227
    v_accvgpr_read_b32 v224, a120
    v_accvgpr_read_b32 v225, a121
    v_accvgpr_read_b32 v226, a122
    v_accvgpr_read_b32 v227, a123
    v_mul_f32 v224, v224, v220
    v_mul_f32 v225, v225, v220
    v_mul_f32 v226, v226, v220
    v_mul_f32 v227, v227, v220
    v_accvgpr_write_b32 a120, v224
    v_accvgpr_write_b32 a121, v225
    v_accvgpr_write_b32 a122, v226
    v_accvgpr_write_b32 a123, v227
    v_add_f32 v218, v218, v124
    v_add_f32 v218, v218, v125
    v_add_f32 v218, v218, v126
    v_add_f32 v218, v218, v127
    v_add_f32 v218, v218, v140
    v_add_f32 v218, v218, v141
    v_add_f32 v218, v218, v142
    v_add_f32 v218, v218, v143
    v_cvt_pk_bf16_f32 v188, v124, v125
    v_cvt_pk_bf16_f32 v189, v126, v127
    v_cvt_pk_bf16_f32 v190, v140, v141
    v_cvt_pk_bf16_f32 v191, v142, v143
    s_nop 1
    v_mfma_f32_16x16x32_bf16 a[8:11], v[196:199], v[188:191], a[8:11]
    v_mfma_f32_16x16x32_bf16 a[24:27], v[200:203], v[188:191], a[24:27]
    v_mfma_f32_16x16x32_bf16 a[40:43], v[204:207], v[188:191], a[40:43]
    v_mfma_f32_16x16x32_bf16 a[56:59], v[208:211], v[188:191], a[56:59]
    v_mfma_f32_16x16x32_bf16 a[72:75], v[228:231], v[188:191], a[72:75]
    v_mfma_f32_16x16x32_bf16 a[88:91], v[232:235], v[188:191], a[88:91]
    v_mfma_f32_16x16x32_bf16 a[104:107], v[236:239], v[188:191], a[104:107]
    v_mfma_f32_16x16x32_bf16 a[120:123], v[240:243], v[188:191], a[120:123]
    v_max3_f32 v224, v128, v129, v130
    v_max3_f32 v224, v224, v131, v144
    v_max3_f32 v224, v224, v145, v146
    v_max3_f32 v224, v224, v147, v215
    v_mov_b32 v225, v224
    s_nop 1
    v_permlane32_swap_b32 v224, v225
    v_max_f32 v224, v224, v225
    v_mov_b32 v225, v224
    s_nop 1
    v_permlane16_swap_b32 v224, v225
    v_max_f32 v224, v224, v225
    v_sub_f32 v220, v215, v224
    v_exp_f32 v220, v220
    v_mov_b32 v215, v224
    v_sub_f32 v128, v128, v224
    v_sub_f32 v129, v129, v224
    v_sub_f32 v130, v130, v224
    v_sub_f32 v131, v131, v224
    v_sub_f32 v144, v144, v224
    v_sub_f32 v145, v145, v224
    v_sub_f32 v146, v146, v224
    v_sub_f32 v147, v147, v224
    v_mul_f32 v219, v219, v220
    v_exp_f32 v128, v128
    v_exp_f32 v129, v129
    v_exp_f32 v130, v130
    v_exp_f32 v131, v131
    v_exp_f32 v144, v144
    v_exp_f32 v145, v145
    v_exp_f32 v146, v146
    v_exp_f32 v147, v147
    v_accvgpr_read_b32 v224, a12
    v_accvgpr_read_b32 v225, a13
    v_accvgpr_read_b32 v226, a14
    v_accvgpr_read_b32 v227, a15
    v_mul_f32 v224, v224, v220
    v_mul_f32 v225, v225, v220
    v_mul_f32 v226, v226, v220
    v_mul_f32 v227, v227, v220
    v_accvgpr_write_b32 a12, v224
    v_accvgpr_write_b32 a13, v225
    v_accvgpr_write_b32 a14, v226
    v_accvgpr_write_b32 a15, v227
    v_accvgpr_read_b32 v224, a28
    v_accvgpr_read_b32 v225, a29
    v_accvgpr_read_b32 v226, a30
    v_accvgpr_read_b32 v227, a31
    v_mul_f32 v224, v224, v220
    v_mul_f32 v225, v225, v220
    v_mul_f32 v226, v226, v220
    v_mul_f32 v227, v227, v220
    v_accvgpr_write_b32 a28, v224
    v_accvgpr_write_b32 a29, v225
    v_accvgpr_write_b32 a30, v226
    v_accvgpr_write_b32 a31, v227
    v_accvgpr_read_b32 v224, a44
    v_accvgpr_read_b32 v225, a45
    v_accvgpr_read_b32 v226, a46
    v_accvgpr_read_b32 v227, a47
    v_mul_f32 v224, v224, v220
    v_mul_f32 v225, v225, v220
    v_mul_f32 v226, v226, v220
    v_mul_f32 v227, v227, v220
    v_accvgpr_write_b32 a44, v224
    v_accvgpr_write_b32 a45, v225
    v_accvgpr_write_b32 a46, v226
    v_accvgpr_write_b32 a47, v227
    v_accvgpr_read_b32 v224, a60
    v_accvgpr_read_b32 v225, a61
    v_accvgpr_read_b32 v226, a62
    v_accvgpr_read_b32 v227, a63
    v_mul_f32 v224, v224, v220
    v_mul_f32 v225, v225, v220
    v_mul_f32 v226, v226, v220
    v_mul_f32 v227, v227, v220
    v_accvgpr_write_b32 a60, v224
    v_accvgpr_write_b32 a61, v225
    v_accvgpr_write_b32 a62, v226
    v_accvgpr_write_b32 a63, v227
    v_accvgpr_read_b32 v224, a76
    v_accvgpr_read_b32 v225, a77
    v_accvgpr_read_b32 v226, a78
    v_accvgpr_read_b32 v227, a79
    v_mul_f32 v224, v224, v220
    v_mul_f32 v225, v225, v220
    v_mul_f32 v226, v226, v220
    v_mul_f32 v227, v227, v220
    v_accvgpr_write_b32 a76, v224
    v_accvgpr_write_b32 a77, v225
    v_accvgpr_write_b32 a78, v226
    v_accvgpr_write_b32 a79, v227
    v_accvgpr_read_b32 v224, a92
    v_accvgpr_read_b32 v225, a93
    v_accvgpr_read_b32 v226, a94
    v_accvgpr_read_b32 v227, a95
    v_mul_f32 v224, v224, v220
    v_mul_f32 v225, v225, v220
    v_mul_f32 v226, v226, v220
    v_mul_f32 v227, v227, v220
    v_accvgpr_write_b32 a92, v224
    v_accvgpr_write_b32 a93, v225
    v_accvgpr_write_b32 a94, v226
    v_accvgpr_write_b32 a95, v227
    v_accvgpr_read_b32 v224, a108
    v_accvgpr_read_b32 v225, a109
    v_accvgpr_read_b32 v226, a110
    v_accvgpr_read_b32 v227, a111
    v_mul_f32 v224, v224, v220
    v_mul_f32 v225, v225, v220
    v_mul_f32 v226, v226, v220
    v_mul_f32 v227, v227, v220
    v_accvgpr_write_b32 a108, v224
    v_accvgpr_write_b32 a109, v225
    v_accvgpr_write_b32 a110, v226
    v_accvgpr_write_b32 a111, v227
    v_accvgpr_read_b32 v224, a124
    v_accvgpr_read_b32 v225, a125
    v_accvgpr_read_b32 v226, a126
    v_accvgpr_read_b32 v227, a127
    v_mul_f32 v224, v224, v220
    v_mul_f32 v225, v225, v220
    v_mul_f32 v226, v226, v220
    v_mul_f32 v227, v227, v220
    v_accvgpr_write_b32 a124, v224
    v_accvgpr_write_b32 a125, v225
    v_accvgpr_write_b32 a126, v226
    v_accvgpr_write_b32 a127, v227
    v_add_f32 v219, v219, v128
    v_add_f32 v219, v219, v129
    v_add_f32 v219, v219, v130
    v_add_f32 v219, v219, v131
    v_add_f32 v219, v219, v144
    v_add_f32 v219, v219, v145
    v_add_f32 v219, v219, v146
    v_add_f32 v219, v219, v147
    v_cvt_pk_bf16_f32 v192, v128, v129
    v_cvt_pk_bf16_f32 v193, v130, v131
    v_cvt_pk_bf16_f32 v194, v144, v145
    v_cvt_pk_bf16_f32 v195, v146, v147
    s_nop 1
    v_mfma_f32_16x16x32_bf16 a[12:15], v[196:199], v[192:195], a[12:15]
    v_mfma_f32_16x16x32_bf16 a[28:31], v[200:203], v[192:195], a[28:31]
    v_mfma_f32_16x16x32_bf16 a[44:47], v[204:207], v[192:195], a[44:47]
    v_mfma_f32_16x16x32_bf16 a[60:63], v[208:211], v[192:195], a[60:63]
    v_mfma_f32_16x16x32_bf16 a[76:79], v[228:231], v[192:195], a[76:79]
    v_mfma_f32_16x16x32_bf16 a[92:95], v[232:235], v[192:195], a[92:95]
    v_mfma_f32_16x16x32_bf16 a[108:111], v[236:239], v[192:195], a[108:111]
    v_mfma_f32_16x16x32_bf16 a[124:127], v[240:243], v[192:195], a[124:127]
    s_add_u32 s28, s28, 8192
    s_cmp_lt_u32 s28, 524288
    s_cbranch_scc1 L_slow_loop
    v_mov_b32 v224, v216
    s_nop 1
    v_permlane32_swap_b32 v216, v224
    v_add_f32 v216, v216, v224
    v_mov_b32 v224, v216
    s_nop 1
    v_permlane16_swap_b32 v216, v224
    v_add_f32 v216, v216, v224
    v_rcp_f32 v100, v216
    v_mov_b32 v224, v217
    s_nop 1
    v_permlane32_swap_b32 v217, v224
    v_add_f32 v217, v217, v224
    v_mov_b32 v224, v217
    s_nop 1
    v_permlane16_swap_b32 v217, v224
    v_add_f32 v217, v217, v224
    v_rcp_f32 v101, v217
    v_mov_b32 v224, v218
    s_nop 1
    v_permlane32_swap_b32 v218, v224
    v_add_f32 v218, v218, v224
    v_mov_b32 v224, v218
    s_nop 1
    v_permlane16_swap_b32 v218, v224
    v_add_f32 v218, v218, v224
    v_rcp_f32 v102, v218
    v_mov_b32 v224, v219
    s_nop 1
    v_permlane32_swap_b32 v219, v224
    v_add_f32 v219, v219, v224
    v_mov_b32 v224, v219
    s_nop 1
    v_permlane16_swap_b32 v219, v224
    v_add_f32 v219, v219, v224
    v_rcp_f32 v103, v219
    s_mov_b32 s36, 0
    v_accvgpr_read_b32 v120, a0
    v_accvgpr_read_b32 v121, a1
    v_accvgpr_read_b32 v122, a2
    v_accvgpr_read_b32 v123, a3
    v_accvgpr_read_b32 v124, a16
    v_accvgpr_read_b32 v125, a17
    v_accvgpr_read_b32 v126, a18
    v_accvgpr_read_b32 v127, a19
    v_mul_f32 v120, v120, v100
    v_mul_f32 v121, v121, v100
    v_mul_f32 v122, v122, v100
    v_mul_f32 v123, v123, v100
    v_mul_f32 v124, v124, v100
    v_mul_f32 v125, v125, v100
    v_mul_f32 v126, v126, v100
    v_mul_f32 v127, v127, v100
    v_cvt_pk_bf16_f32 v152, v120, v121
    v_cvt_pk_bf16_f32 v153, v122, v123
    v_cvt_pk_bf16_f32 v154, v124, v125
    v_cvt_pk_bf16_f32 v155, v126, v127
    buffer_store_dwordx4 v[152:155], v110, s[24:27], s36 offen offset:0 sc1
    v_accvgpr_read_b32 v128, a4
    v_accvgpr_read_b32 v129, a5
    v_accvgpr_read_b32 v130, a6
    v_accvgpr_read_b32 v131, a7
    v_accvgpr_read_b32 v132, a20
    v_accvgpr_read_b32 v133, a21
    v_accvgpr_read_b32 v134, a22
    v_accvgpr_read_b32 v135, a23
    v_mul_f32 v128, v128, v101
    v_mul_f32 v129, v129, v101
    v_mul_f32 v130, v130, v101
    v_mul_f32 v131, v131, v101
    v_mul_f32 v132, v132, v101
    v_mul_f32 v133, v133, v101
    v_mul_f32 v134, v134, v101
    v_mul_f32 v135, v135, v101
    v_cvt_pk_bf16_f32 v156, v128, v129
    v_cvt_pk_bf16_f32 v157, v130, v131
    v_cvt_pk_bf16_f32 v158, v132, v133
    v_cvt_pk_bf16_f32 v159, v134, v135
    buffer_store_dwordx4 v[156:159], v110, s[24:27], s36 offen offset:1024 sc1
    v_accvgpr_read_b32 v136, a8
    v_accvgpr_read_b32 v137, a9
    v_accvgpr_read_b32 v138, a10
    v_accvgpr_read_b32 v139, a11
    v_accvgpr_read_b32 v140, a24
    v_accvgpr_read_b32 v141, a25
    v_accvgpr_read_b32 v142, a26
    v_accvgpr_read_b32 v143, a27
    v_mul_f32 v136, v136, v102
    v_mul_f32 v137, v137, v102
    v_mul_f32 v138, v138, v102
    v_mul_f32 v139, v139, v102
    v_mul_f32 v140, v140, v102
    v_mul_f32 v141, v141, v102
    v_mul_f32 v142, v142, v102
    v_mul_f32 v143, v143, v102
    v_cvt_pk_bf16_f32 v160, v136, v137
    v_cvt_pk_bf16_f32 v161, v138, v139
    v_cvt_pk_bf16_f32 v162, v140, v141
    v_cvt_pk_bf16_f32 v163, v142, v143
    buffer_store_dwordx4 v[160:163], v110, s[24:27], s36 offen offset:2048 sc1
    v_accvgpr_read_b32 v144, a12
    v_accvgpr_read_b32 v145, a13
    v_accvgpr_read_b32 v146, a14
    v_accvgpr_read_b32 v147, a15
    v_accvgpr_read_b32 v148, a28
    v_accvgpr_read_b32 v149, a29
    v_accvgpr_read_b32 v150, a30
    v_accvgpr_read_b32 v151, a31
    v_mul_f32 v144, v144, v103
    v_mul_f32 v145, v145, v103
    v_mul_f32 v146, v146, v103
    v_mul_f32 v147, v147, v103
    v_mul_f32 v148, v148, v103
    v_mul_f32 v149, v149, v103
    v_mul_f32 v150, v150, v103
    v_mul_f32 v151, v151, v103
    v_cvt_pk_bf16_f32 v164, v144, v145
    v_cvt_pk_bf16_f32 v165, v146, v147
    v_cvt_pk_bf16_f32 v166, v148, v149
    v_cvt_pk_bf16_f32 v167, v150, v151
    buffer_store_dwordx4 v[164:167], v110, s[24:27], s36 offen offset:3072 sc1
    s_mov_b32 s36, 4096
    v_accvgpr_read_b32 v120, a32
    v_accvgpr_read_b32 v121, a33
    v_accvgpr_read_b32 v122, a34
    v_accvgpr_read_b32 v123, a35
    v_accvgpr_read_b32 v124, a48
    v_accvgpr_read_b32 v125, a49
    v_accvgpr_read_b32 v126, a50
    v_accvgpr_read_b32 v127, a51
    v_mul_f32 v120, v120, v100
    v_mul_f32 v121, v121, v100
    v_mul_f32 v122, v122, v100
    v_mul_f32 v123, v123, v100
    v_mul_f32 v124, v124, v100
    v_mul_f32 v125, v125, v100
    v_mul_f32 v126, v126, v100
    v_mul_f32 v127, v127, v100
    v_cvt_pk_bf16_f32 v152, v120, v121
    v_cvt_pk_bf16_f32 v153, v122, v123
    v_cvt_pk_bf16_f32 v154, v124, v125
    v_cvt_pk_bf16_f32 v155, v126, v127
    buffer_store_dwordx4 v[152:155], v110, s[24:27], s36 offen offset:0 sc1
    v_accvgpr_read_b32 v128, a36
    v_accvgpr_read_b32 v129, a37
    v_accvgpr_read_b32 v130, a38
    v_accvgpr_read_b32 v131, a39
    v_accvgpr_read_b32 v132, a52
    v_accvgpr_read_b32 v133, a53
    v_accvgpr_read_b32 v134, a54
    v_accvgpr_read_b32 v135, a55
    v_mul_f32 v128, v128, v101
    v_mul_f32 v129, v129, v101
    v_mul_f32 v130, v130, v101
    v_mul_f32 v131, v131, v101
    v_mul_f32 v132, v132, v101
    v_mul_f32 v133, v133, v101
    v_mul_f32 v134, v134, v101
    v_mul_f32 v135, v135, v101
    v_cvt_pk_bf16_f32 v156, v128, v129
    v_cvt_pk_bf16_f32 v157, v130, v131
    v_cvt_pk_bf16_f32 v158, v132, v133
    v_cvt_pk_bf16_f32 v159, v134, v135
    buffer_store_dwordx4 v[156:159], v110, s[24:27], s36 offen offset:1024 sc1
    v_accvgpr_read_b32 v136, a40
    v_accvgpr_read_b32 v137, a41
    v_accvgpr_read_b32 v138, a42
    v_accvgpr_read_b32 v139, a43
    v_accvgpr_read_b32 v140, a56
    v_accvgpr_read_b32 v141, a57
    v_accvgpr_read_b32 v142, a58
    v_accvgpr_read_b32 v143, a59
    v_mul_f32 v136, v136, v102
    v_mul_f32 v137, v137, v102
    v_mul_f32 v138, v138, v102
    v_mul_f32 v139, v139, v102
    v_mul_f32 v140, v140, v102
    v_mul_f32 v141, v141, v102
    v_mul_f32 v142, v142, v102
    v_mul_f32 v143, v143, v102
    v_cvt_pk_bf16_f32 v160, v136, v137
    v_cvt_pk_bf16_f32 v161, v138, v139
    v_cvt_pk_bf16_f32 v162, v140, v141
    v_cvt_pk_bf16_f32 v163, v142, v143
    buffer_store_dwordx4 v[160:163], v110, s[24:27], s36 offen offset:2048 sc1
    v_accvgpr_read_b32 v144, a44
    v_accvgpr_read_b32 v145, a45
    v_accvgpr_read_b32 v146, a46
    v_accvgpr_read_b32 v147, a47
    v_accvgpr_read_b32 v148, a60
    v_accvgpr_read_b32 v149, a61
    v_accvgpr_read_b32 v150, a62
    v_accvgpr_read_b32 v151, a63
    v_mul_f32 v144, v144, v103
    v_mul_f32 v145, v145, v103
    v_mul_f32 v146, v146, v103
    v_mul_f32 v147, v147, v103
    v_mul_f32 v148, v148, v103
    v_mul_f32 v149, v149, v103
    v_mul_f32 v150, v150, v103
    v_mul_f32 v151, v151, v103
    v_cvt_pk_bf16_f32 v164, v144, v145
    v_cvt_pk_bf16_f32 v165, v146, v147
    v_cvt_pk_bf16_f32 v166, v148, v149
    v_cvt_pk_bf16_f32 v167, v150, v151
    buffer_store_dwordx4 v[164:167], v110, s[24:27], s36 offen offset:3072 sc1
    s_mov_b32 s36, 8192
    v_accvgpr_read_b32 v120, a64
    v_accvgpr_read_b32 v121, a65
    v_accvgpr_read_b32 v122, a66
    v_accvgpr_read_b32 v123, a67
    v_accvgpr_read_b32 v124, a80
    v_accvgpr_read_b32 v125, a81
    v_accvgpr_read_b32 v126, a82
    v_accvgpr_read_b32 v127, a83
    v_mul_f32 v120, v120, v100
    v_mul_f32 v121, v121, v100
    v_mul_f32 v122, v122, v100
    v_mul_f32 v123, v123, v100
    v_mul_f32 v124, v124, v100
    v_mul_f32 v125, v125, v100
    v_mul_f32 v126, v126, v100
    v_mul_f32 v127, v127, v100
    v_cvt_pk_bf16_f32 v152, v120, v121
    v_cvt_pk_bf16_f32 v153, v122, v123
    v_cvt_pk_bf16_f32 v154, v124, v125
    v_cvt_pk_bf16_f32 v155, v126, v127
    buffer_store_dwordx4 v[152:155], v110, s[24:27], s36 offen offset:0 sc1
    v_accvgpr_read_b32 v128, a68
    v_accvgpr_read_b32 v129, a69
    v_accvgpr_read_b32 v130, a70
    v_accvgpr_read_b32 v131, a71
    v_accvgpr_read_b32 v132, a84
    v_accvgpr_read_b32 v133, a85
    v_accvgpr_read_b32 v134, a86
    v_accvgpr_read_b32 v135, a87
    v_mul_f32 v128, v128, v101
    v_mul_f32 v129, v129, v101
    v_mul_f32 v130, v130, v101
    v_mul_f32 v131, v131, v101
    v_mul_f32 v132, v132, v101
    v_mul_f32 v133, v133, v101
    v_mul_f32 v134, v134, v101
    v_mul_f32 v135, v135, v101
    v_cvt_pk_bf16_f32 v156, v128, v129
    v_cvt_pk_bf16_f32 v157, v130, v131
    v_cvt_pk_bf16_f32 v158, v132, v133
    v_cvt_pk_bf16_f32 v159, v134, v135
    buffer_store_dwordx4 v[156:159], v110, s[24:27], s36 offen offset:1024 sc1
    v_accvgpr_read_b32 v136, a72
    v_accvgpr_read_b32 v137, a73
    v_accvgpr_read_b32 v138, a74
    v_accvgpr_read_b32 v139, a75
    v_accvgpr_read_b32 v140, a88
    v_accvgpr_read_b32 v141, a89
    v_accvgpr_read_b32 v142, a90
    v_accvgpr_read_b32 v143, a91
    v_mul_f32 v136, v136, v102
    v_mul_f32 v137, v137, v102
    v_mul_f32 v138, v138, v102
    v_mul_f32 v139, v139, v102
    v_mul_f32 v140, v140, v102
    v_mul_f32 v141, v141, v102
    v_mul_f32 v142, v142, v102
    v_mul_f32 v143, v143, v102
    v_cvt_pk_bf16_f32 v160, v136, v137
    v_cvt_pk_bf16_f32 v161, v138, v139
    v_cvt_pk_bf16_f32 v162, v140, v141
    v_cvt_pk_bf16_f32 v163, v142, v143
    buffer_store_dwordx4 v[160:163], v110, s[24:27], s36 offen offset:2048 sc1
    v_accvgpr_read_b32 v144, a76
    v_accvgpr_read_b32 v145, a77
    v_accvgpr_read_b32 v146, a78
    v_accvgpr_read_b32 v147, a79
    v_accvgpr_read_b32 v148, a92
    v_accvgpr_read_b32 v149, a93
    v_accvgpr_read_b32 v150, a94
    v_accvgpr_read_b32 v151, a95
    v_mul_f32 v144, v144, v103
    v_mul_f32 v145, v145, v103
    v_mul_f32 v146, v146, v103
    v_mul_f32 v147, v147, v103
    v_mul_f32 v148, v148, v103
    v_mul_f32 v149, v149, v103
    v_mul_f32 v150, v150, v103
    v_mul_f32 v151, v151, v103
    v_cvt_pk_bf16_f32 v164, v144, v145
    v_cvt_pk_bf16_f32 v165, v146, v147
    v_cvt_pk_bf16_f32 v166, v148, v149
    v_cvt_pk_bf16_f32 v167, v150, v151
    buffer_store_dwordx4 v[164:167], v110, s[24:27], s36 offen offset:3072 sc1
    s_mov_b32 s36, 12288
    v_accvgpr_read_b32 v120, a96
    v_accvgpr_read_b32 v121, a97
    v_accvgpr_read_b32 v122, a98
    v_accvgpr_read_b32 v123, a99
    v_accvgpr_read_b32 v124, a112
    v_accvgpr_read_b32 v125, a113
    v_accvgpr_read_b32 v126, a114
    v_accvgpr_read_b32 v127, a115
    v_mul_f32 v120, v120, v100
    v_mul_f32 v121, v121, v100
    v_mul_f32 v122, v122, v100
    v_mul_f32 v123, v123, v100
    v_mul_f32 v124, v124, v100
    v_mul_f32 v125, v125, v100
    v_mul_f32 v126, v126, v100
    v_mul_f32 v127, v127, v100
    v_cvt_pk_bf16_f32 v152, v120, v121
    v_cvt_pk_bf16_f32 v153, v122, v123
    v_cvt_pk_bf16_f32 v154, v124, v125
    v_cvt_pk_bf16_f32 v155, v126, v127
    buffer_store_dwordx4 v[152:155], v110, s[24:27], s36 offen offset:0 sc1
    v_accvgpr_read_b32 v128, a100
    v_accvgpr_read_b32 v129, a101
    v_accvgpr_read_b32 v130, a102
    v_accvgpr_read_b32 v131, a103
    v_accvgpr_read_b32 v132, a116
    v_accvgpr_read_b32 v133, a117
    v_accvgpr_read_b32 v134, a118
    v_accvgpr_read_b32 v135, a119
    v_mul_f32 v128, v128, v101
    v_mul_f32 v129, v129, v101
    v_mul_f32 v130, v130, v101
    v_mul_f32 v131, v131, v101
    v_mul_f32 v132, v132, v101
    v_mul_f32 v133, v133, v101
    v_mul_f32 v134, v134, v101
    v_mul_f32 v135, v135, v101
    v_cvt_pk_bf16_f32 v156, v128, v129
    v_cvt_pk_bf16_f32 v157, v130, v131
    v_cvt_pk_bf16_f32 v158, v132, v133
    v_cvt_pk_bf16_f32 v159, v134, v135
    buffer_store_dwordx4 v[156:159], v110, s[24:27], s36 offen offset:1024 sc1
    v_accvgpr_read_b32 v136, a104
    v_accvgpr_read_b32 v137, a105
    v_accvgpr_read_b32 v138, a106
    v_accvgpr_read_b32 v139, a107
    v_accvgpr_read_b32 v140, a120
    v_accvgpr_read_b32 v141, a121
    v_accvgpr_read_b32 v142, a122
    v_accvgpr_read_b32 v143, a123
    v_mul_f32 v136, v136, v102
    v_mul_f32 v137, v137, v102
    v_mul_f32 v138, v138, v102
    v_mul_f32 v139, v139, v102
    v_mul_f32 v140, v140, v102
    v_mul_f32 v141, v141, v102
    v_mul_f32 v142, v142, v102
    v_mul_f32 v143, v143, v102
    v_cvt_pk_bf16_f32 v160, v136, v137
    v_cvt_pk_bf16_f32 v161, v138, v139
    v_cvt_pk_bf16_f32 v162, v140, v141
    v_cvt_pk_bf16_f32 v163, v142, v143
    buffer_store_dwordx4 v[160:163], v110, s[24:27], s36 offen offset:2048 sc1
    v_accvgpr_read_b32 v144, a108
    v_accvgpr_read_b32 v145, a109
    v_accvgpr_read_b32 v146, a110
    v_accvgpr_read_b32 v147, a111
    v_accvgpr_read_b32 v148, a124
    v_accvgpr_read_b32 v149, a125
    v_accvgpr_read_b32 v150, a126
    v_accvgpr_read_b32 v151, a127
    v_mul_f32 v144, v144, v103
    v_mul_f32 v145, v145, v103
    v_mul_f32 v146, v146, v103
    v_mul_f32 v147, v147, v103
    v_mul_f32 v148, v148, v103
    v_mul_f32 v149, v149, v103
    v_mul_f32 v150, v150, v103
    v_mul_f32 v151, v151, v103
    v_cvt_pk_bf16_f32 v164, v144, v145
    v_cvt_pk_bf16_f32 v165, v146, v147
    v_cvt_pk_bf16_f32 v166, v148, v149
    v_cvt_pk_bf16_f32 v167, v150, v151
    buffer_store_dwordx4 v[164:167], v110, s[24:27], s36 offen offset:3072 sc1
    s_mov_b32 s45, 61440
    buffer_load_dwordx4 a[0:3], v114, s[20:23], s45 offen offset:1024 sc1
    s_mov_b32 s45, 61440
    buffer_load_dwordx4 a[4:7], v114, s[20:23], s45 offen offset:2048 sc1
    s_mov_b32 s45, 61440
    buffer_load_dwordx4 a[8:11], v114, s[20:23], s45 offen offset:3072 sc1
    s_mov_b32 s45, 61440
    buffer_load_dwordx4 a[12:15], v115, s[20:23], s45 offen offset:0 sc1
    s_mov_b32 s45, 81920
    buffer_load_dwordx4 a[16:19], v114, s[20:23], s45 offen offset:0 sc1
    s_mov_b32 s45, 81920
    buffer_load_dwordx4 a[20:23], v114, s[20:23], s45 offen offset:1024 sc1
    s_mov_b32 s45, 81920
    buffer_load_dwordx4 a[24:27], v114, s[20:23], s45 offen offset:2048 sc1
    s_mov_b32 s45, 81920
    buffer_load_dwordx4 a[28:31], v114, s[20:23], s45 offen offset:3072 sc1
    s_mov_b32 s45, 81920
    buffer_load_dwordx4 a[32:35], v115, s[20:23], s45 offen offset:0 sc1
    s_mov_b32 s45, 102400
    buffer_load_dwordx4 a[36:39], v114, s[20:23], s45 offen offset:0 sc1
    s_mov_b32 s45, 102400
    buffer_load_dwordx4 a[40:43], v114, s[20:23], s45 offen offset:1024 sc1
    s_mov_b32 s45, 102400
    buffer_load_dwordx4 a[44:47], v114, s[20:23], s45 offen offset:2048 sc1
    s_mov_b32 s45, 102400
    buffer_load_dwordx4 a[48:51], v114, s[20:23], s45 offen offset:3072 sc1
    s_mov_b32 s45, 102400
    buffer_load_dwordx4 a[52:55], v115, s[20:23], s45 offen offset:0 sc1
    s_mov_b32 s45, 122880
    buffer_load_dwordx4 a[56:59], v114, s[20:23], s45 offen offset:0 sc1
    s_mov_b32 s45, 122880
    buffer_load_dwordx4 a[60:63], v114, s[20:23], s45 offen offset:1024 sc1
    s_mov_b32 s45, 122880
    buffer_load_dwordx4 a[64:67], v114, s[20:23], s45 offen offset:2048 sc1
    s_mov_b32 s45, 122880
    buffer_load_dwordx4 a[68:71], v114, s[20:23], s45 offen offset:3072 sc1
    s_mov_b32 s45, 122880
    buffer_load_dwordx4 a[72:75], v115, s[20:23], s45 offen offset:0 sc1
    s_mov_b32 s45, 143360
    buffer_load_dwordx4 a[76:79], v114, s[20:23], s45 offen offset:0 sc1
    s_mov_b32 s45, 143360
    buffer_load_dwordx4 a[80:83], v114, s[20:23], s45 offen offset:1024 sc1
    s_mov_b32 s45, 143360
    buffer_load_dwordx4 a[84:87], v114, s[20:23], s45 offen offset:2048 sc1
    s_mov_b32 s45, 143360
    buffer_load_dwordx4 a[88:91], v114, s[20:23], s45 offen offset:3072 sc1
    s_mov_b32 s45, 143360
    buffer_load_dwordx4 a[92:95], v115, s[20:23], s45 offen offset:0 sc1
    s_waitcnt vmcnt(0)
    s_branch L_published
L_spin_rows:
    s_mov_b32 s7, 262144
L_retry_rows:
    s_sleep 4
    buffer_load_dword v252, off, s[92:95], s74 sc1
    s_waitcnt vmcnt(0)
    v_cmp_gt_u32 vcc, 32, v252
    s_and_b64 vcc, vcc, exec
    s_cbranch_scc0 L_back_rows
    s_sub_u32 s7, s7, 1
    s_cbranch_scc0 L_retry_rows
    s_branch L_back_rows
L_spin_all:
    s_mov_b32 s7, 262144
L_retry_all:
    s_sleep 4
    buffer_load_dword v252, v253, s[92:95], 0 offen sc1
    s_waitcnt vmcnt(0)
    v_cmp_gt_u32 vcc, 32, v252
    s_and_b64 vcc, vcc, exec
    s_cbranch_scc0 L_back_all
    s_sub_u32 s7, s7, 1
    s_cbranch_scc0 L_retry_all
    s_branch L_back_all
L_rt_keys:
    s_lshl_b32 s40, s5, 13
    s_add_u32 s40, s40, 0x280008
    v_lshlrev_b32 v253, 4, v19
    buffer_load_dword v28, v253, s[76:79], s40 offen offset:0 sc1
    buffer_load_dword v29, v253, s[76:79], s40 offen offset:1024 sc1
    buffer_load_dword v30, v253, s[76:79], s40 offen offset:2048 sc1
    buffer_load_dword v31, v253, s[76:79], s40 offen offset:3072 sc1
    s_add_u32 s40, s40, 4096
    buffer_load_dword v32, v253, s[76:79], s40 offen offset:0 sc1
    buffer_load_dword v33, v253, s[76:79], s40 offen offset:1024 sc1
    buffer_load_dword v34, v253, s[76:79], s40 offen offset:2048 sc1
    buffer_load_dword v35, v253, s[76:79], s40 offen offset:3072 sc1
    s_branch L_rt_back_keys
L_rt_local:
    s_waitcnt vmcnt(11)
    s_mov_b32 s42, -1
    v_sub_u32 v20, s42, v28
    v_sub_u32 v21, s42, v29
    v_sub_u32 v22, s42, v30
    v_min3_u32 v20, v20, v21, v22
    v_sub_u32 v21, s42, v31
    v_sub_u32 v22, s42, v32
    v_min3_u32 v20, v20, v21, v22
    v_sub_u32 v21, s42, v33
    v_sub_u32 v22, s42, v34
    v_min3_u32 v20, v20, v21, v22
    v_sub_u32 v21, s42, v35
    v_min_u32 v20, v20, v21
    s_nop 1
    v_min_u32_dpp v20, v20, v20 row_shr:1 row_mask:0xf bank_mask:0xf
    s_nop 1
    v_min_u32_dpp v20, v20, v20 row_shr:2 row_mask:0xf bank_mask:0xf
    s_nop 1
    v_min_u32_dpp v20, v20, v20 row_shr:4 row_mask:0xf bank_mask:0xf
    s_nop 1
    v_min_u32_dpp v20, v20, v20 row_shr:8 row_mask:0xf bank_mask:0xf
    s_nop 1
    v_min_u32_dpp v20, v20, v20 row_bcast:15 row_mask:0xa bank_mask:0xf
    s_nop 1
    v_min_u32_dpp v20, v20, v20 row_bcast:31 row_mask:0xc bank_mask:0xf
    s_nop 0
    v_readlane_b32 s50, v20, 63
    s_sub_u32 s50, s42, s50
    s_sub_u32 s42, s50, 1
    v_sub_u32 v20, s42, v28
    v_sub_u32 v21, s42, v29
    v_sub_u32 v22, s42, v30
    v_min3_u32 v20, v20, v21, v22
    v_sub_u32 v21, s42, v31
    v_sub_u32 v22, s42, v32
    v_min3_u32 v20, v20, v21, v22
    v_sub_u32 v21, s42, v33
    v_sub_u32 v22, s42, v34
    v_min3_u32 v20, v20, v21, v22
    v_sub_u32 v21, s42, v35
    v_min_u32 v20, v20, v21
    s_nop 1
    v_min_u32_dpp v20, v20, v20 row_shr:1 row_mask:0xf bank_mask:0xf
    s_nop 1
    v_min_u32_dpp v20, v20, v20 row_shr:2 row_mask:0xf bank_mask:0xf
    s_nop 1
    v_min_u32_dpp v20, v20, v20 row_shr:4 row_mask:0xf bank_mask:0xf
    s_nop 1
    v_min_u32_dpp v20, v20, v20 row_shr:8 row_mask:0xf bank_mask:0xf
    s_nop 1
    v_min_u32_dpp v20, v20, v20 row_bcast:15 row_mask:0xa bank_mask:0xf
    s_nop 1
    v_min_u32_dpp v20, v20, v20 row_bcast:31 row_mask:0xc bank_mask:0xf
    s_nop 0
    v_readlane_b32 s51, v20, 63
    s_sub_u32 s51, s42, s51
    s_sub_u32 s42, s51, 1
    v_sub_u32 v20, s42, v28
    v_sub_u32 v21, s42, v29
    v_sub_u32 v22, s42, v30
    v_min3_u32 v20, v20, v21, v22
    v_sub_u32 v21, s42, v31
    v_sub_u32 v22, s42, v32
    v_min3_u32 v20, v20, v21, v22
    v_sub_u32 v21, s42, v33
    v_sub_u32 v22, s42, v34
    v_min3_u32 v20, v20, v21, v22
    v_sub_u32 v21, s42, v35
    v_min_u32 v20, v20, v21
    s_nop 1
    v_min_u32_dpp v20, v20, v20 row_shr:1 row_mask:0xf bank_mask:0xf
    s_nop 1
    v_min_u32_dpp v20, v20, v20 row_shr:2 row_mask:0xf bank_mask:0xf
    s_nop 1
    v_min_u32_dpp v20, v20, v20 row_shr:4 row_mask:0xf bank_mask:0xf
    s_nop 1
    v_min_u32_dpp v20, v20, v20 row_shr:8 row_mask:0xf bank_mask:0xf
    s_nop 1
    v_min_u32_dpp v20, v20, v20 row_bcast:15 row_mask:0xa bank_mask:0xf
    s_nop 1
    v_min_u32_dpp v20, v20, v20 row_bcast:31 row_mask:0xc bank_mask:0xf
    s_nop 0
    v_readlane_b32 s52, v20, 63
    s_sub_u32 s52, s42, s52
    s_sub_u32 s42, s52, 1
    v_sub_u32 v20, s42, v28
    v_sub_u32 v21, s42, v29
    v_sub_u32 v22, s42, v30
    v_min3_u32 v20, v20, v21, v22
    v_sub_u32 v21, s42, v31
    v_sub_u32 v22, s42, v32
    v_min3_u32 v20, v20, v21, v22
    v_sub_u32 v21, s42, v33
    v_sub_u32 v22, s42, v34
    v_min3_u32 v20, v20, v21, v22
    v_sub_u32 v21, s42, v35
    v_min_u32 v20, v20, v21
    s_nop 1
    v_min_u32_dpp v20, v20, v20 row_shr:1 row_mask:0xf bank_mask:0xf
    s_nop 1
    v_min_u32_dpp v20, v20, v20 row_shr:2 row_mask:0xf bank_mask:0xf
    s_nop 1
    v_min_u32_dpp v20, v20, v20 row_shr:4 row_mask:0xf bank_mask:0xf
    s_nop 1
    v_min_u32_dpp v20, v20, v20 row_shr:8 row_mask:0xf bank_mask:0xf
    s_nop 1
    v_min_u32_dpp v20, v20, v20 row_bcast:15 row_mask:0xa bank_mask:0xf
    s_nop 1
    v_min_u32_dpp v20, v20, v20 row_bcast:31 row_mask:0xc bank_mask:0xf
    s_nop 0
    v_readlane_b32 s53, v20, 63
    s_sub_u32 s53, s42, s53
    s_sub_u32 s42, s53, 1
    v_sub_u32 v20, s42, v28
    v_sub_u32 v21, s42, v29
    v_sub_u32 v22, s42, v30
    v_min3_u32 v20, v20, v21, v22
    v_sub_u32 v21, s42, v31
    v_sub_u32 v22, s42, v32
    v_min3_u32 v20, v20, v21, v22
    v_sub_u32 v21, s42, v33
    v_sub_u32 v22, s42, v34
    v_min3_u32 v20, v20, v21, v22
    v_sub_u32 v21, s42, v35
    v_min_u32 v20, v20, v21
    s_nop 1
    v_min_u32_dpp v20, v20, v20 row_shr:1 row_mask:0xf bank_mask:0xf
    s_nop 1
    v_min_u32_dpp v20, v20, v20 row_shr:2 row_mask:0xf bank_mask:0xf
    s_nop 1
    v_min_u32_dpp v20, v20, v20 row_shr:4 row_mask:0xf bank_mask:0xf
    s_nop 1
    v_min_u32_dpp v20, v20, v20 row_shr:8 row_mask:0xf bank_mask:0xf
    s_nop 1
    v_min_u32_dpp v20, v20, v20 row_bcast:15 row_mask:0xa bank_mask:0xf
    s_nop 1
    v_min_u32_dpp v20, v20, v20 row_bcast:31 row_mask:0xc bank_mask:0xf
    s_nop 0
    v_readlane_b32 s54, v20, 63
    s_sub_u32 s54, s42, s54
    s_sub_u32 s42, s54, 1
    v_sub_u32 v20, s42, v28
    v_sub_u32 v21, s42, v29
    v_sub_u32 v22, s42, v30
    v_min3_u32 v20, v20, v21, v22
    v_sub_u32 v21, s42, v31
    v_sub_u32 v22, s42, v32
    v_min3_u32 v20, v20, v21, v22
    v_sub_u32 v21, s42, v33
    v_sub_u32 v22, s42, v34
    v_min3_u32 v20, v20, v21, v22
    v_sub_u32 v21, s42, v35
    v_min_u32 v20, v20, v21
    s_nop 1
    v_min_u32_dpp v20, v20, v20 row_shr:1 row_mask:0xf bank_mask:0xf
    s_nop 1
    v_min_u32_dpp v20, v20, v20 row_shr:2 row_mask:0xf bank_mask:0xf
    s_nop 1
    v_min_u32_dpp v20, v20, v20 row_shr:4 row_mask:0xf bank_mask:0xf
    s_nop 1
    v_min_u32_dpp v20, v20, v20 row_shr:8 row_mask:0xf bank_mask:0xf
    s_nop 1
    v_min_u32_dpp v20, v20, v20 row_bcast:15 row_mask:0xa bank_mask:0xf
    s_nop 1
    v_min_u32_dpp v20, v20, v20 row_bcast:31 row_mask:0xc bank_mask:0xf
    s_nop 0
    v_readlane_b32 s55, v20, 63
    s_sub_u32 s55, s42, s55
    s_sub_u32 s42, s55, 1
    v_sub_u32 v20, s42, v28
    v_sub_u32 v21, s42, v29
    v_sub_u32 v22, s42, v30
    v_min3_u32 v20, v20, v21, v22
    v_sub_u32 v21, s42, v31
    v_sub_u32 v22, s42, v32
    v_min3_u32 v20, v20, v21, v22
    v_sub_u32 v21, s42, v33
    v_sub_u32 v22, s42, v34
    v_min3_u32 v20, v20, v21, v22
    v_sub_u32 v21, s42, v35
    v_min_u32 v20, v20, v21
    s_nop 1
    v_min_u32_dpp v20, v20, v20 row_shr:1 row_mask:0xf bank_mask:0xf
    s_nop 1
    v_min_u32_dpp v20, v20, v20 row_shr:2 row_mask:0xf bank_mask:0xf
    s_nop 1
    v_min_u32_dpp v20, v20, v20 row_shr:4 row_mask:0xf bank_mask:0xf
    s_nop 1
    v_min_u32_dpp v20, v20, v20 row_shr:8 row_mask:0xf bank_mask:0xf
    s_nop 1
    v_min_u32_dpp v20, v20, v20 row_bcast:15 row_mask:0xa bank_mask:0xf
    s_nop 1
    v_min_u32_dpp v20, v20, v20 row_bcast:31 row_mask:0xc bank_mask:0xf
    s_nop 0
    v_readlane_b32 s56, v20, 63
    s_sub_u32 s56, s42, s56
    s_sub_u32 s42, s56, 1
    v_sub_u32 v20, s42, v28
    v_sub_u32 v21, s42, v29
    v_sub_u32 v22, s42, v30
    v_min3_u32 v20, v20, v21, v22
    v_sub_u32 v21, s42, v31
    v_sub_u32 v22, s42, v32
    v_min3_u32 v20, v20, v21, v22
    v_sub_u32 v21, s42, v33
    v_sub_u32 v22, s42, v34
    v_min3_u32 v20, v20, v21, v22
    v_sub_u32 v21, s42, v35
    v_min_u32 v20, v20, v21
    s_nop 1
    v_min_u32_dpp v20, v20, v20 row_shr:1 row_mask:0xf bank_mask:0xf
    s_nop 1
    v_min_u32_dpp v20, v20, v20 row_shr:2 row_mask:0xf bank_mask:0xf
    s_nop 1
    v_min_u32_dpp v20, v20, v20 row_shr:4 row_mask:0xf bank_mask:0xf
    s_nop 1
    v_min_u32_dpp v20, v20, v20 row_shr:8 row_mask:0xf bank_mask:0xf
    s_nop 1
    v_min_u32_dpp v20, v20, v20 row_bcast:15 row_mask:0xa bank_mask:0xf
    s_nop 1
    v_min_u32_dpp v20, v20, v20 row_bcast:31 row_mask:0xc bank_mask:0xf
    s_nop 0
    v_readlane_b32 s57, v20, 63
    s_sub_u32 s57, s42, s57
    s_sub_u32 s42, s57, 1
    v_mov_b32 v20, s50
    v_writelane_b32 v20, s51, 1
    v_writelane_b32 v20, s52, 2
    v_writelane_b32 v20, s53, 3
    v_writelane_b32 v20, s54, 4
    v_writelane_b32 v20, s55, 5
    v_writelane_b32 v20, s56, 6
    v_writelane_b32 v20, s57, 7
    s_lshl_b32 s42, s5, 8
    s_add_u32 s42, s42, 86016
    v_lshl_add_u32 v21, v19, 2, s42
    ds_write_b32 v21, v20
    s_waitcnt lgkmcnt(0)
    s_branch L_rt_back_local
L_rt_merge:
    v_bfe_u32 v21, v19, 3, 2
    v_lshlrev_b32 v21, 8, v21
    v_and_b32 v20, 7, v19
    v_lshl_add_u32 v21, v20, 2, v21
    v_add_u32 v21, 86016, v21
    ds_read_b32 v20, v21
    s_waitcnt lgkmcnt(0)
    s_mov_b32 s42, -1
    v_sub_u32 v21, s42, v20
    s_nop 1
    v_min_u32_dpp v21, v21, v21 row_shr:1 row_mask:0xf bank_mask:0xf
    s_nop 1
    v_min_u32_dpp v21, v21, v21 row_shr:2 row_mask:0xf bank_mask:0xf
    s_nop 1
    v_min_u32_dpp v21, v21, v21 row_shr:4 row_mask:0xf bank_mask:0xf
    s_nop 1
    v_min_u32_dpp v21, v21, v21 row_shr:8 row_mask:0xf bank_mask:0xf
    s_nop 1
    v_min_u32_dpp v21, v21, v21 row_bcast:15 row_mask:0xa bank_mask:0xf
    s_nop 1
    v_min_u32_dpp v21, v21, v21 row_bcast:31 row_mask:0xc bank_mask:0xf
    s_nop 0
    v_readlane_b32 s50, v21, 63
    s_sub_u32 s50, s42, s50
    s_sub_u32 s42, s50, 1
    v_sub_u32 v21, s42, v20
    s_nop 1
    v_min_u32_dpp v21, v21, v21 row_shr:1 row_mask:0xf bank_mask:0xf
    s_nop 1
    v_min_u32_dpp v21, v21, v21 row_shr:2 row_mask:0xf bank_mask:0xf
    s_nop 1
    v_min_u32_dpp v21, v21, v21 row_shr:4 row_mask:0xf bank_mask:0xf
    s_nop 1
    v_min_u32_dpp v21, v21, v21 row_shr:8 row_mask:0xf bank_mask:0xf
    s_nop 1
    v_min_u32_dpp v21, v21, v21 row_bcast:15 row_mask:0xa bank_mask:0xf
    s_nop 1
    v_min_u32_dpp v21, v21, v21 row_bcast:31 row_mask:0xc bank_mask:0xf
    s_nop 0
    v_readlane_b32 s51, v21, 63
    s_sub_u32 s51, s42, s51
    s_sub_u32 s42, s51, 1
    v_sub_u32 v21, s42, v20
    s_nop 1
    v_min_u32_dpp v21, v21, v21 row_shr:1 row_mask:0xf bank_mask:0xf
    s_nop 1
    v_min_u32_dpp v21, v21, v21 row_shr:2 row_mask:0xf bank_mask:0xf
    s_nop 1
    v_min_u32_dpp v21, v21, v21 row_shr:4 row_mask:0xf bank_mask:0xf
    s_nop 1
    v_min_u32_dpp v21, v21, v21 row_shr:8 row_mask:0xf bank_mask:0xf
    s_nop 1
    v_min_u32_dpp v21, v21, v21 row_bcast:15 row_mask:0xa bank_mask:0xf
    s_nop 1
    v_min_u32_dpp v21, v21, v21 row_bcast:31 row_mask:0xc bank_mask:0xf
    s_nop 0
    v_readlane_b32 s52, v21, 63
    s_sub_u32 s52, s42, s52
    s_sub_u32 s42, s52, 1
    v_sub_u32 v21, s42, v20
    s_nop 1
    v_min_u32_dpp v21, v21, v21 row_shr:1 row_mask:0xf bank_mask:0xf
    s_nop 1
    v_min_u32_dpp v21, v21, v21 row_shr:2 row_mask:0xf bank_mask:0xf
    s_nop 1
    v_min_u32_dpp v21, v21, v21 row_shr:4 row_mask:0xf bank_mask:0xf
    s_nop 1
    v_min_u32_dpp v21, v21, v21 row_shr:8 row_mask:0xf bank_mask:0xf
    s_nop 1
    v_min_u32_dpp v21, v21, v21 row_bcast:15 row_mask:0xa bank_mask:0xf
    s_nop 1
    v_min_u32_dpp v21, v21, v21 row_bcast:31 row_mask:0xc bank_mask:0xf
    s_nop 0
    v_readlane_b32 s53, v21, 63
    s_sub_u32 s53, s42, s53
    s_sub_u32 s42, s53, 1
    v_sub_u32 v21, s42, v20
    s_nop 1
    v_min_u32_dpp v21, v21, v21 row_shr:1 row_mask:0xf bank_mask:0xf
    s_nop 1
    v_min_u32_dpp v21, v21, v21 row_shr:2 row_mask:0xf bank_mask:0xf
    s_nop 1
    v_min_u32_dpp v21, v21, v21 row_shr:4 row_mask:0xf bank_mask:0xf
    s_nop 1
    v_min_u32_dpp v21, v21, v21 row_shr:8 row_mask:0xf bank_mask:0xf
    s_nop 1
    v_min_u32_dpp v21, v21, v21 row_bcast:15 row_mask:0xa bank_mask:0xf
    s_nop 1
    v_min_u32_dpp v21, v21, v21 row_bcast:31 row_mask:0xc bank_mask:0xf
    s_nop 0
    v_readlane_b32 s54, v21, 63
    s_sub_u32 s54, s42, s54
    s_sub_u32 s42, s54, 1
    v_sub_u32 v21, s42, v20
    s_nop 1
    v_min_u32_dpp v21, v21, v21 row_shr:1 row_mask:0xf bank_mask:0xf
    s_nop 1
    v_min_u32_dpp v21, v21, v21 row_shr:2 row_mask:0xf bank_mask:0xf
    s_nop 1
    v_min_u32_dpp v21, v21, v21 row_shr:4 row_mask:0xf bank_mask:0xf
    s_nop 1
    v_min_u32_dpp v21, v21, v21 row_shr:8 row_mask:0xf bank_mask:0xf
    s_nop 1
    v_min_u32_dpp v21, v21, v21 row_bcast:15 row_mask:0xa bank_mask:0xf
    s_nop 1
    v_min_u32_dpp v21, v21, v21 row_bcast:31 row_mask:0xc bank_mask:0xf
    s_nop 0
    v_readlane_b32 s55, v21, 63
    s_sub_u32 s55, s42, s55
    s_sub_u32 s42, s55, 1
    v_sub_u32 v21, s42, v20
    s_nop 1
    v_min_u32_dpp v21, v21, v21 row_shr:1 row_mask:0xf bank_mask:0xf
    s_nop 1
    v_min_u32_dpp v21, v21, v21 row_shr:2 row_mask:0xf bank_mask:0xf
    s_nop 1
    v_min_u32_dpp v21, v21, v21 row_shr:4 row_mask:0xf bank_mask:0xf
    s_nop 1
    v_min_u32_dpp v21, v21, v21 row_shr:8 row_mask:0xf bank_mask:0xf
    s_nop 1
    v_min_u32_dpp v21, v21, v21 row_bcast:15 row_mask:0xa bank_mask:0xf
    s_nop 1
    v_min_u32_dpp v21, v21, v21 row_bcast:31 row_mask:0xc bank_mask:0xf
    s_nop 0
    v_readlane_b32 s56, v21, 63
    s_sub_u32 s56, s42, s56
    s_sub_u32 s42, s56, 1
    v_sub_u32 v21, s42, v20
    s_nop 1
    v_min_u32_dpp v21, v21, v21 row_shr:1 row_mask:0xf bank_mask:0xf
    s_nop 1
    v_min_u32_dpp v21, v21, v21 row_shr:2 row_mask:0xf bank_mask:0xf
    s_nop 1
    v_min_u32_dpp v21, v21, v21 row_shr:4 row_mask:0xf bank_mask:0xf
    s_nop 1
    v_min_u32_dpp v21, v21, v21 row_shr:8 row_mask:0xf bank_mask:0xf
    s_nop 1
    v_min_u32_dpp v21, v21, v21 row_bcast:15 row_mask:0xa bank_mask:0xf
    s_nop 1
    v_min_u32_dpp v21, v21, v21 row_bcast:31 row_mask:0xc bank_mask:0xf
    s_nop 0
    v_readlane_b32 s57, v21, 63
    s_sub_u32 s57, s42, s57
    s_sub_u32 s42, s57, 1
    v_mov_b32 v20, s50
    v_writelane_b32 v20, s51, 1
    v_writelane_b32 v20, s52, 2
    v_writelane_b32 v20, s53, 3
    v_writelane_b32 v20, s54, 4
    v_writelane_b32 v20, s55, 5
    v_writelane_b32 v20, s56, 6
    v_writelane_b32 v20, s57, 7
    v_lshlrev_b32 v21, 2, v19
    s_mov_b32 s42, 0x29b000
    s_mov_b64 exec, 0xff
    buffer_store_dword v20, v21, s[76:79], s42 offen sc1
    s_mov_b64 exec, -1
    s_branch L_rt_back_merge
L_site0:
    s_mov_b32 s43, m0
    s_mov_b32 m0, s38
    s_add_u32 s38, s38, 1024
    buffer_load_dwordx4 v24, s[16:19], s37 offen lds
    s_mov_b32 m0, s43
    s_add_u32 s37, s37, 221184
    s_cmp_eq_u32 s35, 9
    s_cselect_b32 s36, 4, s36
    s_branch L_site_back0
L_site1:
    s_mov_b32 s43, m0
    s_mov_b32 m0, s38
    s_add_u32 s38, s38, 1024
    buffer_load_dwordx4 v24, s[16:19], s37 offen lds
    s_mov_b32 m0, s43
    s_add_u32 s37, s37, 221184
    s_cmp_eq_u32 s35, 9
    s_cselect_b32 s36, 4, s36
    s_branch L_site_back1
L_once_pack:
    s_mov_b64 exec, 1
    buffer_store_dword v27, off, s[76:79], s75 sc1
    s_mov_b64 exec, -1
    s_branch L_once_back_pack
L_site2:
    s_mov_b32 s43, m0
    s_mov_b32 m0, s38
    s_add_u32 s38, s38, 1024
    buffer_load_dwordx4 v24, s[16:19], s37 offen lds
    s_mov_b32 m0, s43
    s_add_u32 s37, s37, 221184
    s_cmp_eq_u32 s35, 9
    s_cselect_b32 s36, 4, s36
    s_branch L_site_back2
L_site3:
    s_mov_b32 s43, m0
    s_mov_b32 m0, s38
    s_add_u32 s38, s38, 1024
    buffer_load_dwordx4 v24, s[16:19], s37 offen lds
    s_mov_b32 m0, s43
    s_add_u32 s37, s37, 221184
    s_cmp_eq_u32 s35, 9
    s_cselect_b32 s36, 4, s36
    s_branch L_site_back3
L_spin_pack:
    s_mov_b32 s7, 262144
L_retry_pack:
    s_sleep 4
    buffer_load_dwordx4 v[28:31], v32, s[76:79], 0 offen sc1
    s_waitcnt vmcnt(0)
    v_min3_u32 v28, v28, v29, v30
    v_min_u32 v28, v28, v31
    v_cmp_gt_u32 vcc, 1, v28
    s_and_b64 vcc, vcc, exec
    s_cbranch_scc0 L_back_pack
    s_sub_u32 s7, s7, 1
    s_cbranch_scc0 L_retry_pack
    s_branch L_back_pack
L_spin_sel:
    s_mov_b32 s7, 262144
L_retry_sel:
    s_sleep 4
    buffer_load_dword v249, v21, s[76:79], 0 offen sc1
    s_waitcnt vmcnt(0)
    v_cmp_eq_u32 vcc, 0, v249
    s_and_b64 vcc, vcc, exec
    s_cbranch_scc0 L_back_sel
    s_sub_u32 s7, s7, 1
    s_cbranch_scc0 L_retry_sel
    s_branch L_back_sel
L_spin_ffn:
    s_mov_b32 s7, 262144
L_retry_ffn:
    s_sleep 4
    buffer_load_dwordx4 v[252:255], v20, s[76:79], 0 offen sc1
    s_waitcnt vmcnt(0)
    v_min3_u32 v252, v252, v253, v254
    v_min_u32 v252, v252, v255
    v_cmp_gt_u32 vcc, 2, v252
    s_and_b64 vcc, vcc, exec
    s_cbranch_scc0 L_back_ffn
    s_sub_u32 s7, s7, 1
    s_cbranch_scc0 L_retry_ffn
    s_branch L_back_ffn
L_spin_o:
    s_mov_b32 s7, 262144
L_retry_o:
    s_sleep 4
    buffer_load_dwordx4 v[158:161], v1, s[76:79], 0 offen sc1
    s_waitcnt vmcnt(0)
    v_min3_u32 v158, v158, v159, v160
    v_min_u32 v158, v158, v161
    v_cmp_gt_u32 vcc, 1, v158
    s_and_b64 vcc, vcc, exec
    s_cbranch_scc0 L_back_o
    s_sub_u32 s7, s7, 1
    s_cbranch_scc0 L_retry_o
    s_branch L_back_o
L_spin_upd:
    s_mov_b32 s7, 262144
L_retry_upd:
    s_sleep 4
    buffer_load_dwordx2 v[20:21], v11, s[76:79], 0 offen offset:0 sc1
    buffer_load_dwordx2 v[246:247], v11, s[76:79], 0 offen offset:32 sc1
    buffer_load_dwordx2 v[248:249], v11, s[76:79], 0 offen offset:64 sc1
    buffer_load_dwordx2 v[252:253], v11, s[76:79], 0 offen offset:96 sc1
    buffer_load_dwordx2 v[254:255], v11, s[76:79], 0 offen offset:128 sc1
    s_waitcnt vmcnt(0)
    v_max3_u32 v1, v20, v21, v246
    v_max3_u32 v1, v1, v247, v248
    v_max3_u32 v1, v1, v249, v252
    v_max3_u32 v1, v1, v253, v254
    v_max_u32 v1, v1, v255
    v_cmp_eq_u32 vcc, -1, v1
    s_and_b64 vcc, vcc, exec
    s_cbranch_scc0 L_back_upd
    s_sub_u32 s7, s7, 1
    s_cbranch_scc0 L_retry_upd
    s_branch L_back_upd
L_spin_half:
    s_mov_b32 s7, 262144
L_retry_half:
    s_sleep 4
    buffer_load_dword v1, off, s[76:79], s37 sc1
    s_waitcnt vmcnt(0)
    v_cmp_ne_u32 vcc, 3, v1
    s_and_b64 vcc, vcc, exec
    s_cbranch_scc0 L_back_half
    s_sub_u32 s7, s7, 1
    s_cbranch_scc0 L_retry_half
    s_branch L_back_half
L_code_end:
    s_endpgm

.section .rodata,"a"
.p2align 6
.amdhsa_kernel recurrent_scan__mha_block_cached__moe_arch_mod__prompt_kernel
  .amdhsa_next_free_vgpr 512
  .amdhsa_next_free_sgpr 102
  .amdhsa_accum_offset 256
  .amdhsa_group_segment_fixed_size 0
  .amdhsa_kernarg_size 104
  .amdhsa_user_sgpr_count 2
  .amdhsa_user_sgpr_kernarg_segment_ptr 1
  .amdhsa_system_sgpr_workgroup_id_x 1
  .amdhsa_float_denorm_mode_32 3
.end_amdhsa_kernel
```

```asm
; @launch grid=(256,1,1) block=(256,1,1) lds=163840
.amdgcn_target "amdgcn-amd-amdhsa--gfx950"
.text
.globl recurrent_scan__mha_block_cached__moe_arch_mod__prompt_kernel
.p2align 8
.type recurrent_scan__mha_block_cached__moe_arch_mod__prompt_kernel,@function
recurrent_scan__mha_block_cached__moe_arch_mod__prompt_kernel:
    s_cmp_ge_u32 s2, 256
    s_cbranch_scc1 L_end
    s_load_dwordx16 s[48:63], s[0:1], 0
    s_load_dwordx8 s[64:71], s[0:1], 64
    s_load_dwordx2 s[72:73], s[0:1], 96
    s_getpc_b64 s[40:41]
L_touch:
    s_bfe_u32 s42, s2, 0x20003
    s_lshl_b32 s42, s42, 8
    v_add_u32 v252, s42, v0
    v_min_u32 v252, (L_code_end - L_touch) / 128, v252
    v_lshlrev_b32 v252, 7, v252
    global_load_dword a120, v252, s[40:41]
    v_lshrrev_b32 v116, 6, v0
    v_and_b32 v19, 63, v0
    s_and_b32 s40, s2, 7
    v_readfirstlane_b32 s5, v116
    s_lshl_b32 s40, s40, 2
    s_bfe_u32 s41, s2, 0x20003
    s_add_u32 s3, s40, s41
    s_lshr_b32 s4, s2, 5
    s_lshl_b32 s74, s4, 5
    s_add_u32 s6, s74, s3
    v_lshrrev_b32 v118, 4, v19
    v_and_b32 v117, 15, v19
    v_lshlrev_b32 v119, 1, v118
    v_xor_b32 v119, v117, v119
    s_lshl_b32 s42, s5, 4
    v_add_u32 v120, s42, v118
    v_lshlrev_b32 v121, 4, v119
    v_xor_b32 v122, 0x80, v121
    v_lshl_add_u32 v123, v120, 13, v121
    v_lshl_add_u32 v116, v120, 13, v122
    v_add_u32 v44, 0, v123
    v_add_u32 v45, 31744, v123
    v_add_u32 v46, 63488, v116
    v_add_u32 v47, 95232, v116
    v_lshl_add_u32 v17, v120, 8, v121
    v_lshl_add_u32 v18, v120, 8, v122
    v_xor_b32 v117, v117, v118
    v_xor_b32 v121, 0, v117
    v_lshlrev_b32 v121, 4, v121
    v_lshl_add_u32 v13, v120, 8, v121
    v_xor_b32 v121, 4, v117
    v_lshlrev_b32 v121, 4, v121
    v_lshl_add_u32 v14, v120, 8, v121
    v_xor_b32 v121, 8, v117
    v_lshlrev_b32 v121, 4, v121
    v_lshl_add_u32 v15, v120, 8, v121
    v_xor_b32 v121, 12, v117
    v_lshlrev_b32 v121, 4, v121
    v_lshl_add_u32 v16, v120, 8, v121
    v_lshrrev_b32 v116, 3, v19
    v_and_b32 v117, 7, v19
    v_xor_b32 v117, v117, v118
    v_mul_u32_u24 v116, 1280, v116
    s_mul_i32 s42, s5, 81920
    v_lshl_add_u32 v119, v117, 4, v116
    v_xor_b32 v117, 4, v117
    v_lshl_add_u32 v120, v117, 4, v116
    v_add_u32 v119, s42, v119
    v_add_u32 v120, s42, v120
    v_add_u32 v36, 0, v119
    v_add_u32 v37, 9216, v120
    v_add_u32 v38, 18432, v119
    v_add_u32 v39, 27648, v120
    v_add_u32 v40, 40960, v119
    v_add_u32 v41, 50176, v120
    v_add_u32 v42, 59392, v119
    v_add_u32 v43, 68608, v120
    s_lshl_b32 s43, s6, 2
    s_add_u32 s43, s43, s5
    s_lshl_b32 s43, s43, 1
    s_mul_i32 s38, s5, 24576
    s_lshl_b32 s40, s5, 12
    s_add_u32 s39, s40, 98304
    s_mov_b32 s34, s39
    s_mov_b32 s28, 0
    s_mov_b32 s29, 0
    s_and_b32 s40, s3, 31
    s_mul_i32 s40, s40, 10
    s_lshr_b32 s40, s40, 5
    s_lshl_b32 s36, s40, 7
    s_waitcnt lgkmcnt(0)
    s_mov_b32 s88, s48
    s_mov_b32 s89, s49
    s_mov_b32 s90, 0x280000
    s_mov_b32 s91, 0x20000
    s_mov_b32 s92, s60
    s_mov_b32 s93, s61
    s_mov_b32 s94, 0x500
    s_mov_b32 s95, 0x20000
    s_lshl_b32 s40, s3, 8
    s_add_u32 s20, s54, s40
    s_addc_u32 s21, s55, 0
    s_mov_b32 s22, 0x4fe100
    s_mov_b32 s23, 0x20000
    s_mul_i32 s40, s4, 327680
    s_add_u32 s16, s48, s40
    s_addc_u32 s17, s49, 0
    s_mov_b32 s18, 0x50000
    s_mov_b32 s19, 0x20000
    s_add_u32 m0, s39, 0
    s_mov_b32 s37, 0
    buffer_load_dwordx4 v44, s[20:23], s37 offen offset:0 lds
    buffer_load_dwordx4 v45, s[20:23], s37 offen offset:1024 lds
    buffer_load_dwordx4 v46, s[20:23], s37 offen offset:2048 lds
    buffer_load_dwordx4 v47, s[20:23], s37 offen offset:3072 lds
    s_add_u32 m0, s38, 0
    s_mov_b32 s36, 0
    buffer_load_dwordx4 v36, s[16:19], s36 offen offset:0 lds
    buffer_load_dwordx4 v37, s[16:19], s36 offen offset:1024 lds
    buffer_load_dwordx4 v38, s[16:19], s36 offen offset:2048 lds
    buffer_load_dwordx4 v39, s[16:19], s36 offen offset:3072 lds
    s_add_u32 m0, s38, 4096
    s_nop 0
    buffer_load_dwordx4 v40, s[16:19], s36 offen offset:0 lds
    buffer_load_dwordx4 v41, s[16:19], s36 offen offset:1024 lds
    buffer_load_dwordx4 v42, s[16:19], s36 offen offset:2048 lds
    buffer_load_dwordx4 v43, s[16:19], s36 offen offset:3072 lds
    v_lshrrev_b32 v108, 5, v19
    v_add_u32 v108, s43, v108
    v_and_b32 v110, 31, v19
    v_lshlrev_b32 v110, 3, v110
    v_mul_u32_u24 v109, 1280, v108
    v_add_u32 v109, v109, v110
    buffer_load_dwordx2 v[60:61], v109, s[88:91], 0 offen offset:0
    buffer_load_dwordx2 v[62:63], v109, s[88:91], 0 offen offset:256
    buffer_load_dwordx2 v[64:65], v109, s[88:91], 0 offen offset:512
    buffer_load_dwordx2 v[66:67], v109, s[88:91], 0 offen offset:768
    buffer_load_dwordx2 v[68:69], v109, s[88:91], 0 offen offset:1024
    buffer_load_dwordx2 v[70:71], v110, s[92:95], 0 offen offset:0
    buffer_load_dwordx2 v[72:73], v110, s[92:95], 0 offen offset:256
    buffer_load_dwordx2 v[74:75], v110, s[92:95], 0 offen offset:512
    buffer_load_dwordx2 v[76:77], v110, s[92:95], 0 offen offset:768
    buffer_load_dwordx2 v[78:79], v110, s[92:95], 0 offen offset:1024
    s_lshl_b32 s40, s3, 19
    s_add_u32 s8, s50, s40
    s_addc_u32 s9, s51, 0
    s_mov_b32 s10, 0x80000
    s_mov_b32 s11, 0x20000
    s_add_u32 s12, s52, s40
    s_addc_u32 s13, s53, 0
    s_mov_b32 s14, 0x80000
    s_mov_b32 s15, 0x20000
    s_and_b32 s40, s5, 1
    s_lshl_b32 s40, s40, 12
    s_cmp_ge_u32 s5, 2
    s_cselect_b32 s30, 32, 8
    s_cselect_b32 s31, 40, 16
    s_cselect_b32 s32, 0, 56
    s_cselect_b32 s33, 48, 24
    s_lshl_b32 s30, s30, 10
    s_add_u32 s30, s30, s40
    s_lshl_b32 s31, s31, 10
    s_add_u32 s31, s31, s40
    s_lshl_b32 s32, s32, 10
    s_add_u32 s32, s32, s40
    s_lshl_b32 s33, s33, 10
    s_add_u32 s33, s33, s40
    s_mov_b32 s44, 0x3e0293ee
    s_mov_b32 s45, 4096
    s_mov_b32 s76, s72
    s_mov_b32 s77, s73
    s_mov_b32 s78, 0x2500000
    s_mov_b32 s79, 0x20000
    s_mov_b32 s92, s70
    s_mov_b32 s93, s71
    s_mov_b32 s94, 0x100
    s_mov_b32 s95, 0x20000
    s_lshl_b32 s41, s4, 2
    s_add_u32 s41, s41, s5
    s_lshl_b32 s40, s41, 5
    s_add_u32 s40, s40, s3
    s_lshl_b32 s40, s40, 14
    s_add_u32 s40, s40, 0x400000
    s_add_u32 s24, s72, s40
    s_addc_u32 s25, s73, 0
    s_mov_b32 s26, 0x4000
    s_mov_b32 s27, 0x20000
    s_and_b32 s42, s3, 3
    s_lshl_b32 s42, s42, 2
    s_lshr_b32 s40, s6, 2
    s_lshl_b32 s40, s40, 7
    s_add_u32 s40, s40, s42
    s_add_u32 s75, s40, 0x290000
    s_lshr_b32 s40, s3, 2
    s_lshl_b32 s40, s40, 7
    s_add_u32 s40, s40, s42
    s_lshl_b32 s42, s41, 10
    s_add_u32 s40, s40, s42
    s_add_u32 s58, s40, 0x292000
    s_lshl_b32 s41, s41, 10
    s_add_u32 s46, s41, 0x280000
    v_lshrrev_b32 v116, 4, v19
    v_and_b32 v117, 15, v19
    v_lshlrev_b32 v59, 4, v117
    v_xor_b32 v118, v116, v117
    v_lshlrev_b32 v119, 8, v117
    v_add_u32 v119, 98304, v119
    s_add_u32 s41, s5, 0
    s_and_b32 s41, s41, 3
    s_lshl_b32 s41, s41, 2
    v_xor_b32 v120, s41, v118
    v_lshl_add_u32 v1, v120, 4, v119
    s_add_u32 s41, s5, 1
    s_and_b32 s41, s41, 3
    s_lshl_b32 s41, s41, 2
    v_xor_b32 v120, s41, v118
    v_lshl_add_u32 v2, v120, 4, v119
    s_add_u32 s41, s5, 2
    s_and_b32 s41, s41, 3
    s_lshl_b32 s41, s41, 2
    v_xor_b32 v120, s41, v118
    v_lshl_add_u32 v3, v120, 4, v119
    s_add_u32 s41, s5, 3
    s_and_b32 s41, s41, 3
    s_lshl_b32 s41, s41, 2
    v_xor_b32 v120, s41, v118
    v_lshl_add_u32 v4, v120, 4, v119
    v_lshrrev_b32 v118, 1, v117
    v_xor_b32 v118, v116, v118
    v_lshlrev_b32 v119, 7, v117
    v_add_u32 v119, s38, v119
    v_xor_b32 v120, 0, v118
    v_lshl_add_u32 v48, v120, 4, v119
    v_xor_b32 v120, 4, v118
    v_lshl_add_u32 v49, v120, 4, v119
    v_bfe_u32 v118, v19, 2, 2
    v_bfe_u32 v119, v19, 2, 3
    v_and_b32 v120, 3, v19
    v_lshlrev_b32 v120, 3, v120
    v_lshl_add_u32 v121, v116, 2, v118
    v_lshl_add_u32 v121, v121, 8, v120
    v_lshl_add_u32 v122, v116, 3, v118
    v_lshl_add_u32 v122, v122, 8, v120
    v_add_u32 v122, 98304, v122
    v_xor_b32 v123, 0, v119
    v_lshl_add_u32 v5, v123, 5, v121
    v_xor_b32 v123, 1, v119
    v_lshl_add_u32 v6, v123, 5, v121
    v_xor_b32 v123, 2, v119
    v_lshl_add_u32 v7, v123, 5, v121
    v_xor_b32 v123, 3, v119
    v_lshl_add_u32 v8, v123, 5, v121
    v_xor_b32 v123, 4, v119
    v_lshl_add_u32 v9, v123, 5, v121
    v_xor_b32 v123, 5, v119
    v_lshl_add_u32 v10, v123, 5, v121
    v_xor_b32 v123, 6, v119
    v_lshl_add_u32 v11, v123, 5, v121
    v_xor_b32 v123, 7, v119
    v_lshl_add_u32 v12, v123, 5, v121
    s_lshl_b32 s42, s5, 1
    s_add_u32 s41, s42, 0
    s_and_b32 s41, s41, 7
    v_xor_b32 v123, s41, v119
    v_lshl_add_u32 v50, v123, 5, v122
    s_add_u32 s41, s42, 1
    s_and_b32 s41, s41, 7
    v_xor_b32 v123, s41, v119
    v_lshl_add_u32 v51, v123, 5, v122
    s_add_u32 s41, s42, 2
    s_and_b32 s41, s41, 7
    v_xor_b32 v123, s41, v119
    v_lshl_add_u32 v52, v123, 5, v122
    s_add_u32 s41, s42, 3
    s_and_b32 s41, s41, 7
    v_xor_b32 v123, s41, v119
    v_lshl_add_u32 v53, v123, 5, v122
    s_add_u32 s41, s42, 4
    s_and_b32 s41, s41, 7
    v_xor_b32 v123, s41, v119
    v_lshl_add_u32 v54, v123, 5, v122
    s_add_u32 s41, s42, 5
    s_and_b32 s41, s41, 7
    v_xor_b32 v123, s41, v119
    v_lshl_add_u32 v55, v123, 5, v122
    s_add_u32 s41, s42, 6
    s_and_b32 s41, s41, 7
    v_xor_b32 v123, s41, v119
    v_lshl_add_u32 v56, v123, 5, v122
    s_add_u32 s41, s42, 7
    s_and_b32 s41, s41, 7
    v_xor_b32 v123, s41, v119
    v_lshl_add_u32 v57, v123, 5, v122
    s_lshl_b32 s41, s5, 7
    s_add_u32 s41, s41, 86016
    v_lshl_add_u32 v58, v116, 4, s41
    v_mov_b32 v32, 0x3f803f80
    v_mov_b32 v33, 0x3f803f80
    v_mov_b32 v34, 0x3f803f80
    v_mov_b32 v35, 0x3f803f80
    v_and_b32 v120, 1, v19
    v_cmp_eq_u32 vcc, 0, v120
    v_mov_b32 v121, 0x44444444
    v_mov_b32 v122, 0xeeeeeeee
    v_cndmask_b32 v248, v122, v121, vcc
    v_and_b32 v120, 2, v19
    v_cmp_eq_u32 vcc, 0, v120
    v_mov_b32 v27, 1
    v_mov_b32 v28, 0
    v_cndmask_b32 v244, 0, v32, vcc
    v_cndmask_b32 v245, 0, v32, vcc
    v_cndmask_b32 v246, 0, v32, vcc
    v_cndmask_b32 v247, 0, v32, vcc
    v_accvgpr_write_b32 a224, 0
    v_accvgpr_write_b32 a225, 0
    v_accvgpr_write_b32 a226, 0
    v_accvgpr_write_b32 a227, 0
    v_accvgpr_write_b32 a228, 0
    v_accvgpr_write_b32 a229, 0
    v_accvgpr_write_b32 a230, 0
    v_accvgpr_write_b32 a231, 0
    v_accvgpr_write_b32 a232, 0
    v_accvgpr_write_b32 a233, 0
    v_accvgpr_write_b32 a234, 0
    v_accvgpr_write_b32 a235, 0
    v_accvgpr_write_b32 a236, 0
    v_accvgpr_write_b32 a237, 0
    v_accvgpr_write_b32 a238, 0
    v_accvgpr_write_b32 a239, 0
    s_mul_i32 s47, s5, 5120
    s_mov_b32 s96, s56
    s_mov_b32 s97, s57
    s_mov_b32 s98, 0x500000
    s_mov_b32 s99, 0x20000
    s_lshr_b32 s40, s6, 1
    s_and_b32 s41, s6, 1
    s_lshl_b32 s41, s41, 2
    s_add_u32 s41, s41, s5
    s_add_u32 s47, s47, 65536
    s_mul_i32 s42, s40, 40960
    s_mul_i32 s43, s41, 160
    s_add_u32 s42, s42, s43
    v_add_u32 v25, 0, v19
    v_mul_u32_u24 v26, 6554, v25
    v_lshrrev_b32 v26, 16, v26
    v_mul_u32_u24 v20, 1120, v26
    v_lshl_add_u32 v20, v25, 4, v20
    v_add_u32 v20, s42, v20
    v_add_u32 v25, 64, v19
    v_mul_u32_u24 v26, 6554, v25
    v_lshrrev_b32 v26, 16, v26
    v_mul_u32_u24 v21, 1120, v26
    v_lshl_add_u32 v21, v25, 4, v21
    v_add_u32 v21, s42, v21
    v_add_u32 v25, 128, v19
    v_mul_u32_u24 v26, 6554, v25
    v_lshrrev_b32 v26, 16, v26
    v_mul_u32_u24 v22, 1120, v26
    v_lshl_add_u32 v22, v25, 4, v22
    v_add_u32 v22, s42, v22
    v_add_u32 v25, 192, v19
    v_mul_u32_u24 v26, 6554, v25
    v_lshrrev_b32 v26, 16, v26
    v_mul_u32_u24 v23, 1120, v26
    v_lshl_add_u32 v23, v25, 4, v23
    v_add_u32 v23, s42, v23
    v_add_u32 v25, 256, v19
    v_mul_u32_u24 v26, 6554, v25
    v_lshrrev_b32 v26, 16, v26
    v_mul_u32_u24 v24, 1120, v26
    v_lshl_add_u32 v24, v25, 4, v24
    v_add_u32 v24, s42, v24
    v_lshrrev_b32 v25, 2, v19
    v_mul_u32_u24 v25, 160, v25
    v_and_b32 v26, 3, v19
    v_lshl_add_u32 v25, v26, 3, v25
    v_add_u32 v25, s47, v25
    s_lshl_b32 s42, s41, 7
    s_add_u32 s42, s42, s40
    s_mul_i32 s42, s42, 5120
    s_add_u32 s42, s42, 0x1400000
    v_lshlrev_b32 v26, 4, v19
    v_add_u32 v26, s42, v26
    s_add_u32 m0, s39, 16384
    s_mov_b32 s37, 524288
    buffer_load_dwordx4 v44, s[20:23], s37 offen offset:0 lds
    buffer_load_dwordx4 v45, s[20:23], s37 offen offset:1024 lds
    buffer_load_dwordx4 v46, s[20:23], s37 offen offset:2048 lds
    buffer_load_dwordx4 v47, s[20:23], s37 offen offset:3072 lds
    s_add_u32 m0, s38, 8192
    s_mov_b32 s36, 128
    buffer_load_dwordx4 v36, s[16:19], s36 offen offset:0 lds
    buffer_load_dwordx4 v37, s[16:19], s36 offen offset:1024 lds
    buffer_load_dwordx4 v38, s[16:19], s36 offen offset:2048 lds
    buffer_load_dwordx4 v39, s[16:19], s36 offen offset:3072 lds
    s_add_u32 m0, s38, 12288
    s_nop 0
    buffer_load_dwordx4 v40, s[16:19], s36 offen offset:0 lds
    buffer_load_dwordx4 v41, s[16:19], s36 offen offset:1024 lds
    buffer_load_dwordx4 v42, s[16:19], s36 offen offset:2048 lds
    buffer_load_dwordx4 v43, s[16:19], s36 offen offset:3072 lds
    s_add_u32 m0, s39, 32768
    s_mov_b32 s37, 1048576
    buffer_load_dwordx4 v44, s[20:23], s37 offen offset:0 lds
    buffer_load_dwordx4 v45, s[20:23], s37 offen offset:1024 lds
    buffer_load_dwordx4 v46, s[20:23], s37 offen offset:2048 lds
    buffer_load_dwordx4 v47, s[20:23], s37 offen offset:3072 lds
    s_waitcnt vmcnt(26)
    s_barrier
    ds_read_b64_tr_b16 a[0:1], v50 offset:0
    ds_read_b64_tr_b16 a[2:3], v50 offset:1024
    ds_read_b128 a[32:35], v48 offset:0
    ds_read_b128 a[36:39], v48 offset:2048
    ds_read_b128 a[40:43], v48 offset:4096
    ds_read_b128 a[44:47], v48 offset:6144
    ds_read_b64_tr_b16 a[4:5], v51 offset:0
    ds_read_b64_tr_b16 a[6:7], v51 offset:1024
    ds_read_b64_tr_b16 a[8:9], v52 offset:0
    ds_read_b64_tr_b16 a[10:11], v52 offset:1024
    ds_read_b64_tr_b16 a[12:13], v53 offset:0
    ds_read_b64_tr_b16 a[14:15], v53 offset:1024
    ds_read_b64_tr_b16 a[16:17], v54 offset:0
    ds_read_b64_tr_b16 a[18:19], v54 offset:1024
    ds_read_b64_tr_b16 a[20:21], v55 offset:0
    ds_read_b64_tr_b16 a[22:23], v55 offset:1024
    ds_read_b64_tr_b16 a[24:25], v56 offset:0
    ds_read_b64_tr_b16 a[26:27], v56 offset:1024
    ds_read_b64_tr_b16 a[28:29], v57 offset:0
    ds_read_b64_tr_b16 a[30:31], v57 offset:1024
    s_waitcnt lgkmcnt(0)
    v_mfma_f32_16x16x32_bf16 v[100:103], a[0:3], v[32:35], 0
    s_waitcnt vmcnt(16)
    ds_read_b64_tr_b16 a[48:49], v50 offset:8192
    v_mfma_f32_16x16x32_bf16 v[104:107], a[4:7], v[32:35], 0
    s_add_u32 m0, s38, 16384
    s_mov_b32 s36, 256
    ds_read_b64_tr_b16 a[50:51], v50 offset:9216
    v_mfma_f32_16x16x32_bf16 v[116:119], a[0:3], a[32:35], 0
    s_lshl_b32 s40, s6, 7
    buffer_load_dwordx4 v36, s[16:19], s36 offen offset:0 lds
    v_mfma_f32_16x16x32_bf16 v[148:151], a[0:3], a[36:39], 0
    s_add_u32 s41, s40, 0x292000
    ds_read_b128 a[80:83], v49 offset:0
    v_mfma_f32_16x16x32_bf16 v[180:183], a[0:3], a[40:43], 0
    s_add_u32 s40, s40, 0x290000
    ds_read_b128 a[84:87], v49 offset:2048
    v_mfma_f32_16x16x32_bf16 v[212:215], a[0:3], a[44:47], 0
    s_cmp_lt_u32 s6, 64
    s_cselect_b32 s40, s40, 0x2500000
    buffer_load_dwordx4 v37, s[16:19], s36 offen offset:1024 lds
    v_mfma_f32_16x16x32_bf16 v[216:219], a[4:7], a[44:47], 0
    s_cmp_eq_u32 s5, 1
    s_cselect_b32 s40, s40, 0x2500000
    ds_read_b128 a[88:91], v49 offset:4096
    v_mfma_f32_16x16x32_bf16 v[184:187], a[4:7], a[40:43], 0
    s_cmp_eq_u32 s5, 0
    s_cselect_b32 s40, s41, s40
    ds_read_b128 a[92:95], v49 offset:6144
    v_mfma_f32_16x16x32_bf16 v[152:155], a[4:7], a[36:39], 0
    s_add_u32 s41, s41, 0xe000
    ds_read_b64_tr_b16 a[52:53], v51 offset:8192
    v_mfma_f32_16x16x32_bf16 v[120:123], a[4:7], a[32:35], 0
    s_cmp_eq_u32 s5, 3
    s_cselect_b32 s40, s41, s40
    buffer_load_dwordx4 v38, s[16:19], s36 offen offset:2048 lds
    v_mfma_f32_16x16x32_bf16 v[124:127], a[8:11], a[32:35], 0
    s_lshl_b32 s41, s6, 2
    ds_read_b64_tr_b16 a[54:55], v51 offset:9216
    v_mfma_f32_16x16x32_bf16 v[156:159], a[8:11], a[36:39], 0
    s_add_u32 s41, s41, s5
    ds_read_b64_tr_b16 a[56:57], v52 offset:8192
    v_mfma_f32_16x16x32_bf16 v[188:191], a[8:11], a[40:43], 0
    s_cmp_eq_u32 s41, 962
    s_cselect_b32 s40, 0x29b000, s40
    ds_read_b64_tr_b16 a[58:59], v52 offset:9216
    v_mfma_f32_16x16x32_bf16 v[220:223], a[8:11], a[44:47], 0
    s_lshl_b32 s41, s6, 7
    buffer_load_dwordx4 v39, s[16:19], s36 offen offset:3072 lds
    v_mfma_f32_16x16x32_bf16 v[224:227], a[12:15], a[44:47], 0
    s_add_u32 s41, s41, 0x29c000
    ds_read_b64_tr_b16 a[60:61], v53 offset:8192
    v_mfma_f32_16x16x32_bf16 v[192:195], a[12:15], a[40:43], 0
    s_xor_b32 s42, s5, 2
    ds_read_b64_tr_b16 a[62:63], v53 offset:9216
    v_mfma_f32_16x16x32_bf16 v[160:163], a[12:15], a[36:39], 0
    s_add_u32 m0, s38, 20480
    ds_read_b64_tr_b16 a[64:65], v54 offset:8192
    v_mfma_f32_16x16x32_bf16 v[128:131], a[12:15], a[32:35], 0
    s_lshl_b32 s42, s42, 8
    buffer_load_dwordx4 v40, s[16:19], s36 offen offset:0 lds
    v_mfma_f32_16x16x32_bf16 v[132:135], a[16:19], a[32:35], 0
    s_add_u32 s42, s42, s6
    ds_read_b64_tr_b16 a[66:67], v54 offset:9216
    v_mfma_f32_16x16x32_bf16 v[164:167], a[16:19], a[36:39], 0
    s_cmp_lt_u32 s42, 80
    s_cselect_b32 s40, s41, s40
    s_cselect_b32 s41, -1, 0
    ds_read_b64_tr_b16 a[68:69], v55 offset:8192
    v_mov_b32 v28, s41
    v_lshlrev_b32 v29, 2, v19
    v_mfma_f32_16x16x32_bf16 v[196:199], a[16:19], a[40:43], 0
    buffer_load_dwordx4 v41, s[16:19], s36 offen offset:1024 lds
    s_mov_b32 exec_hi, 0
    buffer_store_dword v28, v29, s[76:79], s40 offen sc1
    s_mov_b32 exec_hi, -1
    v_lshlrev_b32 v80, 16, v60
    v_and_b32 v81, 0xffff0000, v60
    v_lshlrev_b32 v82, 16, v61
    v_and_b32 v83, 0xffff0000, v61
    v_lshlrev_b32 v84, 16, v62
    v_and_b32 v85, 0xffff0000, v62
    v_mfma_f32_16x16x32_bf16 v[228:231], a[16:19], a[44:47], 0
    ds_read_b64_tr_b16 a[70:71], v55 offset:9216
    v_lshlrev_b32 v86, 16, v63
    v_mfma_f32_16x16x32_bf16 v[232:235], a[20:23], a[44:47], 0
    ds_read_b64_tr_b16 a[72:73], v56 offset:8192
    v_and_b32 v87, 0xffff0000, v63
    v_lshlrev_b32 v88, 16, v64
    v_mfma_f32_16x16x32_bf16 v[200:203], a[20:23], a[40:43], 0
    ds_read_b64_tr_b16 a[74:75], v56 offset:9216
    v_and_b32 v89, 0xffff0000, v64
    v_mfma_f32_16x16x32_bf16 v[168:171], a[20:23], a[36:39], 0
    buffer_load_dwordx4 v42, s[16:19], s36 offen offset:2048 lds
    v_lshlrev_b32 v90, 16, v65
    v_mfma_f32_16x16x32_bf16 v[136:139], a[20:23], a[32:35], 0
    ds_read_b64_tr_b16 a[76:77], v57 offset:8192
    v_and_b32 v91, 0xffff0000, v65
    v_lshlrev_b32 v92, 16, v66
    v_mfma_f32_16x16x32_bf16 v[140:143], a[24:27], a[32:35], 0
    ds_read_b64_tr_b16 a[78:79], v57 offset:9216
    v_and_b32 v93, 0xffff0000, v66
    v_mfma_f32_16x16x32_bf16 v[172:175], a[24:27], a[36:39], 0
    v_lshlrev_b32 v94, 16, v67
    v_and_b32 v95, 0xffff0000, v67
    v_mfma_f32_16x16x32_bf16 v[204:207], a[24:27], a[40:43], 0
    buffer_load_dwordx4 v43, s[16:19], s36 offen offset:3072 lds
    v_lshlrev_b32 v96, 16, v68
    v_mfma_f32_16x16x32_bf16 v[236:239], a[24:27], a[44:47], 0
    v_and_b32 v97, 0xffff0000, v68
    v_lshlrev_b32 v98, 16, v69
    v_mfma_f32_16x16x32_bf16 v[240:243], a[28:31], a[44:47], 0
    v_and_b32 v99, 0xffff0000, v69
    v_add_f32 v109, v80, v81
    v_mfma_f32_16x16x32_bf16 v[208:211], a[28:31], a[40:43], 0
    v_add_f32 v110, v82, v83
    v_add_f32 v109, v109, v84
    v_mfma_f32_16x16x32_bf16 v[176:179], a[28:31], a[36:39], 0
    v_add_f32 v110, v110, v85
    v_add_f32 v109, v109, v86
    v_mfma_f32_16x16x32_bf16 v[144:147], a[28:31], a[32:35], 0
    v_add_f32 v110, v110, v87
    v_add_f32 v109, v109, v88
    s_waitcnt vmcnt(13) lgkmcnt(0)
    s_barrier
    v_mfma_f32_16x16x32_bf16 v[100:103], a[48:51], v[32:35], v[100:103]
    ds_read_b64_tr_b16 a[0:1], v50 offset:16384
    v_add_f32 v110, v110, v89
    v_mfma_f32_16x16x32_bf16 v[104:107], a[52:55], v[32:35], v[104:107]
    s_add_u32 m0, s39, 0
    s_mov_b32 s37, 1572864
    ds_read_b64_tr_b16 a[2:3], v50 offset:17408
    v_add_f32 v109, v109, v90
    v_mfma_f32_16x16x32_bf16 v[116:119], a[48:51], a[80:83], v[116:119]
    buffer_load_dwordx4 v44, s[20:23], s37 offen offset:0 lds
    v_mfma_f32_16x16x32_bf16 v[148:151], a[48:51], a[84:87], v[148:151]
    ds_read_b128 a[32:35], v48 offset:8192
    v_add_f32 v110, v110, v91
    v_mfma_f32_16x16x32_bf16 v[180:183], a[48:51], a[88:91], v[180:183]
    ds_read_b128 a[36:39], v48 offset:10240
    v_add_f32 v109, v109, v92
    v_mfma_f32_16x16x32_bf16 v[212:215], a[48:51], a[92:95], v[212:215]
    ds_read_b128 a[40:43], v48 offset:12288
    v_add_f32 v110, v110, v93
    v_mfma_f32_16x16x32_bf16 v[216:219], a[52:55], a[92:95], v[216:219]
    ds_read_b128 a[44:47], v48 offset:14336
    v_add_f32 v109, v109, v94
    v_mfma_f32_16x16x32_bf16 v[184:187], a[52:55], a[88:91], v[184:187]
    buffer_load_dwordx4 v45, s[20:23], s37 offen offset:1024 lds
    v_add_f32 v110, v110, v95
    v_mfma_f32_16x16x32_bf16 v[152:155], a[52:55], a[84:87], v[152:155]
    ds_read_b64_tr_b16 a[4:5], v51 offset:16384
    v_add_f32 v109, v109, v96
    v_add_f32 v110, v110, v97
    v_mfma_f32_16x16x32_bf16 v[120:123], a[52:55], a[80:83], v[120:123]
    ds_read_b64_tr_b16 a[6:7], v51 offset:17408
    v_add_f32 v109, v109, v98
    v_mfma_f32_16x16x32_bf16 v[124:127], a[56:59], a[80:83], v[124:127]
    ds_read_b64_tr_b16 a[8:9], v52 offset:16384
    v_add_f32 v110, v110, v99
    v_mfma_f32_16x16x32_bf16 v[156:159], a[56:59], a[84:87], v[156:159]
    ds_read_b64_tr_b16 a[10:11], v52 offset:17408
    v_add_f32 v109, v109, v110
    v_mfma_f32_16x16x32_bf16 v[188:191], a[56:59], a[88:91], v[188:191]
    buffer_load_dwordx4 v46, s[20:23], s37 offen offset:2048 lds
    v_add_f32_dpp v109, v109, v109 quad_perm:[1,0,3,2] row_mask:0xf bank_mask:0xf
    v_mfma_f32_16x16x32_bf16 v[220:223], a[56:59], a[92:95], v[220:223]
    ds_read_b64_tr_b16 a[12:13], v53 offset:16384
    v_add_f32_dpp v109, v109, v109 quad_perm:[2,3,0,1] row_mask:0xf bank_mask:0xf
    v_mfma_f32_16x16x32_bf16 v[224:227], a[60:63], a[92:95], v[224:227]
    ds_read_b64_tr_b16 a[14:15], v53 offset:17408
    v_add_f32_dpp v109, v109, v109 row_half_mirror row_mask:0xf bank_mask:0xf
    v_mfma_f32_16x16x32_bf16 v[192:195], a[60:63], a[88:91], v[192:195]
    ds_read_b64_tr_b16 a[16:17], v54 offset:16384
    v_add_f32_dpp v109, v109, v109 row_mirror row_mask:0xf bank_mask:0xf
    v_mov_b32 v110, v109
    v_mfma_f32_16x16x32_bf16 v[160:163], a[60:63], a[84:87], v[160:163]
    ds_read_b64_tr_b16 a[18:19], v54 offset:17408
    v_permlane16_swap_b32 v109, v110
    v_add_f32 v109, v109, v110
    v_mul_f32 v111, 0x3acccccd, v109
    v_mfma_f32_16x16x32_bf16 v[128:131], a[60:63], a[80:83], v[128:131]
    buffer_load_dwordx4 v47, s[20:23], s37 offen offset:3072 lds
    v_sub_f32 v60, v80, v111
    v_mfma_f32_16x16x32_bf16 v[132:135], a[64:67], a[80:83], v[132:135]
    ds_read_b64_tr_b16 a[20:21], v55 offset:16384
    v_mul_f32 v109, v60, v60
    v_mfma_f32_16x16x32_bf16 v[164:167], a[64:67], a[84:87], v[164:167]
    ds_read_b64_tr_b16 a[22:23], v55 offset:17408
    v_sub_f32 v61, v81, v111
    v_mul_f32 v112, v61, v61
    v_mfma_f32_16x16x32_bf16 v[196:199], a[64:67], a[88:91], v[196:199]
    ds_read_b64_tr_b16 a[24:25], v56 offset:16384
    v_sub_f32 v60, v82, v111
    v_mfma_f32_16x16x32_bf16 v[228:231], a[64:67], a[92:95], v[228:231]
    s_add_u32 m0, s38, 0
    s_mov_b32 s36, 384
    ds_read_b64_tr_b16 a[26:27], v56 offset:17408
    v_fmac_f32 v109, v60, v60
    v_mfma_f32_16x16x32_bf16 v[232:235], a[68:71], a[92:95], v[232:235]
    buffer_load_dwordx4 v36, s[16:19], s36 offen offset:0 lds
    v_sub_f32 v61, v83, v111
    v_fmac_f32 v112, v61, v61
    v_mfma_f32_16x16x32_bf16 v[200:203], a[68:71], a[88:91], v[200:203]
    ds_read_b64_tr_b16 a[28:29], v57 offset:16384
    v_sub_f32 v60, v84, v111
    v_mfma_f32_16x16x32_bf16 v[168:171], a[68:71], a[84:87], v[168:171]
    ds_read_b64_tr_b16 a[30:31], v57 offset:17408
    v_fmac_f32 v109, v60, v60
    v_mfma_f32_16x16x32_bf16 v[136:139], a[68:71], a[80:83], v[136:139]
    v_sub_f32 v61, v85, v111
    v_fmac_f32 v112, v61, v61
    v_mfma_f32_16x16x32_bf16 v[140:143], a[72:75], a[80:83], v[140:143]
    v_sub_f32 v60, v86, v111
    v_fmac_f32 v109, v60, v60
    v_mfma_f32_16x16x32_bf16 v[172:175], a[72:75], a[84:87], v[172:175]
    buffer_load_dwordx4 v37, s[16:19], s36 offen offset:1024 lds
    v_sub_f32 v61, v87, v111
    v_mfma_f32_16x16x32_bf16 v[204:207], a[72:75], a[88:91], v[204:207]
    v_fmac_f32 v112, v61, v61
    v_sub_f32 v60, v88, v111
    v_mfma_f32_16x16x32_bf16 v[236:239], a[72:75], a[92:95], v[236:239]
    v_fmac_f32 v109, v60, v60
    v_sub_f32 v61, v89, v111
    v_mfma_f32_16x16x32_bf16 v[240:243], a[76:79], a[92:95], v[240:243]
    v_fmac_f32 v112, v61, v61
    v_sub_f32 v60, v90, v111
    v_mfma_f32_16x16x32_bf16 v[208:211], a[76:79], a[88:91], v[208:211]
    v_fmac_f32 v109, v60, v60
    v_sub_f32 v61, v91, v111
    v_mfma_f32_16x16x32_bf16 v[176:179], a[76:79], a[84:87], v[176:179]
    v_fmac_f32 v112, v61, v61
    v_sub_f32 v60, v92, v111
    v_mfma_f32_16x16x32_bf16 v[144:147], a[76:79], a[80:83], v[144:147]
    v_fmac_f32 v109, v60, v60
    v_sub_f32 v61, v93, v111
    s_waitcnt lgkmcnt(0)
    v_mfma_f32_16x16x32_bf16 v[100:103], a[0:3], v[32:35], v[100:103]
    ds_read_b64_tr_b16 a[48:49], v50 offset:24576
    v_fmac_f32 v112, v61, v61
    v_mfma_f32_16x16x32_bf16 v[104:107], a[4:7], v[32:35], v[104:107]
    ds_read_b64_tr_b16 a[50:51], v50 offset:25600
    v_sub_f32 v60, v94, v111
    v_mfma_f32_16x16x32_bf16 v[116:119], a[0:3], a[32:35], v[116:119]
    buffer_load_dwordx4 v38, s[16:19], s36 offen offset:2048 lds
    v_mfma_f32_16x16x32_bf16 v[148:151], a[0:3], a[36:39], v[148:151]
    ds_read_b128 a[80:83], v49 offset:8192
    v_fmac_f32 v109, v60, v60
    v_mfma_f32_16x16x32_bf16 v[180:183], a[0:3], a[40:43], v[180:183]
    ds_read_b128 a[84:87], v49 offset:10240
    v_sub_f32 v61, v95, v111
    v_mfma_f32_16x16x32_bf16 v[212:215], a[0:3], a[44:47], v[212:215]
    ds_read_b128 a[88:91], v49 offset:12288
    v_fmac_f32 v112, v61, v61
    v_mfma_f32_16x16x32_bf16 v[216:219], a[4:7], a[44:47], v[216:219]
    ds_read_b128 a[92:95], v49 offset:14336
    v_sub_f32 v60, v96, v111
    v_mfma_f32_16x16x32_bf16 v[184:187], a[4:7], a[40:43], v[184:187]
    buffer_load_dwordx4 v39, s[16:19], s36 offen offset:3072 lds
    v_fmac_f32 v109, v60, v60
    v_mfma_f32_16x16x32_bf16 v[152:155], a[4:7], a[36:39], v[152:155]
    ds_read_b64_tr_b16 a[52:53], v51 offset:24576
    v_sub_f32 v61, v97, v111
    v_mfma_f32_16x16x32_bf16 v[120:123], a[4:7], a[32:35], v[120:123]
    ds_read_b64_tr_b16 a[54:55], v51 offset:25600
    v_fmac_f32 v112, v61, v61
    v_mfma_f32_16x16x32_bf16 v[124:127], a[8:11], a[32:35], v[124:127]
    ds_read_b64_tr_b16 a[56:57], v52 offset:24576
    v_sub_f32 v60, v98, v111
    v_mfma_f32_16x16x32_bf16 v[156:159], a[8:11], a[36:39], v[156:159]
    s_add_u32 m0, s38, 4096
    ds_read_b64_tr_b16 a[58:59], v52 offset:25600
    v_fmac_f32 v109, v60, v60
    v_sub_f32 v61, v99, v111
    v_mfma_f32_16x16x32_bf16 v[188:191], a[8:11], a[40:43], v[188:191]
    buffer_load_dwordx4 v40, s[16:19], s36 offen offset:0 lds
    v_fmac_f32 v112, v61, v61
    v_mfma_f32_16x16x32_bf16 v[220:223], a[8:11], a[44:47], v[220:223]
    ds_read_b64_tr_b16 a[60:61], v53 offset:24576
    v_add_f32 v109, v109, v112
    v_mfma_f32_16x16x32_bf16 v[224:227], a[12:15], a[44:47], v[224:227]
    ds_read_b64_tr_b16 a[62:63], v53 offset:25600
    v_add_f32_dpp v109, v109, v109 quad_perm:[1,0,3,2] row_mask:0xf bank_mask:0xf
    v_mfma_f32_16x16x32_bf16 v[192:195], a[12:15], a[40:43], v[192:195]
    ds_read_b64_tr_b16 a[64:65], v54 offset:24576
    v_add_f32_dpp v109, v109, v109 quad_perm:[2,3,0,1] row_mask:0xf bank_mask:0xf
    v_mfma_f32_16x16x32_bf16 v[160:163], a[12:15], a[36:39], v[160:163]
    ds_read_b64_tr_b16 a[66:67], v54 offset:25600
    v_add_f32_dpp v109, v109, v109 row_half_mirror row_mask:0xf bank_mask:0xf
    v_mfma_f32_16x16x32_bf16 v[128:131], a[12:15], a[32:35], v[128:131]
    buffer_load_dwordx4 v41, s[16:19], s36 offen offset:1024 lds
    v_add_f32_dpp v109, v109, v109 row_mirror row_mask:0xf bank_mask:0xf
    v_mov_b32 v110, v109
    v_mfma_f32_16x16x32_bf16 v[132:135], a[16:19], a[32:35], v[132:135]
    ds_read_b64_tr_b16 a[68:69], v55 offset:24576
    v_permlane16_swap_b32 v109, v110
    v_add_f32 v109, v109, v110
    v_mfma_f32_16x16x32_bf16 v[164:167], a[16:19], a[36:39], v[164:167]
    ds_read_b64_tr_b16 a[70:71], v55 offset:25600
    v_mul_f32 v109, 0x3acccccd, v109
    v_cvt_pk_bf16_f32 v110, v111, v109
    v_mfma_f32_16x16x32_bf16 v[196:199], a[16:19], a[40:43], v[196:199]
    ds_read_b64_tr_b16 a[72:73], v56 offset:24576
    v_lshlrev_b32 v111, 16, v110
    v_mfma_f32_16x16x32_bf16 v[228:231], a[16:19], a[44:47], v[228:231]
    ds_read_b64_tr_b16 a[74:75], v56 offset:25600
    v_and_b32 v109, 0xffff0000, v110
    v_mfma_f32_16x16x32_bf16 v[232:235], a[20:23], a[44:47], v[232:235]
    buffer_load_dwordx4 v42, s[16:19], s36 offen offset:2048 lds
    v_add_f32 v109, 0x3727c5ac, v109
    v_cvt_pk_bf16_f32 v109, v109, v109
    v_mfma_f32_16x16x32_bf16 v[200:203], a[20:23], a[40:43], v[200:203]
    ds_read_b64_tr_b16 a[76:77], v57 offset:24576
    v_lshlrev_b32 v109, 16, v109
    v_mfma_f32_16x16x32_bf16 v[168:171], a[20:23], a[36:39], v[168:171]
    ds_read_b64_tr_b16 a[78:79], v57 offset:25600
    v_sqrt_f32 v109, v109
    v_mfma_f32_16x16x32_bf16 v[136:139], a[20:23], a[32:35], v[136:139]
    v_sub_f32 v80, v80, v111
    v_sub_f32 v81, v81, v111
    v_mfma_f32_16x16x32_bf16 v[140:143], a[24:27], a[32:35], v[140:143]
    v_sub_f32 v82, v82, v111
    v_sub_f32 v83, v83, v111
    v_mfma_f32_16x16x32_bf16 v[172:175], a[24:27], a[36:39], v[172:175]
    buffer_load_dwordx4 v43, s[16:19], s36 offen offset:3072 lds
    v_sub_f32 v84, v84, v111
    v_mfma_f32_16x16x32_bf16 v[204:207], a[24:27], a[40:43], v[204:207]
    v_sub_f32 v85, v85, v111
    v_sub_f32 v86, v86, v111
    v_mfma_f32_16x16x32_bf16 v[236:239], a[24:27], a[44:47], v[236:239]
    v_sub_f32 v87, v87, v111
    v_sub_f32 v88, v88, v111
    v_mfma_f32_16x16x32_bf16 v[240:243], a[28:31], a[44:47], v[240:243]
    v_sub_f32 v89, v89, v111
    v_sub_f32 v90, v90, v111
    v_mfma_f32_16x16x32_bf16 v[208:211], a[28:31], a[40:43], v[208:211]
    v_sub_f32 v91, v91, v111
    v_sub_f32 v92, v92, v111
    v_mfma_f32_16x16x32_bf16 v[176:179], a[28:31], a[36:39], v[176:179]
    v_sub_f32 v93, v93, v111
    v_sub_f32 v94, v94, v111
    v_mfma_f32_16x16x32_bf16 v[144:147], a[28:31], a[32:35], v[144:147]
    v_sub_f32 v95, v95, v111
    v_sub_f32 v96, v96, v111
    s_waitcnt vmcnt(12) lgkmcnt(0)
    s_barrier
    v_mfma_f32_16x16x32_bf16 v[100:103], a[48:51], v[32:35], v[100:103]
    ds_read_b64_tr_b16 a[0:1], v50 offset:32768
    v_sub_f32 v97, v97, v111
    v_mfma_f32_16x16x32_bf16 v[104:107], a[52:55], v[32:35], v[104:107]
    s_add_u32 m0, s39, 16384
    s_mov_b32 s37, 2097152
    ds_read_b64_tr_b16 a[2:3], v50 offset:33792
    v_sub_f32 v98, v98, v111
    v_mfma_f32_16x16x32_bf16 v[116:119], a[48:51], a[80:83], v[116:119]
    buffer_load_dwordx4 v44, s[20:23], s37 offen offset:0 lds
    v_mfma_f32_16x16x32_bf16 v[148:151], a[48:51], a[84:87], v[148:151]
    ds_read_b128 a[32:35], v48 offset:16384
    v_sub_f32 v99, v99, v111
    v_mfma_f32_16x16x32_bf16 v[180:183], a[48:51], a[88:91], v[180:183]
    ds_read_b128 a[36:39], v48 offset:18432
    v_cvt_pk_bf16_f32 v109, v109, v109
    v_mfma_f32_16x16x32_bf16 v[212:215], a[48:51], a[92:95], v[212:215]
    ds_read_b128 a[40:43], v48 offset:20480
    v_lshlrev_b32 v109, 16, v109
    v_mfma_f32_16x16x32_bf16 v[216:219], a[52:55], a[92:95], v[216:219]
    ds_read_b128 a[44:47], v48 offset:22528
    v_rcp_f32 v112, v109
    v_mfma_f32_16x16x32_bf16 v[184:187], a[52:55], a[88:91], v[184:187]
    buffer_load_dwordx4 v45, s[20:23], s37 offen offset:1024 lds
    v_cvt_pk_bf16_f32 v60, v80, v81
    v_mfma_f32_16x16x32_bf16 v[152:155], a[52:55], a[84:87], v[152:155]
    ds_read_b64_tr_b16 a[4:5], v51 offset:32768
    v_cvt_pk_bf16_f32 v61, v82, v83
    v_mfma_f32_16x16x32_bf16 v[120:123], a[52:55], a[80:83], v[120:123]
    ds_read_b64_tr_b16 a[6:7], v51 offset:33792
    v_cvt_pk_bf16_f32 v62, v84, v85
    v_mfma_f32_16x16x32_bf16 v[124:127], a[56:59], a[80:83], v[124:127]
    ds_read_b64_tr_b16 a[8:9], v52 offset:32768
    v_cvt_pk_bf16_f32 v63, v86, v87
    v_mfma_f32_16x16x32_bf16 v[156:159], a[56:59], a[84:87], v[156:159]
    ds_read_b64_tr_b16 a[10:11], v52 offset:33792
    v_cvt_pk_bf16_f32 v64, v88, v89
    v_cvt_pk_bf16_f32 v65, v90, v91
    v_mfma_f32_16x16x32_bf16 v[188:191], a[56:59], a[88:91], v[188:191]
    buffer_load_dwordx4 v46, s[20:23], s37 offen offset:2048 lds
    v_cvt_pk_bf16_f32 v66, v92, v93
    v_mfma_f32_16x16x32_bf16 v[220:223], a[56:59], a[92:95], v[220:223]
    ds_read_b64_tr_b16 a[12:13], v53 offset:32768
    v_cvt_pk_bf16_f32 v67, v94, v95
    v_mfma_f32_16x16x32_bf16 v[224:227], a[60:63], a[92:95], v[224:227]
    ds_read_b64_tr_b16 a[14:15], v53 offset:33792
    v_cvt_pk_bf16_f32 v68, v96, v97
    v_cvt_pk_bf16_f32 v69, v98, v99
    v_mfma_f32_16x16x32_bf16 v[192:195], a[60:63], a[88:91], v[192:195]
    ds_read_b64_tr_b16 a[16:17], v54 offset:32768
    v_lshlrev_b32 v80, 16, v60
    v_mfma_f32_16x16x32_bf16 v[160:163], a[60:63], a[84:87], v[160:163]
    ds_read_b64_tr_b16 a[18:19], v54 offset:33792
    v_and_b32 v81, 0xffff0000, v60
    v_lshlrev_b32 v82, 16, v61
    v_mfma_f32_16x16x32_bf16 v[128:131], a[60:63], a[80:83], v[128:131]
    buffer_load_dwordx4 v47, s[20:23], s37 offen offset:3072 lds
    v_and_b32 v83, 0xffff0000, v61
    v_mfma_f32_16x16x32_bf16 v[132:135], a[64:67], a[80:83], v[132:135]
    ds_read_b64_tr_b16 a[20:21], v55 offset:32768
    v_lshlrev_b32 v84, 16, v62
    v_mfma_f32_16x16x32_bf16 v[164:167], a[64:67], a[84:87], v[164:167]
    ds_read_b64_tr_b16 a[22:23], v55 offset:33792
    v_and_b32 v85, 0xffff0000, v62
    v_lshlrev_b32 v86, 16, v63
    v_mfma_f32_16x16x32_bf16 v[196:199], a[64:67], a[88:91], v[196:199]
    ds_read_b64_tr_b16 a[24:25], v56 offset:32768
    v_and_b32 v87, 0xffff0000, v63
    v_mfma_f32_16x16x32_bf16 v[228:231], a[64:67], a[92:95], v[228:231]
    s_add_u32 m0, s38, 8192
    s_mov_b32 s36, 512
    ds_read_b64_tr_b16 a[26:27], v56 offset:33792
    v_lshlrev_b32 v88, 16, v64
    v_mfma_f32_16x16x32_bf16 v[232:235], a[68:71], a[92:95], v[232:235]
    buffer_load_dwordx4 v36, s[16:19], s36 offen offset:0 lds
    v_and_b32 v89, 0xffff0000, v64
    v_lshlrev_b32 v90, 16, v65
    v_mfma_f32_16x16x32_bf16 v[200:203], a[68:71], a[88:91], v[200:203]
    ds_read_b64_tr_b16 a[28:29], v57 offset:32768
    v_and_b32 v91, 0xffff0000, v65
    v_mfma_f32_16x16x32_bf16 v[168:171], a[68:71], a[84:87], v[168:171]
    ds_read_b64_tr_b16 a[30:31], v57 offset:33792
    v_lshlrev_b32 v92, 16, v66
    v_mfma_f32_16x16x32_bf16 v[136:139], a[68:71], a[80:83], v[136:139]
    v_and_b32 v93, 0xffff0000, v66
    v_lshlrev_b32 v94, 16, v67
    v_mfma_f32_16x16x32_bf16 v[140:143], a[72:75], a[80:83], v[140:143]
    v_and_b32 v95, 0xffff0000, v67
    v_lshlrev_b32 v96, 16, v68
    v_mfma_f32_16x16x32_bf16 v[172:175], a[72:75], a[84:87], v[172:175]
    buffer_load_dwordx4 v37, s[16:19], s36 offen offset:1024 lds
    v_and_b32 v97, 0xffff0000, v68
    v_mfma_f32_16x16x32_bf16 v[204:207], a[72:75], a[88:91], v[204:207]
    v_lshlrev_b32 v98, 16, v69
    v_and_b32 v99, 0xffff0000, v69
    v_mfma_f32_16x16x32_bf16 v[236:239], a[72:75], a[92:95], v[236:239]
    v_mul_f32 v80, v80, v112
    v_mul_f32 v81, v81, v112
    v_mfma_f32_16x16x32_bf16 v[240:243], a[76:79], a[92:95], v[240:243]
    v_mul_f32 v82, v82, v112
    v_mul_f32 v83, v83, v112
    v_mfma_f32_16x16x32_bf16 v[208:211], a[76:79], a[88:91], v[208:211]
    v_mul_f32 v84, v84, v112
    v_mul_f32 v85, v85, v112
    v_mfma_f32_16x16x32_bf16 v[176:179], a[76:79], a[84:87], v[176:179]
    v_mul_f32 v86, v86, v112
    v_mul_f32 v87, v87, v112
    v_mfma_f32_16x16x32_bf16 v[144:147], a[76:79], a[80:83], v[144:147]
    v_mul_f32 v88, v88, v112
    v_mul_f32 v89, v89, v112
    s_waitcnt lgkmcnt(0)
    v_mfma_f32_16x16x32_bf16 v[100:103], a[0:3], v[32:35], v[100:103]
    ds_read_b64_tr_b16 a[48:49], v50 offset:40960
    v_mul_f32 v90, v90, v112
    v_mfma_f32_16x16x32_bf16 v[104:107], a[4:7], v[32:35], v[104:107]
    ds_read_b64_tr_b16 a[50:51], v50 offset:41984
    v_mul_f32 v91, v91, v112
    v_mfma_f32_16x16x32_bf16 v[116:119], a[0:3], a[32:35], v[116:119]
    buffer_load_dwordx4 v38, s[16:19], s36 offen offset:2048 lds
    v_mfma_f32_16x16x32_bf16 v[148:151], a[0:3], a[36:39], v[148:151]
    ds_read_b128 a[80:83], v49 offset:16384
    v_mul_f32 v92, v92, v112
    v_mfma_f32_16x16x32_bf16 v[180:183], a[0:3], a[40:43], v[180:183]
    ds_read_b128 a[84:87], v49 offset:18432
    v_mul_f32 v93, v93, v112
    v_mfma_f32_16x16x32_bf16 v[212:215], a[0:3], a[44:47], v[212:215]
    ds_read_b128 a[88:91], v49 offset:20480
    v_mul_f32 v94, v94, v112
    v_mfma_f32_16x16x32_bf16 v[216:219], a[4:7], a[44:47], v[216:219]
    ds_read_b128 a[92:95], v49 offset:22528
    v_mul_f32 v95, v95, v112
    v_mfma_f32_16x16x32_bf16 v[184:187], a[4:7], a[40:43], v[184:187]
    buffer_load_dwordx4 v39, s[16:19], s36 offen offset:3072 lds
    v_mul_f32 v96, v96, v112
    v_mfma_f32_16x16x32_bf16 v[152:155], a[4:7], a[36:39], v[152:155]
    ds_read_b64_tr_b16 a[52:53], v51 offset:40960
    v_mul_f32 v97, v97, v112
    v_mfma_f32_16x16x32_bf16 v[120:123], a[4:7], a[32:35], v[120:123]
    ds_read_b64_tr_b16 a[54:55], v51 offset:41984
    v_mul_f32 v98, v98, v112
    v_mfma_f32_16x16x32_bf16 v[124:127], a[8:11], a[32:35], v[124:127]
    ds_read_b64_tr_b16 a[56:57], v52 offset:40960
    v_mul_f32 v99, v99, v112
    v_mfma_f32_16x16x32_bf16 v[156:159], a[8:11], a[36:39], v[156:159]
    s_add_u32 m0, s38, 12288
    ds_read_b64_tr_b16 a[58:59], v52 offset:41984
    v_cvt_pk_bf16_f32 v60, v80, v81
    v_cvt_pk_bf16_f32 v61, v82, v83
    v_mfma_f32_16x16x32_bf16 v[188:191], a[8:11], a[40:43], v[188:191]
    buffer_load_dwordx4 v40, s[16:19], s36 offen offset:0 lds
    v_cvt_pk_bf16_f32 v62, v84, v85
    v_mfma_f32_16x16x32_bf16 v[220:223], a[8:11], a[44:47], v[220:223]
    ds_read_b64_tr_b16 a[60:61], v53 offset:40960
    v_cvt_pk_bf16_f32 v63, v86, v87
    v_mfma_f32_16x16x32_bf16 v[224:227], a[12:15], a[44:47], v[224:227]
    ds_read_b64_tr_b16 a[62:63], v53 offset:41984
    v_cvt_pk_bf16_f32 v64, v88, v89
    v_cvt_pk_bf16_f32 v65, v90, v91
    v_mfma_f32_16x16x32_bf16 v[192:195], a[12:15], a[40:43], v[192:195]
    ds_read_b64_tr_b16 a[64:65], v54 offset:40960
    v_cvt_pk_bf16_f32 v66, v92, v93
    v_mfma_f32_16x16x32_bf16 v[160:163], a[12:15], a[36:39], v[160:163]
    ds_read_b64_tr_b16 a[66:67], v54 offset:41984
    v_cvt_pk_bf16_f32 v67, v94, v95
    v_cvt_pk_bf16_f32 v68, v96, v97
    v_mfma_f32_16x16x32_bf16 v[128:131], a[12:15], a[32:35], v[128:131]
    buffer_load_dwordx4 v41, s[16:19], s36 offen offset:1024 lds
    v_cvt_pk_bf16_f32 v69, v98, v99
    v_mfma_f32_16x16x32_bf16 v[132:135], a[16:19], a[32:35], v[132:135]
    ds_read_b64_tr_b16 a[68:69], v55 offset:40960
    v_mov_b32 v109, 0
    v_mfma_f32_16x16x32_bf16 v[164:167], a[16:19], a[36:39], v[164:167]
    ds_read_b64_tr_b16 a[70:71], v55 offset:41984
    v_dot2c_f32_bf16 v109, v60, v70
    v_dot2c_f32_bf16 v109, v61, v71
    v_dot2c_f32_bf16 v109, v62, v72
    v_dot2c_f32_bf16 v109, v63, v73
    v_dot2c_f32_bf16 v109, v64, v74
    v_dot2c_f32_bf16 v109, v65, v75
    v_dot2c_f32_bf16 v109, v66, v76
    v_dot2c_f32_bf16 v109, v67, v77
    v_dot2c_f32_bf16 v109, v68, v78
    v_dot2c_f32_bf16 v109, v69, v79
    s_nop 2
    v_mfma_f32_16x16x32_bf16 v[196:199], a[16:19], a[40:43], v[196:199]
    ds_read_b64_tr_b16 a[72:73], v56 offset:40960
    v_add_f32_dpp v109, v109, v109 quad_perm:[1,0,3,2] row_mask:0xf bank_mask:0xf
    v_mfma_f32_16x16x32_bf16 v[228:231], a[16:19], a[44:47], v[228:231]
    ds_read_b64_tr_b16 a[74:75], v56 offset:41984
    v_add_f32_dpp v109, v109, v109 quad_perm:[2,3,0,1] row_mask:0xf bank_mask:0xf
    v_mfma_f32_16x16x32_bf16 v[232:235], a[20:23], a[44:47], v[232:235]
    buffer_load_dwordx4 v42, s[16:19], s36 offen offset:2048 lds
    v_add_f32_dpp v109, v109, v109 row_half_mirror row_mask:0xf bank_mask:0xf
    v_mfma_f32_16x16x32_bf16 v[200:203], a[20:23], a[40:43], v[200:203]
    ds_read_b64_tr_b16 a[76:77], v57 offset:40960
    v_add_f32_dpp v109, v109, v109 row_mirror row_mask:0xf bank_mask:0xf
    v_mov_b32 v110, v109
    v_mfma_f32_16x16x32_bf16 v[168:171], a[20:23], a[36:39], v[168:171]
    ds_read_b64_tr_b16 a[78:79], v57 offset:41984
    v_permlane16_swap_b32 v109, v110
    v_add_f32 v109, v109, v110
    v_mfma_f32_16x16x32_bf16 v[136:139], a[20:23], a[32:35], v[136:139]
    v_cvt_pk_bf16_f32 v109, v109, v109
    v_lshlrev_b32 v109, 16, v109
    v_mfma_f32_16x16x32_bf16 v[140:143], a[24:27], a[32:35], v[140:143]
    v_ashrrev_i32 v110, 31, v109
    v_or_b32 v110, 0x80000000, v110
    v_mfma_f32_16x16x32_bf16 v[172:175], a[24:27], a[36:39], v[172:175]
    buffer_load_dwordx4 v43, s[16:19], s36 offen offset:3072 lds
    v_xor_b32 v109, v109, v110
    v_mfma_f32_16x16x32_bf16 v[204:207], a[24:27], a[40:43], v[204:207]
    v_and_b32 v109, 0xffff0000, v109
    v_sub_u32 v110, 0xffff, v108
    v_mfma_f32_16x16x32_bf16 v[236:239], a[24:27], a[44:47], v[236:239]
    v_or_b32 v62, v109, v110
    v_mov_b32 v60, v111
    v_mfma_f32_16x16x32_bf16 v[240:243], a[28:31], a[44:47], v[240:243]
    v_mov_b32 v61, v112
    v_mov_b32 v63, 0
    v_mfma_f32_16x16x32_bf16 v[208:211], a[28:31], a[40:43], v[208:211]
    v_lshlrev_b32 v110, 4, v108
    v_mfma_f32_16x16x32_bf16 v[176:179], a[28:31], a[36:39], v[176:179]
    s_mov_b32 s40, 0x280000
    s_mov_b32 exec_lo, 1
    s_mov_b32 exec_hi, 1
    buffer_store_dwordx4 v[60:63], v110, s[76:79], s40 offen sc1
    s_mov_b64 exec, -1
    v_mfma_f32_16x16x32_bf16 v[144:147], a[28:31], a[32:35], v[144:147]
    s_waitcnt vmcnt(13) lgkmcnt(0)
    s_barrier
    v_mfma_f32_16x16x32_bf16 v[100:103], a[48:51], v[32:35], v[100:103]
    ds_read_b64_tr_b16 a[0:1], v50 offset:0
    v_mfma_f32_16x16x32_bf16 v[104:107], a[52:55], v[32:35], v[104:107]
    s_add_u32 m0, s39, 32768
    s_mov_b32 s37, 2621440
    ds_read_b64_tr_b16 a[2:3], v50 offset:1024
    v_mfma_f32_16x16x32_bf16 v[116:119], a[48:51], a[80:83], v[116:119]
    buffer_load_dwordx4 v44, s[20:23], s37 offen offset:0 lds
    v_mfma_f32_16x16x32_bf16 v[148:151], a[48:51], a[84:87], v[148:151]
    ds_read_b128 a[32:35], v48 offset:0
    v_mfma_f32_16x16x32_bf16 v[180:183], a[48:51], a[88:91], v[180:183]
    ds_read_b128 a[36:39], v48 offset:2048
    v_mfma_f32_16x16x32_bf16 v[212:215], a[48:51], a[92:95], v[212:215]
    ds_read_b128 a[40:43], v48 offset:4096
    v_mfma_f32_16x16x32_bf16 v[216:219], a[52:55], a[92:95], v[216:219]
    ds_read_b128 a[44:47], v48 offset:6144
    v_mfma_f32_16x16x32_bf16 v[184:187], a[52:55], a[88:91], v[184:187]
    buffer_load_dwordx4 v45, s[20:23], s37 offen offset:1024 lds
    v_mfma_f32_16x16x32_bf16 v[152:155], a[52:55], a[84:87], v[152:155]
    ds_read_b64_tr_b16 a[4:5], v51 offset:0
    v_mfma_f32_16x16x32_bf16 v[120:123], a[52:55], a[80:83], v[120:123]
    ds_read_b64_tr_b16 a[6:7], v51 offset:1024
    v_mfma_f32_16x16x32_bf16 v[124:127], a[56:59], a[80:83], v[124:127]
    ds_read_b64_tr_b16 a[8:9], v52 offset:0
    v_mfma_f32_16x16x32_bf16 v[156:159], a[56:59], a[84:87], v[156:159]
    ds_read_b64_tr_b16 a[10:11], v52 offset:1024
    v_mfma_f32_16x16x32_bf16 v[188:191], a[56:59], a[88:91], v[188:191]
    buffer_load_dwordx4 v46, s[20:23], s37 offen offset:2048 lds
    v_mfma_f32_16x16x32_bf16 v[220:223], a[56:59], a[92:95], v[220:223]
    ds_read_b64_tr_b16 a[12:13], v53 offset:0
    v_mfma_f32_16x16x32_bf16 v[224:227], a[60:63], a[92:95], v[224:227]
    ds_read_b64_tr_b16 a[14:15], v53 offset:1024
    v_mfma_f32_16x16x32_bf16 v[192:195], a[60:63], a[88:91], v[192:195]
    ds_read_b64_tr_b16 a[16:17], v54 offset:0
    v_mfma_f32_16x16x32_bf16 v[160:163], a[60:63], a[84:87], v[160:163]
    ds_read_b64_tr_b16 a[18:19], v54 offset:1024
    v_mfma_f32_16x16x32_bf16 v[128:131], a[60:63], a[80:83], v[128:131]
    buffer_load_dwordx4 v47, s[20:23], s37 offen offset:3072 lds
    v_mfma_f32_16x16x32_bf16 v[132:135], a[64:67], a[80:83], v[132:135]
    ds_read_b64_tr_b16 a[20:21], v55 offset:0
    v_mfma_f32_16x16x32_bf16 v[164:167], a[64:67], a[84:87], v[164:167]
    ds_read_b64_tr_b16 a[22:23], v55 offset:1024
    v_mfma_f32_16x16x32_bf16 v[196:199], a[64:67], a[88:91], v[196:199]
    ds_read_b64_tr_b16 a[24:25], v56 offset:0
    v_mfma_f32_16x16x32_bf16 v[228:231], a[64:67], a[92:95], v[228:231]
    s_add_u32 m0, s38, 16384
    s_mov_b32 s36, 640
    ds_read_b64_tr_b16 a[26:27], v56 offset:1024
    v_mfma_f32_16x16x32_bf16 v[232:235], a[68:71], a[92:95], v[232:235]
    buffer_load_dwordx4 v36, s[16:19], s36 offen offset:0 lds
    v_mfma_f32_16x16x32_bf16 v[200:203], a[68:71], a[88:91], v[200:203]
    ds_read_b64_tr_b16 a[28:29], v57 offset:0
    v_mfma_f32_16x16x32_bf16 v[168:171], a[68:71], a[84:87], v[168:171]
    ds_read_b64_tr_b16 a[30:31], v57 offset:1024
    v_mfma_f32_16x16x32_bf16 v[136:139], a[68:71], a[80:83], v[136:139]
    v_mfma_f32_16x16x32_bf16 v[140:143], a[72:75], a[80:83], v[140:143]
    v_mfma_f32_16x16x32_bf16 v[172:175], a[72:75], a[84:87], v[172:175]
    buffer_load_dwordx4 v37, s[16:19], s36 offen offset:1024 lds
    v_mfma_f32_16x16x32_bf16 v[204:207], a[72:75], a[88:91], v[204:207]
    v_mfma_f32_16x16x32_bf16 v[236:239], a[72:75], a[92:95], v[236:239]
    v_mfma_f32_16x16x32_bf16 v[240:243], a[76:79], a[92:95], v[240:243]
    v_mfma_f32_16x16x32_bf16 v[208:211], a[76:79], a[88:91], v[208:211]
    v_mfma_f32_16x16x32_bf16 v[176:179], a[76:79], a[84:87], v[176:179]
    v_mfma_f32_16x16x32_bf16 v[144:147], a[76:79], a[80:83], v[144:147]
    s_waitcnt lgkmcnt(0)
    v_mfma_f32_16x16x32_bf16 v[100:103], a[0:3], v[32:35], v[100:103]
    ds_read_b64_tr_b16 a[48:49], v50 offset:8192
    v_mfma_f32_16x16x32_bf16 v[104:107], a[4:7], v[32:35], v[104:107]
    ds_read_b64_tr_b16 a[50:51], v50 offset:9216
    v_mfma_f32_16x16x32_bf16 v[116:119], a[0:3], a[32:35], v[116:119]
    buffer_load_dwordx4 v38, s[16:19], s36 offen offset:2048 lds
    v_mfma_f32_16x16x32_bf16 v[148:151], a[0:3], a[36:39], v[148:151]
    ds_read_b128 a[80:83], v49 offset:0
    v_mfma_f32_16x16x32_bf16 v[180:183], a[0:3], a[40:43], v[180:183]
    ds_read_b128 a[84:87], v49 offset:2048
    v_mfma_f32_16x16x32_bf16 v[212:215], a[0:3], a[44:47], v[212:215]
    ds_read_b128 a[88:91], v49 offset:4096
    v_mfma_f32_16x16x32_bf16 v[216:219], a[4:7], a[44:47], v[216:219]
    ds_read_b128 a[92:95], v49 offset:6144
    v_mfma_f32_16x16x32_bf16 v[184:187], a[4:7], a[40:43], v[184:187]
    buffer_load_dwordx4 v39, s[16:19], s36 offen offset:3072 lds
    v_mfma_f32_16x16x32_bf16 v[152:155], a[4:7], a[36:39], v[152:155]
    ds_read_b64_tr_b16 a[52:53], v51 offset:8192
    v_mfma_f32_16x16x32_bf16 v[120:123], a[4:7], a[32:35], v[120:123]
    ds_read_b64_tr_b16 a[54:55], v51 offset:9216
    v_mfma_f32_16x16x32_bf16 v[124:127], a[8:11], a[32:35], v[124:127]
    ds_read_b64_tr_b16 a[56:57], v52 offset:8192
    v_mfma_f32_16x16x32_bf16 v[156:159], a[8:11], a[36:39], v[156:159]
    s_add_u32 m0, s38, 20480
    ds_read_b64_tr_b16 a[58:59], v52 offset:9216
    v_mfma_f32_16x16x32_bf16 v[188:191], a[8:11], a[40:43], v[188:191]
    buffer_load_dwordx4 v40, s[16:19], s36 offen offset:0 lds
    v_mfma_f32_16x16x32_bf16 v[220:223], a[8:11], a[44:47], v[220:223]
    ds_read_b64_tr_b16 a[60:61], v53 offset:8192
    v_mfma_f32_16x16x32_bf16 v[224:227], a[12:15], a[44:47], v[224:227]
    ds_read_b64_tr_b16 a[62:63], v53 offset:9216
    v_mfma_f32_16x16x32_bf16 v[192:195], a[12:15], a[40:43], v[192:195]
    ds_read_b64_tr_b16 a[64:65], v54 offset:8192
    v_mfma_f32_16x16x32_bf16 v[160:163], a[12:15], a[36:39], v[160:163]
    ds_read_b64_tr_b16 a[66:67], v54 offset:9216
    v_mfma_f32_16x16x32_bf16 v[128:131], a[12:15], a[32:35], v[128:131]
    buffer_load_dwordx4 v41, s[16:19], s36 offen offset:1024 lds
    v_mfma_f32_16x16x32_bf16 v[132:135], a[16:19], a[32:35], v[132:135]
    ds_read_b64_tr_b16 a[68:69], v55 offset:8192
    v_mfma_f32_16x16x32_bf16 v[164:167], a[16:19], a[36:39], v[164:167]
    ds_read_b64_tr_b16 a[70:71], v55 offset:9216
    v_mfma_f32_16x16x32_bf16 v[196:199], a[16:19], a[40:43], v[196:199]
    ds_read_b64_tr_b16 a[72:73], v56 offset:8192
    v_mfma_f32_16x16x32_bf16 v[228:231], a[16:19], a[44:47], v[228:231]
    ds_read_b64_tr_b16 a[74:75], v56 offset:9216
    v_mfma_f32_16x16x32_bf16 v[232:235], a[20:23], a[44:47], v[232:235]
    buffer_load_dwordx4 v42, s[16:19], s36 offen offset:2048 lds
    v_mfma_f32_16x16x32_bf16 v[200:203], a[20:23], a[40:43], v[200:203]
    ds_read_b64_tr_b16 a[76:77], v57 offset:8192
    v_mfma_f32_16x16x32_bf16 v[168:171], a[20:23], a[36:39], v[168:171]
    ds_read_b64_tr_b16 a[78:79], v57 offset:9216
    v_mfma_f32_16x16x32_bf16 v[136:139], a[20:23], a[32:35], v[136:139]
    v_mfma_f32_16x16x32_bf16 v[140:143], a[24:27], a[32:35], v[140:143]
    v_mfma_f32_16x16x32_bf16 v[172:175], a[24:27], a[36:39], v[172:175]
    buffer_load_dwordx4 v43, s[16:19], s36 offen offset:3072 lds
    v_mfma_f32_16x16x32_bf16 v[204:207], a[24:27], a[40:43], v[204:207]
    v_mfma_f32_16x16x32_bf16 v[236:239], a[24:27], a[44:47], v[236:239]
    v_mfma_f32_16x16x32_bf16 v[240:243], a[28:31], a[44:47], v[240:243]
    v_mfma_f32_16x16x32_bf16 v[208:211], a[28:31], a[40:43], v[208:211]
    v_mfma_f32_16x16x32_bf16 v[176:179], a[28:31], a[36:39], v[176:179]
    v_mfma_f32_16x16x32_bf16 v[144:147], a[28:31], a[32:35], v[144:147]
    s_waitcnt vmcnt(13) lgkmcnt(0)
    s_barrier
    v_mfma_f32_16x16x32_bf16 v[100:103], a[48:51], v[32:35], v[100:103]
    ds_read_b64_tr_b16 a[0:1], v50 offset:16384
    v_mfma_f32_16x16x32_bf16 v[104:107], a[52:55], v[32:35], v[104:107]
    s_add_u32 m0, s39, 0
    s_mov_b32 s37, 3145728
    ds_read_b64_tr_b16 a[2:3], v50 offset:17408
    v_mfma_f32_16x16x32_bf16 v[116:119], a[48:51], a[80:83], v[116:119]
    buffer_load_dwordx4 v44, s[20:23], s37 offen offset:0 lds
    v_mfma_f32_16x16x32_bf16 v[148:151], a[48:51], a[84:87], v[148:151]
    ds_read_b128 a[32:35], v48 offset:8192
    v_mfma_f32_16x16x32_bf16 v[180:183], a[48:51], a[88:91], v[180:183]
    ds_read_b128 a[36:39], v48 offset:10240
    v_mfma_f32_16x16x32_bf16 v[212:215], a[48:51], a[92:95], v[212:215]
    ds_read_b128 a[40:43], v48 offset:12288
    v_mfma_f32_16x16x32_bf16 v[216:219], a[52:55], a[92:95], v[216:219]
    ds_read_b128 a[44:47], v48 offset:14336
    v_mfma_f32_16x16x32_bf16 v[184:187], a[52:55], a[88:91], v[184:187]
    buffer_load_dwordx4 v45, s[20:23], s37 offen offset:1024 lds
    v_mfma_f32_16x16x32_bf16 v[152:155], a[52:55], a[84:87], v[152:155]
    ds_read_b64_tr_b16 a[4:5], v51 offset:16384
    v_mfma_f32_16x16x32_bf16 v[120:123], a[52:55], a[80:83], v[120:123]
    ds_read_b64_tr_b16 a[6:7], v51 offset:17408
    v_mfma_f32_16x16x32_bf16 v[124:127], a[56:59], a[80:83], v[124:127]
    ds_read_b64_tr_b16 a[8:9], v52 offset:16384
    v_mfma_f32_16x16x32_bf16 v[156:159], a[56:59], a[84:87], v[156:159]
    ds_read_b64_tr_b16 a[10:11], v52 offset:17408
    v_mfma_f32_16x16x32_bf16 v[188:191], a[56:59], a[88:91], v[188:191]
    buffer_load_dwordx4 v46, s[20:23], s37 offen offset:2048 lds
    v_mfma_f32_16x16x32_bf16 v[220:223], a[56:59], a[92:95], v[220:223]
    ds_read_b64_tr_b16 a[12:13], v53 offset:16384
    v_mfma_f32_16x16x32_bf16 v[224:227], a[60:63], a[92:95], v[224:227]
    ds_read_b64_tr_b16 a[14:15], v53 offset:17408
    v_mfma_f32_16x16x32_bf16 v[192:195], a[60:63], a[88:91], v[192:195]
    ds_read_b64_tr_b16 a[16:17], v54 offset:16384
    v_mfma_f32_16x16x32_bf16 v[160:163], a[60:63], a[84:87], v[160:163]
    ds_read_b64_tr_b16 a[18:19], v54 offset:17408
    v_mfma_f32_16x16x32_bf16 v[128:131], a[60:63], a[80:83], v[128:131]
    buffer_load_dwordx4 v47, s[20:23], s37 offen offset:3072 lds
    v_mfma_f32_16x16x32_bf16 v[132:135], a[64:67], a[80:83], v[132:135]
    ds_read_b64_tr_b16 a[20:21], v55 offset:16384
    v_mfma_f32_16x16x32_bf16 v[164:167], a[64:67], a[84:87], v[164:167]
    ds_read_b64_tr_b16 a[22:23], v55 offset:17408
    v_mfma_f32_16x16x32_bf16 v[196:199], a[64:67], a[88:91], v[196:199]
    ds_read_b64_tr_b16 a[24:25], v56 offset:16384
    v_mfma_f32_16x16x32_bf16 v[228:231], a[64:67], a[92:95], v[228:231]
    s_add_u32 m0, s38, 0
    s_mov_b32 s36, 768
    ds_read_b64_tr_b16 a[26:27], v56 offset:17408
    v_mfma_f32_16x16x32_bf16 v[232:235], a[68:71], a[92:95], v[232:235]
    buffer_load_dwordx4 v36, s[16:19], s36 offen offset:0 lds
    v_mfma_f32_16x16x32_bf16 v[200:203], a[68:71], a[88:91], v[200:203]
    ds_read_b64_tr_b16 a[28:29], v57 offset:16384
    v_mfma_f32_16x16x32_bf16 v[168:171], a[68:71], a[84:87], v[168:171]
    ds_read_b64_tr_b16 a[30:31], v57 offset:17408
    v_mfma_f32_16x16x32_bf16 v[136:139], a[68:71], a[80:83], v[136:139]
    v_mfma_f32_16x16x32_bf16 v[140:143], a[72:75], a[80:83], v[140:143]
    v_mfma_f32_16x16x32_bf16 v[172:175], a[72:75], a[84:87], v[172:175]
    buffer_load_dwordx4 v37, s[16:19], s36 offen offset:1024 lds
    v_mfma_f32_16x16x32_bf16 v[204:207], a[72:75], a[88:91], v[204:207]
    v_mfma_f32_16x16x32_bf16 v[236:239], a[72:75], a[92:95], v[236:239]
    v_mfma_f32_16x16x32_bf16 v[240:243], a[76:79], a[92:95], v[240:243]
    v_mfma_f32_16x16x32_bf16 v[208:211], a[76:79], a[88:91], v[208:211]
    v_mfma_f32_16x16x32_bf16 v[176:179], a[76:79], a[84:87], v[176:179]
    v_mfma_f32_16x16x32_bf16 v[144:147], a[76:79], a[80:83], v[144:147]
    s_waitcnt lgkmcnt(0)
    v_mfma_f32_16x16x32_bf16 v[100:103], a[0:3], v[32:35], v[100:103]
    ds_read_b64_tr_b16 a[48:49], v50 offset:24576
    v_mfma_f32_16x16x32_bf16 v[104:107], a[4:7], v[32:35], v[104:107]
    ds_read_b64_tr_b16 a[50:51], v50 offset:25600
    v_mfma_f32_16x16x32_bf16 v[116:119], a[0:3], a[32:35], v[116:119]
    buffer_load_dwordx4 v38, s[16:19], s36 offen offset:2048 lds
    v_mfma_f32_16x16x32_bf16 v[148:151], a[0:3], a[36:39], v[148:151]
    ds_read_b128 a[80:83], v49 offset:8192
    v_mfma_f32_16x16x32_bf16 v[180:183], a[0:3], a[40:43], v[180:183]
    ds_read_b128 a[84:87], v49 offset:10240
    v_mfma_f32_16x16x32_bf16 v[212:215], a[0:3], a[44:47], v[212:215]
    ds_read_b128 a[88:91], v49 offset:12288
    v_mfma_f32_16x16x32_bf16 v[216:219], a[4:7], a[44:47], v[216:219]
    ds_read_b128 a[92:95], v49 offset:14336
    v_mfma_f32_16x16x32_bf16 v[184:187], a[4:7], a[40:43], v[184:187]
    buffer_load_dwordx4 v39, s[16:19], s36 offen offset:3072 lds
    v_mfma_f32_16x16x32_bf16 v[152:155], a[4:7], a[36:39], v[152:155]
    ds_read_b64_tr_b16 a[52:53], v51 offset:24576
    v_mfma_f32_16x16x32_bf16 v[120:123], a[4:7], a[32:35], v[120:123]
    ds_read_b64_tr_b16 a[54:55], v51 offset:25600
    v_mfma_f32_16x16x32_bf16 v[124:127], a[8:11], a[32:35], v[124:127]
    ds_read_b64_tr_b16 a[56:57], v52 offset:24576
    v_mfma_f32_16x16x32_bf16 v[156:159], a[8:11], a[36:39], v[156:159]
    s_add_u32 m0, s38, 4096
    ds_read_b64_tr_b16 a[58:59], v52 offset:25600
    v_mfma_f32_16x16x32_bf16 v[188:191], a[8:11], a[40:43], v[188:191]
    buffer_load_dwordx4 v40, s[16:19], s36 offen offset:0 lds
    v_mfma_f32_16x16x32_bf16 v[220:223], a[8:11], a[44:47], v[220:223]
    ds_read_b64_tr_b16 a[60:61], v53 offset:24576
    v_mfma_f32_16x16x32_bf16 v[224:227], a[12:15], a[44:47], v[224:227]
    ds_read_b64_tr_b16 a[62:63], v53 offset:25600
    v_mfma_f32_16x16x32_bf16 v[192:195], a[12:15], a[40:43], v[192:195]
    ds_read_b64_tr_b16 a[64:65], v54 offset:24576
    v_mfma_f32_16x16x32_bf16 v[160:163], a[12:15], a[36:39], v[160:163]
    ds_read_b64_tr_b16 a[66:67], v54 offset:25600
    v_mfma_f32_16x16x32_bf16 v[128:131], a[12:15], a[32:35], v[128:131]
    buffer_load_dwordx4 v41, s[16:19], s36 offen offset:1024 lds
    v_mfma_f32_16x16x32_bf16 v[132:135], a[16:19], a[32:35], v[132:135]
    ds_read_b64_tr_b16 a[68:69], v55 offset:24576
    v_mfma_f32_16x16x32_bf16 v[164:167], a[16:19], a[36:39], v[164:167]
    ds_read_b64_tr_b16 a[70:71], v55 offset:25600
    v_mfma_f32_16x16x32_bf16 v[196:199], a[16:19], a[40:43], v[196:199]
    ds_read_b64_tr_b16 a[72:73], v56 offset:24576
    v_mfma_f32_16x16x32_bf16 v[228:231], a[16:19], a[44:47], v[228:231]
    ds_read_b64_tr_b16 a[74:75], v56 offset:25600
    v_mfma_f32_16x16x32_bf16 v[232:235], a[20:23], a[44:47], v[232:235]
    buffer_load_dwordx4 v42, s[16:19], s36 offen offset:2048 lds
    v_mfma_f32_16x16x32_bf16 v[200:203], a[20:23], a[40:43], v[200:203]
    ds_read_b64_tr_b16 a[76:77], v57 offset:24576
    v_mfma_f32_16x16x32_bf16 v[168:171], a[20:23], a[36:39], v[168:171]
    ds_read_b64_tr_b16 a[78:79], v57 offset:25600
    v_mfma_f32_16x16x32_bf16 v[136:139], a[20:23], a[32:35], v[136:139]
    v_mfma_f32_16x16x32_bf16 v[140:143], a[24:27], a[32:35], v[140:143]
    v_mfma_f32_16x16x32_bf16 v[172:175], a[24:27], a[36:39], v[172:175]
    buffer_load_dwordx4 v43, s[16:19], s36 offen offset:3072 lds
    v_mfma_f32_16x16x32_bf16 v[204:207], a[24:27], a[40:43], v[204:207]
    v_mfma_f32_16x16x32_bf16 v[236:239], a[24:27], a[44:47], v[236:239]
    v_mfma_f32_16x16x32_bf16 v[240:243], a[28:31], a[44:47], v[240:243]
    v_mfma_f32_16x16x32_bf16 v[208:211], a[28:31], a[40:43], v[208:211]
    v_mfma_f32_16x16x32_bf16 v[176:179], a[28:31], a[36:39], v[176:179]
    v_mfma_f32_16x16x32_bf16 v[144:147], a[28:31], a[32:35], v[144:147]
    s_waitcnt vmcnt(12) lgkmcnt(0)
    s_barrier
    s_cmp_lg_u32 s5, 0
    s_cbranch_scc1 L_signalled
    s_mov_b64 exec, 1
    buffer_atomic_add v27, off, s[92:95], s74 sc1
    s_mov_b64 exec, -1
L_signalled:
    v_mfma_f32_16x16x32_bf16 v[100:103], a[48:51], v[32:35], v[100:103]
    ds_read_b64_tr_b16 a[0:1], v50 offset:32768
    v_mfma_f32_16x16x32_bf16 v[104:107], a[52:55], v[32:35], v[104:107]
    s_add_u32 m0, s39, 16384
    s_mov_b32 s37, 3670016
    ds_read_b64_tr_b16 a[2:3], v50 offset:33792
    v_mfma_f32_16x16x32_bf16 v[116:119], a[48:51], a[80:83], v[116:119]
    buffer_load_dwordx4 v44, s[20:23], s37 offen offset:0 lds
    v_mfma_f32_16x16x32_bf16 v[148:151], a[48:51], a[84:87], v[148:151]
    ds_read_b128 a[32:35], v48 offset:16384
    v_mfma_f32_16x16x32_bf16 v[180:183], a[48:51], a[88:91], v[180:183]
    ds_read_b128 a[36:39], v48 offset:18432
    v_mfma_f32_16x16x32_bf16 v[212:215], a[48:51], a[92:95], v[212:215]
    buffer_load_dwordx4 v45, s[20:23], s37 offen offset:1024 lds
    v_mfma_f32_16x16x32_bf16 v[216:219], a[52:55], a[92:95], v[216:219]
    ds_read_b128 a[40:43], v48 offset:20480
    v_mfma_f32_16x16x32_bf16 v[184:187], a[52:55], a[88:91], v[184:187]
    ds_read_b128 a[44:47], v48 offset:22528
    v_mfma_f32_16x16x32_bf16 v[152:155], a[52:55], a[84:87], v[152:155]
    ds_read_b64_tr_b16 a[4:5], v51 offset:32768
    v_mfma_f32_16x16x32_bf16 v[120:123], a[52:55], a[80:83], v[120:123]
    buffer_load_dwordx4 v46, s[20:23], s37 offen offset:2048 lds
    v_mfma_f32_16x16x32_bf16 v[124:127], a[56:59], a[80:83], v[124:127]
    ds_read_b64_tr_b16 a[6:7], v51 offset:33792
    v_mfma_f32_16x16x32_bf16 v[156:159], a[56:59], a[84:87], v[156:159]
    ds_read_b64_tr_b16 a[8:9], v52 offset:32768
    v_mfma_f32_16x16x32_bf16 v[188:191], a[56:59], a[88:91], v[188:191]
    ds_read_b64_tr_b16 a[10:11], v52 offset:33792
    v_mfma_f32_16x16x32_bf16 v[220:223], a[56:59], a[92:95], v[220:223]
    buffer_load_dwordx4 v47, s[20:23], s37 offen offset:3072 lds
    v_mfma_f32_16x16x32_bf16 v[224:227], a[60:63], a[92:95], v[224:227]
    ds_read_b64_tr_b16 a[12:13], v53 offset:32768
    v_mfma_f32_16x16x32_bf16 v[192:195], a[60:63], a[88:91], v[192:195]
    ds_read_b64_tr_b16 a[14:15], v53 offset:33792
    v_mfma_f32_16x16x32_bf16 v[160:163], a[60:63], a[84:87], v[160:163]
    s_add_u32 m0, s38, 8192
    s_mov_b32 s36, 896
    ds_read_b64_tr_b16 a[16:17], v54 offset:32768
    v_mfma_f32_16x16x32_bf16 v[128:131], a[60:63], a[80:83], v[128:131]
    buffer_load_dwordx4 v36, s[16:19], s36 offen offset:0 lds
    v_mfma_f32_16x16x32_bf16 v[132:135], a[64:67], a[80:83], v[132:135]
    ds_read_b64_tr_b16 a[18:19], v54 offset:33792
    v_mfma_f32_16x16x32_bf16 v[164:167], a[64:67], a[84:87], v[164:167]
    ds_read_b64_tr_b16 a[20:21], v55 offset:32768
    v_mfma_f32_16x16x32_bf16 v[196:199], a[64:67], a[88:91], v[196:199]
    buffer_load_dwordx4 v37, s[16:19], s36 offen offset:1024 lds
    v_mfma_f32_16x16x32_bf16 v[228:231], a[64:67], a[92:95], v[228:231]
    ds_read_b64_tr_b16 a[22:23], v55 offset:33792
    v_mfma_f32_16x16x32_bf16 v[232:235], a[68:71], a[92:95], v[232:235]
    ds_read_b64_tr_b16 a[24:25], v56 offset:32768
    v_mfma_f32_16x16x32_bf16 v[200:203], a[68:71], a[88:91], v[200:203]
    ds_read_b64_tr_b16 a[26:27], v56 offset:33792
    v_mfma_f32_16x16x32_bf16 v[168:171], a[68:71], a[84:87], v[168:171]
    buffer_load_dwordx4 v38, s[16:19], s36 offen offset:2048 lds
    v_mfma_f32_16x16x32_bf16 v[136:139], a[68:71], a[80:83], v[136:139]
    ds_read_b64_tr_b16 a[28:29], v57 offset:32768
    v_mfma_f32_16x16x32_bf16 v[140:143], a[72:75], a[80:83], v[140:143]
    ds_read_b64_tr_b16 a[30:31], v57 offset:33792
    v_mfma_f32_16x16x32_bf16 v[172:175], a[72:75], a[84:87], v[172:175]
    v_mfma_f32_16x16x32_bf16 v[204:207], a[72:75], a[88:91], v[204:207]
    buffer_load_dwordx4 v39, s[16:19], s36 offen offset:3072 lds
    v_mfma_f32_16x16x32_bf16 v[236:239], a[72:75], a[92:95], v[236:239]
    v_mfma_f32_16x16x32_bf16 v[240:243], a[76:79], a[92:95], v[240:243]
    v_mfma_f32_16x16x32_bf16 v[208:211], a[76:79], a[88:91], v[208:211]
    v_mfma_f32_16x16x32_bf16 v[176:179], a[76:79], a[84:87], v[176:179]
    v_mfma_f32_16x16x32_bf16 v[144:147], a[76:79], a[80:83], v[144:147]
    s_waitcnt lgkmcnt(0)
    v_mfma_f32_16x16x32_bf16 v[100:103], a[0:3], v[32:35], v[100:103]
    ds_read_b64_tr_b16 a[48:49], v50 offset:40960
    v_mfma_f32_16x16x32_bf16 v[104:107], a[4:7], v[32:35], v[104:107]
    s_add_u32 m0, s38, 12288
    ds_read_b64_tr_b16 a[50:51], v50 offset:41984
    v_mfma_f32_16x16x32_bf16 v[116:119], a[0:3], a[32:35], v[116:119]
    buffer_load_dwordx4 v40, s[16:19], s36 offen offset:0 lds
    v_mfma_f32_16x16x32_bf16 v[148:151], a[0:3], a[36:39], v[148:151]
    ds_read_b128 a[80:83], v49 offset:16384
    v_mfma_f32_16x16x32_bf16 v[180:183], a[0:3], a[40:43], v[180:183]
    ds_read_b128 a[84:87], v49 offset:18432
    v_mfma_f32_16x16x32_bf16 v[212:215], a[0:3], a[44:47], v[212:215]
    buffer_load_dwordx4 v41, s[16:19], s36 offen offset:1024 lds
    v_mfma_f32_16x16x32_bf16 v[216:219], a[4:7], a[44:47], v[216:219]
    ds_read_b128 a[88:91], v49 offset:20480
    v_mfma_f32_16x16x32_bf16 v[184:187], a[4:7], a[40:43], v[184:187]
    ds_read_b128 a[92:95], v49 offset:22528
    v_mfma_f32_16x16x32_bf16 v[152:155], a[4:7], a[36:39], v[152:155]
    ds_read_b64_tr_b16 a[52:53], v51 offset:40960
    v_mfma_f32_16x16x32_bf16 v[120:123], a[4:7], a[32:35], v[120:123]
    buffer_load_dwordx4 v42, s[16:19], s36 offen offset:2048 lds
    v_mfma_f32_16x16x32_bf16 v[124:127], a[8:11], a[32:35], v[124:127]
    ds_read_b64_tr_b16 a[54:55], v51 offset:41984
    v_mfma_f32_16x16x32_bf16 v[156:159], a[8:11], a[36:39], v[156:159]
    ds_read_b64_tr_b16 a[56:57], v52 offset:40960
    v_mfma_f32_16x16x32_bf16 v[188:191], a[8:11], a[40:43], v[188:191]
    ds_read_b64_tr_b16 a[58:59], v52 offset:41984
    v_mfma_f32_16x16x32_bf16 v[220:223], a[8:11], a[44:47], v[220:223]
    buffer_load_dwordx4 v43, s[16:19], s36 offen offset:3072 lds
    v_mfma_f32_16x16x32_bf16 v[224:227], a[12:15], a[44:47], v[224:227]
    ds_read_b64_tr_b16 a[60:61], v53 offset:40960
    v_mfma_f32_16x16x32_bf16 v[192:195], a[12:15], a[40:43], v[192:195]
    ds_read_b64_tr_b16 a[62:63], v53 offset:41984
    v_mfma_f32_16x16x32_bf16 v[160:163], a[12:15], a[36:39], v[160:163]
    s_add_u32 m0, s34, 49152
    ds_read_b64_tr_b16 a[64:65], v54 offset:40960
    v_mfma_f32_16x16x32_bf16 v[128:131], a[12:15], a[32:35], v[128:131]
    buffer_load_dwordx4 v13, s[8:11], s28 offen offset:0 lds
    v_mfma_f32_16x16x32_bf16 v[132:135], a[16:19], a[32:35], v[132:135]
    ds_read_b64_tr_b16 a[66:67], v54 offset:41984
    v_mfma_f32_16x16x32_bf16 v[164:167], a[16:19], a[36:39], v[164:167]
    ds_read_b64_tr_b16 a[68:69], v55 offset:40960
    v_mfma_f32_16x16x32_bf16 v[196:199], a[16:19], a[40:43], v[196:199]
    buffer_load_dwordx4 v14, s[8:11], s28 offen offset:1024 lds
    v_mfma_f32_16x16x32_bf16 v[228:231], a[16:19], a[44:47], v[228:231]
    ds_read_b64_tr_b16 a[70:71], v55 offset:41984
    v_mfma_f32_16x16x32_bf16 v[232:235], a[20:23], a[44:47], v[232:235]
    ds_read_b64_tr_b16 a[72:73], v56 offset:40960
    v_mfma_f32_16x16x32_bf16 v[200:203], a[20:23], a[40:43], v[200:203]
    ds_read_b64_tr_b16 a[74:75], v56 offset:41984
    v_mfma_f32_16x16x32_bf16 v[168:171], a[20:23], a[36:39], v[168:171]
    buffer_load_dwordx4 v15, s[8:11], s28 offen offset:2048 lds
    v_mfma_f32_16x16x32_bf16 v[136:139], a[20:23], a[32:35], v[136:139]
    ds_read_b64_tr_b16 a[76:77], v57 offset:40960
    v_mfma_f32_16x16x32_bf16 v[140:143], a[24:27], a[32:35], v[140:143]
    ds_read_b64_tr_b16 a[78:79], v57 offset:41984
    v_mfma_f32_16x16x32_bf16 v[172:175], a[24:27], a[36:39], v[172:175]
    v_mfma_f32_16x16x32_bf16 v[204:207], a[24:27], a[40:43], v[204:207]
    buffer_load_dwordx4 v16, s[8:11], s28 offen offset:3072 lds
    v_mfma_f32_16x16x32_bf16 v[236:239], a[24:27], a[44:47], v[236:239]
    v_mfma_f32_16x16x32_bf16 v[240:243], a[28:31], a[44:47], v[240:243]
    v_mfma_f32_16x16x32_bf16 v[208:211], a[28:31], a[40:43], v[208:211]
    v_mfma_f32_16x16x32_bf16 v[176:179], a[28:31], a[36:39], v[176:179]
    v_mfma_f32_16x16x32_bf16 v[144:147], a[28:31], a[32:35], v[144:147]
    s_add_u32 s28, s28, 16384
    s_waitcnt vmcnt(16) lgkmcnt(0)
    s_barrier
    v_mfma_f32_16x16x32_bf16 v[100:103], a[48:51], v[32:35], v[100:103]
    ds_read_b64_tr_b16 a[0:1], v50 offset:0
    v_mfma_f32_16x16x32_bf16 v[104:107], a[52:55], v[32:35], v[104:107]
    s_add_u32 m0, s39, 32768
    s_mov_b32 s37, 4194304
    ds_read_b64_tr_b16 a[2:3], v50 offset:1024
    v_mfma_f32_16x16x32_bf16 v[116:119], a[48:51], a[80:83], v[116:119]
    buffer_load_dwordx4 v44, s[20:23], s37 offen offset:0 lds
    v_mfma_f32_16x16x32_bf16 v[148:151], a[48:51], a[84:87], v[148:151]
    ds_read_b128 a[32:35], v48 offset:0
    v_mfma_f32_16x16x32_bf16 v[180:183], a[48:51], a[88:91], v[180:183]
    ds_read_b128 a[36:39], v48 offset:2048
    v_mfma_f32_16x16x32_bf16 v[212:215], a[48:51], a[92:95], v[212:215]
    ds_read_b128 a[40:43], v48 offset:4096
    v_mfma_f32_16x16x32_bf16 v[216:219], a[52:55], a[92:95], v[216:219]
    ds_read_b128 a[44:47], v48 offset:6144
    v_mfma_f32_16x16x32_bf16 v[184:187], a[52:55], a[88:91], v[184:187]
    buffer_load_dwordx4 v45, s[20:23], s37 offen offset:1024 lds
    v_mfma_f32_16x16x32_bf16 v[152:155], a[52:55], a[84:87], v[152:155]
    ds_read_b64_tr_b16 a[4:5], v51 offset:0
    v_mfma_f32_16x16x32_bf16 v[120:123], a[52:55], a[80:83], v[120:123]
    ds_read_b64_tr_b16 a[6:7], v51 offset:1024
    v_mfma_f32_16x16x32_bf16 v[124:127], a[56:59], a[80:83], v[124:127]
    ds_read_b64_tr_b16 a[8:9], v52 offset:0
    v_mfma_f32_16x16x32_bf16 v[156:159], a[56:59], a[84:87], v[156:159]
    ds_read_b64_tr_b16 a[10:11], v52 offset:1024
    v_mfma_f32_16x16x32_bf16 v[188:191], a[56:59], a[88:91], v[188:191]
    buffer_load_dwordx4 v46, s[20:23], s37 offen offset:2048 lds
    v_mfma_f32_16x16x32_bf16 v[220:223], a[56:59], a[92:95], v[220:223]
    ds_read_b64_tr_b16 a[12:13], v53 offset:0
    v_mfma_f32_16x16x32_bf16 v[224:227], a[60:63], a[92:95], v[224:227]
    ds_read_b64_tr_b16 a[14:15], v53 offset:1024
    v_mfma_f32_16x16x32_bf16 v[192:195], a[60:63], a[88:91], v[192:195]
    ds_read_b64_tr_b16 a[16:17], v54 offset:0
    v_mfma_f32_16x16x32_bf16 v[160:163], a[60:63], a[84:87], v[160:163]
    ds_read_b64_tr_b16 a[18:19], v54 offset:1024
    v_mfma_f32_16x16x32_bf16 v[128:131], a[60:63], a[80:83], v[128:131]
    buffer_load_dwordx4 v47, s[20:23], s37 offen offset:3072 lds
    v_mfma_f32_16x16x32_bf16 v[132:135], a[64:67], a[80:83], v[132:135]
    ds_read_b64_tr_b16 a[20:21], v55 offset:0
    v_mfma_f32_16x16x32_bf16 v[164:167], a[64:67], a[84:87], v[164:167]
    ds_read_b64_tr_b16 a[22:23], v55 offset:1024
    v_mfma_f32_16x16x32_bf16 v[196:199], a[64:67], a[88:91], v[196:199]
    ds_read_b64_tr_b16 a[24:25], v56 offset:0
    v_mfma_f32_16x16x32_bf16 v[228:231], a[64:67], a[92:95], v[228:231]
    s_add_u32 m0, s38, 16384
    s_mov_b32 s36, 1024
    ds_read_b64_tr_b16 a[26:27], v56 offset:1024
    v_mfma_f32_16x16x32_bf16 v[232:235], a[68:71], a[92:95], v[232:235]
    buffer_load_dwordx4 v36, s[16:19], s36 offen offset:0 lds
    v_mfma_f32_16x16x32_bf16 v[200:203], a[68:71], a[88:91], v[200:203]
    ds_read_b64_tr_b16 a[28:29], v57 offset:0
    v_mfma_f32_16x16x32_bf16 v[168:171], a[68:71], a[84:87], v[168:171]
    ds_read_b64_tr_b16 a[30:31], v57 offset:1024
    v_mfma_f32_16x16x32_bf16 v[136:139], a[68:71], a[80:83], v[136:139]
    v_mfma_f32_16x16x32_bf16 v[140:143], a[72:75], a[80:83], v[140:143]
    v_mfma_f32_16x16x32_bf16 v[172:175], a[72:75], a[84:87], v[172:175]
    buffer_load_dwordx4 v37, s[16:19], s36 offen offset:1024 lds
    v_mfma_f32_16x16x32_bf16 v[204:207], a[72:75], a[88:91], v[204:207]
    v_mfma_f32_16x16x32_bf16 v[236:239], a[72:75], a[92:95], v[236:239]
    v_mfma_f32_16x16x32_bf16 v[240:243], a[76:79], a[92:95], v[240:243]
    v_mfma_f32_16x16x32_bf16 v[208:211], a[76:79], a[88:91], v[208:211]
    v_mfma_f32_16x16x32_bf16 v[176:179], a[76:79], a[84:87], v[176:179]
    v_mfma_f32_16x16x32_bf16 v[144:147], a[76:79], a[80:83], v[144:147]
    s_waitcnt lgkmcnt(0)
    v_mfma_f32_16x16x32_bf16 v[100:103], a[0:3], v[32:35], v[100:103]
    ds_read_b64_tr_b16 a[48:49], v50 offset:8192
    v_mfma_f32_16x16x32_bf16 v[104:107], a[4:7], v[32:35], v[104:107]
    ds_read_b64_tr_b16 a[50:51], v50 offset:9216
    v_mfma_f32_16x16x32_bf16 v[116:119], a[0:3], a[32:35], v[116:119]
    buffer_load_dwordx4 v38, s[16:19], s36 offen offset:2048 lds
    v_mfma_f32_16x16x32_bf16 v[148:151], a[0:3], a[36:39], v[148:151]
    ds_read_b128 a[80:83], v49 offset:0
    v_mfma_f32_16x16x32_bf16 v[180:183], a[0:3], a[40:43], v[180:183]
    ds_read_b128 a[84:87], v49 offset:2048
    v_mfma_f32_16x16x32_bf16 v[212:215], a[0:3], a[44:47], v[212:215]
    ds_read_b128 a[88:91], v49 offset:4096
    v_mfma_f32_16x16x32_bf16 v[216:219], a[4:7], a[44:47], v[216:219]
    ds_read_b128 a[92:95], v49 offset:6144
    v_mfma_f32_16x16x32_bf16 v[184:187], a[4:7], a[40:43], v[184:187]
    buffer_load_dwordx4 v39, s[16:19], s36 offen offset:3072 lds
    v_mfma_f32_16x16x32_bf16 v[152:155], a[4:7], a[36:39], v[152:155]
    ds_read_b64_tr_b16 a[52:53], v51 offset:8192
    v_mfma_f32_16x16x32_bf16 v[120:123], a[4:7], a[32:35], v[120:123]
    ds_read_b64_tr_b16 a[54:55], v51 offset:9216
    v_mfma_f32_16x16x32_bf16 v[124:127], a[8:11], a[32:35], v[124:127]
    ds_read_b64_tr_b16 a[56:57], v52 offset:8192
    v_mfma_f32_16x16x32_bf16 v[156:159], a[8:11], a[36:39], v[156:159]
    s_add_u32 m0, s38, 20480
    ds_read_b64_tr_b16 a[58:59], v52 offset:9216
    v_mfma_f32_16x16x32_bf16 v[188:191], a[8:11], a[40:43], v[188:191]
    buffer_load_dwordx4 v40, s[16:19], s36 offen offset:0 lds
    v_mfma_f32_16x16x32_bf16 v[220:223], a[8:11], a[44:47], v[220:223]
    ds_read_b64_tr_b16 a[60:61], v53 offset:8192
    v_mfma_f32_16x16x32_bf16 v[224:227], a[12:15], a[44:47], v[224:227]
    ds_read_b64_tr_b16 a[62:63], v53 offset:9216
    v_mfma_f32_16x16x32_bf16 v[192:195], a[12:15], a[40:43], v[192:195]
    ds_read_b64_tr_b16 a[64:65], v54 offset:8192
    v_mfma_f32_16x16x32_bf16 v[160:163], a[12:15], a[36:39], v[160:163]
    ds_read_b64_tr_b16 a[66:67], v54 offset:9216
    v_mfma_f32_16x16x32_bf16 v[128:131], a[12:15], a[32:35], v[128:131]
    buffer_load_dwordx4 v41, s[16:19], s36 offen offset:1024 lds
    v_mfma_f32_16x16x32_bf16 v[132:135], a[16:19], a[32:35], v[132:135]
    ds_read_b64_tr_b16 a[68:69], v55 offset:8192
    v_mfma_f32_16x16x32_bf16 v[164:167], a[16:19], a[36:39], v[164:167]
    ds_read_b64_tr_b16 a[70:71], v55 offset:9216
    v_mfma_f32_16x16x32_bf16 v[196:199], a[16:19], a[40:43], v[196:199]
    ds_read_b64_tr_b16 a[72:73], v56 offset:8192
    v_mfma_f32_16x16x32_bf16 v[228:231], a[16:19], a[44:47], v[228:231]
    ds_read_b64_tr_b16 a[74:75], v56 offset:9216
    v_mfma_f32_16x16x32_bf16 v[232:235], a[20:23], a[44:47], v[232:235]
    buffer_load_dwordx4 v42, s[16:19], s36 offen offset:2048 lds
    v_mfma_f32_16x16x32_bf16 v[200:203], a[20:23], a[40:43], v[200:203]
    ds_read_b64_tr_b16 a[76:77], v57 offset:8192
    v_mfma_f32_16x16x32_bf16 v[168:171], a[20:23], a[36:39], v[168:171]
    ds_read_b64_tr_b16 a[78:79], v57 offset:9216
    v_mfma_f32_16x16x32_bf16 v[136:139], a[20:23], a[32:35], v[136:139]
    v_mfma_f32_16x16x32_bf16 v[140:143], a[24:27], a[32:35], v[140:143]
    v_mfma_f32_16x16x32_bf16 v[172:175], a[24:27], a[36:39], v[172:175]
    buffer_load_dwordx4 v43, s[16:19], s36 offen offset:3072 lds
    v_mfma_f32_16x16x32_bf16 v[204:207], a[24:27], a[40:43], v[204:207]
    v_mfma_f32_16x16x32_bf16 v[236:239], a[24:27], a[44:47], v[236:239]
    v_mfma_f32_16x16x32_bf16 v[240:243], a[28:31], a[44:47], v[240:243]
    v_mfma_f32_16x16x32_bf16 v[208:211], a[28:31], a[40:43], v[208:211]
    v_mfma_f32_16x16x32_bf16 v[176:179], a[28:31], a[36:39], v[176:179]
    v_mfma_f32_16x16x32_bf16 v[144:147], a[28:31], a[32:35], v[144:147]
    s_waitcnt vmcnt(16) lgkmcnt(0)
    s_barrier
    v_mfma_f32_16x16x32_bf16 v[100:103], a[48:51], v[32:35], v[100:103]
    ds_read_b64_tr_b16 a[0:1], v50 offset:16384
    v_mfma_f32_16x16x32_bf16 v[104:107], a[52:55], v[32:35], v[104:107]
    s_add_u32 m0, s39, 0
    s_mov_b32 s37, 4718592
    ds_read_b64_tr_b16 a[2:3], v50 offset:17408
    v_mfma_f32_16x16x32_bf16 v[116:119], a[48:51], a[80:83], v[116:119]
    buffer_load_dwordx4 v44, s[20:23], s37 offen offset:0 lds
    v_mfma_f32_16x16x32_bf16 v[148:151], a[48:51], a[84:87], v[148:151]
    ds_read_b128 a[32:35], v48 offset:8192
    v_mfma_f32_16x16x32_bf16 v[180:183], a[48:51], a[88:91], v[180:183]
    ds_read_b128 a[36:39], v48 offset:10240
    v_mfma_f32_16x16x32_bf16 v[212:215], a[48:51], a[92:95], v[212:215]
    ds_read_b128 a[40:43], v48 offset:12288
    v_mfma_f32_16x16x32_bf16 v[216:219], a[52:55], a[92:95], v[216:219]
    ds_read_b128 a[44:47], v48 offset:14336
    v_mfma_f32_16x16x32_bf16 v[184:187], a[52:55], a[88:91], v[184:187]
    buffer_load_dwordx4 v45, s[20:23], s37 offen offset:1024 lds
    v_mfma_f32_16x16x32_bf16 v[152:155], a[52:55], a[84:87], v[152:155]
    ds_read_b64_tr_b16 a[4:5], v51 offset:16384
    v_mfma_f32_16x16x32_bf16 v[120:123], a[52:55], a[80:83], v[120:123]
    ds_read_b64_tr_b16 a[6:7], v51 offset:17408
    v_mfma_f32_16x16x32_bf16 v[124:127], a[56:59], a[80:83], v[124:127]
    ds_read_b64_tr_b16 a[8:9], v52 offset:16384
    v_mfma_f32_16x16x32_bf16 v[156:159], a[56:59], a[84:87], v[156:159]
    ds_read_b64_tr_b16 a[10:11], v52 offset:17408
    v_mfma_f32_16x16x32_bf16 v[188:191], a[56:59], a[88:91], v[188:191]
    buffer_load_dwordx4 v46, s[20:23], s37 offen offset:2048 lds
    v_mfma_f32_16x16x32_bf16 v[220:223], a[56:59], a[92:95], v[220:223]
    ds_read_b64_tr_b16 a[12:13], v53 offset:16384
    v_mfma_f32_16x16x32_bf16 v[224:227], a[60:63], a[92:95], v[224:227]
    ds_read_b64_tr_b16 a[14:15], v53 offset:17408
    v_mfma_f32_16x16x32_bf16 v[192:195], a[60:63], a[88:91], v[192:195]
    ds_read_b64_tr_b16 a[16:17], v54 offset:16384
    v_mfma_f32_16x16x32_bf16 v[160:163], a[60:63], a[84:87], v[160:163]
    ds_read_b64_tr_b16 a[18:19], v54 offset:17408
    v_mfma_f32_16x16x32_bf16 v[128:131], a[60:63], a[80:83], v[128:131]
    buffer_load_dwordx4 v47, s[20:23], s37 offen offset:3072 lds
    v_mfma_f32_16x16x32_bf16 v[132:135], a[64:67], a[80:83], v[132:135]
    ds_read_b64_tr_b16 a[20:21], v55 offset:16384
    v_mfma_f32_16x16x32_bf16 v[164:167], a[64:67], a[84:87], v[164:167]
    ds_read_b64_tr_b16 a[22:23], v55 offset:17408
    v_mfma_f32_16x16x32_bf16 v[196:199], a[64:67], a[88:91], v[196:199]
    ds_read_b64_tr_b16 a[24:25], v56 offset:16384
    v_mfma_f32_16x16x32_bf16 v[228:231], a[64:67], a[92:95], v[228:231]
    s_add_u32 m0, s38, 0
    s_mov_b32 s36, 1152
    ds_read_b64_tr_b16 a[26:27], v56 offset:17408
    v_mfma_f32_16x16x32_bf16 v[232:235], a[68:71], a[92:95], v[232:235]
    buffer_load_dword v252, off, s[92:95], s74 sc1
    buffer_load_dwordx4 v36, s[16:19], s36 offen offset:0 lds
    v_mfma_f32_16x16x32_bf16 v[200:203], a[68:71], a[88:91], v[200:203]
    ds_read_b64_tr_b16 a[28:29], v57 offset:16384
    v_mfma_f32_16x16x32_bf16 v[168:171], a[68:71], a[84:87], v[168:171]
    ds_read_b64_tr_b16 a[30:31], v57 offset:17408
    v_mfma_f32_16x16x32_bf16 v[136:139], a[68:71], a[80:83], v[136:139]
    v_mfma_f32_16x16x32_bf16 v[140:143], a[72:75], a[80:83], v[140:143]
    v_mfma_f32_16x16x32_bf16 v[172:175], a[72:75], a[84:87], v[172:175]
    buffer_load_dwordx4 v37, s[16:19], s36 offen offset:1024 lds
    v_mfma_f32_16x16x32_bf16 v[204:207], a[72:75], a[88:91], v[204:207]
    v_mfma_f32_16x16x32_bf16 v[236:239], a[72:75], a[92:95], v[236:239]
    v_mfma_f32_16x16x32_bf16 v[240:243], a[76:79], a[92:95], v[240:243]
    v_mfma_f32_16x16x32_bf16 v[208:211], a[76:79], a[88:91], v[208:211]
    v_mfma_f32_16x16x32_bf16 v[176:179], a[76:79], a[84:87], v[176:179]
    v_mfma_f32_16x16x32_bf16 v[144:147], a[76:79], a[80:83], v[144:147]
    s_waitcnt lgkmcnt(0)
    v_mfma_f32_16x16x32_bf16 v[100:103], a[0:3], v[32:35], v[100:103]
    ds_read_b64_tr_b16 a[48:49], v50 offset:24576
    v_mfma_f32_16x16x32_bf16 v[104:107], a[4:7], v[32:35], v[104:107]
    ds_read_b64_tr_b16 a[50:51], v50 offset:25600
    v_mfma_f32_16x16x32_bf16 v[116:119], a[0:3], a[32:35], v[116:119]
    buffer_load_dwordx4 v38, s[16:19], s36 offen offset:2048 lds
    v_mfma_f32_16x16x32_bf16 v[148:151], a[0:3], a[36:39], v[148:151]
    ds_read_b128 a[80:83], v49 offset:8192
    v_mfma_f32_16x16x32_bf16 v[180:183], a[0:3], a[40:43], v[180:183]
    ds_read_b128 a[84:87], v49 offset:10240
    v_mfma_f32_16x16x32_bf16 v[212:215], a[0:3], a[44:47], v[212:215]
    ds_read_b128 a[88:91], v49 offset:12288
    v_mfma_f32_16x16x32_bf16 v[216:219], a[4:7], a[44:47], v[216:219]
    ds_read_b128 a[92:95], v49 offset:14336
    v_mfma_f32_16x16x32_bf16 v[184:187], a[4:7], a[40:43], v[184:187]
    buffer_load_dwordx4 v39, s[16:19], s36 offen offset:3072 lds
    v_mfma_f32_16x16x32_bf16 v[152:155], a[4:7], a[36:39], v[152:155]
    ds_read_b64_tr_b16 a[52:53], v51 offset:24576
    v_mfma_f32_16x16x32_bf16 v[120:123], a[4:7], a[32:35], v[120:123]
    ds_read_b64_tr_b16 a[54:55], v51 offset:25600
    v_mfma_f32_16x16x32_bf16 v[124:127], a[8:11], a[32:35], v[124:127]
    ds_read_b64_tr_b16 a[56:57], v52 offset:24576
    v_mfma_f32_16x16x32_bf16 v[156:159], a[8:11], a[36:39], v[156:159]
    s_add_u32 m0, s38, 4096
    ds_read_b64_tr_b16 a[58:59], v52 offset:25600
    v_mfma_f32_16x16x32_bf16 v[188:191], a[8:11], a[40:43], v[188:191]
    buffer_load_dwordx4 v40, s[16:19], s36 offen offset:0 lds
    v_mfma_f32_16x16x32_bf16 v[220:223], a[8:11], a[44:47], v[220:223]
    ds_read_b64_tr_b16 a[60:61], v53 offset:24576
    v_mfma_f32_16x16x32_bf16 v[224:227], a[12:15], a[44:47], v[224:227]
    ds_read_b64_tr_b16 a[62:63], v53 offset:25600
    v_mfma_f32_16x16x32_bf16 v[192:195], a[12:15], a[40:43], v[192:195]
    ds_read_b64_tr_b16 a[64:65], v54 offset:24576
    v_mfma_f32_16x16x32_bf16 v[160:163], a[12:15], a[36:39], v[160:163]
    ds_read_b64_tr_b16 a[66:67], v54 offset:25600
    v_mfma_f32_16x16x32_bf16 v[128:131], a[12:15], a[32:35], v[128:131]
    buffer_load_dwordx4 v41, s[16:19], s36 offen offset:1024 lds
    v_mfma_f32_16x16x32_bf16 v[132:135], a[16:19], a[32:35], v[132:135]
    ds_read_b64_tr_b16 a[68:69], v55 offset:24576
    v_mfma_f32_16x16x32_bf16 v[164:167], a[16:19], a[36:39], v[164:167]
    ds_read_b64_tr_b16 a[70:71], v55 offset:25600
    v_mfma_f32_16x16x32_bf16 v[196:199], a[16:19], a[40:43], v[196:199]
    ds_read_b64_tr_b16 a[72:73], v56 offset:24576
    v_mfma_f32_16x16x32_bf16 v[228:231], a[16:19], a[44:47], v[228:231]
    ds_read_b64_tr_b16 a[74:75], v56 offset:25600
    v_mfma_f32_16x16x32_bf16 v[232:235], a[20:23], a[44:47], v[232:235]
    buffer_load_dwordx4 v42, s[16:19], s36 offen offset:2048 lds
    v_mfma_f32_16x16x32_bf16 v[200:203], a[20:23], a[40:43], v[200:203]
    ds_read_b64_tr_b16 a[76:77], v57 offset:24576
    v_mfma_f32_16x16x32_bf16 v[168:171], a[20:23], a[36:39], v[168:171]
    ds_read_b64_tr_b16 a[78:79], v57 offset:25600
    v_mfma_f32_16x16x32_bf16 v[136:139], a[20:23], a[32:35], v[136:139]
    v_mfma_f32_16x16x32_bf16 v[140:143], a[24:27], a[32:35], v[140:143]
    v_mfma_f32_16x16x32_bf16 v[172:175], a[24:27], a[36:39], v[172:175]
    buffer_load_dwordx4 v43, s[16:19], s36 offen offset:3072 lds
    v_mfma_f32_16x16x32_bf16 v[204:207], a[24:27], a[40:43], v[204:207]
    v_mfma_f32_16x16x32_bf16 v[236:239], a[24:27], a[44:47], v[236:239]
    v_mfma_f32_16x16x32_bf16 v[240:243], a[28:31], a[44:47], v[240:243]
    v_mfma_f32_16x16x32_bf16 v[208:211], a[28:31], a[40:43], v[208:211]
    v_mfma_f32_16x16x32_bf16 v[176:179], a[28:31], a[36:39], v[176:179]
    v_mfma_f32_16x16x32_bf16 v[144:147], a[28:31], a[32:35], v[144:147]
    s_waitcnt vmcnt(13) lgkmcnt(0)
    s_barrier
    v_mfma_f32_16x16x32_bf16 v[100:103], a[48:51], v[32:35], v[100:103]
    ds_read_b64_tr_b16 a[0:1], v50 offset:32768
    v_mfma_f32_16x16x32_bf16 v[104:107], a[52:55], v[32:35], v[104:107]
    s_add_u32 m0, s34, 16384
    ds_read_b64_tr_b16 a[2:3], v50 offset:33792
    v_mfma_f32_16x16x32_bf16 v[116:119], a[48:51], a[80:83], v[116:119]
    buffer_load_dwordx4 v13, s[8:11], s28 offen offset:0 lds
    v_mfma_f32_16x16x32_bf16 v[148:151], a[48:51], a[84:87], v[148:151]
    ds_read_b128 a[32:35], v48 offset:16384
    v_mfma_f32_16x16x32_bf16 v[180:183], a[48:51], a[88:91], v[180:183]
    ds_read_b128 a[36:39], v48 offset:18432
    v_mfma_f32_16x16x32_bf16 v[212:215], a[48:51], a[92:95], v[212:215]
    ds_read_b128 a[40:43], v48 offset:20480
    v_mfma_f32_16x16x32_bf16 v[216:219], a[52:55], a[92:95], v[216:219]
    ds_read_b128 a[44:47], v48 offset:22528
    v_mfma_f32_16x16x32_bf16 v[184:187], a[52:55], a[88:91], v[184:187]
    ds_read_b64_tr_b16 a[4:5], v51 offset:32768
    v_mfma_f32_16x16x32_bf16 v[152:155], a[52:55], a[84:87], v[152:155]
    ds_read_b64_tr_b16 a[6:7], v51 offset:33792
    v_mfma_f32_16x16x32_bf16 v[120:123], a[52:55], a[80:83], v[120:123]
    ds_read_b64_tr_b16 a[8:9], v52 offset:32768
    v_mfma_f32_16x16x32_bf16 v[124:127], a[56:59], a[80:83], v[124:127]
    ds_read_b64_tr_b16 a[10:11], v52 offset:33792
    v_mfma_f32_16x16x32_bf16 v[156:159], a[56:59], a[84:87], v[156:159]
    ds_read_b64_tr_b16 a[12:13], v53 offset:32768
    v_mfma_f32_16x16x32_bf16 v[188:191], a[56:59], a[88:91], v[188:191]
    ds_read_b64_tr_b16 a[14:15], v53 offset:33792
    v_mfma_f32_16x16x32_bf16 v[220:223], a[56:59], a[92:95], v[220:223]
    ds_read_b64_tr_b16 a[16:17], v54 offset:32768
    v_mfma_f32_16x16x32_bf16 v[224:227], a[60:63], a[92:95], v[224:227]
    ds_read_b64_tr_b16 a[18:19], v54 offset:33792
    v_mfma_f32_16x16x32_bf16 v[192:195], a[60:63], a[88:91], v[192:195]
    ds_read_b64_tr_b16 a[20:21], v55 offset:32768
    v_mfma_f32_16x16x32_bf16 v[160:163], a[60:63], a[84:87], v[160:163]
    ds_read_b64_tr_b16 a[22:23], v55 offset:33792
    v_mfma_f32_16x16x32_bf16 v[128:131], a[60:63], a[80:83], v[128:131]
    buffer_load_dwordx4 v14, s[8:11], s28 offen offset:1024 lds
    v_mfma_f32_16x16x32_bf16 v[132:135], a[64:67], a[80:83], v[132:135]
    ds_read_b64_tr_b16 a[24:25], v56 offset:32768
    v_mfma_f32_16x16x32_bf16 v[164:167], a[64:67], a[84:87], v[164:167]
    ds_read_b64_tr_b16 a[26:27], v56 offset:33792
    v_mfma_f32_16x16x32_bf16 v[196:199], a[64:67], a[88:91], v[196:199]
    ds_read_b64_tr_b16 a[28:29], v57 offset:32768
    v_mfma_f32_16x16x32_bf16 v[228:231], a[64:67], a[92:95], v[228:231]
    s_waitcnt vmcnt(10)
    v_cmp_gt_u32 vcc, 32, v252
    s_and_b64 vcc, vcc, exec
    s_cbranch_scc1 L_spin_rows
L_back_rows:
    buffer_load_dwordx2 v[108:109], v59, s[76:79], s46 offen offset:0 sc1
    buffer_load_dwordx2 v[110:111], v59, s[76:79], s46 offen offset:256 sc1
    buffer_load_dwordx2 v[112:113], v59, s[76:79], s46 offen offset:512 sc1
    buffer_load_dwordx2 v[114:115], v59, s[76:79], s46 offen offset:768 sc1
    ds_read_b64_tr_b16 a[30:31], v57 offset:33792
    v_mfma_f32_16x16x32_bf16 v[232:235], a[68:71], a[92:95], v[232:235]
    v_mfma_f32_16x16x32_bf16 v[200:203], a[68:71], a[88:91], v[200:203]
    v_mfma_f32_16x16x32_bf16 v[168:171], a[68:71], a[84:87], v[168:171]
    v_mfma_f32_16x16x32_bf16 v[136:139], a[68:71], a[80:83], v[136:139]
    v_mfma_f32_16x16x32_bf16 v[140:143], a[72:75], a[80:83], v[140:143]
    v_mfma_f32_16x16x32_bf16 v[172:175], a[72:75], a[84:87], v[172:175]
    v_mfma_f32_16x16x32_bf16 v[204:207], a[72:75], a[88:91], v[204:207]
    v_mfma_f32_16x16x32_bf16 v[236:239], a[72:75], a[92:95], v[236:239]
    v_mfma_f32_16x16x32_bf16 v[240:243], a[76:79], a[92:95], v[240:243]
    v_mfma_f32_16x16x32_bf16 v[208:211], a[76:79], a[88:91], v[208:211]
    v_mfma_f32_16x16x32_bf16 v[176:179], a[76:79], a[84:87], v[176:179]
    v_mfma_f32_16x16x32_bf16 v[144:147], a[76:79], a[80:83], v[144:147]
    s_waitcnt lgkmcnt(0)
    v_mfma_f32_16x16x32_bf16 v[100:103], a[0:3], v[32:35], v[100:103]
    ds_read_b64_tr_b16 a[48:49], v50 offset:40960
    v_mfma_f32_16x16x32_bf16 v[104:107], a[4:7], v[32:35], v[104:107]
    ds_read_b64_tr_b16 a[50:51], v50 offset:41984
    v_mfma_f32_16x16x32_bf16 v[116:119], a[0:3], a[32:35], v[116:119]
    buffer_load_dwordx4 v15, s[8:11], s28 offen offset:2048 lds
    v_mfma_f32_16x16x32_bf16 v[148:151], a[0:3], a[36:39], v[148:151]
    ds_read_b128 a[80:83], v49 offset:16384
    v_mfma_f32_16x16x32_bf16 v[180:183], a[0:3], a[40:43], v[180:183]
    ds_read_b128 a[84:87], v49 offset:18432
    v_mfma_f32_16x16x32_bf16 v[212:215], a[0:3], a[44:47], v[212:215]
    ds_read_b128 a[88:91], v49 offset:20480
    v_mfma_f32_16x16x32_bf16 v[216:219], a[4:7], a[44:47], v[216:219]
    ds_read_b128 a[92:95], v49 offset:22528
    v_mfma_f32_16x16x32_bf16 v[184:187], a[4:7], a[40:43], v[184:187]
    ds_read_b64_tr_b16 a[52:53], v51 offset:40960
    v_mfma_f32_16x16x32_bf16 v[152:155], a[4:7], a[36:39], v[152:155]
    ds_read_b64_tr_b16 a[54:55], v51 offset:41984
    v_mfma_f32_16x16x32_bf16 v[120:123], a[4:7], a[32:35], v[120:123]
    ds_read_b64_tr_b16 a[56:57], v52 offset:40960
    v_mfma_f32_16x16x32_bf16 v[124:127], a[8:11], a[32:35], v[124:127]
    ds_read_b64_tr_b16 a[58:59], v52 offset:41984
    v_mfma_f32_16x16x32_bf16 v[156:159], a[8:11], a[36:39], v[156:159]
    ds_read_b64_tr_b16 a[60:61], v53 offset:40960
    v_mfma_f32_16x16x32_bf16 v[188:191], a[8:11], a[40:43], v[188:191]
    ds_read_b64_tr_b16 a[62:63], v53 offset:41984
    v_mfma_f32_16x16x32_bf16 v[220:223], a[8:11], a[44:47], v[220:223]
    ds_read_b64_tr_b16 a[64:65], v54 offset:40960
    v_mfma_f32_16x16x32_bf16 v[224:227], a[12:15], a[44:47], v[224:227]
    ds_read_b64_tr_b16 a[66:67], v54 offset:41984
    v_mfma_f32_16x16x32_bf16 v[192:195], a[12:15], a[40:43], v[192:195]
    ds_read_b64_tr_b16 a[68:69], v55 offset:40960
    v_mfma_f32_16x16x32_bf16 v[160:163], a[12:15], a[36:39], v[160:163]
    ds_read_b64_tr_b16 a[70:71], v55 offset:41984
    v_mfma_f32_16x16x32_bf16 v[128:131], a[12:15], a[32:35], v[128:131]
    buffer_load_dwordx4 v16, s[8:11], s28 offen offset:3072 lds
    v_mfma_f32_16x16x32_bf16 v[132:135], a[16:19], a[32:35], v[132:135]
    ds_read_b64_tr_b16 a[72:73], v56 offset:40960
    v_mfma_f32_16x16x32_bf16 v[164:167], a[16:19], a[36:39], v[164:167]
    ds_read_b64_tr_b16 a[74:75], v56 offset:41984
    v_mfma_f32_16x16x32_bf16 v[196:199], a[16:19], a[40:43], v[196:199]
    ds_read_b64_tr_b16 a[76:77], v57 offset:40960
    v_mfma_f32_16x16x32_bf16 v[228:231], a[16:19], a[44:47], v[228:231]
    ds_read_b64_tr_b16 a[78:79], v57 offset:41984
    v_mfma_f32_16x16x32_bf16 v[232:235], a[20:23], a[44:47], v[232:235]
    v_mfma_f32_16x16x32_bf16 v[200:203], a[20:23], a[40:43], v[200:203]
    v_mfma_f32_16x16x32_bf16 v[168:171], a[20:23], a[36:39], v[168:171]
    v_mfma_f32_16x16x32_bf16 v[136:139], a[20:23], a[32:35], v[136:139]
    v_mfma_f32_16x16x32_bf16 v[140:143], a[24:27], a[32:35], v[140:143]
    v_mfma_f32_16x16x32_bf16 v[172:175], a[24:27], a[36:39], v[172:175]
    v_mfma_f32_16x16x32_bf16 v[204:207], a[24:27], a[40:43], v[204:207]
    v_mfma_f32_16x16x32_bf16 v[236:239], a[24:27], a[44:47], v[236:239]
    v_mfma_f32_16x16x32_bf16 v[240:243], a[28:31], a[44:47], v[240:243]
    v_mfma_f32_16x16x32_bf16 v[208:211], a[28:31], a[40:43], v[208:211]
    v_mfma_f32_16x16x32_bf16 v[176:179], a[28:31], a[36:39], v[176:179]
    v_mfma_f32_16x16x32_bf16 v[144:147], a[28:31], a[32:35], v[144:147]
    s_add_u32 s28, s28, 16384
    s_waitcnt vmcnt(8) lgkmcnt(0)
    s_barrier
    v_mfma_f32_16x16x32_bf16 v[100:103], a[48:51], v[32:35], v[100:103]
    ds_read_b64_tr_b16 a[0:1], v50 offset:0
    v_mfma_f32_16x16x32_bf16 v[104:107], a[52:55], v[32:35], v[104:107]
    s_add_u32 m0, s34, 32768
    ds_read_b64_tr_b16 a[2:3], v50 offset:1024
    v_mfma_f32_16x16x32_bf16 v[116:119], a[48:51], a[80:83], v[116:119]
    buffer_load_dwordx4 v13, s[8:11], s28 offen offset:0 lds
    v_mfma_f32_16x16x32_bf16 v[148:151], a[48:51], a[84:87], v[148:151]
    ds_read_b128 a[32:35], v48 offset:0
    v_mfma_f32_16x16x32_bf16 v[180:183], a[48:51], a[88:91], v[180:183]
    ds_read_b128 a[36:39], v48 offset:2048
    v_mfma_f32_16x16x32_bf16 v[212:215], a[48:51], a[92:95], v[212:215]
    ds_read_b128 a[40:43], v48 offset:4096
    v_mfma_f32_16x16x32_bf16 v[216:219], a[52:55], a[92:95], v[216:219]
    ds_read_b128 a[44:47], v48 offset:6144
    v_mfma_f32_16x16x32_bf16 v[184:187], a[52:55], a[88:91], v[184:187]
    ds_read_b64_tr_b16 a[4:5], v51 offset:0
    v_mfma_f32_16x16x32_bf16 v[152:155], a[52:55], a[84:87], v[152:155]
    ds_read_b64_tr_b16 a[6:7], v51 offset:1024
    v_mfma_f32_16x16x32_bf16 v[120:123], a[52:55], a[80:83], v[120:123]
    buffer_load_dwordx4 v14, s[8:11], s28 offen offset:1024 lds
    v_mfma_f32_16x16x32_bf16 v[124:127], a[56:59], a[80:83], v[124:127]
    ds_read_b64_tr_b16 a[8:9], v52 offset:0
    v_mfma_f32_16x16x32_bf16 v[156:159], a[56:59], a[84:87], v[156:159]
    ds_read_b64_tr_b16 a[10:11], v52 offset:1024
    v_mfma_f32_16x16x32_bf16 v[188:191], a[56:59], a[88:91], v[188:191]
    ds_read_b64_tr_b16 a[12:13], v53 offset:0
    v_mfma_f32_16x16x32_bf16 v[220:223], a[56:59], a[92:95], v[220:223]
    ds_read_b64_tr_b16 a[14:15], v53 offset:1024
    v_mfma_f32_16x16x32_bf16 v[224:227], a[60:63], a[92:95], v[224:227]
    ds_read_b64_tr_b16 a[16:17], v54 offset:0
    v_mfma_f32_16x16x32_bf16 v[192:195], a[60:63], a[88:91], v[192:195]
    ds_read_b64_tr_b16 a[18:19], v54 offset:1024
    v_mfma_f32_16x16x32_bf16 v[160:163], a[60:63], a[84:87], v[160:163]
    ds_read_b64_tr_b16 a[20:21], v55 offset:0
    v_mfma_f32_16x16x32_bf16 v[128:131], a[60:63], a[80:83], v[128:131]
    buffer_load_dwordx4 v15, s[8:11], s28 offen offset:2048 lds
    v_mfma_f32_16x16x32_bf16 v[132:135], a[64:67], a[80:83], v[132:135]
    ds_read_b64_tr_b16 a[22:23], v55 offset:1024
    v_mfma_f32_16x16x32_bf16 v[164:167], a[64:67], a[84:87], v[164:167]
    ds_read_b64_tr_b16 a[24:25], v56 offset:0
    v_mfma_f32_16x16x32_bf16 v[196:199], a[64:67], a[88:91], v[196:199]
    ds_read_b64_tr_b16 a[26:27], v56 offset:1024
    v_mfma_f32_16x16x32_bf16 v[228:231], a[64:67], a[92:95], v[228:231]
    ds_read_b64_tr_b16 a[28:29], v57 offset:0
    v_mfma_f32_16x16x32_bf16 v[232:235], a[68:71], a[92:95], v[232:235]
    ds_read_b64_tr_b16 a[30:31], v57 offset:1024
    v_mfma_f32_16x16x32_bf16 v[200:203], a[68:71], a[88:91], v[200:203]
    v_mfma_f32_16x16x32_bf16 v[168:171], a[68:71], a[84:87], v[168:171]
    buffer_load_dwordx4 v16, s[8:11], s28 offen offset:3072 lds
    v_mfma_f32_16x16x32_bf16 v[136:139], a[68:71], a[80:83], v[136:139]
    v_mfma_f32_16x16x32_bf16 v[140:143], a[72:75], a[80:83], v[140:143]
    v_mfma_f32_16x16x32_bf16 v[172:175], a[72:75], a[84:87], v[172:175]
    v_mfma_f32_16x16x32_bf16 v[204:207], a[72:75], a[88:91], v[204:207]
    v_mfma_f32_16x16x32_bf16 v[236:239], a[72:75], a[92:95], v[236:239]
    v_mfma_f32_16x16x32_bf16 v[240:243], a[76:79], a[92:95], v[240:243]
    v_mfma_f32_16x16x32_bf16 v[208:211], a[76:79], a[88:91], v[208:211]
    v_mfma_f32_16x16x32_bf16 v[176:179], a[76:79], a[84:87], v[176:179]
    v_mfma_f32_16x16x32_bf16 v[144:147], a[76:79], a[80:83], v[144:147]
    s_waitcnt lgkmcnt(0)
    v_mfma_f32_16x16x32_bf16 v[100:103], a[0:3], v[32:35], v[100:103]
    ds_read_b64_tr_b16 a[48:49], v50 offset:8192
    v_mfma_f32_16x16x32_bf16 v[104:107], a[4:7], v[32:35], v[104:107]
    s_add_u32 s28, s28, 16384
    s_mov_b32 m0, s30
    ds_read_b64_tr_b16 a[50:51], v50 offset:9216
    v_mfma_f32_16x16x32_bf16 v[116:119], a[0:3], a[32:35], v[116:119]
    buffer_load_dwordx4 v17, s[12:15], s29 offen offset:0 lds
    v_mfma_f32_16x16x32_bf16 v[148:151], a[0:3], a[36:39], v[148:151]
    ds_read_b64_tr_b16 a[52:53], v51 offset:8192
    v_mfma_f32_16x16x32_bf16 v[180:183], a[0:3], a[40:43], v[180:183]
    ds_read_b64_tr_b16 a[54:55], v51 offset:9216
    v_mfma_f32_16x16x32_bf16 v[212:215], a[0:3], a[44:47], v[212:215]
    ds_read_b128 a[80:83], v49 offset:0
    v_mfma_f32_16x16x32_bf16 v[216:219], a[4:7], a[44:47], v[216:219]
    ds_read_b128 a[84:87], v49 offset:2048
    v_mfma_f32_16x16x32_bf16 v[184:187], a[4:7], a[40:43], v[184:187]
    ds_read_b128 a[88:91], v49 offset:4096
    v_mfma_f32_16x16x32_bf16 v[152:155], a[4:7], a[36:39], v[152:155]
    ds_read_b128 a[92:95], v49 offset:6144
    v_mfma_f32_16x16x32_bf16 v[120:123], a[4:7], a[32:35], v[120:123]
    buffer_load_dwordx4 v18, s[12:15], s29 offen offset:1024 lds
    v_mfma_f32_16x16x32_bf16 v[124:127], a[8:11], a[32:35], v[124:127]
    ds_read_b64_tr_b16 a[56:57], v52 offset:8192
    v_mfma_f32_16x16x32_bf16 v[156:159], a[8:11], a[36:39], v[156:159]
    ds_read_b64_tr_b16 a[58:59], v52 offset:9216
    v_mfma_f32_16x16x32_bf16 v[188:191], a[8:11], a[40:43], v[188:191]
    ds_read_b64_tr_b16 a[60:61], v53 offset:8192
    v_mfma_f32_16x16x32_bf16 v[220:223], a[8:11], a[44:47], v[220:223]
    ds_read_b64_tr_b16 a[62:63], v53 offset:9216
    v_mfma_f32_16x16x32_bf16 v[224:227], a[12:15], a[44:47], v[224:227]
    ds_read_b64_tr_b16 a[64:65], v54 offset:8192
    v_mfma_f32_16x16x32_bf16 v[192:195], a[12:15], a[40:43], v[192:195]
    s_waitcnt lgkmcnt(9)
    ds_read_b64_tr_b16 a[66:67], v54 offset:9216
    v_mfma_f32_16x16x32_bf16 v[100:103], a[48:51], v[32:35], v[100:103]
    ds_read_b64_tr_b16 a[68:69], v55 offset:8192
    v_mfma_f32_16x16x32_bf16 v[104:107], a[52:55], v[32:35], v[104:107]
    buffer_load_dwordx4 v17, s[12:15], s29 offen offset:2048 lds
    v_mfma_f32_16x16x32_bf16 v[160:163], a[12:15], a[36:39], v[160:163]
    ds_read_b64_tr_b16 a[70:71], v55 offset:9216
    v_mfma_f32_16x16x32_bf16 v[128:131], a[12:15], a[32:35], v[128:131]
    ds_read_b64_tr_b16 a[72:73], v56 offset:8192
    v_mfma_f32_16x16x32_bf16 v[132:135], a[16:19], a[32:35], v[132:135]
    ds_read_b64_tr_b16 a[74:75], v56 offset:9216
    v_mfma_f32_16x16x32_bf16 v[164:167], a[16:19], a[36:39], v[164:167]
    ds_read_b64_tr_b16 a[76:77], v57 offset:8192
    v_mfma_f32_16x16x32_bf16 v[196:199], a[16:19], a[40:43], v[196:199]
    ds_read_b64_tr_b16 a[78:79], v57 offset:9216
    v_mfma_f32_16x16x32_bf16 v[228:231], a[16:19], a[44:47], v[228:231]
    ds_write_b128 v58, v[100:103] offset:0
    v_mfma_f32_16x16x32_bf16 v[232:235], a[20:23], a[44:47], v[232:235]
    buffer_load_dwordx4 v18, s[12:15], s29 offen offset:3072 lds
    v_mfma_f32_16x16x32_bf16 v[200:203], a[20:23], a[40:43], v[200:203]
    ds_write_b128 v58, v[104:107] offset:64
    v_mfma_f32_16x16x32_bf16 v[168:171], a[20:23], a[36:39], v[168:171]
    ds_write_b128 v58, v[100:103] offset:512
    v_mfma_f32_16x16x32_bf16 v[136:139], a[20:23], a[32:35], v[136:139]
    ds_write_b128 v58, v[104:107] offset:576
    v_mfma_f32_16x16x32_bf16 v[140:143], a[24:27], a[32:35], v[140:143]
    v_mfma_f32_16x16x32_bf16 v[172:175], a[24:27], a[36:39], v[172:175]
    v_mfma_f32_16x16x32_bf16 v[204:207], a[24:27], a[40:43], v[204:207]
    v_mfma_f32_16x16x32_bf16 v[236:239], a[24:27], a[44:47], v[236:239]
    v_mfma_f32_16x16x32_bf16 v[240:243], a[28:31], a[44:47], v[240:243]
    v_mfma_f32_16x16x32_bf16 v[208:211], a[28:31], a[40:43], v[208:211]
    v_mfma_f32_16x16x32_bf16 v[176:179], a[28:31], a[36:39], v[176:179]
    v_mfma_f32_16x16x32_bf16 v[144:147], a[28:31], a[32:35], v[144:147]
    s_add_u32 s29, s29, 16384
    s_waitcnt vmcnt(10) lgkmcnt(0)
    s_barrier
    v_mfma_f32_16x16x32_bf16 v[116:119], a[48:51], a[80:83], v[116:119]
    ds_read_b128 v[68:71], v58 offset:0
    v_mfma_f32_16x16x32_bf16 v[120:123], a[52:55], a[80:83], v[120:123]
    ds_read_b128 v[72:75], v58 offset:64
    v_mul_f32 v109, s44, v109
    v_mfma_f32_16x16x32_bf16 v[124:127], a[56:59], a[80:83], v[124:127]
    ds_read_b128 v[76:79], v58 offset:128
    v_mul_f32 v111, s44, v111
    v_mfma_f32_16x16x32_bf16 v[128:131], a[60:63], a[80:83], v[128:131]
    ds_read_b128 v[80:83], v58 offset:192
    v_mul_f32 v113, s44, v113
    v_mfma_f32_16x16x32_bf16 v[132:135], a[64:67], a[80:83], v[132:135]
    ds_read_b128 v[84:87], v58 offset:256
    v_mfma_f32_16x16x32_bf16 v[136:139], a[68:71], a[80:83], v[136:139]
    ds_read_b128 v[88:91], v58 offset:320
    v_mul_f32 v115, s44, v115
    v_mfma_f32_16x16x32_bf16 v[140:143], a[72:75], a[80:83], v[140:143]
    ds_read_b128 v[92:95], v58 offset:384
    v_and_b32 v253, 7, v19
    v_mfma_f32_16x16x32_bf16 v[144:147], a[76:79], a[80:83], v[144:147]
    ds_read_b128 v[96:99], v58 offset:448
    v_lshlrev_b32 v253, 5, v253
    v_mfma_f32_16x16x32_bf16 v[148:151], a[48:51], a[84:87], v[148:151]
    ds_read_b128 a[128:131], v1 offset:49152
    v_mfma_f32_16x16x32_bf16 v[152:155], a[52:55], a[84:87], v[152:155]
    ds_read_b128 a[132:135], v2 offset:49152
    v_mfma_f32_16x16x32_bf16 v[156:159], a[56:59], a[84:87], v[156:159]
    ds_read_b128 a[136:139], v3 offset:49152
    v_mfma_f32_16x16x32_bf16 v[160:163], a[60:63], a[84:87], v[160:163]
    ds_read_b128 a[140:143], v4 offset:49152
    v_mfma_f32_16x16x32_bf16 v[164:167], a[64:67], a[84:87], v[164:167]
    ds_read_b128 a[144:147], v1 offset:53248
    v_mfma_f32_16x16x32_bf16 v[168:171], a[68:71], a[84:87], v[168:171]
    ds_read_b128 a[148:151], v2 offset:53248
    v_mfma_f32_16x16x32_bf16 v[172:175], a[72:75], a[84:87], v[172:175]
    ds_read_b128 a[152:155], v3 offset:53248
    v_mfma_f32_16x16x32_bf16 v[176:179], a[76:79], a[84:87], v[176:179]
    ds_read_b128 a[156:159], v4 offset:53248
    buffer_load_dword v252, v253, s[92:95], 0 offen sc1
    s_waitcnt lgkmcnt(8)
    v_pk_fma_f32 v[116:117], v[108:109], v[68:69], v[116:117] op_sel_hi:[0,1,1] neg_lo:[1,0,0] neg_hi:[1,0,0]
    v_pk_fma_f32 v[118:119], v[108:109], v[70:71], v[118:119] op_sel_hi:[0,1,1] neg_lo:[1,0,0] neg_hi:[1,0,0]
    v_pk_fma_f32 v[120:121], v[108:109], v[72:73], v[120:121] op_sel_hi:[0,1,1] neg_lo:[1,0,0] neg_hi:[1,0,0]
    v_pk_fma_f32 v[122:123], v[108:109], v[74:75], v[122:123] op_sel_hi:[0,1,1] neg_lo:[1,0,0] neg_hi:[1,0,0]
    v_pk_fma_f32 v[124:125], v[108:109], v[76:77], v[124:125] op_sel_hi:[0,1,1] neg_lo:[1,0,0] neg_hi:[1,0,0]
    v_pk_fma_f32 v[126:127], v[108:109], v[78:79], v[126:127] op_sel_hi:[0,1,1] neg_lo:[1,0,0] neg_hi:[1,0,0]
    v_pk_fma_f32 v[128:129], v[108:109], v[80:81], v[128:129] op_sel_hi:[0,1,1] neg_lo:[1,0,0] neg_hi:[1,0,0]
    v_pk_fma_f32 v[130:131], v[108:109], v[82:83], v[130:131] op_sel_hi:[0,1,1] neg_lo:[1,0,0] neg_hi:[1,0,0]
    v_pk_fma_f32 v[132:133], v[108:109], v[84:85], v[132:133] op_sel_hi:[0,1,1] neg_lo:[1,0,0] neg_hi:[1,0,0]
    v_pk_fma_f32 v[134:135], v[108:109], v[86:87], v[134:135] op_sel_hi:[0,1,1] neg_lo:[1,0,0] neg_hi:[1,0,0]
    v_pk_fma_f32 v[136:137], v[108:109], v[88:89], v[136:137] op_sel_hi:[0,1,1] neg_lo:[1,0,0] neg_hi:[1,0,0]
    v_pk_fma_f32 v[138:139], v[108:109], v[90:91], v[138:139] op_sel_hi:[0,1,1] neg_lo:[1,0,0] neg_hi:[1,0,0]
    v_pk_fma_f32 v[140:141], v[108:109], v[92:93], v[140:141] op_sel_hi:[0,1,1] neg_lo:[1,0,0] neg_hi:[1,0,0]
    v_pk_fma_f32 v[142:143], v[108:109], v[94:95], v[142:143] op_sel_hi:[0,1,1] neg_lo:[1,0,0] neg_hi:[1,0,0]
    v_pk_fma_f32 v[144:145], v[108:109], v[96:97], v[144:145] op_sel_hi:[0,1,1] neg_lo:[1,0,0] neg_hi:[1,0,0]
    v_pk_fma_f32 v[146:147], v[108:109], v[98:99], v[146:147] op_sel_hi:[0,1,1] neg_lo:[1,0,0] neg_hi:[1,0,0]
    v_pk_mul_f32 v[116:117], v[116:117], v[108:109] op_sel:[0,1] op_sel_hi:[1,1]
    v_pk_mul_f32 v[118:119], v[118:119], v[108:109] op_sel:[0,1] op_sel_hi:[1,1]
    v_pk_mul_f32 v[120:121], v[120:121], v[108:109] op_sel:[0,1] op_sel_hi:[1,1]
    v_pk_mul_f32 v[122:123], v[122:123], v[108:109] op_sel:[0,1] op_sel_hi:[1,1]
    v_pk_mul_f32 v[124:125], v[124:125], v[108:109] op_sel:[0,1] op_sel_hi:[1,1]
    v_pk_mul_f32 v[126:127], v[126:127], v[108:109] op_sel:[0,1] op_sel_hi:[1,1]
    v_pk_mul_f32 v[128:129], v[128:129], v[108:109] op_sel:[0,1] op_sel_hi:[1,1]
    v_pk_mul_f32 v[130:131], v[130:131], v[108:109] op_sel:[0,1] op_sel_hi:[1,1]
    v_pk_mul_f32 v[132:133], v[132:133], v[108:109] op_sel:[0,1] op_sel_hi:[1,1]
    v_pk_mul_f32 v[134:135], v[134:135], v[108:109] op_sel:[0,1] op_sel_hi:[1,1]
    v_pk_mul_f32 v[136:137], v[136:137], v[108:109] op_sel:[0,1] op_sel_hi:[1,1]
    v_pk_mul_f32 v[138:139], v[138:139], v[108:109] op_sel:[0,1] op_sel_hi:[1,1]
    v_pk_mul_f32 v[140:141], v[140:141], v[108:109] op_sel:[0,1] op_sel_hi:[1,1]
    v_pk_mul_f32 v[142:143], v[142:143], v[108:109] op_sel:[0,1] op_sel_hi:[1,1]
    v_pk_mul_f32 v[144:145], v[144:145], v[108:109] op_sel:[0,1] op_sel_hi:[1,1]
    v_pk_mul_f32 v[146:147], v[146:147], v[108:109] op_sel:[0,1] op_sel_hi:[1,1]
    v_mfma_f32_16x16x32_bf16 v[180:183], a[48:51], a[88:91], v[180:183]
    ds_read_b128 a[160:163], v1 offset:57344
    v_cvt_pk_bf16_f32 v36, v116, v117
    v_cvt_pk_bf16_f32 v37, v118, v119
    v_cvt_pk_bf16_f32 v38, v120, v121
    v_cvt_pk_bf16_f32 v39, v122, v123
    v_mfma_f32_16x16x32_bf16 v[184:187], a[52:55], a[88:91], v[184:187]
    ds_read_b128 a[164:167], v2 offset:57344
    v_cvt_pk_bf16_f32 v40, v124, v125
    v_cvt_pk_bf16_f32 v41, v126, v127
    v_cvt_pk_bf16_f32 v42, v128, v129
    v_cvt_pk_bf16_f32 v43, v130, v131
    v_mfma_f32_16x16x32_bf16 v[188:191], a[56:59], a[88:91], v[188:191]
    ds_read_b128 a[168:171], v3 offset:57344
    v_cvt_pk_bf16_f32 v44, v132, v133
    v_cvt_pk_bf16_f32 v45, v134, v135
    v_cvt_pk_bf16_f32 v46, v136, v137
    v_cvt_pk_bf16_f32 v47, v138, v139
    v_mfma_f32_16x16x32_bf16 v[192:195], a[60:63], a[88:91], v[192:195]
    ds_read_b128 a[172:175], v4 offset:57344
    v_cvt_pk_bf16_f32 v48, v140, v141
    v_cvt_pk_bf16_f32 v49, v142, v143
    v_cvt_pk_bf16_f32 v50, v144, v145
    v_cvt_pk_bf16_f32 v51, v146, v147
    v_mfma_f32_16x16x32_bf16 v[196:199], a[64:67], a[88:91], v[196:199]
    ds_read_b128 a[176:179], v1 offset:61440
    v_permlane32_swap_b32 v36, v38
    v_permlane32_swap_b32 v37, v39
    v_permlane32_swap_b32 v40, v42
    v_permlane32_swap_b32 v41, v43
    v_mfma_f32_16x16x32_bf16 v[200:203], a[68:71], a[88:91], v[200:203]
    ds_read_b128 a[180:183], v2 offset:61440
    v_permlane32_swap_b32 v44, v46
    v_permlane32_swap_b32 v45, v47
    v_permlane32_swap_b32 v48, v50
    v_permlane32_swap_b32 v49, v51
    v_mfma_f32_16x16x32_bf16 v[204:207], a[72:75], a[88:91], v[204:207]
    ds_read_b128 a[184:187], v3 offset:61440
    v_permlane16_swap_b32 v36, v38
    v_permlane16_swap_b32 v37, v39
    v_permlane16_swap_b32 v40, v42
    v_permlane16_swap_b32 v41, v43
    v_mfma_f32_16x16x32_bf16 v[208:211], a[76:79], a[88:91], v[208:211]
    ds_read_b128 a[188:191], v4 offset:61440
    v_permlane16_swap_b32 v44, v46
    v_permlane16_swap_b32 v45, v47
    v_permlane16_swap_b32 v48, v50
    v_permlane16_swap_b32 v49, v51
    v_pk_fma_f32 v[148:149], v[110:111], v[68:69], v[148:149] op_sel_hi:[0,1,1] neg_lo:[1,0,0] neg_hi:[1,0,0]
    v_pk_fma_f32 v[150:151], v[110:111], v[70:71], v[150:151] op_sel_hi:[0,1,1] neg_lo:[1,0,0] neg_hi:[1,0,0]
    v_pk_fma_f32 v[152:153], v[110:111], v[72:73], v[152:153] op_sel_hi:[0,1,1] neg_lo:[1,0,0] neg_hi:[1,0,0]
    v_pk_fma_f32 v[154:155], v[110:111], v[74:75], v[154:155] op_sel_hi:[0,1,1] neg_lo:[1,0,0] neg_hi:[1,0,0]
    v_pk_fma_f32 v[156:157], v[110:111], v[76:77], v[156:157] op_sel_hi:[0,1,1] neg_lo:[1,0,0] neg_hi:[1,0,0]
    v_pk_fma_f32 v[158:159], v[110:111], v[78:79], v[158:159] op_sel_hi:[0,1,1] neg_lo:[1,0,0] neg_hi:[1,0,0]
    v_pk_fma_f32 v[160:161], v[110:111], v[80:81], v[160:161] op_sel_hi:[0,1,1] neg_lo:[1,0,0] neg_hi:[1,0,0]
    v_pk_fma_f32 v[162:163], v[110:111], v[82:83], v[162:163] op_sel_hi:[0,1,1] neg_lo:[1,0,0] neg_hi:[1,0,0]
    v_pk_fma_f32 v[164:165], v[110:111], v[84:85], v[164:165] op_sel_hi:[0,1,1] neg_lo:[1,0,0] neg_hi:[1,0,0]
    v_pk_fma_f32 v[166:167], v[110:111], v[86:87], v[166:167] op_sel_hi:[0,1,1] neg_lo:[1,0,0] neg_hi:[1,0,0]
    v_pk_fma_f32 v[168:169], v[110:111], v[88:89], v[168:169] op_sel_hi:[0,1,1] neg_lo:[1,0,0] neg_hi:[1,0,0]
    v_pk_fma_f32 v[170:171], v[110:111], v[90:91], v[170:171] op_sel_hi:[0,1,1] neg_lo:[1,0,0] neg_hi:[1,0,0]
    v_pk_fma_f32 v[172:173], v[110:111], v[92:93], v[172:173] op_sel_hi:[0,1,1] neg_lo:[1,0,0] neg_hi:[1,0,0]
    v_pk_fma_f32 v[174:175], v[110:111], v[94:95], v[174:175] op_sel_hi:[0,1,1] neg_lo:[1,0,0] neg_hi:[1,0,0]
    v_pk_fma_f32 v[176:177], v[110:111], v[96:97], v[176:177] op_sel_hi:[0,1,1] neg_lo:[1,0,0] neg_hi:[1,0,0]
    v_pk_fma_f32 v[178:179], v[110:111], v[98:99], v[178:179] op_sel_hi:[0,1,1] neg_lo:[1,0,0] neg_hi:[1,0,0]
    v_pk_mul_f32 v[148:149], v[148:149], v[110:111] op_sel:[0,1] op_sel_hi:[1,1]
    v_pk_mul_f32 v[150:151], v[150:151], v[110:111] op_sel:[0,1] op_sel_hi:[1,1]
    v_pk_mul_f32 v[152:153], v[152:153], v[110:111] op_sel:[0,1] op_sel_hi:[1,1]
    v_pk_mul_f32 v[154:155], v[154:155], v[110:111] op_sel:[0,1] op_sel_hi:[1,1]
    v_pk_mul_f32 v[156:157], v[156:157], v[110:111] op_sel:[0,1] op_sel_hi:[1,1]
    v_pk_mul_f32 v[158:159], v[158:159], v[110:111] op_sel:[0,1] op_sel_hi:[1,1]
    v_pk_mul_f32 v[160:161], v[160:161], v[110:111] op_sel:[0,1] op_sel_hi:[1,1]
    v_pk_mul_f32 v[162:163], v[162:163], v[110:111] op_sel:[0,1] op_sel_hi:[1,1]
    v_pk_mul_f32 v[164:165], v[164:165], v[110:111] op_sel:[0,1] op_sel_hi:[1,1]
    v_pk_mul_f32 v[166:167], v[166:167], v[110:111] op_sel:[0,1] op_sel_hi:[1,1]
    v_pk_mul_f32 v[168:169], v[168:169], v[110:111] op_sel:[0,1] op_sel_hi:[1,1]
    v_pk_mul_f32 v[170:171], v[170:171], v[110:111] op_sel:[0,1] op_sel_hi:[1,1]
    v_pk_mul_f32 v[172:173], v[172:173], v[110:111] op_sel:[0,1] op_sel_hi:[1,1]
    v_pk_mul_f32 v[174:175], v[174:175], v[110:111] op_sel:[0,1] op_sel_hi:[1,1]
    v_pk_mul_f32 v[176:177], v[176:177], v[110:111] op_sel:[0,1] op_sel_hi:[1,1]
    v_pk_mul_f32 v[178:179], v[178:179], v[110:111] op_sel:[0,1] op_sel_hi:[1,1]
    v_mfma_f32_16x16x32_bf16 v[212:215], a[48:51], a[92:95], v[212:215]
    s_add_u32 m0, s47, 0
    s_nop 0
    buffer_load_dwordx4 v20, s[96:99], 0 offen lds
    v_cvt_pk_bf16_f32 v52, v148, v149
    v_cvt_pk_bf16_f32 v53, v150, v151
    v_cvt_pk_bf16_f32 v54, v152, v153
    v_cvt_pk_bf16_f32 v55, v154, v155
    v_mfma_f32_16x16x32_bf16 v[216:219], a[52:55], a[92:95], v[216:219]
    s_add_u32 m0, s47, 1024
    s_nop 0
    buffer_load_dwordx4 v21, s[96:99], 0 offen lds
    v_cvt_pk_bf16_f32 v56, v156, v157
    v_cvt_pk_bf16_f32 v57, v158, v159
    v_cvt_pk_bf16_f32 v58, v160, v161
    v_cvt_pk_bf16_f32 v59, v162, v163
    v_mfma_f32_16x16x32_bf16 v[220:223], a[56:59], a[92:95], v[220:223]
    s_add_u32 m0, s47, 2048
    s_nop 0
    buffer_load_dwordx4 v22, s[96:99], 0 offen lds
    v_cvt_pk_bf16_f32 v60, v164, v165
    v_cvt_pk_bf16_f32 v61, v166, v167
    v_cvt_pk_bf16_f32 v62, v168, v169
    v_cvt_pk_bf16_f32 v63, v170, v171
    v_mfma_f32_16x16x32_bf16 v[224:227], a[60:63], a[92:95], v[224:227]
    s_add_u32 m0, s47, 3072
    s_nop 0
    buffer_load_dwordx4 v23, s[96:99], 0 offen lds
    v_cvt_pk_bf16_f32 v64, v172, v173
    v_cvt_pk_bf16_f32 v65, v174, v175
    v_cvt_pk_bf16_f32 v66, v176, v177
    v_cvt_pk_bf16_f32 v67, v178, v179
    v_mfma_f32_16x16x32_bf16 v[228:231], a[64:67], a[92:95], v[228:231]
    s_add_u32 m0, s47, 4096
    s_nop 0
    buffer_load_dwordx4 v24, s[96:99], 0 offen lds
    v_permlane32_swap_b32 v52, v54
    v_permlane32_swap_b32 v53, v55
    v_permlane32_swap_b32 v56, v58
    v_permlane32_swap_b32 v57, v59
    v_mfma_f32_16x16x32_bf16 v[232:235], a[68:71], a[92:95], v[232:235]
    v_permlane32_swap_b32 v60, v62
    v_permlane32_swap_b32 v61, v63
    v_permlane32_swap_b32 v64, v66
    v_permlane32_swap_b32 v65, v67
    v_mfma_f32_16x16x32_bf16 v[236:239], a[72:75], a[92:95], v[236:239]
    v_permlane16_swap_b32 v52, v54
    v_permlane16_swap_b32 v53, v55
    v_permlane16_swap_b32 v56, v58
    v_permlane16_swap_b32 v57, v59
    v_mfma_f32_16x16x32_bf16 v[240:243], a[76:79], a[92:95], v[240:243]
    v_permlane16_swap_b32 v60, v62
    v_permlane16_swap_b32 v61, v63
    v_permlane16_swap_b32 v64, v66
    v_permlane16_swap_b32 v65, v67
    v_pk_fma_f32 v[180:181], v[112:113], v[68:69], v[180:181] op_sel_hi:[0,1,1] neg_lo:[1,0,0] neg_hi:[1,0,0]
    v_pk_fma_f32 v[182:183], v[112:113], v[70:71], v[182:183] op_sel_hi:[0,1,1] neg_lo:[1,0,0] neg_hi:[1,0,0]
    v_pk_fma_f32 v[184:185], v[112:113], v[72:73], v[184:185] op_sel_hi:[0,1,1] neg_lo:[1,0,0] neg_hi:[1,0,0]
    v_pk_fma_f32 v[186:187], v[112:113], v[74:75], v[186:187] op_sel_hi:[0,1,1] neg_lo:[1,0,0] neg_hi:[1,0,0]
    v_pk_fma_f32 v[188:189], v[112:113], v[76:77], v[188:189] op_sel_hi:[0,1,1] neg_lo:[1,0,0] neg_hi:[1,0,0]
    v_pk_fma_f32 v[190:191], v[112:113], v[78:79], v[190:191] op_sel_hi:[0,1,1] neg_lo:[1,0,0] neg_hi:[1,0,0]
    v_pk_fma_f32 v[192:193], v[112:113], v[80:81], v[192:193] op_sel_hi:[0,1,1] neg_lo:[1,0,0] neg_hi:[1,0,0]
    v_pk_fma_f32 v[194:195], v[112:113], v[82:83], v[194:195] op_sel_hi:[0,1,1] neg_lo:[1,0,0] neg_hi:[1,0,0]
    v_pk_fma_f32 v[196:197], v[112:113], v[84:85], v[196:197] op_sel_hi:[0,1,1] neg_lo:[1,0,0] neg_hi:[1,0,0]
    v_pk_fma_f32 v[198:199], v[112:113], v[86:87], v[198:199] op_sel_hi:[0,1,1] neg_lo:[1,0,0] neg_hi:[1,0,0]
    v_pk_fma_f32 v[200:201], v[112:113], v[88:89], v[200:201] op_sel_hi:[0,1,1] neg_lo:[1,0,0] neg_hi:[1,0,0]
    v_pk_fma_f32 v[202:203], v[112:113], v[90:91], v[202:203] op_sel_hi:[0,1,1] neg_lo:[1,0,0] neg_hi:[1,0,0]
    v_pk_fma_f32 v[204:205], v[112:113], v[92:93], v[204:205] op_sel_hi:[0,1,1] neg_lo:[1,0,0] neg_hi:[1,0,0]
    v_pk_fma_f32 v[206:207], v[112:113], v[94:95], v[206:207] op_sel_hi:[0,1,1] neg_lo:[1,0,0] neg_hi:[1,0,0]
    v_pk_fma_f32 v[208:209], v[112:113], v[96:97], v[208:209] op_sel_hi:[0,1,1] neg_lo:[1,0,0] neg_hi:[1,0,0]
    v_pk_fma_f32 v[210:211], v[112:113], v[98:99], v[210:211] op_sel_hi:[0,1,1] neg_lo:[1,0,0] neg_hi:[1,0,0]
    v_pk_mul_f32 v[180:181], v[180:181], v[112:113] op_sel:[0,1] op_sel_hi:[1,1]
    v_pk_mul_f32 v[182:183], v[182:183], v[112:113] op_sel:[0,1] op_sel_hi:[1,1]
    v_pk_mul_f32 v[184:185], v[184:185], v[112:113] op_sel:[0,1] op_sel_hi:[1,1]
    v_pk_mul_f32 v[186:187], v[186:187], v[112:113] op_sel:[0,1] op_sel_hi:[1,1]
    v_pk_mul_f32 v[188:189], v[188:189], v[112:113] op_sel:[0,1] op_sel_hi:[1,1]
    v_pk_mul_f32 v[190:191], v[190:191], v[112:113] op_sel:[0,1] op_sel_hi:[1,1]
    v_pk_mul_f32 v[192:193], v[192:193], v[112:113] op_sel:[0,1] op_sel_hi:[1,1]
    v_pk_mul_f32 v[194:195], v[194:195], v[112:113] op_sel:[0,1] op_sel_hi:[1,1]
    v_pk_mul_f32 v[196:197], v[196:197], v[112:113] op_sel:[0,1] op_sel_hi:[1,1]
    v_pk_mul_f32 v[198:199], v[198:199], v[112:113] op_sel:[0,1] op_sel_hi:[1,1]
    v_pk_mul_f32 v[200:201], v[200:201], v[112:113] op_sel:[0,1] op_sel_hi:[1,1]
    v_pk_mul_f32 v[202:203], v[202:203], v[112:113] op_sel:[0,1] op_sel_hi:[1,1]
    v_pk_mul_f32 v[204:205], v[204:205], v[112:113] op_sel:[0,1] op_sel_hi:[1,1]
    v_pk_mul_f32 v[206:207], v[206:207], v[112:113] op_sel:[0,1] op_sel_hi:[1,1]
    v_pk_mul_f32 v[208:209], v[208:209], v[112:113] op_sel:[0,1] op_sel_hi:[1,1]
    v_pk_mul_f32 v[210:211], v[210:211], v[112:113] op_sel:[0,1] op_sel_hi:[1,1]
    v_pk_fma_f32 v[212:213], v[114:115], v[68:69], v[212:213] op_sel_hi:[0,1,1] neg_lo:[1,0,0] neg_hi:[1,0,0]
    v_pk_fma_f32 v[214:215], v[114:115], v[70:71], v[214:215] op_sel_hi:[0,1,1] neg_lo:[1,0,0] neg_hi:[1,0,0]
    v_pk_fma_f32 v[216:217], v[114:115], v[72:73], v[216:217] op_sel_hi:[0,1,1] neg_lo:[1,0,0] neg_hi:[1,0,0]
    v_pk_fma_f32 v[218:219], v[114:115], v[74:75], v[218:219] op_sel_hi:[0,1,1] neg_lo:[1,0,0] neg_hi:[1,0,0]
    v_pk_fma_f32 v[220:221], v[114:115], v[76:77], v[220:221] op_sel_hi:[0,1,1] neg_lo:[1,0,0] neg_hi:[1,0,0]
    v_pk_fma_f32 v[222:223], v[114:115], v[78:79], v[222:223] op_sel_hi:[0,1,1] neg_lo:[1,0,0] neg_hi:[1,0,0]
    v_pk_fma_f32 v[224:225], v[114:115], v[80:81], v[224:225] op_sel_hi:[0,1,1] neg_lo:[1,0,0] neg_hi:[1,0,0]
    v_pk_fma_f32 v[226:227], v[114:115], v[82:83], v[226:227] op_sel_hi:[0,1,1] neg_lo:[1,0,0] neg_hi:[1,0,0]
    v_pk_fma_f32 v[228:229], v[114:115], v[84:85], v[228:229] op_sel_hi:[0,1,1] neg_lo:[1,0,0] neg_hi:[1,0,0]
    v_pk_fma_f32 v[230:231], v[114:115], v[86:87], v[230:231] op_sel_hi:[0,1,1] neg_lo:[1,0,0] neg_hi:[1,0,0]
    v_pk_fma_f32 v[232:233], v[114:115], v[88:89], v[232:233] op_sel_hi:[0,1,1] neg_lo:[1,0,0] neg_hi:[1,0,0]
    v_pk_fma_f32 v[234:235], v[114:115], v[90:91], v[234:235] op_sel_hi:[0,1,1] neg_lo:[1,0,0] neg_hi:[1,0,0]
    v_pk_fma_f32 v[236:237], v[114:115], v[92:93], v[236:237] op_sel_hi:[0,1,1] neg_lo:[1,0,0] neg_hi:[1,0,0]
    v_pk_fma_f32 v[238:239], v[114:115], v[94:95], v[238:239] op_sel_hi:[0,1,1] neg_lo:[1,0,0] neg_hi:[1,0,0]
    v_pk_fma_f32 v[240:241], v[114:115], v[96:97], v[240:241] op_sel_hi:[0,1,1] neg_lo:[1,0,0] neg_hi:[1,0,0]
    v_pk_fma_f32 v[242:243], v[114:115], v[98:99], v[242:243] op_sel_hi:[0,1,1] neg_lo:[1,0,0] neg_hi:[1,0,0]
    s_waitcnt lgkmcnt(0)
    v_mfma_f32_16x16x32_bf16 v[116:119], a[128:131], v[36:39], 0
    v_cvt_pk_bf16_f32 v68, v180, v181
    v_cvt_pk_bf16_f32 v69, v182, v183
    v_cvt_pk_bf16_f32 v70, v184, v185
    v_cvt_pk_bf16_f32 v71, v186, v187
    v_mfma_f32_16x16x32_bf16 v[116:119], a[132:135], v[40:43], v[116:119]
    v_cvt_pk_bf16_f32 v72, v188, v189
    v_cvt_pk_bf16_f32 v73, v190, v191
    v_cvt_pk_bf16_f32 v74, v192, v193
    v_cvt_pk_bf16_f32 v75, v194, v195
    v_mfma_f32_16x16x32_bf16 v[116:119], a[136:139], v[44:47], v[116:119]
    v_cvt_pk_bf16_f32 v76, v196, v197
    v_cvt_pk_bf16_f32 v77, v198, v199
    v_cvt_pk_bf16_f32 v78, v200, v201
    v_cvt_pk_bf16_f32 v79, v202, v203
    v_mfma_f32_16x16x32_bf16 v[116:119], a[140:143], v[48:51], v[116:119]
    v_cvt_pk_bf16_f32 v80, v204, v205
    v_cvt_pk_bf16_f32 v81, v206, v207
    v_cvt_pk_bf16_f32 v82, v208, v209
    v_cvt_pk_bf16_f32 v83, v210, v211
    v_mfma_f32_16x16x32_bf16 v[132:135], a[144:147], v[36:39], 0
    v_permlane32_swap_b32 v68, v70
    v_permlane32_swap_b32 v69, v71
    v_permlane32_swap_b32 v72, v74
    v_permlane32_swap_b32 v73, v75
    v_mfma_f32_16x16x32_bf16 v[132:135], a[148:151], v[40:43], v[132:135]
    v_permlane32_swap_b32 v76, v78
    v_permlane32_swap_b32 v77, v79
    v_permlane32_swap_b32 v80, v82
    v_permlane32_swap_b32 v81, v83
    v_mfma_f32_16x16x32_bf16 v[132:135], a[152:155], v[44:47], v[132:135]
    v_permlane16_swap_b32 v68, v70
    v_permlane16_swap_b32 v69, v71
    v_permlane16_swap_b32 v72, v74
    v_permlane16_swap_b32 v73, v75
    v_mfma_f32_16x16x32_bf16 v[132:135], a[156:159], v[48:51], v[132:135]
    v_permlane16_swap_b32 v76, v78
    v_permlane16_swap_b32 v77, v79
    v_permlane16_swap_b32 v80, v82
    v_permlane16_swap_b32 v81, v83
    v_pk_mul_f32 v[212:213], v[212:213], v[114:115] op_sel:[0,1] op_sel_hi:[1,1]
    v_pk_mul_f32 v[214:215], v[214:215], v[114:115] op_sel:[0,1] op_sel_hi:[1,1]
    v_pk_mul_f32 v[216:217], v[216:217], v[114:115] op_sel:[0,1] op_sel_hi:[1,1]
    v_pk_mul_f32 v[218:219], v[218:219], v[114:115] op_sel:[0,1] op_sel_hi:[1,1]
    v_pk_mul_f32 v[220:221], v[220:221], v[114:115] op_sel:[0,1] op_sel_hi:[1,1]
    v_pk_mul_f32 v[222:223], v[222:223], v[114:115] op_sel:[0,1] op_sel_hi:[1,1]
    v_pk_mul_f32 v[224:225], v[224:225], v[114:115] op_sel:[0,1] op_sel_hi:[1,1]
    v_pk_mul_f32 v[226:227], v[226:227], v[114:115] op_sel:[0,1] op_sel_hi:[1,1]
    v_pk_mul_f32 v[228:229], v[228:229], v[114:115] op_sel:[0,1] op_sel_hi:[1,1]
    v_pk_mul_f32 v[230:231], v[230:231], v[114:115] op_sel:[0,1] op_sel_hi:[1,1]
    v_pk_mul_f32 v[232:233], v[232:233], v[114:115] op_sel:[0,1] op_sel_hi:[1,1]
    v_pk_mul_f32 v[234:235], v[234:235], v[114:115] op_sel:[0,1] op_sel_hi:[1,1]
    v_pk_mul_f32 v[236:237], v[236:237], v[114:115] op_sel:[0,1] op_sel_hi:[1,1]
    v_pk_mul_f32 v[238:239], v[238:239], v[114:115] op_sel:[0,1] op_sel_hi:[1,1]
    v_pk_mul_f32 v[240:241], v[240:241], v[114:115] op_sel:[0,1] op_sel_hi:[1,1]
    v_pk_mul_f32 v[242:243], v[242:243], v[114:115] op_sel:[0,1] op_sel_hi:[1,1]
    v_mfma_f32_16x16x32_bf16 v[120:123], a[140:143], v[64:67], 0
    v_cvt_pk_bf16_f32 v84, v212, v213
    v_cvt_pk_bf16_f32 v85, v214, v215
    v_cvt_pk_bf16_f32 v86, v216, v217
    v_cvt_pk_bf16_f32 v87, v218, v219
    v_mfma_f32_16x16x32_bf16 v[120:123], a[136:139], v[60:63], v[120:123]
    v_cvt_pk_bf16_f32 v88, v220, v221
    v_cvt_pk_bf16_f32 v89, v222, v223
    v_cvt_pk_bf16_f32 v90, v224, v225
    v_cvt_pk_bf16_f32 v91, v226, v227
    v_mfma_f32_16x16x32_bf16 v[120:123], a[132:135], v[56:59], v[120:123]
    v_cvt_pk_bf16_f32 v92, v228, v229
    v_cvt_pk_bf16_f32 v93, v230, v231
    v_cvt_pk_bf16_f32 v94, v232, v233
    v_cvt_pk_bf16_f32 v95, v234, v235
    v_mfma_f32_16x16x32_bf16 v[120:123], a[128:131], v[52:55], v[120:123]
    v_cvt_pk_bf16_f32 v96, v236, v237
    v_cvt_pk_bf16_f32 v97, v238, v239
    v_cvt_pk_bf16_f32 v98, v240, v241
    v_cvt_pk_bf16_f32 v99, v242, v243
    v_mfma_f32_16x16x32_bf16 v[136:139], a[156:159], v[64:67], 0
    v_permlane32_swap_b32 v84, v86
    v_permlane32_swap_b32 v85, v87
    v_permlane32_swap_b32 v88, v90
    v_permlane32_swap_b32 v89, v91
    v_mfma_f32_16x16x32_bf16 v[136:139], a[152:155], v[60:63], v[136:139]
    v_permlane32_swap_b32 v92, v94
    v_permlane32_swap_b32 v93, v95
    v_permlane32_swap_b32 v96, v98
    v_permlane32_swap_b32 v97, v99
    v_mfma_f32_16x16x32_bf16 v[136:139], a[148:151], v[56:59], v[136:139]
    v_permlane16_swap_b32 v84, v86
    v_permlane16_swap_b32 v85, v87
    v_permlane16_swap_b32 v88, v90
    v_permlane16_swap_b32 v89, v91
    v_mfma_f32_16x16x32_bf16 v[136:139], a[144:147], v[52:55], v[136:139]
    v_permlane16_swap_b32 v92, v94
    v_permlane16_swap_b32 v93, v95
    v_permlane16_swap_b32 v96, v98
    v_permlane16_swap_b32 v97, v99
    v_mfma_f32_16x16x32_bf16 v[124:127], a[128:131], v[68:71], 0
    v_max3_f32 v28, v116, v117, v118
    v_max3_f32 v30, v120, v121, v122
    v_mfma_f32_16x16x32_bf16 v[124:127], a[132:135], v[72:75], v[124:127]
    v_max3_f32 v29, v119, v132, v133
    v_max3_f32 v31, v123, v136, v137
    v_max3_f32 v28, v28, v134, v135
    v_mfma_f32_16x16x32_bf16 v[124:127], a[136:139], v[76:79], v[124:127]
    v_max3_f32 v30, v30, v138, v139
    v_max_f32 v28, v28, v29
    v_max_f32 v30, v30, v31
    v_mfma_f32_16x16x32_bf16 v[124:127], a[140:143], v[80:83], v[124:127]
    v_mov_b32 v29, v28
    v_mov_b32 v31, v30
    s_nop 0
    v_permlane32_swap_b32 v28, v29
    v_mfma_f32_16x16x32_bf16 v[140:143], a[144:147], v[68:71], 0
    v_permlane32_swap_b32 v30, v31
    v_max_f32 v28, v28, v29
    v_mfma_f32_16x16x32_bf16 v[140:143], a[148:151], v[72:75], v[140:143]
    v_max_f32 v30, v30, v31
    v_mov_b32 v29, v28
    v_mov_b32 v31, v30
    v_mfma_f32_16x16x32_bf16 v[140:143], a[152:155], v[76:79], v[140:143]
    v_permlane16_swap_b32 v28, v29
    v_permlane16_swap_b32 v30, v31
    v_max_f32 v28, v28, v29
    v_mfma_f32_16x16x32_bf16 v[140:143], a[156:159], v[80:83], v[140:143]
    v_max_f32 v30, v30, v31
    v_sub_f32 v100, 0, v28
    v_sub_f32 v104, 0, v30
    v_mfma_f32_16x16x32_bf16 v[128:131], a[140:143], v[96:99], 0
    v_sub_f32 v101, 0, v28
    v_sub_f32 v105, 0, v30
    v_mfma_f32_16x16x32_bf16 v[128:131], a[136:139], v[92:95], v[128:131]
    v_sub_f32 v102, 0, v28
    v_sub_f32 v106, 0, v30
    v_sub_f32 v103, 0, v28
    v_mfma_f32_16x16x32_bf16 v[128:131], a[132:135], v[88:91], v[128:131]
    v_sub_f32 v107, 0, v30
    v_sub_f32 v116, v116, v28
    v_sub_f32 v120, v120, v30
    v_mfma_f32_16x16x32_bf16 v[128:131], a[128:131], v[84:87], v[128:131]
    v_sub_f32 v117, v117, v28
    v_sub_f32 v121, v121, v30
    v_sub_f32 v118, v118, v28
    v_mfma_f32_16x16x32_bf16 v[144:147], a[156:159], v[96:99], 0
    v_sub_f32 v122, v122, v30
    v_sub_f32 v119, v119, v28
    v_mfma_f32_16x16x32_bf16 v[144:147], a[152:155], v[92:95], v[144:147]
    v_sub_f32 v123, v123, v30
    v_sub_f32 v132, v132, v28
    v_sub_f32 v136, v136, v30
    v_mfma_f32_16x16x32_bf16 v[144:147], a[148:151], v[88:91], v[144:147]
    v_sub_f32 v133, v133, v28
    v_sub_f32 v137, v137, v30
    v_sub_f32 v134, v134, v28
    v_mfma_f32_16x16x32_bf16 v[144:147], a[144:147], v[84:87], v[144:147]
    v_sub_f32 v138, v138, v30
    v_sub_f32 v135, v135, v28
    v_sub_f32 v139, v139, v30
    s_waitcnt vmcnt(14)
    s_barrier
    v_mfma_f32_16x16x32_bf16 v[148:151], a[160:163], v[36:39], v[100:103]
    s_add_u32 m0, s34, 0
    s_nop 3
    v_mfma_f32_16x16x32_bf16 v[148:151], a[164:167], v[40:43], v[148:151]
    ds_read_b128 a[128:131], v1 offset:16384
    v_max3_f32 v32, v124, v125, v126
    v_max3_f32 v34, v128, v129, v130
    v_mfma_f32_16x16x32_bf16 v[148:151], a[168:171], v[44:47], v[148:151]
    ds_read_b128 a[132:135], v2 offset:16384
    v_max3_f32 v33, v127, v140, v141
    v_max3_f32 v35, v131, v144, v145
    v_max3_f32 v32, v32, v142, v143
    v_mfma_f32_16x16x32_bf16 v[148:151], a[172:175], v[48:51], v[148:151]
    buffer_load_dwordx4 v13, s[8:11], s28 offen offset:0 lds
    v_max3_f32 v34, v34, v146, v147
    v_max_f32 v32, v32, v33
    v_max_f32 v34, v34, v35
    v_mfma_f32_16x16x32_bf16 v[152:155], a[172:175], v[64:67], v[104:107]
    v_mov_b32 v33, v32
    v_mov_b32 v35, v34
    s_nop 0
    v_permlane32_swap_b32 v32, v33
    v_mfma_f32_16x16x32_bf16 v[152:155], a[168:171], v[60:63], v[152:155]
    v_permlane32_swap_b32 v34, v35
    v_max_f32 v32, v32, v33
    v_max_f32 v34, v34, v35
    v_mfma_f32_16x16x32_bf16 v[152:155], a[164:167], v[56:59], v[152:155]
    v_mov_b32 v33, v32
    v_mov_b32 v35, v34
    s_nop 0
    v_permlane16_swap_b32 v32, v33
    v_mfma_f32_16x16x32_bf16 v[152:155], a[160:163], v[52:55], v[152:155]
    v_permlane16_swap_b32 v34, v35
    v_max_f32 v32, v32, v33
    v_max_f32 v34, v34, v35
    v_mfma_f32_16x16x32_bf16 v[164:167], a[176:179], v[36:39], v[100:103]
    v_sub_f32 v108, 0, v32
    v_sub_f32 v112, 0, v34
    v_sub_f32 v109, 0, v32
    v_mfma_f32_16x16x32_bf16 v[164:167], a[180:183], v[40:43], v[164:167]
    v_sub_f32 v113, 0, v34
    v_sub_f32 v110, 0, v32
    v_sub_f32 v114, 0, v34
    v_mfma_f32_16x16x32_bf16 v[164:167], a[184:187], v[44:47], v[164:167]
    v_sub_f32 v111, 0, v32
    v_sub_f32 v115, 0, v34
    v_sub_f32 v124, v124, v32
    v_mfma_f32_16x16x32_bf16 v[164:167], a[188:191], v[48:51], v[164:167]
    v_sub_f32 v128, v128, v34
    v_sub_f32 v125, v125, v32
    v_sub_f32 v129, v129, v34
    v_mfma_f32_16x16x32_bf16 v[168:171], a[188:191], v[64:67], v[104:107]
    v_sub_f32 v126, v126, v32
    v_sub_f32 v130, v130, v34
    v_sub_f32 v127, v127, v32
    v_mfma_f32_16x16x32_bf16 v[168:171], a[184:187], v[60:63], v[168:171]
    v_sub_f32 v131, v131, v34
    v_sub_f32 v140, v140, v32
    v_sub_f32 v144, v144, v34
    v_mfma_f32_16x16x32_bf16 v[168:171], a[180:183], v[56:59], v[168:171]
    v_sub_f32 v141, v141, v32
    v_sub_f32 v145, v145, v34
    v_sub_f32 v142, v142, v32
    v_mfma_f32_16x16x32_bf16 v[168:171], a[176:179], v[52:55], v[168:171]
    v_sub_f32 v146, v146, v34
    v_sub_f32 v143, v143, v32
    v_sub_f32 v147, v147, v34
    s_nop 0
    v_mfma_f32_16x16x32_bf16 v[156:159], a[160:163], v[68:71], v[108:111]
    ds_read_b128 a[136:139], v3 offset:16384
    v_mfma_f32_16x16x32_bf16 v[156:159], a[164:167], v[72:75], v[156:159]
    ds_read_b128 a[140:143], v4 offset:16384
    v_mfma_f32_16x16x32_bf16 v[156:159], a[168:171], v[76:79], v[156:159]
    buffer_load_dwordx4 v14, s[8:11], s28 offen offset:1024 lds
    v_mfma_f32_16x16x32_bf16 v[156:159], a[172:175], v[80:83], v[156:159]
    v_mfma_f32_16x16x32_bf16 v[160:163], a[172:175], v[96:99], v[112:115]
    v_mfma_f32_16x16x32_bf16 v[160:163], a[168:171], v[92:95], v[160:163]
    v_mfma_f32_16x16x32_bf16 v[160:163], a[164:167], v[88:91], v[160:163]
    v_mfma_f32_16x16x32_bf16 v[160:163], a[160:163], v[84:87], v[160:163]
    s_waitcnt lgkmcnt(2)
    v_mfma_f32_16x16x32_bf16 v[172:175], a[176:179], v[68:71], v[108:111]
    s_waitcnt vmcnt(7)
    ds_read_b128 a[144:147], v1 offset:20480
    v_exp_f32 v116, v116
    v_mfma_f32_16x16x32_bf16 v[172:175], a[180:183], v[72:75], v[172:175]
    ds_read_b128 a[148:151], v2 offset:20480
    v_exp_f32 v117, v117
    v_mfma_f32_16x16x32_bf16 v[172:175], a[184:187], v[76:79], v[172:175]
    v_cvt_pk_bf16_f32 v180, v116, v117
    v_exp_f32 v118, v118
    v_mfma_f32_16x16x32_bf16 v[172:175], a[188:191], v[80:83], v[172:175]
    v_exp_f32 v119, v119
    v_mfma_f32_16x16x32_bf16 v[176:179], a[188:191], v[96:99], v[112:115]
    v_cvt_pk_bf16_f32 v181, v118, v119
    v_exp_f32 v120, v120
    v_mfma_f32_16x16x32_bf16 v[176:179], a[184:187], v[92:95], v[176:179]
    v_exp_f32 v121, v121
    v_mfma_f32_16x16x32_bf16 v[176:179], a[180:183], v[88:91], v[176:179]
    buffer_load_dwordx4 v15, s[8:11], s28 offen offset:2048 lds
    v_cvt_pk_bf16_f32 v188, v120, v121
    v_exp_f32 v122, v122
    v_mfma_f32_16x16x32_bf16 v[176:179], a[176:179], v[84:87], v[176:179]
    s_waitcnt lgkmcnt(2)
    v_exp_f32 v123, v123
    v_mfma_f32_16x16x32_bf16 v[116:119], a[128:131], v[36:39], v[100:103]
    ds_read_b128 a[152:155], v3 offset:20480
    v_cvt_pk_bf16_f32 v189, v122, v123
    v_exp_f32 v124, v124
    v_mfma_f32_16x16x32_bf16 v[116:119], a[132:135], v[40:43], v[116:119]
    ds_read_b128 a[156:159], v4 offset:20480
    v_exp_f32 v125, v125
    v_mfma_f32_16x16x32_bf16 v[116:119], a[136:139], v[44:47], v[116:119]
    v_cvt_pk_bf16_f32 v196, v124, v125
    v_exp_f32 v126, v126
    v_cmp_gt_u32 vcc, 32, v252
    s_and_b64 vcc, vcc, exec
    s_cbranch_scc1 L_spin_all
L_back_all:
    v_mfma_f32_16x16x32_bf16 v[116:119], a[140:143], v[48:51], v[116:119]
    s_cmp_eq_u32 s6, 240
    s_cbranch_scc1 L_rt_keys
L_rt_back_keys:
    v_exp_f32 v127, v127
    v_mfma_f32_16x16x32_bf16 v[120:123], a[140:143], v[64:67], v[104:107]
    v_cvt_pk_bf16_f32 v197, v126, v127
    v_exp_f32 v128, v128
    v_mfma_f32_16x16x32_bf16 v[120:123], a[136:139], v[60:63], v[120:123]
    v_exp_f32 v129, v129
    v_mfma_f32_16x16x32_bf16 v[120:123], a[132:135], v[56:59], v[120:123]
    buffer_load_dwordx4 v16, s[8:11], s28 offen offset:3072 lds
    v_cvt_pk_bf16_f32 v204, v128, v129
    v_exp_f32 v130, v130
    v_mfma_f32_16x16x32_bf16 v[120:123], a[128:131], v[52:55], v[120:123]
    s_waitcnt lgkmcnt(2)
    v_exp_f32 v131, v131
    v_mfma_f32_16x16x32_bf16 v[124:127], a[128:131], v[68:71], v[108:111]
    ds_read_b128 a[160:163], v1 offset:24576
    v_cvt_pk_bf16_f32 v205, v130, v131
    v_exp_f32 v132, v132
    v_mfma_f32_16x16x32_bf16 v[124:127], a[132:135], v[72:75], v[124:127]
    ds_read_b128 a[164:167], v2 offset:24576
    v_exp_f32 v133, v133
    v_mfma_f32_16x16x32_bf16 v[124:127], a[136:139], v[76:79], v[124:127]
    v_cvt_pk_bf16_f32 v182, v132, v133
    v_exp_f32 v134, v134
    v_mfma_f32_16x16x32_bf16 v[124:127], a[140:143], v[80:83], v[124:127]
    v_exp_f32 v135, v135
    v_mfma_f32_16x16x32_bf16 v[128:131], a[140:143], v[96:99], v[112:115]
    v_cvt_pk_bf16_f32 v183, v134, v135
    v_exp_f32 v136, v136
    v_mfma_f32_16x16x32_bf16 v[128:131], a[136:139], v[92:95], v[128:131]
    s_add_u32 s28, s28, 16384
    s_mov_b32 m0, s31
    v_exp_f32 v137, v137
    v_mfma_f32_16x16x32_bf16 v[128:131], a[132:135], v[88:91], v[128:131]
    buffer_load_dwordx4 v17, s[12:15], s29 offen offset:0 lds
    v_cvt_pk_bf16_f32 v190, v136, v137
    v_exp_f32 v138, v138
    v_mfma_f32_16x16x32_bf16 v[128:131], a[128:131], v[84:87], v[128:131]
    s_waitcnt lgkmcnt(2)
    v_exp_f32 v139, v139
    v_mfma_f32_16x16x32_bf16 v[132:135], a[144:147], v[36:39], v[100:103]
    ds_read_b128 a[168:171], v3 offset:24576
    v_cvt_pk_bf16_f32 v191, v138, v139
    v_exp_f32 v140, v140
    v_mfma_f32_16x16x32_bf16 v[132:135], a[148:151], v[40:43], v[132:135]
    ds_read_b128 a[172:175], v4 offset:24576
    v_exp_f32 v141, v141
    v_mfma_f32_16x16x32_bf16 v[132:135], a[152:155], v[44:47], v[132:135]
    v_cvt_pk_bf16_f32 v198, v140, v141
    v_exp_f32 v142, v142
    v_mfma_f32_16x16x32_bf16 v[132:135], a[156:159], v[48:51], v[132:135]
    v_exp_f32 v143, v143
    v_mfma_f32_16x16x32_bf16 v[136:139], a[156:159], v[64:67], v[104:107]
    v_cvt_pk_bf16_f32 v199, v142, v143
    v_exp_f32 v144, v144
    v_mfma_f32_16x16x32_bf16 v[136:139], a[152:155], v[60:63], v[136:139]
    v_exp_f32 v145, v145
    v_mfma_f32_16x16x32_bf16 v[136:139], a[148:151], v[56:59], v[136:139]
    buffer_load_dwordx4 v18, s[12:15], s29 offen offset:1024 lds
    v_cvt_pk_bf16_f32 v206, v144, v145
    v_exp_f32 v146, v146
    v_mfma_f32_16x16x32_bf16 v[136:139], a[144:147], v[52:55], v[136:139]
    s_waitcnt lgkmcnt(2)
    v_exp_f32 v147, v147
    v_mfma_f32_16x16x32_bf16 v[140:143], a[144:147], v[68:71], v[108:111]
    ds_read_b128 a[176:179], v1 offset:28672
    v_cvt_pk_bf16_f32 v207, v146, v147
    v_exp_f32 v148, v148
    v_mfma_f32_16x16x32_bf16 v[140:143], a[148:151], v[72:75], v[140:143]
    ds_read_b128 a[180:183], v2 offset:28672
    v_exp_f32 v149, v149
    v_mfma_f32_16x16x32_bf16 v[140:143], a[152:155], v[76:79], v[140:143]
    v_cvt_pk_bf16_f32 v184, v148, v149
    v_exp_f32 v150, v150
    v_mfma_f32_16x16x32_bf16 v[140:143], a[156:159], v[80:83], v[140:143]
    v_exp_f32 v151, v151
    v_mfma_f32_16x16x32_bf16 v[144:147], a[156:159], v[96:99], v[112:115]
    v_cvt_pk_bf16_f32 v185, v150, v151
    v_exp_f32 v152, v152
    v_mfma_f32_16x16x32_bf16 v[144:147], a[152:155], v[92:95], v[144:147]
    v_exp_f32 v153, v153
    v_mfma_f32_16x16x32_bf16 v[144:147], a[148:151], v[88:91], v[144:147]
    buffer_load_dwordx4 v17, s[12:15], s29 offen offset:2048 lds
    v_cvt_pk_bf16_f32 v192, v152, v153
    v_exp_f32 v154, v154
    v_mfma_f32_16x16x32_bf16 v[144:147], a[144:147], v[84:87], v[144:147]
    s_waitcnt lgkmcnt(2)
    v_exp_f32 v155, v155
    v_mfma_f32_16x16x32_bf16 v[148:151], a[160:163], v[36:39], v[100:103]
    ds_read_b128 a[184:187], v3 offset:28672
    v_cvt_pk_bf16_f32 v193, v154, v155
    v_exp_f32 v156, v156
    v_mfma_f32_16x16x32_bf16 v[148:151], a[164:167], v[40:43], v[148:151]
    ds_read_b128 a[188:191], v4 offset:28672
    v_exp_f32 v157, v157
    v_mfma_f32_16x16x32_bf16 v[148:151], a[168:171], v[44:47], v[148:151]
    v_cvt_pk_bf16_f32 v200, v156, v157
    v_exp_f32 v158, v158
    v_mfma_f32_16x16x32_bf16 v[148:151], a[172:175], v[48:51], v[148:151]
    v_exp_f32 v159, v159
    v_mfma_f32_16x16x32_bf16 v[152:155], a[172:175], v[64:67], v[104:107]
    v_cvt_pk_bf16_f32 v201, v158, v159
    v_exp_f32 v160, v160
    v_mfma_f32_16x16x32_bf16 v[152:155], a[168:171], v[60:63], v[152:155]
    v_exp_f32 v161, v161
    v_mfma_f32_16x16x32_bf16 v[152:155], a[164:167], v[56:59], v[152:155]
    buffer_load_dwordx4 v18, s[12:15], s29 offen offset:3072 lds
    v_cvt_pk_bf16_f32 v208, v160, v161
    v_exp_f32 v162, v162
    v_mfma_f32_16x16x32_bf16 v[152:155], a[160:163], v[52:55], v[152:155]
    s_waitcnt vmcnt(14) lgkmcnt(2)
    s_barrier
    s_add_u32 s29, s29, 16384
    v_exp_f32 v163, v163
    v_mfma_f32_16x16x32_bf16 v[156:159], a[160:163], v[68:71], v[108:111]
    s_waitcnt vmcnt(8)
    ds_read_b64_tr_b16 a[192:193], v5 offset:8192
    v_cvt_pk_bf16_f32 v209, v162, v163
    v_exp_f32 v164, v164
    v_mfma_f32_16x16x32_bf16 v[156:159], a[164:167], v[72:75], v[156:159]
    ds_read_b64_tr_b16 a[194:195], v5 offset:12288
    v_exp_f32 v165, v165
    v_mfma_f32_16x16x32_bf16 v[156:159], a[168:171], v[76:79], v[156:159]
    ds_read_b128 a[128:131], v1 offset:32768
    ds_read_b64_tr_b16 a[240:241], v25 offset:0
    v_cvt_pk_bf16_f32 v186, v164, v165
    v_exp_f32 v166, v166
    v_mfma_f32_16x16x32_bf16 v[156:159], a[172:175], v[80:83], v[156:159]
    ds_read_b64_tr_b16 a[196:197], v5 offset:32768
    v_exp_f32 v167, v167
    v_mfma_f32_16x16x32_bf16 v[160:163], a[172:175], v[96:99], v[112:115]
    ds_read_b64_tr_b16 a[198:199], v5 offset:36864
    ds_read_b64_tr_b16 a[242:243], v25 offset:2560
    v_cvt_pk_bf16_f32 v187, v166, v167
    v_exp_f32 v168, v168
    v_mfma_f32_16x16x32_bf16 v[160:163], a[168:171], v[92:95], v[160:163]
    s_add_u32 m0, s34, 49152
    ds_read_b128 a[132:135], v2 offset:32768
    ds_read_b64_tr_b16 a[244:245], v25 offset:32
    v_exp_f32 v169, v169
    v_mfma_f32_16x16x32_bf16 v[160:163], a[164:167], v[88:91], v[160:163]
    buffer_load_dwordx4 v13, s[8:11], s28 offen offset:0 lds
    v_cvt_pk_bf16_f32 v194, v168, v169
    v_exp_f32 v170, v170
    v_mfma_f32_16x16x32_bf16 v[160:163], a[160:163], v[84:87], v[160:163]
    s_waitcnt lgkmcnt(6)
    ds_read_b64_tr_b16 a[246:247], v25 offset:2592
    v_exp_f32 v171, v171
    v_mfma_f32_16x16x32_bf16 v[164:167], a[176:179], v[36:39], v[100:103]
    ds_read_b64_tr_b16 a[200:201], v6 offset:8192
    ds_read_b64_tr_b16 a[248:249], v25 offset:64
    v_cvt_pk_bf16_f32 v195, v170, v171
    v_exp_f32 v172, v172
    v_mfma_f32_16x16x32_bf16 v[164:167], a[180:183], v[40:43], v[164:167]
    ds_read_b64_tr_b16 a[202:203], v6 offset:12288
    v_exp_f32 v173, v173
    v_mfma_f32_16x16x32_bf16 v[164:167], a[184:187], v[44:47], v[164:167]
    ds_read_b128 a[136:139], v3 offset:32768
    ds_read_b64_tr_b16 a[250:251], v25 offset:2624
    v_cvt_pk_bf16_f32 v202, v172, v173
    v_exp_f32 v174, v174
    v_mfma_f32_16x16x32_bf16 v[164:167], a[188:191], v[48:51], v[164:167]
    ds_read_b64_tr_b16 a[204:205], v6 offset:32768
    ds_read_b64_tr_b16 a[252:253], v25 offset:96
    v_exp_f32 v175, v175
    v_mfma_f32_16x16x32_bf16 v[168:171], a[188:191], v[64:67], v[104:107]
    ds_read_b64_tr_b16 a[206:207], v6 offset:36864
    v_cvt_pk_bf16_f32 v203, v174, v175
    v_exp_f32 v176, v176
    v_mfma_f32_16x16x32_bf16 v[168:171], a[184:187], v[60:63], v[168:171]
    ds_read_b128 a[140:143], v4 offset:32768
    ds_read_b64_tr_b16 a[254:255], v25 offset:2656
    v_exp_f32 v177, v177
    v_mfma_f32_16x16x32_bf16 v[168:171], a[180:183], v[56:59], v[168:171]
    buffer_load_dwordx4 v14, s[8:11], s28 offen offset:1024 lds
    ds_read_b64_tr_b16 v[252:253], v25 offset:128
    v_cvt_pk_bf16_f32 v210, v176, v177
    v_exp_f32 v178, v178
    v_mfma_f32_16x16x32_bf16 v[168:171], a[176:179], v[52:55], v[168:171]
    s_waitcnt lgkmcnt(6)
    ds_read_b64_tr_b16 v[254:255], v25 offset:2688
    v_exp_f32 v179, v179
    v_mfma_f32_16x16x32_bf16 v[172:175], a[176:179], v[68:71], v[108:111]
    s_mov_b32 s16, s62
    v_exp_f32 v116, v116
    v_mfma_f32_16x16x32_bf16 v[172:175], a[180:183], v[72:75], v[172:175]
    s_mov_b32 s17, s63
    ds_read_b64_tr_b16 a[208:209], v7 offset:8192
    v_cvt_pk_bf16_f32 v211, v178, v179
    v_mfma_f32_16x16x32_bf16 v[172:175], a[184:187], v[76:79], v[172:175]
    s_mov_b32 s18, 0x21c000
    v_exp_f32 v117, v117
    v_mfma_f32_16x16x32_bf16 v[172:175], a[188:191], v[80:83], v[172:175]
    s_mov_b32 s19, 0x20000
    ds_read_b64_tr_b16 a[210:211], v7 offset:12288
    v_mfma_f32_16x16x32_bf16 v[176:179], a[188:191], v[96:99], v[112:115]
    s_mov_b32 s20, s64
    v_exp_f32 v118, v118
    v_mfma_f32_16x16x32_bf16 v[176:179], a[184:187], v[92:95], v[176:179]
    s_mov_b32 s21, s65
    ds_read_b128 a[144:147], v1 offset:36864
    v_cvt_pk_bf16_f32 v212, v116, v117
    v_mfma_f32_16x16x32_bf16 v[176:179], a[180:183], v[88:91], v[176:179]
    s_mov_b32 s22, 0x21c000
    v_exp_f32 v119, v119
    v_mfma_f32_16x16x32_bf16 v[176:179], a[176:179], v[84:87], v[176:179]
    s_mov_b32 s23, 0x20000
    ds_read_b64_tr_b16 a[212:213], v7 offset:32768
    v_mfma_f32_16x16x32_bf16 a[0:3], a[192:195], v[180:183], 0
    s_mov_b32 s96, s66
    v_exp_f32 v120, v120
    v_mfma_f32_16x16x32_bf16 a[0:3], a[196:199], v[184:187], a[0:3]
    s_mov_b32 s97, s67
    ds_read_b64_tr_b16 a[214:215], v7 offset:36864
    v_cvt_pk_bf16_f32 v213, v118, v119
    v_mfma_f32_16x16x32_bf16 a[4:7], a[196:199], v[192:195], 0
    s_mov_b32 s98, 0x21c000
    v_exp_f32 v121, v121
    v_mfma_f32_16x16x32_bf16 a[4:7], a[192:195], v[188:191], a[4:7]
    s_mov_b32 s99, 0x20000
    ds_read_b128 a[148:151], v2 offset:36864
    v_cvt_pk_bf16_f32 v220, v120, v121
    v_mfma_f32_16x16x32_bf16 a[8:11], a[192:195], v[196:199], 0
    v_exp_f32 v122, v122
    v_mfma_f32_16x16x32_bf16 a[8:11], a[196:199], v[200:203], a[8:11]
    buffer_load_dwordx4 v15, s[8:11], s28 offen offset:2048 lds
    v_mfma_f32_16x16x32_bf16 a[12:15], a[196:199], v[208:211], 0
    v_exp_f32 v123, v123
    v_mfma_f32_16x16x32_bf16 a[12:15], a[192:195], v[204:207], a[12:15]
    s_waitcnt lgkmcnt(6)
    v_mul_u32_u24 v24, 3456, v19
    v_mfma_f32_16x16x32_bf16 v[116:119], a[128:131], v[36:39], v[100:103]
    s_lshl_b32 s40, s6, 4
    v_exp_f32 v124, v124
    v_mfma_f32_16x16x32_bf16 v[116:119], a[132:135], v[40:43], v[116:119]
    ds_read_b64_tr_b16 a[216:217], v8 offset:8192
    v_cvt_pk_bf16_f32 v221, v122, v123
    v_mfma_f32_16x16x32_bf16 v[116:119], a[136:139], v[44:47], v[116:119]
    v_exp_f32 v125, v125
    v_mfma_f32_16x16x32_bf16 v[116:119], a[140:143], v[48:51], v[116:119]
    ds_read_b64_tr_b16 a[218:219], v8 offset:12288
    v_add_u32 v24, s40, v24
    v_mfma_f32_16x16x32_bf16 v[120:123], a[140:143], v[64:67], v[104:107]
    s_cmp_ge_u32 s5, 2
    s_cselect_b32 s16, s20, s16
    s_cselect_b32 s17, s21, s17
    v_exp_f32 v126, v126
    v_mfma_f32_16x16x32_bf16 v[120:123], a[136:139], v[60:63], v[120:123]
    s_cmp_ge_u32 s6, 216
    s_cselect_b32 s18, 0, s18
    ds_read_b128 a[152:155], v3 offset:36864
    v_cvt_pk_bf16_f32 v228, v124, v125
    v_mfma_f32_16x16x32_bf16 v[120:123], a[132:135], v[56:59], v[120:123]
    s_and_b32 s40, s5, 1
    v_exp_f32 v127, v127
    v_mfma_f32_16x16x32_bf16 v[120:123], a[128:131], v[52:55], v[120:123]
    s_mul_i32 s37, s40, 1105920
    ds_read_b64_tr_b16 a[220:221], v8 offset:32768
    v_mfma_f32_16x16x32_bf16 a[16:19], a[200:203], v[180:183], 0
    s_mul_i32 s38, s5, 5120
    v_exp_f32 v128, v128
    v_mfma_f32_16x16x32_bf16 a[16:19], a[204:207], v[184:187], a[16:19]
    s_add_u32 s38, s38, 65536
    ds_read_b64_tr_b16 a[222:223], v8 offset:36864
    v_cvt_pk_bf16_f32 v229, v126, v127
    v_mfma_f32_16x16x32_bf16 a[20:23], a[204:207], v[192:195], 0
    buffer_store_dwordx4 a[240:243], v26, s[76:79], 0 offen offset:0 sc1
    v_exp_f32 v129, v129
    v_mfma_f32_16x16x32_bf16 a[20:23], a[200:203], v[188:191], a[20:23]
    ds_read_b128 a[156:159], v4 offset:36864
    v_mfma_f32_16x16x32_bf16 a[24:27], a[200:203], v[196:199], 0
    v_exp_f32 v130, v130
    v_mfma_f32_16x16x32_bf16 a[24:27], a[204:207], v[200:203], a[24:27]
    v_cvt_pk_bf16_f32 v236, v128, v129
    v_mfma_f32_16x16x32_bf16 a[28:31], a[204:207], v[208:211], 0
    v_exp_f32 v131, v131
    v_mfma_f32_16x16x32_bf16 a[28:31], a[200:203], v[204:207], a[28:31]
    buffer_load_dwordx4 v16, s[8:11], s28 offen offset:3072 lds
    v_smfmac_f32_16x16x64_bf16 a[224:227], v[244:247], v[180:187], v248
    s_waitcnt lgkmcnt(6)
    buffer_store_dwordx4 a[244:247], v26, s[76:79], 0 offen offset:1024 sc1
    v_mfma_f32_16x16x32_bf16 v[124:127], a[128:131], v[68:71], v[108:111]
    v_exp_f32 v132, v132
    v_mfma_f32_16x16x32_bf16 v[124:127], a[132:135], v[72:75], v[124:127]
    ds_read_b64_tr_b16 a[192:193], v9 offset:8192
    v_cvt_pk_bf16_f32 v237, v130, v131
    v_mfma_f32_16x16x32_bf16 v[124:127], a[136:139], v[76:79], v[124:127]
    v_exp_f32 v133, v133
    v_mfma_f32_16x16x32_bf16 v[124:127], a[140:143], v[80:83], v[124:127]
    ds_read_b64_tr_b16 a[194:195], v9 offset:12288
    v_mfma_f32_16x16x32_bf16 v[128:131], a[140:143], v[96:99], v[112:115]
    v_exp_f32 v134, v134
    v_mfma_f32_16x16x32_bf16 v[128:131], a[136:139], v[92:95], v[128:131]
    ds_read_b128 a[160:163], v1 offset:40960
    v_cvt_pk_bf16_f32 v214, v132, v133
    v_mfma_f32_16x16x32_bf16 v[128:131], a[132:135], v[88:91], v[128:131]
    v_exp_f32 v135, v135
    v_mfma_f32_16x16x32_bf16 v[128:131], a[128:131], v[84:87], v[128:131]
    ds_read_b64_tr_b16 a[196:197], v9 offset:32768
    v_mfma_f32_16x16x32_bf16 a[32:35], a[208:211], v[180:183], 0
    v_exp_f32 v136, v136
    v_mfma_f32_16x16x32_bf16 a[32:35], a[212:215], v[184:187], a[32:35]
    ds_read_b64_tr_b16 a[198:199], v9 offset:36864
    v_cvt_pk_bf16_f32 v215, v134, v135
    v_mfma_f32_16x16x32_bf16 a[36:39], a[212:215], v[192:195], 0
    v_exp_f32 v137, v137
    v_mfma_f32_16x16x32_bf16 a[36:39], a[208:211], v[188:191], a[36:39]
    ds_read_b128 a[164:167], v2 offset:40960
    v_cvt_pk_bf16_f32 v222, v136, v137
    v_mfma_f32_16x16x32_bf16 a[40:43], a[208:211], v[196:199], 0
    s_add_u32 s28, s28, 16384
    s_mov_b32 m0, s32
    buffer_store_dwordx4 a[248:251], v26, s[76:79], 0 offen offset:2048 sc1
    v_exp_f32 v138, v138
    v_mfma_f32_16x16x32_bf16 a[40:43], a[212:215], v[200:203], a[40:43]
    buffer_load_dwordx4 v17, s[12:15], s29 offen offset:0 lds
    v_mfma_f32_16x16x32_bf16 a[44:47], a[212:215], v[208:211], 0
    v_exp_f32 v139, v139
    v_mfma_f32_16x16x32_bf16 a[44:47], a[208:211], v[204:207], a[44:47]
    s_waitcnt lgkmcnt(6)
    buffer_store_dwordx4 a[252:255], v26, s[76:79], 0 offen offset:3072 sc1
    v_mfma_f32_16x16x32_bf16 v[132:135], a[144:147], v[36:39], v[100:103]
    v_exp_f32 v140, v140
    v_mfma_f32_16x16x32_bf16 v[132:135], a[148:151], v[40:43], v[132:135]
    ds_read_b64_tr_b16 a[200:201], v10 offset:8192
    v_cvt_pk_bf16_f32 v223, v138, v139
    v_mfma_f32_16x16x32_bf16 v[132:135], a[152:155], v[44:47], v[132:135]
    v_exp_f32 v141, v141
    v_mfma_f32_16x16x32_bf16 v[132:135], a[156:159], v[48:51], v[132:135]
    ds_read_b64_tr_b16 a[202:203], v10 offset:12288
    v_mfma_f32_16x16x32_bf16 v[136:139], a[156:159], v[64:67], v[104:107]
    v_exp_f32 v142, v142
    v_mfma_f32_16x16x32_bf16 v[136:139], a[152:155], v[60:63], v[136:139]
    ds_read_b128 a[168:171], v3 offset:40960
    v_cvt_pk_bf16_f32 v230, v140, v141
    v_mfma_f32_16x16x32_bf16 v[136:139], a[148:151], v[56:59], v[136:139]
    v_exp_f32 v143, v143
    v_mfma_f32_16x16x32_bf16 v[136:139], a[144:147], v[52:55], v[136:139]
    ds_read_b64_tr_b16 a[204:205], v10 offset:32768
    v_mfma_f32_16x16x32_bf16 a[48:51], a[216:219], v[180:183], 0
    v_exp_f32 v144, v144
    v_mfma_f32_16x16x32_bf16 a[48:51], a[220:223], v[184:187], a[48:51]
    ds_read_b64_tr_b16 a[206:207], v10 offset:36864
    v_cvt_pk_bf16_f32 v231, v142, v143
    v_mfma_f32_16x16x32_bf16 a[52:55], a[220:223], v[192:195], 0
    v_exp_f32 v145, v145
    v_mfma_f32_16x16x32_bf16 a[52:55], a[216:219], v[188:191], a[52:55]
    ds_read_b128 a[172:175], v4 offset:40960
    v_mfma_f32_16x16x32_bf16 a[56:59], a[216:219], v[196:199], 0
    v_exp_f32 v146, v146
    v_mfma_f32_16x16x32_bf16 a[56:59], a[220:223], v[200:203], a[56:59]
    v_cvt_pk_bf16_f32 v238, v144, v145
    v_mfma_f32_16x16x32_bf16 a[60:63], a[220:223], v[208:211], 0
    v_exp_f32 v147, v147
    v_mfma_f32_16x16x32_bf16 a[60:63], a[216:219], v[204:207], a[60:63]
    buffer_load_dwordx4 v18, s[12:15], s29 offen offset:1024 lds
    v_smfmac_f32_16x16x64_bf16 a[228:231], v[244:247], v[188:195], v248
    s_waitcnt lgkmcnt(6)
    buffer_store_dwordx4 v[252:255], v26, s[76:79], s45 offen offset:0 sc1
    v_mfma_f32_16x16x32_bf16 v[140:143], a[144:147], v[68:71], v[108:111]
    s_cmp_eq_u32 s6, 240
    s_cbranch_scc1 L_rt_local
L_rt_back_local:
    v_exp_f32 v148, v148
    v_mfma_f32_16x16x32_bf16 v[140:143], a[148:151], v[72:75], v[140:143]
    ds_read_b64_tr_b16 a[208:209], v11 offset:8192
    v_cvt_pk_bf16_f32 v239, v146, v147
    v_mfma_f32_16x16x32_bf16 v[140:143], a[152:155], v[76:79], v[140:143]
    v_exp_f32 v149, v149
    v_mfma_f32_16x16x32_bf16 v[140:143], a[156:159], v[80:83], v[140:143]
    ds_read_b64_tr_b16 a[210:211], v11 offset:12288
    v_mfma_f32_16x16x32_bf16 v[144:147], a[156:159], v[96:99], v[112:115]
    v_exp_f32 v150, v150
    v_mfma_f32_16x16x32_bf16 v[144:147], a[152:155], v[92:95], v[144:147]
    ds_read_b128 a[176:179], v1 offset:45056
    v_cvt_pk_bf16_f32 v216, v148, v149
    v_mfma_f32_16x16x32_bf16 v[144:147], a[148:151], v[88:91], v[144:147]
    v_exp_f32 v151, v151
    v_mfma_f32_16x16x32_bf16 v[144:147], a[144:147], v[84:87], v[144:147]
    ds_read_b64_tr_b16 a[212:213], v11 offset:32768
    v_mfma_f32_16x16x32_bf16 a[64:67], a[192:195], v[180:183], 0
    v_exp_f32 v152, v152
    v_mfma_f32_16x16x32_bf16 a[64:67], a[196:199], v[184:187], a[64:67]
    ds_read_b64_tr_b16 a[214:215], v11 offset:36864
    v_cvt_pk_bf16_f32 v217, v150, v151
    v_mfma_f32_16x16x32_bf16 a[68:71], a[196:199], v[192:195], 0
    v_exp_f32 v153, v153
    v_mfma_f32_16x16x32_bf16 a[68:71], a[192:195], v[188:191], a[68:71]
    ds_read_b128 a[180:183], v2 offset:45056
    v_cvt_pk_bf16_f32 v224, v152, v153
    v_mfma_f32_16x16x32_bf16 a[72:75], a[192:195], v[196:199], 0
    v_exp_f32 v154, v154
    v_mfma_f32_16x16x32_bf16 a[72:75], a[196:199], v[200:203], a[72:75]
    buffer_load_dwordx4 v17, s[12:15], s29 offen offset:2048 lds
    v_mfma_f32_16x16x32_bf16 a[76:79], a[196:199], v[208:211], 0
    v_exp_f32 v155, v155
    v_mfma_f32_16x16x32_bf16 a[76:79], a[192:195], v[204:207], a[76:79]
    s_waitcnt lgkmcnt(6)
    v_mfma_f32_16x16x32_bf16 v[148:151], a[160:163], v[36:39], v[100:103]
    v_exp_f32 v156, v156
    v_mfma_f32_16x16x32_bf16 v[148:151], a[164:167], v[40:43], v[148:151]
    ds_read_b64_tr_b16 a[216:217], v12 offset:8192
    v_cvt_pk_bf16_f32 v225, v154, v155
    v_mfma_f32_16x16x32_bf16 v[148:151], a[168:171], v[44:47], v[148:151]
    v_exp_f32 v157, v157
    v_mfma_f32_16x16x32_bf16 v[148:151], a[172:175], v[48:51], v[148:151]
    ds_read_b64_tr_b16 a[218:219], v12 offset:12288
    v_mfma_f32_16x16x32_bf16 v[152:155], a[172:175], v[64:67], v[104:107]
    v_exp_f32 v158, v158
    v_mfma_f32_16x16x32_bf16 v[152:155], a[168:171], v[60:63], v[152:155]
    ds_read_b128 a[184:187], v3 offset:45056
    v_cvt_pk_bf16_f32 v232, v156, v157
    v_mfma_f32_16x16x32_bf16 v[152:155], a[164:167], v[56:59], v[152:155]
    v_exp_f32 v159, v159
    v_mfma_f32_16x16x32_bf16 v[152:155], a[160:163], v[52:55], v[152:155]
    ds_read_b64_tr_b16 a[220:221], v12 offset:32768
    v_mfma_f32_16x16x32_bf16 a[80:83], a[200:203], v[180:183], 0
    v_exp_f32 v160, v160
    v_mfma_f32_16x16x32_bf16 a[80:83], a[204:207], v[184:187], a[80:83]
    ds_read_b64_tr_b16 a[222:223], v12 offset:36864
    v_cvt_pk_bf16_f32 v233, v158, v159
    v_mfma_f32_16x16x32_bf16 a[84:87], a[204:207], v[192:195], 0
    v_exp_f32 v161, v161
    v_mfma_f32_16x16x32_bf16 a[84:87], a[200:203], v[188:191], a[84:87]
    ds_read_b128 a[188:191], v4 offset:45056
    v_mfma_f32_16x16x32_bf16 a[88:91], a[200:203], v[196:199], 0
    v_exp_f32 v162, v162
    v_mfma_f32_16x16x32_bf16 a[88:91], a[204:207], v[200:203], a[88:91]
    v_cvt_pk_bf16_f32 v240, v160, v161
    v_mfma_f32_16x16x32_bf16 a[92:95], a[204:207], v[208:211], 0
    v_exp_f32 v163, v163
    v_mfma_f32_16x16x32_bf16 a[92:95], a[200:203], v[204:207], a[92:95]
    buffer_load_dwordx4 v18, s[12:15], s29 offen offset:3072 lds
    v_smfmac_f32_16x16x64_bf16 a[232:235], v[244:247], v[196:203], v248
    s_waitcnt vmcnt(13) lgkmcnt(6)
    s_barrier
    s_add_u32 s29, s29, 16384
    v_mfma_f32_16x16x32_bf16 v[156:159], a[160:163], v[68:71], v[108:111]
    v_exp_f32 v164, v164
    v_mfma_f32_16x16x32_bf16 v[156:159], a[164:167], v[72:75], v[156:159]
    ds_read_b64_tr_b16 a[192:193], v5 offset:16384
    v_cvt_pk_bf16_f32 v241, v162, v163
    v_mfma_f32_16x16x32_bf16 v[156:159], a[168:171], v[76:79], v[156:159]
    v_exp_f32 v165, v165
    v_mfma_f32_16x16x32_bf16 v[156:159], a[172:175], v[80:83], v[156:159]
    ds_read_b64_tr_b16 a[194:195], v5 offset:20480
    v_mfma_f32_16x16x32_bf16 v[160:163], a[172:175], v[96:99], v[112:115]
    v_exp_f32 v166, v166
    v_mfma_f32_16x16x32_bf16 v[160:163], a[168:171], v[92:95], v[160:163]
    ds_read_b128 a[128:131], v1 offset:0
    v_cvt_pk_bf16_f32 v218, v164, v165
    v_mfma_f32_16x16x32_bf16 v[160:163], a[164:167], v[88:91], v[160:163]
    v_exp_f32 v167, v167
    v_mfma_f32_16x16x32_bf16 v[160:163], a[160:163], v[84:87], v[160:163]
    ds_read_b64_tr_b16 a[196:197], v5 offset:40960
    v_mfma_f32_16x16x32_bf16 a[96:99], a[208:211], v[180:183], 0
    v_exp_f32 v168, v168
    v_mfma_f32_16x16x32_bf16 a[96:99], a[212:215], v[184:187], a[96:99]
    ds_read_b64_tr_b16 a[198:199], v5 offset:45056
    v_cvt_pk_bf16_f32 v219, v166, v167
    v_mfma_f32_16x16x32_bf16 a[100:103], a[212:215], v[192:195], 0
    v_exp_f32 v169, v169
    v_mfma_f32_16x16x32_bf16 a[100:103], a[208:211], v[188:191], a[100:103]
    ds_read_b128 a[132:135], v2 offset:0
    v_cvt_pk_bf16_f32 v226, v168, v169
    v_mfma_f32_16x16x32_bf16 a[104:107], a[208:211], v[196:199], 0
    s_add_u32 m0, s34, 16384
    v_exp_f32 v170, v170
    v_mfma_f32_16x16x32_bf16 a[104:107], a[212:215], v[200:203], a[104:107]
    buffer_load_dwordx4 v13, s[8:11], s28 offen offset:0 lds
    v_mfma_f32_16x16x32_bf16 a[108:111], a[212:215], v[208:211], 0
    v_exp_f32 v171, v171
    v_mfma_f32_16x16x32_bf16 a[108:111], a[208:211], v[204:207], a[108:111]
    s_waitcnt lgkmcnt(6)
    v_mfma_f32_16x16x32_bf16 v[164:167], a[176:179], v[36:39], v[100:103]
    s_cmp_eq_u32 s6, 240
    s_cbranch_scc1 L_rt_merge
L_rt_back_merge:
    v_exp_f32 v172, v172
    v_mfma_f32_16x16x32_bf16 v[164:167], a[180:183], v[40:43], v[164:167]
    ds_read_b64_tr_b16 a[200:201], v6 offset:16384
    v_cvt_pk_bf16_f32 v227, v170, v171
    v_mfma_f32_16x16x32_bf16 v[164:167], a[184:187], v[44:47], v[164:167]
    v_exp_f32 v173, v173
    v_mfma_f32_16x16x32_bf16 v[164:167], a[188:191], v[48:51], v[164:167]
    ds_read_b64_tr_b16 a[202:203], v6 offset:20480
    v_mfma_f32_16x16x32_bf16 v[168:171], a[188:191], v[64:67], v[104:107]
    v_exp_f32 v174, v174
    v_mfma_f32_16x16x32_bf16 v[168:171], a[184:187], v[60:63], v[168:171]
    ds_read_b128 a[136:139], v3 offset:0
    v_cvt_pk_bf16_f32 v234, v172, v173
    v_mfma_f32_16x16x32_bf16 v[168:171], a[180:183], v[56:59], v[168:171]
    v_exp_f32 v175, v175
    v_mfma_f32_16x16x32_bf16 v[168:171], a[176:179], v[52:55], v[168:171]
    ds_read_b64_tr_b16 a[204:205], v6 offset:40960
    v_mfma_f32_16x16x32_bf16 a[112:115], a[216:219], v[180:183], 0
    v_exp_f32 v176, v176
    v_mfma_f32_16x16x32_bf16 a[112:115], a[220:223], v[184:187], a[112:115]
    ds_read_b64_tr_b16 a[206:207], v6 offset:45056
    v_cvt_pk_bf16_f32 v235, v174, v175
    v_mfma_f32_16x16x32_bf16 a[116:119], a[220:223], v[192:195], 0
    v_exp_f32 v177, v177
    v_mfma_f32_16x16x32_bf16 a[116:119], a[216:219], v[188:191], a[116:119]
    ds_read_b128 a[140:143], v4 offset:0
    v_mfma_f32_16x16x32_bf16 a[120:123], a[216:219], v[196:199], 0
    v_exp_f32 v178, v178
    v_mfma_f32_16x16x32_bf16 a[120:123], a[220:223], v[200:203], a[120:123]
    v_cvt_pk_bf16_f32 v242, v176, v177
    v_mfma_f32_16x16x32_bf16 a[124:127], a[220:223], v[208:211], 0
    v_exp_f32 v179, v179
    v_mfma_f32_16x16x32_bf16 a[124:127], a[216:219], v[204:207], a[124:127]
    buffer_load_dwordx4 v14, s[8:11], s28 offen offset:1024 lds
    v_smfmac_f32_16x16x64_bf16 a[236:239], v[244:247], v[204:211], v248
    s_waitcnt lgkmcnt(6)
    s_mov_b32 s35, 4
.p2align 6
L_attn_loop:
    v_mfma_f32_16x16x32_bf16 v[172:175], a[176:179], v[68:71], v[108:111]
    v_exp_f32 v116, v116
    v_mfma_f32_16x16x32_bf16 v[172:175], a[180:183], v[72:75], v[172:175]
    ds_read_b64_tr_b16 a[208:209], v7 offset:16384
    v_cvt_pk_bf16_f32 v243, v178, v179
    v_mfma_f32_16x16x32_bf16 v[172:175], a[184:187], v[76:79], v[172:175]
    v_exp_f32 v117, v117
    v_mfma_f32_16x16x32_bf16 v[172:175], a[188:191], v[80:83], v[172:175]
    ds_read_b64_tr_b16 a[210:211], v7 offset:20480
    v_mfma_f32_16x16x32_bf16 v[176:179], a[188:191], v[96:99], v[112:115]
    v_exp_f32 v118, v118
    v_mfma_f32_16x16x32_bf16 v[176:179], a[184:187], v[92:95], v[176:179]
    ds_read_b128 a[144:147], v1 offset:4096
    v_cvt_pk_bf16_f32 v180, v116, v117
    v_mfma_f32_16x16x32_bf16 v[176:179], a[180:183], v[88:91], v[176:179]
    v_exp_f32 v119, v119
    v_mfma_f32_16x16x32_bf16 v[176:179], a[176:179], v[84:87], v[176:179]
    ds_read_b64_tr_b16 a[212:213], v7 offset:40960
    v_mfma_f32_16x16x32_bf16 a[0:3], a[192:195], v[212:215], a[0:3]
    v_exp_f32 v120, v120
    v_mfma_f32_16x16x32_bf16 a[0:3], a[196:199], v[216:219], a[0:3]
    ds_read_b64_tr_b16 a[214:215], v7 offset:45056
    v_cvt_pk_bf16_f32 v181, v118, v119
    v_mfma_f32_16x16x32_bf16 a[4:7], a[196:199], v[224:227], a[4:7]
    v_exp_f32 v121, v121
    v_mfma_f32_16x16x32_bf16 a[4:7], a[192:195], v[220:223], a[4:7]
    ds_read_b128 a[148:151], v2 offset:4096
    v_cvt_pk_bf16_f32 v188, v120, v121
    v_mfma_f32_16x16x32_bf16 a[8:11], a[192:195], v[228:231], a[8:11]
    v_exp_f32 v122, v122
    v_mfma_f32_16x16x32_bf16 a[8:11], a[196:199], v[232:235], a[8:11]
    buffer_load_dwordx4 v15, s[8:11], s28 offen offset:2048 lds
    v_mfma_f32_16x16x32_bf16 a[12:15], a[196:199], v[240:243], a[12:15]
    v_exp_f32 v123, v123
    v_mfma_f32_16x16x32_bf16 a[12:15], a[192:195], v[236:239], a[12:15]
    s_waitcnt lgkmcnt(6)
    v_mfma_f32_16x16x32_bf16 v[116:119], a[128:131], v[36:39], v[100:103]
    v_exp_f32 v124, v124
    v_mfma_f32_16x16x32_bf16 v[116:119], a[132:135], v[40:43], v[116:119]
    ds_read_b64_tr_b16 a[216:217], v8 offset:16384
    v_cvt_pk_bf16_f32 v189, v122, v123
    v_mfma_f32_16x16x32_bf16 v[116:119], a[136:139], v[44:47], v[116:119]
    v_exp_f32 v125, v125
    v_mfma_f32_16x16x32_bf16 v[116:119], a[140:143], v[48:51], v[116:119]
    ds_read_b64_tr_b16 a[218:219], v8 offset:20480
    v_mfma_f32_16x16x32_bf16 v[120:123], a[140:143], v[64:67], v[104:107]
    v_exp_f32 v126, v126
    v_mfma_f32_16x16x32_bf16 v[120:123], a[136:139], v[60:63], v[120:123]
    ds_read_b128 a[152:155], v3 offset:4096
    v_cvt_pk_bf16_f32 v196, v124, v125
    v_mfma_f32_16x16x32_bf16 v[120:123], a[132:135], v[56:59], v[120:123]
    v_exp_f32 v127, v127
    v_mfma_f32_16x16x32_bf16 v[120:123], a[128:131], v[52:55], v[120:123]
    ds_read_b64_tr_b16 a[220:221], v8 offset:40960
    v_mfma_f32_16x16x32_bf16 a[16:19], a[200:203], v[212:215], a[16:19]
    v_exp_f32 v128, v128
    v_mfma_f32_16x16x32_bf16 a[16:19], a[204:207], v[216:219], a[16:19]
    ds_read_b64_tr_b16 a[222:223], v8 offset:45056
    v_cvt_pk_bf16_f32 v197, v126, v127
    v_mfma_f32_16x16x32_bf16 a[20:23], a[204:207], v[224:227], a[20:23]
    v_exp_f32 v129, v129
    v_mfma_f32_16x16x32_bf16 a[20:23], a[200:203], v[220:223], a[20:23]
    ds_read_b128 a[156:159], v4 offset:4096
    v_mfma_f32_16x16x32_bf16 a[24:27], a[200:203], v[228:231], a[24:27]
    v_exp_f32 v130, v130
    v_mfma_f32_16x16x32_bf16 a[24:27], a[204:207], v[232:235], a[24:27]
    v_cvt_pk_bf16_f32 v204, v128, v129
    v_mfma_f32_16x16x32_bf16 a[28:31], a[204:207], v[240:243], a[28:31]
    v_exp_f32 v131, v131
    v_mfma_f32_16x16x32_bf16 a[28:31], a[200:203], v[236:239], a[28:31]
    buffer_load_dwordx4 v16, s[8:11], s28 offen offset:3072 lds
    v_smfmac_f32_16x16x64_bf16 a[224:227], v[244:247], v[212:219], v248
    s_waitcnt lgkmcnt(6)
    v_mfma_f32_16x16x32_bf16 v[124:127], a[128:131], v[68:71], v[108:111]
    s_cmp_eq_u32 s5, 0
    s_cbranch_scc1 L_site0
L_site_back0:
    v_exp_f32 v132, v132
    v_mfma_f32_16x16x32_bf16 v[124:127], a[132:135], v[72:75], v[124:127]
    ds_read_b64_tr_b16 a[192:193], v9 offset:16384
    v_cvt_pk_bf16_f32 v205, v130, v131
    v_mfma_f32_16x16x32_bf16 v[124:127], a[136:139], v[76:79], v[124:127]
    v_exp_f32 v133, v133
    v_mfma_f32_16x16x32_bf16 v[124:127], a[140:143], v[80:83], v[124:127]
    ds_read_b64_tr_b16 a[194:195], v9 offset:20480
    v_mfma_f32_16x16x32_bf16 v[128:131], a[140:143], v[96:99], v[112:115]
    v_exp_f32 v134, v134
    v_mfma_f32_16x16x32_bf16 v[128:131], a[136:139], v[92:95], v[128:131]
    ds_read_b128 a[160:163], v1 offset:8192
    v_cvt_pk_bf16_f32 v182, v132, v133
    v_mfma_f32_16x16x32_bf16 v[128:131], a[132:135], v[88:91], v[128:131]
    v_exp_f32 v135, v135
    v_mfma_f32_16x16x32_bf16 v[128:131], a[128:131], v[84:87], v[128:131]
    ds_read_b64_tr_b16 a[196:197], v9 offset:40960
    v_mfma_f32_16x16x32_bf16 a[32:35], a[208:211], v[212:215], a[32:35]
    v_exp_f32 v136, v136
    v_mfma_f32_16x16x32_bf16 a[32:35], a[212:215], v[216:219], a[32:35]
    ds_read_b64_tr_b16 a[198:199], v9 offset:45056
    v_cvt_pk_bf16_f32 v183, v134, v135
    v_mfma_f32_16x16x32_bf16 a[36:39], a[212:215], v[224:227], a[36:39]
    v_exp_f32 v137, v137
    v_mfma_f32_16x16x32_bf16 a[36:39], a[208:211], v[220:223], a[36:39]
    ds_read_b128 a[164:167], v2 offset:8192
    v_cvt_pk_bf16_f32 v190, v136, v137
    v_mfma_f32_16x16x32_bf16 a[40:43], a[208:211], v[228:231], a[40:43]
    s_add_u32 s28, s28, 16384
    s_mov_b32 m0, s33
    v_exp_f32 v138, v138
    v_mfma_f32_16x16x32_bf16 a[40:43], a[212:215], v[232:235], a[40:43]
    buffer_load_dwordx4 v17, s[12:15], s29 offen offset:0 lds
    v_mfma_f32_16x16x32_bf16 a[44:47], a[212:215], v[240:243], a[44:47]
    v_exp_f32 v139, v139
    v_mfma_f32_16x16x32_bf16 a[44:47], a[208:211], v[236:239], a[44:47]
    s_waitcnt lgkmcnt(6)
    v_mfma_f32_16x16x32_bf16 v[132:135], a[144:147], v[36:39], v[100:103]
    v_exp_f32 v140, v140
    v_mfma_f32_16x16x32_bf16 v[132:135], a[148:151], v[40:43], v[132:135]
    ds_read_b64_tr_b16 a[200:201], v10 offset:16384
    v_cvt_pk_bf16_f32 v191, v138, v139
    v_mfma_f32_16x16x32_bf16 v[132:135], a[152:155], v[44:47], v[132:135]
    v_exp_f32 v141, v141
    v_mfma_f32_16x16x32_bf16 v[132:135], a[156:159], v[48:51], v[132:135]
    ds_read_b64_tr_b16 a[202:203], v10 offset:20480
    v_mfma_f32_16x16x32_bf16 v[136:139], a[156:159], v[64:67], v[104:107]
    v_exp_f32 v142, v142
    v_mfma_f32_16x16x32_bf16 v[136:139], a[152:155], v[60:63], v[136:139]
    ds_read_b128 a[168:171], v3 offset:8192
    v_cvt_pk_bf16_f32 v198, v140, v141
    v_mfma_f32_16x16x32_bf16 v[136:139], a[148:151], v[56:59], v[136:139]
    v_exp_f32 v143, v143
    v_mfma_f32_16x16x32_bf16 v[136:139], a[144:147], v[52:55], v[136:139]
    ds_read_b64_tr_b16 a[204:205], v10 offset:40960
    v_mfma_f32_16x16x32_bf16 a[48:51], a[216:219], v[212:215], a[48:51]
    v_exp_f32 v144, v144
    v_mfma_f32_16x16x32_bf16 a[48:51], a[220:223], v[216:219], a[48:51]
    ds_read_b64_tr_b16 a[206:207], v10 offset:45056
    v_cvt_pk_bf16_f32 v199, v142, v143
    v_mfma_f32_16x16x32_bf16 a[52:55], a[220:223], v[224:227], a[52:55]
    v_exp_f32 v145, v145
    v_mfma_f32_16x16x32_bf16 a[52:55], a[216:219], v[220:223], a[52:55]
    ds_read_b128 a[172:175], v4 offset:8192
    v_mfma_f32_16x16x32_bf16 a[56:59], a[216:219], v[228:231], a[56:59]
    v_exp_f32 v146, v146
    v_mfma_f32_16x16x32_bf16 a[56:59], a[220:223], v[232:235], a[56:59]
    v_cvt_pk_bf16_f32 v206, v144, v145
    v_mfma_f32_16x16x32_bf16 a[60:63], a[220:223], v[240:243], a[60:63]
    v_exp_f32 v147, v147
    v_mfma_f32_16x16x32_bf16 a[60:63], a[216:219], v[236:239], a[60:63]
    buffer_load_dwordx4 v18, s[12:15], s29 offen offset:1024 lds
    v_smfmac_f32_16x16x64_bf16 a[228:231], v[244:247], v[220:227], v248
    s_waitcnt lgkmcnt(6)
    v_mfma_f32_16x16x32_bf16 v[140:143], a[144:147], v[68:71], v[108:111]
    v_exp_f32 v148, v148
    v_mfma_f32_16x16x32_bf16 v[140:143], a[148:151], v[72:75], v[140:143]
    ds_read_b64_tr_b16 a[208:209], v11 offset:16384
    v_cvt_pk_bf16_f32 v207, v146, v147
    v_mfma_f32_16x16x32_bf16 v[140:143], a[152:155], v[76:79], v[140:143]
    v_exp_f32 v149, v149
    v_mfma_f32_16x16x32_bf16 v[140:143], a[156:159], v[80:83], v[140:143]
    ds_read_b64_tr_b16 a[210:211], v11 offset:20480
    v_mfma_f32_16x16x32_bf16 v[144:147], a[156:159], v[96:99], v[112:115]
    v_exp_f32 v150, v150
    v_mfma_f32_16x16x32_bf16 v[144:147], a[152:155], v[92:95], v[144:147]
    ds_read_b128 a[176:179], v1 offset:12288
    v_cvt_pk_bf16_f32 v184, v148, v149
    v_mfma_f32_16x16x32_bf16 v[144:147], a[148:151], v[88:91], v[144:147]
    v_exp_f32 v151, v151
    v_mfma_f32_16x16x32_bf16 v[144:147], a[144:147], v[84:87], v[144:147]
    ds_read_b64_tr_b16 a[212:213], v11 offset:40960
    v_mfma_f32_16x16x32_bf16 a[64:67], a[192:195], v[212:215], a[64:67]
    v_exp_f32 v152, v152
    v_mfma_f32_16x16x32_bf16 a[64:67], a[196:199], v[216:219], a[64:67]
    ds_read_b64_tr_b16 a[214:215], v11 offset:45056
    v_cvt_pk_bf16_f32 v185, v150, v151
    v_mfma_f32_16x16x32_bf16 a[68:71], a[196:199], v[224:227], a[68:71]
    v_exp_f32 v153, v153
    v_mfma_f32_16x16x32_bf16 a[68:71], a[192:195], v[220:223], a[68:71]
    ds_read_b128 a[180:183], v2 offset:12288
    v_cvt_pk_bf16_f32 v192, v152, v153
    v_mfma_f32_16x16x32_bf16 a[72:75], a[192:195], v[228:231], a[72:75]
    v_exp_f32 v154, v154
    v_mfma_f32_16x16x32_bf16 a[72:75], a[196:199], v[232:235], a[72:75]
    buffer_load_dwordx4 v17, s[12:15], s29 offen offset:2048 lds
    v_mfma_f32_16x16x32_bf16 a[76:79], a[196:199], v[240:243], a[76:79]
    v_exp_f32 v155, v155
    v_mfma_f32_16x16x32_bf16 a[76:79], a[192:195], v[236:239], a[76:79]
    s_waitcnt lgkmcnt(6)
    v_mfma_f32_16x16x32_bf16 v[148:151], a[160:163], v[36:39], v[100:103]
    v_exp_f32 v156, v156
    v_mfma_f32_16x16x32_bf16 v[148:151], a[164:167], v[40:43], v[148:151]
    ds_read_b64_tr_b16 a[216:217], v12 offset:16384
    v_cvt_pk_bf16_f32 v193, v154, v155
    v_mfma_f32_16x16x32_bf16 v[148:151], a[168:171], v[44:47], v[148:151]
    v_exp_f32 v157, v157
    v_mfma_f32_16x16x32_bf16 v[148:151], a[172:175], v[48:51], v[148:151]
    ds_read_b64_tr_b16 a[218:219], v12 offset:20480
    v_mfma_f32_16x16x32_bf16 v[152:155], a[172:175], v[64:67], v[104:107]
    v_exp_f32 v158, v158
    v_mfma_f32_16x16x32_bf16 v[152:155], a[168:171], v[60:63], v[152:155]
    ds_read_b128 a[184:187], v3 offset:12288
    v_cvt_pk_bf16_f32 v200, v156, v157
    v_mfma_f32_16x16x32_bf16 v[152:155], a[164:167], v[56:59], v[152:155]
    v_exp_f32 v159, v159
    v_mfma_f32_16x16x32_bf16 v[152:155], a[160:163], v[52:55], v[152:155]
    ds_read_b64_tr_b16 a[220:221], v12 offset:40960
    v_mfma_f32_16x16x32_bf16 a[80:83], a[200:203], v[212:215], a[80:83]
    v_exp_f32 v160, v160
    v_mfma_f32_16x16x32_bf16 a[80:83], a[204:207], v[216:219], a[80:83]
    ds_read_b64_tr_b16 a[222:223], v12 offset:45056
    v_cvt_pk_bf16_f32 v201, v158, v159
    v_mfma_f32_16x16x32_bf16 a[84:87], a[204:207], v[224:227], a[84:87]
    v_exp_f32 v161, v161
    v_mfma_f32_16x16x32_bf16 a[84:87], a[200:203], v[220:223], a[84:87]
    ds_read_b128 a[188:191], v4 offset:12288
    v_mfma_f32_16x16x32_bf16 a[88:91], a[200:203], v[228:231], a[88:91]
    v_exp_f32 v162, v162
    v_mfma_f32_16x16x32_bf16 a[88:91], a[204:207], v[232:235], a[88:91]
    v_cvt_pk_bf16_f32 v208, v160, v161
    v_mfma_f32_16x16x32_bf16 a[92:95], a[204:207], v[240:243], a[92:95]
    v_exp_f32 v163, v163
    v_mfma_f32_16x16x32_bf16 a[92:95], a[200:203], v[236:239], a[92:95]
    buffer_load_dwordx4 v18, s[12:15], s29 offen offset:3072 lds
    v_smfmac_f32_16x16x64_bf16 a[232:235], v[244:247], v[228:235], v248
    s_waitcnt vmcnt(8) lgkmcnt(6)
    s_barrier
    s_add_u32 s29, s29, 16384
    v_mfma_f32_16x16x32_bf16 v[156:159], a[160:163], v[68:71], v[108:111]
    v_exp_f32 v164, v164
    v_mfma_f32_16x16x32_bf16 v[156:159], a[164:167], v[72:75], v[156:159]
    ds_read_b64_tr_b16 a[192:193], v5 offset:57344
    v_cvt_pk_bf16_f32 v209, v162, v163
    v_mfma_f32_16x16x32_bf16 v[156:159], a[168:171], v[76:79], v[156:159]
    v_exp_f32 v165, v165
    v_mfma_f32_16x16x32_bf16 v[156:159], a[172:175], v[80:83], v[156:159]
    ds_read_b64_tr_b16 a[194:195], v5 offset:61440
    v_mfma_f32_16x16x32_bf16 v[160:163], a[172:175], v[96:99], v[112:115]
    v_exp_f32 v166, v166
    v_mfma_f32_16x16x32_bf16 v[160:163], a[168:171], v[92:95], v[160:163]
    ds_read_b128 a[128:131], v1 offset:49152
    v_cvt_pk_bf16_f32 v186, v164, v165
    v_mfma_f32_16x16x32_bf16 v[160:163], a[164:167], v[88:91], v[160:163]
    v_exp_f32 v167, v167
    v_mfma_f32_16x16x32_bf16 v[160:163], a[160:163], v[84:87], v[160:163]
    ds_read_b64_tr_b16 a[196:197], v5 offset:0
    v_mfma_f32_16x16x32_bf16 a[96:99], a[208:211], v[212:215], a[96:99]
    v_exp_f32 v168, v168
    v_mfma_f32_16x16x32_bf16 a[96:99], a[212:215], v[216:219], a[96:99]
    ds_read_b64_tr_b16 a[198:199], v5 offset:4096
    v_cvt_pk_bf16_f32 v187, v166, v167
    v_mfma_f32_16x16x32_bf16 a[100:103], a[212:215], v[224:227], a[100:103]
    v_exp_f32 v169, v169
    v_mfma_f32_16x16x32_bf16 a[100:103], a[208:211], v[220:223], a[100:103]
    ds_read_b128 a[132:135], v2 offset:49152
    v_cvt_pk_bf16_f32 v194, v168, v169
    v_mfma_f32_16x16x32_bf16 a[104:107], a[208:211], v[228:231], a[104:107]
    s_add_u32 m0, s34, 32768
    v_exp_f32 v170, v170
    v_mfma_f32_16x16x32_bf16 a[104:107], a[212:215], v[232:235], a[104:107]
    buffer_load_dwordx4 v13, s[8:11], s28 offen offset:0 lds
    v_mfma_f32_16x16x32_bf16 a[108:111], a[212:215], v[240:243], a[108:111]
    v_exp_f32 v171, v171
    v_mfma_f32_16x16x32_bf16 a[108:111], a[208:211], v[236:239], a[108:111]
    s_waitcnt lgkmcnt(6)
    v_mfma_f32_16x16x32_bf16 v[164:167], a[176:179], v[36:39], v[100:103]
    v_exp_f32 v172, v172
    v_mfma_f32_16x16x32_bf16 v[164:167], a[180:183], v[40:43], v[164:167]
    ds_read_b64_tr_b16 a[200:201], v6 offset:57344
    v_cvt_pk_bf16_f32 v195, v170, v171
    v_mfma_f32_16x16x32_bf16 v[164:167], a[184:187], v[44:47], v[164:167]
    v_exp_f32 v173, v173
    v_mfma_f32_16x16x32_bf16 v[164:167], a[188:191], v[48:51], v[164:167]
    ds_read_b64_tr_b16 a[202:203], v6 offset:61440
    v_mfma_f32_16x16x32_bf16 v[168:171], a[188:191], v[64:67], v[104:107]
    v_exp_f32 v174, v174
    v_mfma_f32_16x16x32_bf16 v[168:171], a[184:187], v[60:63], v[168:171]
    ds_read_b128 a[136:139], v3 offset:49152
    v_cvt_pk_bf16_f32 v202, v172, v173
    v_mfma_f32_16x16x32_bf16 v[168:171], a[180:183], v[56:59], v[168:171]
    v_exp_f32 v175, v175
    v_mfma_f32_16x16x32_bf16 v[168:171], a[176:179], v[52:55], v[168:171]
    ds_read_b64_tr_b16 a[204:205], v6 offset:0
    v_mfma_f32_16x16x32_bf16 a[112:115], a[216:219], v[212:215], a[112:115]
    v_exp_f32 v176, v176
    v_mfma_f32_16x16x32_bf16 a[112:115], a[220:223], v[216:219], a[112:115]
    ds_read_b64_tr_b16 a[206:207], v6 offset:4096
    v_cvt_pk_bf16_f32 v203, v174, v175
    v_mfma_f32_16x16x32_bf16 a[116:119], a[220:223], v[224:227], a[116:119]
    v_exp_f32 v177, v177
    v_mfma_f32_16x16x32_bf16 a[116:119], a[216:219], v[220:223], a[116:119]
    ds_read_b128 a[140:143], v4 offset:49152
    v_mfma_f32_16x16x32_bf16 a[120:123], a[216:219], v[228:231], a[120:123]
    v_exp_f32 v178, v178
    v_mfma_f32_16x16x32_bf16 a[120:123], a[220:223], v[232:235], a[120:123]
    v_cvt_pk_bf16_f32 v210, v176, v177
    v_mfma_f32_16x16x32_bf16 a[124:127], a[220:223], v[240:243], a[124:127]
    v_exp_f32 v179, v179
    v_mfma_f32_16x16x32_bf16 a[124:127], a[216:219], v[236:239], a[124:127]
    buffer_load_dwordx4 v14, s[8:11], s28 offen offset:1024 lds
    v_smfmac_f32_16x16x64_bf16 a[236:239], v[244:247], v[236:243], v248
    s_waitcnt lgkmcnt(6)
    v_mfma_f32_16x16x32_bf16 v[172:175], a[176:179], v[68:71], v[108:111]
    v_exp_f32 v116, v116
    v_mfma_f32_16x16x32_bf16 v[172:175], a[180:183], v[72:75], v[172:175]
    ds_read_b64_tr_b16 a[208:209], v7 offset:57344
    v_cvt_pk_bf16_f32 v211, v178, v179
    v_mfma_f32_16x16x32_bf16 v[172:175], a[184:187], v[76:79], v[172:175]
    v_exp_f32 v117, v117
    v_mfma_f32_16x16x32_bf16 v[172:175], a[188:191], v[80:83], v[172:175]
    ds_read_b64_tr_b16 a[210:211], v7 offset:61440
    v_mfma_f32_16x16x32_bf16 v[176:179], a[188:191], v[96:99], v[112:115]
    v_exp_f32 v118, v118
    v_mfma_f32_16x16x32_bf16 v[176:179], a[184:187], v[92:95], v[176:179]
    ds_read_b128 a[144:147], v1 offset:53248
    v_cvt_pk_bf16_f32 v212, v116, v117
    v_mfma_f32_16x16x32_bf16 v[176:179], a[180:183], v[88:91], v[176:179]
    v_exp_f32 v119, v119
    v_mfma_f32_16x16x32_bf16 v[176:179], a[176:179], v[84:87], v[176:179]
    ds_read_b64_tr_b16 a[212:213], v7 offset:0
    v_mfma_f32_16x16x32_bf16 a[0:3], a[192:195], v[180:183], a[0:3]
    v_exp_f32 v120, v120
    v_mfma_f32_16x16x32_bf16 a[0:3], a[196:199], v[184:187], a[0:3]
    ds_read_b64_tr_b16 a[214:215], v7 offset:4096
    v_cvt_pk_bf16_f32 v213, v118, v119
    v_mfma_f32_16x16x32_bf16 a[4:7], a[196:199], v[192:195], a[4:7]
    v_exp_f32 v121, v121
    v_mfma_f32_16x16x32_bf16 a[4:7], a[192:195], v[188:191], a[4:7]
    ds_read_b128 a[148:151], v2 offset:53248
    v_cvt_pk_bf16_f32 v220, v120, v121
    v_mfma_f32_16x16x32_bf16 a[8:11], a[192:195], v[196:199], a[8:11]
    v_exp_f32 v122, v122
    v_mfma_f32_16x16x32_bf16 a[8:11], a[196:199], v[200:203], a[8:11]
    buffer_load_dwordx4 v15, s[8:11], s28 offen offset:2048 lds
    v_mfma_f32_16x16x32_bf16 a[12:15], a[196:199], v[208:211], a[12:15]
    v_exp_f32 v123, v123
    v_mfma_f32_16x16x32_bf16 a[12:15], a[192:195], v[204:207], a[12:15]
    s_waitcnt lgkmcnt(6)
    v_mfma_f32_16x16x32_bf16 v[116:119], a[128:131], v[36:39], v[100:103]
    v_exp_f32 v124, v124
    v_mfma_f32_16x16x32_bf16 v[116:119], a[132:135], v[40:43], v[116:119]
    ds_read_b64_tr_b16 a[216:217], v8 offset:57344
    v_cvt_pk_bf16_f32 v221, v122, v123
    v_mfma_f32_16x16x32_bf16 v[116:119], a[136:139], v[44:47], v[116:119]
    v_exp_f32 v125, v125
    v_mfma_f32_16x16x32_bf16 v[116:119], a[140:143], v[48:51], v[116:119]
    ds_read_b64_tr_b16 a[218:219], v8 offset:61440
    v_mfma_f32_16x16x32_bf16 v[120:123], a[140:143], v[64:67], v[104:107]
    v_exp_f32 v126, v126
    v_mfma_f32_16x16x32_bf16 v[120:123], a[136:139], v[60:63], v[120:123]
    ds_read_b128 a[152:155], v3 offset:53248
    v_cvt_pk_bf16_f32 v228, v124, v125
    v_mfma_f32_16x16x32_bf16 v[120:123], a[132:135], v[56:59], v[120:123]
    v_exp_f32 v127, v127
    v_mfma_f32_16x16x32_bf16 v[120:123], a[128:131], v[52:55], v[120:123]
    ds_read_b64_tr_b16 a[220:221], v8 offset:0
    v_mfma_f32_16x16x32_bf16 a[16:19], a[200:203], v[180:183], a[16:19]
    v_exp_f32 v128, v128
    v_mfma_f32_16x16x32_bf16 a[16:19], a[204:207], v[184:187], a[16:19]
    ds_read_b64_tr_b16 a[222:223], v8 offset:4096
    v_cvt_pk_bf16_f32 v229, v126, v127
    v_mfma_f32_16x16x32_bf16 a[20:23], a[204:207], v[192:195], a[20:23]
    v_exp_f32 v129, v129
    v_mfma_f32_16x16x32_bf16 a[20:23], a[200:203], v[188:191], a[20:23]
    ds_read_b128 a[156:159], v4 offset:53248
    v_mfma_f32_16x16x32_bf16 a[24:27], a[200:203], v[196:199], a[24:27]
    v_exp_f32 v130, v130
    v_mfma_f32_16x16x32_bf16 a[24:27], a[204:207], v[200:203], a[24:27]
    v_cvt_pk_bf16_f32 v236, v128, v129
    v_mfma_f32_16x16x32_bf16 a[28:31], a[204:207], v[208:211], a[28:31]
    v_exp_f32 v131, v131
    v_mfma_f32_16x16x32_bf16 a[28:31], a[200:203], v[204:207], a[28:31]
    buffer_load_dwordx4 v16, s[8:11], s28 offen offset:3072 lds
    v_smfmac_f32_16x16x64_bf16 a[224:227], v[244:247], v[180:187], v248
    s_waitcnt lgkmcnt(6)
    v_mfma_f32_16x16x32_bf16 v[124:127], a[128:131], v[68:71], v[108:111]
    s_cmp_eq_u32 s5, 1
    s_cbranch_scc1 L_site1
L_site_back1:
    v_exp_f32 v132, v132
    v_mfma_f32_16x16x32_bf16 v[124:127], a[132:135], v[72:75], v[124:127]
    ds_read_b64_tr_b16 a[192:193], v9 offset:57344
    v_cvt_pk_bf16_f32 v237, v130, v131
    v_mfma_f32_16x16x32_bf16 v[124:127], a[136:139], v[76:79], v[124:127]
    v_exp_f32 v133, v133
    v_mfma_f32_16x16x32_bf16 v[124:127], a[140:143], v[80:83], v[124:127]
    ds_read_b64_tr_b16 a[194:195], v9 offset:61440
    v_mfma_f32_16x16x32_bf16 v[128:131], a[140:143], v[96:99], v[112:115]
    v_exp_f32 v134, v134
    v_mfma_f32_16x16x32_bf16 v[128:131], a[136:139], v[92:95], v[128:131]
    ds_read_b128 a[160:163], v1 offset:57344
    v_cvt_pk_bf16_f32 v214, v132, v133
    v_mfma_f32_16x16x32_bf16 v[128:131], a[132:135], v[88:91], v[128:131]
    v_exp_f32 v135, v135
    v_mfma_f32_16x16x32_bf16 v[128:131], a[128:131], v[84:87], v[128:131]
    ds_read_b64_tr_b16 a[196:197], v9 offset:0
    v_mfma_f32_16x16x32_bf16 a[32:35], a[208:211], v[180:183], a[32:35]
    v_exp_f32 v136, v136
    v_mfma_f32_16x16x32_bf16 a[32:35], a[212:215], v[184:187], a[32:35]
    ds_read_b64_tr_b16 a[198:199], v9 offset:4096
    v_cvt_pk_bf16_f32 v215, v134, v135
    v_mfma_f32_16x16x32_bf16 a[36:39], a[212:215], v[192:195], a[36:39]
    v_exp_f32 v137, v137
    v_mfma_f32_16x16x32_bf16 a[36:39], a[208:211], v[188:191], a[36:39]
    ds_read_b128 a[164:167], v2 offset:57344
    v_cvt_pk_bf16_f32 v222, v136, v137
    v_mfma_f32_16x16x32_bf16 a[40:43], a[208:211], v[196:199], a[40:43]
    s_add_u32 s28, s28, 16384
    s_mov_b32 m0, s30
    v_exp_f32 v138, v138
    v_mfma_f32_16x16x32_bf16 a[40:43], a[212:215], v[200:203], a[40:43]
    buffer_load_dwordx4 v17, s[12:15], s29 offen offset:0 lds
    v_mfma_f32_16x16x32_bf16 a[44:47], a[212:215], v[208:211], a[44:47]
    v_exp_f32 v139, v139
    v_mfma_f32_16x16x32_bf16 a[44:47], a[208:211], v[204:207], a[44:47]
    s_waitcnt lgkmcnt(6)
    v_mfma_f32_16x16x32_bf16 v[132:135], a[144:147], v[36:39], v[100:103]
    v_exp_f32 v140, v140
    v_mfma_f32_16x16x32_bf16 v[132:135], a[148:151], v[40:43], v[132:135]
    ds_read_b64_tr_b16 a[200:201], v10 offset:57344
    v_cvt_pk_bf16_f32 v223, v138, v139
    v_mfma_f32_16x16x32_bf16 v[132:135], a[152:155], v[44:47], v[132:135]
    v_exp_f32 v141, v141
    v_mfma_f32_16x16x32_bf16 v[132:135], a[156:159], v[48:51], v[132:135]
    ds_read_b64_tr_b16 a[202:203], v10 offset:61440
    v_mfma_f32_16x16x32_bf16 v[136:139], a[156:159], v[64:67], v[104:107]
    v_exp_f32 v142, v142
    v_mfma_f32_16x16x32_bf16 v[136:139], a[152:155], v[60:63], v[136:139]
    ds_read_b128 a[168:171], v3 offset:57344
    v_cvt_pk_bf16_f32 v230, v140, v141
    v_mfma_f32_16x16x32_bf16 v[136:139], a[148:151], v[56:59], v[136:139]
    v_exp_f32 v143, v143
    v_mfma_f32_16x16x32_bf16 v[136:139], a[144:147], v[52:55], v[136:139]
    ds_read_b64_tr_b16 a[204:205], v10 offset:0
    v_mfma_f32_16x16x32_bf16 a[48:51], a[216:219], v[180:183], a[48:51]
    v_exp_f32 v144, v144
    v_mfma_f32_16x16x32_bf16 a[48:51], a[220:223], v[184:187], a[48:51]
    ds_read_b64_tr_b16 a[206:207], v10 offset:4096
    v_cvt_pk_bf16_f32 v231, v142, v143
    v_mfma_f32_16x16x32_bf16 a[52:55], a[220:223], v[192:195], a[52:55]
    v_exp_f32 v145, v145
    v_mfma_f32_16x16x32_bf16 a[52:55], a[216:219], v[188:191], a[52:55]
    ds_read_b128 a[172:175], v4 offset:57344
    v_mfma_f32_16x16x32_bf16 a[56:59], a[216:219], v[196:199], a[56:59]
    v_exp_f32 v146, v146
    v_mfma_f32_16x16x32_bf16 a[56:59], a[220:223], v[200:203], a[56:59]
    v_cvt_pk_bf16_f32 v238, v144, v145
    v_mfma_f32_16x16x32_bf16 a[60:63], a[220:223], v[208:211], a[60:63]
    v_exp_f32 v147, v147
    v_mfma_f32_16x16x32_bf16 a[60:63], a[216:219], v[204:207], a[60:63]
    buffer_load_dwordx4 v18, s[12:15], s29 offen offset:1024 lds
    v_smfmac_f32_16x16x64_bf16 a[228:231], v[244:247], v[188:195], v248
    s_waitcnt lgkmcnt(6)
    v_mfma_f32_16x16x32_bf16 v[140:143], a[144:147], v[68:71], v[108:111]
    v_exp_f32 v148, v148
    v_mfma_f32_16x16x32_bf16 v[140:143], a[148:151], v[72:75], v[140:143]
    ds_read_b64_tr_b16 a[208:209], v11 offset:57344
    v_cvt_pk_bf16_f32 v239, v146, v147
    v_mfma_f32_16x16x32_bf16 v[140:143], a[152:155], v[76:79], v[140:143]
    v_exp_f32 v149, v149
    v_mfma_f32_16x16x32_bf16 v[140:143], a[156:159], v[80:83], v[140:143]
    ds_read_b64_tr_b16 a[210:211], v11 offset:61440
    v_mfma_f32_16x16x32_bf16 v[144:147], a[156:159], v[96:99], v[112:115]
    v_exp_f32 v150, v150
    v_mfma_f32_16x16x32_bf16 v[144:147], a[152:155], v[92:95], v[144:147]
    ds_read_b128 a[176:179], v1 offset:61440
    v_cvt_pk_bf16_f32 v216, v148, v149
    v_mfma_f32_16x16x32_bf16 v[144:147], a[148:151], v[88:91], v[144:147]
    v_exp_f32 v151, v151
    v_mfma_f32_16x16x32_bf16 v[144:147], a[144:147], v[84:87], v[144:147]
    ds_read_b64_tr_b16 a[212:213], v11 offset:0
    v_mfma_f32_16x16x32_bf16 a[64:67], a[192:195], v[180:183], a[64:67]
    v_exp_f32 v152, v152
    v_mfma_f32_16x16x32_bf16 a[64:67], a[196:199], v[184:187], a[64:67]
    ds_read_b64_tr_b16 a[214:215], v11 offset:4096
    v_cvt_pk_bf16_f32 v217, v150, v151
    v_mfma_f32_16x16x32_bf16 a[68:71], a[196:199], v[192:195], a[68:71]
    v_exp_f32 v153, v153
    v_mfma_f32_16x16x32_bf16 a[68:71], a[192:195], v[188:191], a[68:71]
    ds_read_b128 a[180:183], v2 offset:61440
    v_cvt_pk_bf16_f32 v224, v152, v153
    v_mfma_f32_16x16x32_bf16 a[72:75], a[192:195], v[196:199], a[72:75]
    v_exp_f32 v154, v154
    v_mfma_f32_16x16x32_bf16 a[72:75], a[196:199], v[200:203], a[72:75]
    buffer_load_dwordx4 v17, s[12:15], s29 offen offset:2048 lds
    v_mfma_f32_16x16x32_bf16 a[76:79], a[196:199], v[208:211], a[76:79]
    v_exp_f32 v155, v155
    v_mfma_f32_16x16x32_bf16 a[76:79], a[192:195], v[204:207], a[76:79]
    s_waitcnt lgkmcnt(6)
    v_mfma_f32_16x16x32_bf16 v[148:151], a[160:163], v[36:39], v[100:103]
    v_exp_f32 v156, v156
    v_mfma_f32_16x16x32_bf16 v[148:151], a[164:167], v[40:43], v[148:151]
    ds_read_b64_tr_b16 a[216:217], v12 offset:57344
    v_cvt_pk_bf16_f32 v225, v154, v155
    v_mfma_f32_16x16x32_bf16 v[148:151], a[168:171], v[44:47], v[148:151]
    v_exp_f32 v157, v157
    v_mfma_f32_16x16x32_bf16 v[148:151], a[172:175], v[48:51], v[148:151]
    ds_read_b64_tr_b16 a[218:219], v12 offset:61440
    v_mfma_f32_16x16x32_bf16 v[152:155], a[172:175], v[64:67], v[104:107]
    v_exp_f32 v158, v158
    v_mfma_f32_16x16x32_bf16 v[152:155], a[168:171], v[60:63], v[152:155]
    ds_read_b128 a[184:187], v3 offset:61440
    v_cvt_pk_bf16_f32 v232, v156, v157
    v_mfma_f32_16x16x32_bf16 v[152:155], a[164:167], v[56:59], v[152:155]
    v_exp_f32 v159, v159
    v_mfma_f32_16x16x32_bf16 v[152:155], a[160:163], v[52:55], v[152:155]
    ds_read_b64_tr_b16 a[220:221], v12 offset:0
    v_mfma_f32_16x16x32_bf16 a[80:83], a[200:203], v[180:183], a[80:83]
    v_exp_f32 v160, v160
    v_mfma_f32_16x16x32_bf16 a[80:83], a[204:207], v[184:187], a[80:83]
    ds_read_b64_tr_b16 a[222:223], v12 offset:4096
    v_cvt_pk_bf16_f32 v233, v158, v159
    v_mfma_f32_16x16x32_bf16 a[84:87], a[204:207], v[192:195], a[84:87]
    v_exp_f32 v161, v161
    v_mfma_f32_16x16x32_bf16 a[84:87], a[200:203], v[188:191], a[84:87]
    ds_read_b128 a[188:191], v4 offset:61440
    v_mfma_f32_16x16x32_bf16 a[88:91], a[200:203], v[196:199], a[88:91]
    v_exp_f32 v162, v162
    v_mfma_f32_16x16x32_bf16 a[88:91], a[204:207], v[200:203], a[88:91]
    v_cvt_pk_bf16_f32 v240, v160, v161
    v_mfma_f32_16x16x32_bf16 a[92:95], a[204:207], v[208:211], a[92:95]
    v_exp_f32 v163, v163
    v_mfma_f32_16x16x32_bf16 a[92:95], a[200:203], v[204:207], a[92:95]
    buffer_load_dwordx4 v18, s[12:15], s29 offen offset:3072 lds
    v_smfmac_f32_16x16x64_bf16 a[232:235], v[244:247], v[196:203], v248
    s_waitcnt vmcnt(8) lgkmcnt(6)
    s_barrier
    s_add_u32 s29, s29, 16384
    v_mfma_f32_16x16x32_bf16 v[156:159], a[160:163], v[68:71], v[108:111]
    v_exp_f32 v164, v164
    v_mfma_f32_16x16x32_bf16 v[156:159], a[164:167], v[72:75], v[156:159]
    ds_read_b64_tr_b16 a[192:193], v5 offset:24576
    v_cvt_pk_bf16_f32 v241, v162, v163
    v_mfma_f32_16x16x32_bf16 v[156:159], a[168:171], v[76:79], v[156:159]
    v_exp_f32 v165, v165
    v_mfma_f32_16x16x32_bf16 v[156:159], a[172:175], v[80:83], v[156:159]
    ds_read_b64_tr_b16 a[194:195], v5 offset:28672
    v_mfma_f32_16x16x32_bf16 v[160:163], a[172:175], v[96:99], v[112:115]
    v_exp_f32 v166, v166
    v_mfma_f32_16x16x32_bf16 v[160:163], a[168:171], v[92:95], v[160:163]
    ds_read_b128 a[128:131], v1 offset:16384
    v_cvt_pk_bf16_f32 v218, v164, v165
    v_mfma_f32_16x16x32_bf16 v[160:163], a[164:167], v[88:91], v[160:163]
    v_exp_f32 v167, v167
    v_mfma_f32_16x16x32_bf16 v[160:163], a[160:163], v[84:87], v[160:163]
    ds_read_b64_tr_b16 a[196:197], v5 offset:49152
    v_mfma_f32_16x16x32_bf16 a[96:99], a[208:211], v[180:183], a[96:99]
    v_exp_f32 v168, v168
    v_mfma_f32_16x16x32_bf16 a[96:99], a[212:215], v[184:187], a[96:99]
    ds_read_b64_tr_b16 a[198:199], v5 offset:53248
    v_cvt_pk_bf16_f32 v219, v166, v167
    v_mfma_f32_16x16x32_bf16 a[100:103], a[212:215], v[192:195], a[100:103]
    v_exp_f32 v169, v169
    v_mfma_f32_16x16x32_bf16 a[100:103], a[208:211], v[188:191], a[100:103]
    ds_read_b128 a[132:135], v2 offset:16384
    v_cvt_pk_bf16_f32 v226, v168, v169
    v_mfma_f32_16x16x32_bf16 a[104:107], a[208:211], v[196:199], a[104:107]
    s_add_u32 m0, s34, 0
    v_exp_f32 v170, v170
    v_mfma_f32_16x16x32_bf16 a[104:107], a[212:215], v[200:203], a[104:107]
    buffer_load_dwordx4 v13, s[8:11], s28 offen offset:0 lds
    v_mfma_f32_16x16x32_bf16 a[108:111], a[212:215], v[208:211], a[108:111]
    v_exp_f32 v171, v171
    v_mfma_f32_16x16x32_bf16 a[108:111], a[208:211], v[204:207], a[108:111]
    s_waitcnt lgkmcnt(6)
    v_mfma_f32_16x16x32_bf16 v[164:167], a[176:179], v[36:39], v[100:103]
    v_exp_f32 v172, v172
    v_mfma_f32_16x16x32_bf16 v[164:167], a[180:183], v[40:43], v[164:167]
    ds_read_b64_tr_b16 a[200:201], v6 offset:24576
    v_cvt_pk_bf16_f32 v227, v170, v171
    v_mfma_f32_16x16x32_bf16 v[164:167], a[184:187], v[44:47], v[164:167]
    v_exp_f32 v173, v173
    v_mfma_f32_16x16x32_bf16 v[164:167], a[188:191], v[48:51], v[164:167]
    ds_read_b64_tr_b16 a[202:203], v6 offset:28672
    v_mfma_f32_16x16x32_bf16 v[168:171], a[188:191], v[64:67], v[104:107]
    v_exp_f32 v174, v174
    v_mfma_f32_16x16x32_bf16 v[168:171], a[184:187], v[60:63], v[168:171]
    ds_read_b128 a[136:139], v3 offset:16384
    v_cvt_pk_bf16_f32 v234, v172, v173
    v_mfma_f32_16x16x32_bf16 v[168:171], a[180:183], v[56:59], v[168:171]
    v_exp_f32 v175, v175
    v_mfma_f32_16x16x32_bf16 v[168:171], a[176:179], v[52:55], v[168:171]
    ds_read_b64_tr_b16 a[204:205], v6 offset:49152
    v_mfma_f32_16x16x32_bf16 a[112:115], a[216:219], v[180:183], a[112:115]
    v_exp_f32 v176, v176
    v_mfma_f32_16x16x32_bf16 a[112:115], a[220:223], v[184:187], a[112:115]
    ds_read_b64_tr_b16 a[206:207], v6 offset:53248
    v_cvt_pk_bf16_f32 v235, v174, v175
    v_mfma_f32_16x16x32_bf16 a[116:119], a[220:223], v[192:195], a[116:119]
    v_exp_f32 v177, v177
    v_mfma_f32_16x16x32_bf16 a[116:119], a[216:219], v[188:191], a[116:119]
    ds_read_b128 a[140:143], v4 offset:16384
    v_mfma_f32_16x16x32_bf16 a[120:123], a[216:219], v[196:199], a[120:123]
    v_exp_f32 v178, v178
    v_mfma_f32_16x16x32_bf16 a[120:123], a[220:223], v[200:203], a[120:123]
    v_cvt_pk_bf16_f32 v242, v176, v177
    v_mfma_f32_16x16x32_bf16 a[124:127], a[220:223], v[208:211], a[124:127]
    v_exp_f32 v179, v179
    v_mfma_f32_16x16x32_bf16 a[124:127], a[216:219], v[204:207], a[124:127]
    buffer_load_dwordx4 v14, s[8:11], s28 offen offset:1024 lds
    v_smfmac_f32_16x16x64_bf16 a[236:239], v[244:247], v[204:211], v248
    s_waitcnt lgkmcnt(6)
    v_mfma_f32_16x16x32_bf16 v[172:175], a[176:179], v[68:71], v[108:111]
    v_exp_f32 v116, v116
    v_mfma_f32_16x16x32_bf16 v[172:175], a[180:183], v[72:75], v[172:175]
    ds_read_b64_tr_b16 a[208:209], v7 offset:24576
    v_cvt_pk_bf16_f32 v243, v178, v179
    v_mfma_f32_16x16x32_bf16 v[172:175], a[184:187], v[76:79], v[172:175]
    v_exp_f32 v117, v117
    v_mfma_f32_16x16x32_bf16 v[172:175], a[188:191], v[80:83], v[172:175]
    ds_read_b64_tr_b16 a[210:211], v7 offset:28672
    v_mfma_f32_16x16x32_bf16 v[176:179], a[188:191], v[96:99], v[112:115]
    v_exp_f32 v118, v118
    v_mfma_f32_16x16x32_bf16 v[176:179], a[184:187], v[92:95], v[176:179]
    ds_read_b128 a[144:147], v1 offset:20480
    v_cvt_pk_bf16_f32 v180, v116, v117
    v_mfma_f32_16x16x32_bf16 v[176:179], a[180:183], v[88:91], v[176:179]
    v_exp_f32 v119, v119
    v_mfma_f32_16x16x32_bf16 v[176:179], a[176:179], v[84:87], v[176:179]
    ds_read_b64_tr_b16 a[212:213], v7 offset:49152
    v_mfma_f32_16x16x32_bf16 a[0:3], a[192:195], v[212:215], a[0:3]
    v_exp_f32 v120, v120
    v_mfma_f32_16x16x32_bf16 a[0:3], a[196:199], v[216:219], a[0:3]
    ds_read_b64_tr_b16 a[214:215], v7 offset:53248
    v_cvt_pk_bf16_f32 v181, v118, v119
    v_mfma_f32_16x16x32_bf16 a[4:7], a[196:199], v[224:227], a[4:7]
    v_exp_f32 v121, v121
    v_mfma_f32_16x16x32_bf16 a[4:7], a[192:195], v[220:223], a[4:7]
    ds_read_b128 a[148:151], v2 offset:20480
    v_cvt_pk_bf16_f32 v188, v120, v121
    v_mfma_f32_16x16x32_bf16 a[8:11], a[192:195], v[228:231], a[8:11]
    v_exp_f32 v122, v122
    v_mfma_f32_16x16x32_bf16 a[8:11], a[196:199], v[232:235], a[8:11]
    buffer_load_dwordx4 v15, s[8:11], s28 offen offset:2048 lds
    v_mfma_f32_16x16x32_bf16 a[12:15], a[196:199], v[240:243], a[12:15]
    v_exp_f32 v123, v123
    v_mfma_f32_16x16x32_bf16 a[12:15], a[192:195], v[236:239], a[12:15]
    s_waitcnt lgkmcnt(6)
    v_mfma_f32_16x16x32_bf16 v[116:119], a[128:131], v[36:39], v[100:103]
    v_exp_f32 v124, v124
    v_mfma_f32_16x16x32_bf16 v[116:119], a[132:135], v[40:43], v[116:119]
    ds_read_b64_tr_b16 a[216:217], v8 offset:24576
    v_cvt_pk_bf16_f32 v189, v122, v123
    v_mfma_f32_16x16x32_bf16 v[116:119], a[136:139], v[44:47], v[116:119]
    v_exp_f32 v125, v125
    v_mfma_f32_16x16x32_bf16 v[116:119], a[140:143], v[48:51], v[116:119]
    ds_read_b64_tr_b16 a[218:219], v8 offset:28672
    v_mfma_f32_16x16x32_bf16 v[120:123], a[140:143], v[64:67], v[104:107]
    v_exp_f32 v126, v126
    v_mfma_f32_16x16x32_bf16 v[120:123], a[136:139], v[60:63], v[120:123]
    ds_read_b128 a[152:155], v3 offset:20480
    v_cvt_pk_bf16_f32 v196, v124, v125
    v_mfma_f32_16x16x32_bf16 v[120:123], a[132:135], v[56:59], v[120:123]
    v_exp_f32 v127, v127
    v_mfma_f32_16x16x32_bf16 v[120:123], a[128:131], v[52:55], v[120:123]
    ds_read_b64_tr_b16 a[220:221], v8 offset:49152
    v_mfma_f32_16x16x32_bf16 a[16:19], a[200:203], v[212:215], a[16:19]
    v_exp_f32 v128, v128
    v_mfma_f32_16x16x32_bf16 a[16:19], a[204:207], v[216:219], a[16:19]
    ds_read_b64_tr_b16 a[222:223], v8 offset:53248
    v_cvt_pk_bf16_f32 v197, v126, v127
    v_mfma_f32_16x16x32_bf16 a[20:23], a[204:207], v[224:227], a[20:23]
    v_exp_f32 v129, v129
    v_mfma_f32_16x16x32_bf16 a[20:23], a[200:203], v[220:223], a[20:23]
    ds_read_b128 a[156:159], v4 offset:20480
    v_mfma_f32_16x16x32_bf16 a[24:27], a[200:203], v[228:231], a[24:27]
    v_exp_f32 v130, v130
    v_mfma_f32_16x16x32_bf16 a[24:27], a[204:207], v[232:235], a[24:27]
    v_cvt_pk_bf16_f32 v204, v128, v129
    v_mfma_f32_16x16x32_bf16 a[28:31], a[204:207], v[240:243], a[28:31]
    v_exp_f32 v131, v131
    v_mfma_f32_16x16x32_bf16 a[28:31], a[200:203], v[236:239], a[28:31]
    buffer_load_dwordx4 v16, s[8:11], s28 offen offset:3072 lds
    v_smfmac_f32_16x16x64_bf16 a[224:227], v[244:247], v[212:219], v248
    s_waitcnt lgkmcnt(6)
    v_mfma_f32_16x16x32_bf16 v[124:127], a[128:131], v[68:71], v[108:111]
    s_cmp_eq_u32 s5, 2
    s_cbranch_scc1 L_site2
L_site_back2:
    v_exp_f32 v132, v132
    v_mfma_f32_16x16x32_bf16 v[124:127], a[132:135], v[72:75], v[124:127]
    ds_read_b64_tr_b16 a[192:193], v9 offset:24576
    v_cvt_pk_bf16_f32 v205, v130, v131
    v_mfma_f32_16x16x32_bf16 v[124:127], a[136:139], v[76:79], v[124:127]
    v_exp_f32 v133, v133
    v_mfma_f32_16x16x32_bf16 v[124:127], a[140:143], v[80:83], v[124:127]
    ds_read_b64_tr_b16 a[194:195], v9 offset:28672
    v_mfma_f32_16x16x32_bf16 v[128:131], a[140:143], v[96:99], v[112:115]
    v_exp_f32 v134, v134
    v_mfma_f32_16x16x32_bf16 v[128:131], a[136:139], v[92:95], v[128:131]
    ds_read_b128 a[160:163], v1 offset:24576
    v_cvt_pk_bf16_f32 v182, v132, v133
    v_mfma_f32_16x16x32_bf16 v[128:131], a[132:135], v[88:91], v[128:131]
    v_exp_f32 v135, v135
    v_mfma_f32_16x16x32_bf16 v[128:131], a[128:131], v[84:87], v[128:131]
    ds_read_b64_tr_b16 a[196:197], v9 offset:49152
    v_mfma_f32_16x16x32_bf16 a[32:35], a[208:211], v[212:215], a[32:35]
    v_exp_f32 v136, v136
    v_mfma_f32_16x16x32_bf16 a[32:35], a[212:215], v[216:219], a[32:35]
    ds_read_b64_tr_b16 a[198:199], v9 offset:53248
    v_cvt_pk_bf16_f32 v183, v134, v135
    v_mfma_f32_16x16x32_bf16 a[36:39], a[212:215], v[224:227], a[36:39]
    v_exp_f32 v137, v137
    v_mfma_f32_16x16x32_bf16 a[36:39], a[208:211], v[220:223], a[36:39]
    ds_read_b128 a[164:167], v2 offset:24576
    v_cvt_pk_bf16_f32 v190, v136, v137
    v_mfma_f32_16x16x32_bf16 a[40:43], a[208:211], v[228:231], a[40:43]
    s_add_u32 s28, s28, 16384
    s_mov_b32 m0, s31
    v_exp_f32 v138, v138
    v_mfma_f32_16x16x32_bf16 a[40:43], a[212:215], v[232:235], a[40:43]
    buffer_load_dwordx4 v17, s[12:15], s29 offen offset:0 lds
    v_mfma_f32_16x16x32_bf16 a[44:47], a[212:215], v[240:243], a[44:47]
    v_exp_f32 v139, v139
    v_mfma_f32_16x16x32_bf16 a[44:47], a[208:211], v[236:239], a[44:47]
    s_waitcnt lgkmcnt(6)
    v_mfma_f32_16x16x32_bf16 v[132:135], a[144:147], v[36:39], v[100:103]
    v_exp_f32 v140, v140
    v_mfma_f32_16x16x32_bf16 v[132:135], a[148:151], v[40:43], v[132:135]
    ds_read_b64_tr_b16 a[200:201], v10 offset:24576
    v_cvt_pk_bf16_f32 v191, v138, v139
    v_mfma_f32_16x16x32_bf16 v[132:135], a[152:155], v[44:47], v[132:135]
    v_exp_f32 v141, v141
    v_mfma_f32_16x16x32_bf16 v[132:135], a[156:159], v[48:51], v[132:135]
    ds_read_b64_tr_b16 a[202:203], v10 offset:28672
    v_mfma_f32_16x16x32_bf16 v[136:139], a[156:159], v[64:67], v[104:107]
    v_exp_f32 v142, v142
    v_mfma_f32_16x16x32_bf16 v[136:139], a[152:155], v[60:63], v[136:139]
    ds_read_b128 a[168:171], v3 offset:24576
    v_cvt_pk_bf16_f32 v198, v140, v141
    v_mfma_f32_16x16x32_bf16 v[136:139], a[148:151], v[56:59], v[136:139]
    v_exp_f32 v143, v143
    v_mfma_f32_16x16x32_bf16 v[136:139], a[144:147], v[52:55], v[136:139]
    ds_read_b64_tr_b16 a[204:205], v10 offset:49152
    v_mfma_f32_16x16x32_bf16 a[48:51], a[216:219], v[212:215], a[48:51]
    v_exp_f32 v144, v144
    v_mfma_f32_16x16x32_bf16 a[48:51], a[220:223], v[216:219], a[48:51]
    ds_read_b64_tr_b16 a[206:207], v10 offset:53248
    v_cvt_pk_bf16_f32 v199, v142, v143
    v_mfma_f32_16x16x32_bf16 a[52:55], a[220:223], v[224:227], a[52:55]
    v_exp_f32 v145, v145
    v_mfma_f32_16x16x32_bf16 a[52:55], a[216:219], v[220:223], a[52:55]
    ds_read_b128 a[172:175], v4 offset:24576
    v_mfma_f32_16x16x32_bf16 a[56:59], a[216:219], v[228:231], a[56:59]
    v_exp_f32 v146, v146
    v_mfma_f32_16x16x32_bf16 a[56:59], a[220:223], v[232:235], a[56:59]
    v_cvt_pk_bf16_f32 v206, v144, v145
    v_mfma_f32_16x16x32_bf16 a[60:63], a[220:223], v[240:243], a[60:63]
    v_exp_f32 v147, v147
    v_mfma_f32_16x16x32_bf16 a[60:63], a[216:219], v[236:239], a[60:63]
    buffer_load_dwordx4 v18, s[12:15], s29 offen offset:1024 lds
    v_smfmac_f32_16x16x64_bf16 a[228:231], v[244:247], v[220:227], v248
    s_waitcnt lgkmcnt(6)
    v_mfma_f32_16x16x32_bf16 v[140:143], a[144:147], v[68:71], v[108:111]
    v_exp_f32 v148, v148
    v_mfma_f32_16x16x32_bf16 v[140:143], a[148:151], v[72:75], v[140:143]
    ds_read_b64_tr_b16 a[208:209], v11 offset:24576
    v_cvt_pk_bf16_f32 v207, v146, v147
    v_mfma_f32_16x16x32_bf16 v[140:143], a[152:155], v[76:79], v[140:143]
    v_exp_f32 v149, v149
    v_mfma_f32_16x16x32_bf16 v[140:143], a[156:159], v[80:83], v[140:143]
    ds_read_b64_tr_b16 a[210:211], v11 offset:28672
    v_mfma_f32_16x16x32_bf16 v[144:147], a[156:159], v[96:99], v[112:115]
    v_exp_f32 v150, v150
    v_mfma_f32_16x16x32_bf16 v[144:147], a[152:155], v[92:95], v[144:147]
    ds_read_b128 a[176:179], v1 offset:28672
    v_cvt_pk_bf16_f32 v184, v148, v149
    v_mfma_f32_16x16x32_bf16 v[144:147], a[148:151], v[88:91], v[144:147]
    v_exp_f32 v151, v151
    v_mfma_f32_16x16x32_bf16 v[144:147], a[144:147], v[84:87], v[144:147]
    ds_read_b64_tr_b16 a[212:213], v11 offset:49152
    v_mfma_f32_16x16x32_bf16 a[64:67], a[192:195], v[212:215], a[64:67]
    v_exp_f32 v152, v152
    v_mfma_f32_16x16x32_bf16 a[64:67], a[196:199], v[216:219], a[64:67]
    ds_read_b64_tr_b16 a[214:215], v11 offset:53248
    v_cvt_pk_bf16_f32 v185, v150, v151
    v_mfma_f32_16x16x32_bf16 a[68:71], a[196:199], v[224:227], a[68:71]
    v_exp_f32 v153, v153
    v_mfma_f32_16x16x32_bf16 a[68:71], a[192:195], v[220:223], a[68:71]
    ds_read_b128 a[180:183], v2 offset:28672
    v_cvt_pk_bf16_f32 v192, v152, v153
    v_mfma_f32_16x16x32_bf16 a[72:75], a[192:195], v[228:231], a[72:75]
    v_exp_f32 v154, v154
    v_mfma_f32_16x16x32_bf16 a[72:75], a[196:199], v[232:235], a[72:75]
    buffer_load_dwordx4 v17, s[12:15], s29 offen offset:2048 lds
    v_mfma_f32_16x16x32_bf16 a[76:79], a[196:199], v[240:243], a[76:79]
    v_exp_f32 v155, v155
    v_mfma_f32_16x16x32_bf16 a[76:79], a[192:195], v[236:239], a[76:79]
    s_waitcnt lgkmcnt(6)
    v_mfma_f32_16x16x32_bf16 v[148:151], a[160:163], v[36:39], v[100:103]
    v_exp_f32 v156, v156
    v_mfma_f32_16x16x32_bf16 v[148:151], a[164:167], v[40:43], v[148:151]
    ds_read_b64_tr_b16 a[216:217], v12 offset:24576
    v_cvt_pk_bf16_f32 v193, v154, v155
    v_mfma_f32_16x16x32_bf16 v[148:151], a[168:171], v[44:47], v[148:151]
    v_exp_f32 v157, v157
    v_mfma_f32_16x16x32_bf16 v[148:151], a[172:175], v[48:51], v[148:151]
    ds_read_b64_tr_b16 a[218:219], v12 offset:28672
    v_mfma_f32_16x16x32_bf16 v[152:155], a[172:175], v[64:67], v[104:107]
    v_exp_f32 v158, v158
    v_mfma_f32_16x16x32_bf16 v[152:155], a[168:171], v[60:63], v[152:155]
    ds_read_b128 a[184:187], v3 offset:28672
    v_cvt_pk_bf16_f32 v200, v156, v157
    v_mfma_f32_16x16x32_bf16 v[152:155], a[164:167], v[56:59], v[152:155]
    v_exp_f32 v159, v159
    v_mfma_f32_16x16x32_bf16 v[152:155], a[160:163], v[52:55], v[152:155]
    ds_read_b64_tr_b16 a[220:221], v12 offset:49152
    v_mfma_f32_16x16x32_bf16 a[80:83], a[200:203], v[212:215], a[80:83]
    v_exp_f32 v160, v160
    v_mfma_f32_16x16x32_bf16 a[80:83], a[204:207], v[216:219], a[80:83]
    ds_read_b64_tr_b16 a[222:223], v12 offset:53248
    v_cvt_pk_bf16_f32 v201, v158, v159
    v_mfma_f32_16x16x32_bf16 a[84:87], a[204:207], v[224:227], a[84:87]
    v_exp_f32 v161, v161
    v_mfma_f32_16x16x32_bf16 a[84:87], a[200:203], v[220:223], a[84:87]
    ds_read_b128 a[188:191], v4 offset:28672
    v_mfma_f32_16x16x32_bf16 a[88:91], a[200:203], v[228:231], a[88:91]
    v_exp_f32 v162, v162
    v_mfma_f32_16x16x32_bf16 a[88:91], a[204:207], v[232:235], a[88:91]
    v_cvt_pk_bf16_f32 v208, v160, v161
    v_mfma_f32_16x16x32_bf16 a[92:95], a[204:207], v[240:243], a[92:95]
    v_exp_f32 v163, v163
    v_mfma_f32_16x16x32_bf16 a[92:95], a[200:203], v[236:239], a[92:95]
    buffer_load_dwordx4 v18, s[12:15], s29 offen offset:3072 lds
    v_smfmac_f32_16x16x64_bf16 a[232:235], v[244:247], v[228:235], v248
    s_waitcnt vmcnt(8) lgkmcnt(6)
    s_barrier
    s_add_u32 s29, s29, 16384
    v_mfma_f32_16x16x32_bf16 v[156:159], a[160:163], v[68:71], v[108:111]
    v_exp_f32 v164, v164
    v_mfma_f32_16x16x32_bf16 v[156:159], a[164:167], v[72:75], v[156:159]
    ds_read_b64_tr_b16 a[192:193], v5 offset:8192
    v_cvt_pk_bf16_f32 v209, v162, v163
    v_mfma_f32_16x16x32_bf16 v[156:159], a[168:171], v[76:79], v[156:159]
    v_exp_f32 v165, v165
    v_mfma_f32_16x16x32_bf16 v[156:159], a[172:175], v[80:83], v[156:159]
    ds_read_b64_tr_b16 a[194:195], v5 offset:12288
    v_mfma_f32_16x16x32_bf16 v[160:163], a[172:175], v[96:99], v[112:115]
    v_exp_f32 v166, v166
    v_mfma_f32_16x16x32_bf16 v[160:163], a[168:171], v[92:95], v[160:163]
    ds_read_b128 a[128:131], v1 offset:32768
    v_cvt_pk_bf16_f32 v186, v164, v165
    v_mfma_f32_16x16x32_bf16 v[160:163], a[164:167], v[88:91], v[160:163]
    v_exp_f32 v167, v167
    v_mfma_f32_16x16x32_bf16 v[160:163], a[160:163], v[84:87], v[160:163]
    ds_read_b64_tr_b16 a[196:197], v5 offset:32768
    v_mfma_f32_16x16x32_bf16 a[96:99], a[208:211], v[212:215], a[96:99]
    v_exp_f32 v168, v168
    v_mfma_f32_16x16x32_bf16 a[96:99], a[212:215], v[216:219], a[96:99]
    ds_read_b64_tr_b16 a[198:199], v5 offset:36864
    v_cvt_pk_bf16_f32 v187, v166, v167
    v_mfma_f32_16x16x32_bf16 a[100:103], a[212:215], v[224:227], a[100:103]
    v_exp_f32 v169, v169
    v_mfma_f32_16x16x32_bf16 a[100:103], a[208:211], v[220:223], a[100:103]
    ds_read_b128 a[132:135], v2 offset:32768
    v_cvt_pk_bf16_f32 v194, v168, v169
    v_mfma_f32_16x16x32_bf16 a[104:107], a[208:211], v[228:231], a[104:107]
    s_add_u32 m0, s34, 49152
    v_exp_f32 v170, v170
    v_mfma_f32_16x16x32_bf16 a[104:107], a[212:215], v[232:235], a[104:107]
    buffer_load_dwordx4 v13, s[8:11], s28 offen offset:0 lds
    v_mfma_f32_16x16x32_bf16 a[108:111], a[212:215], v[240:243], a[108:111]
    v_exp_f32 v171, v171
    v_mfma_f32_16x16x32_bf16 a[108:111], a[208:211], v[236:239], a[108:111]
    s_waitcnt lgkmcnt(6)
    v_mfma_f32_16x16x32_bf16 v[164:167], a[176:179], v[36:39], v[100:103]
    v_exp_f32 v172, v172
    v_mfma_f32_16x16x32_bf16 v[164:167], a[180:183], v[40:43], v[164:167]
    ds_read_b64_tr_b16 a[200:201], v6 offset:8192
    v_cvt_pk_bf16_f32 v195, v170, v171
    v_mfma_f32_16x16x32_bf16 v[164:167], a[184:187], v[44:47], v[164:167]
    v_exp_f32 v173, v173
    v_mfma_f32_16x16x32_bf16 v[164:167], a[188:191], v[48:51], v[164:167]
    ds_read_b64_tr_b16 a[202:203], v6 offset:12288
    v_mfma_f32_16x16x32_bf16 v[168:171], a[188:191], v[64:67], v[104:107]
    v_exp_f32 v174, v174
    v_mfma_f32_16x16x32_bf16 v[168:171], a[184:187], v[60:63], v[168:171]
    ds_read_b128 a[136:139], v3 offset:32768
    v_cvt_pk_bf16_f32 v202, v172, v173
    v_mfma_f32_16x16x32_bf16 v[168:171], a[180:183], v[56:59], v[168:171]
    v_exp_f32 v175, v175
    v_mfma_f32_16x16x32_bf16 v[168:171], a[176:179], v[52:55], v[168:171]
    ds_read_b64_tr_b16 a[204:205], v6 offset:32768
    v_mfma_f32_16x16x32_bf16 a[112:115], a[216:219], v[212:215], a[112:115]
    v_exp_f32 v176, v176
    v_mfma_f32_16x16x32_bf16 a[112:115], a[220:223], v[216:219], a[112:115]
    ds_read_b64_tr_b16 a[206:207], v6 offset:36864
    v_cvt_pk_bf16_f32 v203, v174, v175
    v_mfma_f32_16x16x32_bf16 a[116:119], a[220:223], v[224:227], a[116:119]
    v_exp_f32 v177, v177
    v_mfma_f32_16x16x32_bf16 a[116:119], a[216:219], v[220:223], a[116:119]
    ds_read_b128 a[140:143], v4 offset:32768
    v_mfma_f32_16x16x32_bf16 a[120:123], a[216:219], v[228:231], a[120:123]
    v_exp_f32 v178, v178
    v_mfma_f32_16x16x32_bf16 a[120:123], a[220:223], v[232:235], a[120:123]
    v_cvt_pk_bf16_f32 v210, v176, v177
    v_mfma_f32_16x16x32_bf16 a[124:127], a[220:223], v[240:243], a[124:127]
    v_exp_f32 v179, v179
    v_mfma_f32_16x16x32_bf16 a[124:127], a[216:219], v[236:239], a[124:127]
    buffer_load_dwordx4 v14, s[8:11], s28 offen offset:1024 lds
    v_smfmac_f32_16x16x64_bf16 a[236:239], v[244:247], v[236:243], v248
    s_waitcnt lgkmcnt(6)
    v_mfma_f32_16x16x32_bf16 v[172:175], a[176:179], v[68:71], v[108:111]
    v_exp_f32 v116, v116
    v_mfma_f32_16x16x32_bf16 v[172:175], a[180:183], v[72:75], v[172:175]
    ds_read_b64_tr_b16 a[208:209], v7 offset:8192
    v_cvt_pk_bf16_f32 v211, v178, v179
    v_mfma_f32_16x16x32_bf16 v[172:175], a[184:187], v[76:79], v[172:175]
    v_exp_f32 v117, v117
    v_mfma_f32_16x16x32_bf16 v[172:175], a[188:191], v[80:83], v[172:175]
    ds_read_b64_tr_b16 a[210:211], v7 offset:12288
    v_mfma_f32_16x16x32_bf16 v[176:179], a[188:191], v[96:99], v[112:115]
    v_exp_f32 v118, v118
    v_mfma_f32_16x16x32_bf16 v[176:179], a[184:187], v[92:95], v[176:179]
    ds_read_b128 a[144:147], v1 offset:36864
    v_cvt_pk_bf16_f32 v212, v116, v117
    v_mfma_f32_16x16x32_bf16 v[176:179], a[180:183], v[88:91], v[176:179]
    v_exp_f32 v119, v119
    v_mfma_f32_16x16x32_bf16 v[176:179], a[176:179], v[84:87], v[176:179]
    ds_read_b64_tr_b16 a[212:213], v7 offset:32768
    v_mfma_f32_16x16x32_bf16 a[0:3], a[192:195], v[180:183], a[0:3]
    v_exp_f32 v120, v120
    v_mfma_f32_16x16x32_bf16 a[0:3], a[196:199], v[184:187], a[0:3]
    ds_read_b64_tr_b16 a[214:215], v7 offset:36864
    v_cvt_pk_bf16_f32 v213, v118, v119
    v_mfma_f32_16x16x32_bf16 a[4:7], a[196:199], v[192:195], a[4:7]
    v_exp_f32 v121, v121
    v_mfma_f32_16x16x32_bf16 a[4:7], a[192:195], v[188:191], a[4:7]
    ds_read_b128 a[148:151], v2 offset:36864
    v_cvt_pk_bf16_f32 v220, v120, v121
    v_mfma_f32_16x16x32_bf16 a[8:11], a[192:195], v[196:199], a[8:11]
    v_exp_f32 v122, v122
    v_mfma_f32_16x16x32_bf16 a[8:11], a[196:199], v[200:203], a[8:11]
    buffer_load_dwordx4 v15, s[8:11], s28 offen offset:2048 lds
    v_mfma_f32_16x16x32_bf16 a[12:15], a[196:199], v[208:211], a[12:15]
    v_exp_f32 v123, v123
    v_mfma_f32_16x16x32_bf16 a[12:15], a[192:195], v[204:207], a[12:15]
    s_waitcnt lgkmcnt(6)
    v_mfma_f32_16x16x32_bf16 v[116:119], a[128:131], v[36:39], v[100:103]
    v_exp_f32 v124, v124
    v_mfma_f32_16x16x32_bf16 v[116:119], a[132:135], v[40:43], v[116:119]
    ds_read_b64_tr_b16 a[216:217], v8 offset:8192
    v_cvt_pk_bf16_f32 v221, v122, v123
    v_mfma_f32_16x16x32_bf16 v[116:119], a[136:139], v[44:47], v[116:119]
    v_exp_f32 v125, v125
    v_mfma_f32_16x16x32_bf16 v[116:119], a[140:143], v[48:51], v[116:119]
    ds_read_b64_tr_b16 a[218:219], v8 offset:12288
    v_mfma_f32_16x16x32_bf16 v[120:123], a[140:143], v[64:67], v[104:107]
    v_exp_f32 v126, v126
    v_mfma_f32_16x16x32_bf16 v[120:123], a[136:139], v[60:63], v[120:123]
    ds_read_b128 a[152:155], v3 offset:36864
    v_cvt_pk_bf16_f32 v228, v124, v125
    v_mfma_f32_16x16x32_bf16 v[120:123], a[132:135], v[56:59], v[120:123]
    v_exp_f32 v127, v127
    v_mfma_f32_16x16x32_bf16 v[120:123], a[128:131], v[52:55], v[120:123]
    ds_read_b64_tr_b16 a[220:221], v8 offset:32768
    v_mfma_f32_16x16x32_bf16 a[16:19], a[200:203], v[180:183], a[16:19]
    v_exp_f32 v128, v128
    v_mfma_f32_16x16x32_bf16 a[16:19], a[204:207], v[184:187], a[16:19]
    ds_read_b64_tr_b16 a[222:223], v8 offset:36864
    v_cvt_pk_bf16_f32 v229, v126, v127
    v_mfma_f32_16x16x32_bf16 a[20:23], a[204:207], v[192:195], a[20:23]
    v_exp_f32 v129, v129
    v_mfma_f32_16x16x32_bf16 a[20:23], a[200:203], v[188:191], a[20:23]
    ds_read_b128 a[156:159], v4 offset:36864
    v_mfma_f32_16x16x32_bf16 a[24:27], a[200:203], v[196:199], a[24:27]
    v_exp_f32 v130, v130
    v_mfma_f32_16x16x32_bf16 a[24:27], a[204:207], v[200:203], a[24:27]
    v_cvt_pk_bf16_f32 v236, v128, v129
    v_mfma_f32_16x16x32_bf16 a[28:31], a[204:207], v[208:211], a[28:31]
    v_exp_f32 v131, v131
    v_mfma_f32_16x16x32_bf16 a[28:31], a[200:203], v[204:207], a[28:31]
    buffer_load_dwordx4 v16, s[8:11], s28 offen offset:3072 lds
    v_smfmac_f32_16x16x64_bf16 a[224:227], v[244:247], v[180:187], v248
    s_waitcnt lgkmcnt(6)
    v_mfma_f32_16x16x32_bf16 v[124:127], a[128:131], v[68:71], v[108:111]
    s_cmp_eq_u32 s5, 3
    s_cbranch_scc1 L_site3
L_site_back3:
    v_exp_f32 v132, v132
    v_mfma_f32_16x16x32_bf16 v[124:127], a[132:135], v[72:75], v[124:127]
    ds_read_b64_tr_b16 a[192:193], v9 offset:8192
    v_cvt_pk_bf16_f32 v237, v130, v131
    v_mfma_f32_16x16x32_bf16 v[124:127], a[136:139], v[76:79], v[124:127]
    v_exp_f32 v133, v133
    v_mfma_f32_16x16x32_bf16 v[124:127], a[140:143], v[80:83], v[124:127]
    ds_read_b64_tr_b16 a[194:195], v9 offset:12288
    v_mfma_f32_16x16x32_bf16 v[128:131], a[140:143], v[96:99], v[112:115]
    v_exp_f32 v134, v134
    v_mfma_f32_16x16x32_bf16 v[128:131], a[136:139], v[92:95], v[128:131]
    ds_read_b128 a[160:163], v1 offset:40960
    v_cvt_pk_bf16_f32 v214, v132, v133
    v_mfma_f32_16x16x32_bf16 v[128:131], a[132:135], v[88:91], v[128:131]
    v_exp_f32 v135, v135
    v_mfma_f32_16x16x32_bf16 v[128:131], a[128:131], v[84:87], v[128:131]
    ds_read_b64_tr_b16 a[196:197], v9 offset:32768
    v_mfma_f32_16x16x32_bf16 a[32:35], a[208:211], v[180:183], a[32:35]
    v_exp_f32 v136, v136
    v_mfma_f32_16x16x32_bf16 a[32:35], a[212:215], v[184:187], a[32:35]
    ds_read_b64_tr_b16 a[198:199], v9 offset:36864
    v_cvt_pk_bf16_f32 v215, v134, v135
    v_mfma_f32_16x16x32_bf16 a[36:39], a[212:215], v[192:195], a[36:39]
    v_exp_f32 v137, v137
    v_mfma_f32_16x16x32_bf16 a[36:39], a[208:211], v[188:191], a[36:39]
    ds_read_b128 a[164:167], v2 offset:40960
    v_cvt_pk_bf16_f32 v222, v136, v137
    v_mfma_f32_16x16x32_bf16 a[40:43], a[208:211], v[196:199], a[40:43]
    s_add_u32 s28, s28, 16384
    s_mov_b32 m0, s32
    v_exp_f32 v138, v138
    v_mfma_f32_16x16x32_bf16 a[40:43], a[212:215], v[200:203], a[40:43]
    buffer_load_dwordx4 v17, s[12:15], s29 offen offset:0 lds
    v_mfma_f32_16x16x32_bf16 a[44:47], a[212:215], v[208:211], a[44:47]
    v_exp_f32 v139, v139
    v_mfma_f32_16x16x32_bf16 a[44:47], a[208:211], v[204:207], a[44:47]
    s_waitcnt lgkmcnt(6)
    v_mfma_f32_16x16x32_bf16 v[132:135], a[144:147], v[36:39], v[100:103]
    v_exp_f32 v140, v140
    v_mfma_f32_16x16x32_bf16 v[132:135], a[148:151], v[40:43], v[132:135]
    ds_read_b64_tr_b16 a[200:201], v10 offset:8192
    v_cvt_pk_bf16_f32 v223, v138, v139
    v_mfma_f32_16x16x32_bf16 v[132:135], a[152:155], v[44:47], v[132:135]
    v_exp_f32 v141, v141
    v_mfma_f32_16x16x32_bf16 v[132:135], a[156:159], v[48:51], v[132:135]
    ds_read_b64_tr_b16 a[202:203], v10 offset:12288
    v_mfma_f32_16x16x32_bf16 v[136:139], a[156:159], v[64:67], v[104:107]
    v_exp_f32 v142, v142
    v_mfma_f32_16x16x32_bf16 v[136:139], a[152:155], v[60:63], v[136:139]
    ds_read_b128 a[168:171], v3 offset:40960
    v_cvt_pk_bf16_f32 v230, v140, v141
    v_mfma_f32_16x16x32_bf16 v[136:139], a[148:151], v[56:59], v[136:139]
    v_exp_f32 v143, v143
    v_mfma_f32_16x16x32_bf16 v[136:139], a[144:147], v[52:55], v[136:139]
    ds_read_b64_tr_b16 a[204:205], v10 offset:32768
    v_mfma_f32_16x16x32_bf16 a[48:51], a[216:219], v[180:183], a[48:51]
    v_exp_f32 v144, v144
    v_mfma_f32_16x16x32_bf16 a[48:51], a[220:223], v[184:187], a[48:51]
    ds_read_b64_tr_b16 a[206:207], v10 offset:36864
    v_cvt_pk_bf16_f32 v231, v142, v143
    v_mfma_f32_16x16x32_bf16 a[52:55], a[220:223], v[192:195], a[52:55]
    v_exp_f32 v145, v145
    v_mfma_f32_16x16x32_bf16 a[52:55], a[216:219], v[188:191], a[52:55]
    ds_read_b128 a[172:175], v4 offset:40960
    v_mfma_f32_16x16x32_bf16 a[56:59], a[216:219], v[196:199], a[56:59]
    v_exp_f32 v146, v146
    v_mfma_f32_16x16x32_bf16 a[56:59], a[220:223], v[200:203], a[56:59]
    v_cvt_pk_bf16_f32 v238, v144, v145
    v_mfma_f32_16x16x32_bf16 a[60:63], a[220:223], v[208:211], a[60:63]
    v_exp_f32 v147, v147
    v_mfma_f32_16x16x32_bf16 a[60:63], a[216:219], v[204:207], a[60:63]
    buffer_load_dwordx4 v18, s[12:15], s29 offen offset:1024 lds
    v_smfmac_f32_16x16x64_bf16 a[228:231], v[244:247], v[188:195], v248
    s_waitcnt lgkmcnt(6)
    v_mfma_f32_16x16x32_bf16 v[140:143], a[144:147], v[68:71], v[108:111]
    v_exp_f32 v148, v148
    v_mfma_f32_16x16x32_bf16 v[140:143], a[148:151], v[72:75], v[140:143]
    ds_read_b64_tr_b16 a[208:209], v11 offset:8192
    v_cvt_pk_bf16_f32 v239, v146, v147
    v_mfma_f32_16x16x32_bf16 v[140:143], a[152:155], v[76:79], v[140:143]
    v_exp_f32 v149, v149
    v_mfma_f32_16x16x32_bf16 v[140:143], a[156:159], v[80:83], v[140:143]
    ds_read_b64_tr_b16 a[210:211], v11 offset:12288
    v_mfma_f32_16x16x32_bf16 v[144:147], a[156:159], v[96:99], v[112:115]
    v_exp_f32 v150, v150
    v_mfma_f32_16x16x32_bf16 v[144:147], a[152:155], v[92:95], v[144:147]
    ds_read_b128 a[176:179], v1 offset:45056
    v_cvt_pk_bf16_f32 v216, v148, v149
    v_mfma_f32_16x16x32_bf16 v[144:147], a[148:151], v[88:91], v[144:147]
    v_exp_f32 v151, v151
    v_mfma_f32_16x16x32_bf16 v[144:147], a[144:147], v[84:87], v[144:147]
    ds_read_b64_tr_b16 a[212:213], v11 offset:32768
    v_mfma_f32_16x16x32_bf16 a[64:67], a[192:195], v[180:183], a[64:67]
    v_exp_f32 v152, v152
    v_mfma_f32_16x16x32_bf16 a[64:67], a[196:199], v[184:187], a[64:67]
    ds_read_b64_tr_b16 a[214:215], v11 offset:36864
    v_cvt_pk_bf16_f32 v217, v150, v151
    v_mfma_f32_16x16x32_bf16 a[68:71], a[196:199], v[192:195], a[68:71]
    v_exp_f32 v153, v153
    v_mfma_f32_16x16x32_bf16 a[68:71], a[192:195], v[188:191], a[68:71]
    ds_read_b128 a[180:183], v2 offset:45056
    v_cvt_pk_bf16_f32 v224, v152, v153
    v_mfma_f32_16x16x32_bf16 a[72:75], a[192:195], v[196:199], a[72:75]
    v_exp_f32 v154, v154
    v_mfma_f32_16x16x32_bf16 a[72:75], a[196:199], v[200:203], a[72:75]
    buffer_load_dwordx4 v17, s[12:15], s29 offen offset:2048 lds
    v_mfma_f32_16x16x32_bf16 a[76:79], a[196:199], v[208:211], a[76:79]
    v_exp_f32 v155, v155
    v_mfma_f32_16x16x32_bf16 a[76:79], a[192:195], v[204:207], a[76:79]
    s_waitcnt lgkmcnt(6)
    v_mfma_f32_16x16x32_bf16 v[148:151], a[160:163], v[36:39], v[100:103]
    v_exp_f32 v156, v156
    v_mfma_f32_16x16x32_bf16 v[148:151], a[164:167], v[40:43], v[148:151]
    ds_read_b64_tr_b16 a[216:217], v12 offset:8192
    v_cvt_pk_bf16_f32 v225, v154, v155
    v_mfma_f32_16x16x32_bf16 v[148:151], a[168:171], v[44:47], v[148:151]
    v_exp_f32 v157, v157
    v_mfma_f32_16x16x32_bf16 v[148:151], a[172:175], v[48:51], v[148:151]
    ds_read_b64_tr_b16 a[218:219], v12 offset:12288
    v_mfma_f32_16x16x32_bf16 v[152:155], a[172:175], v[64:67], v[104:107]
    v_exp_f32 v158, v158
    v_mfma_f32_16x16x32_bf16 v[152:155], a[168:171], v[60:63], v[152:155]
    ds_read_b128 a[184:187], v3 offset:45056
    v_cvt_pk_bf16_f32 v232, v156, v157
    v_mfma_f32_16x16x32_bf16 v[152:155], a[164:167], v[56:59], v[152:155]
    v_exp_f32 v159, v159
    v_mfma_f32_16x16x32_bf16 v[152:155], a[160:163], v[52:55], v[152:155]
    ds_read_b64_tr_b16 a[220:221], v12 offset:32768
    v_mfma_f32_16x16x32_bf16 a[80:83], a[200:203], v[180:183], a[80:83]
    v_exp_f32 v160, v160
    v_mfma_f32_16x16x32_bf16 a[80:83], a[204:207], v[184:187], a[80:83]
    ds_read_b64_tr_b16 a[222:223], v12 offset:36864
    v_cvt_pk_bf16_f32 v233, v158, v159
    v_mfma_f32_16x16x32_bf16 a[84:87], a[204:207], v[192:195], a[84:87]
    v_exp_f32 v161, v161
    v_mfma_f32_16x16x32_bf16 a[84:87], a[200:203], v[188:191], a[84:87]
    ds_read_b128 a[188:191], v4 offset:45056
    v_mfma_f32_16x16x32_bf16 a[88:91], a[200:203], v[196:199], a[88:91]
    v_exp_f32 v162, v162
    v_mfma_f32_16x16x32_bf16 a[88:91], a[204:207], v[200:203], a[88:91]
    v_cvt_pk_bf16_f32 v240, v160, v161
    v_mfma_f32_16x16x32_bf16 a[92:95], a[204:207], v[208:211], a[92:95]
    v_exp_f32 v163, v163
    v_mfma_f32_16x16x32_bf16 a[92:95], a[200:203], v[204:207], a[92:95]
    buffer_load_dwordx4 v18, s[12:15], s29 offen offset:3072 lds
    v_smfmac_f32_16x16x64_bf16 a[232:235], v[244:247], v[196:203], v248
    s_waitcnt vmcnt(8) lgkmcnt(6)
    s_barrier
    s_add_u32 s29, s29, 16384
    v_mfma_f32_16x16x32_bf16 v[156:159], a[160:163], v[68:71], v[108:111]
    v_exp_f32 v164, v164
    v_mfma_f32_16x16x32_bf16 v[156:159], a[164:167], v[72:75], v[156:159]
    ds_read_b64_tr_b16 a[192:193], v5 offset:16384
    v_cvt_pk_bf16_f32 v241, v162, v163
    v_mfma_f32_16x16x32_bf16 v[156:159], a[168:171], v[76:79], v[156:159]
    v_exp_f32 v165, v165
    v_mfma_f32_16x16x32_bf16 v[156:159], a[172:175], v[80:83], v[156:159]
    ds_read_b64_tr_b16 a[194:195], v5 offset:20480
    v_mfma_f32_16x16x32_bf16 v[160:163], a[172:175], v[96:99], v[112:115]
    v_exp_f32 v166, v166
    v_mfma_f32_16x16x32_bf16 v[160:163], a[168:171], v[92:95], v[160:163]
    ds_read_b128 a[128:131], v1 offset:0
    v_cvt_pk_bf16_f32 v218, v164, v165
    v_mfma_f32_16x16x32_bf16 v[160:163], a[164:167], v[88:91], v[160:163]
    v_exp_f32 v167, v167
    v_mfma_f32_16x16x32_bf16 v[160:163], a[160:163], v[84:87], v[160:163]
    ds_read_b64_tr_b16 a[196:197], v5 offset:40960
    v_mfma_f32_16x16x32_bf16 a[96:99], a[208:211], v[180:183], a[96:99]
    v_exp_f32 v168, v168
    v_mfma_f32_16x16x32_bf16 a[96:99], a[212:215], v[184:187], a[96:99]
    ds_read_b64_tr_b16 a[198:199], v5 offset:45056
    v_cvt_pk_bf16_f32 v219, v166, v167
    v_mfma_f32_16x16x32_bf16 a[100:103], a[212:215], v[192:195], a[100:103]
    v_exp_f32 v169, v169
    v_mfma_f32_16x16x32_bf16 a[100:103], a[208:211], v[188:191], a[100:103]
    ds_read_b128 a[132:135], v2 offset:0
    v_cvt_pk_bf16_f32 v226, v168, v169
    v_mfma_f32_16x16x32_bf16 a[104:107], a[208:211], v[196:199], a[104:107]
    s_add_u32 m0, s34, 16384
    v_exp_f32 v170, v170
    v_mfma_f32_16x16x32_bf16 a[104:107], a[212:215], v[200:203], a[104:107]
    buffer_load_dwordx4 v13, s[8:11], s28 offen offset:0 lds
    v_mfma_f32_16x16x32_bf16 a[108:111], a[212:215], v[208:211], a[108:111]
    v_exp_f32 v171, v171
    v_mfma_f32_16x16x32_bf16 a[108:111], a[208:211], v[204:207], a[108:111]
    s_waitcnt lgkmcnt(6)
    v_mfma_f32_16x16x32_bf16 v[164:167], a[176:179], v[36:39], v[100:103]
    v_exp_f32 v172, v172
    v_mfma_f32_16x16x32_bf16 v[164:167], a[180:183], v[40:43], v[164:167]
    ds_read_b64_tr_b16 a[200:201], v6 offset:16384
    v_cvt_pk_bf16_f32 v227, v170, v171
    v_mfma_f32_16x16x32_bf16 v[164:167], a[184:187], v[44:47], v[164:167]
    v_exp_f32 v173, v173
    v_mfma_f32_16x16x32_bf16 v[164:167], a[188:191], v[48:51], v[164:167]
    ds_read_b64_tr_b16 a[202:203], v6 offset:20480
    v_mfma_f32_16x16x32_bf16 v[168:171], a[188:191], v[64:67], v[104:107]
    v_exp_f32 v174, v174
    v_mfma_f32_16x16x32_bf16 v[168:171], a[184:187], v[60:63], v[168:171]
    ds_read_b128 a[136:139], v3 offset:0
    v_cvt_pk_bf16_f32 v234, v172, v173
    v_mfma_f32_16x16x32_bf16 v[168:171], a[180:183], v[56:59], v[168:171]
    v_exp_f32 v175, v175
    v_mfma_f32_16x16x32_bf16 v[168:171], a[176:179], v[52:55], v[168:171]
    ds_read_b64_tr_b16 a[204:205], v6 offset:40960
    v_mfma_f32_16x16x32_bf16 a[112:115], a[216:219], v[180:183], a[112:115]
    v_exp_f32 v176, v176
    v_mfma_f32_16x16x32_bf16 a[112:115], a[220:223], v[184:187], a[112:115]
    ds_read_b64_tr_b16 a[206:207], v6 offset:45056
    v_cvt_pk_bf16_f32 v235, v174, v175
    v_mfma_f32_16x16x32_bf16 a[116:119], a[220:223], v[192:195], a[116:119]
    v_exp_f32 v177, v177
    v_mfma_f32_16x16x32_bf16 a[116:119], a[216:219], v[188:191], a[116:119]
    ds_read_b128 a[140:143], v4 offset:0
    v_mfma_f32_16x16x32_bf16 a[120:123], a[216:219], v[196:199], a[120:123]
    v_exp_f32 v178, v178
    v_mfma_f32_16x16x32_bf16 a[120:123], a[220:223], v[200:203], a[120:123]
    v_cvt_pk_bf16_f32 v242, v176, v177
    v_mfma_f32_16x16x32_bf16 a[124:127], a[220:223], v[208:211], a[124:127]
    v_exp_f32 v179, v179
    v_mfma_f32_16x16x32_bf16 a[124:127], a[216:219], v[204:207], a[124:127]
    buffer_load_dwordx4 v14, s[8:11], s28 offen offset:1024 lds
    v_smfmac_f32_16x16x64_bf16 a[236:239], v[244:247], v[204:211], v248
    s_waitcnt lgkmcnt(6)
    s_sub_u32 s35, s35, 1
    s_cbranch_scc0 L_attn_loop
    v_mfma_f32_16x16x32_bf16 v[172:175], a[176:179], v[68:71], v[108:111]
    s_bfe_u32 s47, s2, 0x10003
    v_exp_f32 v116, v116
    v_mfma_f32_16x16x32_bf16 v[172:175], a[180:183], v[72:75], v[172:175]
    s_bfe_u32 s40, s2, 0x20001
    ds_read_b64_tr_b16 a[208:209], v7 offset:16384
    v_cvt_pk_bf16_f32 v243, v178, v179
    v_mfma_f32_16x16x32_bf16 v[172:175], a[184:187], v[76:79], v[172:175]
    s_lshl_b32 s40, s40, 3
    v_exp_f32 v117, v117
    v_mfma_f32_16x16x32_bf16 v[172:175], a[188:191], v[80:83], v[172:175]
    s_bfe_u32 s41, s2, 0x30003
    ds_read_b64_tr_b16 a[210:211], v7 offset:20480
    v_and_b32 v21, 7, v19
    v_mfma_f32_16x16x32_bf16 v[176:179], a[188:191], v[96:99], v[112:115]
    s_add_u32 s87, s40, s41
    v_exp_f32 v118, v118
    v_mfma_f32_16x16x32_bf16 v[176:179], a[184:187], v[92:95], v[176:179]
    s_and_b32 s40, s2, 1
    ds_read_b128 a[144:147], v1 offset:4096
    v_cvt_pk_bf16_f32 v180, v116, v117
    v_mfma_f32_16x16x32_bf16 v[176:179], a[180:183], v[88:91], v[176:179]
    s_lshl_b32 s40, s40, 2
    v_exp_f32 v119, v119
    v_mfma_f32_16x16x32_bf16 v[176:179], a[176:179], v[84:87], v[176:179]
    s_lshr_b32 s41, s2, 6
    ds_read_b64_tr_b16 a[212:213], v7 offset:40960
    v_lshlrev_b32 v21, 2, v21
    v_mfma_f32_16x16x32_bf16 a[0:3], a[192:195], v[212:215], a[0:3]
    s_add_u32 s100, s40, s41
    v_exp_f32 v120, v120
    v_mfma_f32_16x16x32_bf16 a[0:3], a[196:199], v[216:219], a[0:3]
    s_add_u32 s16, s72, 0x1a00000
    s_addc_u32 s17, s73, 0
    ds_read_b64_tr_b16 a[214:215], v7 offset:45056
    v_cvt_pk_bf16_f32 v181, v118, v119
    v_mfma_f32_16x16x32_bf16 a[4:7], a[196:199], v[224:227], a[4:7]
    s_mov_b32 s18, 0x438000
    v_exp_f32 v121, v121
    v_mfma_f32_16x16x32_bf16 a[4:7], a[192:195], v[220:223], a[4:7]
    s_mov_b32 s19, 0x20000
    ds_read_b128 a[148:151], v2 offset:4096
    v_cvt_pk_bf16_f32 v188, v120, v121
    v_mfma_f32_16x16x32_bf16 a[8:11], a[192:195], v[228:231], a[8:11]
    v_exp_f32 v122, v122
    v_mfma_f32_16x16x32_bf16 a[8:11], a[196:199], v[232:235], a[8:11]
    buffer_load_dwordx4 v15, s[8:11], s28 offen offset:2048 lds
    v_mfma_f32_16x16x32_bf16 a[12:15], a[196:199], v[240:243], a[12:15]
    v_exp_f32 v123, v123
    v_mfma_f32_16x16x32_bf16 a[12:15], a[192:195], v[236:239], a[12:15]
    s_waitcnt lgkmcnt(6)
    v_add_u32 v21, 0x29b000, v21
    v_mfma_f32_16x16x32_bf16 v[116:119], a[128:131], v[36:39], v[100:103]
    v_exp_f32 v124, v124
    v_mfma_f32_16x16x32_bf16 v[116:119], a[132:135], v[40:43], v[116:119]
    ds_read_b64_tr_b16 a[216:217], v8 offset:16384
    v_cvt_pk_bf16_f32 v189, v122, v123
    v_mfma_f32_16x16x32_bf16 v[116:119], a[136:139], v[44:47], v[116:119]
    v_exp_f32 v125, v125
    v_mfma_f32_16x16x32_bf16 v[116:119], a[140:143], v[48:51], v[116:119]
    ds_read_b64_tr_b16 a[218:219], v8 offset:20480
    v_mfma_f32_16x16x32_bf16 v[120:123], a[140:143], v[64:67], v[104:107]
    v_exp_f32 v126, v126
    v_mfma_f32_16x16x32_bf16 v[120:123], a[136:139], v[60:63], v[120:123]
    ds_read_b128 a[152:155], v3 offset:4096
    v_cvt_pk_bf16_f32 v196, v124, v125
    v_mfma_f32_16x16x32_bf16 v[120:123], a[132:135], v[56:59], v[120:123]
    v_exp_f32 v127, v127
    v_mfma_f32_16x16x32_bf16 v[120:123], a[128:131], v[52:55], v[120:123]
    ds_read_b64_tr_b16 a[220:221], v8 offset:40960
    v_mfma_f32_16x16x32_bf16 a[16:19], a[200:203], v[212:215], a[16:19]
    v_exp_f32 v128, v128
    v_mfma_f32_16x16x32_bf16 a[16:19], a[204:207], v[216:219], a[16:19]
    ds_read_b64_tr_b16 a[222:223], v8 offset:45056
    v_cvt_pk_bf16_f32 v197, v126, v127
    v_mfma_f32_16x16x32_bf16 a[20:23], a[204:207], v[224:227], a[20:23]
    v_exp_f32 v129, v129
    v_mfma_f32_16x16x32_bf16 a[20:23], a[200:203], v[220:223], a[20:23]
    ds_read_b128 a[156:159], v4 offset:4096
    v_mfma_f32_16x16x32_bf16 a[24:27], a[200:203], v[228:231], a[24:27]
    v_exp_f32 v130, v130
    v_mfma_f32_16x16x32_bf16 a[24:27], a[204:207], v[232:235], a[24:27]
    v_cvt_pk_bf16_f32 v204, v128, v129
    v_mfma_f32_16x16x32_bf16 a[28:31], a[204:207], v[240:243], a[28:31]
    v_exp_f32 v131, v131
    v_mfma_f32_16x16x32_bf16 a[28:31], a[200:203], v[236:239], a[28:31]
    buffer_load_dwordx4 v16, s[8:11], s28 offen offset:3072 lds
    v_smfmac_f32_16x16x64_bf16 a[224:227], v[244:247], v[212:219], v248
    s_waitcnt lgkmcnt(6)
    buffer_load_dword v249, v21, s[76:79], 0 offen sc1
    v_mfma_f32_16x16x32_bf16 v[124:127], a[128:131], v[68:71], v[108:111]
    v_exp_f32 v132, v132
    v_mfma_f32_16x16x32_bf16 v[124:127], a[132:135], v[72:75], v[124:127]
    ds_read_b64_tr_b16 a[192:193], v9 offset:16384
    v_cvt_pk_bf16_f32 v205, v130, v131
    v_mfma_f32_16x16x32_bf16 v[124:127], a[136:139], v[76:79], v[124:127]
    v_exp_f32 v133, v133
    v_mfma_f32_16x16x32_bf16 v[124:127], a[140:143], v[80:83], v[124:127]
    ds_read_b64_tr_b16 a[194:195], v9 offset:20480
    v_mov_b32 v24, 0x3f803f80
    v_mfma_f32_16x16x32_bf16 v[128:131], a[140:143], v[96:99], v[112:115]
    v_exp_f32 v134, v134
    v_mfma_f32_16x16x32_bf16 v[128:131], a[136:139], v[92:95], v[128:131]
    ds_read_b128 a[160:163], v1 offset:8192
    v_cvt_pk_bf16_f32 v182, v132, v133
    v_mfma_f32_16x16x32_bf16 v[128:131], a[132:135], v[88:91], v[128:131]
    v_exp_f32 v135, v135
    v_accvgpr_write_b32 a240, v24
    v_mfma_f32_16x16x32_bf16 v[128:131], a[128:131], v[84:87], v[128:131]
    ds_read_b64_tr_b16 a[196:197], v9 offset:40960
    v_accvgpr_write_b32 a241, v24
    v_mfma_f32_16x16x32_bf16 a[32:35], a[208:211], v[212:215], a[32:35]
    v_exp_f32 v136, v136
    v_mfma_f32_16x16x32_bf16 a[32:35], a[212:215], v[216:219], a[32:35]
    ds_read_b64_tr_b16 a[198:199], v9 offset:45056
    v_cvt_pk_bf16_f32 v183, v134, v135
    v_lshlrev_b32 v25, 4, v19
    v_mfma_f32_16x16x32_bf16 a[36:39], a[212:215], v[224:227], a[36:39]
    s_mul_i32 s40, s5, 3072
    v_exp_f32 v137, v137
    v_mfma_f32_16x16x32_bf16 a[36:39], a[208:211], v[220:223], a[36:39]
    s_mul_i32 s41, s6, 10240
    ds_read_b128 a[164:167], v2 offset:8192
    v_cvt_pk_bf16_f32 v190, v136, v137
    v_mfma_f32_16x16x32_bf16 a[40:43], a[208:211], v[228:231], a[40:43]
    s_add_u32 s28, s28, 16384
    s_mov_b32 m0, s33
    v_exp_f32 v138, v138
    v_accvgpr_write_b32 a242, v24
    v_mfma_f32_16x16x32_bf16 a[40:43], a[212:215], v[232:235], a[40:43]
    s_add_u32 s41, s41, s40
    buffer_load_dwordx4 v17, s[12:15], s29 offen offset:0 lds
    v_mfma_f32_16x16x32_bf16 a[44:47], a[212:215], v[240:243], a[44:47]
    v_exp_f32 v139, v139
    v_mfma_f32_16x16x32_bf16 a[44:47], a[208:211], v[236:239], a[44:47]
    s_waitcnt lgkmcnt(6)
    v_accvgpr_write_b32 a243, v24
    v_accvgpr_write_b32 a244, v24
    v_mfma_f32_16x16x32_bf16 v[132:135], a[144:147], v[36:39], v[100:103]
    v_exp_f32 v140, v140
    v_mfma_f32_16x16x32_bf16 v[132:135], a[148:151], v[40:43], v[132:135]
    ds_read_b64_tr_b16 a[200:201], v10 offset:16384
    v_cvt_pk_bf16_f32 v191, v138, v139
    v_mfma_f32_16x16x32_bf16 v[132:135], a[152:155], v[44:47], v[132:135]
    v_exp_f32 v141, v141
    v_mfma_f32_16x16x32_bf16 v[132:135], a[156:159], v[48:51], v[132:135]
    ds_read_b64_tr_b16 a[202:203], v10 offset:20480
    v_accvgpr_write_b32 a245, v24
    v_mfma_f32_16x16x32_bf16 v[136:139], a[156:159], v[64:67], v[104:107]
    v_exp_f32 v142, v142
    v_mfma_f32_16x16x32_bf16 v[136:139], a[152:155], v[60:63], v[136:139]
    ds_read_b128 a[168:171], v3 offset:8192
    v_cvt_pk_bf16_f32 v198, v140, v141
    v_mfma_f32_16x16x32_bf16 v[136:139], a[148:151], v[56:59], v[136:139]
    v_exp_f32 v143, v143
    v_mfma_f32_16x16x32_bf16 v[136:139], a[144:147], v[52:55], v[136:139]
    ds_read_b64_tr_b16 a[204:205], v10 offset:40960
    v_accvgpr_write_b32 a246, v24
    v_mfma_f32_16x16x32_bf16 a[48:51], a[216:219], v[212:215], a[48:51]
    v_exp_f32 v144, v144
    v_mfma_f32_16x16x32_bf16 a[48:51], a[220:223], v[216:219], a[48:51]
    ds_read_b64_tr_b16 a[206:207], v10 offset:45056
    v_cvt_pk_bf16_f32 v199, v142, v143
    v_mfma_f32_16x16x32_bf16 a[52:55], a[220:223], v[224:227], a[52:55]
    v_exp_f32 v145, v145
    v_mfma_f32_16x16x32_bf16 a[52:55], a[216:219], v[220:223], a[52:55]
    ds_read_b128 a[172:175], v4 offset:8192
    v_accvgpr_write_b32 a247, v24
    v_mfma_f32_16x16x32_bf16 a[56:59], a[216:219], v[228:231], a[56:59]
    v_exp_f32 v146, v146
    v_mfma_f32_16x16x32_bf16 a[56:59], a[220:223], v[232:235], a[56:59]
    v_cvt_pk_bf16_f32 v206, v144, v145
    v_accvgpr_write_b32 a248, v24
    v_mfma_f32_16x16x32_bf16 a[60:63], a[220:223], v[240:243], a[60:63]
    v_exp_f32 v147, v147
    v_mfma_f32_16x16x32_bf16 a[60:63], a[216:219], v[236:239], a[60:63]
    buffer_load_dwordx4 v18, s[12:15], s29 offen offset:1024 lds
    v_smfmac_f32_16x16x64_bf16 a[228:231], v[244:247], v[220:227], v248
    s_waitcnt lgkmcnt(6)
    v_accvgpr_write_b32 a249, v24
    v_accvgpr_write_b32 a250, v24
    v_mfma_f32_16x16x32_bf16 v[140:143], a[144:147], v[68:71], v[108:111]
    v_exp_f32 v148, v148
    v_mfma_f32_16x16x32_bf16 v[140:143], a[148:151], v[72:75], v[140:143]
    ds_read_b64_tr_b16 a[208:209], v11 offset:16384
    v_cvt_pk_bf16_f32 v207, v146, v147
    v_mfma_f32_16x16x32_bf16 v[140:143], a[152:155], v[76:79], v[140:143]
    v_exp_f32 v149, v149
    v_mfma_f32_16x16x32_bf16 v[140:143], a[156:159], v[80:83], v[140:143]
    ds_read_b64_tr_b16 a[210:211], v11 offset:20480
    v_accvgpr_write_b32 a251, v24
    v_mfma_f32_16x16x32_bf16 v[144:147], a[156:159], v[96:99], v[112:115]
    v_exp_f32 v150, v150
    v_mfma_f32_16x16x32_bf16 v[144:147], a[152:155], v[92:95], v[144:147]
    ds_read_b128 a[176:179], v1 offset:12288
    v_cvt_pk_bf16_f32 v184, v148, v149
    v_mfma_f32_16x16x32_bf16 v[144:147], a[148:151], v[88:91], v[144:147]
    v_exp_f32 v151, v151
    v_mfma_f32_16x16x32_bf16 v[144:147], a[144:147], v[84:87], v[144:147]
    ds_read_b64_tr_b16 a[212:213], v11 offset:40960
    v_accvgpr_write_b32 a252, v24
    v_mfma_f32_16x16x32_bf16 a[64:67], a[192:195], v[212:215], a[64:67]
    v_exp_f32 v152, v152
    v_mfma_f32_16x16x32_bf16 a[64:67], a[196:199], v[216:219], a[64:67]
    ds_read_b64_tr_b16 a[214:215], v11 offset:45056
    v_cvt_pk_bf16_f32 v185, v150, v151
    v_mfma_f32_16x16x32_bf16 a[68:71], a[196:199], v[224:227], a[68:71]
    v_exp_f32 v153, v153
    v_mfma_f32_16x16x32_bf16 a[68:71], a[192:195], v[220:223], a[68:71]
    ds_read_b128 a[180:183], v2 offset:12288
    v_cvt_pk_bf16_f32 v192, v152, v153
    v_mfma_f32_16x16x32_bf16 a[72:75], a[192:195], v[228:231], a[72:75]
    v_exp_f32 v154, v154
    v_mfma_f32_16x16x32_bf16 a[72:75], a[196:199], v[232:235], a[72:75]
    buffer_load_dwordx4 v17, s[12:15], s29 offen offset:2048 lds
    s_mov_b32 s43, m0
    s_add_u32 m0, s40, 86016
    s_nop 0
    buffer_load_dwordx4 v25, s[96:99], s41 offen offset:0 lds
    s_mov_b32 m0, s43
    v_accvgpr_write_b32 a253, v24
    v_mfma_f32_16x16x32_bf16 a[76:79], a[196:199], v[240:243], a[76:79]
    v_exp_f32 v155, v155
    v_mfma_f32_16x16x32_bf16 a[76:79], a[192:195], v[236:239], a[76:79]
    s_waitcnt lgkmcnt(6)
    v_accvgpr_write_b32 a254, v24
    v_accvgpr_write_b32 a255, v24
    v_mfma_f32_16x16x32_bf16 v[148:151], a[160:163], v[36:39], v[100:103]
    v_exp_f32 v156, v156
    v_mfma_f32_16x16x32_bf16 v[148:151], a[164:167], v[40:43], v[148:151]
    ds_read_b64_tr_b16 a[216:217], v12 offset:16384
    v_cvt_pk_bf16_f32 v193, v154, v155
    v_mfma_f32_16x16x32_bf16 v[148:151], a[168:171], v[44:47], v[148:151]
    v_exp_f32 v157, v157
    v_mfma_f32_16x16x32_bf16 v[148:151], a[172:175], v[48:51], v[148:151]
    ds_read_b64_tr_b16 a[218:219], v12 offset:20480
    v_mov_b32 v252, v24
    v_mfma_f32_16x16x32_bf16 v[152:155], a[172:175], v[64:67], v[104:107]
    v_exp_f32 v158, v158
    v_mfma_f32_16x16x32_bf16 v[152:155], a[168:171], v[60:63], v[152:155]
    ds_read_b128 a[184:187], v3 offset:12288
    v_cvt_pk_bf16_f32 v200, v156, v157
    v_mfma_f32_16x16x32_bf16 v[152:155], a[164:167], v[56:59], v[152:155]
    v_exp_f32 v159, v159
    v_mfma_f32_16x16x32_bf16 v[152:155], a[160:163], v[52:55], v[152:155]
    ds_read_b64_tr_b16 a[220:221], v12 offset:40960
    s_mov_b32 s43, m0
    s_add_u32 m0, s40, 86016
    s_nop 0
    buffer_load_dwordx4 v25, s[96:99], s41 offen offset:1024 lds
    s_mov_b32 m0, s43
    v_mov_b32 v253, v24
    v_mfma_f32_16x16x32_bf16 a[80:83], a[200:203], v[212:215], a[80:83]
    v_exp_f32 v160, v160
    v_mfma_f32_16x16x32_bf16 a[80:83], a[204:207], v[216:219], a[80:83]
    ds_read_b64_tr_b16 a[222:223], v12 offset:45056
    v_cvt_pk_bf16_f32 v201, v158, v159
    v_mfma_f32_16x16x32_bf16 a[84:87], a[204:207], v[224:227], a[84:87]
    v_exp_f32 v161, v161
    v_mfma_f32_16x16x32_bf16 a[84:87], a[200:203], v[220:223], a[84:87]
    ds_read_b128 a[188:191], v4 offset:12288
    v_mov_b32 v254, v24
    v_mfma_f32_16x16x32_bf16 a[88:91], a[200:203], v[228:231], a[88:91]
    v_exp_f32 v162, v162
    v_mfma_f32_16x16x32_bf16 a[88:91], a[204:207], v[232:235], a[88:91]
    v_cvt_pk_bf16_f32 v208, v160, v161
    v_mov_b32 v255, v24
    v_mfma_f32_16x16x32_bf16 a[92:95], a[204:207], v[240:243], a[92:95]
    v_exp_f32 v163, v163
    v_mfma_f32_16x16x32_bf16 a[92:95], a[200:203], v[236:239], a[92:95]
    buffer_load_dwordx4 v18, s[12:15], s29 offen offset:3072 lds
    v_smfmac_f32_16x16x64_bf16 a[232:235], v[244:247], v[228:235], v248
    s_waitcnt vmcnt(11) lgkmcnt(6)
    s_barrier
    s_add_u32 s29, s29, 16384
    s_mov_b32 s43, m0
    s_add_u32 m0, s40, 86016
    s_nop 0
    buffer_load_dwordx4 v25, s[96:99], s41 offen offset:2048 lds
    s_mov_b32 m0, s43
    v_mfma_f32_16x16x32_bf16 v[156:159], a[160:163], v[68:71], v[108:111]
    v_exp_f32 v164, v164
    v_mfma_f32_16x16x32_bf16 v[156:159], a[164:167], v[72:75], v[156:159]
    ds_read_b64_tr_b16 a[192:193], v5 offset:57344
    v_cvt_pk_bf16_f32 v209, v162, v163
    v_mfma_f32_16x16x32_bf16 v[156:159], a[168:171], v[76:79], v[156:159]
    v_exp_f32 v165, v165
    v_mfma_f32_16x16x32_bf16 v[156:159], a[172:175], v[80:83], v[156:159]
    ds_read_b64_tr_b16 a[194:195], v5 offset:61440
    v_mfma_f32_16x16x32_bf16 v[160:163], a[172:175], v[96:99], v[112:115]
    v_exp_f32 v166, v166
    v_mfma_f32_16x16x32_bf16 v[160:163], a[168:171], v[92:95], v[160:163]
    ds_read_b128 a[128:131], v1 offset:49152
    v_cvt_pk_bf16_f32 v186, v164, v165
    v_mfma_f32_16x16x32_bf16 v[160:163], a[164:167], v[88:91], v[160:163]
    v_exp_f32 v167, v167
    v_mfma_f32_16x16x32_bf16 v[160:163], a[160:163], v[84:87], v[160:163]
    ds_read_b64_tr_b16 a[196:197], v5 offset:0
    v_mfma_f32_16x16x32_bf16 a[96:99], a[208:211], v[212:215], a[96:99]
    v_exp_f32 v168, v168
    v_mfma_f32_16x16x32_bf16 a[96:99], a[212:215], v[216:219], a[96:99]
    ds_read_b64_tr_b16 a[198:199], v5 offset:4096
    v_cvt_pk_bf16_f32 v187, v166, v167
    v_mfma_f32_16x16x32_bf16 a[100:103], a[212:215], v[224:227], a[100:103]
    v_exp_f32 v169, v169
    v_mfma_f32_16x16x32_bf16 a[100:103], a[208:211], v[220:223], a[100:103]
    ds_read_b128 a[132:135], v2 offset:49152
    v_cvt_pk_bf16_f32 v194, v168, v169
    v_mfma_f32_16x16x32_bf16 a[104:107], a[208:211], v[228:231], a[104:107]
    s_add_u32 m0, s34, 32768
    v_exp_f32 v170, v170
    v_mfma_f32_16x16x32_bf16 a[104:107], a[212:215], v[232:235], a[104:107]
    buffer_load_dwordx4 v13, s[8:11], s28 offen offset:0 lds
    v_mfma_f32_16x16x32_bf16 a[108:111], a[212:215], v[240:243], a[108:111]
    v_exp_f32 v171, v171
    v_mfma_f32_16x16x32_bf16 a[108:111], a[208:211], v[236:239], a[108:111]
    s_waitcnt lgkmcnt(6)
    v_mfma_f32_16x16x32_bf16 v[164:167], a[176:179], v[36:39], v[100:103]
    s_waitcnt vmcnt(8)
    v_exp_f32 v172, v172
    v_mfma_f32_16x16x32_bf16 v[164:167], a[180:183], v[40:43], v[164:167]
    ds_read_b64_tr_b16 a[200:201], v6 offset:57344
    v_cvt_pk_bf16_f32 v195, v170, v171
    v_mfma_f32_16x16x32_bf16 v[164:167], a[184:187], v[44:47], v[164:167]
    v_exp_f32 v173, v173
    v_mfma_f32_16x16x32_bf16 v[164:167], a[188:191], v[48:51], v[164:167]
    ds_read_b64_tr_b16 a[202:203], v6 offset:61440
    v_cmp_eq_u32 vcc, 0, v249
    s_and_b64 vcc, vcc, exec
    s_cbranch_scc1 L_spin_sel
L_back_sel:
    v_mfma_f32_16x16x32_bf16 v[168:171], a[188:191], v[64:67], v[104:107]
    v_exp_f32 v174, v174
    v_mfma_f32_16x16x32_bf16 v[168:171], a[184:187], v[60:63], v[168:171]
    ds_read_b128 a[136:139], v3 offset:49152
    v_cvt_pk_bf16_f32 v202, v172, v173
    v_mfma_f32_16x16x32_bf16 v[168:171], a[180:183], v[56:59], v[168:171]
    v_exp_f32 v175, v175
    v_mfma_f32_16x16x32_bf16 v[168:171], a[176:179], v[52:55], v[168:171]
    ds_read_b64_tr_b16 a[204:205], v6 offset:0
    v_mfma_f32_16x16x32_bf16 a[112:115], a[216:219], v[212:215], a[112:115]
    v_exp_f32 v176, v176
    v_mfma_f32_16x16x32_bf16 a[112:115], a[220:223], v[216:219], a[112:115]
    ds_read_b64_tr_b16 a[206:207], v6 offset:4096
    v_cvt_pk_bf16_f32 v203, v174, v175
    v_mfma_f32_16x16x32_bf16 a[116:119], a[220:223], v[224:227], a[116:119]
    v_exp_f32 v177, v177
    v_mfma_f32_16x16x32_bf16 a[116:119], a[216:219], v[220:223], a[116:119]
    ds_read_b128 a[140:143], v4 offset:49152
    v_mfma_f32_16x16x32_bf16 a[120:123], a[216:219], v[228:231], a[120:123]
    v_exp_f32 v178, v178
    v_mfma_f32_16x16x32_bf16 a[120:123], a[220:223], v[232:235], a[120:123]
    v_cvt_pk_bf16_f32 v210, v176, v177
    v_mfma_f32_16x16x32_bf16 a[124:127], a[220:223], v[240:243], a[124:127]
    v_exp_f32 v179, v179
    v_mfma_f32_16x16x32_bf16 a[124:127], a[216:219], v[236:239], a[124:127]
    buffer_load_dwordx4 v14, s[8:11], s28 offen offset:1024 lds
    v_smfmac_f32_16x16x64_bf16 a[236:239], v[244:247], v[236:243], v248
    s_waitcnt lgkmcnt(6)
    v_mfma_f32_16x16x32_bf16 v[172:175], a[176:179], v[68:71], v[108:111]
    v_exp_f32 v116, v116
    v_mfma_f32_16x16x32_bf16 v[172:175], a[180:183], v[72:75], v[172:175]
    ds_read_b64_tr_b16 a[208:209], v7 offset:57344
    v_cvt_pk_bf16_f32 v211, v178, v179
    v_mfma_f32_16x16x32_bf16 v[172:175], a[184:187], v[76:79], v[172:175]
    v_exp_f32 v117, v117
    v_mfma_f32_16x16x32_bf16 v[172:175], a[188:191], v[80:83], v[172:175]
    ds_read_b64_tr_b16 a[210:211], v7 offset:61440
    v_mov_b32 v22, v249
    v_mfma_f32_16x16x32_bf16 v[176:179], a[188:191], v[96:99], v[112:115]
    v_exp_f32 v118, v118
    v_mfma_f32_16x16x32_bf16 v[176:179], a[184:187], v[92:95], v[176:179]
    ds_read_b128 a[144:147], v1 offset:53248
    v_cvt_pk_bf16_f32 v212, v116, v117
    v_mfma_f32_16x16x32_bf16 v[176:179], a[180:183], v[88:91], v[176:179]
    v_exp_f32 v119, v119
    v_mfma_f32_16x16x32_bf16 v[176:179], a[176:179], v[84:87], v[176:179]
    ds_read_b64_tr_b16 a[212:213], v7 offset:0
    v_not_b32 v22, v22
    v_mfma_f32_16x16x32_bf16 a[0:3], a[192:195], v[180:183], a[0:3]
    v_exp_f32 v120, v120
    v_mfma_f32_16x16x32_bf16 a[0:3], a[196:199], v[184:187], a[0:3]
    ds_read_b64_tr_b16 a[214:215], v7 offset:4096
    v_cvt_pk_bf16_f32 v213, v118, v119
    v_mfma_f32_16x16x32_bf16 a[4:7], a[196:199], v[192:195], a[4:7]
    v_exp_f32 v121, v121
    v_mfma_f32_16x16x32_bf16 a[4:7], a[192:195], v[188:191], a[4:7]
    ds_read_b128 a[148:151], v2 offset:53248
    v_cvt_pk_bf16_f32 v220, v120, v121
    v_mfma_f32_16x16x32_bf16 a[8:11], a[192:195], v[196:199], a[8:11]
    v_exp_f32 v122, v122
    v_and_b32 v22, 0x7ff, v22
    v_mfma_f32_16x16x32_bf16 a[8:11], a[196:199], v[200:203], a[8:11]
    buffer_load_dwordx4 v15, s[8:11], s28 offen offset:2048 lds
    v_mfma_f32_16x16x32_bf16 a[12:15], a[196:199], v[208:211], a[12:15]
    v_exp_f32 v123, v123
    v_mfma_f32_16x16x32_bf16 a[12:15], a[192:195], v[204:207], a[12:15]
    s_waitcnt lgkmcnt(6)
    v_lshrrev_b32 v24, 4, v19
    v_lshlrev_b32 v23, 4, v22
    v_mfma_f32_16x16x32_bf16 v[116:119], a[128:131], v[36:39], v[100:103]
    v_exp_f32 v124, v124
    v_mfma_f32_16x16x32_bf16 v[116:119], a[132:135], v[40:43], v[116:119]
    ds_read_b64_tr_b16 a[216:217], v8 offset:57344
    v_cvt_pk_bf16_f32 v221, v122, v123
    v_mfma_f32_16x16x32_bf16 v[116:119], a[136:139], v[44:47], v[116:119]
    v_exp_f32 v125, v125
    v_mfma_f32_16x16x32_bf16 v[116:119], a[140:143], v[48:51], v[116:119]
    ds_read_b64_tr_b16 a[218:219], v8 offset:61440
    v_mul_u32_u24 v22, 1280, v22
    v_mfma_f32_16x16x32_bf16 v[120:123], a[140:143], v[64:67], v[104:107]
    v_exp_f32 v126, v126
    v_mfma_f32_16x16x32_bf16 v[120:123], a[136:139], v[60:63], v[120:123]
    ds_read_b128 a[152:155], v3 offset:53248
    v_cvt_pk_bf16_f32 v228, v124, v125
    v_mfma_f32_16x16x32_bf16 v[120:123], a[132:135], v[56:59], v[120:123]
    v_exp_f32 v127, v127
    v_mfma_f32_16x16x32_bf16 v[120:123], a[128:131], v[52:55], v[120:123]
    ds_read_b64_tr_b16 a[220:221], v8 offset:0
    v_lshl_add_u32 v22, v24, 4, v22
    v_mfma_f32_16x16x32_bf16 a[16:19], a[200:203], v[180:183], a[16:19]
    s_mul_i32 s40, s5, 320
    v_exp_f32 v128, v128
    v_mfma_f32_16x16x32_bf16 a[16:19], a[204:207], v[184:187], a[16:19]
    s_mov_b32 s41, 0x280000
    ds_read_b64_tr_b16 a[222:223], v8 offset:4096
    v_cvt_pk_bf16_f32 v229, v126, v127
    v_mfma_f32_16x16x32_bf16 a[20:23], a[204:207], v[192:195], a[20:23]
    v_exp_f32 v129, v129
    v_mfma_f32_16x16x32_bf16 a[20:23], a[200:203], v[188:191], a[20:23]
    ds_read_b128 a[156:159], v4 offset:53248
    v_mfma_f32_16x16x32_bf16 a[24:27], a[200:203], v[196:199], a[24:27]
    v_exp_f32 v130, v130
    v_mfma_f32_16x16x32_bf16 a[24:27], a[204:207], v[200:203], a[24:27]
    v_cvt_pk_bf16_f32 v236, v128, v129
    v_mfma_f32_16x16x32_bf16 a[28:31], a[204:207], v[208:211], a[28:31]
    v_exp_f32 v131, v131
    v_mfma_f32_16x16x32_bf16 a[28:31], a[200:203], v[204:207], a[28:31]
    buffer_load_dwordx4 v16, s[8:11], s28 offen offset:3072 lds
    v_smfmac_f32_16x16x64_bf16 a[224:227], v[244:247], v[180:187], v248
    s_waitcnt lgkmcnt(6)
    buffer_load_dwordx2 v[20:21], v23, s[76:79], s41 offen sc1
    v_mfma_f32_16x16x32_bf16 v[124:127], a[128:131], v[68:71], v[108:111]
    v_exp_f32 v132, v132
    v_mfma_f32_16x16x32_bf16 v[124:127], a[132:135], v[72:75], v[124:127]
    ds_read_b64_tr_b16 a[192:193], v9 offset:57344
    v_cvt_pk_bf16_f32 v237, v130, v131
    v_mfma_f32_16x16x32_bf16 v[124:127], a[136:139], v[76:79], v[124:127]
    v_exp_f32 v133, v133
    v_mfma_f32_16x16x32_bf16 v[124:127], a[140:143], v[80:83], v[124:127]
    ds_read_b64_tr_b16 a[194:195], v9 offset:61440
    v_mfma_f32_16x16x32_bf16 v[128:131], a[140:143], v[96:99], v[112:115]
    v_exp_f32 v134, v134
    v_mfma_f32_16x16x32_bf16 v[128:131], a[136:139], v[92:95], v[128:131]
    ds_read_b128 a[160:163], v1 offset:57344
    v_cvt_pk_bf16_f32 v214, v132, v133
    v_mfma_f32_16x16x32_bf16 v[128:131], a[132:135], v[88:91], v[128:131]
    v_exp_f32 v135, v135
    v_mfma_f32_16x16x32_bf16 v[128:131], a[128:131], v[84:87], v[128:131]
    ds_read_b64_tr_b16 a[196:197], v9 offset:0
    v_mfma_f32_16x16x32_bf16 a[32:35], a[208:211], v[180:183], a[32:35]
    v_exp_f32 v136, v136
    v_mfma_f32_16x16x32_bf16 a[32:35], a[212:215], v[184:187], a[32:35]
    ds_read_b64_tr_b16 a[198:199], v9 offset:4096
    v_cvt_pk_bf16_f32 v215, v134, v135
    v_mfma_f32_16x16x32_bf16 a[36:39], a[212:215], v[192:195], a[36:39]
    v_exp_f32 v137, v137
    v_mfma_f32_16x16x32_bf16 a[36:39], a[208:211], v[188:191], a[36:39]
    ds_read_b128 a[164:167], v2 offset:57344
    v_cvt_pk_bf16_f32 v222, v136, v137
    v_mfma_f32_16x16x32_bf16 a[40:43], a[208:211], v[196:199], a[40:43]
    s_add_u32 s28, s28, 16384
    s_mov_b32 m0, s30
    v_exp_f32 v138, v138
    v_mfma_f32_16x16x32_bf16 a[40:43], a[212:215], v[200:203], a[40:43]
    buffer_load_dwordx4 v17, s[12:15], s29 offen offset:0 lds
    v_mfma_f32_16x16x32_bf16 a[44:47], a[212:215], v[208:211], a[44:47]
    s_mov_b32 exec_lo, 0x00ff00ff
    s_mov_b32 exec_hi, 0x00ff00ff
    buffer_load_dwordx4 a[240:243], v22, s[88:91], s40 offen offset:0
    s_mov_b64 exec, -1
    v_exp_f32 v139, v139
    v_mfma_f32_16x16x32_bf16 a[44:47], a[208:211], v[204:207], a[44:47]
    s_waitcnt lgkmcnt(6)
    s_mov_b32 exec_lo, 0x00ff00ff
    s_mov_b32 exec_hi, 0x00ff00ff
    buffer_load_dwordx4 a[244:247], v22, s[88:91], s40 offen offset:64
    s_mov_b64 exec, -1
    v_mfma_f32_16x16x32_bf16 v[132:135], a[144:147], v[36:39], v[100:103]
    v_exp_f32 v140, v140
    v_mfma_f32_16x16x32_bf16 v[132:135], a[148:151], v[40:43], v[132:135]
    ds_read_b64_tr_b16 a[200:201], v10 offset:57344
    v_cvt_pk_bf16_f32 v223, v138, v139
    v_mfma_f32_16x16x32_bf16 v[132:135], a[152:155], v[44:47], v[132:135]
    v_exp_f32 v141, v141
    v_mfma_f32_16x16x32_bf16 v[132:135], a[156:159], v[48:51], v[132:135]
    ds_read_b64_tr_b16 a[202:203], v10 offset:61440
    v_mfma_f32_16x16x32_bf16 v[136:139], a[156:159], v[64:67], v[104:107]
    v_exp_f32 v142, v142
    v_mfma_f32_16x16x32_bf16 v[136:139], a[152:155], v[60:63], v[136:139]
    ds_read_b128 a[168:171], v3 offset:57344
    v_cvt_pk_bf16_f32 v230, v140, v141
    v_mfma_f32_16x16x32_bf16 v[136:139], a[148:151], v[56:59], v[136:139]
    v_exp_f32 v143, v143
    v_mfma_f32_16x16x32_bf16 v[136:139], a[144:147], v[52:55], v[136:139]
    ds_read_b64_tr_b16 a[204:205], v10 offset:0
    s_mov_b32 exec_lo, 0x00ff00ff
    s_mov_b32 exec_hi, 0x00ff00ff
    buffer_load_dwordx4 a[248:251], v22, s[88:91], s40 offen offset:128
    s_mov_b64 exec, -1
    v_mfma_f32_16x16x32_bf16 a[48:51], a[216:219], v[180:183], a[48:51]
    v_exp_f32 v144, v144
    v_mfma_f32_16x16x32_bf16 a[48:51], a[220:223], v[184:187], a[48:51]
    ds_read_b64_tr_b16 a[206:207], v10 offset:4096
    v_cvt_pk_bf16_f32 v231, v142, v143
    v_mfma_f32_16x16x32_bf16 a[52:55], a[220:223], v[192:195], a[52:55]
    v_exp_f32 v145, v145
    v_mfma_f32_16x16x32_bf16 a[52:55], a[216:219], v[188:191], a[52:55]
    ds_read_b128 a[172:175], v4 offset:57344
    v_mfma_f32_16x16x32_bf16 a[56:59], a[216:219], v[196:199], a[56:59]
    s_mov_b32 exec_lo, 0x00ff00ff
    s_mov_b32 exec_hi, 0x00ff00ff
    buffer_load_dwordx4 a[252:255], v22, s[88:91], s40 offen offset:192
    s_mov_b64 exec, -1
    v_exp_f32 v146, v146
    v_mfma_f32_16x16x32_bf16 a[56:59], a[220:223], v[200:203], a[56:59]
    v_cvt_pk_bf16_f32 v238, v144, v145
    v_mfma_f32_16x16x32_bf16 a[60:63], a[220:223], v[208:211], a[60:63]
    v_exp_f32 v147, v147
    v_mfma_f32_16x16x32_bf16 a[60:63], a[216:219], v[204:207], a[60:63]
    buffer_load_dwordx4 v18, s[12:15], s29 offen offset:1024 lds
    v_smfmac_f32_16x16x64_bf16 a[228:231], v[244:247], v[188:195], v248
    s_waitcnt lgkmcnt(6)
    s_mov_b32 exec_lo, 0x00ff00ff
    s_mov_b32 exec_hi, 0x00ff00ff
    buffer_load_dwordx4 v[252:255], v22, s[88:91], s40 offen offset:256
    s_mov_b64 exec, -1
    v_mfma_f32_16x16x32_bf16 v[140:143], a[144:147], v[68:71], v[108:111]
    v_exp_f32 v148, v148
    v_mfma_f32_16x16x32_bf16 v[140:143], a[148:151], v[72:75], v[140:143]
    ds_read_b64_tr_b16 a[208:209], v11 offset:57344
    v_cvt_pk_bf16_f32 v239, v146, v147
    v_mfma_f32_16x16x32_bf16 v[140:143], a[152:155], v[76:79], v[140:143]
    v_exp_f32 v149, v149
    v_lshrrev_b32 v22, 4, v19
    v_mfma_f32_16x16x32_bf16 v[140:143], a[156:159], v[80:83], v[140:143]
    ds_read_b64_tr_b16 a[210:211], v11 offset:61440
    v_bfe_u32 v24, v19, 2, 2
    v_mfma_f32_16x16x32_bf16 v[144:147], a[156:159], v[96:99], v[112:115]
    v_exp_f32 v150, v150
    v_mfma_f32_16x16x32_bf16 v[144:147], a[152:155], v[92:95], v[144:147]
    ds_read_b128 a[176:179], v1 offset:61440
    v_cvt_pk_bf16_f32 v216, v148, v149
    v_mfma_f32_16x16x32_bf16 v[144:147], a[148:151], v[88:91], v[144:147]
    v_exp_f32 v151, v151
    v_lshl_add_u32 v22, v22, 3, v24
    v_mfma_f32_16x16x32_bf16 v[144:147], a[144:147], v[84:87], v[144:147]
    ds_read_b64_tr_b16 a[212:213], v11 offset:0
    v_and_b32 v24, 1, v19
    v_mfma_f32_16x16x32_bf16 a[64:67], a[192:195], v[180:183], a[64:67]
    v_exp_f32 v152, v152
    v_mfma_f32_16x16x32_bf16 a[64:67], a[196:199], v[184:187], a[64:67]
    ds_read_b64_tr_b16 a[214:215], v11 offset:4096
    v_cvt_pk_bf16_f32 v217, v150, v151
    v_mfma_f32_16x16x32_bf16 a[68:71], a[196:199], v[192:195], a[68:71]
    v_exp_f32 v153, v153
    v_mfma_f32_16x16x32_bf16 a[68:71], a[192:195], v[188:191], a[68:71]
    ds_read_b128 a[180:183], v2 offset:61440
    v_cvt_pk_bf16_f32 v224, v152, v153
    v_lshl_add_u32 v22, v22, 1, v24
    v_mfma_f32_16x16x32_bf16 a[72:75], a[192:195], v[196:199], a[72:75]
    v_exp_f32 v154, v154
    v_mfma_f32_16x16x32_bf16 a[72:75], a[196:199], v[200:203], a[72:75]
    buffer_load_dwordx4 v17, s[12:15], s29 offen offset:2048 lds
    v_bfe_u32 v24, v19, 1, 1
    v_mfma_f32_16x16x32_bf16 a[76:79], a[196:199], v[208:211], a[76:79]
    v_exp_f32 v155, v155
    v_mfma_f32_16x16x32_bf16 a[76:79], a[192:195], v[204:207], a[76:79]
    s_waitcnt lgkmcnt(6)
    v_mul_u32_u24 v24, 10240, v24
    v_lshl_add_u32 v22, v22, 3, v24
    v_mfma_f32_16x16x32_bf16 v[148:151], a[160:163], v[36:39], v[100:103]
    s_mul_i32 s42, s5, 2560
    v_exp_f32 v156, v156
    v_mfma_f32_16x16x32_bf16 v[148:151], a[164:167], v[40:43], v[148:151]
    s_add_u32 s42, s42, 65536
    ds_read_b64_tr_b16 a[216:217], v12 offset:57344
    v_cvt_pk_bf16_f32 v225, v154, v155
    v_mfma_f32_16x16x32_bf16 v[148:151], a[168:171], v[44:47], v[148:151]
    v_exp_f32 v157, v157
    v_mfma_f32_16x16x32_bf16 v[148:151], a[172:175], v[48:51], v[148:151]
    ds_read_b64_tr_b16 a[218:219], v12 offset:61440
    v_add_u32 v22, s42, v22
    v_mfma_f32_16x16x32_bf16 v[152:155], a[172:175], v[64:67], v[104:107]
    s_mov_b32 s42, 65536
    v_exp_f32 v158, v158
    v_mfma_f32_16x16x32_bf16 v[152:155], a[168:171], v[60:63], v[152:155]
    ds_read_b128 a[184:187], v3 offset:61440
    v_cvt_pk_bf16_f32 v232, v156, v157
    v_mfma_f32_16x16x32_bf16 v[152:155], a[164:167], v[56:59], v[152:155]
    v_exp_f32 v159, v159
    v_mfma_f32_16x16x32_bf16 v[152:155], a[160:163], v[52:55], v[152:155]
    ds_read_b64_tr_b16 a[220:221], v12 offset:0
    v_lshl_add_u32 v23, v19, 4, s42
    v_mfma_f32_16x16x32_bf16 a[80:83], a[200:203], v[180:183], a[80:83]
    v_exp_f32 v160, v160
    v_mfma_f32_16x16x32_bf16 a[80:83], a[204:207], v[184:187], a[80:83]
    ds_read_b64_tr_b16 a[222:223], v12 offset:4096
    v_cvt_pk_bf16_f32 v233, v158, v159
    v_mfma_f32_16x16x32_bf16 a[84:87], a[204:207], v[192:195], a[84:87]
    v_exp_f32 v161, v161
    v_mfma_f32_16x16x32_bf16 a[84:87], a[200:203], v[188:191], a[84:87]
    ds_read_b128 a[188:191], v4 offset:61440
    v_readlane_b32 s50, v249, 0
    v_mfma_f32_16x16x32_bf16 a[88:91], a[200:203], v[196:199], a[88:91]
    v_exp_f32 v162, v162
    v_mfma_f32_16x16x32_bf16 a[88:91], a[204:207], v[200:203], a[88:91]
    v_cvt_pk_bf16_f32 v240, v160, v161
    v_readlane_b32 s51, v249, 1
    v_mfma_f32_16x16x32_bf16 a[92:95], a[204:207], v[208:211], a[92:95]
    v_exp_f32 v163, v163
    v_mfma_f32_16x16x32_bf16 a[92:95], a[200:203], v[204:207], a[92:95]
    buffer_load_dwordx4 v18, s[12:15], s29 offen offset:3072 lds
    v_smfmac_f32_16x16x64_bf16 a[232:235], v[244:247], v[196:203], v248
    s_waitcnt vmcnt(15) lgkmcnt(6)
    s_barrier
    s_add_u32 s29, s29, 16384
    v_readlane_b32 s52, v249, 2
    v_mfma_f32_16x16x32_bf16 v[156:159], a[160:163], v[68:71], v[108:111]
    v_exp_f32 v164, v164
    v_mfma_f32_16x16x32_bf16 v[156:159], a[164:167], v[72:75], v[156:159]
    ds_read_b64_tr_b16 a[192:193], v5 offset:24576
    v_cvt_pk_bf16_f32 v241, v162, v163
    v_mfma_f32_16x16x32_bf16 v[156:159], a[168:171], v[76:79], v[156:159]
    v_exp_f32 v165, v165
    v_mfma_f32_16x16x32_bf16 v[156:159], a[172:175], v[80:83], v[156:159]
    ds_read_b64_tr_b16 a[194:195], v5 offset:28672
    v_readlane_b32 s53, v249, 3
    v_mfma_f32_16x16x32_bf16 v[160:163], a[172:175], v[96:99], v[112:115]
    v_exp_f32 v166, v166
    v_mfma_f32_16x16x32_bf16 v[160:163], a[168:171], v[92:95], v[160:163]
    ds_read_b128 a[128:131], v1 offset:16384
    v_cvt_pk_bf16_f32 v218, v164, v165
    v_mfma_f32_16x16x32_bf16 v[160:163], a[164:167], v[88:91], v[160:163]
    v_exp_f32 v167, v167
    v_mfma_f32_16x16x32_bf16 v[160:163], a[160:163], v[84:87], v[160:163]
    ds_read_b64_tr_b16 a[196:197], v5 offset:49152
    v_readlane_b32 s54, v249, 4
    v_mfma_f32_16x16x32_bf16 a[96:99], a[208:211], v[180:183], a[96:99]
    v_exp_f32 v168, v168
    v_mfma_f32_16x16x32_bf16 a[96:99], a[212:215], v[184:187], a[96:99]
    ds_read_b64_tr_b16 a[198:199], v5 offset:53248
    v_cvt_pk_bf16_f32 v219, v166, v167
    v_mfma_f32_16x16x32_bf16 a[100:103], a[212:215], v[192:195], a[100:103]
    v_exp_f32 v169, v169
    v_mfma_f32_16x16x32_bf16 a[100:103], a[208:211], v[188:191], a[100:103]
    ds_read_b128 a[132:135], v2 offset:16384
    v_cvt_pk_bf16_f32 v226, v168, v169
    v_readlane_b32 s55, v249, 5
    v_mfma_f32_16x16x32_bf16 a[104:107], a[208:211], v[196:199], a[104:107]
    s_add_u32 m0, s34, 0
    v_exp_f32 v170, v170
    v_mfma_f32_16x16x32_bf16 a[104:107], a[212:215], v[200:203], a[104:107]
    buffer_load_dwordx4 v13, s[8:11], s28 offen offset:0 lds
    v_readlane_b32 s56, v249, 6
    v_mfma_f32_16x16x32_bf16 a[108:111], a[212:215], v[208:211], a[108:111]
    v_exp_f32 v171, v171
    v_mfma_f32_16x16x32_bf16 a[108:111], a[208:211], v[204:207], a[108:111]
    s_waitcnt lgkmcnt(6)
    v_readlane_b32 s57, v249, 7
    v_mfma_f32_16x16x32_bf16 v[164:167], a[176:179], v[36:39], v[100:103]
    v_exp_f32 v172, v172
    v_mfma_f32_16x16x32_bf16 v[164:167], a[180:183], v[40:43], v[164:167]
    ds_read_b64_tr_b16 a[200:201], v6 offset:24576
    v_cvt_pk_bf16_f32 v227, v170, v171
    v_mfma_f32_16x16x32_bf16 v[164:167], a[184:187], v[44:47], v[164:167]
    v_exp_f32 v173, v173
    v_mfma_f32_16x16x32_bf16 v[164:167], a[188:191], v[48:51], v[164:167]
    ds_read_b64_tr_b16 a[202:203], v6 offset:28672
    v_mfma_f32_16x16x32_bf16 v[168:171], a[188:191], v[64:67], v[104:107]
    v_exp_f32 v174, v174
    v_mfma_f32_16x16x32_bf16 v[168:171], a[184:187], v[60:63], v[168:171]
    ds_read_b128 a[136:139], v3 offset:16384
    v_cvt_pk_bf16_f32 v234, v172, v173
    v_mfma_f32_16x16x32_bf16 v[168:171], a[180:183], v[56:59], v[168:171]
    v_exp_f32 v175, v175
    v_mfma_f32_16x16x32_bf16 v[168:171], a[176:179], v[52:55], v[168:171]
    ds_read_b64_tr_b16 a[204:205], v6 offset:49152
    ds_read_b64_tr_b16 v[24:25], v22 offset:0
    v_mfma_f32_16x16x32_bf16 a[112:115], a[216:219], v[180:183], a[112:115]
    v_exp_f32 v176, v176
    v_mfma_f32_16x16x32_bf16 a[112:115], a[220:223], v[184:187], a[112:115]
    ds_read_b64_tr_b16 a[206:207], v6 offset:53248
    v_cvt_pk_bf16_f32 v235, v174, v175
    v_mfma_f32_16x16x32_bf16 a[116:119], a[220:223], v[192:195], a[116:119]
    v_exp_f32 v177, v177
    v_mfma_f32_16x16x32_bf16 a[116:119], a[216:219], v[188:191], a[116:119]
    ds_read_b128 a[140:143], v4 offset:16384
    ds_read_b64_tr_b16 v[26:27], v22 offset:64
    v_mfma_f32_16x16x32_bf16 a[120:123], a[216:219], v[196:199], a[120:123]
    v_exp_f32 v178, v178
    v_mfma_f32_16x16x32_bf16 a[120:123], a[220:223], v[200:203], a[120:123]
    ds_read_b64_tr_b16 v[28:29], v22 offset:512
    v_cvt_pk_bf16_f32 v242, v176, v177
    v_mfma_f32_16x16x32_bf16 a[124:127], a[220:223], v[208:211], a[124:127]
    v_exp_f32 v179, v179
    v_mfma_f32_16x16x32_bf16 a[124:127], a[216:219], v[204:207], a[124:127]
    buffer_load_dwordx4 v14, s[8:11], s28 offen offset:1024 lds
    v_smfmac_f32_16x16x64_bf16 a[236:239], v[244:247], v[204:211], v248
    s_waitcnt lgkmcnt(6)
    ds_read_b64_tr_b16 v[30:31], v22 offset:576
    v_mfma_f32_16x16x32_bf16 v[172:175], a[176:179], v[68:71], v[108:111]
    v_exp_f32 v116, v116
    v_mfma_f32_16x16x32_bf16 v[172:175], a[180:183], v[72:75], v[172:175]
    ds_read_b64_tr_b16 a[208:209], v7 offset:24576
    v_cvt_pk_bf16_f32 v243, v178, v179
    v_mfma_f32_16x16x32_bf16 v[172:175], a[184:187], v[76:79], v[172:175]
    v_exp_f32 v117, v117
    v_mfma_f32_16x16x32_bf16 v[172:175], a[188:191], v[80:83], v[172:175]
    ds_read_b64_tr_b16 a[210:211], v7 offset:28672
    v_mfma_f32_16x16x32_bf16 v[176:179], a[188:191], v[96:99], v[112:115]
    v_exp_f32 v118, v118
    v_mfma_f32_16x16x32_bf16 v[176:179], a[184:187], v[92:95], v[176:179]
    ds_read_b128 a[144:147], v1 offset:20480
    v_cvt_pk_bf16_f32 v180, v116, v117
    v_mfma_f32_16x16x32_bf16 v[176:179], a[180:183], v[88:91], v[176:179]
    v_exp_f32 v119, v119
    v_mfma_f32_16x16x32_bf16 v[176:179], a[176:179], v[84:87], v[176:179]
    ds_read_b64_tr_b16 a[212:213], v7 offset:49152
    v_mfma_f32_16x16x32_bf16 a[0:3], a[192:195], v[212:215], a[0:3]
    v_exp_f32 v120, v120
    v_mfma_f32_16x16x32_bf16 a[0:3], a[196:199], v[216:219], a[0:3]
    ds_read_b64_tr_b16 a[214:215], v7 offset:53248
    v_cvt_pk_bf16_f32 v181, v118, v119
    v_mfma_f32_16x16x32_bf16 a[4:7], a[196:199], v[224:227], a[4:7]
    v_exp_f32 v121, v121
    v_mfma_f32_16x16x32_bf16 a[4:7], a[192:195], v[220:223], a[4:7]
    ds_read_b128 a[148:151], v2 offset:20480
    v_cvt_pk_bf16_f32 v188, v120, v121
    v_mfma_f32_16x16x32_bf16 a[8:11], a[192:195], v[228:231], a[8:11]
    v_exp_f32 v122, v122
    v_mfma_f32_16x16x32_bf16 a[8:11], a[196:199], v[232:235], a[8:11]
    buffer_load_dwordx4 v15, s[8:11], s28 offen offset:2048 lds
    v_mfma_f32_16x16x32_bf16 a[12:15], a[196:199], v[240:243], a[12:15]
    v_exp_f32 v123, v123
    v_mfma_f32_16x16x32_bf16 a[12:15], a[192:195], v[236:239], a[12:15]
    s_waitcnt lgkmcnt(6)
    v_mfma_f32_16x16x32_bf16 v[116:119], a[128:131], v[36:39], v[100:103]
    s_waitcnt vmcnt(5)
    v_exp_f32 v124, v124
    v_mfma_f32_16x16x32_bf16 v[32:35], v[24:27], a[240:243], 0
    v_mfma_f32_16x16x32_bf16 v[32:35], v[28:31], a[244:247], v[32:35]
    ds_read_b64_tr_b16 v[24:25], v22 offset:1024
    v_mfma_f32_16x16x32_bf16 v[116:119], a[132:135], v[40:43], v[116:119]
    ds_read_b64_tr_b16 a[216:217], v8 offset:24576
    v_cvt_pk_bf16_f32 v189, v122, v123
    v_mfma_f32_16x16x32_bf16 v[116:119], a[136:139], v[44:47], v[116:119]
    v_exp_f32 v125, v125
    v_mfma_f32_16x16x32_bf16 v[116:119], a[140:143], v[48:51], v[116:119]
    ds_read_b64_tr_b16 a[218:219], v8 offset:28672
    v_mfma_f32_16x16x32_bf16 v[120:123], a[140:143], v[64:67], v[104:107]
    v_exp_f32 v126, v126
    v_mfma_f32_16x16x32_bf16 v[120:123], a[136:139], v[60:63], v[120:123]
    ds_read_b128 a[152:155], v3 offset:20480
    v_cvt_pk_bf16_f32 v196, v124, v125
    v_mfma_f32_16x16x32_bf16 v[120:123], a[132:135], v[56:59], v[120:123]
    v_exp_f32 v127, v127
    v_mfma_f32_16x16x32_bf16 v[120:123], a[128:131], v[52:55], v[120:123]
    ds_read_b64_tr_b16 a[220:221], v8 offset:49152
    v_mfma_f32_16x16x32_bf16 a[16:19], a[200:203], v[212:215], a[16:19]
    v_exp_f32 v128, v128
    v_mfma_f32_16x16x32_bf16 a[16:19], a[204:207], v[216:219], a[16:19]
    ds_read_b64_tr_b16 a[222:223], v8 offset:53248
    v_cvt_pk_bf16_f32 v197, v126, v127
    v_mfma_f32_16x16x32_bf16 a[20:23], a[204:207], v[224:227], a[20:23]
    v_exp_f32 v129, v129
    v_mfma_f32_16x16x32_bf16 a[20:23], a[200:203], v[220:223], a[20:23]
    ds_read_b128 a[156:159], v4 offset:20480
    v_mfma_f32_16x16x32_bf16 a[24:27], a[200:203], v[228:231], a[24:27]
    v_exp_f32 v130, v130
    v_mfma_f32_16x16x32_bf16 a[24:27], a[204:207], v[232:235], a[24:27]
    ds_read_b64_tr_b16 v[26:27], v22 offset:1088
    v_cvt_pk_bf16_f32 v204, v128, v129
    v_mfma_f32_16x16x32_bf16 a[28:31], a[204:207], v[240:243], a[28:31]
    v_exp_f32 v131, v131
    v_mfma_f32_16x16x32_bf16 a[28:31], a[200:203], v[236:239], a[28:31]
    buffer_load_dwordx4 v16, s[8:11], s28 offen offset:3072 lds
    v_smfmac_f32_16x16x64_bf16 a[224:227], v[244:247], v[212:219], v248
    s_waitcnt lgkmcnt(6)
    ds_read_b64_tr_b16 v[28:29], v22 offset:1536
    ds_read_b64_tr_b16 v[30:31], v22 offset:1600
    v_mfma_f32_16x16x32_bf16 v[124:127], a[128:131], v[68:71], v[108:111]
    s_mul_i32 s40, s5, 2560
    v_exp_f32 v132, v132
    v_mfma_f32_16x16x32_bf16 v[124:127], a[132:135], v[72:75], v[124:127]
    ds_read_b64_tr_b16 a[192:193], v9 offset:24576
    v_cvt_pk_bf16_f32 v205, v130, v131
    v_mfma_f32_16x16x32_bf16 v[124:127], a[136:139], v[76:79], v[124:127]
    v_exp_f32 v133, v133
    v_add_u32 v0, s40, v23
    v_mfma_f32_16x16x32_bf16 v[124:127], a[140:143], v[80:83], v[124:127]
    ds_read_b64_tr_b16 a[194:195], v9 offset:28672
    v_mfma_f32_16x16x32_bf16 v[128:131], a[140:143], v[96:99], v[112:115]
    v_exp_f32 v134, v134
    v_mfma_f32_16x16x32_bf16 v[128:131], a[136:139], v[92:95], v[128:131]
    ds_read_b128 a[160:163], v1 offset:24576
    v_cvt_pk_bf16_f32 v182, v132, v133
    v_mfma_f32_16x16x32_bf16 v[128:131], a[132:135], v[88:91], v[128:131]
    v_exp_f32 v135, v135
    v_mfma_f32_16x16x32_bf16 v[128:131], a[128:131], v[84:87], v[128:131]
    ds_read_b64_tr_b16 a[196:197], v9 offset:49152
    v_mfma_f32_16x16x32_bf16 a[32:35], a[208:211], v[212:215], a[32:35]
    v_exp_f32 v136, v136
    v_mfma_f32_16x16x32_bf16 a[32:35], a[212:215], v[216:219], a[32:35]
    s_waitcnt lgkmcnt(4)
    ds_read_b64_tr_b16 a[198:199], v9 offset:53248
    v_cvt_pk_bf16_f32 v183, v134, v135
    v_mfma_f32_16x16x32_bf16 v[32:35], v[24:27], a[248:251], v[32:35]
    v_mfma_f32_16x16x32_bf16 v[32:35], v[28:31], a[252:255], v[32:35]
    ds_read_b64_tr_b16 v[24:25], v22 offset:2048
    v_mfma_f32_16x16x32_bf16 a[36:39], a[212:215], v[224:227], a[36:39]
    v_exp_f32 v137, v137
    v_mfma_f32_16x16x32_bf16 a[36:39], a[208:211], v[220:223], a[36:39]
    ds_read_b128 a[164:167], v2 offset:24576
    v_cvt_pk_bf16_f32 v190, v136, v137
    v_mfma_f32_16x16x32_bf16 a[40:43], a[208:211], v[228:231], a[40:43]
    s_add_u32 s28, s28, 16384
    s_mov_b32 m0, s31
    v_exp_f32 v138, v138
    v_mfma_f32_16x16x32_bf16 a[40:43], a[212:215], v[232:235], a[40:43]
    buffer_load_dwordx4 v17, s[12:15], s29 offen offset:0 lds
    v_mfma_f32_16x16x32_bf16 a[44:47], a[212:215], v[240:243], a[44:47]
    v_exp_f32 v139, v139
    v_mfma_f32_16x16x32_bf16 a[44:47], a[208:211], v[236:239], a[44:47]
    s_waitcnt lgkmcnt(6)
    ds_read_b64_tr_b16 v[26:27], v22 offset:2112
    v_mfma_f32_16x16x32_bf16 v[132:135], a[144:147], v[36:39], v[100:103]
    v_exp_f32 v140, v140
    v_mfma_f32_16x16x32_bf16 v[132:135], a[148:151], v[40:43], v[132:135]
    ds_read_b64_tr_b16 a[200:201], v10 offset:24576
    v_cvt_pk_bf16_f32 v191, v138, v139
    v_mfma_f32_16x16x32_bf16 v[132:135], a[152:155], v[44:47], v[132:135]
    v_exp_f32 v141, v141
    v_mfma_f32_16x16x32_bf16 v[132:135], a[156:159], v[48:51], v[132:135]
    ds_read_b64_tr_b16 a[202:203], v10 offset:28672
    v_mfma_f32_16x16x32_bf16 v[136:139], a[156:159], v[64:67], v[104:107]
    v_exp_f32 v142, v142
    v_mfma_f32_16x16x32_bf16 v[136:139], a[152:155], v[60:63], v[136:139]
    ds_read_b128 a[168:171], v3 offset:24576
    v_cvt_pk_bf16_f32 v198, v140, v141
    v_mfma_f32_16x16x32_bf16 v[136:139], a[148:151], v[56:59], v[136:139]
    v_exp_f32 v143, v143
    v_mfma_f32_16x16x32_bf16 v[136:139], a[144:147], v[52:55], v[136:139]
    ds_read_b64_tr_b16 a[204:205], v10 offset:49152
    v_mfma_f32_16x16x32_bf16 a[48:51], a[216:219], v[212:215], a[48:51]
    s_waitcnt lgkmcnt(4)
    v_exp_f32 v144, v144
    v_mfma_f32_16x16x32_bf16 v[32:35], v[24:27], v[252:255], v[32:35]
    v_mfma_f32_16x16x32_bf16 a[48:51], a[220:223], v[216:219], a[48:51]
    ds_read_b64_tr_b16 a[206:207], v10 offset:53248
    v_cvt_pk_bf16_f32 v199, v142, v143
    v_mfma_f32_16x16x32_bf16 a[52:55], a[220:223], v[224:227], a[52:55]
    v_exp_f32 v145, v145
    v_mfma_f32_16x16x32_bf16 a[52:55], a[216:219], v[220:223], a[52:55]
    ds_read_b128 a[172:175], v4 offset:24576
    v_mfma_f32_16x16x32_bf16 a[56:59], a[216:219], v[228:231], a[56:59]
    v_exp_f32 v146, v146
    v_mfma_f32_16x16x32_bf16 a[56:59], a[220:223], v[232:235], a[56:59]
    v_cvt_pk_bf16_f32 v206, v144, v145
    v_mfma_f32_16x16x32_bf16 a[60:63], a[220:223], v[240:243], a[60:63]
    v_exp_f32 v147, v147
    v_mfma_f32_16x16x32_bf16 a[60:63], a[216:219], v[236:239], a[60:63]
    buffer_load_dwordx4 v18, s[12:15], s29 offen offset:1024 lds
    v_smfmac_f32_16x16x64_bf16 a[228:231], v[244:247], v[220:227], v248
    s_waitcnt lgkmcnt(6)
    v_mfma_f32_16x16x32_bf16 v[140:143], a[144:147], v[68:71], v[108:111]
    v_exp_f32 v148, v148
    v_mfma_f32_16x16x32_bf16 v[140:143], a[148:151], v[72:75], v[140:143]
    ds_read_b64_tr_b16 a[208:209], v11 offset:24576
    v_cvt_pk_bf16_f32 v207, v146, v147
    v_mfma_f32_16x16x32_bf16 v[140:143], a[152:155], v[76:79], v[140:143]
    v_exp_f32 v149, v149
    v_mfma_f32_16x16x32_bf16 v[140:143], a[156:159], v[80:83], v[140:143]
    ds_read_b64_tr_b16 a[210:211], v11 offset:28672
    v_mfma_f32_16x16x32_bf16 v[144:147], a[156:159], v[96:99], v[112:115]
    v_exp_f32 v150, v150
    v_mfma_f32_16x16x32_bf16 v[144:147], a[152:155], v[92:95], v[144:147]
    ds_read_b128 a[176:179], v1 offset:28672
    v_cvt_pk_bf16_f32 v184, v148, v149
    v_mfma_f32_16x16x32_bf16 v[144:147], a[148:151], v[88:91], v[144:147]
    v_exp_f32 v151, v151
    v_mfma_f32_16x16x32_bf16 v[144:147], a[144:147], v[84:87], v[144:147]
    ds_read_b64_tr_b16 a[212:213], v11 offset:49152
    ds_write_b128 v0, v[32:35]
    v_bfe_u32 v22, v19, 2, 3
    v_mfma_f32_16x16x32_bf16 a[64:67], a[192:195], v[212:215], a[64:67]
    v_exp_f32 v152, v152
    v_mul_u32_u24 v22, 160, v22
    v_mfma_f32_16x16x32_bf16 a[64:67], a[196:199], v[216:219], a[64:67]
    ds_read_b64_tr_b16 a[214:215], v11 offset:53248
    v_cvt_pk_bf16_f32 v185, v150, v151
    v_mfma_f32_16x16x32_bf16 a[68:71], a[196:199], v[224:227], a[68:71]
    v_exp_f32 v153, v153
    v_and_b32 v28, 3, v19
    v_mfma_f32_16x16x32_bf16 a[68:71], a[192:195], v[220:223], a[68:71]
    ds_read_b128 a[180:183], v2 offset:28672
    v_cvt_pk_bf16_f32 v192, v152, v153
    v_add_u32 v22, v22, v28
    v_mfma_f32_16x16x32_bf16 a[72:75], a[192:195], v[228:231], a[72:75]
    s_mul_i32 s42, s5, 320
    v_exp_f32 v154, v154
    v_mfma_f32_16x16x32_bf16 a[72:75], a[196:199], v[232:235], a[72:75]
    s_add_u32 s42, s42, 86016
    buffer_load_dwordx4 v17, s[12:15], s29 offen offset:2048 lds
    v_mfma_f32_16x16x32_bf16 a[76:79], a[196:199], v[240:243], a[76:79]
    v_exp_f32 v155, v155
    v_mfma_f32_16x16x32_bf16 a[76:79], a[192:195], v[236:239], a[76:79]
    s_waitcnt lgkmcnt(6)
    v_lshl_add_u32 v22, v22, 3, s42
    v_mfma_f32_16x16x32_bf16 v[148:151], a[160:163], v[36:39], v[100:103]
    v_exp_f32 v156, v156
    v_mfma_f32_16x16x32_bf16 v[148:151], a[164:167], v[40:43], v[148:151]
    ds_read_b64_tr_b16 a[216:217], v12 offset:24576
    v_cvt_pk_bf16_f32 v193, v154, v155
    v_mfma_f32_16x16x32_bf16 v[148:151], a[168:171], v[44:47], v[148:151]
    v_exp_f32 v157, v157
    v_mfma_f32_16x16x32_bf16 v[148:151], a[172:175], v[48:51], v[148:151]
    ds_read_b64_tr_b16 a[218:219], v12 offset:28672
    v_mfma_f32_16x16x32_bf16 v[152:155], a[172:175], v[64:67], v[104:107]
    v_exp_f32 v158, v158
    v_mfma_f32_16x16x32_bf16 v[152:155], a[168:171], v[60:63], v[152:155]
    ds_read_b128 a[184:187], v3 offset:28672
    v_cvt_pk_bf16_f32 v200, v156, v157
    v_mfma_f32_16x16x32_bf16 v[152:155], a[164:167], v[56:59], v[152:155]
    v_exp_f32 v159, v159
    v_mfma_f32_16x16x32_bf16 v[152:155], a[160:163], v[52:55], v[152:155]
    ds_read_b64_tr_b16 a[220:221], v12 offset:49152
    v_mfma_f32_16x16x32_bf16 a[80:83], a[200:203], v[212:215], a[80:83]
    v_exp_f32 v160, v160
    v_mfma_f32_16x16x32_bf16 a[80:83], a[204:207], v[216:219], a[80:83]
    ds_read_b64_tr_b16 a[222:223], v12 offset:53248
    v_cvt_pk_bf16_f32 v201, v158, v159
    v_mfma_f32_16x16x32_bf16 a[84:87], a[204:207], v[224:227], a[84:87]
    v_exp_f32 v161, v161
    v_mfma_f32_16x16x32_bf16 a[84:87], a[200:203], v[220:223], a[84:87]
    ds_read_b128 a[188:191], v4 offset:28672
    v_mfma_f32_16x16x32_bf16 a[88:91], a[200:203], v[228:231], a[88:91]
    v_exp_f32 v162, v162
    v_mfma_f32_16x16x32_bf16 a[88:91], a[204:207], v[232:235], a[88:91]
    v_cvt_pk_bf16_f32 v208, v160, v161
    v_mfma_f32_16x16x32_bf16 a[92:95], a[204:207], v[240:243], a[92:95]
    v_exp_f32 v163, v163
    v_mfma_f32_16x16x32_bf16 a[92:95], a[200:203], v[236:239], a[92:95]
    buffer_load_dwordx4 v18, s[12:15], s29 offen offset:3072 lds
    v_smfmac_f32_16x16x64_bf16 a[232:235], v[244:247], v[228:235], v248
    s_waitcnt vmcnt(8) lgkmcnt(6)
    s_barrier
    s_add_u32 s29, s29, 16384
    v_mfma_f32_16x16x32_bf16 v[156:159], a[160:163], v[68:71], v[108:111]
    v_exp_f32 v164, v164
    v_mfma_f32_16x16x32_bf16 v[156:159], a[164:167], v[72:75], v[156:159]
    ds_read_b64_tr_b16 a[192:193], v5 offset:8192
    v_cvt_pk_bf16_f32 v209, v162, v163
    v_mfma_f32_16x16x32_bf16 v[156:159], a[168:171], v[76:79], v[156:159]
    v_exp_f32 v165, v165
    v_mfma_f32_16x16x32_bf16 v[156:159], a[172:175], v[80:83], v[156:159]
    ds_read_b64_tr_b16 a[194:195], v5 offset:12288
    ds_read_b128 v[24:27], v23 offset:0
    v_mfma_f32_16x16x32_bf16 v[160:163], a[172:175], v[96:99], v[112:115]
    v_exp_f32 v166, v166
    v_mfma_f32_16x16x32_bf16 v[160:163], a[168:171], v[92:95], v[160:163]
    ds_read_b128 a[128:131], v1 offset:32768
    v_cvt_pk_bf16_f32 v186, v164, v165
    v_mfma_f32_16x16x32_bf16 v[160:163], a[164:167], v[88:91], v[160:163]
    v_exp_f32 v167, v167
    v_mfma_f32_16x16x32_bf16 v[160:163], a[160:163], v[84:87], v[160:163]
    ds_read_b64_tr_b16 a[196:197], v5 offset:32768
    ds_read_b128 v[28:31], v23 offset:2560
    v_mfma_f32_16x16x32_bf16 a[96:99], a[208:211], v[212:215], a[96:99]
    v_exp_f32 v168, v168
    v_mfma_f32_16x16x32_bf16 a[96:99], a[212:215], v[216:219], a[96:99]
    ds_read_b64_tr_b16 a[198:199], v5 offset:36864
    v_cvt_pk_bf16_f32 v187, v166, v167
    v_mfma_f32_16x16x32_bf16 a[100:103], a[212:215], v[224:227], a[100:103]
    v_exp_f32 v169, v169
    v_mfma_f32_16x16x32_bf16 a[100:103], a[208:211], v[220:223], a[100:103]
    ds_read_b128 a[132:135], v2 offset:32768
    v_cvt_pk_bf16_f32 v194, v168, v169
    v_mfma_f32_16x16x32_bf16 a[104:107], a[208:211], v[228:231], a[104:107]
    s_add_u32 m0, s34, 49152
    v_exp_f32 v170, v170
    v_mfma_f32_16x16x32_bf16 a[104:107], a[212:215], v[232:235], a[104:107]
    buffer_load_dwordx4 v13, s[8:11], s28 offen offset:0 lds
    v_mfma_f32_16x16x32_bf16 a[108:111], a[212:215], v[240:243], a[108:111]
    v_exp_f32 v171, v171
    v_mfma_f32_16x16x32_bf16 a[108:111], a[208:211], v[236:239], a[108:111]
    s_waitcnt lgkmcnt(6)
    ds_read_b128 v[32:35], v23 offset:5120
    ds_read_b128 v[252:255], v23 offset:7680
    v_mfma_f32_16x16x32_bf16 v[164:167], a[176:179], v[36:39], v[100:103]
    v_exp_f32 v172, v172
    v_mfma_f32_16x16x32_bf16 v[164:167], a[180:183], v[40:43], v[164:167]
    ds_read_b64_tr_b16 a[200:201], v6 offset:8192
    v_cvt_pk_bf16_f32 v195, v170, v171
    v_mfma_f32_16x16x32_bf16 v[164:167], a[184:187], v[44:47], v[164:167]
    v_exp_f32 v173, v173
    v_mfma_f32_16x16x32_bf16 v[164:167], a[188:191], v[48:51], v[164:167]
    ds_read_b64_tr_b16 a[202:203], v6 offset:12288
    v_mfma_f32_16x16x32_bf16 v[168:171], a[188:191], v[64:67], v[104:107]
    v_exp_f32 v174, v174
    v_mfma_f32_16x16x32_bf16 v[168:171], a[184:187], v[60:63], v[168:171]
    ds_read_b128 a[136:139], v3 offset:32768
    v_cvt_pk_bf16_f32 v202, v172, v173
    v_mfma_f32_16x16x32_bf16 v[168:171], a[180:183], v[56:59], v[168:171]
    v_exp_f32 v175, v175
    v_mfma_f32_16x16x32_bf16 v[168:171], a[176:179], v[52:55], v[168:171]
    ds_read_b64_tr_b16 a[204:205], v6 offset:32768
    ds_read_b64_tr_b16 a[240:241], v22 offset:0
    v_mfma_f32_16x16x32_bf16 a[112:115], a[216:219], v[212:215], a[112:115]
    v_exp_f32 v176, v176
    v_mfma_f32_16x16x32_bf16 a[112:115], a[220:223], v[216:219], a[112:115]
    ds_read_b64_tr_b16 a[206:207], v6 offset:36864
    v_cvt_pk_bf16_f32 v203, v174, v175
    v_mfma_f32_16x16x32_bf16 a[116:119], a[220:223], v[224:227], a[116:119]
    v_exp_f32 v177, v177
    v_mfma_f32_16x16x32_bf16 a[116:119], a[216:219], v[220:223], a[116:119]
    ds_read_b128 a[140:143], v4 offset:32768
    ds_read_b64_tr_b16 a[242:243], v22 offset:32
    v_mfma_f32_16x16x32_bf16 a[120:123], a[216:219], v[228:231], a[120:123]
    v_exp_f32 v178, v178
    v_mfma_f32_16x16x32_bf16 a[120:123], a[220:223], v[232:235], a[120:123]
    ds_read_b64_tr_b16 a[244:245], v22 offset:64
    v_cvt_pk_bf16_f32 v210, v176, v177
    v_mfma_f32_16x16x32_bf16 a[124:127], a[220:223], v[240:243], a[124:127]
    v_exp_f32 v179, v179
    v_mfma_f32_16x16x32_bf16 a[124:127], a[216:219], v[236:239], a[124:127]
    buffer_load_dwordx4 v14, s[8:11], s28 offen offset:1024 lds
    v_smfmac_f32_16x16x64_bf16 a[236:239], v[244:247], v[236:243], v248
    s_waitcnt lgkmcnt(6)
    ds_read_b64_tr_b16 a[246:247], v22 offset:96
    v_mfma_f32_16x16x32_bf16 v[172:175], a[176:179], v[68:71], v[108:111]
    v_exp_f32 v116, v116
    v_mfma_f32_16x16x32_bf16 v[172:175], a[180:183], v[72:75], v[172:175]
    ds_read_b64_tr_b16 a[208:209], v7 offset:8192
    v_cvt_pk_bf16_f32 v211, v178, v179
    v_add_f32 v24, v24, v28
    v_mfma_f32_16x16x32_bf16 v[172:175], a[184:187], v[76:79], v[172:175]
    v_exp_f32 v117, v117
    v_mfma_f32_16x16x32_bf16 v[172:175], a[188:191], v[80:83], v[172:175]
    ds_read_b64_tr_b16 a[210:211], v7 offset:12288
    v_add_f32 v25, v25, v29
    v_mfma_f32_16x16x32_bf16 v[176:179], a[188:191], v[96:99], v[112:115]
    v_exp_f32 v118, v118
    v_add_f32 v26, v26, v30
    v_mfma_f32_16x16x32_bf16 v[176:179], a[184:187], v[92:95], v[176:179]
    ds_read_b128 a[144:147], v1 offset:36864
    v_cvt_pk_bf16_f32 v212, v116, v117
    v_mfma_f32_16x16x32_bf16 v[176:179], a[180:183], v[88:91], v[176:179]
    v_exp_f32 v119, v119
    v_add_f32 v27, v27, v31
    v_mfma_f32_16x16x32_bf16 v[176:179], a[176:179], v[84:87], v[176:179]
    ds_read_b64_tr_b16 a[212:213], v7 offset:32768
    v_add_f32 v24, v24, v32
    v_mfma_f32_16x16x32_bf16 a[0:3], a[192:195], v[180:183], a[0:3]
    v_exp_f32 v120, v120
    v_mfma_f32_16x16x32_bf16 a[0:3], a[196:199], v[184:187], a[0:3]
    ds_read_b64_tr_b16 a[214:215], v7 offset:36864
    v_cvt_pk_bf16_f32 v213, v118, v119
    v_add_f32 v25, v25, v33
    v_mfma_f32_16x16x32_bf16 a[4:7], a[196:199], v[192:195], a[4:7]
    v_exp_f32 v121, v121
    v_add_f32 v26, v26, v34
    v_mfma_f32_16x16x32_bf16 a[4:7], a[192:195], v[188:191], a[4:7]
    ds_read_b128 a[148:151], v2 offset:36864
    v_cvt_pk_bf16_f32 v220, v120, v121
    v_mfma_f32_16x16x32_bf16 a[8:11], a[192:195], v[196:199], a[8:11]
    v_exp_f32 v122, v122
    v_add_f32 v27, v27, v35
    v_mfma_f32_16x16x32_bf16 a[8:11], a[196:199], v[200:203], a[8:11]
    buffer_load_dwordx4 v15, s[8:11], s28 offen offset:2048 lds
    v_add_f32 v24, v24, v252
    v_mfma_f32_16x16x32_bf16 a[12:15], a[196:199], v[208:211], a[12:15]
    v_exp_f32 v123, v123
    v_mfma_f32_16x16x32_bf16 a[12:15], a[192:195], v[204:207], a[12:15]
    s_waitcnt lgkmcnt(6)
    v_add_f32 v25, v25, v253
    v_add_f32 v26, v26, v254
    v_mfma_f32_16x16x32_bf16 v[116:119], a[128:131], v[36:39], v[100:103]
    v_exp_f32 v124, v124
    v_mfma_f32_16x16x32_bf16 v[116:119], a[132:135], v[40:43], v[116:119]
    ds_read_b64_tr_b16 a[216:217], v8 offset:8192
    v_cvt_pk_bf16_f32 v221, v122, v123
    v_mfma_f32_16x16x32_bf16 v[116:119], a[136:139], v[44:47], v[116:119]
    v_exp_f32 v125, v125
    v_add_f32 v27, v27, v255
    v_mfma_f32_16x16x32_bf16 v[116:119], a[140:143], v[48:51], v[116:119]
    ds_read_b64_tr_b16 a[218:219], v8 offset:12288
    v_mov_b32_dpp v28, v24 row_newbcast:8 row_mask:0xf bank_mask:0xf
    v_mfma_f32_16x16x32_bf16 v[120:123], a[140:143], v[64:67], v[104:107]
    v_exp_f32 v126, v126
    v_mfma_f32_16x16x32_bf16 v[120:123], a[136:139], v[60:63], v[120:123]
    ds_read_b128 a[152:155], v3 offset:36864
    v_cvt_pk_bf16_f32 v228, v124, v125
    v_mov_b32_dpp v29, v25 row_newbcast:8 row_mask:0xf bank_mask:0xf
    v_mfma_f32_16x16x32_bf16 v[120:123], a[132:135], v[56:59], v[120:123]
    v_exp_f32 v127, v127
    v_mfma_f32_16x16x32_bf16 v[120:123], a[128:131], v[52:55], v[120:123]
    ds_read_b64_tr_b16 a[220:221], v8 offset:32768
    v_mov_b32_dpp v30, v26 row_newbcast:8 row_mask:0xf bank_mask:0xf
    v_mfma_f32_16x16x32_bf16 a[16:19], a[200:203], v[180:183], a[16:19]
    v_exp_f32 v128, v128
    v_mov_b32_dpp v31, v27 row_newbcast:8 row_mask:0xf bank_mask:0xf
    v_mfma_f32_16x16x32_bf16 a[16:19], a[204:207], v[184:187], a[16:19]
    ds_read_b64_tr_b16 a[222:223], v8 offset:36864
    v_cvt_pk_bf16_f32 v229, v126, v127
    v_mfma_f32_16x16x32_bf16 a[20:23], a[204:207], v[192:195], a[20:23]
    v_exp_f32 v129, v129
    v_fma_f32 v24, -v20, v28, v24
    v_mfma_f32_16x16x32_bf16 a[20:23], a[200:203], v[188:191], a[20:23]
    ds_read_b128 a[156:159], v4 offset:36864
    v_fma_f32 v25, -v20, v29, v25
    v_mfma_f32_16x16x32_bf16 a[24:27], a[200:203], v[196:199], a[24:27]
    v_exp_f32 v130, v130
    v_mfma_f32_16x16x32_bf16 a[24:27], a[204:207], v[200:203], a[24:27]
    v_cvt_pk_bf16_f32 v236, v128, v129
    v_fma_f32 v26, -v20, v30, v26
    v_mfma_f32_16x16x32_bf16 a[28:31], a[204:207], v[208:211], a[28:31]
    v_exp_f32 v131, v131
    v_mfma_f32_16x16x32_bf16 a[28:31], a[200:203], v[204:207], a[28:31]
    buffer_load_dwordx4 v16, s[8:11], s28 offen offset:3072 lds
    v_fma_f32 v27, -v20, v31, v27
    v_smfmac_f32_16x16x64_bf16 a[224:227], v[244:247], v[180:187], v248
    s_waitcnt lgkmcnt(6)
    ds_read_b64_tr_b16 a[248:249], v22 offset:128
    ds_read_b64_tr_b16 a[250:251], v22 offset:160
    ds_read_b64_tr_b16 a[252:253], v22 offset:192
    ds_read_b64_tr_b16 a[254:255], v22 offset:224
    v_mul_f32 v24, v24, v21
    v_mul_f32 v25, v25, v21
    v_mfma_f32_16x16x32_bf16 v[124:127], a[128:131], v[68:71], v[108:111]
    v_exp_f32 v132, v132
    v_mfma_f32_16x16x32_bf16 v[124:127], a[132:135], v[72:75], v[124:127]
    ds_read_b64_tr_b16 a[192:193], v9 offset:8192
    v_cvt_pk_bf16_f32 v237, v130, v131
    v_mfma_f32_16x16x32_bf16 v[124:127], a[136:139], v[76:79], v[124:127]
    v_exp_f32 v133, v133
    v_mfma_f32_16x16x32_bf16 v[124:127], a[140:143], v[80:83], v[124:127]
    ds_read_b64_tr_b16 a[194:195], v9 offset:12288
    v_mul_f32 v26, v26, v21
    v_mfma_f32_16x16x32_bf16 v[128:131], a[140:143], v[96:99], v[112:115]
    v_exp_f32 v134, v134
    v_mul_f32 v27, v27, v21
    v_mfma_f32_16x16x32_bf16 v[128:131], a[136:139], v[92:95], v[128:131]
    ds_read_b128 a[160:163], v1 offset:40960
    v_cvt_pk_bf16_f32 v214, v132, v133
    v_mfma_f32_16x16x32_bf16 v[128:131], a[132:135], v[88:91], v[128:131]
    v_exp_f32 v135, v135
    v_cvt_pk_bf16_f32 v28, v24, v25
    v_mfma_f32_16x16x32_bf16 v[128:131], a[128:131], v[84:87], v[128:131]
    ds_read_b64_tr_b16 a[196:197], v9 offset:32768
    v_cvt_pk_bf16_f32 v29, v26, v27
    v_mfma_f32_16x16x32_bf16 a[32:35], a[208:211], v[180:183], a[32:35]
    v_exp_f32 v136, v136
    v_mfma_f32_16x16x32_bf16 a[32:35], a[212:215], v[184:187], a[32:35]
    ds_read_b64_tr_b16 a[198:199], v9 offset:36864
    v_cvt_pk_bf16_f32 v215, v134, v135
    v_lshlrev_b32 v24, 16, v28
    v_mfma_f32_16x16x32_bf16 a[36:39], a[212:215], v[192:195], a[36:39]
    v_exp_f32 v137, v137
    v_and_b32 v25, 0xffff0000, v28
    v_mfma_f32_16x16x32_bf16 a[36:39], a[208:211], v[188:191], a[36:39]
    ds_read_b128 a[164:167], v2 offset:40960
    v_cvt_pk_bf16_f32 v222, v136, v137
    v_mfma_f32_16x16x32_bf16 a[40:43], a[208:211], v[196:199], a[40:43]
    s_add_u32 s28, s28, 16384
    s_mov_b32 m0, s32
    v_exp_f32 v138, v138
    v_lshlrev_b32 v26, 16, v29
    v_mfma_f32_16x16x32_bf16 a[40:43], a[212:215], v[200:203], a[40:43]
    buffer_load_dwordx4 v17, s[12:15], s29 offen offset:0 lds
    v_and_b32 v27, 0xffff0000, v29
    v_mfma_f32_16x16x32_bf16 a[44:47], a[212:215], v[208:211], a[44:47]
    v_exp_f32 v139, v139
    v_mfma_f32_16x16x32_bf16 a[44:47], a[208:211], v[204:207], a[44:47]
    s_waitcnt lgkmcnt(6)
    v_mov_b32 v32, v24
    v_mov_b32 v33, v25
    v_mfma_f32_16x16x32_bf16 v[132:135], a[144:147], v[36:39], v[100:103]
    v_exp_f32 v140, v140
    v_mfma_f32_16x16x32_bf16 v[132:135], a[148:151], v[40:43], v[132:135]
    ds_read_b64_tr_b16 a[200:201], v10 offset:8192
    v_cvt_pk_bf16_f32 v223, v138, v139
    v_mfma_f32_16x16x32_bf16 v[132:135], a[152:155], v[44:47], v[132:135]
    v_exp_f32 v141, v141
    v_mov_b32 v34, v26
    v_mfma_f32_16x16x32_bf16 v[132:135], a[156:159], v[48:51], v[132:135]
    ds_read_b64_tr_b16 a[202:203], v10 offset:12288
    v_mov_b32 v35, v27
    v_mfma_f32_16x16x32_bf16 v[136:139], a[156:159], v[64:67], v[104:107]
    v_exp_f32 v142, v142
    v_mfma_f32_16x16x32_bf16 v[136:139], a[152:155], v[60:63], v[136:139]
    ds_read_b128 a[168:171], v3 offset:40960
    v_cvt_pk_bf16_f32 v230, v140, v141
    v_permlane32_swap_b32 v24, v32
    v_mfma_f32_16x16x32_bf16 v[136:139], a[148:151], v[56:59], v[136:139]
    v_exp_f32 v143, v143
    v_mfma_f32_16x16x32_bf16 v[136:139], a[144:147], v[52:55], v[136:139]
    ds_read_b64_tr_b16 a[204:205], v10 offset:32768
    v_permlane32_swap_b32 v25, v33
    v_mfma_f32_16x16x32_bf16 a[48:51], a[216:219], v[180:183], a[48:51]
    v_exp_f32 v144, v144
    v_permlane32_swap_b32 v26, v34
    v_mfma_f32_16x16x32_bf16 a[48:51], a[220:223], v[184:187], a[48:51]
    ds_read_b64_tr_b16 a[206:207], v10 offset:36864
    v_cvt_pk_bf16_f32 v231, v142, v143
    v_mfma_f32_16x16x32_bf16 a[52:55], a[220:223], v[192:195], a[52:55]
    v_exp_f32 v145, v145
    v_permlane32_swap_b32 v27, v35
    v_mfma_f32_16x16x32_bf16 a[52:55], a[216:219], v[188:191], a[52:55]
    ds_read_b128 a[172:175], v4 offset:40960
    v_mul_f32 v28, 0xbfb8aa3b, v24
    v_mfma_f32_16x16x32_bf16 a[56:59], a[216:219], v[196:199], a[56:59]
    v_exp_f32 v146, v146
    v_mfma_f32_16x16x32_bf16 a[56:59], a[220:223], v[200:203], a[56:59]
    v_cvt_pk_bf16_f32 v238, v144, v145
    v_mul_f32 v29, 0xbfb8aa3b, v25
    v_mfma_f32_16x16x32_bf16 a[60:63], a[220:223], v[208:211], a[60:63]
    v_exp_f32 v147, v147
    v_mfma_f32_16x16x32_bf16 a[60:63], a[216:219], v[204:207], a[60:63]
    buffer_load_dwordx4 v18, s[12:15], s29 offen offset:1024 lds
    v_mul_f32 v30, 0xbfb8aa3b, v26
    v_smfmac_f32_16x16x64_bf16 a[228:231], v[244:247], v[188:195], v248
    s_waitcnt lgkmcnt(6)
    v_mul_f32 v31, 0xbfb8aa3b, v27
    v_mfma_f32_16x16x32_bf16 v[140:143], a[144:147], v[68:71], v[108:111]
    v_exp_f32 v148, v148
    v_mfma_f32_16x16x32_bf16 v[140:143], a[148:151], v[72:75], v[140:143]
    ds_read_b64_tr_b16 a[208:209], v11 offset:8192
    v_cvt_pk_bf16_f32 v239, v146, v147
    v_exp_f32 v28, v28
    v_mfma_f32_16x16x32_bf16 v[140:143], a[152:155], v[76:79], v[140:143]
    v_exp_f32 v149, v149
    v_mfma_f32_16x16x32_bf16 v[140:143], a[156:159], v[80:83], v[140:143]
    ds_read_b64_tr_b16 a[210:211], v11 offset:12288
    v_exp_f32 v29, v29
    v_mfma_f32_16x16x32_bf16 v[144:147], a[156:159], v[96:99], v[112:115]
    v_exp_f32 v150, v150
    v_exp_f32 v30, v30
    v_mfma_f32_16x16x32_bf16 v[144:147], a[152:155], v[92:95], v[144:147]
    ds_read_b128 a[176:179], v1 offset:45056
    v_cvt_pk_bf16_f32 v216, v148, v149
    v_mfma_f32_16x16x32_bf16 v[144:147], a[148:151], v[88:91], v[144:147]
    v_exp_f32 v151, v151
    v_exp_f32 v31, v31
    v_mfma_f32_16x16x32_bf16 v[144:147], a[144:147], v[84:87], v[144:147]
    ds_read_b64_tr_b16 a[212:213], v11 offset:32768
    v_add_f32 v28, 1.0, v28
    v_mfma_f32_16x16x32_bf16 a[64:67], a[192:195], v[180:183], a[64:67]
    v_exp_f32 v152, v152
    v_mfma_f32_16x16x32_bf16 a[64:67], a[196:199], v[184:187], a[64:67]
    ds_read_b64_tr_b16 a[214:215], v11 offset:36864
    v_cvt_pk_bf16_f32 v217, v150, v151
    v_add_f32 v29, 1.0, v29
    v_mfma_f32_16x16x32_bf16 a[68:71], a[196:199], v[192:195], a[68:71]
    v_exp_f32 v153, v153
    v_add_f32 v30, 1.0, v30
    v_mfma_f32_16x16x32_bf16 a[68:71], a[192:195], v[188:191], a[68:71]
    ds_read_b128 a[180:183], v2 offset:45056
    v_cvt_pk_bf16_f32 v224, v152, v153
    v_mfma_f32_16x16x32_bf16 a[72:75], a[192:195], v[196:199], a[72:75]
    v_exp_f32 v154, v154
    v_add_f32 v31, 1.0, v31
    v_mfma_f32_16x16x32_bf16 a[72:75], a[196:199], v[200:203], a[72:75]
    buffer_load_dwordx4 v17, s[12:15], s29 offen offset:2048 lds
    v_rcp_f32 v28, v28
    v_mfma_f32_16x16x32_bf16 a[76:79], a[196:199], v[208:211], a[76:79]
    v_exp_f32 v155, v155
    v_mfma_f32_16x16x32_bf16 a[76:79], a[192:195], v[204:207], a[76:79]
    s_waitcnt lgkmcnt(6)
    v_rcp_f32 v29, v29
    v_mfma_f32_16x16x32_bf16 v[148:151], a[160:163], v[36:39], v[100:103]
    v_exp_f32 v156, v156
    v_rcp_f32 v30, v30
    v_mfma_f32_16x16x32_bf16 v[148:151], a[164:167], v[40:43], v[148:151]
    ds_read_b64_tr_b16 a[216:217], v12 offset:8192
    v_cvt_pk_bf16_f32 v225, v154, v155
    v_mfma_f32_16x16x32_bf16 v[148:151], a[168:171], v[44:47], v[148:151]
    v_exp_f32 v157, v157
    v_rcp_f32 v31, v31
    v_mfma_f32_16x16x32_bf16 v[148:151], a[172:175], v[48:51], v[148:151]
    ds_read_b64_tr_b16 a[218:219], v12 offset:12288
    v_mul_f32 v24, v24, v28
    v_mfma_f32_16x16x32_bf16 v[152:155], a[172:175], v[64:67], v[104:107]
    v_exp_f32 v158, v158
    v_mfma_f32_16x16x32_bf16 v[152:155], a[168:171], v[60:63], v[152:155]
    ds_read_b128 a[184:187], v3 offset:45056
    v_cvt_pk_bf16_f32 v232, v156, v157
    v_mul_f32 v25, v25, v29
    v_mfma_f32_16x16x32_bf16 v[152:155], a[164:167], v[56:59], v[152:155]
    v_exp_f32 v159, v159
    v_mfma_f32_16x16x32_bf16 v[152:155], a[160:163], v[52:55], v[152:155]
    ds_read_b64_tr_b16 a[220:221], v12 offset:32768
    v_mul_f32 v26, v26, v30
    v_mfma_f32_16x16x32_bf16 a[80:83], a[200:203], v[180:183], a[80:83]
    v_exp_f32 v160, v160
    v_mul_f32 v27, v27, v31
    v_mfma_f32_16x16x32_bf16 a[80:83], a[204:207], v[184:187], a[80:83]
    ds_read_b64_tr_b16 a[222:223], v12 offset:36864
    v_cvt_pk_bf16_f32 v233, v158, v159
    v_mfma_f32_16x16x32_bf16 a[84:87], a[204:207], v[192:195], a[84:87]
    v_exp_f32 v161, v161
    v_cvt_pk_bf16_f32 v28, v24, v25
    v_mfma_f32_16x16x32_bf16 a[84:87], a[200:203], v[188:191], a[84:87]
    ds_read_b128 a[188:191], v4 offset:45056
    v_cvt_pk_bf16_f32 v29, v26, v27
    v_mfma_f32_16x16x32_bf16 a[88:91], a[200:203], v[196:199], a[88:91]
    v_exp_f32 v162, v162
    v_mfma_f32_16x16x32_bf16 a[88:91], a[204:207], v[200:203], a[88:91]
    v_cvt_pk_bf16_f32 v240, v160, v161
    v_lshlrev_b32 v24, 16, v28
    v_mfma_f32_16x16x32_bf16 a[92:95], a[204:207], v[208:211], a[92:95]
    v_exp_f32 v163, v163
    v_mfma_f32_16x16x32_bf16 a[92:95], a[200:203], v[204:207], a[92:95]
    buffer_load_dwordx4 v18, s[12:15], s29 offen offset:3072 lds
    v_and_b32 v25, 0xffff0000, v28
    v_smfmac_f32_16x16x64_bf16 a[232:235], v[244:247], v[196:203], v248
    s_waitcnt vmcnt(8) lgkmcnt(6)
    s_barrier
    s_add_u32 s29, s29, 16384
    v_lshlrev_b32 v26, 16, v29
    v_and_b32 v27, 0xffff0000, v29
    v_mfma_f32_16x16x32_bf16 v[156:159], a[160:163], v[68:71], v[108:111]
    v_exp_f32 v164, v164
    v_mfma_f32_16x16x32_bf16 v[156:159], a[164:167], v[72:75], v[156:159]
    ds_read_b64_tr_b16 a[192:193], v5 offset:16384
    v_cvt_pk_bf16_f32 v241, v162, v163
    v_mfma_f32_16x16x32_bf16 v[156:159], a[168:171], v[76:79], v[156:159]
    v_exp_f32 v165, v165
    v_mfma_f32_16x16x32_bf16 v[156:159], a[172:175], v[80:83], v[156:159]
    ds_read_b64_tr_b16 a[194:195], v5 offset:20480
    v_mul_f32 v24, v24, v32
    v_mfma_f32_16x16x32_bf16 v[160:163], a[172:175], v[96:99], v[112:115]
    v_exp_f32 v166, v166
    v_mul_f32 v25, v25, v33
    v_mfma_f32_16x16x32_bf16 v[160:163], a[168:171], v[92:95], v[160:163]
    ds_read_b128 a[128:131], v1 offset:0
    v_cvt_pk_bf16_f32 v218, v164, v165
    v_mfma_f32_16x16x32_bf16 v[160:163], a[164:167], v[88:91], v[160:163]
    v_exp_f32 v167, v167
    v_mul_f32 v26, v26, v34
    v_mfma_f32_16x16x32_bf16 v[160:163], a[160:163], v[84:87], v[160:163]
    ds_read_b64_tr_b16 a[196:197], v5 offset:40960
    v_mul_f32 v27, v27, v35
    v_mfma_f32_16x16x32_bf16 a[96:99], a[208:211], v[180:183], a[96:99]
    v_exp_f32 v168, v168
    v_mfma_f32_16x16x32_bf16 a[96:99], a[212:215], v[184:187], a[96:99]
    ds_read_b64_tr_b16 a[198:199], v5 offset:45056
    v_cvt_pk_bf16_f32 v219, v166, v167
    v_cmp_gt_u32 vcc, 32, v19
    v_mfma_f32_16x16x32_bf16 a[100:103], a[212:215], v[192:195], a[100:103]
    v_exp_f32 v169, v169
    v_cvt_pk_bf16_f32 v252, v24, v25
    v_mfma_f32_16x16x32_bf16 a[100:103], a[208:211], v[188:191], a[100:103]
    ds_read_b128 a[132:135], v2 offset:0
    v_cvt_pk_bf16_f32 v226, v168, v169
    v_mfma_f32_16x16x32_bf16 a[104:107], a[208:211], v[196:199], a[104:107]
    s_add_u32 m0, s34, 16384
    v_exp_f32 v170, v170
    v_cvt_pk_bf16_f32 v253, v26, v27
    v_mfma_f32_16x16x32_bf16 a[104:107], a[212:215], v[200:203], a[104:107]
    buffer_load_dwordx4 v13, s[8:11], s28 offen offset:0 lds
    v_cndmask_b32 v252, 0, v252, vcc
    v_mfma_f32_16x16x32_bf16 a[108:111], a[212:215], v[208:211], a[108:111]
    v_exp_f32 v171, v171
    v_mfma_f32_16x16x32_bf16 a[108:111], a[208:211], v[204:207], a[108:111]
    s_waitcnt lgkmcnt(6)
    v_cndmask_b32 v253, 0, v253, vcc
    v_and_b32 v23, 7, v19
    v_mfma_f32_16x16x32_bf16 v[164:167], a[176:179], v[36:39], v[100:103]
    v_exp_f32 v172, v172
    v_mfma_f32_16x16x32_bf16 v[164:167], a[180:183], v[40:43], v[164:167]
    ds_read_b64_tr_b16 a[200:201], v6 offset:16384
    v_cvt_pk_bf16_f32 v227, v170, v171
    v_mfma_f32_16x16x32_bf16 v[164:167], a[184:187], v[44:47], v[164:167]
    v_exp_f32 v173, v173
    v_mul_u32_u24 v23, 34560, v23
    v_mfma_f32_16x16x32_bf16 v[164:167], a[188:191], v[48:51], v[164:167]
    ds_read_b64_tr_b16 a[202:203], v6 offset:20480
    v_lshrrev_b32 v0, 4, v19
    v_mfma_f32_16x16x32_bf16 v[168:171], a[188:191], v[64:67], v[104:107]
    v_exp_f32 v174, v174
    v_mfma_f32_16x16x32_bf16 v[168:171], a[184:187], v[60:63], v[168:171]
    ds_read_b128 a[136:139], v3 offset:0
    v_cvt_pk_bf16_f32 v234, v172, v173
    v_add_u32 v23, v23, v0
    v_mfma_f32_16x16x32_bf16 v[168:171], a[180:183], v[56:59], v[168:171]
    v_exp_f32 v175, v175
    v_mfma_f32_16x16x32_bf16 v[168:171], a[176:179], v[52:55], v[168:171]
    ds_read_b64_tr_b16 a[204:205], v6 offset:40960
    v_and_b32 v0, 8, v19
    v_mfma_f32_16x16x32_bf16 a[112:115], a[216:219], v[180:183], a[112:115]
    v_exp_f32 v176, v176
    v_lshrrev_b32 v0, 1, v0
    v_mfma_f32_16x16x32_bf16 a[112:115], a[220:223], v[184:187], a[112:115]
    ds_read_b64_tr_b16 a[206:207], v6 offset:45056
    v_cvt_pk_bf16_f32 v235, v174, v175
    v_mfma_f32_16x16x32_bf16 a[116:119], a[220:223], v[192:195], a[116:119]
    v_exp_f32 v177, v177
    v_add_lshl_u32 v23, v23, v0, 4
    v_mfma_f32_16x16x32_bf16 a[116:119], a[216:219], v[188:191], a[116:119]
    s_mul_i32 s42, s5, 1080
    ds_read_b128 a[140:143], v4 offset:0
    v_mfma_f32_16x16x32_bf16 a[120:123], a[216:219], v[196:199], a[120:123]
    s_add_u32 s42, s42, s6
    v_exp_f32 v178, v178
    v_mfma_f32_16x16x32_bf16 a[120:123], a[220:223], v[200:203], a[120:123]
    s_lshl_b32 s42, s42, 7
    v_cvt_pk_bf16_f32 v242, v176, v177
    v_mfma_f32_16x16x32_bf16 a[124:127], a[220:223], v[208:211], a[124:127]
    s_cmp_lt_u32 s6, 216
    s_cselect_b32 s42, s42, 0x438000
    v_exp_f32 v179, v179
    v_mfma_f32_16x16x32_bf16 a[124:127], a[216:219], v[204:207], a[124:127]
    buffer_load_dwordx4 v14, s[8:11], s28 offen offset:1024 lds
    v_smfmac_f32_16x16x64_bf16 a[236:239], v[244:247], v[204:211], v248
    s_waitcnt lgkmcnt(6)
    v_mfma_f32_16x16x32_bf16 v[172:175], a[176:179], v[68:71], v[108:111]
    v_exp_f32 v116, v116
    v_mfma_f32_16x16x16_bf16 v[24:27], a[240:241], v[252:253], 0
    v_mfma_f32_16x16x16_bf16 v[28:31], a[242:243], v[252:253], 0
    v_mfma_f32_16x16x32_bf16 v[172:175], a[180:183], v[72:75], v[172:175]
    ds_read_b64_tr_b16 a[208:209], v7 offset:16384
    v_cvt_pk_bf16_f32 v243, v178, v179
    v_mfma_f32_16x16x32_bf16 v[172:175], a[184:187], v[76:79], v[172:175]
    v_exp_f32 v117, v117
    v_mfma_f32_16x16x32_bf16 v[172:175], a[188:191], v[80:83], v[172:175]
    ds_read_b64_tr_b16 a[210:211], v7 offset:20480
    v_mfma_f32_16x16x32_bf16 v[176:179], a[188:191], v[96:99], v[112:115]
    v_exp_f32 v118, v118
    v_mfma_f32_16x16x32_bf16 v[176:179], a[184:187], v[92:95], v[176:179]
    ds_read_b128 a[144:147], v1 offset:4096
    v_cvt_pk_bf16_f32 v180, v116, v117
    v_mfma_f32_16x16x32_bf16 v[176:179], a[180:183], v[88:91], v[176:179]
    v_exp_f32 v119, v119
    v_mfma_f32_16x16x32_bf16 v[176:179], a[176:179], v[84:87], v[176:179]
    ds_read_b64_tr_b16 a[212:213], v7 offset:40960
    v_mov_b32_dpp v24, v28 row_shr:8 row_mask:0xf bank_mask:0xc
    v_mfma_f32_16x16x32_bf16 a[0:3], a[192:195], v[212:215], a[0:3]
    v_exp_f32 v120, v120
    v_mfma_f32_16x16x32_bf16 a[0:3], a[196:199], v[216:219], a[0:3]
    ds_read_b64_tr_b16 a[214:215], v7 offset:45056
    v_cvt_pk_bf16_f32 v181, v118, v119
    v_mov_b32_dpp v25, v29 row_shr:8 row_mask:0xf bank_mask:0xc
    v_mfma_f32_16x16x32_bf16 a[4:7], a[196:199], v[224:227], a[4:7]
    v_exp_f32 v121, v121
    v_mov_b32_dpp v26, v30 row_shr:8 row_mask:0xf bank_mask:0xc
    v_mfma_f32_16x16x32_bf16 a[4:7], a[192:195], v[220:223], a[4:7]
    ds_read_b128 a[148:151], v2 offset:4096
    v_cvt_pk_bf16_f32 v188, v120, v121
    v_mov_b32_dpp v27, v31 row_shr:8 row_mask:0xf bank_mask:0xc
    v_mfma_f32_16x16x32_bf16 a[8:11], a[192:195], v[228:231], a[8:11]
    buffer_store_dwordx4 v[24:27], v23, s[16:19], s42 offen sc1
    v_exp_f32 v122, v122
    v_mfma_f32_16x16x32_bf16 a[8:11], a[196:199], v[232:235], a[8:11]
    s_add_u32 s42, s42, 27648
    buffer_load_dwordx4 v15, s[8:11], s28 offen offset:2048 lds
    v_mfma_f32_16x16x32_bf16 a[12:15], a[196:199], v[240:243], a[12:15]
    v_exp_f32 v123, v123
    v_mfma_f32_16x16x32_bf16 a[12:15], a[192:195], v[236:239], a[12:15]
    s_waitcnt lgkmcnt(6)
    ds_read_b64_tr_b16 a[240:241], v22 offset:256
    ds_read_b64_tr_b16 a[242:243], v22 offset:288
    v_mfma_f32_16x16x32_bf16 v[116:119], a[128:131], v[36:39], v[100:103]
    v_exp_f32 v124, v124
    v_mfma_f32_16x16x16_bf16 v[32:35], a[244:245], v[252:253], 0
    v_mfma_f32_16x16x16_bf16 v[28:31], a[246:247], v[252:253], 0
    v_mfma_f32_16x16x32_bf16 v[116:119], a[132:135], v[40:43], v[116:119]
    ds_read_b64_tr_b16 a[216:217], v8 offset:16384
    v_cvt_pk_bf16_f32 v189, v122, v123
    v_mfma_f32_16x16x32_bf16 v[116:119], a[136:139], v[44:47], v[116:119]
    v_exp_f32 v125, v125
    v_mfma_f32_16x16x32_bf16 v[116:119], a[140:143], v[48:51], v[116:119]
    ds_read_b64_tr_b16 a[218:219], v8 offset:20480
    v_mfma_f32_16x16x32_bf16 v[120:123], a[140:143], v[64:67], v[104:107]
    v_exp_f32 v126, v126
    v_mfma_f32_16x16x32_bf16 v[120:123], a[136:139], v[60:63], v[120:123]
    ds_read_b128 a[152:155], v3 offset:4096
    v_cvt_pk_bf16_f32 v196, v124, v125
    v_mfma_f32_16x16x32_bf16 v[120:123], a[132:135], v[56:59], v[120:123]
    v_exp_f32 v127, v127
    v_mfma_f32_16x16x32_bf16 v[120:123], a[128:131], v[52:55], v[120:123]
    ds_read_b64_tr_b16 a[220:221], v8 offset:40960
    v_mov_b32_dpp v32, v28 row_shr:8 row_mask:0xf bank_mask:0xc
    v_mfma_f32_16x16x32_bf16 a[16:19], a[200:203], v[212:215], a[16:19]
    v_exp_f32 v128, v128
    v_mfma_f32_16x16x32_bf16 a[16:19], a[204:207], v[216:219], a[16:19]
    ds_read_b64_tr_b16 a[222:223], v8 offset:45056
    v_cvt_pk_bf16_f32 v197, v126, v127
    v_mfma_f32_16x16x32_bf16 a[20:23], a[204:207], v[224:227], a[20:23]
    v_exp_f32 v129, v129
    v_mfma_f32_16x16x32_bf16 a[20:23], a[200:203], v[220:223], a[20:23]
    ds_read_b128 a[156:159], v4 offset:4096
    v_mov_b32_dpp v33, v29 row_shr:8 row_mask:0xf bank_mask:0xc
    v_mfma_f32_16x16x32_bf16 a[24:27], a[200:203], v[228:231], a[24:27]
    v_exp_f32 v130, v130
    v_mfma_f32_16x16x32_bf16 a[24:27], a[204:207], v[232:235], a[24:27]
    v_cvt_pk_bf16_f32 v204, v128, v129
    v_mov_b32_dpp v34, v30 row_shr:8 row_mask:0xf bank_mask:0xc
    v_mfma_f32_16x16x32_bf16 a[28:31], a[204:207], v[240:243], a[28:31]
    v_exp_f32 v131, v131
    v_mov_b32_dpp v35, v31 row_shr:8 row_mask:0xf bank_mask:0xc
    v_mfma_f32_16x16x32_bf16 a[28:31], a[200:203], v[236:239], a[28:31]
    buffer_load_dwordx4 v16, s[8:11], s28 offen offset:3072 lds
    buffer_store_dwordx4 v[32:35], v23, s[16:19], s42 offen sc1
    v_smfmac_f32_16x16x64_bf16 a[224:227], v[244:247], v[212:219], v248
    s_waitcnt lgkmcnt(6)
    s_add_u32 s42, s42, 27648
    v_mfma_f32_16x16x32_bf16 v[124:127], a[128:131], v[68:71], v[108:111]
    v_exp_f32 v132, v132
    v_mfma_f32_16x16x16_bf16 v[24:27], a[248:249], v[252:253], 0
    v_mfma_f32_16x16x16_bf16 v[28:31], a[250:251], v[252:253], 0
    v_mfma_f32_16x16x32_bf16 v[124:127], a[132:135], v[72:75], v[124:127]
    ds_read_b64_tr_b16 a[192:193], v9 offset:16384
    v_cvt_pk_bf16_f32 v205, v130, v131
    v_mfma_f32_16x16x32_bf16 v[124:127], a[136:139], v[76:79], v[124:127]
    v_exp_f32 v133, v133
    v_mfma_f32_16x16x32_bf16 v[124:127], a[140:143], v[80:83], v[124:127]
    ds_read_b64_tr_b16 a[194:195], v9 offset:20480
    v_mfma_f32_16x16x32_bf16 v[128:131], a[140:143], v[96:99], v[112:115]
    v_exp_f32 v134, v134
    v_mfma_f32_16x16x32_bf16 v[128:131], a[136:139], v[92:95], v[128:131]
    ds_read_b128 a[160:163], v1 offset:8192
    v_cvt_pk_bf16_f32 v182, v132, v133
    v_mfma_f32_16x16x32_bf16 v[128:131], a[132:135], v[88:91], v[128:131]
    v_exp_f32 v135, v135
    v_mfma_f32_16x16x32_bf16 v[128:131], a[128:131], v[84:87], v[128:131]
    ds_read_b64_tr_b16 a[196:197], v9 offset:40960
    v_mov_b32_dpp v24, v28 row_shr:8 row_mask:0xf bank_mask:0xc
    v_mfma_f32_16x16x32_bf16 a[32:35], a[208:211], v[212:215], a[32:35]
    v_exp_f32 v136, v136
    v_mfma_f32_16x16x32_bf16 a[32:35], a[212:215], v[216:219], a[32:35]
    ds_read_b64_tr_b16 a[198:199], v9 offset:45056
    v_cvt_pk_bf16_f32 v183, v134, v135
    v_mfma_f32_16x16x32_bf16 a[36:39], a[212:215], v[224:227], a[36:39]
    v_exp_f32 v137, v137
    v_mfma_f32_16x16x32_bf16 a[36:39], a[208:211], v[220:223], a[36:39]
    ds_read_b128 a[164:167], v2 offset:8192
    v_cvt_pk_bf16_f32 v190, v136, v137
    v_mov_b32_dpp v25, v29 row_shr:8 row_mask:0xf bank_mask:0xc
    v_mfma_f32_16x16x32_bf16 a[40:43], a[208:211], v[228:231], a[40:43]
    s_add_u32 s28, s28, 16384
    s_mov_b32 m0, s33
    v_exp_f32 v138, v138
    v_mov_b32_dpp v26, v30 row_shr:8 row_mask:0xf bank_mask:0xc
    v_mfma_f32_16x16x32_bf16 a[40:43], a[212:215], v[232:235], a[40:43]
    buffer_load_dwordx4 v17, s[12:15], s29 offen offset:0 lds
    v_mov_b32_dpp v27, v31 row_shr:8 row_mask:0xf bank_mask:0xc
    v_mfma_f32_16x16x32_bf16 a[44:47], a[212:215], v[240:243], a[44:47]
    buffer_store_dwordx4 v[24:27], v23, s[16:19], s42 offen sc1
    v_exp_f32 v139, v139
    v_mfma_f32_16x16x32_bf16 a[44:47], a[208:211], v[236:239], a[44:47]
    s_waitcnt lgkmcnt(6)
    s_add_u32 s42, s42, 27648
    v_mfma_f32_16x16x32_bf16 v[132:135], a[144:147], v[36:39], v[100:103]
    v_exp_f32 v140, v140
    v_mfma_f32_16x16x16_bf16 v[32:35], a[252:253], v[252:253], 0
    v_mfma_f32_16x16x16_bf16 v[28:31], a[254:255], v[252:253], 0
    v_mfma_f32_16x16x32_bf16 v[132:135], a[148:151], v[40:43], v[132:135]
    ds_read_b64_tr_b16 a[200:201], v10 offset:16384
    v_cvt_pk_bf16_f32 v191, v138, v139
    v_mfma_f32_16x16x32_bf16 v[132:135], a[152:155], v[44:47], v[132:135]
    v_exp_f32 v141, v141
    v_mfma_f32_16x16x32_bf16 v[132:135], a[156:159], v[48:51], v[132:135]
    ds_read_b64_tr_b16 a[202:203], v10 offset:20480
    v_mfma_f32_16x16x32_bf16 v[136:139], a[156:159], v[64:67], v[104:107]
    v_exp_f32 v142, v142
    v_mfma_f32_16x16x32_bf16 v[136:139], a[152:155], v[60:63], v[136:139]
    ds_read_b128 a[168:171], v3 offset:8192
    v_cvt_pk_bf16_f32 v198, v140, v141
    v_mfma_f32_16x16x32_bf16 v[136:139], a[148:151], v[56:59], v[136:139]
    v_exp_f32 v143, v143
    v_mfma_f32_16x16x32_bf16 v[136:139], a[144:147], v[52:55], v[136:139]
    ds_read_b64_tr_b16 a[204:205], v10 offset:40960
    v_mov_b32_dpp v32, v28 row_shr:8 row_mask:0xf bank_mask:0xc
    v_mfma_f32_16x16x32_bf16 a[48:51], a[216:219], v[212:215], a[48:51]
    v_exp_f32 v144, v144
    v_mfma_f32_16x16x32_bf16 a[48:51], a[220:223], v[216:219], a[48:51]
    ds_read_b64_tr_b16 a[206:207], v10 offset:45056
    v_cvt_pk_bf16_f32 v199, v142, v143
    v_mfma_f32_16x16x32_bf16 a[52:55], a[220:223], v[224:227], a[52:55]
    v_exp_f32 v145, v145
    v_mfma_f32_16x16x32_bf16 a[52:55], a[216:219], v[220:223], a[52:55]
    ds_read_b128 a[172:175], v4 offset:8192
    v_mov_b32_dpp v33, v29 row_shr:8 row_mask:0xf bank_mask:0xc
    v_mfma_f32_16x16x32_bf16 a[56:59], a[216:219], v[228:231], a[56:59]
    v_exp_f32 v146, v146
    v_mfma_f32_16x16x32_bf16 a[56:59], a[220:223], v[232:235], a[56:59]
    v_cvt_pk_bf16_f32 v206, v144, v145
    v_mov_b32_dpp v34, v30 row_shr:8 row_mask:0xf bank_mask:0xc
    v_mfma_f32_16x16x32_bf16 a[60:63], a[220:223], v[240:243], a[60:63]
    v_exp_f32 v147, v147
    v_mov_b32_dpp v35, v31 row_shr:8 row_mask:0xf bank_mask:0xc
    v_mfma_f32_16x16x32_bf16 a[60:63], a[216:219], v[236:239], a[60:63]
    buffer_load_dwordx4 v18, s[12:15], s29 offen offset:1024 lds
    buffer_store_dwordx4 v[32:35], v23, s[16:19], s42 offen sc1
    v_smfmac_f32_16x16x64_bf16 a[228:231], v[244:247], v[220:227], v248
    s_waitcnt lgkmcnt(6)
    s_add_u32 s42, s42, 27648
    v_mfma_f32_16x16x32_bf16 v[140:143], a[144:147], v[68:71], v[108:111]
    v_exp_f32 v148, v148
    v_mfma_f32_16x16x16_bf16 v[24:27], a[240:241], v[252:253], 0
    v_mfma_f32_16x16x16_bf16 v[28:31], a[242:243], v[252:253], 0
    v_mfma_f32_16x16x32_bf16 v[140:143], a[148:151], v[72:75], v[140:143]
    ds_read_b64_tr_b16 a[208:209], v11 offset:16384
    v_cvt_pk_bf16_f32 v207, v146, v147
    v_mfma_f32_16x16x32_bf16 v[140:143], a[152:155], v[76:79], v[140:143]
    v_exp_f32 v149, v149
    v_mfma_f32_16x16x32_bf16 v[140:143], a[156:159], v[80:83], v[140:143]
    ds_read_b64_tr_b16 a[210:211], v11 offset:20480
    v_mfma_f32_16x16x32_bf16 v[144:147], a[156:159], v[96:99], v[112:115]
    v_exp_f32 v150, v150
    v_mfma_f32_16x16x32_bf16 v[144:147], a[152:155], v[92:95], v[144:147]
    ds_read_b128 a[176:179], v1 offset:12288
    v_cvt_pk_bf16_f32 v184, v148, v149
    v_mfma_f32_16x16x32_bf16 v[144:147], a[148:151], v[88:91], v[144:147]
    v_exp_f32 v151, v151
    v_mfma_f32_16x16x32_bf16 v[144:147], a[144:147], v[84:87], v[144:147]
    ds_read_b64_tr_b16 a[212:213], v11 offset:40960
    v_mov_b32_dpp v24, v28 row_shr:8 row_mask:0xf bank_mask:0xc
    v_mfma_f32_16x16x32_bf16 a[64:67], a[192:195], v[212:215], a[64:67]
    v_exp_f32 v152, v152
    v_mfma_f32_16x16x32_bf16 a[64:67], a[196:199], v[216:219], a[64:67]
    ds_read_b64_tr_b16 a[214:215], v11 offset:45056
    v_cvt_pk_bf16_f32 v185, v150, v151
    v_mfma_f32_16x16x32_bf16 a[68:71], a[196:199], v[224:227], a[68:71]
    v_exp_f32 v153, v153
    v_mfma_f32_16x16x32_bf16 a[68:71], a[192:195], v[220:223], a[68:71]
    ds_read_b128 a[180:183], v2 offset:12288
    v_cvt_pk_bf16_f32 v192, v152, v153
    v_mov_b32_dpp v25, v29 row_shr:8 row_mask:0xf bank_mask:0xc
    v_mfma_f32_16x16x32_bf16 a[72:75], a[192:195], v[228:231], a[72:75]
    v_exp_f32 v154, v154
    v_mov_b32_dpp v26, v30 row_shr:8 row_mask:0xf bank_mask:0xc
    v_mfma_f32_16x16x32_bf16 a[72:75], a[196:199], v[232:235], a[72:75]
    buffer_load_dwordx4 v17, s[12:15], s29 offen offset:2048 lds
    v_mov_b32_dpp v27, v31 row_shr:8 row_mask:0xf bank_mask:0xc
    v_mfma_f32_16x16x32_bf16 a[76:79], a[196:199], v[240:243], a[76:79]
    buffer_store_dwordx4 v[24:27], v23, s[16:19], s42 offen sc1
    v_exp_f32 v155, v155
    v_mfma_f32_16x16x32_bf16 a[76:79], a[192:195], v[236:239], a[76:79]
    s_waitcnt lgkmcnt(6)
    s_add_u32 s42, s42, 27648
    v_mfma_f32_16x16x32_bf16 v[148:151], a[160:163], v[36:39], v[100:103]
    v_exp_f32 v156, v156
    v_mfma_f32_16x16x32_bf16 v[148:151], a[164:167], v[40:43], v[148:151]
    ds_read_b64_tr_b16 a[216:217], v12 offset:16384
    v_cvt_pk_bf16_f32 v193, v154, v155
    v_mfma_f32_16x16x32_bf16 v[148:151], a[168:171], v[44:47], v[148:151]
    v_exp_f32 v157, v157
    v_mfma_f32_16x16x32_bf16 v[148:151], a[172:175], v[48:51], v[148:151]
    ds_read_b64_tr_b16 a[218:219], v12 offset:20480
    v_mfma_f32_16x16x32_bf16 v[152:155], a[172:175], v[64:67], v[104:107]
    v_exp_f32 v158, v158
    v_mfma_f32_16x16x32_bf16 v[152:155], a[168:171], v[60:63], v[152:155]
    ds_read_b128 a[184:187], v3 offset:12288
    v_cvt_pk_bf16_f32 v200, v156, v157
    v_mfma_f32_16x16x32_bf16 v[152:155], a[164:167], v[56:59], v[152:155]
    v_exp_f32 v159, v159
    v_mfma_f32_16x16x32_bf16 v[152:155], a[160:163], v[52:55], v[152:155]
    ds_read_b64_tr_b16 a[220:221], v12 offset:40960
    v_mfma_f32_16x16x32_bf16 a[80:83], a[200:203], v[212:215], a[80:83]
    v_exp_f32 v160, v160
    v_mfma_f32_16x16x32_bf16 a[80:83], a[204:207], v[216:219], a[80:83]
    ds_read_b64_tr_b16 a[222:223], v12 offset:45056
    v_cvt_pk_bf16_f32 v201, v158, v159
    v_mfma_f32_16x16x32_bf16 a[84:87], a[204:207], v[224:227], a[84:87]
    v_exp_f32 v161, v161
    v_mfma_f32_16x16x32_bf16 a[84:87], a[200:203], v[220:223], a[84:87]
    ds_read_b128 a[188:191], v4 offset:12288
    v_mfma_f32_16x16x32_bf16 a[88:91], a[200:203], v[228:231], a[88:91]
    v_exp_f32 v162, v162
    v_mfma_f32_16x16x32_bf16 a[88:91], a[204:207], v[232:235], a[88:91]
    v_cvt_pk_bf16_f32 v208, v160, v161
    v_mfma_f32_16x16x32_bf16 a[92:95], a[204:207], v[240:243], a[92:95]
    v_exp_f32 v163, v163
    v_mfma_f32_16x16x32_bf16 a[92:95], a[200:203], v[236:239], a[92:95]
    buffer_load_dwordx4 v18, s[12:15], s29 offen offset:3072 lds
    v_smfmac_f32_16x16x64_bf16 a[232:235], v[244:247], v[228:235], v248
    s_waitcnt vmcnt(13) lgkmcnt(6)
    s_barrier
    s_add_u32 s29, s29, 16384
    v_mfma_f32_16x16x32_bf16 v[156:159], a[160:163], v[68:71], v[108:111]
    v_exp_f32 v164, v164
    v_mfma_f32_16x16x32_bf16 v[156:159], a[164:167], v[72:75], v[156:159]
    ds_read_b64_tr_b16 a[192:193], v5 offset:57344
    v_cvt_pk_bf16_f32 v209, v162, v163
    v_mfma_f32_16x16x32_bf16 v[156:159], a[168:171], v[76:79], v[156:159]
    v_exp_f32 v165, v165
    v_mfma_f32_16x16x32_bf16 v[156:159], a[172:175], v[80:83], v[156:159]
    ds_read_b64_tr_b16 a[194:195], v5 offset:61440
    v_mfma_f32_16x16x32_bf16 v[160:163], a[172:175], v[96:99], v[112:115]
    v_exp_f32 v166, v166
    v_mfma_f32_16x16x32_bf16 v[160:163], a[168:171], v[92:95], v[160:163]
    ds_read_b128 a[128:131], v1 offset:49152
    v_cvt_pk_bf16_f32 v186, v164, v165
    v_mfma_f32_16x16x32_bf16 v[160:163], a[164:167], v[88:91], v[160:163]
    v_exp_f32 v167, v167
    v_mfma_f32_16x16x32_bf16 v[160:163], a[160:163], v[84:87], v[160:163]
    ds_read_b64_tr_b16 a[196:197], v5 offset:0
    v_mfma_f32_16x16x32_bf16 a[96:99], a[208:211], v[212:215], a[96:99]
    v_exp_f32 v168, v168
    v_mfma_f32_16x16x32_bf16 a[96:99], a[212:215], v[216:219], a[96:99]
    ds_read_b64_tr_b16 a[198:199], v5 offset:4096
    v_cvt_pk_bf16_f32 v187, v166, v167
    v_mfma_f32_16x16x32_bf16 a[100:103], a[212:215], v[224:227], a[100:103]
    v_exp_f32 v169, v169
    v_mfma_f32_16x16x32_bf16 a[100:103], a[208:211], v[220:223], a[100:103]
    ds_read_b128 a[132:135], v2 offset:49152
    v_cvt_pk_bf16_f32 v194, v168, v169
    v_mfma_f32_16x16x32_bf16 a[104:107], a[208:211], v[228:231], a[104:107]
    s_add_u32 m0, s34, 32768
    v_exp_f32 v170, v170
    v_mfma_f32_16x16x32_bf16 a[104:107], a[212:215], v[232:235], a[104:107]
    buffer_load_dwordx4 v13, s[8:11], s28 offen offset:0 lds
    v_mfma_f32_16x16x32_bf16 a[108:111], a[212:215], v[240:243], a[108:111]
    v_exp_f32 v171, v171
    v_mfma_f32_16x16x32_bf16 a[108:111], a[208:211], v[236:239], a[108:111]
    s_waitcnt lgkmcnt(6)
    v_mfma_f32_16x16x32_bf16 v[164:167], a[176:179], v[36:39], v[100:103]
    v_exp_f32 v172, v172
    v_mfma_f32_16x16x32_bf16 v[164:167], a[180:183], v[40:43], v[164:167]
    ds_read_b64_tr_b16 a[200:201], v6 offset:57344
    v_cvt_pk_bf16_f32 v195, v170, v171
    v_mfma_f32_16x16x32_bf16 v[164:167], a[184:187], v[44:47], v[164:167]
    v_exp_f32 v173, v173
    v_mfma_f32_16x16x32_bf16 v[164:167], a[188:191], v[48:51], v[164:167]
    ds_read_b64_tr_b16 a[202:203], v6 offset:61440
    v_mfma_f32_16x16x32_bf16 v[168:171], a[188:191], v[64:67], v[104:107]
    v_exp_f32 v174, v174
    v_mfma_f32_16x16x32_bf16 v[168:171], a[184:187], v[60:63], v[168:171]
    ds_read_b128 a[136:139], v3 offset:49152
    v_cvt_pk_bf16_f32 v202, v172, v173
    v_mfma_f32_16x16x32_bf16 v[168:171], a[180:183], v[56:59], v[168:171]
    v_exp_f32 v175, v175
    v_mfma_f32_16x16x32_bf16 v[168:171], a[176:179], v[52:55], v[168:171]
    ds_read_b64_tr_b16 a[204:205], v6 offset:0
    v_mfma_f32_16x16x32_bf16 a[112:115], a[216:219], v[212:215], a[112:115]
    v_exp_f32 v176, v176
    v_mfma_f32_16x16x32_bf16 a[112:115], a[220:223], v[216:219], a[112:115]
    ds_read_b64_tr_b16 a[206:207], v6 offset:4096
    v_cvt_pk_bf16_f32 v203, v174, v175
    v_mfma_f32_16x16x32_bf16 a[116:119], a[220:223], v[224:227], a[116:119]
    v_exp_f32 v177, v177
    v_mfma_f32_16x16x32_bf16 a[116:119], a[216:219], v[220:223], a[116:119]
    ds_read_b128 a[140:143], v4 offset:49152
    v_mfma_f32_16x16x32_bf16 a[120:123], a[216:219], v[228:231], a[120:123]
    v_exp_f32 v178, v178
    v_mfma_f32_16x16x32_bf16 a[120:123], a[220:223], v[232:235], a[120:123]
    v_cvt_pk_bf16_f32 v210, v176, v177
    v_mfma_f32_16x16x32_bf16 a[124:127], a[220:223], v[240:243], a[124:127]
    v_exp_f32 v179, v179
    v_mfma_f32_16x16x32_bf16 a[124:127], a[216:219], v[236:239], a[124:127]
    buffer_load_dwordx4 v14, s[8:11], s28 offen offset:1024 lds
    v_smfmac_f32_16x16x64_bf16 a[236:239], v[244:247], v[236:243], v248
    s_waitcnt lgkmcnt(6)
    v_mfma_f32_16x16x32_bf16 v[172:175], a[176:179], v[68:71], v[108:111]
    v_exp_f32 v116, v116
    v_mfma_f32_16x16x32_bf16 v[172:175], a[180:183], v[72:75], v[172:175]
    ds_read_b64_tr_b16 a[208:209], v7 offset:57344
    v_cvt_pk_bf16_f32 v211, v178, v179
    v_mfma_f32_16x16x32_bf16 v[172:175], a[184:187], v[76:79], v[172:175]
    v_exp_f32 v117, v117
    v_mfma_f32_16x16x32_bf16 v[172:175], a[188:191], v[80:83], v[172:175]
    ds_read_b64_tr_b16 a[210:211], v7 offset:61440
    v_mov_b32 v0, 1
    v_mfma_f32_16x16x32_bf16 v[176:179], a[188:191], v[96:99], v[112:115]
    v_exp_f32 v118, v118
    v_mfma_f32_16x16x32_bf16 v[176:179], a[184:187], v[92:95], v[176:179]
    ds_read_b128 a[144:147], v1 offset:53248
    v_cvt_pk_bf16_f32 v212, v116, v117
    v_mfma_f32_16x16x32_bf16 v[176:179], a[180:183], v[88:91], v[176:179]
    v_exp_f32 v119, v119
    v_mfma_f32_16x16x32_bf16 v[176:179], a[176:179], v[84:87], v[176:179]
    ds_read_b64_tr_b16 a[212:213], v7 offset:0
    v_mfma_f32_16x16x32_bf16 a[0:3], a[192:195], v[180:183], a[0:3]
    v_exp_f32 v120, v120
    v_mfma_f32_16x16x32_bf16 a[0:3], a[196:199], v[184:187], a[0:3]
    ds_read_b64_tr_b16 a[214:215], v7 offset:4096
    v_cvt_pk_bf16_f32 v213, v118, v119
    v_mfma_f32_16x16x32_bf16 a[4:7], a[196:199], v[192:195], a[4:7]
    v_exp_f32 v121, v121
    v_mfma_f32_16x16x32_bf16 a[4:7], a[192:195], v[188:191], a[4:7]
    ds_read_b128 a[148:151], v2 offset:53248
    v_cvt_pk_bf16_f32 v220, v120, v121
    v_mfma_f32_16x16x32_bf16 a[8:11], a[192:195], v[196:199], a[8:11]
    v_exp_f32 v122, v122
    v_mfma_f32_16x16x32_bf16 a[8:11], a[196:199], v[200:203], a[8:11]
    buffer_load_dwordx4 v15, s[8:11], s28 offen offset:2048 lds
    v_mfma_f32_16x16x32_bf16 a[12:15], a[196:199], v[208:211], a[12:15]
    v_exp_f32 v123, v123
    v_mfma_f32_16x16x32_bf16 a[12:15], a[192:195], v[204:207], a[12:15]
    s_waitcnt lgkmcnt(6)
    v_mfma_f32_16x16x32_bf16 v[116:119], a[128:131], v[36:39], v[100:103]
    v_exp_f32 v124, v124
    v_mfma_f32_16x16x32_bf16 v[116:119], a[132:135], v[40:43], v[116:119]
    ds_read_b64_tr_b16 a[216:217], v8 offset:57344
    v_cvt_pk_bf16_f32 v221, v122, v123
    v_mfma_f32_16x16x32_bf16 v[116:119], a[136:139], v[44:47], v[116:119]
    v_exp_f32 v125, v125
    v_mfma_f32_16x16x32_bf16 v[116:119], a[140:143], v[48:51], v[116:119]
    ds_read_b64_tr_b16 a[218:219], v8 offset:61440
    v_mfma_f32_16x16x32_bf16 v[120:123], a[140:143], v[64:67], v[104:107]
    v_exp_f32 v126, v126
    v_mfma_f32_16x16x32_bf16 v[120:123], a[136:139], v[60:63], v[120:123]
    ds_read_b128 a[152:155], v3 offset:53248
    v_cvt_pk_bf16_f32 v228, v124, v125
    v_mfma_f32_16x16x32_bf16 v[120:123], a[132:135], v[56:59], v[120:123]
    v_exp_f32 v127, v127
    v_mfma_f32_16x16x32_bf16 v[120:123], a[128:131], v[52:55], v[120:123]
    ds_read_b64_tr_b16 a[220:221], v8 offset:0
    v_mfma_f32_16x16x32_bf16 a[16:19], a[200:203], v[180:183], a[16:19]
    v_exp_f32 v128, v128
    v_mfma_f32_16x16x32_bf16 a[16:19], a[204:207], v[184:187], a[16:19]
    ds_read_b64_tr_b16 a[222:223], v8 offset:4096
    v_cvt_pk_bf16_f32 v229, v126, v127
    v_mfma_f32_16x16x32_bf16 a[20:23], a[204:207], v[192:195], a[20:23]
    v_exp_f32 v129, v129
    v_mfma_f32_16x16x32_bf16 a[20:23], a[200:203], v[188:191], a[20:23]
    ds_read_b128 a[156:159], v4 offset:53248
    v_mfma_f32_16x16x32_bf16 a[24:27], a[200:203], v[196:199], a[24:27]
    v_exp_f32 v130, v130
    v_mfma_f32_16x16x32_bf16 a[24:27], a[204:207], v[200:203], a[24:27]
    v_cvt_pk_bf16_f32 v236, v128, v129
    v_mfma_f32_16x16x32_bf16 a[28:31], a[204:207], v[208:211], a[28:31]
    v_exp_f32 v131, v131
    v_mfma_f32_16x16x32_bf16 a[28:31], a[200:203], v[204:207], a[28:31]
    buffer_load_dwordx4 v16, s[8:11], s28 offen offset:3072 lds
    v_smfmac_f32_16x16x64_bf16 a[224:227], v[244:247], v[180:187], v248
    s_waitcnt lgkmcnt(6)
    v_mfma_f32_16x16x32_bf16 v[124:127], a[128:131], v[68:71], v[108:111]
    v_exp_f32 v132, v132
    v_mfma_f32_16x16x32_bf16 v[124:127], a[132:135], v[72:75], v[124:127]
    ds_read_b64_tr_b16 a[192:193], v9 offset:57344
    v_cvt_pk_bf16_f32 v237, v130, v131
    v_mfma_f32_16x16x32_bf16 v[124:127], a[136:139], v[76:79], v[124:127]
    v_exp_f32 v133, v133
    v_mfma_f32_16x16x32_bf16 v[124:127], a[140:143], v[80:83], v[124:127]
    ds_read_b64_tr_b16 a[194:195], v9 offset:61440
    v_mfma_f32_16x16x32_bf16 v[128:131], a[140:143], v[96:99], v[112:115]
    v_exp_f32 v134, v134
    v_mfma_f32_16x16x32_bf16 v[128:131], a[136:139], v[92:95], v[128:131]
    ds_read_b128 a[160:163], v1 offset:57344
    v_cvt_pk_bf16_f32 v214, v132, v133
    v_mfma_f32_16x16x32_bf16 v[128:131], a[132:135], v[88:91], v[128:131]
    v_exp_f32 v135, v135
    v_mfma_f32_16x16x32_bf16 v[128:131], a[128:131], v[84:87], v[128:131]
    ds_read_b64_tr_b16 a[196:197], v9 offset:0
    v_mfma_f32_16x16x32_bf16 a[32:35], a[208:211], v[180:183], a[32:35]
    v_exp_f32 v136, v136
    v_mfma_f32_16x16x32_bf16 a[32:35], a[212:215], v[184:187], a[32:35]
    ds_read_b64_tr_b16 a[198:199], v9 offset:4096
    v_cvt_pk_bf16_f32 v215, v134, v135
    v_mfma_f32_16x16x32_bf16 a[36:39], a[212:215], v[192:195], a[36:39]
    v_exp_f32 v137, v137
    v_mfma_f32_16x16x32_bf16 a[36:39], a[208:211], v[188:191], a[36:39]
    ds_read_b128 a[164:167], v2 offset:57344
    v_cvt_pk_bf16_f32 v222, v136, v137
    v_mfma_f32_16x16x32_bf16 a[40:43], a[208:211], v[196:199], a[40:43]
    s_add_u32 s28, s28, 16384
    s_mov_b32 m0, s30
    v_exp_f32 v138, v138
    v_mfma_f32_16x16x32_bf16 a[40:43], a[212:215], v[200:203], a[40:43]
    buffer_load_dwordx4 v17, s[12:15], s29 offen offset:0 lds
    v_mfma_f32_16x16x32_bf16 a[44:47], a[212:215], v[208:211], a[44:47]
    v_exp_f32 v139, v139
    v_mfma_f32_16x16x32_bf16 a[44:47], a[208:211], v[204:207], a[44:47]
    s_waitcnt lgkmcnt(6)
    v_mfma_f32_16x16x32_bf16 v[132:135], a[144:147], v[36:39], v[100:103]
    v_exp_f32 v140, v140
    v_mfma_f32_16x16x32_bf16 v[132:135], a[148:151], v[40:43], v[132:135]
    ds_read_b64_tr_b16 a[200:201], v10 offset:57344
    v_cvt_pk_bf16_f32 v223, v138, v139
    v_mfma_f32_16x16x32_bf16 v[132:135], a[152:155], v[44:47], v[132:135]
    v_exp_f32 v141, v141
    v_mfma_f32_16x16x32_bf16 v[132:135], a[156:159], v[48:51], v[132:135]
    ds_read_b64_tr_b16 a[202:203], v10 offset:61440
    v_mfma_f32_16x16x32_bf16 v[136:139], a[156:159], v[64:67], v[104:107]
    v_exp_f32 v142, v142
    v_mfma_f32_16x16x32_bf16 v[136:139], a[152:155], v[60:63], v[136:139]
    ds_read_b128 a[168:171], v3 offset:57344
    v_cvt_pk_bf16_f32 v230, v140, v141
    v_mfma_f32_16x16x32_bf16 v[136:139], a[148:151], v[56:59], v[136:139]
    v_exp_f32 v143, v143
    v_mfma_f32_16x16x32_bf16 v[136:139], a[144:147], v[52:55], v[136:139]
    ds_read_b64_tr_b16 a[204:205], v10 offset:0
    v_mfma_f32_16x16x32_bf16 a[48:51], a[216:219], v[180:183], a[48:51]
    v_exp_f32 v144, v144
    v_mfma_f32_16x16x32_bf16 a[48:51], a[220:223], v[184:187], a[48:51]
    ds_read_b64_tr_b16 a[206:207], v10 offset:4096
    v_cvt_pk_bf16_f32 v231, v142, v143
    v_mfma_f32_16x16x32_bf16 a[52:55], a[220:223], v[192:195], a[52:55]
    v_exp_f32 v145, v145
    v_mfma_f32_16x16x32_bf16 a[52:55], a[216:219], v[188:191], a[52:55]
    ds_read_b128 a[172:175], v4 offset:57344
    v_mfma_f32_16x16x32_bf16 a[56:59], a[216:219], v[196:199], a[56:59]
    v_exp_f32 v146, v146
    v_mfma_f32_16x16x32_bf16 a[56:59], a[220:223], v[200:203], a[56:59]
    v_cvt_pk_bf16_f32 v238, v144, v145
    v_mfma_f32_16x16x32_bf16 a[60:63], a[220:223], v[208:211], a[60:63]
    v_exp_f32 v147, v147
    v_mfma_f32_16x16x32_bf16 a[60:63], a[216:219], v[204:207], a[60:63]
    buffer_load_dwordx4 v18, s[12:15], s29 offen offset:1024 lds
    v_smfmac_f32_16x16x64_bf16 a[228:231], v[244:247], v[188:195], v248
    s_waitcnt lgkmcnt(6)
    v_mfma_f32_16x16x32_bf16 v[140:143], a[144:147], v[68:71], v[108:111]
    v_exp_f32 v148, v148
    v_mfma_f32_16x16x32_bf16 v[140:143], a[148:151], v[72:75], v[140:143]
    ds_read_b64_tr_b16 a[208:209], v11 offset:57344
    v_cvt_pk_bf16_f32 v239, v146, v147
    v_mfma_f32_16x16x32_bf16 v[140:143], a[152:155], v[76:79], v[140:143]
    v_exp_f32 v149, v149
    v_mfma_f32_16x16x32_bf16 v[140:143], a[156:159], v[80:83], v[140:143]
    ds_read_b64_tr_b16 a[210:211], v11 offset:61440
    v_mfma_f32_16x16x32_bf16 v[144:147], a[156:159], v[96:99], v[112:115]
    v_exp_f32 v150, v150
    v_mfma_f32_16x16x32_bf16 v[144:147], a[152:155], v[92:95], v[144:147]
    ds_read_b128 a[176:179], v1 offset:61440
    v_cvt_pk_bf16_f32 v216, v148, v149
    v_mfma_f32_16x16x32_bf16 v[144:147], a[148:151], v[88:91], v[144:147]
    v_exp_f32 v151, v151
    v_mfma_f32_16x16x32_bf16 v[144:147], a[144:147], v[84:87], v[144:147]
    ds_read_b64_tr_b16 a[212:213], v11 offset:0
    v_mfma_f32_16x16x32_bf16 a[64:67], a[192:195], v[180:183], a[64:67]
    v_exp_f32 v152, v152
    v_mfma_f32_16x16x32_bf16 a[64:67], a[196:199], v[184:187], a[64:67]
    ds_read_b64_tr_b16 a[214:215], v11 offset:4096
    v_cvt_pk_bf16_f32 v217, v150, v151
    v_mfma_f32_16x16x32_bf16 a[68:71], a[196:199], v[192:195], a[68:71]
    v_exp_f32 v153, v153
    v_mfma_f32_16x16x32_bf16 a[68:71], a[192:195], v[188:191], a[68:71]
    ds_read_b128 a[180:183], v2 offset:61440
    v_cvt_pk_bf16_f32 v224, v152, v153
    v_mfma_f32_16x16x32_bf16 a[72:75], a[192:195], v[196:199], a[72:75]
    v_exp_f32 v154, v154
    v_mfma_f32_16x16x32_bf16 a[72:75], a[196:199], v[200:203], a[72:75]
    buffer_load_dwordx4 v17, s[12:15], s29 offen offset:2048 lds
    v_mfma_f32_16x16x32_bf16 a[76:79], a[196:199], v[208:211], a[76:79]
    v_exp_f32 v155, v155
    v_mfma_f32_16x16x32_bf16 a[76:79], a[192:195], v[204:207], a[76:79]
    s_waitcnt lgkmcnt(6)
    v_mfma_f32_16x16x32_bf16 v[148:151], a[160:163], v[36:39], v[100:103]
    v_exp_f32 v156, v156
    v_mfma_f32_16x16x32_bf16 v[148:151], a[164:167], v[40:43], v[148:151]
    ds_read_b64_tr_b16 a[216:217], v12 offset:57344
    v_cvt_pk_bf16_f32 v225, v154, v155
    v_mfma_f32_16x16x32_bf16 v[148:151], a[168:171], v[44:47], v[148:151]
    v_exp_f32 v157, v157
    v_mfma_f32_16x16x32_bf16 v[148:151], a[172:175], v[48:51], v[148:151]
    ds_read_b64_tr_b16 a[218:219], v12 offset:61440
    v_mfma_f32_16x16x32_bf16 v[152:155], a[172:175], v[64:67], v[104:107]
    v_exp_f32 v158, v158
    v_mfma_f32_16x16x32_bf16 v[152:155], a[168:171], v[60:63], v[152:155]
    ds_read_b128 a[184:187], v3 offset:61440
    v_cvt_pk_bf16_f32 v232, v156, v157
    v_mfma_f32_16x16x32_bf16 v[152:155], a[164:167], v[56:59], v[152:155]
    v_exp_f32 v159, v159
    v_mfma_f32_16x16x32_bf16 v[152:155], a[160:163], v[52:55], v[152:155]
    ds_read_b64_tr_b16 a[220:221], v12 offset:0
    v_mfma_f32_16x16x32_bf16 a[80:83], a[200:203], v[180:183], a[80:83]
    v_exp_f32 v160, v160
    v_mfma_f32_16x16x32_bf16 a[80:83], a[204:207], v[184:187], a[80:83]
    ds_read_b64_tr_b16 a[222:223], v12 offset:4096
    v_cvt_pk_bf16_f32 v233, v158, v159
    v_mfma_f32_16x16x32_bf16 a[84:87], a[204:207], v[192:195], a[84:87]
    v_exp_f32 v161, v161
    v_mfma_f32_16x16x32_bf16 a[84:87], a[200:203], v[188:191], a[84:87]
    ds_read_b128 a[188:191], v4 offset:61440
    v_mfma_f32_16x16x32_bf16 a[88:91], a[200:203], v[196:199], a[88:91]
    v_exp_f32 v162, v162
    v_mfma_f32_16x16x32_bf16 a[88:91], a[204:207], v[200:203], a[88:91]
    v_cvt_pk_bf16_f32 v240, v160, v161
    v_mfma_f32_16x16x32_bf16 a[92:95], a[204:207], v[208:211], a[92:95]
    v_exp_f32 v163, v163
    v_mfma_f32_16x16x32_bf16 a[92:95], a[200:203], v[204:207], a[92:95]
    buffer_load_dwordx4 v18, s[12:15], s29 offen offset:3072 lds
    v_smfmac_f32_16x16x64_bf16 a[232:235], v[244:247], v[196:203], v248
    s_waitcnt vmcnt(8) lgkmcnt(6)
    s_barrier
    s_add_u32 s29, s29, 16384
    v_mfma_f32_16x16x32_bf16 v[156:159], a[160:163], v[68:71], v[108:111]
    v_exp_f32 v164, v164
    v_mfma_f32_16x16x32_bf16 v[156:159], a[164:167], v[72:75], v[156:159]
    ds_read_b64_tr_b16 a[192:193], v5 offset:24576
    v_cvt_pk_bf16_f32 v241, v162, v163
    v_mfma_f32_16x16x32_bf16 v[156:159], a[168:171], v[76:79], v[156:159]
    v_exp_f32 v165, v165
    v_mfma_f32_16x16x32_bf16 v[156:159], a[172:175], v[80:83], v[156:159]
    ds_read_b64_tr_b16 a[194:195], v5 offset:28672
    v_mfma_f32_16x16x32_bf16 v[160:163], a[172:175], v[96:99], v[112:115]
    v_exp_f32 v166, v166
    v_mfma_f32_16x16x32_bf16 v[160:163], a[168:171], v[92:95], v[160:163]
    ds_read_b128 a[128:131], v1 offset:16384
    v_cvt_pk_bf16_f32 v218, v164, v165
    v_mfma_f32_16x16x32_bf16 v[160:163], a[164:167], v[88:91], v[160:163]
    v_exp_f32 v167, v167
    v_mfma_f32_16x16x32_bf16 v[160:163], a[160:163], v[84:87], v[160:163]
    ds_read_b64_tr_b16 a[196:197], v5 offset:49152
    v_mfma_f32_16x16x32_bf16 a[96:99], a[208:211], v[180:183], a[96:99]
    v_exp_f32 v168, v168
    v_mfma_f32_16x16x32_bf16 a[96:99], a[212:215], v[184:187], a[96:99]
    ds_read_b64_tr_b16 a[198:199], v5 offset:53248
    v_cvt_pk_bf16_f32 v219, v166, v167
    v_mfma_f32_16x16x32_bf16 a[100:103], a[212:215], v[192:195], a[100:103]
    v_exp_f32 v169, v169
    v_mfma_f32_16x16x32_bf16 a[100:103], a[208:211], v[188:191], a[100:103]
    ds_read_b128 a[132:135], v2 offset:16384
    v_cvt_pk_bf16_f32 v226, v168, v169
    v_mfma_f32_16x16x32_bf16 a[104:107], a[208:211], v[196:199], a[104:107]
    s_add_u32 m0, s34, 0
    v_exp_f32 v170, v170
    v_mfma_f32_16x16x32_bf16 a[104:107], a[212:215], v[200:203], a[104:107]
    buffer_load_dwordx4 v13, s[8:11], s28 offen offset:0 lds
    v_mfma_f32_16x16x32_bf16 a[108:111], a[212:215], v[208:211], a[108:111]
    v_exp_f32 v171, v171
    v_mfma_f32_16x16x32_bf16 a[108:111], a[208:211], v[204:207], a[108:111]
    s_waitcnt lgkmcnt(6)
    s_cmp_lg_u32 s5, 0
    s_cbranch_scc1 L_ffn_flagged
    s_mov_b64 exec, 1
    buffer_store_dword v0, off, s[76:79], s75 sc1
    s_mov_b64 exec, -1
L_ffn_flagged:
    v_mfma_f32_16x16x32_bf16 v[164:167], a[176:179], v[36:39], v[100:103]
    v_exp_f32 v172, v172
    v_mfma_f32_16x16x32_bf16 v[164:167], a[180:183], v[40:43], v[164:167]
    ds_read_b64_tr_b16 a[200:201], v6 offset:24576
    v_cvt_pk_bf16_f32 v227, v170, v171
    v_mfma_f32_16x16x32_bf16 v[164:167], a[184:187], v[44:47], v[164:167]
    v_exp_f32 v173, v173
    v_mfma_f32_16x16x32_bf16 v[164:167], a[188:191], v[48:51], v[164:167]
    ds_read_b64_tr_b16 a[202:203], v6 offset:28672
    v_mfma_f32_16x16x32_bf16 v[168:171], a[188:191], v[64:67], v[104:107]
    v_exp_f32 v174, v174
    v_mfma_f32_16x16x32_bf16 v[168:171], a[184:187], v[60:63], v[168:171]
    ds_read_b128 a[136:139], v3 offset:16384
    v_cvt_pk_bf16_f32 v234, v172, v173
    v_mfma_f32_16x16x32_bf16 v[168:171], a[180:183], v[56:59], v[168:171]
    v_exp_f32 v175, v175
    v_mfma_f32_16x16x32_bf16 v[168:171], a[176:179], v[52:55], v[168:171]
    ds_read_b64_tr_b16 a[204:205], v6 offset:49152
    v_mfma_f32_16x16x32_bf16 a[112:115], a[216:219], v[180:183], a[112:115]
    v_exp_f32 v176, v176
    v_mfma_f32_16x16x32_bf16 a[112:115], a[220:223], v[184:187], a[112:115]
    ds_read_b64_tr_b16 a[206:207], v6 offset:53248
    v_cvt_pk_bf16_f32 v235, v174, v175
    v_mfma_f32_16x16x32_bf16 a[116:119], a[220:223], v[192:195], a[116:119]
    v_exp_f32 v177, v177
    v_mfma_f32_16x16x32_bf16 a[116:119], a[216:219], v[188:191], a[116:119]
    ds_read_b128 a[140:143], v4 offset:16384
    v_mfma_f32_16x16x32_bf16 a[120:123], a[216:219], v[196:199], a[120:123]
    v_exp_f32 v178, v178
    v_mfma_f32_16x16x32_bf16 a[120:123], a[220:223], v[200:203], a[120:123]
    v_cvt_pk_bf16_f32 v242, v176, v177
    v_mfma_f32_16x16x32_bf16 a[124:127], a[220:223], v[208:211], a[124:127]
    v_exp_f32 v179, v179
    v_mfma_f32_16x16x32_bf16 a[124:127], a[216:219], v[204:207], a[124:127]
    buffer_load_dwordx4 v14, s[8:11], s28 offen offset:1024 lds
    v_smfmac_f32_16x16x64_bf16 a[236:239], v[244:247], v[204:211], v248
    s_waitcnt lgkmcnt(6)
    v_mfma_f32_16x16x32_bf16 v[172:175], a[176:179], v[68:71], v[108:111]
    s_mul_i32 s46, s5, 10240
    v_exp_f32 v116, v116
    v_mfma_f32_16x16x32_bf16 v[172:175], a[180:183], v[72:75], v[172:175]
    s_lshl_b32 s40, s100, 1
    ds_read_b64_tr_b16 a[208:209], v7 offset:24576
    v_cvt_pk_bf16_f32 v243, v178, v179
    v_mfma_f32_16x16x32_bf16 v[172:175], a[184:187], v[76:79], v[172:175]
    s_add_u32 s40, s40, s47
    v_exp_f32 v117, v117
    v_mfma_f32_16x16x32_bf16 v[172:175], a[188:191], v[80:83], v[172:175]
    s_mul_i32 s40, s40, 327680
    ds_read_b64_tr_b16 a[210:211], v7 offset:28672
    v_mfma_f32_16x16x32_bf16 v[176:179], a[188:191], v[96:99], v[112:115]
    s_add_u32 s40, s40, 0x1400000
    v_exp_f32 v118, v118
    v_mfma_f32_16x16x32_bf16 v[176:179], a[184:187], v[92:95], v[176:179]
    s_add_u32 s20, s72, s40
    s_addc_u32 s21, s73, 0
    ds_read_b128 a[144:147], v1 offset:20480
    v_cvt_pk_bf16_f32 v180, v116, v117
    v_mfma_f32_16x16x32_bf16 v[176:179], a[180:183], v[88:91], v[176:179]
    s_mov_b32 s22, 0x50000
    v_exp_f32 v119, v119
    v_mfma_f32_16x16x32_bf16 v[176:179], a[176:179], v[84:87], v[176:179]
    s_mov_b32 s23, 0x20000
    ds_read_b64_tr_b16 a[212:213], v7 offset:49152
    v_mfma_f32_16x16x32_bf16 a[0:3], a[192:195], v[212:215], a[0:3]
    s_mul_i32 s40, s5, 5120
    v_exp_f32 v120, v120
    v_mfma_f32_16x16x32_bf16 a[0:3], a[196:199], v[216:219], a[0:3]
    ds_read_b64_tr_b16 a[214:215], v7 offset:53248
    v_cvt_pk_bf16_f32 v181, v118, v119
    v_mfma_f32_16x16x32_bf16 a[4:7], a[196:199], v[224:227], a[4:7]
    v_exp_f32 v121, v121
    v_mfma_f32_16x16x32_bf16 a[4:7], a[192:195], v[220:223], a[4:7]
    ds_read_b128 a[148:151], v2 offset:20480
    v_cvt_pk_bf16_f32 v188, v120, v121
    v_mfma_f32_16x16x32_bf16 a[8:11], a[192:195], v[228:231], a[8:11]
    v_exp_f32 v122, v122
    v_mfma_f32_16x16x32_bf16 a[8:11], a[196:199], v[232:235], a[8:11]
    buffer_load_dwordx4 v15, s[8:11], s28 offen offset:2048 lds
    v_mfma_f32_16x16x32_bf16 a[12:15], a[196:199], v[240:243], a[12:15]
    v_exp_f32 v123, v123
    v_mfma_f32_16x16x32_bf16 a[12:15], a[192:195], v[236:239], a[12:15]
    s_waitcnt lgkmcnt(6)
    v_lshl_add_u32 v254, v19, 4, s40
    v_mfma_f32_16x16x32_bf16 v[116:119], a[128:131], v[36:39], v[100:103]
    v_exp_f32 v124, v124
    v_mfma_f32_16x16x32_bf16 v[116:119], a[132:135], v[40:43], v[116:119]
    ds_read_b64_tr_b16 a[216:217], v8 offset:24576
    v_cvt_pk_bf16_f32 v189, v122, v123
    v_mfma_f32_16x16x32_bf16 v[116:119], a[136:139], v[44:47], v[116:119]
    v_exp_f32 v125, v125
    v_mfma_f32_16x16x32_bf16 v[116:119], a[140:143], v[48:51], v[116:119]
    ds_read_b64_tr_b16 a[218:219], v8 offset:28672
    v_mfma_f32_16x16x32_bf16 v[120:123], a[140:143], v[64:67], v[104:107]
    v_exp_f32 v126, v126
    v_mfma_f32_16x16x32_bf16 v[120:123], a[136:139], v[60:63], v[120:123]
    ds_read_b128 a[152:155], v3 offset:20480
    v_cvt_pk_bf16_f32 v196, v124, v125
    v_mfma_f32_16x16x32_bf16 v[120:123], a[132:135], v[56:59], v[120:123]
    v_exp_f32 v127, v127
    v_mfma_f32_16x16x32_bf16 v[120:123], a[128:131], v[52:55], v[120:123]
    ds_read_b64_tr_b16 a[220:221], v8 offset:49152
    v_mfma_f32_16x16x32_bf16 a[16:19], a[200:203], v[212:215], a[16:19]
    v_exp_f32 v128, v128
    v_mfma_f32_16x16x32_bf16 a[16:19], a[204:207], v[216:219], a[16:19]
    ds_read_b64_tr_b16 a[222:223], v8 offset:53248
    v_cvt_pk_bf16_f32 v197, v126, v127
    v_mfma_f32_16x16x32_bf16 a[20:23], a[204:207], v[224:227], a[20:23]
    v_exp_f32 v129, v129
    v_mfma_f32_16x16x32_bf16 a[20:23], a[200:203], v[220:223], a[20:23]
    ds_read_b128 a[156:159], v4 offset:20480
    v_mfma_f32_16x16x32_bf16 a[24:27], a[200:203], v[228:231], a[24:27]
    v_exp_f32 v130, v130
    v_mfma_f32_16x16x32_bf16 a[24:27], a[204:207], v[232:235], a[24:27]
    v_cvt_pk_bf16_f32 v204, v128, v129
    v_mfma_f32_16x16x32_bf16 a[28:31], a[204:207], v[240:243], a[28:31]
    v_exp_f32 v131, v131
    v_mfma_f32_16x16x32_bf16 a[28:31], a[200:203], v[236:239], a[28:31]
    buffer_load_dwordx4 v16, s[8:11], s28 offen offset:3072 lds
    v_smfmac_f32_16x16x64_bf16 a[224:227], v[244:247], v[212:219], v248
    s_waitcnt lgkmcnt(6)
    v_mfma_f32_16x16x32_bf16 v[124:127], a[128:131], v[68:71], v[108:111]
    v_exp_f32 v132, v132
    v_mfma_f32_16x16x32_bf16 v[124:127], a[132:135], v[72:75], v[124:127]
    ds_read_b64_tr_b16 a[192:193], v9 offset:24576
    v_cvt_pk_bf16_f32 v205, v130, v131
    v_mfma_f32_16x16x32_bf16 v[124:127], a[136:139], v[76:79], v[124:127]
    v_exp_f32 v133, v133
    v_mfma_f32_16x16x32_bf16 v[124:127], a[140:143], v[80:83], v[124:127]
    ds_read_b64_tr_b16 a[194:195], v9 offset:28672
    v_mfma_f32_16x16x32_bf16 v[128:131], a[140:143], v[96:99], v[112:115]
    v_exp_f32 v134, v134
    v_mfma_f32_16x16x32_bf16 v[128:131], a[136:139], v[92:95], v[128:131]
    ds_read_b128 a[160:163], v1 offset:24576
    v_cvt_pk_bf16_f32 v182, v132, v133
    v_mfma_f32_16x16x32_bf16 v[128:131], a[132:135], v[88:91], v[128:131]
    v_exp_f32 v135, v135
    v_mfma_f32_16x16x32_bf16 v[128:131], a[128:131], v[84:87], v[128:131]
    ds_read_b64_tr_b16 a[196:197], v9 offset:49152
    v_mfma_f32_16x16x32_bf16 a[32:35], a[208:211], v[212:215], a[32:35]
    v_exp_f32 v136, v136
    v_mfma_f32_16x16x32_bf16 a[32:35], a[212:215], v[216:219], a[32:35]
    ds_read_b64_tr_b16 a[198:199], v9 offset:53248
    v_cvt_pk_bf16_f32 v183, v134, v135
    v_mfma_f32_16x16x32_bf16 a[36:39], a[212:215], v[224:227], a[36:39]
    v_exp_f32 v137, v137
    v_mfma_f32_16x16x32_bf16 a[36:39], a[208:211], v[220:223], a[36:39]
    ds_read_b128 a[164:167], v2 offset:24576
    v_cvt_pk_bf16_f32 v190, v136, v137
    v_mfma_f32_16x16x32_bf16 a[40:43], a[208:211], v[228:231], a[40:43]
    s_add_u32 s28, s28, 16384
    s_mov_b32 m0, s31
    v_exp_f32 v138, v138
    v_mfma_f32_16x16x32_bf16 a[40:43], a[212:215], v[232:235], a[40:43]
    buffer_load_dwordx4 v17, s[12:15], s29 offen offset:0 lds
    v_mfma_f32_16x16x32_bf16 a[44:47], a[212:215], v[240:243], a[44:47]
    v_exp_f32 v139, v139
    v_mfma_f32_16x16x32_bf16 a[44:47], a[208:211], v[236:239], a[44:47]
    s_waitcnt lgkmcnt(6)
    v_mfma_f32_16x16x32_bf16 v[132:135], a[144:147], v[36:39], v[100:103]
    v_exp_f32 v140, v140
    v_mfma_f32_16x16x32_bf16 v[132:135], a[148:151], v[40:43], v[132:135]
    ds_read_b64_tr_b16 a[200:201], v10 offset:24576
    v_cvt_pk_bf16_f32 v191, v138, v139
    v_mfma_f32_16x16x32_bf16 v[132:135], a[152:155], v[44:47], v[132:135]
    v_exp_f32 v141, v141
    v_mfma_f32_16x16x32_bf16 v[132:135], a[156:159], v[48:51], v[132:135]
    ds_read_b64_tr_b16 a[202:203], v10 offset:28672
    v_mfma_f32_16x16x32_bf16 v[136:139], a[156:159], v[64:67], v[104:107]
    v_exp_f32 v142, v142
    v_mfma_f32_16x16x32_bf16 v[136:139], a[152:155], v[60:63], v[136:139]
    ds_read_b128 a[168:171], v3 offset:24576
    v_cvt_pk_bf16_f32 v198, v140, v141
    v_mfma_f32_16x16x32_bf16 v[136:139], a[148:151], v[56:59], v[136:139]
    v_exp_f32 v143, v143
    v_mfma_f32_16x16x32_bf16 v[136:139], a[144:147], v[52:55], v[136:139]
    ds_read_b64_tr_b16 a[204:205], v10 offset:49152
    v_mfma_f32_16x16x32_bf16 a[48:51], a[216:219], v[212:215], a[48:51]
    v_exp_f32 v144, v144
    v_mfma_f32_16x16x32_bf16 a[48:51], a[220:223], v[216:219], a[48:51]
    ds_read_b64_tr_b16 a[206:207], v10 offset:53248
    v_cvt_pk_bf16_f32 v199, v142, v143
    v_mfma_f32_16x16x32_bf16 a[52:55], a[220:223], v[224:227], a[52:55]
    v_exp_f32 v145, v145
    v_mfma_f32_16x16x32_bf16 a[52:55], a[216:219], v[220:223], a[52:55]
    ds_read_b128 a[172:175], v4 offset:24576
    v_mfma_f32_16x16x32_bf16 a[56:59], a[216:219], v[228:231], a[56:59]
    v_exp_f32 v146, v146
    v_mfma_f32_16x16x32_bf16 a[56:59], a[220:223], v[232:235], a[56:59]
    v_cvt_pk_bf16_f32 v206, v144, v145
    v_mfma_f32_16x16x32_bf16 a[60:63], a[220:223], v[240:243], a[60:63]
    v_exp_f32 v147, v147
    v_mfma_f32_16x16x32_bf16 a[60:63], a[216:219], v[236:239], a[60:63]
    buffer_load_dwordx4 v18, s[12:15], s29 offen offset:1024 lds
    v_smfmac_f32_16x16x64_bf16 a[228:231], v[244:247], v[220:227], v248
    s_waitcnt lgkmcnt(6)
    v_mfma_f32_16x16x32_bf16 v[140:143], a[144:147], v[68:71], v[108:111]
    v_exp_f32 v148, v148
    v_mfma_f32_16x16x32_bf16 v[140:143], a[148:151], v[72:75], v[140:143]
    ds_read_b64_tr_b16 a[208:209], v11 offset:24576
    v_cvt_pk_bf16_f32 v207, v146, v147
    v_mfma_f32_16x16x32_bf16 v[140:143], a[152:155], v[76:79], v[140:143]
    v_exp_f32 v149, v149
    v_mfma_f32_16x16x32_bf16 v[140:143], a[156:159], v[80:83], v[140:143]
    ds_read_b64_tr_b16 a[210:211], v11 offset:28672
    v_mfma_f32_16x16x32_bf16 v[144:147], a[156:159], v[96:99], v[112:115]
    v_exp_f32 v150, v150
    v_mfma_f32_16x16x32_bf16 v[144:147], a[152:155], v[92:95], v[144:147]
    ds_read_b128 a[176:179], v1 offset:28672
    v_cvt_pk_bf16_f32 v184, v148, v149
    v_mfma_f32_16x16x32_bf16 v[144:147], a[148:151], v[88:91], v[144:147]
    v_exp_f32 v151, v151
    v_mfma_f32_16x16x32_bf16 v[144:147], a[144:147], v[84:87], v[144:147]
    ds_read_b64_tr_b16 a[212:213], v11 offset:49152
    v_mfma_f32_16x16x32_bf16 a[64:67], a[192:195], v[212:215], a[64:67]
    v_exp_f32 v152, v152
    v_mfma_f32_16x16x32_bf16 a[64:67], a[196:199], v[216:219], a[64:67]
    ds_read_b64_tr_b16 a[214:215], v11 offset:53248
    v_cvt_pk_bf16_f32 v185, v150, v151
    v_mfma_f32_16x16x32_bf16 a[68:71], a[196:199], v[224:227], a[68:71]
    v_exp_f32 v153, v153
    v_mfma_f32_16x16x32_bf16 a[68:71], a[192:195], v[220:223], a[68:71]
    ds_read_b128 a[180:183], v2 offset:28672
    v_cvt_pk_bf16_f32 v192, v152, v153
    v_mfma_f32_16x16x32_bf16 a[72:75], a[192:195], v[228:231], a[72:75]
    v_exp_f32 v154, v154
    v_mfma_f32_16x16x32_bf16 a[72:75], a[196:199], v[232:235], a[72:75]
    buffer_load_dwordx4 v17, s[12:15], s29 offen offset:2048 lds
    v_mfma_f32_16x16x32_bf16 a[76:79], a[196:199], v[240:243], a[76:79]
    v_exp_f32 v155, v155
    v_mfma_f32_16x16x32_bf16 a[76:79], a[192:195], v[236:239], a[76:79]
    s_waitcnt lgkmcnt(6)
    v_mfma_f32_16x16x32_bf16 v[148:151], a[160:163], v[36:39], v[100:103]
    v_exp_f32 v156, v156
    v_mfma_f32_16x16x32_bf16 v[148:151], a[164:167], v[40:43], v[148:151]
    ds_read_b64_tr_b16 a[216:217], v12 offset:24576
    v_cvt_pk_bf16_f32 v193, v154, v155
    v_mfma_f32_16x16x32_bf16 v[148:151], a[168:171], v[44:47], v[148:151]
    v_exp_f32 v157, v157
    v_mfma_f32_16x16x32_bf16 v[148:151], a[172:175], v[48:51], v[148:151]
    ds_read_b64_tr_b16 a[218:219], v12 offset:28672
    v_mfma_f32_16x16x32_bf16 v[152:155], a[172:175], v[64:67], v[104:107]
    v_exp_f32 v158, v158
    v_mfma_f32_16x16x32_bf16 v[152:155], a[168:171], v[60:63], v[152:155]
    ds_read_b128 a[184:187], v3 offset:28672
    v_cvt_pk_bf16_f32 v200, v156, v157
    v_mfma_f32_16x16x32_bf16 v[152:155], a[164:167], v[56:59], v[152:155]
    v_exp_f32 v159, v159
    v_mfma_f32_16x16x32_bf16 v[152:155], a[160:163], v[52:55], v[152:155]
    ds_read_b64_tr_b16 a[220:221], v12 offset:49152
    v_mfma_f32_16x16x32_bf16 a[80:83], a[200:203], v[212:215], a[80:83]
    v_exp_f32 v160, v160
    v_mfma_f32_16x16x32_bf16 a[80:83], a[204:207], v[216:219], a[80:83]
    ds_read_b64_tr_b16 a[222:223], v12 offset:53248
    v_cvt_pk_bf16_f32 v201, v158, v159
    v_mfma_f32_16x16x32_bf16 a[84:87], a[204:207], v[224:227], a[84:87]
    v_exp_f32 v161, v161
    v_mfma_f32_16x16x32_bf16 a[84:87], a[200:203], v[220:223], a[84:87]
    ds_read_b128 a[188:191], v4 offset:28672
    v_mfma_f32_16x16x32_bf16 a[88:91], a[200:203], v[228:231], a[88:91]
    v_exp_f32 v162, v162
    v_mfma_f32_16x16x32_bf16 a[88:91], a[204:207], v[232:235], a[88:91]
    v_cvt_pk_bf16_f32 v208, v160, v161
    v_mfma_f32_16x16x32_bf16 a[92:95], a[204:207], v[240:243], a[92:95]
    v_exp_f32 v163, v163
    v_mfma_f32_16x16x32_bf16 a[92:95], a[200:203], v[236:239], a[92:95]
    buffer_load_dwordx4 v18, s[12:15], s29 offen offset:3072 lds
    v_smfmac_f32_16x16x64_bf16 a[232:235], v[244:247], v[228:235], v248
    s_waitcnt vmcnt(8) lgkmcnt(6)
    s_barrier
    s_add_u32 s29, s29, 16384
    v_mfma_f32_16x16x32_bf16 v[156:159], a[160:163], v[68:71], v[108:111]
    v_exp_f32 v164, v164
    v_mfma_f32_16x16x32_bf16 v[156:159], a[164:167], v[72:75], v[156:159]
    ds_read_b64_tr_b16 a[192:193], v5 offset:8192
    v_cvt_pk_bf16_f32 v209, v162, v163
    v_mfma_f32_16x16x32_bf16 v[156:159], a[168:171], v[76:79], v[156:159]
    v_exp_f32 v165, v165
    v_mfma_f32_16x16x32_bf16 v[156:159], a[172:175], v[80:83], v[156:159]
    ds_read_b64_tr_b16 a[194:195], v5 offset:12288
    v_mfma_f32_16x16x32_bf16 v[160:163], a[172:175], v[96:99], v[112:115]
    v_exp_f32 v166, v166
    v_mfma_f32_16x16x32_bf16 v[160:163], a[168:171], v[92:95], v[160:163]
    ds_read_b128 a[128:131], v1 offset:32768
    v_cvt_pk_bf16_f32 v186, v164, v165
    v_mfma_f32_16x16x32_bf16 v[160:163], a[164:167], v[88:91], v[160:163]
    v_exp_f32 v167, v167
    v_mfma_f32_16x16x32_bf16 v[160:163], a[160:163], v[84:87], v[160:163]
    ds_read_b64_tr_b16 a[196:197], v5 offset:32768
    v_mfma_f32_16x16x32_bf16 a[96:99], a[208:211], v[212:215], a[96:99]
    v_exp_f32 v168, v168
    v_mfma_f32_16x16x32_bf16 a[96:99], a[212:215], v[216:219], a[96:99]
    ds_read_b64_tr_b16 a[198:199], v5 offset:36864
    v_cvt_pk_bf16_f32 v187, v166, v167
    v_mfma_f32_16x16x32_bf16 a[100:103], a[212:215], v[224:227], a[100:103]
    v_exp_f32 v169, v169
    v_mfma_f32_16x16x32_bf16 a[100:103], a[208:211], v[220:223], a[100:103]
    ds_read_b128 a[132:135], v2 offset:32768
    v_cvt_pk_bf16_f32 v194, v168, v169
    v_mfma_f32_16x16x32_bf16 a[104:107], a[208:211], v[228:231], a[104:107]
    s_mov_b32 m0, s32
    v_exp_f32 v170, v170
    v_mfma_f32_16x16x32_bf16 a[104:107], a[212:215], v[232:235], a[104:107]
    buffer_load_dwordx4 v17, s[12:15], s29 offen offset:0 lds
    v_mfma_f32_16x16x32_bf16 a[108:111], a[212:215], v[240:243], a[108:111]
    v_exp_f32 v171, v171
    v_mfma_f32_16x16x32_bf16 a[108:111], a[208:211], v[236:239], a[108:111]
    s_waitcnt lgkmcnt(6)
    v_mfma_f32_16x16x32_bf16 v[164:167], a[176:179], v[36:39], v[100:103]
    v_exp_f32 v172, v172
    v_mfma_f32_16x16x32_bf16 v[164:167], a[180:183], v[40:43], v[164:167]
    ds_read_b64_tr_b16 a[200:201], v6 offset:8192
    v_cvt_pk_bf16_f32 v195, v170, v171
    v_mfma_f32_16x16x32_bf16 v[164:167], a[184:187], v[44:47], v[164:167]
    v_exp_f32 v173, v173
    v_mfma_f32_16x16x32_bf16 v[164:167], a[188:191], v[48:51], v[164:167]
    ds_read_b64_tr_b16 a[202:203], v6 offset:12288
    v_lshlrev_b32 v32, 7, v19
    v_mfma_f32_16x16x32_bf16 v[168:171], a[188:191], v[64:67], v[104:107]
    v_exp_f32 v174, v174
    v_mfma_f32_16x16x32_bf16 v[168:171], a[184:187], v[60:63], v[168:171]
    ds_read_b128 a[136:139], v3 offset:32768
    v_cvt_pk_bf16_f32 v202, v172, v173
    v_mfma_f32_16x16x32_bf16 v[168:171], a[180:183], v[56:59], v[168:171]
    v_exp_f32 v175, v175
    v_mfma_f32_16x16x32_bf16 v[168:171], a[176:179], v[52:55], v[168:171]
    ds_read_b64_tr_b16 a[204:205], v6 offset:32768
    v_add_u32 v32, 0x290000, v32
    v_mfma_f32_16x16x32_bf16 a[112:115], a[216:219], v[212:215], a[112:115]
    v_exp_f32 v176, v176
    v_mfma_f32_16x16x32_bf16 a[112:115], a[220:223], v[216:219], a[112:115]
    ds_read_b64_tr_b16 a[206:207], v6 offset:36864
    v_cvt_pk_bf16_f32 v203, v174, v175
    v_mfma_f32_16x16x32_bf16 a[116:119], a[220:223], v[224:227], a[116:119]
    v_exp_f32 v177, v177
    v_mfma_f32_16x16x32_bf16 a[116:119], a[216:219], v[220:223], a[116:119]
    ds_read_b128 a[140:143], v4 offset:32768
    v_mfma_f32_16x16x32_bf16 a[120:123], a[216:219], v[228:231], a[120:123]
    v_exp_f32 v178, v178
    v_mfma_f32_16x16x32_bf16 a[120:123], a[220:223], v[232:235], a[120:123]
    v_cvt_pk_bf16_f32 v210, v176, v177
    v_mfma_f32_16x16x32_bf16 a[124:127], a[220:223], v[240:243], a[124:127]
    v_exp_f32 v179, v179
    v_mfma_f32_16x16x32_bf16 a[124:127], a[216:219], v[236:239], a[124:127]
    buffer_load_dwordx4 v18, s[12:15], s29 offen offset:1024 lds
    v_smfmac_f32_16x16x64_bf16 a[236:239], v[244:247], v[236:243], v248
    s_waitcnt lgkmcnt(6)
    s_cmp_lg_u32 s5, 0
    s_cbranch_scc1 L_no_ask
    buffer_load_dwordx4 v[28:31], v32, s[76:79], 0 offen sc1
L_no_ask:
    v_mfma_f32_16x16x32_bf16 v[172:175], a[176:179], v[68:71], v[108:111]
    v_exp_f32 v116, v116
    v_mfma_f32_16x16x32_bf16 v[172:175], a[180:183], v[72:75], v[172:175]
    ds_read_b64_tr_b16 a[208:209], v7 offset:8192
    v_cvt_pk_bf16_f32 v211, v178, v179
    v_mfma_f32_16x16x32_bf16 v[172:175], a[184:187], v[76:79], v[172:175]
    v_exp_f32 v117, v117
    v_mfma_f32_16x16x32_bf16 v[172:175], a[188:191], v[80:83], v[172:175]
    ds_read_b64_tr_b16 a[210:211], v7 offset:12288
    v_mfma_f32_16x16x32_bf16 v[176:179], a[188:191], v[96:99], v[112:115]
    v_exp_f32 v118, v118
    v_mfma_f32_16x16x32_bf16 v[176:179], a[184:187], v[92:95], v[176:179]
    ds_read_b128 a[144:147], v1 offset:36864
    v_cvt_pk_bf16_f32 v212, v116, v117
    v_mfma_f32_16x16x32_bf16 v[176:179], a[180:183], v[88:91], v[176:179]
    v_exp_f32 v119, v119
    v_mfma_f32_16x16x32_bf16 v[176:179], a[176:179], v[84:87], v[176:179]
    ds_read_b64_tr_b16 a[212:213], v7 offset:32768
    v_mfma_f32_16x16x32_bf16 a[0:3], a[192:195], v[180:183], a[0:3]
    v_exp_f32 v120, v120
    v_mfma_f32_16x16x32_bf16 a[0:3], a[196:199], v[184:187], a[0:3]
    ds_read_b64_tr_b16 a[214:215], v7 offset:36864
    v_cvt_pk_bf16_f32 v213, v118, v119
    v_mfma_f32_16x16x32_bf16 a[4:7], a[196:199], v[192:195], a[4:7]
    v_exp_f32 v121, v121
    v_mfma_f32_16x16x32_bf16 a[4:7], a[192:195], v[188:191], a[4:7]
    ds_read_b128 a[148:151], v2 offset:36864
    v_cvt_pk_bf16_f32 v220, v120, v121
    v_mfma_f32_16x16x32_bf16 a[8:11], a[192:195], v[196:199], a[8:11]
    v_exp_f32 v122, v122
    v_mfma_f32_16x16x32_bf16 a[8:11], a[196:199], v[200:203], a[8:11]
    buffer_load_dwordx4 v17, s[12:15], s29 offen offset:2048 lds
    v_mfma_f32_16x16x32_bf16 a[12:15], a[196:199], v[208:211], a[12:15]
    v_exp_f32 v123, v123
    v_mfma_f32_16x16x32_bf16 a[12:15], a[192:195], v[204:207], a[12:15]
    s_waitcnt lgkmcnt(6)
    v_mfma_f32_16x16x32_bf16 v[116:119], a[128:131], v[36:39], v[100:103]
    v_exp_f32 v124, v124
    v_mfma_f32_16x16x32_bf16 v[116:119], a[132:135], v[40:43], v[116:119]
    ds_read_b64_tr_b16 a[216:217], v8 offset:8192
    v_cvt_pk_bf16_f32 v221, v122, v123
    v_mfma_f32_16x16x32_bf16 v[116:119], a[136:139], v[44:47], v[116:119]
    v_exp_f32 v125, v125
    v_mfma_f32_16x16x32_bf16 v[116:119], a[140:143], v[48:51], v[116:119]
    ds_read_b64_tr_b16 a[218:219], v8 offset:12288
    v_mfma_f32_16x16x32_bf16 v[120:123], a[140:143], v[64:67], v[104:107]
    v_exp_f32 v126, v126
    v_mfma_f32_16x16x32_bf16 v[120:123], a[136:139], v[60:63], v[120:123]
    ds_read_b128 a[152:155], v3 offset:36864
    v_cvt_pk_bf16_f32 v228, v124, v125
    v_mfma_f32_16x16x32_bf16 v[120:123], a[132:135], v[56:59], v[120:123]
    v_exp_f32 v127, v127
    v_mfma_f32_16x16x32_bf16 v[120:123], a[128:131], v[52:55], v[120:123]
    ds_read_b64_tr_b16 a[220:221], v8 offset:32768
    v_mfma_f32_16x16x32_bf16 a[16:19], a[200:203], v[180:183], a[16:19]
    v_exp_f32 v128, v128
    v_mfma_f32_16x16x32_bf16 a[16:19], a[204:207], v[184:187], a[16:19]
    ds_read_b64_tr_b16 a[222:223], v8 offset:36864
    v_cvt_pk_bf16_f32 v229, v126, v127
    v_mfma_f32_16x16x32_bf16 a[20:23], a[204:207], v[192:195], a[20:23]
    v_exp_f32 v129, v129
    v_mfma_f32_16x16x32_bf16 a[20:23], a[200:203], v[188:191], a[20:23]
    ds_read_b128 a[156:159], v4 offset:36864
    v_mfma_f32_16x16x32_bf16 a[24:27], a[200:203], v[196:199], a[24:27]
    v_exp_f32 v130, v130
    v_mfma_f32_16x16x32_bf16 a[24:27], a[204:207], v[200:203], a[24:27]
    v_cvt_pk_bf16_f32 v236, v128, v129
    v_mfma_f32_16x16x32_bf16 a[28:31], a[204:207], v[208:211], a[28:31]
    v_exp_f32 v131, v131
    v_mfma_f32_16x16x32_bf16 a[28:31], a[200:203], v[204:207], a[28:31]
    buffer_load_dwordx4 v18, s[12:15], s29 offen offset:3072 lds
    v_smfmac_f32_16x16x64_bf16 a[224:227], v[244:247], v[180:187], v248
    s_waitcnt lgkmcnt(6)
    s_add_u32 s29, s29, 16384
    v_mfma_f32_16x16x32_bf16 v[124:127], a[128:131], v[68:71], v[108:111]
    v_exp_f32 v132, v132
    v_mfma_f32_16x16x32_bf16 v[124:127], a[132:135], v[72:75], v[124:127]
    ds_read_b64_tr_b16 a[192:193], v9 offset:8192
    v_cvt_pk_bf16_f32 v237, v130, v131
    v_mfma_f32_16x16x32_bf16 v[124:127], a[136:139], v[76:79], v[124:127]
    v_exp_f32 v133, v133
    v_mfma_f32_16x16x32_bf16 v[124:127], a[140:143], v[80:83], v[124:127]
    ds_read_b64_tr_b16 a[194:195], v9 offset:12288
    v_mfma_f32_16x16x32_bf16 v[128:131], a[140:143], v[96:99], v[112:115]
    v_exp_f32 v134, v134
    v_mfma_f32_16x16x32_bf16 v[128:131], a[136:139], v[92:95], v[128:131]
    ds_read_b128 a[160:163], v1 offset:40960
    v_cvt_pk_bf16_f32 v214, v132, v133
    v_mfma_f32_16x16x32_bf16 v[128:131], a[132:135], v[88:91], v[128:131]
    v_exp_f32 v135, v135
    v_mfma_f32_16x16x32_bf16 v[128:131], a[128:131], v[84:87], v[128:131]
    ds_read_b64_tr_b16 a[196:197], v9 offset:32768
    v_mfma_f32_16x16x32_bf16 a[32:35], a[208:211], v[180:183], a[32:35]
    v_exp_f32 v136, v136
    v_mfma_f32_16x16x32_bf16 a[32:35], a[212:215], v[184:187], a[32:35]
    ds_read_b64_tr_b16 a[198:199], v9 offset:36864
    v_cvt_pk_bf16_f32 v215, v134, v135
    v_mfma_f32_16x16x32_bf16 a[36:39], a[212:215], v[192:195], a[36:39]
    v_exp_f32 v137, v137
    v_mfma_f32_16x16x32_bf16 a[36:39], a[208:211], v[188:191], a[36:39]
    ds_read_b128 a[164:167], v2 offset:40960
    v_mfma_f32_16x16x32_bf16 a[40:43], a[208:211], v[196:199], a[40:43]
    v_exp_f32 v138, v138
    v_mfma_f32_16x16x32_bf16 a[40:43], a[212:215], v[200:203], a[40:43]
    v_cvt_pk_bf16_f32 v222, v136, v137
    v_mfma_f32_16x16x32_bf16 a[44:47], a[212:215], v[208:211], a[44:47]
    v_exp_f32 v139, v139
    v_mfma_f32_16x16x32_bf16 a[44:47], a[208:211], v[204:207], a[44:47]
    s_waitcnt lgkmcnt(6)
    v_mfma_f32_16x16x32_bf16 v[132:135], a[144:147], v[36:39], v[100:103]
    v_exp_f32 v140, v140
    v_mfma_f32_16x16x32_bf16 v[132:135], a[148:151], v[40:43], v[132:135]
    ds_read_b64_tr_b16 a[200:201], v10 offset:8192
    v_cvt_pk_bf16_f32 v223, v138, v139
    v_mfma_f32_16x16x32_bf16 v[132:135], a[152:155], v[44:47], v[132:135]
    v_exp_f32 v141, v141
    v_mfma_f32_16x16x32_bf16 v[132:135], a[156:159], v[48:51], v[132:135]
    ds_read_b64_tr_b16 a[202:203], v10 offset:12288
    v_mfma_f32_16x16x32_bf16 v[136:139], a[156:159], v[64:67], v[104:107]
    v_exp_f32 v142, v142
    v_mfma_f32_16x16x32_bf16 v[136:139], a[152:155], v[60:63], v[136:139]
    ds_read_b128 a[168:171], v3 offset:40960
    v_cvt_pk_bf16_f32 v230, v140, v141
    v_mfma_f32_16x16x32_bf16 v[136:139], a[148:151], v[56:59], v[136:139]
    v_exp_f32 v143, v143
    v_mfma_f32_16x16x32_bf16 v[136:139], a[144:147], v[52:55], v[136:139]
    ds_read_b64_tr_b16 a[204:205], v10 offset:32768
    v_mfma_f32_16x16x32_bf16 a[48:51], a[216:219], v[180:183], a[48:51]
    v_exp_f32 v144, v144
    v_mfma_f32_16x16x32_bf16 a[48:51], a[220:223], v[184:187], a[48:51]
    ds_read_b64_tr_b16 a[206:207], v10 offset:36864
    v_cvt_pk_bf16_f32 v231, v142, v143
    v_mfma_f32_16x16x32_bf16 a[52:55], a[220:223], v[192:195], a[52:55]
    v_exp_f32 v145, v145
    v_mfma_f32_16x16x32_bf16 a[52:55], a[216:219], v[188:191], a[52:55]
    ds_read_b128 a[172:175], v4 offset:40960
    v_mfma_f32_16x16x32_bf16 a[56:59], a[216:219], v[196:199], a[56:59]
    v_exp_f32 v146, v146
    v_mfma_f32_16x16x32_bf16 a[56:59], a[220:223], v[200:203], a[56:59]
    v_cvt_pk_bf16_f32 v238, v144, v145
    v_mfma_f32_16x16x32_bf16 a[60:63], a[220:223], v[208:211], a[60:63]
    v_exp_f32 v147, v147
    v_mfma_f32_16x16x32_bf16 a[60:63], a[216:219], v[204:207], a[60:63]
    v_smfmac_f32_16x16x64_bf16 a[228:231], v[244:247], v[188:195], v248
    s_waitcnt lgkmcnt(6)
    v_mfma_f32_16x16x32_bf16 v[140:143], a[144:147], v[68:71], v[108:111]
    v_exp_f32 v148, v148
    v_mfma_f32_16x16x32_bf16 v[140:143], a[148:151], v[72:75], v[140:143]
    ds_read_b64_tr_b16 a[208:209], v11 offset:8192
    v_cvt_pk_bf16_f32 v239, v146, v147
    v_mfma_f32_16x16x32_bf16 v[140:143], a[152:155], v[76:79], v[140:143]
    v_exp_f32 v149, v149
    v_mfma_f32_16x16x32_bf16 v[140:143], a[156:159], v[80:83], v[140:143]
    ds_read_b64_tr_b16 a[210:211], v11 offset:12288
    s_cmp_lg_u32 s5, 0
    s_cbranch_scc1 L_back_ffn
    s_waitcnt vmcnt(2)
    v_min3_u32 v28, v28, v29, v30
    v_min_u32 v28, v28, v31
    v_cmp_gt_u32 vcc, 1, v28
    s_and_b64 vcc, vcc, exec
    s_cbranch_scc1 L_spin_ffn
L_back_ffn:
    v_mfma_f32_16x16x32_bf16 v[144:147], a[156:159], v[96:99], v[112:115]
    v_exp_f32 v150, v150
    v_mfma_f32_16x16x32_bf16 v[144:147], a[152:155], v[92:95], v[144:147]
    ds_read_b128 a[176:179], v1 offset:45056
    v_cvt_pk_bf16_f32 v216, v148, v149
    v_mfma_f32_16x16x32_bf16 v[144:147], a[148:151], v[88:91], v[144:147]
    v_exp_f32 v151, v151
    v_mfma_f32_16x16x32_bf16 v[144:147], a[144:147], v[84:87], v[144:147]
    ds_read_b64_tr_b16 a[212:213], v11 offset:32768
    v_mfma_f32_16x16x32_bf16 a[64:67], a[192:195], v[180:183], a[64:67]
    v_exp_f32 v152, v152
    v_mfma_f32_16x16x32_bf16 a[64:67], a[196:199], v[184:187], a[64:67]
    ds_read_b64_tr_b16 a[214:215], v11 offset:36864
    v_cvt_pk_bf16_f32 v217, v150, v151
    v_mfma_f32_16x16x32_bf16 a[68:71], a[196:199], v[192:195], a[68:71]
    v_exp_f32 v153, v153
    v_mfma_f32_16x16x32_bf16 a[68:71], a[192:195], v[188:191], a[68:71]
    ds_read_b128 a[180:183], v2 offset:45056
    v_mfma_f32_16x16x32_bf16 a[72:75], a[192:195], v[196:199], a[72:75]
    v_exp_f32 v154, v154
    v_mfma_f32_16x16x32_bf16 a[72:75], a[196:199], v[200:203], a[72:75]
    v_cvt_pk_bf16_f32 v224, v152, v153
    v_mfma_f32_16x16x32_bf16 a[76:79], a[196:199], v[208:211], a[76:79]
    v_exp_f32 v155, v155
    v_mfma_f32_16x16x32_bf16 a[76:79], a[192:195], v[204:207], a[76:79]
    s_waitcnt lgkmcnt(6)
    v_mfma_f32_16x16x32_bf16 v[148:151], a[160:163], v[36:39], v[100:103]
    v_exp_f32 v156, v156
    v_mfma_f32_16x16x32_bf16 v[148:151], a[164:167], v[40:43], v[148:151]
    ds_read_b64_tr_b16 a[216:217], v12 offset:8192
    v_cvt_pk_bf16_f32 v225, v154, v155
    v_mfma_f32_16x16x32_bf16 v[148:151], a[168:171], v[44:47], v[148:151]
    v_exp_f32 v157, v157
    v_mfma_f32_16x16x32_bf16 v[148:151], a[172:175], v[48:51], v[148:151]
    ds_read_b64_tr_b16 a[218:219], v12 offset:12288
    v_mfma_f32_16x16x32_bf16 v[152:155], a[172:175], v[64:67], v[104:107]
    v_exp_f32 v158, v158
    v_mfma_f32_16x16x32_bf16 v[152:155], a[168:171], v[60:63], v[152:155]
    ds_read_b128 a[184:187], v3 offset:45056
    v_cvt_pk_bf16_f32 v232, v156, v157
    v_mfma_f32_16x16x32_bf16 v[152:155], a[164:167], v[56:59], v[152:155]
    v_exp_f32 v159, v159
    v_mfma_f32_16x16x32_bf16 v[152:155], a[160:163], v[52:55], v[152:155]
    ds_read_b64_tr_b16 a[220:221], v12 offset:32768
    v_mfma_f32_16x16x32_bf16 a[80:83], a[200:203], v[180:183], a[80:83]
    v_exp_f32 v160, v160
    v_mfma_f32_16x16x32_bf16 a[80:83], a[204:207], v[184:187], a[80:83]
    ds_read_b64_tr_b16 a[222:223], v12 offset:36864
    v_cvt_pk_bf16_f32 v233, v158, v159
    v_mfma_f32_16x16x32_bf16 a[84:87], a[204:207], v[192:195], a[84:87]
    v_exp_f32 v161, v161
    v_mfma_f32_16x16x32_bf16 a[84:87], a[200:203], v[188:191], a[84:87]
    ds_read_b128 a[188:191], v4 offset:45056
    v_mfma_f32_16x16x32_bf16 a[88:91], a[200:203], v[196:199], a[88:91]
    v_exp_f32 v162, v162
    v_mfma_f32_16x16x32_bf16 a[88:91], a[204:207], v[200:203], a[88:91]
    v_cvt_pk_bf16_f32 v240, v160, v161
    v_mfma_f32_16x16x32_bf16 a[92:95], a[204:207], v[208:211], a[92:95]
    v_exp_f32 v163, v163
    v_mfma_f32_16x16x32_bf16 a[92:95], a[200:203], v[204:207], a[92:95]
    v_smfmac_f32_16x16x64_bf16 a[232:235], v[244:247], v[196:203], v248
    s_waitcnt vmcnt(4) lgkmcnt(0)
    s_barrier
    v_mfma_f32_16x16x32_bf16 v[156:159], a[160:163], v[68:71], v[108:111]
    v_exp_f32 v164, v164
    v_mfma_f32_16x16x32_bf16 v[156:159], a[164:167], v[72:75], v[156:159]
    ds_read_b64_tr_b16 a[192:193], v5 offset:16384
    v_cvt_pk_bf16_f32 v241, v162, v163
    v_mfma_f32_16x16x32_bf16 v[156:159], a[168:171], v[76:79], v[156:159]
    v_exp_f32 v165, v165
    v_mfma_f32_16x16x32_bf16 v[156:159], a[172:175], v[80:83], v[156:159]
    ds_read_b64_tr_b16 a[194:195], v5 offset:20480
    v_mfma_f32_16x16x32_bf16 v[160:163], a[172:175], v[96:99], v[112:115]
    v_exp_f32 v166, v166
    v_mfma_f32_16x16x32_bf16 v[160:163], a[168:171], v[92:95], v[160:163]
    ds_read_b128 a[128:131], v1 offset:0
    v_cvt_pk_bf16_f32 v218, v164, v165
    v_mfma_f32_16x16x32_bf16 v[160:163], a[164:167], v[88:91], v[160:163]
    v_exp_f32 v167, v167
    v_mfma_f32_16x16x32_bf16 v[160:163], a[160:163], v[84:87], v[160:163]
    ds_read_b64_tr_b16 a[196:197], v5 offset:40960
    s_mul_i32 s36, s6, 27648
    s_lshl_b32 s37, s5, 10
    s_add_u32 s36, s36, s37
    v_lshlrev_b32 v0, 4, v19
    buffer_load_dwordx4 v[20:23], v0, s[16:19], s36 offen sc1
    v_mfma_f32_16x16x32_bf16 a[96:99], a[208:211], v[180:183], a[96:99]
    v_exp_f32 v168, v168
    v_mfma_f32_16x16x32_bf16 a[96:99], a[212:215], v[184:187], a[96:99]
    ds_read_b64_tr_b16 a[198:199], v5 offset:45056
    v_cvt_pk_bf16_f32 v219, v166, v167
    v_mfma_f32_16x16x32_bf16 a[100:103], a[212:215], v[192:195], a[100:103]
    v_exp_f32 v169, v169
    v_mfma_f32_16x16x32_bf16 a[100:103], a[208:211], v[188:191], a[100:103]
    ds_read_b128 a[132:135], v2 offset:0
    v_cvt_pk_bf16_f32 v226, v168, v169
    v_mfma_f32_16x16x32_bf16 a[104:107], a[208:211], v[196:199], a[104:107]
    v_exp_f32 v170, v170
    v_mfma_f32_16x16x32_bf16 a[104:107], a[212:215], v[200:203], a[104:107]
    s_mov_b32 m0, s33
    s_nop 0
    buffer_load_dwordx4 v17, s[12:15], s29 offen offset:0 lds
    v_mfma_f32_16x16x32_bf16 a[108:111], a[212:215], v[208:211], a[108:111]
    v_exp_f32 v171, v171
    v_mfma_f32_16x16x32_bf16 a[108:111], a[208:211], v[204:207], a[108:111]
    s_waitcnt lgkmcnt(6)
    s_add_u32 s36, s36, 4096
    buffer_load_dwordx4 v[24:27], v0, s[16:19], s36 offen sc1
    s_add_u32 m0, s46, 122880
    s_mov_b32 s45, 245760
    buffer_load_dwordx4 v254, s[20:23], s45 offen sc1 lds
    v_mfma_f32_16x16x32_bf16 v[164:167], a[176:179], v[36:39], v[100:103]
    v_exp_f32 v172, v172
    v_mfma_f32_16x16x32_bf16 v[164:167], a[180:183], v[40:43], v[164:167]
    ds_read_b64_tr_b16 a[200:201], v6 offset:16384
    v_cvt_pk_bf16_f32 v227, v170, v171
    v_mfma_f32_16x16x32_bf16 v[164:167], a[184:187], v[44:47], v[164:167]
    v_exp_f32 v173, v173
    v_mfma_f32_16x16x32_bf16 v[164:167], a[188:191], v[48:51], v[164:167]
    ds_read_b64_tr_b16 a[202:203], v6 offset:20480
    v_mfma_f32_16x16x32_bf16 v[168:171], a[188:191], v[64:67], v[104:107]
    v_exp_f32 v174, v174
    v_mfma_f32_16x16x32_bf16 v[168:171], a[184:187], v[60:63], v[168:171]
    ds_read_b128 a[136:139], v3 offset:0
    v_cvt_pk_bf16_f32 v234, v172, v173
    v_mfma_f32_16x16x32_bf16 v[168:171], a[180:183], v[56:59], v[168:171]
    v_exp_f32 v175, v175
    v_mfma_f32_16x16x32_bf16 v[168:171], a[176:179], v[52:55], v[168:171]
    ds_read_b64_tr_b16 a[204:205], v6 offset:40960
    v_mfma_f32_16x16x32_bf16 a[112:115], a[216:219], v[180:183], a[112:115]
    s_add_u32 s36, s36, 4096
    buffer_load_dwordx4 v[28:31], v0, s[16:19], s36 offen sc1
    v_exp_f32 v176, v176
    v_mfma_f32_16x16x32_bf16 a[112:115], a[220:223], v[184:187], a[112:115]
    ds_read_b64_tr_b16 a[206:207], v6 offset:45056
    v_cvt_pk_bf16_f32 v235, v174, v175
    v_mfma_f32_16x16x32_bf16 a[116:119], a[220:223], v[192:195], a[116:119]
    v_exp_f32 v177, v177
    v_mfma_f32_16x16x32_bf16 a[116:119], a[216:219], v[188:191], a[116:119]
    ds_read_b128 a[140:143], v4 offset:0
    v_mfma_f32_16x16x32_bf16 a[120:123], a[216:219], v[196:199], a[120:123]
    v_exp_f32 v178, v178
    v_mfma_f32_16x16x32_bf16 a[120:123], a[220:223], v[200:203], a[120:123]
    v_cvt_pk_bf16_f32 v242, v176, v177
    v_mfma_f32_16x16x32_bf16 a[124:127], a[220:223], v[208:211], a[124:127]
    v_exp_f32 v179, v179
    v_mfma_f32_16x16x32_bf16 a[124:127], a[216:219], v[204:207], a[124:127]
    s_mov_b32 m0, s33
    s_nop 0
    buffer_load_dwordx4 v18, s[12:15], s29 offen offset:1024 lds
    v_smfmac_f32_16x16x64_bf16 a[236:239], v[244:247], v[204:211], v248
    s_waitcnt lgkmcnt(6)
    s_add_u32 s36, s36, 4096
    buffer_load_dwordx4 v[32:35], v0, s[16:19], s36 offen sc1
    s_add_u32 m0, s46, 123904
    s_mov_b32 s45, 246784
    buffer_load_dwordx4 v254, s[20:23], s45 offen sc1 lds
    v_mfma_f32_16x16x32_bf16 v[172:175], a[176:179], v[68:71], v[108:111]
    v_exp_f32 v116, v116
    v_mfma_f32_16x16x32_bf16 v[172:175], a[180:183], v[72:75], v[172:175]
    ds_read_b64_tr_b16 a[208:209], v7 offset:16384
    v_cvt_pk_bf16_f32 v243, v178, v179
    v_mfma_f32_16x16x32_bf16 v[172:175], a[184:187], v[76:79], v[172:175]
    v_exp_f32 v117, v117
    v_mfma_f32_16x16x32_bf16 v[172:175], a[188:191], v[80:83], v[172:175]
    ds_read_b64_tr_b16 a[210:211], v7 offset:20480
    v_mfma_f32_16x16x32_bf16 v[176:179], a[188:191], v[96:99], v[112:115]
    v_exp_f32 v118, v118
    v_mfma_f32_16x16x32_bf16 v[176:179], a[184:187], v[92:95], v[176:179]
    ds_read_b128 a[144:147], v1 offset:4096
    v_cvt_pk_bf16_f32 v180, v116, v117
    v_mfma_f32_16x16x32_bf16 v[176:179], a[180:183], v[88:91], v[176:179]
    v_exp_f32 v119, v119
    v_mfma_f32_16x16x32_bf16 v[176:179], a[176:179], v[84:87], v[176:179]
    ds_read_b64_tr_b16 a[212:213], v7 offset:40960
    v_mfma_f32_16x16x32_bf16 a[0:3], a[192:195], v[212:215], a[0:3]
    v_exp_f32 v120, v120
    v_mfma_f32_16x16x32_bf16 a[0:3], a[196:199], v[216:219], a[0:3]
    ds_read_b64_tr_b16 a[214:215], v7 offset:45056
    v_cvt_pk_bf16_f32 v181, v118, v119
    v_mfma_f32_16x16x32_bf16 a[4:7], a[196:199], v[224:227], a[4:7]
    s_add_u32 s36, s36, 4096
    buffer_load_dwordx4 a[240:243], v0, s[16:19], s36 offen sc1
    v_exp_f32 v121, v121
    v_mfma_f32_16x16x32_bf16 a[4:7], a[192:195], v[220:223], a[4:7]
    ds_read_b128 a[148:151], v2 offset:4096
    s_add_u32 m0, s46, 124928
    s_mov_b32 s45, 247808
    buffer_load_dwordx4 v254, s[20:23], s45 offen sc1 lds
    v_cvt_pk_bf16_f32 v188, v120, v121
    v_mfma_f32_16x16x32_bf16 a[8:11], a[192:195], v[228:231], a[8:11]
    v_exp_f32 v122, v122
    v_mfma_f32_16x16x32_bf16 a[8:11], a[196:199], v[232:235], a[8:11]
    s_mov_b32 m0, s33
    s_nop 0
    buffer_load_dwordx4 v17, s[12:15], s29 offen offset:2048 lds
    v_mfma_f32_16x16x32_bf16 a[12:15], a[196:199], v[240:243], a[12:15]
    v_exp_f32 v123, v123
    v_mfma_f32_16x16x32_bf16 a[12:15], a[192:195], v[236:239], a[12:15]
    s_waitcnt lgkmcnt(6)
    s_add_u32 s36, s36, 4096
    buffer_load_dwordx4 a[244:247], v0, s[16:19], s36 offen sc1
    v_mfma_f32_16x16x32_bf16 v[116:119], a[128:131], v[36:39], v[100:103]
    v_exp_f32 v124, v124
    v_mfma_f32_16x16x32_bf16 v[116:119], a[132:135], v[40:43], v[116:119]
    ds_read_b64_tr_b16 a[216:217], v8 offset:16384
    v_cvt_pk_bf16_f32 v189, v122, v123
    v_mfma_f32_16x16x32_bf16 v[116:119], a[136:139], v[44:47], v[116:119]
    v_exp_f32 v125, v125
    v_mfma_f32_16x16x32_bf16 v[116:119], a[140:143], v[48:51], v[116:119]
    ds_read_b64_tr_b16 a[218:219], v8 offset:20480
    v_mfma_f32_16x16x32_bf16 v[120:123], a[140:143], v[64:67], v[104:107]
    v_exp_f32 v126, v126
    v_mfma_f32_16x16x32_bf16 v[120:123], a[136:139], v[60:63], v[120:123]
    ds_read_b128 a[152:155], v3 offset:4096
    v_cvt_pk_bf16_f32 v196, v124, v125
    v_mfma_f32_16x16x32_bf16 v[120:123], a[132:135], v[56:59], v[120:123]
    v_exp_f32 v127, v127
    v_mfma_f32_16x16x32_bf16 v[120:123], a[128:131], v[52:55], v[120:123]
    ds_read_b64_tr_b16 a[220:221], v8 offset:40960
    v_mfma_f32_16x16x32_bf16 a[16:19], a[200:203], v[212:215], a[16:19]
    s_add_u32 m0, s46, 125952
    s_mov_b32 s45, 248832
    buffer_load_dwordx4 v254, s[20:23], s45 offen sc1 lds
    v_exp_f32 v128, v128
    v_mfma_f32_16x16x32_bf16 a[16:19], a[204:207], v[216:219], a[16:19]
    ds_read_b64_tr_b16 a[222:223], v8 offset:45056
    v_cvt_pk_bf16_f32 v197, v126, v127
    v_mfma_f32_16x16x32_bf16 a[20:23], a[204:207], v[224:227], a[20:23]
    v_exp_f32 v129, v129
    v_mfma_f32_16x16x32_bf16 a[20:23], a[200:203], v[220:223], a[20:23]
    ds_read_b128 a[156:159], v4 offset:4096
    v_mfma_f32_16x16x32_bf16 a[24:27], a[200:203], v[228:231], a[24:27]
    v_exp_f32 v130, v130
    v_mfma_f32_16x16x32_bf16 a[24:27], a[204:207], v[232:235], a[24:27]
    v_cvt_pk_bf16_f32 v204, v128, v129
    v_mfma_f32_16x16x32_bf16 a[28:31], a[204:207], v[240:243], a[28:31]
    v_exp_f32 v131, v131
    v_mfma_f32_16x16x32_bf16 a[28:31], a[200:203], v[236:239], a[28:31]
    s_mov_b32 m0, s33
    s_nop 0
    buffer_load_dwordx4 v18, s[12:15], s29 offen offset:3072 lds
    v_smfmac_f32_16x16x64_bf16 a[224:227], v[244:247], v[212:219], v248
    s_waitcnt lgkmcnt(6)
    s_add_u32 s29, s29, 16384
    s_add_u32 s36, s36, 4096
    s_cmp_eq_u32 s5, 3
    s_cselect_b32 s36, 0x438000, s36
    buffer_load_dwordx4 a[248:251], v0, s[16:19], s36 offen sc1
    v_mfma_f32_16x16x32_bf16 v[124:127], a[128:131], v[68:71], v[108:111]
    v_exp_f32 v132, v132
    v_mfma_f32_16x16x32_bf16 v[124:127], a[132:135], v[72:75], v[124:127]
    ds_read_b64_tr_b16 a[192:193], v9 offset:16384
    v_cvt_pk_bf16_f32 v205, v130, v131
    v_mfma_f32_16x16x32_bf16 v[124:127], a[136:139], v[76:79], v[124:127]
    v_exp_f32 v133, v133
    v_mfma_f32_16x16x32_bf16 v[124:127], a[140:143], v[80:83], v[124:127]
    ds_read_b64_tr_b16 a[194:195], v9 offset:20480
    s_add_u32 m0, s46, 126976
    s_mov_b32 s45, 249856
    buffer_load_dwordx4 v254, s[20:23], s45 offen sc1 lds
    v_mfma_f32_16x16x32_bf16 v[128:131], a[140:143], v[96:99], v[112:115]
    v_exp_f32 v134, v134
    v_mfma_f32_16x16x32_bf16 v[128:131], a[136:139], v[92:95], v[128:131]
    ds_read_b128 a[160:163], v1 offset:8192
    v_cvt_pk_bf16_f32 v182, v132, v133
    v_mfma_f32_16x16x32_bf16 v[128:131], a[132:135], v[88:91], v[128:131]
    v_exp_f32 v135, v135
    v_mfma_f32_16x16x32_bf16 v[128:131], a[128:131], v[84:87], v[128:131]
    ds_read_b64_tr_b16 a[196:197], v9 offset:40960
    v_mfma_f32_16x16x32_bf16 a[32:35], a[208:211], v[212:215], a[32:35]
    v_exp_f32 v136, v136
    v_mfma_f32_16x16x32_bf16 a[32:35], a[212:215], v[216:219], a[32:35]
    ds_read_b64_tr_b16 a[198:199], v9 offset:45056
    v_cvt_pk_bf16_f32 v183, v134, v135
    v_mfma_f32_16x16x32_bf16 a[36:39], a[212:215], v[224:227], a[36:39]
    v_exp_f32 v137, v137
    v_mfma_f32_16x16x32_bf16 a[36:39], a[208:211], v[220:223], a[36:39]
    ds_read_b128 a[164:167], v2 offset:8192
    v_mfma_f32_16x16x32_bf16 a[40:43], a[208:211], v[228:231], a[40:43]
    v_exp_f32 v138, v138
    v_mfma_f32_16x16x32_bf16 a[40:43], a[212:215], v[232:235], a[40:43]
    v_cvt_pk_bf16_f32 v190, v136, v137
    v_mfma_f32_16x16x32_bf16 a[44:47], a[212:215], v[240:243], a[44:47]
    v_exp_f32 v139, v139
    v_mfma_f32_16x16x32_bf16 a[44:47], a[208:211], v[236:239], a[44:47]
    s_waitcnt lgkmcnt(6)
    s_add_u32 m0, s46, 128000
    s_mov_b32 s45, 266240
    buffer_load_dwordx4 v254, s[20:23], s45 offen sc1 lds
    v_mfma_f32_16x16x32_bf16 v[132:135], a[144:147], v[36:39], v[100:103]
    v_exp_f32 v140, v140
    v_mfma_f32_16x16x32_bf16 v[132:135], a[148:151], v[40:43], v[132:135]
    ds_read_b64_tr_b16 a[200:201], v10 offset:16384
    v_cvt_pk_bf16_f32 v191, v138, v139
    v_mfma_f32_16x16x32_bf16 v[132:135], a[152:155], v[44:47], v[132:135]
    v_exp_f32 v141, v141
    v_mfma_f32_16x16x32_bf16 v[132:135], a[156:159], v[48:51], v[132:135]
    ds_read_b64_tr_b16 a[202:203], v10 offset:20480
    v_mfma_f32_16x16x32_bf16 v[136:139], a[156:159], v[64:67], v[104:107]
    v_exp_f32 v142, v142
    v_mfma_f32_16x16x32_bf16 v[136:139], a[152:155], v[60:63], v[136:139]
    ds_read_b128 a[168:171], v3 offset:8192
    v_cvt_pk_bf16_f32 v198, v140, v141
    v_mfma_f32_16x16x32_bf16 v[136:139], a[148:151], v[56:59], v[136:139]
    v_exp_f32 v143, v143
    v_mfma_f32_16x16x32_bf16 v[136:139], a[144:147], v[52:55], v[136:139]
    ds_read_b64_tr_b16 a[204:205], v10 offset:40960
    v_mfma_f32_16x16x32_bf16 a[48:51], a[216:219], v[212:215], a[48:51]
    v_exp_f32 v144, v144
    v_mfma_f32_16x16x32_bf16 a[48:51], a[220:223], v[216:219], a[48:51]
    ds_read_b64_tr_b16 a[206:207], v10 offset:45056
    v_cvt_pk_bf16_f32 v199, v142, v143
    v_mfma_f32_16x16x32_bf16 a[52:55], a[220:223], v[224:227], a[52:55]
    v_exp_f32 v145, v145
    v_mfma_f32_16x16x32_bf16 a[52:55], a[216:219], v[220:223], a[52:55]
    ds_read_b128 a[172:175], v4 offset:8192
    v_mfma_f32_16x16x32_bf16 a[56:59], a[216:219], v[228:231], a[56:59]
    s_add_u32 m0, s46, 129024
    s_mov_b32 s45, 267264
    buffer_load_dwordx4 v254, s[20:23], s45 offen sc1 lds
    v_exp_f32 v146, v146
    v_mfma_f32_16x16x32_bf16 a[56:59], a[220:223], v[232:235], a[56:59]
    v_cvt_pk_bf16_f32 v206, v144, v145
    v_mfma_f32_16x16x32_bf16 a[60:63], a[220:223], v[240:243], a[60:63]
    v_exp_f32 v147, v147
    v_mfma_f32_16x16x32_bf16 a[60:63], a[216:219], v[236:239], a[60:63]
    s_add_u32 m0, s46, 130048
    s_mov_b32 s45, 268288
    buffer_load_dwordx4 v254, s[20:23], s45 offen sc1 lds
    v_smfmac_f32_16x16x64_bf16 a[228:231], v[244:247], v[220:227], v248
    s_waitcnt lgkmcnt(6)
    s_add_u32 m0, s46, 131072
    s_mov_b32 s45, 269312
    buffer_load_dwordx4 v254, s[20:23], s45 offen sc1 lds
    v_mfma_f32_16x16x32_bf16 v[140:143], a[144:147], v[68:71], v[108:111]
    v_exp_f32 v148, v148
    v_mfma_f32_16x16x32_bf16 v[140:143], a[148:151], v[72:75], v[140:143]
    ds_read_b64_tr_b16 a[208:209], v11 offset:16384
    v_cvt_pk_bf16_f32 v207, v146, v147
    v_mfma_f32_16x16x32_bf16 v[140:143], a[152:155], v[76:79], v[140:143]
    v_exp_f32 v149, v149
    v_mfma_f32_16x16x32_bf16 v[140:143], a[156:159], v[80:83], v[140:143]
    ds_read_b64_tr_b16 a[210:211], v11 offset:20480
    v_mfma_f32_16x16x32_bf16 v[144:147], a[156:159], v[96:99], v[112:115]
    v_exp_f32 v150, v150
    v_mfma_f32_16x16x32_bf16 v[144:147], a[152:155], v[92:95], v[144:147]
    ds_read_b128 a[176:179], v1 offset:12288
    v_cvt_pk_bf16_f32 v184, v148, v149
    v_mfma_f32_16x16x32_bf16 v[144:147], a[148:151], v[88:91], v[144:147]
    v_exp_f32 v151, v151
    v_mfma_f32_16x16x32_bf16 v[144:147], a[144:147], v[84:87], v[144:147]
    ds_read_b64_tr_b16 a[212:213], v11 offset:40960
    v_mfma_f32_16x16x32_bf16 a[64:67], a[192:195], v[212:215], a[64:67]
    v_exp_f32 v152, v152
    v_mfma_f32_16x16x32_bf16 a[64:67], a[196:199], v[216:219], a[64:67]
    ds_read_b64_tr_b16 a[214:215], v11 offset:45056
    v_cvt_pk_bf16_f32 v185, v150, v151
    v_mfma_f32_16x16x32_bf16 a[68:71], a[196:199], v[224:227], a[68:71]
    v_exp_f32 v153, v153
    v_mfma_f32_16x16x32_bf16 a[68:71], a[192:195], v[220:223], a[68:71]
    ds_read_b128 a[180:183], v2 offset:12288
    v_mfma_f32_16x16x32_bf16 a[72:75], a[192:195], v[228:231], a[72:75]
    v_exp_f32 v154, v154
    v_mfma_f32_16x16x32_bf16 a[72:75], a[196:199], v[232:235], a[72:75]
    v_cvt_pk_bf16_f32 v192, v152, v153
    v_mfma_f32_16x16x32_bf16 a[76:79], a[196:199], v[240:243], a[76:79]
    v_exp_f32 v155, v155
    v_mfma_f32_16x16x32_bf16 a[76:79], a[192:195], v[236:239], a[76:79]
    s_waitcnt lgkmcnt(6)
    s_add_u32 m0, s46, 132096
    s_mov_b32 s45, 270336
    buffer_load_dwordx4 v254, s[20:23], s45 offen sc1 lds
    v_mfma_f32_16x16x32_bf16 v[148:151], a[160:163], v[36:39], v[100:103]
    s_waitcnt vmcnt(6)
    v_exp_f32 v156, v156
    v_mfma_f32_16x16x32_bf16 v[148:151], a[164:167], v[40:43], v[148:151]
    ds_read_b64_tr_b16 a[216:217], v12 offset:16384
    v_cvt_pk_bf16_f32 v193, v154, v155
    v_mfma_f32_16x16x32_bf16 v[148:151], a[168:171], v[44:47], v[148:151]
    v_exp_f32 v157, v157
    v_add_f32 v20, v20, v24
    v_mfma_f32_16x16x32_bf16 v[148:151], a[172:175], v[48:51], v[148:151]
    ds_read_b64_tr_b16 a[218:219], v12 offset:20480
    v_add_f32 v21, v21, v25
    v_mfma_f32_16x16x32_bf16 v[152:155], a[172:175], v[64:67], v[104:107]
    v_exp_f32 v158, v158
    v_add_f32 v22, v22, v26
    v_mfma_f32_16x16x32_bf16 v[152:155], a[168:171], v[60:63], v[152:155]
    ds_read_b128 a[184:187], v3 offset:12288
    v_cvt_pk_bf16_f32 v200, v156, v157
    v_mfma_f32_16x16x32_bf16 v[152:155], a[164:167], v[56:59], v[152:155]
    v_exp_f32 v159, v159
    v_add_f32 v23, v23, v27
    v_mfma_f32_16x16x32_bf16 v[152:155], a[160:163], v[52:55], v[152:155]
    ds_read_b64_tr_b16 a[220:221], v12 offset:40960
    v_add_f32 v20, v20, v28
    v_mfma_f32_16x16x32_bf16 a[80:83], a[200:203], v[212:215], a[80:83]
    v_exp_f32 v160, v160
    v_add_f32 v21, v21, v29
    v_mfma_f32_16x16x32_bf16 a[80:83], a[204:207], v[216:219], a[80:83]
    ds_read_b64_tr_b16 a[222:223], v12 offset:45056
    v_cvt_pk_bf16_f32 v201, v158, v159
    v_add_f32 v22, v22, v30
    v_mfma_f32_16x16x32_bf16 a[84:87], a[204:207], v[224:227], a[84:87]
    v_exp_f32 v161, v161
    v_mfma_f32_16x16x32_bf16 a[84:87], a[200:203], v[220:223], a[84:87]
    ds_read_b128 a[188:191], v4 offset:12288
    v_add_f32 v23, v23, v31
    v_mfma_f32_16x16x32_bf16 a[88:91], a[200:203], v[228:231], a[88:91]
    v_exp_f32 v162, v162
    v_add_f32 v20, v20, v32
    v_mfma_f32_16x16x32_bf16 a[88:91], a[204:207], v[232:235], a[88:91]
    v_cvt_pk_bf16_f32 v208, v160, v161
    v_add_f32 v21, v21, v33
    v_mfma_f32_16x16x32_bf16 a[92:95], a[204:207], v[240:243], a[92:95]
    v_exp_f32 v163, v163
    v_add_f32 v22, v22, v34
    v_mfma_f32_16x16x32_bf16 a[92:95], a[200:203], v[236:239], a[92:95]
    v_add_f32 v23, v23, v35
    v_accvgpr_read_b32 v24, a240
    v_smfmac_f32_16x16x64_bf16 a[232:235], v[244:247], v[228:235], v248
    s_waitcnt vmcnt(21) lgkmcnt(0)
    s_barrier
    v_accvgpr_read_b32 v25, a241
    v_accvgpr_read_b32 v26, a242
    v_mfma_f32_16x16x32_bf16 v[156:159], a[160:163], v[68:71], v[108:111]
    v_exp_f32 v164, v164
    v_mfma_f32_16x16x32_bf16 v[156:159], a[164:167], v[72:75], v[156:159]
    ds_read_b64_tr_b16 a[192:193], v5 offset:57344
    v_cvt_pk_bf16_f32 v209, v162, v163
    v_mfma_f32_16x16x32_bf16 v[156:159], a[168:171], v[76:79], v[156:159]
    v_exp_f32 v165, v165
    v_mfma_f32_16x16x32_bf16 v[156:159], a[172:175], v[80:83], v[156:159]
    ds_read_b64_tr_b16 a[194:195], v5 offset:61440
    v_accvgpr_read_b32 v27, a243
    v_mfma_f32_16x16x32_bf16 v[160:163], a[172:175], v[96:99], v[112:115]
    v_exp_f32 v166, v166
    v_mfma_f32_16x16x32_bf16 v[160:163], a[168:171], v[92:95], v[160:163]
    ds_read_b64_tr_b16 a[196:197], v5 offset:0
    v_cvt_pk_bf16_f32 v186, v164, v165
    v_accvgpr_read_b32 v28, a244
    v_mfma_f32_16x16x32_bf16 v[160:163], a[164:167], v[88:91], v[160:163]
    s_add_u32 m0, s46, 81920
    s_mov_b32 s45, 286720
    buffer_load_dwordx4 v254, s[20:23], s45 offen sc1 lds
    v_exp_f32 v167, v167
    v_accvgpr_read_b32 v29, a245
    v_mfma_f32_16x16x32_bf16 v[160:163], a[160:163], v[84:87], v[160:163]
    ds_read_b64_tr_b16 a[198:199], v5 offset:4096
    v_accvgpr_read_b32 v30, a246
    v_mfma_f32_16x16x32_bf16 a[96:99], a[208:211], v[212:215], a[96:99]
    v_exp_f32 v168, v168
    v_accvgpr_read_b32 v31, a247
    v_mfma_f32_16x16x32_bf16 a[96:99], a[212:215], v[216:219], a[96:99]
    v_cvt_pk_bf16_f32 v187, v166, v167
    v_accvgpr_read_b32 v32, a248
    v_mfma_f32_16x16x32_bf16 a[100:103], a[212:215], v[224:227], a[100:103]
    v_exp_f32 v169, v169
    v_accvgpr_read_b32 v33, a249
    v_mfma_f32_16x16x32_bf16 a[100:103], a[208:211], v[220:223], a[100:103]
    v_accvgpr_read_b32 v34, a250
    v_accvgpr_read_b32 v35, a251
    v_mfma_f32_16x16x32_bf16 a[104:107], a[208:211], v[228:231], a[104:107]
    s_add_u32 m0, s46, 82944
    s_mov_b32 s45, 287744
    buffer_load_dwordx4 v254, s[20:23], s45 offen sc1 lds
    v_exp_f32 v170, v170
    v_mfma_f32_16x16x32_bf16 a[104:107], a[212:215], v[232:235], a[104:107]
    v_cvt_pk_bf16_f32 v194, v168, v169
    v_add_f32 v20, v20, v24
    v_mfma_f32_16x16x32_bf16 a[108:111], a[212:215], v[240:243], a[108:111]
    v_exp_f32 v171, v171
    v_mfma_f32_16x16x32_bf16 a[108:111], a[208:211], v[236:239], a[108:111]
    s_waitcnt lgkmcnt(4)
    v_add_f32 v21, v21, v25
    v_add_f32 v22, v22, v26
    v_mfma_f32_16x16x32_bf16 v[164:167], a[176:179], v[36:39], v[100:103]
    v_exp_f32 v172, v172
    v_mfma_f32_16x16x32_bf16 v[164:167], a[180:183], v[40:43], v[164:167]
    ds_read_b64_tr_b16 a[200:201], v6 offset:57344
    v_cvt_pk_bf16_f32 v195, v170, v171
    v_mfma_f32_16x16x32_bf16 v[164:167], a[184:187], v[44:47], v[164:167]
    v_exp_f32 v173, v173
    v_add_f32 v23, v23, v27
    v_mfma_f32_16x16x32_bf16 v[164:167], a[188:191], v[48:51], v[164:167]
    ds_read_b64_tr_b16 a[202:203], v6 offset:61440
    s_add_u32 m0, s46, 83968
    s_mov_b32 s45, 288768
    buffer_load_dwordx4 v254, s[20:23], s45 offen sc1 lds
    v_add_f32 v20, v20, v28
    v_mfma_f32_16x16x32_bf16 v[168:171], a[188:191], v[64:67], v[104:107]
    v_exp_f32 v174, v174
    v_add_f32 v21, v21, v29
    v_mfma_f32_16x16x32_bf16 v[168:171], a[184:187], v[60:63], v[168:171]
    ds_read_b64_tr_b16 a[204:205], v6 offset:0
    v_cvt_pk_bf16_f32 v202, v172, v173
    v_add_f32 v22, v22, v30
    v_mfma_f32_16x16x32_bf16 v[168:171], a[180:183], v[56:59], v[168:171]
    v_exp_f32 v175, v175
    v_mfma_f32_16x16x32_bf16 v[168:171], a[176:179], v[52:55], v[168:171]
    ds_read_b64_tr_b16 a[206:207], v6 offset:4096
    v_add_f32 v23, v23, v31
    v_mfma_f32_16x16x32_bf16 a[112:115], a[216:219], v[212:215], a[112:115]
    v_exp_f32 v176, v176
    v_add_f32 v20, v20, v32
    v_mfma_f32_16x16x32_bf16 a[112:115], a[220:223], v[216:219], a[112:115]
    v_cvt_pk_bf16_f32 v203, v174, v175
    v_add_f32 v21, v21, v33
    v_mfma_f32_16x16x32_bf16 a[116:119], a[220:223], v[224:227], a[116:119]
    s_add_u32 m0, s46, 84992
    s_mov_b32 s45, 289792
    buffer_load_dwordx4 v254, s[20:23], s45 offen sc1 lds
    v_exp_f32 v177, v177
    v_add_f32 v22, v22, v34
    v_mfma_f32_16x16x32_bf16 a[116:119], a[216:219], v[220:223], a[116:119]
    v_add_f32 v23, v23, v35
    v_mfma_f32_16x16x32_bf16 a[120:123], a[216:219], v[228:231], a[120:123]
    v_exp_f32 v178, v178
    v_mfma_f32_16x16x32_bf16 a[120:123], a[220:223], v[232:235], a[120:123]
    v_cvt_pk_bf16_f32 v210, v176, v177
    v_add_f32_dpp v20, v20, v20 row_ror:8 row_mask:0xf bank_mask:0xf
    v_mfma_f32_16x16x32_bf16 a[124:127], a[220:223], v[240:243], a[124:127]
    v_exp_f32 v179, v179
    v_add_f32_dpp v21, v21, v21 row_ror:8 row_mask:0xf bank_mask:0xf
    v_mfma_f32_16x16x32_bf16 a[124:127], a[216:219], v[236:239], a[124:127]
    v_add_f32_dpp v22, v22, v22 row_ror:8 row_mask:0xf bank_mask:0xf
    v_smfmac_f32_16x16x64_bf16 a[236:239], v[244:247], v[236:243], v248
    s_waitcnt lgkmcnt(4)
    s_add_u32 m0, s46, 86016
    s_mov_b32 s45, 290816
    buffer_load_dwordx4 v254, s[20:23], s45 offen sc1 lds
    v_add_f32_dpp v23, v23, v23 row_ror:8 row_mask:0xf bank_mask:0xf
    v_mfma_f32_16x16x32_bf16 v[172:175], a[176:179], v[68:71], v[108:111]
    v_exp_f32 v116, v116
    v_mfma_f32_16x16x32_bf16 v[172:175], a[180:183], v[72:75], v[172:175]
    ds_read_b64_tr_b16 a[208:209], v7 offset:57344
    v_cvt_pk_bf16_f32 v211, v178, v179
    v_mfma_f32_16x16x32_bf16 v[172:175], a[184:187], v[76:79], v[172:175]
    v_exp_f32 v117, v117
    v_mov_b32 v24, v20
    v_mfma_f32_16x16x32_bf16 v[172:175], a[188:191], v[80:83], v[172:175]
    ds_read_b64_tr_b16 a[210:211], v7 offset:61440
    v_mov_b32 v25, v21
    v_mfma_f32_16x16x32_bf16 v[176:179], a[188:191], v[96:99], v[112:115]
    v_exp_f32 v118, v118
    v_mfma_f32_16x16x32_bf16 v[176:179], a[184:187], v[92:95], v[176:179]
    ds_read_b64_tr_b16 a[212:213], v7 offset:0
    v_cvt_pk_bf16_f32 v212, v116, v117
    v_mfma_f32_16x16x32_bf16 v[176:179], a[180:183], v[88:91], v[176:179]
    v_exp_f32 v119, v119
    v_mov_b32 v26, v22
    v_mfma_f32_16x16x32_bf16 v[176:179], a[176:179], v[84:87], v[176:179]
    ds_read_b64_tr_b16 a[214:215], v7 offset:4096
    v_mov_b32 v27, v23
    v_mfma_f32_16x16x32_bf16 a[0:3], a[192:195], v[180:183], a[0:3]
    v_exp_f32 v120, v120
    v_mfma_f32_16x16x32_bf16 a[0:3], a[196:199], v[184:187], a[0:3]
    s_add_u32 m0, s46, 87040
    s_mov_b32 s45, 307200
    buffer_load_dwordx4 v254, s[20:23], s45 offen sc1 lds
    v_cvt_pk_bf16_f32 v213, v118, v119
    v_mfma_f32_16x16x32_bf16 a[4:7], a[196:199], v[192:195], a[4:7]
    v_exp_f32 v121, v121
    v_permlane16_swap_b32 v20, v24
    v_mfma_f32_16x16x32_bf16 a[4:7], a[192:195], v[188:191], a[4:7]
    s_add_u32 m0, s46, 88064
    s_mov_b32 s45, 308224
    buffer_load_dwordx4 v254, s[20:23], s45 offen sc1 lds
    v_mfma_f32_16x16x32_bf16 a[8:11], a[192:195], v[196:199], a[8:11]
    v_exp_f32 v122, v122
    v_permlane16_swap_b32 v21, v25
    v_mfma_f32_16x16x32_bf16 a[8:11], a[196:199], v[200:203], a[8:11]
    v_cvt_pk_bf16_f32 v220, v120, v121
    v_permlane16_swap_b32 v22, v26
    v_mfma_f32_16x16x32_bf16 a[12:15], a[196:199], v[208:211], a[12:15]
    v_exp_f32 v123, v123
    v_mfma_f32_16x16x32_bf16 a[12:15], a[192:195], v[204:207], a[12:15]
    s_waitcnt lgkmcnt(4)
    s_add_u32 m0, s46, 89088
    s_mov_b32 s45, 309248
    buffer_load_dwordx4 v254, s[20:23], s45 offen sc1 lds
    v_mfma_f32_16x16x32_bf16 a[16:19], a[200:203], v[180:183], a[16:19]
    ds_read_b64_tr_b16 a[216:217], v8 offset:57344
    v_cvt_pk_bf16_f32 v221, v122, v123
    v_exp_f32 v124, v124
    v_permlane16_swap_b32 v23, v27
    v_mfma_f32_16x16x32_bf16 a[16:19], a[204:207], v[184:187], a[16:19]
    ds_read_b64_tr_b16 a[218:219], v8 offset:61440
    v_exp_f32 v125, v125
    v_add_f32 v20, v20, v24
    v_mfma_f32_16x16x32_bf16 a[20:23], a[204:207], v[192:195], a[20:23]
    ds_read_b64_tr_b16 a[220:221], v8 offset:0
    v_cvt_pk_bf16_f32 v228, v124, v125
    v_exp_f32 v126, v126
    v_add_f32 v21, v21, v25
    v_mfma_f32_16x16x32_bf16 a[20:23], a[200:203], v[188:191], a[20:23]
    ds_read_b64_tr_b16 a[222:223], v8 offset:4096
    v_exp_f32 v127, v127
    v_mfma_f32_16x16x32_bf16 a[24:27], a[200:203], v[196:199], a[24:27]
    v_cvt_pk_bf16_f32 v229, v126, v127
    v_exp_f32 v128, v128
    v_mov_b32 v114, v254
    v_add_f32 v22, v22, v26
    v_mfma_f32_16x16x32_bf16 a[24:27], a[204:207], v[200:203], a[24:27]
    v_exp_f32 v129, v129
    v_add_f32 v23, v23, v27
    v_mfma_f32_16x16x32_bf16 a[28:31], a[204:207], v[208:211], a[28:31]
    v_cvt_pk_bf16_f32 v236, v128, v129
    v_exp_f32 v130, v130
    v_mov_b32 v24, v20
    v_mfma_f32_16x16x32_bf16 a[28:31], a[200:203], v[204:207], a[28:31]
    v_exp_f32 v131, v131
    v_mov_b32 v25, v21
    v_smfmac_f32_16x16x64_bf16 a[224:227], v[244:247], v[180:187], v248
    s_waitcnt lgkmcnt(4)
    s_add_u32 m0, s46, 90112
    s_mov_b32 s45, 310272
    buffer_load_dwordx4 v254, s[20:23], s45 offen sc1 lds
    v_add_u32 v115, 4096, v254
    v_mov_b32 v26, v22
    v_mfma_f32_16x16x32_bf16 a[32:35], a[208:211], v[180:183], a[32:35]
    ds_read_b64_tr_b16 a[192:193], v9 offset:57344
    v_cvt_pk_bf16_f32 v237, v130, v131
    v_exp_f32 v132, v132
    v_mfma_f32_16x16x32_bf16 a[32:35], a[212:215], v[184:187], a[32:35]
    ds_read_b64_tr_b16 a[194:195], v9 offset:61440
    v_exp_f32 v133, v133
    v_mov_b32 v27, v23
    v_mfma_f32_16x16x32_bf16 a[36:39], a[212:215], v[192:195], a[36:39]
    ds_read_b64_tr_b16 a[196:197], v9 offset:0
    v_cvt_pk_bf16_f32 v214, v132, v133
    v_exp_f32 v134, v134
    v_permlane32_swap_b32 v20, v24
    v_mfma_f32_16x16x32_bf16 a[36:39], a[208:211], v[188:191], a[36:39]
    ds_read_b64_tr_b16 a[198:199], v9 offset:4096
    v_exp_f32 v135, v135
    v_permlane32_swap_b32 v21, v25
    v_mfma_f32_16x16x32_bf16 a[40:43], a[208:211], v[196:199], a[40:43]
    v_cvt_pk_bf16_f32 v215, v134, v135
    v_exp_f32 v136, v136
    v_permlane32_swap_b32 v22, v26
    v_mfma_f32_16x16x32_bf16 a[40:43], a[212:215], v[200:203], a[40:43]
    v_exp_f32 v137, v137
    v_permlane32_swap_b32 v23, v27
    v_mfma_f32_16x16x32_bf16 a[44:47], a[212:215], v[208:211], a[44:47]
    v_cvt_pk_bf16_f32 v222, v136, v137
    v_exp_f32 v138, v138
    v_add_f32 v20, v20, v24
    v_mfma_f32_16x16x32_bf16 a[44:47], a[208:211], v[204:207], a[44:47]
    s_waitcnt lgkmcnt(4)
    s_add_u32 m0, s46, 91136
    s_mov_b32 s45, 311296
    buffer_load_dwordx4 v254, s[20:23], s45 offen sc1 lds
    v_exp_f32 v139, v139
    v_add_f32 v21, v21, v25
    v_mfma_f32_16x16x32_bf16 a[48:51], a[216:219], v[180:183], a[48:51]
    s_mov_b32 s45, 0
    ds_read_b64_tr_b16 a[200:201], v10 offset:57344
    v_cvt_pk_bf16_f32 v223, v138, v139
    v_exp_f32 v140, v140
    v_add_f32 v22, v22, v26
    v_mfma_f32_16x16x32_bf16 a[48:51], a[220:223], v[184:187], a[48:51]
    ds_read_b64_tr_b16 a[202:203], v10 offset:61440
    v_exp_f32 v141, v141
    v_add_f32 v23, v23, v27
    v_mfma_f32_16x16x32_bf16 a[52:55], a[220:223], v[192:195], a[52:55]
    ds_read_b64_tr_b16 a[204:205], v10 offset:0
    buffer_load_dwordx4 a[128:131], v114, s[20:23], s45 offen offset:0 sc1
    v_cvt_pk_bf16_f32 v230, v140, v141
    v_exp_f32 v142, v142
    v_and_b32 v255, 7, v19
    v_mfma_f32_16x16x32_bf16 a[52:55], a[216:219], v[188:191], a[52:55]
    s_mov_b32 s45, 0
    ds_read_b64_tr_b16 a[206:207], v10 offset:4096
    v_exp_f32 v143, v143
    v_mfma_f32_16x16x32_bf16 a[56:59], a[216:219], v[196:199], a[56:59]
    v_cvt_pk_bf16_f32 v231, v142, v143
    v_exp_f32 v144, v144
    v_lshlrev_b32 v255, 4, v255
    v_mfma_f32_16x16x32_bf16 a[56:59], a[220:223], v[200:203], a[56:59]
    buffer_load_dwordx4 a[132:135], v114, s[20:23], s45 offen offset:1024 sc1
    v_exp_f32 v145, v145
    v_add_u32 v255, 65536, v255
    v_mfma_f32_16x16x32_bf16 a[60:63], a[220:223], v[208:211], a[60:63]
    s_mov_b32 s45, 0
    v_cvt_pk_bf16_f32 v238, v144, v145
    v_exp_f32 v146, v146
    v_mfma_f32_16x16x32_bf16 a[60:63], a[216:219], v[204:207], a[60:63]
    s_lshl_b32 s40, s5, 7
    v_exp_f32 v147, v147
    v_add_u32 v24, s40, v255
    v_smfmac_f32_16x16x64_bf16 a[228:231], v[244:247], v[188:195], v248
    s_waitcnt lgkmcnt(4)
    buffer_load_dwordx4 a[136:139], v114, s[20:23], s45 offen offset:2048 sc1
    ds_write_b128 v24, v[20:23]
    v_mfma_f32_16x16x32_bf16 a[64:67], a[192:195], v[180:183], a[64:67]
    s_mov_b32 s45, 0
    ds_read_b64_tr_b16 a[208:209], v11 offset:57344
    v_cvt_pk_bf16_f32 v239, v146, v147
    v_exp_f32 v148, v148
    v_mfma_f32_16x16x32_bf16 a[64:67], a[196:199], v[184:187], a[64:67]
    ds_read_b64_tr_b16 a[210:211], v11 offset:61440
    buffer_load_dwordx4 a[140:143], v114, s[20:23], s45 offen offset:3072 sc1
    v_exp_f32 v149, v149
    v_mfma_f32_16x16x32_bf16 a[68:71], a[196:199], v[192:195], a[68:71]
    s_mov_b32 s45, 0
    ds_read_b64_tr_b16 a[212:213], v11 offset:0
    v_cvt_pk_bf16_f32 v216, v148, v149
    v_exp_f32 v150, v150
    v_mfma_f32_16x16x32_bf16 a[68:71], a[192:195], v[188:191], a[68:71]
    ds_read_b64_tr_b16 a[214:215], v11 offset:4096
    v_exp_f32 v151, v151
    v_mfma_f32_16x16x32_bf16 a[72:75], a[192:195], v[196:199], a[72:75]
    buffer_load_dwordx4 a[144:147], v115, s[20:23], s45 offen offset:0 sc1
    v_cvt_pk_bf16_f32 v217, v150, v151
    v_exp_f32 v152, v152
    v_mfma_f32_16x16x32_bf16 a[72:75], a[196:199], v[200:203], a[72:75]
    s_mov_b32 s45, 20480
    v_exp_f32 v153, v153
    v_mfma_f32_16x16x32_bf16 a[76:79], a[196:199], v[208:211], a[76:79]
    buffer_load_dwordx4 a[148:151], v114, s[20:23], s45 offen offset:0 sc1
    v_cvt_pk_bf16_f32 v224, v152, v153
    v_exp_f32 v154, v154
    v_mfma_f32_16x16x32_bf16 a[76:79], a[192:195], v[204:207], a[76:79]
    s_waitcnt lgkmcnt(4)
    v_exp_f32 v155, v155
    v_mfma_f32_16x16x32_bf16 a[80:83], a[200:203], v[180:183], a[80:83]
    s_mov_b32 s45, 20480
    ds_read_b64_tr_b16 a[216:217], v12 offset:57344
    v_cvt_pk_bf16_f32 v225, v154, v155
    v_exp_f32 v156, v156
    v_mfma_f32_16x16x32_bf16 a[80:83], a[204:207], v[184:187], a[80:83]
    ds_read_b64_tr_b16 a[218:219], v12 offset:61440
    buffer_load_dwordx4 a[152:155], v114, s[20:23], s45 offen offset:1024 sc1
    v_exp_f32 v157, v157
    v_mfma_f32_16x16x32_bf16 a[84:87], a[204:207], v[192:195], a[84:87]
    s_mov_b32 s45, 20480
    ds_read_b64_tr_b16 a[220:221], v12 offset:0
    v_cvt_pk_bf16_f32 v232, v156, v157
    v_exp_f32 v158, v158
    v_mfma_f32_16x16x32_bf16 a[84:87], a[200:203], v[188:191], a[84:87]
    ds_read_b64_tr_b16 a[222:223], v12 offset:4096
    v_exp_f32 v159, v159
    v_mfma_f32_16x16x32_bf16 a[88:91], a[200:203], v[196:199], a[88:91]
    buffer_load_dwordx4 a[156:159], v114, s[20:23], s45 offen offset:2048 sc1
    v_cvt_pk_bf16_f32 v233, v158, v159
    v_exp_f32 v160, v160
    v_mfma_f32_16x16x32_bf16 a[88:91], a[204:207], v[200:203], a[88:91]
    s_mov_b32 s45, 20480
    v_exp_f32 v161, v161
    v_mfma_f32_16x16x32_bf16 a[92:95], a[204:207], v[208:211], a[92:95]
    v_cvt_pk_bf16_f32 v240, v160, v161
    v_exp_f32 v162, v162
    v_mfma_f32_16x16x32_bf16 a[92:95], a[200:203], v[204:207], a[92:95]
    buffer_load_dwordx4 a[160:163], v114, s[20:23], s45 offen offset:3072 sc1
    v_exp_f32 v163, v163
    v_smfmac_f32_16x16x64_bf16 a[232:235], v[244:247], v[196:203], v248
    s_waitcnt vmcnt(26) lgkmcnt(0)
    s_barrier
    v_mfma_f32_16x16x32_bf16 a[96:99], a[208:211], v[180:183], a[96:99]
    s_mov_b32 s45, 20480
    ds_read_b64_tr_b16 a[192:193], v5 offset:24576
    buffer_load_dwordx4 a[164:167], v115, s[20:23], s45 offen offset:0 sc1
    ds_read_b128 v[20:23], v255 offset:0
    ds_read_b128 v[24:27], v255 offset:128
    ds_read_b128 v[28:31], v255 offset:256
    v_cvt_pk_bf16_f32 v241, v162, v163
    v_exp_f32 v164, v164
    v_mfma_f32_16x16x32_bf16 a[96:99], a[212:215], v[184:187], a[96:99]
    s_mov_b32 s45, 40960
    ds_read_b64_tr_b16 a[194:195], v5 offset:28672
    ds_read_b128 v[32:35], v255 offset:384
    v_exp_f32 v165, v165
    v_mfma_f32_16x16x32_bf16 a[100:103], a[212:215], v[192:195], a[100:103]
    s_mul_i32 s42, s6, 3277
    ds_read_b64_tr_b16 a[196:197], v5 offset:49152
    v_cvt_pk_bf16_f32 v218, v164, v165
    v_exp_f32 v166, v166
    v_mfma_f32_16x16x32_bf16 a[100:103], a[208:211], v[188:191], a[100:103]
    s_lshr_b32 s42, s42, 16
    ds_read_b64_tr_b16 a[198:199], v5 offset:53248
    buffer_load_dwordx4 a[168:171], v114, s[20:23], s45 offen offset:0 sc1
    v_exp_f32 v167, v167
    v_mfma_f32_16x16x32_bf16 a[104:107], a[208:211], v[196:199], a[104:107]
    s_mov_b32 s45, 40960
    v_cvt_pk_bf16_f32 v219, v166, v167
    v_exp_f32 v168, v168
    v_mfma_f32_16x16x32_bf16 a[104:107], a[212:215], v[200:203], a[104:107]
    s_min_u32 s42, s42, 7
    buffer_load_dwordx4 a[172:175], v114, s[20:23], s45 offen offset:1024 sc1
    v_exp_f32 v169, v169
    v_readlane_b32 s40, v249, s42
    v_mfma_f32_16x16x32_bf16 a[108:111], a[212:215], v[208:211], a[108:111]
    s_mov_b32 s45, 40960
    v_cvt_pk_bf16_f32 v226, v168, v169
    v_exp_f32 v170, v170
    v_mfma_f32_16x16x32_bf16 a[108:111], a[208:211], v[204:207], a[108:111]
    s_waitcnt lgkmcnt(4)
    v_exp_f32 v171, v171
    v_mfma_f32_16x16x32_bf16 a[112:115], a[216:219], v[180:183], a[112:115]
    s_and_b32 s40, s40, 0xffff0000
    ds_read_b64_tr_b16 a[200:201], v6 offset:24576
    buffer_load_dwordx4 a[176:179], v114, s[20:23], s45 offen offset:2048 sc1
    v_cvt_pk_bf16_f32 v227, v170, v171
    v_exp_f32 v172, v172
    v_mfma_f32_16x16x32_bf16 a[112:115], a[220:223], v[184:187], a[112:115]
    s_mov_b32 s45, 40960
    ds_read_b64_tr_b16 a[202:203], v6 offset:28672
    v_exp_f32 v173, v173
    v_mfma_f32_16x16x32_bf16 a[116:119], a[220:223], v[192:195], a[116:119]
    s_ashr_i32 s41, s40, 31
    ds_read_b64_tr_b16 a[204:205], v6 offset:49152
    v_cvt_pk_bf16_f32 v234, v172, v173
    v_exp_f32 v174, v174
    v_mfma_f32_16x16x32_bf16 a[116:119], a[216:219], v[188:191], a[116:119]
    s_andn2_b32 s41, 0x7fff0000, s41
    ds_read_b64_tr_b16 a[206:207], v6 offset:53248
    buffer_load_dwordx4 a[180:183], v114, s[20:23], s45 offen offset:3072 sc1
    v_exp_f32 v175, v175
    v_mfma_f32_16x16x32_bf16 a[120:123], a[216:219], v[196:199], a[120:123]
    s_mov_b32 s45, 40960
    v_cvt_pk_bf16_f32 v235, v174, v175
    v_exp_f32 v176, v176
    v_mfma_f32_16x16x32_bf16 a[120:123], a[220:223], v[200:203], a[120:123]
    s_or_b32 s41, s41, 0x80000000
    v_exp_f32 v177, v177
    v_mfma_f32_16x16x32_bf16 a[124:127], a[220:223], v[208:211], a[124:127]
    s_xor_b32 s40, s40, s41
    buffer_load_dwordx4 a[184:187], v115, s[20:23], s45 offen offset:0 sc1
    v_cvt_pk_bf16_f32 v242, v176, v177
    v_exp_f32 v178, v178
    v_mov_b32 v252, 0xbfb8aa3b
    v_mul_f32 v252, s40, v252
    v_exp_f32 v252, v252
    v_mfma_f32_16x16x32_bf16 a[124:127], a[216:219], v[204:207], a[124:127]
    s_mov_b32 s45, 61440
    v_exp_f32 v179, v179
    v_smfmac_f32_16x16x64_bf16 a[236:239], v[244:247], v[204:211], v248
    s_waitcnt lgkmcnt(4)
    s_nop 0
    buffer_load_dwordx4 a[188:191], v114, s[20:23], s45 offen offset:0 sc1
    v_add_f32 v252, 1.0, v252
    v_rcp_f32 v252, v252
    s_nop 0
    v_cvt_pk_bf16_f32 v252, v252, v252
    v_lshlrev_b32 v252, 16, v252
    s_lshl_b32 s40, s6, 6
    s_add_u32 s40, s40, 0x29c000
    s_lshl_b32 s41, s5, 8
    s_add_u32 s41, s41, s6
    s_cmp_lt_u32 s41, 160
    s_cselect_b32 s40, s40, 0x2500000
    v_lshlrev_b32 v253, 3, v19
    s_waitcnt lgkmcnt(0)
    v_add_f32 v20, v20, v24
    v_add_f32 v21, v21, v25
    v_add_f32 v22, v22, v26
    v_add_f32 v23, v23, v27
    v_add_f32 v20, v20, v28
    v_add_f32 v21, v21, v29
    v_add_f32 v22, v22, v30
    v_add_f32 v23, v23, v31
    v_add_f32 v20, v20, v32
    v_add_f32 v21, v21, v33
    v_add_f32 v22, v22, v34
    v_add_f32 v23, v23, v35
    v_cvt_pk_bf16_f32 v24, v20, v21
    v_cvt_pk_bf16_f32 v25, v22, v23
    v_lshlrev_b32 v20, 16, v24
    v_and_b32 v21, 0xffff0000, v24
    v_lshlrev_b32 v22, 16, v25
    v_and_b32 v23, 0xffff0000, v25
    v_mul_f32 v20, v20, v252
    v_mul_f32 v21, v21, v252
    v_mul_f32 v22, v22, v252
    v_mul_f32 v23, v23, v252
    v_cvt_pk_bf16_f32 v24, v20, v21
    v_cvt_pk_bf16_f32 v25, v22, v23
    s_mov_b64 exec, 0xff
    buffer_store_dwordx2 v[24:25], v253, s[76:79], s40 offen sc1
    s_mov_b64 exec, -1
    v_mfma_f32_16x16x32_bf16 a[0:3], a[192:195], v[212:215], a[0:3]
    s_lshl_b32 s40, s87, 2
    ds_read_b64_tr_b16 a[208:209], v7 offset:24576
    v_cvt_pk_bf16_f32 v243, v178, v179
    v_mfma_f32_16x16x32_bf16 a[0:3], a[196:199], v[216:219], a[0:3]
    s_add_u32 s40, s40, s5
    ds_read_b64_tr_b16 a[210:211], v7 offset:28672
    v_smfmac_f32_16x16x64_bf16 a[224:227], v[244:247], v[212:219], v248
    s_lshl_b32 s40, s40, 4
    ds_read_b64_tr_b16 a[212:213], v7 offset:49152
    v_and_b32 v35, 15, v19
    v_smfmac_f32_16x16x64_bf16 a[228:231], v[244:247], v[220:227], v248
    ds_read_b64_tr_b16 a[214:215], v7 offset:53248
    v_add_u32 v35, s40, v35
    v_smfmac_f32_16x16x64_bf16 a[232:235], v[244:247], v[228:235], v248
    v_mul_u32_u24 v34, 1280, v35
    v_lshrrev_b32 v116, 4, v19
    v_smfmac_f32_16x16x64_bf16 a[236:239], v[244:247], v[236:243], v248
    v_lshl_add_u32 v34, v116, 3, v34
    v_mfma_f32_16x16x32_bf16 a[4:7], a[196:199], v[224:227], a[4:7]
    s_mul_i32 s40, s100, 160
    v_add_u32 v34, s40, v34
    v_lshlrev_b32 v116, 4, v35
    v_mfma_f32_16x16x32_bf16 a[4:7], a[192:195], v[220:223], a[4:7]
    s_mov_b32 s40, 0x280000
    buffer_load_dwordx2 v[32:33], v116, s[76:79], s40 offen sc1
    v_mfma_f32_16x16x32_bf16 a[8:11], a[192:195], v[228:231], a[8:11]
    buffer_load_dwordx2 v[22:23], v34, s[88:91], 0 offen offset:0
    v_mfma_f32_16x16x32_bf16 a[8:11], a[196:199], v[232:235], a[8:11]
    buffer_load_dwordx2 v[24:25], v34, s[88:91], 0 offen offset:32
    v_mfma_f32_16x16x32_bf16 a[12:15], a[196:199], v[240:243], a[12:15]
    buffer_load_dwordx2 v[26:27], v34, s[88:91], 0 offen offset:64
    v_mfma_f32_16x16x32_bf16 a[12:15], a[192:195], v[236:239], a[12:15]
    s_waitcnt lgkmcnt(4)
    buffer_load_dwordx2 v[28:29], v34, s[88:91], 0 offen offset:96
    v_mfma_f32_16x16x32_bf16 a[16:19], a[200:203], v[212:215], a[16:19]
    ds_read_b64_tr_b16 a[216:217], v8 offset:24576
    v_accvgpr_read_b32 v100, a224
    v_mfma_f32_16x16x32_bf16 a[16:19], a[204:207], v[216:219], a[16:19]
    ds_read_b64_tr_b16 a[218:219], v8 offset:28672
    v_accvgpr_read_b32 v104, a225
    v_accvgpr_read_b32 v101, a228
    v_accvgpr_read_b32 v105, a229
    v_mfma_f32_16x16x32_bf16 a[20:23], a[204:207], v[224:227], a[20:23]
    ds_read_b64_tr_b16 a[220:221], v8 offset:49152
    v_accvgpr_read_b32 v102, a232
    v_accvgpr_read_b32 v106, a233
    v_mfma_f32_16x16x32_bf16 a[20:23], a[200:203], v[220:223], a[20:23]
    ds_read_b64_tr_b16 a[222:223], v8 offset:53248
    v_accvgpr_read_b32 v103, a236
    v_accvgpr_read_b32 v107, a237
    v_add_f32 v100, v100, v104
    v_mfma_f32_16x16x32_bf16 a[24:27], a[200:203], v[228:231], a[24:27]
    buffer_load_dwordx2 v[30:31], v34, s[88:91], 0 offen offset:128
    v_add_f32 v101, v101, v105
    v_add_f32 v102, v102, v106
    v_add_f32 v103, v103, v107
    v_mfma_f32_16x16x32_bf16 a[24:27], a[204:207], v[232:235], a[24:27]
    v_maximum3_f32 v108, v100, v101, v102
    v_maximum3_f32 v108, v108, v103, v103
    v_mfma_f32_16x16x32_bf16 a[28:31], a[204:207], v[240:243], a[28:31]
    v_mul_f32 v108, 0x4d800000, v108
    v_mov_b32 v109, 0
    v_lshlrev_b32 v110, 4, v19
    v_mfma_f32_16x16x32_bf16 a[28:31], a[200:203], v[236:239], a[28:31]
    s_waitcnt lgkmcnt(4)
    v_rcp_f32 v100, v100
    v_rcp_f32 v101, v101
    v_rcp_f32 v102, v102
    v_rcp_f32 v103, v103
    v_mfma_f32_16x16x32_bf16 a[32:35], a[208:211], v[212:215], a[32:35]
    s_mov_b32 s36, 0
    ds_read_b64_tr_b16 a[192:193], v9 offset:24576
    v_accvgpr_read_b32 v120, a0
    v_accvgpr_read_b32 v121, a1
    v_accvgpr_read_b32 v122, a2
    v_accvgpr_read_b32 v123, a3
    v_mfma_f32_16x16x32_bf16 a[32:35], a[212:215], v[216:219], a[32:35]
    ds_read_b64_tr_b16 a[194:195], v9 offset:28672
    v_accvgpr_read_b32 v124, a16
    v_accvgpr_read_b32 v125, a17
    v_accvgpr_read_b32 v126, a18
    v_accvgpr_read_b32 v127, a19
    v_maximum3_f32 v108, v108, |v120|, |v121|
    v_maximum3_f32 v109, v109, |v122|, |v123|
    v_mfma_f32_16x16x32_bf16 a[36:39], a[212:215], v[224:227], a[36:39]
    ds_read_b64_tr_b16 a[196:197], v9 offset:49152
    v_maximum3_f32 v108, v108, |v124|, |v125|
    v_maximum3_f32 v109, v109, |v126|, |v127|
    v_mul_f32 v120, v120, v100
    v_mul_f32 v121, v121, v100
    v_mul_f32 v122, v122, v100
    v_mul_f32 v123, v123, v100
    v_mfma_f32_16x16x32_bf16 a[36:39], a[208:211], v[220:223], a[36:39]
    ds_read_b64_tr_b16 a[198:199], v9 offset:53248
    v_mul_f32 v124, v124, v100
    v_mul_f32 v125, v125, v100
    v_mul_f32 v126, v126, v100
    v_mul_f32 v127, v127, v100
    v_cvt_pk_bf16_f32 v152, v120, v121
    v_cvt_pk_bf16_f32 v153, v122, v123
    v_cvt_pk_bf16_f32 v154, v124, v125
    v_mfma_f32_16x16x32_bf16 a[40:43], a[208:211], v[228:231], a[40:43]
    v_cvt_pk_bf16_f32 v155, v126, v127
    v_mfma_f32_16x16x32_bf16 a[40:43], a[212:215], v[232:235], a[40:43]
    buffer_store_dwordx4 v[152:155], v110, s[24:27], s36 offen offset:0 sc1
    v_accvgpr_read_b32 v128, a4
    v_accvgpr_read_b32 v129, a5
    v_accvgpr_read_b32 v130, a6
    v_accvgpr_read_b32 v131, a7
    v_accvgpr_read_b32 v132, a20
    v_accvgpr_read_b32 v133, a21
    v_accvgpr_read_b32 v134, a22
    v_accvgpr_read_b32 v135, a23
    v_maximum3_f32 v108, v108, |v128|, |v129|
    v_maximum3_f32 v109, v109, |v130|, |v131|
    v_mfma_f32_16x16x32_bf16 a[44:47], a[212:215], v[240:243], a[44:47]
    v_maximum3_f32 v108, v108, |v132|, |v133|
    v_maximum3_f32 v109, v109, |v134|, |v135|
    v_mul_f32 v128, v128, v101
    v_mul_f32 v129, v129, v101
    v_mul_f32 v130, v130, v101
    v_mul_f32 v131, v131, v101
    v_mul_f32 v132, v132, v101
    v_mfma_f32_16x16x32_bf16 a[44:47], a[208:211], v[236:239], a[44:47]
    s_waitcnt lgkmcnt(4)
    v_mul_f32 v133, v133, v101
    v_mul_f32 v134, v134, v101
    v_mul_f32 v135, v135, v101
    v_cvt_pk_bf16_f32 v156, v128, v129
    v_cvt_pk_bf16_f32 v157, v130, v131
    v_cvt_pk_bf16_f32 v158, v132, v133
    v_mfma_f32_16x16x32_bf16 a[48:51], a[216:219], v[212:215], a[48:51]
    ds_read_b64_tr_b16 a[200:201], v10 offset:24576
    v_cvt_pk_bf16_f32 v159, v134, v135
    v_mfma_f32_16x16x32_bf16 a[48:51], a[220:223], v[216:219], a[48:51]
    ds_read_b64_tr_b16 a[202:203], v10 offset:28672
    buffer_store_dwordx4 v[156:159], v110, s[24:27], s36 offen offset:1024 sc1
    v_accvgpr_read_b32 v136, a8
    v_accvgpr_read_b32 v137, a9
    v_accvgpr_read_b32 v138, a10
    v_accvgpr_read_b32 v139, a11
    v_accvgpr_read_b32 v140, a24
    v_accvgpr_read_b32 v141, a25
    v_accvgpr_read_b32 v142, a26
    v_accvgpr_read_b32 v143, a27
    v_maximum3_f32 v108, v108, |v136|, |v137|
    v_maximum3_f32 v109, v109, |v138|, |v139|
    v_maximum3_f32 v108, v108, |v140|, |v141|
    v_mfma_f32_16x16x32_bf16 a[52:55], a[220:223], v[224:227], a[52:55]
    ds_read_b64_tr_b16 a[204:205], v10 offset:49152
    v_maximum3_f32 v109, v109, |v142|, |v143|
    v_mul_f32 v136, v136, v102
    v_mul_f32 v137, v137, v102
    v_mul_f32 v138, v138, v102
    v_mul_f32 v139, v139, v102
    v_mul_f32 v140, v140, v102
    v_mfma_f32_16x16x32_bf16 a[52:55], a[216:219], v[220:223], a[52:55]
    ds_read_b64_tr_b16 a[206:207], v10 offset:53248
    v_mul_f32 v141, v141, v102
    v_mul_f32 v142, v142, v102
    v_mul_f32 v143, v143, v102
    v_cvt_pk_bf16_f32 v160, v136, v137
    v_cvt_pk_bf16_f32 v161, v138, v139
    v_cvt_pk_bf16_f32 v162, v140, v141
    v_mfma_f32_16x16x32_bf16 a[56:59], a[216:219], v[228:231], a[56:59]
    v_cvt_pk_bf16_f32 v163, v142, v143
    v_mfma_f32_16x16x32_bf16 a[56:59], a[220:223], v[232:235], a[56:59]
    buffer_store_dwordx4 v[160:163], v110, s[24:27], s36 offen offset:2048 sc1
    v_accvgpr_read_b32 v144, a12
    v_accvgpr_read_b32 v145, a13
    v_accvgpr_read_b32 v146, a14
    v_accvgpr_read_b32 v147, a15
    v_accvgpr_read_b32 v148, a28
    v_accvgpr_read_b32 v149, a29
    v_accvgpr_read_b32 v150, a30
    v_accvgpr_read_b32 v151, a31
    v_maximum3_f32 v108, v108, |v144|, |v145|
    v_maximum3_f32 v109, v109, |v146|, |v147|
    v_maximum3_f32 v108, v108, |v148|, |v149|
    v_mfma_f32_16x16x32_bf16 a[60:63], a[220:223], v[240:243], a[60:63]
    v_maximum3_f32 v109, v109, |v150|, |v151|
    v_mul_f32 v144, v144, v103
    v_mul_f32 v145, v145, v103
    v_mul_f32 v146, v146, v103
    v_mul_f32 v147, v147, v103
    v_mul_f32 v148, v148, v103
    v_mfma_f32_16x16x32_bf16 a[60:63], a[216:219], v[236:239], a[60:63]
    s_waitcnt lgkmcnt(4)
    v_mul_f32 v149, v149, v103
    v_mul_f32 v150, v150, v103
    v_mul_f32 v151, v151, v103
    v_cvt_pk_bf16_f32 v164, v144, v145
    v_cvt_pk_bf16_f32 v165, v146, v147
    v_cvt_pk_bf16_f32 v166, v148, v149
    v_cvt_pk_bf16_f32 v167, v150, v151
    buffer_store_dwordx4 v[164:167], v110, s[24:27], s36 offen offset:3072 sc1
    v_mfma_f32_16x16x32_bf16 a[64:67], a[192:195], v[212:215], a[64:67]
    s_mov_b32 s36, 4096
    ds_read_b64_tr_b16 a[208:209], v11 offset:24576
    v_accvgpr_read_b32 v120, a32
    v_accvgpr_read_b32 v121, a33
    v_accvgpr_read_b32 v122, a34
    v_accvgpr_read_b32 v123, a35
    v_accvgpr_read_b32 v124, a48
    v_mfma_f32_16x16x32_bf16 a[64:67], a[196:199], v[216:219], a[64:67]
    ds_read_b64_tr_b16 a[210:211], v11 offset:28672
    v_accvgpr_read_b32 v125, a49
    v_accvgpr_read_b32 v126, a50
    v_accvgpr_read_b32 v127, a51
    v_maximum3_f32 v108, v108, |v120|, |v121|
    v_maximum3_f32 v109, v109, |v122|, |v123|
    v_maximum3_f32 v108, v108, |v124|, |v125|
    v_maximum3_f32 v109, v109, |v126|, |v127|
    v_mfma_f32_16x16x32_bf16 a[68:71], a[196:199], v[224:227], a[68:71]
    ds_read_b64_tr_b16 a[212:213], v11 offset:49152
    v_mul_f32 v120, v120, v100
    v_mul_f32 v121, v121, v100
    v_mul_f32 v122, v122, v100
    v_mul_f32 v123, v123, v100
    v_mul_f32 v124, v124, v100
    v_mul_f32 v125, v125, v100
    v_mul_f32 v126, v126, v100
    v_mfma_f32_16x16x32_bf16 a[68:71], a[192:195], v[220:223], a[68:71]
    ds_read_b64_tr_b16 a[214:215], v11 offset:53248
    v_mul_f32 v127, v127, v100
    v_cvt_pk_bf16_f32 v152, v120, v121
    v_cvt_pk_bf16_f32 v153, v122, v123
    v_cvt_pk_bf16_f32 v154, v124, v125
    v_cvt_pk_bf16_f32 v155, v126, v127
    v_mfma_f32_16x16x32_bf16 a[72:75], a[192:195], v[228:231], a[72:75]
    buffer_store_dwordx4 v[152:155], v110, s[24:27], s36 offen offset:0 sc1
    v_mfma_f32_16x16x32_bf16 a[72:75], a[196:199], v[232:235], a[72:75]
    s_mov_b32 s45, 61440
    buffer_load_dwordx4 a[0:3], v114, s[20:23], s45 offen offset:1024 sc1
    v_mfma_f32_16x16x32_bf16 a[76:79], a[196:199], v[240:243], a[76:79]
    s_mov_b32 s45, 61440
    buffer_load_dwordx4 a[4:7], v114, s[20:23], s45 offen offset:2048 sc1
    v_accvgpr_read_b32 v128, a36
    v_accvgpr_read_b32 v129, a37
    v_accvgpr_read_b32 v130, a38
    v_accvgpr_read_b32 v131, a39
    v_accvgpr_read_b32 v132, a52
    v_accvgpr_read_b32 v133, a53
    v_accvgpr_read_b32 v134, a54
    v_accvgpr_read_b32 v135, a55
    v_maximum3_f32 v108, v108, |v128|, |v129|
    v_maximum3_f32 v109, v109, |v130|, |v131|
    v_maximum3_f32 v108, v108, |v132|, |v133|
    v_maximum3_f32 v109, v109, |v134|, |v135|
    v_mul_f32 v128, v128, v101
    v_mul_f32 v129, v129, v101
    v_mul_f32 v130, v130, v101
    v_mul_f32 v131, v131, v101
    v_mul_f32 v132, v132, v101
    v_mul_f32 v133, v133, v101
    v_mul_f32 v134, v134, v101
    v_mul_f32 v135, v135, v101
    v_mfma_f32_16x16x32_bf16 a[76:79], a[192:195], v[236:239], a[76:79]
    s_waitcnt lgkmcnt(4)
    v_cvt_pk_bf16_f32 v156, v128, v129
    v_cvt_pk_bf16_f32 v157, v130, v131
    v_cvt_pk_bf16_f32 v158, v132, v133
    v_cvt_pk_bf16_f32 v159, v134, v135
    v_mfma_f32_16x16x32_bf16 a[80:83], a[200:203], v[212:215], a[80:83]
    ds_read_b64_tr_b16 a[216:217], v12 offset:24576
    buffer_store_dwordx4 v[156:159], v110, s[24:27], s36 offen offset:1024 sc1
    v_mfma_f32_16x16x32_bf16 a[80:83], a[204:207], v[216:219], a[80:83]
    s_mov_b32 s45, 61440
    ds_read_b64_tr_b16 a[218:219], v12 offset:28672
    buffer_load_dwordx4 a[8:11], v114, s[20:23], s45 offen offset:3072 sc1
    v_mfma_f32_16x16x32_bf16 a[84:87], a[204:207], v[224:227], a[84:87]
    s_mov_b32 s45, 61440
    ds_read_b64_tr_b16 a[220:221], v12 offset:49152
    buffer_load_dwordx4 a[12:15], v115, s[20:23], s45 offen offset:0 sc1
    v_accvgpr_read_b32 v136, a40
    v_accvgpr_read_b32 v137, a41
    v_accvgpr_read_b32 v138, a42
    v_accvgpr_read_b32 v139, a43
    v_accvgpr_read_b32 v140, a56
    v_accvgpr_read_b32 v141, a57
    v_accvgpr_read_b32 v142, a58
    v_accvgpr_read_b32 v143, a59
    v_maximum3_f32 v108, v108, |v136|, |v137|
    v_maximum3_f32 v109, v109, |v138|, |v139|
    v_maximum3_f32 v108, v108, |v140|, |v141|
    v_maximum3_f32 v109, v109, |v142|, |v143|
    v_mul_f32 v136, v136, v102
    v_mul_f32 v137, v137, v102
    v_mul_f32 v138, v138, v102
    v_mul_f32 v139, v139, v102
    v_mul_f32 v140, v140, v102
    v_mul_f32 v141, v141, v102
    v_mul_f32 v142, v142, v102
    v_mul_f32 v143, v143, v102
    v_mfma_f32_16x16x32_bf16 a[84:87], a[200:203], v[220:223], a[84:87]
    ds_read_b64_tr_b16 a[222:223], v12 offset:53248
    v_cvt_pk_bf16_f32 v160, v136, v137
    v_cvt_pk_bf16_f32 v161, v138, v139
    v_cvt_pk_bf16_f32 v162, v140, v141
    v_cvt_pk_bf16_f32 v163, v142, v143
    v_mfma_f32_16x16x32_bf16 a[88:91], a[200:203], v[228:231], a[88:91]
    buffer_store_dwordx4 v[160:163], v110, s[24:27], s36 offen offset:2048 sc1
    v_mfma_f32_16x16x32_bf16 a[88:91], a[204:207], v[232:235], a[88:91]
    s_mov_b32 s45, 81920
    buffer_load_dwordx4 a[16:19], v114, s[20:23], s45 offen offset:0 sc1
    v_mfma_f32_16x16x32_bf16 a[92:95], a[204:207], v[240:243], a[92:95]
    s_mov_b32 s45, 81920
    buffer_load_dwordx4 a[20:23], v114, s[20:23], s45 offen offset:1024 sc1
    v_accvgpr_read_b32 v144, a44
    v_accvgpr_read_b32 v145, a45
    v_accvgpr_read_b32 v146, a46
    v_accvgpr_read_b32 v147, a47
    v_accvgpr_read_b32 v148, a60
    v_accvgpr_read_b32 v149, a61
    v_accvgpr_read_b32 v150, a62
    v_accvgpr_read_b32 v151, a63
    v_maximum3_f32 v108, v108, |v144|, |v145|
    v_maximum3_f32 v109, v109, |v146|, |v147|
    v_maximum3_f32 v108, v108, |v148|, |v149|
    v_maximum3_f32 v109, v109, |v150|, |v151|
    v_mul_f32 v144, v144, v103
    v_mul_f32 v145, v145, v103
    v_mul_f32 v146, v146, v103
    v_mul_f32 v147, v147, v103
    v_mul_f32 v148, v148, v103
    v_mul_f32 v149, v149, v103
    v_mul_f32 v150, v150, v103
    v_mul_f32 v151, v151, v103
    v_mfma_f32_16x16x32_bf16 a[92:95], a[200:203], v[236:239], a[92:95]
    s_waitcnt lgkmcnt(4)
    v_cvt_pk_bf16_f32 v164, v144, v145
    v_cvt_pk_bf16_f32 v165, v146, v147
    v_cvt_pk_bf16_f32 v166, v148, v149
    v_cvt_pk_bf16_f32 v167, v150, v151
    buffer_store_dwordx4 v[164:167], v110, s[24:27], s36 offen offset:3072 sc1
    s_mov_b32 s45, 81920
    buffer_load_dwordx4 a[24:27], v114, s[20:23], s45 offen offset:2048 sc1
    s_mov_b32 s45, 81920
    buffer_load_dwordx4 a[28:31], v114, s[20:23], s45 offen offset:3072 sc1
    v_mfma_f32_16x16x32_bf16 a[96:99], a[208:211], v[212:215], a[96:99]
    s_mov_b32 s36, 8192
    v_accvgpr_read_b32 v120, a64
    v_accvgpr_read_b32 v121, a65
    v_accvgpr_read_b32 v122, a66
    v_accvgpr_read_b32 v123, a67
    v_accvgpr_read_b32 v124, a80
    v_mfma_f32_16x16x32_bf16 a[96:99], a[212:215], v[216:219], a[96:99]
    v_accvgpr_read_b32 v125, a81
    v_accvgpr_read_b32 v126, a82
    v_accvgpr_read_b32 v127, a83
    v_maximum3_f32 v108, v108, |v120|, |v121|
    v_maximum3_f32 v109, v109, |v122|, |v123|
    v_maximum3_f32 v108, v108, |v124|, |v125|
    v_maximum3_f32 v109, v109, |v126|, |v127|
    v_mfma_f32_16x16x32_bf16 a[100:103], a[212:215], v[224:227], a[100:103]
    v_mul_f32 v120, v120, v100
    v_mul_f32 v121, v121, v100
    v_mul_f32 v122, v122, v100
    v_mul_f32 v123, v123, v100
    v_mul_f32 v124, v124, v100
    v_mul_f32 v125, v125, v100
    v_mul_f32 v126, v126, v100
    v_mfma_f32_16x16x32_bf16 a[100:103], a[208:211], v[220:223], a[100:103]
    v_mul_f32 v127, v127, v100
    v_cvt_pk_bf16_f32 v152, v120, v121
    v_cvt_pk_bf16_f32 v153, v122, v123
    v_cvt_pk_bf16_f32 v154, v124, v125
    v_cvt_pk_bf16_f32 v155, v126, v127
    v_mfma_f32_16x16x32_bf16 a[104:107], a[208:211], v[228:231], a[104:107]
    buffer_store_dwordx4 v[152:155], v110, s[24:27], s36 offen offset:0 sc1
    v_mfma_f32_16x16x32_bf16 a[104:107], a[212:215], v[232:235], a[104:107]
    s_mov_b32 s45, 81920
    buffer_load_dwordx4 a[32:35], v115, s[20:23], s45 offen offset:0 sc1
    v_mfma_f32_16x16x32_bf16 a[108:111], a[212:215], v[240:243], a[108:111]
    s_mov_b32 s45, 102400
    buffer_load_dwordx4 a[36:39], v114, s[20:23], s45 offen offset:0 sc1
    v_accvgpr_read_b32 v128, a68
    v_accvgpr_read_b32 v129, a69
    v_accvgpr_read_b32 v130, a70
    v_accvgpr_read_b32 v131, a71
    v_accvgpr_read_b32 v132, a84
    v_accvgpr_read_b32 v133, a85
    v_accvgpr_read_b32 v134, a86
    v_accvgpr_read_b32 v135, a87
    v_maximum3_f32 v108, v108, |v128|, |v129|
    v_maximum3_f32 v109, v109, |v130|, |v131|
    v_maximum3_f32 v108, v108, |v132|, |v133|
    v_maximum3_f32 v109, v109, |v134|, |v135|
    v_mul_f32 v128, v128, v101
    v_mul_f32 v129, v129, v101
    v_mul_f32 v130, v130, v101
    v_mul_f32 v131, v131, v101
    v_mul_f32 v132, v132, v101
    v_mul_f32 v133, v133, v101
    v_mul_f32 v134, v134, v101
    v_mul_f32 v135, v135, v101
    v_mfma_f32_16x16x32_bf16 a[108:111], a[208:211], v[236:239], a[108:111]
    s_waitcnt lgkmcnt(0)
    v_cvt_pk_bf16_f32 v156, v128, v129
    v_cvt_pk_bf16_f32 v157, v130, v131
    v_cvt_pk_bf16_f32 v158, v132, v133
    v_cvt_pk_bf16_f32 v159, v134, v135
    v_mfma_f32_16x16x32_bf16 a[112:115], a[216:219], v[212:215], a[112:115]
    buffer_store_dwordx4 v[156:159], v110, s[24:27], s36 offen offset:1024 sc1
    v_mfma_f32_16x16x32_bf16 a[112:115], a[220:223], v[216:219], a[112:115]
    s_mov_b32 s45, 102400
    buffer_load_dwordx4 a[40:43], v114, s[20:23], s45 offen offset:1024 sc1
    v_mfma_f32_16x16x32_bf16 a[116:119], a[220:223], v[224:227], a[116:119]
    s_mov_b32 s45, 102400
    buffer_load_dwordx4 a[44:47], v114, s[20:23], s45 offen offset:2048 sc1
    v_accvgpr_read_b32 v136, a72
    v_accvgpr_read_b32 v137, a73
    v_accvgpr_read_b32 v138, a74
    v_accvgpr_read_b32 v139, a75
    v_accvgpr_read_b32 v140, a88
    v_accvgpr_read_b32 v141, a89
    v_accvgpr_read_b32 v142, a90
    v_accvgpr_read_b32 v143, a91
    v_maximum3_f32 v108, v108, |v136|, |v137|
    v_maximum3_f32 v109, v109, |v138|, |v139|
    v_maximum3_f32 v108, v108, |v140|, |v141|
    v_maximum3_f32 v109, v109, |v142|, |v143|
    v_mul_f32 v136, v136, v102
    v_mul_f32 v137, v137, v102
    v_mul_f32 v138, v138, v102
    v_mul_f32 v139, v139, v102
    v_mul_f32 v140, v140, v102
    v_mul_f32 v141, v141, v102
    v_mul_f32 v142, v142, v102
    v_mul_f32 v143, v143, v102
    v_mfma_f32_16x16x32_bf16 a[116:119], a[216:219], v[220:223], a[116:119]
    v_cvt_pk_bf16_f32 v160, v136, v137
    v_cvt_pk_bf16_f32 v161, v138, v139
    v_cvt_pk_bf16_f32 v162, v140, v141
    v_cvt_pk_bf16_f32 v163, v142, v143
    v_mfma_f32_16x16x32_bf16 a[120:123], a[216:219], v[228:231], a[120:123]
    buffer_store_dwordx4 v[160:163], v110, s[24:27], s36 offen offset:2048 sc1
    v_mfma_f32_16x16x32_bf16 a[120:123], a[220:223], v[232:235], a[120:123]
    s_mov_b32 s45, 102400
    buffer_load_dwordx4 a[48:51], v114, s[20:23], s45 offen offset:3072 sc1
    v_mfma_f32_16x16x32_bf16 a[124:127], a[220:223], v[240:243], a[124:127]
    s_mov_b32 s45, 102400
    buffer_load_dwordx4 a[52:55], v115, s[20:23], s45 offen offset:0 sc1
    v_accvgpr_read_b32 v144, a76
    v_accvgpr_read_b32 v145, a77
    v_accvgpr_read_b32 v146, a78
    v_accvgpr_read_b32 v147, a79
    v_accvgpr_read_b32 v148, a92
    v_accvgpr_read_b32 v149, a93
    v_accvgpr_read_b32 v150, a94
    v_accvgpr_read_b32 v151, a95
    v_maximum3_f32 v108, v108, |v144|, |v145|
    v_maximum3_f32 v109, v109, |v146|, |v147|
    v_maximum3_f32 v108, v108, |v148|, |v149|
    v_maximum3_f32 v109, v109, |v150|, |v151|
    v_mul_f32 v144, v144, v103
    v_mul_f32 v145, v145, v103
    v_mul_f32 v146, v146, v103
    v_mul_f32 v147, v147, v103
    v_mul_f32 v148, v148, v103
    v_mul_f32 v149, v149, v103
    v_mul_f32 v150, v150, v103
    v_mul_f32 v151, v151, v103
    v_mfma_f32_16x16x32_bf16 a[124:127], a[216:219], v[236:239], a[124:127]
    v_cvt_pk_bf16_f32 v164, v144, v145
    v_cvt_pk_bf16_f32 v165, v146, v147
    v_cvt_pk_bf16_f32 v166, v148, v149
    v_cvt_pk_bf16_f32 v167, v150, v151
    buffer_store_dwordx4 v[164:167], v110, s[24:27], s36 offen offset:3072 sc1
    s_mov_b32 s45, 122880
    buffer_load_dwordx4 a[56:59], v114, s[20:23], s45 offen offset:0 sc1
    s_mov_b32 s45, 122880
    buffer_load_dwordx4 a[60:63], v114, s[20:23], s45 offen offset:1024 sc1
    s_mov_b32 s36, 12288
    v_accvgpr_read_b32 v120, a96
    v_accvgpr_read_b32 v121, a97
    v_accvgpr_read_b32 v122, a98
    v_accvgpr_read_b32 v123, a99
    v_accvgpr_read_b32 v124, a112
    v_accvgpr_read_b32 v125, a113
    v_accvgpr_read_b32 v126, a114
    v_accvgpr_read_b32 v127, a115
    v_maximum3_f32 v108, v108, |v120|, |v121|
    v_maximum3_f32 v109, v109, |v122|, |v123|
    v_maximum3_f32 v108, v108, |v124|, |v125|
    v_maximum3_f32 v109, v109, |v126|, |v127|
    v_mul_f32 v120, v120, v100
    v_mul_f32 v121, v121, v100
    v_mul_f32 v122, v122, v100
    v_mul_f32 v123, v123, v100
    v_mul_f32 v124, v124, v100
    v_mul_f32 v125, v125, v100
    v_mul_f32 v126, v126, v100
    v_mul_f32 v127, v127, v100
    v_cvt_pk_bf16_f32 v152, v120, v121
    v_cvt_pk_bf16_f32 v153, v122, v123
    v_cvt_pk_bf16_f32 v154, v124, v125
    v_cvt_pk_bf16_f32 v155, v126, v127
    buffer_store_dwordx4 v[152:155], v110, s[24:27], s36 offen offset:0 sc1
    s_mov_b32 s45, 122880
    buffer_load_dwordx4 a[64:67], v114, s[20:23], s45 offen offset:2048 sc1
    s_mov_b32 s45, 122880
    buffer_load_dwordx4 a[68:71], v114, s[20:23], s45 offen offset:3072 sc1
    v_accvgpr_read_b32 v128, a100
    v_accvgpr_read_b32 v129, a101
    v_accvgpr_read_b32 v130, a102
    v_accvgpr_read_b32 v131, a103
    v_accvgpr_read_b32 v132, a116
    v_accvgpr_read_b32 v133, a117
    v_accvgpr_read_b32 v134, a118
    v_accvgpr_read_b32 v135, a119
    v_maximum3_f32 v108, v108, |v128|, |v129|
    v_maximum3_f32 v109, v109, |v130|, |v131|
    v_maximum3_f32 v108, v108, |v132|, |v133|
    v_maximum3_f32 v109, v109, |v134|, |v135|
    v_mul_f32 v128, v128, v101
    v_mul_f32 v129, v129, v101
    v_mul_f32 v130, v130, v101
    v_mul_f32 v131, v131, v101
    v_mul_f32 v132, v132, v101
    v_mul_f32 v133, v133, v101
    v_mul_f32 v134, v134, v101
    v_mul_f32 v135, v135, v101
    v_cvt_pk_bf16_f32 v156, v128, v129
    v_cvt_pk_bf16_f32 v157, v130, v131
    v_cvt_pk_bf16_f32 v158, v132, v133
    v_cvt_pk_bf16_f32 v159, v134, v135
    buffer_store_dwordx4 v[156:159], v110, s[24:27], s36 offen offset:1024 sc1
    s_mov_b32 s45, 122880
    buffer_load_dwordx4 a[72:75], v115, s[20:23], s45 offen offset:0 sc1
    s_mov_b32 s45, 143360
    buffer_load_dwordx4 a[76:79], v114, s[20:23], s45 offen offset:0 sc1
    v_accvgpr_read_b32 v136, a104
    v_accvgpr_read_b32 v137, a105
    v_accvgpr_read_b32 v138, a106
    v_accvgpr_read_b32 v139, a107
    v_accvgpr_read_b32 v140, a120
    v_accvgpr_read_b32 v141, a121
    v_accvgpr_read_b32 v142, a122
    v_accvgpr_read_b32 v143, a123
    v_maximum3_f32 v108, v108, |v136|, |v137|
    v_maximum3_f32 v109, v109, |v138|, |v139|
    v_maximum3_f32 v108, v108, |v140|, |v141|
    v_maximum3_f32 v109, v109, |v142|, |v143|
    v_mul_f32 v136, v136, v102
    v_mul_f32 v137, v137, v102
    v_mul_f32 v138, v138, v102
    v_mul_f32 v139, v139, v102
    v_mul_f32 v140, v140, v102
    v_mul_f32 v141, v141, v102
    v_mul_f32 v142, v142, v102
    v_mul_f32 v143, v143, v102
    v_cvt_pk_bf16_f32 v160, v136, v137
    v_cvt_pk_bf16_f32 v161, v138, v139
    v_cvt_pk_bf16_f32 v162, v140, v141
    v_cvt_pk_bf16_f32 v163, v142, v143
    buffer_store_dwordx4 v[160:163], v110, s[24:27], s36 offen offset:2048 sc1
    s_mov_b32 s45, 143360
    buffer_load_dwordx4 a[80:83], v114, s[20:23], s45 offen offset:1024 sc1
    s_mov_b32 s45, 143360
    buffer_load_dwordx4 a[84:87], v114, s[20:23], s45 offen offset:2048 sc1
    v_accvgpr_read_b32 v144, a108
    v_accvgpr_read_b32 v145, a109
    v_accvgpr_read_b32 v146, a110
    v_accvgpr_read_b32 v147, a111
    v_accvgpr_read_b32 v148, a124
    v_accvgpr_read_b32 v149, a125
    v_accvgpr_read_b32 v150, a126
    v_accvgpr_read_b32 v151, a127
    v_maximum3_f32 v108, v108, |v144|, |v145|
    v_maximum3_f32 v109, v109, |v146|, |v147|
    v_maximum3_f32 v108, v108, |v148|, |v149|
    v_maximum3_f32 v109, v109, |v150|, |v151|
    v_mul_f32 v144, v144, v103
    v_mul_f32 v145, v145, v103
    v_mul_f32 v146, v146, v103
    v_mul_f32 v147, v147, v103
    v_mul_f32 v148, v148, v103
    v_mul_f32 v149, v149, v103
    v_mul_f32 v150, v150, v103
    v_mul_f32 v151, v151, v103
    v_cvt_pk_bf16_f32 v164, v144, v145
    v_cvt_pk_bf16_f32 v165, v146, v147
    v_cvt_pk_bf16_f32 v166, v148, v149
    v_cvt_pk_bf16_f32 v167, v150, v151
    buffer_store_dwordx4 v[164:167], v110, s[24:27], s36 offen offset:3072 sc1
    s_mov_b32 s45, 143360
    buffer_load_dwordx4 a[88:91], v114, s[20:23], s45 offen offset:3072 sc1
    s_mov_b32 s45, 143360
    buffer_load_dwordx4 a[92:95], v115, s[20:23], s45 offen offset:0 sc1
    v_maximum3_f32 v108, v108, v109, v109
    v_cmp_ngt_f32 vcc, 0x7f800000, v108
    s_and_b64 vcc, vcc, exec
    s_cbranch_scc1 L_slow
L_published:
    v_mov_b32 v16, v114
    v_mov_b32 v17, v115
    v_mov_b32 v2, 1
    v_mov_b32 v11, 0x2500000
    s_not_b32 s40, s50
    s_and_b32 s40, s40, 0x7ff
    v_cmp_eq_u32 vcc, s40, v35
    v_mov_b32 v12, 0x29c000
    s_nop 0
    v_cndmask_b32 v11, v11, v12, vcc
    s_not_b32 s40, s51
    s_and_b32 s40, s40, 0x7ff
    v_cmp_eq_u32 vcc, s40, v35
    v_mov_b32 v12, 0x29c500
    s_nop 0
    v_cndmask_b32 v11, v11, v12, vcc
    s_not_b32 s40, s52
    s_and_b32 s40, s40, 0x7ff
    v_cmp_eq_u32 vcc, s40, v35
    v_mov_b32 v12, 0x29ca00
    s_nop 0
    v_cndmask_b32 v11, v11, v12, vcc
    s_not_b32 s40, s53
    s_and_b32 s40, s40, 0x7ff
    v_cmp_eq_u32 vcc, s40, v35
    v_mov_b32 v12, 0x29cf00
    s_nop 0
    v_cndmask_b32 v11, v11, v12, vcc
    s_not_b32 s40, s54
    s_and_b32 s40, s40, 0x7ff
    v_cmp_eq_u32 vcc, s40, v35
    v_mov_b32 v12, 0x29d400
    s_nop 0
    v_cndmask_b32 v11, v11, v12, vcc
    s_not_b32 s40, s55
    s_and_b32 s40, s40, 0x7ff
    v_cmp_eq_u32 vcc, s40, v35
    v_mov_b32 v12, 0x29d900
    s_nop 0
    v_cndmask_b32 v11, v11, v12, vcc
    s_not_b32 s40, s56
    s_and_b32 s40, s40, 0x7ff
    v_cmp_eq_u32 vcc, s40, v35
    v_mov_b32 v12, 0x29de00
    s_nop 0
    v_cndmask_b32 v11, v11, v12, vcc
    s_not_b32 s40, s57
    s_and_b32 s40, s40, 0x7ff
    v_cmp_eq_u32 vcc, s40, v35
    v_mov_b32 v12, 0x29e300
    s_nop 0
    v_cndmask_b32 v11, v11, v12, vcc
    v_mul_u32_u24 v12, 1280, v35
    v_sub_u32 v12, v34, v12
    v_add_u32 v11, v11, v12
    buffer_load_dwordx2 v[20:21], v11, s[76:79], 0 offen offset:0 sc1
    buffer_load_dwordx2 v[246:247], v11, s[76:79], 0 offen offset:32 sc1
    buffer_load_dwordx2 v[248:249], v11, s[76:79], 0 offen offset:64 sc1
    buffer_load_dwordx2 v[252:253], v11, s[76:79], 0 offen offset:96 sc1
    buffer_load_dwordx2 v[254:255], v11, s[76:79], 0 offen offset:128 sc1
    s_waitcnt vmcnt(45)
    v_lshlrev_b32 v166, 16, v22
    v_and_b32 v167, 0xffff0000, v22
    v_lshlrev_b32 v168, 16, v23
    v_and_b32 v169, 0xffff0000, v23
    v_lshlrev_b32 v170, 16, v24
    v_and_b32 v171, 0xffff0000, v24
    v_lshlrev_b32 v172, 16, v25
    v_and_b32 v173, 0xffff0000, v25
    v_lshlrev_b32 v174, 16, v26
    v_and_b32 v175, 0xffff0000, v26
    v_lshlrev_b32 v176, 16, v27
    v_and_b32 v177, 0xffff0000, v27
    v_lshlrev_b32 v178, 16, v28
    v_and_b32 v179, 0xffff0000, v28
    v_lshlrev_b32 v180, 16, v29
    v_and_b32 v181, 0xffff0000, v29
    v_lshlrev_b32 v182, 16, v30
    v_and_b32 v183, 0xffff0000, v30
    v_lshlrev_b32 v184, 16, v31
    v_and_b32 v185, 0xffff0000, v31
    v_pk_add_f32 v[166:167], v[166:167], v[32:33] op_sel_hi:[1,0] neg_lo:[0,1] neg_hi:[0,1]
    v_pk_add_f32 v[168:169], v[168:169], v[32:33] op_sel_hi:[1,0] neg_lo:[0,1] neg_hi:[0,1]
    v_pk_add_f32 v[170:171], v[170:171], v[32:33] op_sel_hi:[1,0] neg_lo:[0,1] neg_hi:[0,1]
    v_pk_add_f32 v[172:173], v[172:173], v[32:33] op_sel_hi:[1,0] neg_lo:[0,1] neg_hi:[0,1]
    v_pk_add_f32 v[174:175], v[174:175], v[32:33] op_sel_hi:[1,0] neg_lo:[0,1] neg_hi:[0,1]
    v_pk_add_f32 v[176:177], v[176:177], v[32:33] op_sel_hi:[1,0] neg_lo:[0,1] neg_hi:[0,1]
    v_pk_add_f32 v[178:179], v[178:179], v[32:33] op_sel_hi:[1,0] neg_lo:[0,1] neg_hi:[0,1]
    v_pk_add_f32 v[180:181], v[180:181], v[32:33] op_sel_hi:[1,0] neg_lo:[0,1] neg_hi:[0,1]
    v_pk_add_f32 v[182:183], v[182:183], v[32:33] op_sel_hi:[1,0] neg_lo:[0,1] neg_hi:[0,1]
    v_pk_add_f32 v[184:185], v[184:185], v[32:33] op_sel_hi:[1,0] neg_lo:[0,1] neg_hi:[0,1]
    v_cvt_pk_bf16_f32 v36, v166, v167
    v_cvt_pk_bf16_f32 v37, v168, v169
    v_cvt_pk_bf16_f32 v38, v170, v171
    v_cvt_pk_bf16_f32 v39, v172, v173
    v_cvt_pk_bf16_f32 v40, v174, v175
    v_cvt_pk_bf16_f32 v41, v176, v177
    v_cvt_pk_bf16_f32 v42, v178, v179
    v_cvt_pk_bf16_f32 v43, v180, v181
    v_cvt_pk_bf16_f32 v44, v182, v183
    v_cvt_pk_bf16_f32 v45, v184, v185
    v_lshlrev_b32 v166, 16, v36
    v_and_b32 v167, 0xffff0000, v36
    v_lshlrev_b32 v168, 16, v37
    v_and_b32 v169, 0xffff0000, v37
    v_lshlrev_b32 v170, 16, v38
    v_and_b32 v171, 0xffff0000, v38
    v_lshlrev_b32 v172, 16, v39
    v_and_b32 v173, 0xffff0000, v39
    v_lshlrev_b32 v174, 16, v40
    v_and_b32 v175, 0xffff0000, v40
    v_lshlrev_b32 v176, 16, v41
    v_and_b32 v177, 0xffff0000, v41
    v_lshlrev_b32 v178, 16, v42
    v_and_b32 v179, 0xffff0000, v42
    v_lshlrev_b32 v180, 16, v43
    v_and_b32 v181, 0xffff0000, v43
    v_lshlrev_b32 v182, 16, v44
    v_and_b32 v183, 0xffff0000, v44
    v_lshlrev_b32 v184, 16, v45
    v_and_b32 v185, 0xffff0000, v45
    v_pk_mul_f32 v[166:167], v[166:167], v[32:33] op_sel:[0,1] op_sel_hi:[1,1]
    v_pk_mul_f32 v[168:169], v[168:169], v[32:33] op_sel:[0,1] op_sel_hi:[1,1]
    v_pk_mul_f32 v[170:171], v[170:171], v[32:33] op_sel:[0,1] op_sel_hi:[1,1]
    v_pk_mul_f32 v[172:173], v[172:173], v[32:33] op_sel:[0,1] op_sel_hi:[1,1]
    v_pk_mul_f32 v[174:175], v[174:175], v[32:33] op_sel:[0,1] op_sel_hi:[1,1]
    v_pk_mul_f32 v[176:177], v[176:177], v[32:33] op_sel:[0,1] op_sel_hi:[1,1]
    v_pk_mul_f32 v[178:179], v[178:179], v[32:33] op_sel:[0,1] op_sel_hi:[1,1]
    v_pk_mul_f32 v[180:181], v[180:181], v[32:33] op_sel:[0,1] op_sel_hi:[1,1]
    v_pk_mul_f32 v[182:183], v[182:183], v[32:33] op_sel:[0,1] op_sel_hi:[1,1]
    v_pk_mul_f32 v[184:185], v[184:185], v[32:33] op_sel:[0,1] op_sel_hi:[1,1]
    v_cvt_pk_bf16_f32 v36, v166, v167
    v_cvt_pk_bf16_f32 v37, v168, v169
    v_cvt_pk_bf16_f32 v38, v170, v171
    v_cvt_pk_bf16_f32 v39, v172, v173
    v_cvt_pk_bf16_f32 v40, v174, v175
    v_cvt_pk_bf16_f32 v41, v176, v177
    v_cvt_pk_bf16_f32 v42, v178, v179
    v_cvt_pk_bf16_f32 v43, v180, v181
    v_cvt_pk_bf16_f32 v44, v182, v183
    v_cvt_pk_bf16_f32 v45, v184, v185
    s_lshr_b32 s40, s87, 1
    s_lshl_b32 s40, s40, 2
    s_add_u32 s40, s40, s47
    s_lshl_b32 s40, s40, 18
    s_add_u32 s40, s40, 0x400000
    s_add_u32 s8, s72, s40
    s_addc_u32 s9, s73, 0
    s_mov_b32 s10, 0xc0000
    s_mov_b32 s11, 0x20000
    s_mov_b32 s12, s68
    s_mov_b32 s13, s69
    s_mov_b32 s14, 0x280000
    s_mov_b32 s15, 0x20000
    s_xor_b32 s40, s47, 1
    s_lshl_b32 s30, s40, 19
    s_lshl_b32 s31, s47, 19
    s_add_u32 s40, s5, 0
    s_and_b32 s40, s40, 3
    s_lshl_b32 s41, s5, 2
    s_add_u32 s41, s41, s40
    s_lshl_b32 s41, s41, 10
    v_lshl_add_u32 v4, v19, 4, s41
    s_add_u32 s40, s5, 1
    s_and_b32 s40, s40, 3
    s_lshl_b32 s41, s5, 2
    s_add_u32 s41, s41, s40
    s_lshl_b32 s41, s41, 10
    v_lshl_add_u32 v5, v19, 4, s41
    s_add_u32 s40, s5, 2
    s_and_b32 s40, s40, 3
    s_lshl_b32 s41, s5, 2
    s_add_u32 s41, s41, s40
    s_lshl_b32 s41, s41, 10
    v_lshl_add_u32 v6, v19, 4, s41
    s_add_u32 s40, s5, 3
    s_and_b32 s40, s40, 3
    s_lshl_b32 s41, s5, 2
    s_add_u32 s41, s41, s40
    s_lshl_b32 s41, s41, 10
    v_lshl_add_u32 v7, v19, 4, s41
    s_add_u32 s40, s46, 122880
    v_lshl_add_u32 v8, v19, 4, s40
    s_add_u32 s40, s46, 81920
    v_lshl_add_u32 v9, v19, 4, s40
    s_lshl_b32 s40, s46, 1
    v_lshl_add_u32 v10, v19, 4, s40
    s_and_b32 s40, s87, 30
    s_lshl_b32 s40, s40, 1
    s_add_u32 s40, s40, s47
    s_lshl_b32 s40, s40, 9
    s_add_u32 s40, s40, 0x292000
    v_bfe_u32 v1, v19, 2, 1
    v_lshlrev_b32 v1, 3, v1
    v_and_or_b32 v1, v19, 3, v1
    v_lshl_add_u32 v1, v1, 7, s40
    s_waitcnt vmcnt(7)
    s_mov_b64 exec, 1
    buffer_store_dword v2, off, s[76:79], s58 sc1
    s_mov_b64 exec, -1
    s_waitcnt vmcnt(1)
    v_max3_u32 v3, v20, v21, v246
    v_max3_u32 v3, v3, v247, v248
    v_max3_u32 v3, v3, v249, v252
    v_max3_u32 v3, v3, v253, v254
    v_max_u32 v3, v3, v255
    v_cmp_eq_u32 vcc, -1, v3
    s_and_b64 vcc, vcc, exec
    s_cbranch_scc1 L_spin_upd
L_back_upd:
    v_lshlrev_b32 v166, 16, v36
    v_and_b32 v167, 0xffff0000, v36
    v_lshlrev_b32 v186, 16, v20
    v_and_b32 v187, 0xffff0000, v20
    v_lshlrev_b32 v168, 16, v37
    v_and_b32 v169, 0xffff0000, v37
    v_lshlrev_b32 v188, 16, v21
    v_and_b32 v189, 0xffff0000, v21
    s_mov_b32 s45, 163840
    buffer_load_dwordx4 v[46:49], v16, s[20:23], s45 offen offset:0 sc1
    v_lshlrev_b32 v170, 16, v38
    v_and_b32 v171, 0xffff0000, v38
    v_lshlrev_b32 v190, 16, v246
    v_and_b32 v191, 0xffff0000, v246
    v_lshlrev_b32 v172, 16, v39
    v_and_b32 v173, 0xffff0000, v39
    v_lshlrev_b32 v192, 16, v247
    v_and_b32 v193, 0xffff0000, v247
    buffer_load_dwordx4 v[50:53], v16, s[20:23], s45 offen offset:1024 sc1
    v_lshlrev_b32 v174, 16, v40
    v_and_b32 v175, 0xffff0000, v40
    v_lshlrev_b32 v194, 16, v248
    v_and_b32 v195, 0xffff0000, v248
    v_lshlrev_b32 v176, 16, v41
    v_and_b32 v177, 0xffff0000, v41
    v_lshlrev_b32 v196, 16, v249
    v_and_b32 v197, 0xffff0000, v249
    buffer_load_dwordx4 v[54:57], v16, s[20:23], s45 offen offset:2048 sc1
    v_lshlrev_b32 v178, 16, v42
    v_and_b32 v179, 0xffff0000, v42
    v_lshlrev_b32 v198, 16, v252
    v_and_b32 v199, 0xffff0000, v252
    v_lshlrev_b32 v180, 16, v43
    v_and_b32 v181, 0xffff0000, v43
    v_lshlrev_b32 v200, 16, v253
    v_and_b32 v201, 0xffff0000, v253
    buffer_load_dwordx4 v[58:61], v16, s[20:23], s45 offen offset:3072 sc1
    v_lshlrev_b32 v182, 16, v44
    v_and_b32 v183, 0xffff0000, v44
    v_lshlrev_b32 v202, 16, v254
    v_and_b32 v203, 0xffff0000, v254
    v_lshlrev_b32 v184, 16, v45
    v_and_b32 v185, 0xffff0000, v45
    v_lshlrev_b32 v204, 16, v255
    v_and_b32 v205, 0xffff0000, v255
    buffer_load_dwordx4 v[62:65], v17, s[20:23], s45 offen offset:0 sc1
    v_pk_add_f32 v[166:167], v[166:167], v[186:187]
    v_pk_add_f32 v[168:169], v[168:169], v[188:189]
    v_pk_add_f32 v[170:171], v[170:171], v[190:191]
    v_pk_add_f32 v[172:173], v[172:173], v[192:193]
    v_pk_add_f32 v[174:175], v[174:175], v[194:195]
    v_pk_add_f32 v[176:177], v[176:177], v[196:197]
    v_pk_add_f32 v[178:179], v[178:179], v[198:199]
    v_pk_add_f32 v[180:181], v[180:181], v[200:201]
    s_mov_b32 s45, 184320
    buffer_load_dwordx4 v[66:69], v16, s[20:23], s45 offen offset:0 sc1
    v_pk_add_f32 v[182:183], v[182:183], v[202:203]
    v_pk_add_f32 v[184:185], v[184:185], v[204:205]
    v_cvt_pk_bf16_f32 v186, v166, v167
    v_cvt_pk_bf16_f32 v187, v168, v169
    v_cvt_pk_bf16_f32 v188, v170, v171
    v_cvt_pk_bf16_f32 v189, v172, v173
    v_cvt_pk_bf16_f32 v190, v174, v175
    v_cvt_pk_bf16_f32 v191, v176, v177
    buffer_load_dwordx4 v[70:73], v16, s[20:23], s45 offen offset:1024 sc1
    v_cvt_pk_bf16_f32 v192, v178, v179
    v_cvt_pk_bf16_f32 v193, v180, v181
    v_cvt_pk_bf16_f32 v194, v182, v183
    v_cvt_pk_bf16_f32 v195, v184, v185
    buffer_load_dwordx4 v[74:77], v16, s[20:23], s45 offen offset:2048 sc1
    buffer_load_dwordx4 v[78:81], v16, s[20:23], s45 offen offset:3072 sc1
    buffer_load_dwordx4 v[82:85], v17, s[20:23], s45 offen offset:0 sc1
    buffer_load_dwordx4 v[126:129], v1, s[76:79], 0 offen sc1
    v_lshlrev_b32 v166, 16, v186
    v_and_b32 v167, 0xffff0000, v186
    v_lshlrev_b32 v168, 16, v187
    v_and_b32 v169, 0xffff0000, v187
    v_lshlrev_b32 v170, 16, v188
    v_and_b32 v171, 0xffff0000, v188
    v_lshlrev_b32 v172, 16, v189
    v_and_b32 v173, 0xffff0000, v189
    v_lshlrev_b32 v174, 16, v190
    v_and_b32 v175, 0xffff0000, v190
    v_lshlrev_b32 v176, 16, v191
    v_and_b32 v177, 0xffff0000, v191
    v_lshlrev_b32 v178, 16, v192
    v_and_b32 v179, 0xffff0000, v192
    v_lshlrev_b32 v180, 16, v193
    v_and_b32 v181, 0xffff0000, v193
    s_mov_b32 s45, 204800
    buffer_load_dwordx4 v[86:89], v16, s[20:23], s45 offen offset:0 sc1
    v_lshlrev_b32 v182, 16, v194
    v_and_b32 v183, 0xffff0000, v194
    v_lshlrev_b32 v184, 16, v195
    v_and_b32 v185, 0xffff0000, v195
    v_mul_f32 v186, 0xbfb8aa3b, v166
    v_mul_f32 v187, 0xbfb8aa3b, v167
    v_mul_f32 v188, 0xbfb8aa3b, v168
    v_mul_f32 v189, 0xbfb8aa3b, v169
    v_mul_f32 v190, 0xbfb8aa3b, v170
    v_mul_f32 v191, 0xbfb8aa3b, v171
    v_mul_f32 v192, 0xbfb8aa3b, v172
    v_mul_f32 v193, 0xbfb8aa3b, v173
    v_mul_f32 v194, 0xbfb8aa3b, v174
    v_mul_f32 v195, 0xbfb8aa3b, v175
    v_mul_f32 v196, 0xbfb8aa3b, v176
    v_mul_f32 v197, 0xbfb8aa3b, v177
    buffer_load_dwordx4 v[90:93], v16, s[20:23], s45 offen offset:1024 sc1
    v_mul_f32 v198, 0xbfb8aa3b, v178
    v_mul_f32 v199, 0xbfb8aa3b, v179
    v_mul_f32 v200, 0xbfb8aa3b, v180
    v_mul_f32 v201, 0xbfb8aa3b, v181
    v_mul_f32 v202, 0xbfb8aa3b, v182
    v_mul_f32 v203, 0xbfb8aa3b, v183
    v_mul_f32 v204, 0xbfb8aa3b, v184
    v_mul_f32 v205, 0xbfb8aa3b, v185
    v_exp_f32 v186, v186
    v_exp_f32 v187, v187
    v_exp_f32 v188, v188
    v_exp_f32 v189, v189
    v_exp_f32 v190, v190
    v_exp_f32 v191, v191
    v_exp_f32 v192, v192
    v_exp_f32 v193, v193
    buffer_load_dwordx4 v[94:97], v16, s[20:23], s45 offen offset:2048 sc1
    v_exp_f32 v194, v194
    v_exp_f32 v195, v195
    v_exp_f32 v196, v196
    v_exp_f32 v197, v197
    v_exp_f32 v198, v198
    v_exp_f32 v199, v199
    v_exp_f32 v200, v200
    v_exp_f32 v201, v201
    v_exp_f32 v202, v202
    v_exp_f32 v203, v203
    v_exp_f32 v204, v204
    v_exp_f32 v205, v205
    v_add_f32 v186, 1.0, v186
    v_add_f32 v187, 1.0, v187
    v_add_f32 v188, 1.0, v188
    v_add_f32 v189, 1.0, v189
    buffer_load_dwordx4 v[98:101], v16, s[20:23], s45 offen offset:3072 sc1
    v_add_f32 v190, 1.0, v190
    v_add_f32 v191, 1.0, v191
    v_add_f32 v192, 1.0, v192
    v_add_f32 v193, 1.0, v193
    v_add_f32 v194, 1.0, v194
    v_add_f32 v195, 1.0, v195
    v_add_f32 v196, 1.0, v196
    v_add_f32 v197, 1.0, v197
    v_add_f32 v198, 1.0, v198
    v_add_f32 v199, 1.0, v199
    v_add_f32 v200, 1.0, v200
    v_add_f32 v201, 1.0, v201
    v_add_f32 v202, 1.0, v202
    v_add_f32 v203, 1.0, v203
    v_add_f32 v204, 1.0, v204
    v_add_f32 v205, 1.0, v205
    buffer_load_dwordx4 v[102:105], v17, s[20:23], s45 offen offset:0 sc1
    v_rcp_f32 v186, v186
    v_rcp_f32 v187, v187
    v_rcp_f32 v188, v188
    v_rcp_f32 v189, v189
    v_rcp_f32 v190, v190
    v_rcp_f32 v191, v191
    v_rcp_f32 v192, v192
    v_rcp_f32 v193, v193
    v_rcp_f32 v194, v194
    v_rcp_f32 v195, v195
    v_rcp_f32 v196, v196
    v_rcp_f32 v197, v197
    v_rcp_f32 v198, v198
    v_rcp_f32 v199, v199
    v_rcp_f32 v200, v200
    v_rcp_f32 v201, v201
    s_mov_b32 s45, 225280
    buffer_load_dwordx4 v[106:109], v16, s[20:23], s45 offen offset:0 sc1
    v_rcp_f32 v202, v202
    v_rcp_f32 v203, v203
    v_rcp_f32 v204, v204
    v_rcp_f32 v205, v205
    v_mul_f32 v166, v166, v186
    v_mul_f32 v167, v167, v187
    v_mul_f32 v168, v168, v188
    v_mul_f32 v169, v169, v189
    v_mul_f32 v170, v170, v190
    v_mul_f32 v171, v171, v191
    v_mul_f32 v172, v172, v192
    v_mul_f32 v173, v173, v193
    v_mul_f32 v174, v174, v194
    v_mul_f32 v175, v175, v195
    v_mul_f32 v176, v176, v196
    v_mul_f32 v177, v177, v197
    buffer_load_dwordx4 v[110:113], v16, s[20:23], s45 offen offset:1024 sc1
    v_mul_f32 v178, v178, v198
    v_mul_f32 v179, v179, v199
    v_mul_f32 v180, v180, v200
    v_mul_f32 v181, v181, v201
    v_mul_f32 v182, v182, v202
    v_mul_f32 v183, v183, v203
    v_mul_f32 v184, v184, v204
    v_mul_f32 v185, v185, v205
    v_cvt_pk_bf16_f32 v36, v166, v167
    v_cvt_pk_bf16_f32 v37, v168, v169
    v_cvt_pk_bf16_f32 v38, v170, v171
    v_cvt_pk_bf16_f32 v39, v172, v173
    v_cvt_pk_bf16_f32 v40, v174, v175
    v_cvt_pk_bf16_f32 v41, v176, v177
    v_cvt_pk_bf16_f32 v42, v178, v179
    v_cvt_pk_bf16_f32 v43, v180, v181
    buffer_load_dwordx4 v[114:117], v16, s[20:23], s45 offen offset:2048 sc1
    v_cvt_pk_bf16_f32 v44, v182, v183
    v_cvt_pk_bf16_f32 v45, v184, v185
    buffer_load_dwordx4 v[118:121], v16, s[20:23], s45 offen offset:3072 sc1
    buffer_load_dwordx4 v[122:125], v17, s[20:23], s45 offen offset:0 sc1
    v_mov_b32 v2, 3
    s_cmp_lg_u32 s5, 0
    s_cbranch_scc1 L_back_o
    s_waitcnt vmcnt(10)
    v_min3_u32 v126, v126, v127, v128
    v_min_u32 v126, v126, v129
    v_cmp_gt_u32 vcc, 1, v126
    s_and_b64 vcc, vcc, exec
    s_cbranch_scc1 L_spin_o
L_back_o:
    s_barrier
    s_add_u32 s44, s30, 0
    buffer_load_dwordx4 a[96:99], v4, s[8:11], s44 offen sc1
    buffer_load_dwordx4 a[100:103], v5, s[8:11], s44 offen sc1
    buffer_load_dwordx4 a[104:107], v6, s[8:11], s44 offen sc1
    buffer_load_dwordx4 a[108:111], v7, s[8:11], s44 offen sc1
    s_add_u32 s44, s30, 16384
    buffer_load_dwordx4 a[112:115], v4, s[8:11], s44 offen sc1
    buffer_load_dwordx4 a[116:119], v5, s[8:11], s44 offen sc1
    buffer_load_dwordx4 a[120:123], v6, s[8:11], s44 offen sc1
    buffer_load_dwordx4 a[124:127], v7, s[8:11], s44 offen sc1
    s_add_u32 s44, s30, 32768
    buffer_load_dwordx4 a[192:195], v4, s[8:11], s44 offen sc1
    buffer_load_dwordx4 a[196:199], v5, s[8:11], s44 offen sc1
    buffer_load_dwordx4 a[200:203], v6, s[8:11], s44 offen sc1
    buffer_load_dwordx4 a[204:207], v7, s[8:11], s44 offen sc1
    s_add_u32 s44, s30, 49152
    buffer_load_dwordx4 a[208:211], v4, s[8:11], s44 offen sc1
    buffer_load_dwordx4 a[212:215], v5, s[8:11], s44 offen sc1
    buffer_load_dwordx4 a[216:219], v6, s[8:11], s44 offen sc1
    buffer_load_dwordx4 a[220:223], v7, s[8:11], s44 offen sc1
    s_waitcnt vmcnt(8)
    v_mfma_f32_16x16x32_bf16 v[166:169], a[128:131], a[96:99], 0
    v_mfma_f32_16x16x32_bf16 v[166:169], a[148:151], a[112:115], v[166:169]
    s_add_u32 s44, s30, 65536
    buffer_load_dwordx4 a[224:227], v4, s[8:11], s44 offen sc1
    v_mfma_f32_16x16x32_bf16 v[186:189], a[148:151], a[116:119], 0
    v_mfma_f32_16x16x32_bf16 v[186:189], a[128:131], a[100:103], v[186:189]
    v_mfma_f32_16x16x32_bf16 v[206:209], a[128:131], a[104:107], 0
    buffer_load_dwordx4 a[228:231], v5, s[8:11], s44 offen sc1
    v_mfma_f32_16x16x32_bf16 v[206:209], a[148:151], a[120:123], v[206:209]
    v_mfma_f32_16x16x32_bf16 v[226:229], a[148:151], a[124:127], 0
    v_mfma_f32_16x16x32_bf16 v[226:229], a[128:131], a[108:111], v[226:229]
    v_mfma_f32_16x16x32_bf16 v[170:173], a[132:135], a[96:99], 0
    buffer_load_dwordx4 a[232:235], v6, s[8:11], s44 offen sc1
    v_mfma_f32_16x16x32_bf16 v[170:173], a[152:155], a[112:115], v[170:173]
    v_mfma_f32_16x16x32_bf16 v[190:193], a[152:155], a[116:119], 0
    v_mfma_f32_16x16x32_bf16 v[190:193], a[132:135], a[100:103], v[190:193]
    v_mfma_f32_16x16x32_bf16 v[210:213], a[132:135], a[104:107], 0
    buffer_load_dwordx4 a[236:239], v7, s[8:11], s44 offen sc1
    v_mfma_f32_16x16x32_bf16 v[210:213], a[152:155], a[120:123], v[210:213]
    v_mfma_f32_16x16x32_bf16 v[230:233], a[152:155], a[124:127], 0
    v_mfma_f32_16x16x32_bf16 v[230:233], a[132:135], a[108:111], v[230:233]
    v_mfma_f32_16x16x32_bf16 v[174:177], a[136:139], a[96:99], 0
    s_add_u32 s44, s30, 81920
    buffer_load_dwordx4 a[240:243], v4, s[8:11], s44 offen sc1
    v_mfma_f32_16x16x32_bf16 v[174:177], a[156:159], a[112:115], v[174:177]
    v_mfma_f32_16x16x32_bf16 v[194:197], a[156:159], a[116:119], 0
    v_mfma_f32_16x16x32_bf16 v[194:197], a[136:139], a[100:103], v[194:197]
    buffer_load_dwordx4 a[244:247], v5, s[8:11], s44 offen sc1
    v_mfma_f32_16x16x32_bf16 v[214:217], a[136:139], a[104:107], 0
    v_mfma_f32_16x16x32_bf16 v[214:217], a[156:159], a[120:123], v[214:217]
    v_mfma_f32_16x16x32_bf16 v[234:237], a[156:159], a[124:127], 0
    v_mfma_f32_16x16x32_bf16 v[234:237], a[136:139], a[108:111], v[234:237]
    buffer_load_dwordx4 a[248:251], v6, s[8:11], s44 offen sc1
    v_mfma_f32_16x16x32_bf16 v[178:181], a[140:143], a[96:99], 0
    v_mfma_f32_16x16x32_bf16 v[178:181], a[160:163], a[112:115], v[178:181]
    v_mfma_f32_16x16x32_bf16 v[198:201], a[160:163], a[116:119], 0
    v_mfma_f32_16x16x32_bf16 v[198:201], a[140:143], a[100:103], v[198:201]
    buffer_load_dwordx4 a[252:255], v7, s[8:11], s44 offen sc1
    v_mfma_f32_16x16x32_bf16 v[218:221], a[140:143], a[104:107], 0
    v_mfma_f32_16x16x32_bf16 v[218:221], a[160:163], a[120:123], v[218:221]
    v_mfma_f32_16x16x32_bf16 v[238:241], a[160:163], a[124:127], 0
    v_mfma_f32_16x16x32_bf16 v[238:241], a[140:143], a[108:111], v[238:241]
    v_mfma_f32_16x16x32_bf16 v[182:185], a[144:147], a[96:99], 0
    v_mfma_f32_16x16x32_bf16 v[182:185], a[164:167], a[112:115], v[182:185]
    v_mfma_f32_16x16x32_bf16 v[202:205], a[164:167], a[116:119], 0
    v_mfma_f32_16x16x32_bf16 v[202:205], a[144:147], a[100:103], v[202:205]
    v_mfma_f32_16x16x32_bf16 v[222:225], a[144:147], a[104:107], 0
    v_mfma_f32_16x16x32_bf16 v[222:225], a[164:167], a[120:123], v[222:225]
    v_mfma_f32_16x16x32_bf16 v[242:245], a[164:167], a[124:127], 0
    v_mfma_f32_16x16x32_bf16 v[242:245], a[144:147], a[108:111], v[242:245]
    s_waitcnt vmcnt(8)
    v_mfma_f32_16x16x32_bf16 v[166:169], a[168:171], a[192:195], v[166:169]
    v_mfma_f32_16x16x32_bf16 v[166:169], a[188:191], a[208:211], v[166:169]
    s_add_u32 s44, s30, 98304
    buffer_load_dwordx4 a[96:99], v4, s[8:11], s44 offen sc1
    v_mfma_f32_16x16x32_bf16 v[186:189], a[188:191], a[212:215], v[186:189]
    v_mfma_f32_16x16x32_bf16 v[186:189], a[168:171], a[196:199], v[186:189]
    v_mfma_f32_16x16x32_bf16 v[206:209], a[168:171], a[200:203], v[206:209]
    buffer_load_dwordx4 a[100:103], v5, s[8:11], s44 offen sc1
    v_mfma_f32_16x16x32_bf16 v[206:209], a[188:191], a[216:219], v[206:209]
    v_mfma_f32_16x16x32_bf16 v[226:229], a[188:191], a[220:223], v[226:229]
    v_mfma_f32_16x16x32_bf16 v[226:229], a[168:171], a[204:207], v[226:229]
    v_mfma_f32_16x16x32_bf16 v[170:173], a[172:175], a[192:195], v[170:173]
    buffer_load_dwordx4 a[104:107], v6, s[8:11], s44 offen sc1
    v_mfma_f32_16x16x32_bf16 v[170:173], a[0:3], a[208:211], v[170:173]
    v_mfma_f32_16x16x32_bf16 v[190:193], a[0:3], a[212:215], v[190:193]
    v_mfma_f32_16x16x32_bf16 v[190:193], a[172:175], a[196:199], v[190:193]
    v_mfma_f32_16x16x32_bf16 v[210:213], a[172:175], a[200:203], v[210:213]
    buffer_load_dwordx4 a[108:111], v7, s[8:11], s44 offen sc1
    v_mfma_f32_16x16x32_bf16 v[210:213], a[0:3], a[216:219], v[210:213]
    v_mfma_f32_16x16x32_bf16 v[230:233], a[0:3], a[220:223], v[230:233]
    v_mfma_f32_16x16x32_bf16 v[230:233], a[172:175], a[204:207], v[230:233]
    v_mfma_f32_16x16x32_bf16 v[174:177], a[176:179], a[192:195], v[174:177]
    s_add_u32 s44, s30, 114688
    buffer_load_dwordx4 a[112:115], v4, s[8:11], s44 offen sc1
    v_mfma_f32_16x16x32_bf16 v[174:177], a[4:7], a[208:211], v[174:177]
    v_mfma_f32_16x16x32_bf16 v[194:197], a[4:7], a[212:215], v[194:197]
    v_mfma_f32_16x16x32_bf16 v[194:197], a[176:179], a[196:199], v[194:197]
    buffer_load_dwordx4 a[116:119], v5, s[8:11], s44 offen sc1
    v_mfma_f32_16x16x32_bf16 v[214:217], a[176:179], a[200:203], v[214:217]
    v_mfma_f32_16x16x32_bf16 v[214:217], a[4:7], a[216:219], v[214:217]
    v_mfma_f32_16x16x32_bf16 v[234:237], a[4:7], a[220:223], v[234:237]
    v_mfma_f32_16x16x32_bf16 v[234:237], a[176:179], a[204:207], v[234:237]
    buffer_load_dwordx4 a[120:123], v6, s[8:11], s44 offen sc1
    v_mfma_f32_16x16x32_bf16 v[178:181], a[180:183], a[192:195], v[178:181]
    v_mfma_f32_16x16x32_bf16 v[178:181], a[8:11], a[208:211], v[178:181]
    v_mfma_f32_16x16x32_bf16 v[198:201], a[8:11], a[212:215], v[198:201]
    v_mfma_f32_16x16x32_bf16 v[198:201], a[180:183], a[196:199], v[198:201]
    buffer_load_dwordx4 a[124:127], v7, s[8:11], s44 offen sc1
    v_mfma_f32_16x16x32_bf16 v[218:221], a[180:183], a[200:203], v[218:221]
    v_mfma_f32_16x16x32_bf16 v[218:221], a[8:11], a[216:219], v[218:221]
    v_mfma_f32_16x16x32_bf16 v[238:241], a[8:11], a[220:223], v[238:241]
    v_mfma_f32_16x16x32_bf16 v[238:241], a[180:183], a[204:207], v[238:241]
    v_mfma_f32_16x16x32_bf16 v[182:185], a[184:187], a[192:195], v[182:185]
    v_mfma_f32_16x16x32_bf16 v[182:185], a[12:15], a[208:211], v[182:185]
    v_mfma_f32_16x16x32_bf16 v[202:205], a[12:15], a[212:215], v[202:205]
    v_mfma_f32_16x16x32_bf16 v[202:205], a[184:187], a[196:199], v[202:205]
    v_mfma_f32_16x16x32_bf16 v[222:225], a[184:187], a[200:203], v[222:225]
    v_mfma_f32_16x16x32_bf16 v[222:225], a[12:15], a[216:219], v[222:225]
    v_mfma_f32_16x16x32_bf16 v[242:245], a[12:15], a[220:223], v[242:245]
    v_mfma_f32_16x16x32_bf16 v[242:245], a[184:187], a[204:207], v[242:245]
    s_waitcnt vmcnt(8)
    v_mfma_f32_16x16x32_bf16 v[166:169], a[16:19], a[224:227], v[166:169]
    v_mfma_f32_16x16x32_bf16 v[166:169], a[36:39], a[240:243], v[166:169]
    s_add_u32 s44, s30, 196608
    buffer_load_dwordx4 a[192:195], v4, s[8:11], s44 offen sc1
    v_mfma_f32_16x16x32_bf16 v[186:189], a[36:39], a[244:247], v[186:189]
    v_mfma_f32_16x16x32_bf16 v[186:189], a[16:19], a[228:231], v[186:189]
    v_mfma_f32_16x16x32_bf16 v[206:209], a[16:19], a[232:235], v[206:209]
    buffer_load_dwordx4 a[196:199], v5, s[8:11], s44 offen sc1
    v_mfma_f32_16x16x32_bf16 v[206:209], a[36:39], a[248:251], v[206:209]
    v_mfma_f32_16x16x32_bf16 v[226:229], a[36:39], a[252:255], v[226:229]
    v_mfma_f32_16x16x32_bf16 v[226:229], a[16:19], a[236:239], v[226:229]
    v_mfma_f32_16x16x32_bf16 v[170:173], a[20:23], a[224:227], v[170:173]
    buffer_load_dwordx4 a[200:203], v6, s[8:11], s44 offen sc1
    v_mfma_f32_16x16x32_bf16 v[170:173], a[40:43], a[240:243], v[170:173]
    v_mfma_f32_16x16x32_bf16 v[190:193], a[40:43], a[244:247], v[190:193]
    v_mfma_f32_16x16x32_bf16 v[190:193], a[20:23], a[228:231], v[190:193]
    v_mfma_f32_16x16x32_bf16 v[210:213], a[20:23], a[232:235], v[210:213]
    buffer_load_dwordx4 a[204:207], v7, s[8:11], s44 offen sc1
    v_mfma_f32_16x16x32_bf16 v[210:213], a[40:43], a[248:251], v[210:213]
    v_mfma_f32_16x16x32_bf16 v[230:233], a[40:43], a[252:255], v[230:233]
    v_mfma_f32_16x16x32_bf16 v[230:233], a[20:23], a[236:239], v[230:233]
    v_mfma_f32_16x16x32_bf16 v[174:177], a[24:27], a[224:227], v[174:177]
    s_add_u32 s44, s30, 212992
    buffer_load_dwordx4 a[208:211], v4, s[8:11], s44 offen sc1
    v_mfma_f32_16x16x32_bf16 v[174:177], a[44:47], a[240:243], v[174:177]
    v_mfma_f32_16x16x32_bf16 v[194:197], a[44:47], a[244:247], v[194:197]
    v_mfma_f32_16x16x32_bf16 v[194:197], a[24:27], a[228:231], v[194:197]
    buffer_load_dwordx4 a[212:215], v5, s[8:11], s44 offen sc1
    v_mfma_f32_16x16x32_bf16 v[214:217], a[24:27], a[232:235], v[214:217]
    v_mfma_f32_16x16x32_bf16 v[214:217], a[44:47], a[248:251], v[214:217]
    v_mfma_f32_16x16x32_bf16 v[234:237], a[44:47], a[252:255], v[234:237]
    v_mfma_f32_16x16x32_bf16 v[234:237], a[24:27], a[236:239], v[234:237]
    buffer_load_dwordx4 a[216:219], v6, s[8:11], s44 offen sc1
    v_mfma_f32_16x16x32_bf16 v[178:181], a[28:31], a[224:227], v[178:181]
    v_mfma_f32_16x16x32_bf16 v[178:181], a[48:51], a[240:243], v[178:181]
    v_mfma_f32_16x16x32_bf16 v[198:201], a[48:51], a[244:247], v[198:201]
    v_mfma_f32_16x16x32_bf16 v[198:201], a[28:31], a[228:231], v[198:201]
    buffer_load_dwordx4 a[220:223], v7, s[8:11], s44 offen sc1
    v_mfma_f32_16x16x32_bf16 v[218:221], a[28:31], a[232:235], v[218:221]
    v_mfma_f32_16x16x32_bf16 v[218:221], a[48:51], a[248:251], v[218:221]
    v_mfma_f32_16x16x32_bf16 v[238:241], a[48:51], a[252:255], v[238:241]
    v_mfma_f32_16x16x32_bf16 v[238:241], a[28:31], a[236:239], v[238:241]
    v_mfma_f32_16x16x32_bf16 v[182:185], a[32:35], a[224:227], v[182:185]
    v_mfma_f32_16x16x32_bf16 v[182:185], a[52:55], a[240:243], v[182:185]
    v_mfma_f32_16x16x32_bf16 v[202:205], a[52:55], a[244:247], v[202:205]
    v_mfma_f32_16x16x32_bf16 v[202:205], a[32:35], a[228:231], v[202:205]
    v_mfma_f32_16x16x32_bf16 v[222:225], a[32:35], a[232:235], v[222:225]
    v_mfma_f32_16x16x32_bf16 v[222:225], a[52:55], a[248:251], v[222:225]
    v_mfma_f32_16x16x32_bf16 v[242:245], a[52:55], a[252:255], v[242:245]
    v_mfma_f32_16x16x32_bf16 v[242:245], a[32:35], a[236:239], v[242:245]
    s_waitcnt vmcnt(8)
    v_mfma_f32_16x16x32_bf16 v[166:169], a[56:59], a[96:99], v[166:169]
    v_mfma_f32_16x16x32_bf16 v[166:169], a[76:79], a[112:115], v[166:169]
    s_add_u32 s44, s30, 131072
    buffer_load_dwordx4 a[224:227], v4, s[8:11], s44 offen sc1
    v_mfma_f32_16x16x32_bf16 v[186:189], a[76:79], a[116:119], v[186:189]
    ds_read_b128 v[126:129], v8 offset:0
    v_mfma_f32_16x16x32_bf16 v[186:189], a[56:59], a[100:103], v[186:189]
    v_mfma_f32_16x16x32_bf16 v[206:209], a[56:59], a[104:107], v[206:209]
    buffer_load_dwordx4 a[228:231], v5, s[8:11], s44 offen sc1
    v_mfma_f32_16x16x32_bf16 v[206:209], a[76:79], a[120:123], v[206:209]
    ds_read_b128 v[130:133], v8 offset:1024
    v_mfma_f32_16x16x32_bf16 v[226:229], a[76:79], a[124:127], v[226:229]
    v_mfma_f32_16x16x32_bf16 v[226:229], a[56:59], a[108:111], v[226:229]
    ds_read_b128 v[134:137], v8 offset:2048
    v_mfma_f32_16x16x32_bf16 v[170:173], a[60:63], a[96:99], v[170:173]
    buffer_load_dwordx4 a[232:235], v6, s[8:11], s44 offen sc1
    v_mfma_f32_16x16x32_bf16 v[170:173], a[80:83], a[112:115], v[170:173]
    v_mfma_f32_16x16x32_bf16 v[190:193], a[80:83], a[116:119], v[190:193]
    ds_read_b128 v[138:141], v8 offset:3072
    v_mfma_f32_16x16x32_bf16 v[190:193], a[60:63], a[100:103], v[190:193]
    v_mfma_f32_16x16x32_bf16 v[210:213], a[60:63], a[104:107], v[210:213]
    buffer_load_dwordx4 a[236:239], v7, s[8:11], s44 offen sc1
    v_mfma_f32_16x16x32_bf16 v[210:213], a[80:83], a[120:123], v[210:213]
    ds_read_b128 v[142:145], v8 offset:4096
    v_mfma_f32_16x16x32_bf16 v[230:233], a[80:83], a[124:127], v[230:233]
    v_mfma_f32_16x16x32_bf16 v[230:233], a[60:63], a[108:111], v[230:233]
    ds_read_b128 v[146:149], v8 offset:5120
    v_mfma_f32_16x16x32_bf16 v[174:177], a[64:67], a[96:99], v[174:177]
    s_add_u32 s44, s30, 147456
    buffer_load_dwordx4 a[240:243], v4, s[8:11], s44 offen sc1
    v_mfma_f32_16x16x32_bf16 v[174:177], a[84:87], a[112:115], v[174:177]
    v_mfma_f32_16x16x32_bf16 v[194:197], a[84:87], a[116:119], v[194:197]
    ds_read_b128 v[150:153], v8 offset:6144
    v_mfma_f32_16x16x32_bf16 v[194:197], a[64:67], a[100:103], v[194:197]
    buffer_load_dwordx4 a[244:247], v5, s[8:11], s44 offen sc1
    v_mfma_f32_16x16x32_bf16 v[214:217], a[64:67], a[104:107], v[214:217]
    v_mfma_f32_16x16x32_bf16 v[214:217], a[84:87], a[120:123], v[214:217]
    ds_read_b128 v[154:157], v8 offset:7168
    v_mfma_f32_16x16x32_bf16 v[234:237], a[84:87], a[124:127], v[234:237]
    v_mfma_f32_16x16x32_bf16 v[234:237], a[64:67], a[108:111], v[234:237]
    buffer_load_dwordx4 a[248:251], v6, s[8:11], s44 offen sc1
    v_mfma_f32_16x16x32_bf16 v[178:181], a[68:71], a[96:99], v[178:181]
    ds_read_b128 v[158:161], v8 offset:8192
    v_mfma_f32_16x16x32_bf16 v[178:181], a[88:91], a[112:115], v[178:181]
    v_mfma_f32_16x16x32_bf16 v[198:201], a[88:91], a[116:119], v[198:201]
    ds_read_b128 v[162:165], v8 offset:9216
    v_mfma_f32_16x16x32_bf16 v[198:201], a[68:71], a[100:103], v[198:201]
    buffer_load_dwordx4 a[252:255], v7, s[8:11], s44 offen sc1
    v_mfma_f32_16x16x32_bf16 v[218:221], a[68:71], a[104:107], v[218:221]
    v_mfma_f32_16x16x32_bf16 v[218:221], a[88:91], a[120:123], v[218:221]
    v_mfma_f32_16x16x32_bf16 v[238:241], a[88:91], a[124:127], v[238:241]
    v_mfma_f32_16x16x32_bf16 v[238:241], a[68:71], a[108:111], v[238:241]
    v_mfma_f32_16x16x32_bf16 v[182:185], a[72:75], a[96:99], v[182:185]
    v_mfma_f32_16x16x32_bf16 v[182:185], a[92:95], a[112:115], v[182:185]
    v_mfma_f32_16x16x32_bf16 v[202:205], a[92:95], a[116:119], v[202:205]
    v_mfma_f32_16x16x32_bf16 v[202:205], a[72:75], a[100:103], v[202:205]
    v_mfma_f32_16x16x32_bf16 v[222:225], a[72:75], a[104:107], v[222:225]
    v_mfma_f32_16x16x32_bf16 v[222:225], a[92:95], a[120:123], v[222:225]
    v_mfma_f32_16x16x32_bf16 v[242:245], a[92:95], a[124:127], v[242:245]
    v_mfma_f32_16x16x32_bf16 v[242:245], a[72:75], a[108:111], v[242:245]
    s_waitcnt vmcnt(8) lgkmcnt(0)
    v_mfma_f32_16x16x32_bf16 v[166:169], v[126:129], a[192:195], v[166:169]
    v_mfma_f32_16x16x32_bf16 v[166:169], v[146:149], a[208:211], v[166:169]
    s_add_u32 s44, s30, 229376
    buffer_load_dwordx4 a[96:99], v4, s[8:11], s44 offen sc1
    v_mfma_f32_16x16x32_bf16 v[186:189], v[146:149], a[212:215], v[186:189]
    v_mfma_f32_16x16x32_bf16 v[186:189], v[126:129], a[196:199], v[186:189]
    v_mfma_f32_16x16x32_bf16 v[206:209], v[126:129], a[200:203], v[206:209]
    buffer_load_dwordx4 a[100:103], v5, s[8:11], s44 offen sc1
    v_mfma_f32_16x16x32_bf16 v[206:209], v[146:149], a[216:219], v[206:209]
    v_mfma_f32_16x16x32_bf16 v[226:229], v[146:149], a[220:223], v[226:229]
    v_mfma_f32_16x16x32_bf16 v[226:229], v[126:129], a[204:207], v[226:229]
    v_mfma_f32_16x16x32_bf16 v[170:173], v[130:133], a[192:195], v[170:173]
    buffer_load_dwordx4 a[104:107], v6, s[8:11], s44 offen sc1
    v_mfma_f32_16x16x32_bf16 v[170:173], v[150:153], a[208:211], v[170:173]
    v_mfma_f32_16x16x32_bf16 v[190:193], v[150:153], a[212:215], v[190:193]
    v_mfma_f32_16x16x32_bf16 v[190:193], v[130:133], a[196:199], v[190:193]
    v_mfma_f32_16x16x32_bf16 v[210:213], v[130:133], a[200:203], v[210:213]
    buffer_load_dwordx4 a[108:111], v7, s[8:11], s44 offen sc1
    v_mfma_f32_16x16x32_bf16 v[210:213], v[150:153], a[216:219], v[210:213]
    v_mfma_f32_16x16x32_bf16 v[230:233], v[150:153], a[220:223], v[230:233]
    v_mfma_f32_16x16x32_bf16 v[230:233], v[130:133], a[204:207], v[230:233]
    v_mfma_f32_16x16x32_bf16 v[174:177], v[134:137], a[192:195], v[174:177]
    s_add_u32 s44, s30, 245760
    buffer_load_dwordx4 a[112:115], v4, s[8:11], s44 offen sc1
    v_mfma_f32_16x16x32_bf16 v[174:177], v[154:157], a[208:211], v[174:177]
    v_mfma_f32_16x16x32_bf16 v[194:197], v[154:157], a[212:215], v[194:197]
    v_mfma_f32_16x16x32_bf16 v[194:197], v[134:137], a[196:199], v[194:197]
    buffer_load_dwordx4 a[116:119], v5, s[8:11], s44 offen sc1
    v_mfma_f32_16x16x32_bf16 v[214:217], v[134:137], a[200:203], v[214:217]
    v_mfma_f32_16x16x32_bf16 v[214:217], v[154:157], a[216:219], v[214:217]
    v_mfma_f32_16x16x32_bf16 v[234:237], v[154:157], a[220:223], v[234:237]
    v_mfma_f32_16x16x32_bf16 v[234:237], v[134:137], a[204:207], v[234:237]
    buffer_load_dwordx4 a[120:123], v6, s[8:11], s44 offen sc1
    v_mfma_f32_16x16x32_bf16 v[178:181], v[138:141], a[192:195], v[178:181]
    v_mfma_f32_16x16x32_bf16 v[178:181], v[158:161], a[208:211], v[178:181]
    v_mfma_f32_16x16x32_bf16 v[198:201], v[158:161], a[212:215], v[198:201]
    v_mfma_f32_16x16x32_bf16 v[198:201], v[138:141], a[196:199], v[198:201]
    buffer_load_dwordx4 a[124:127], v7, s[8:11], s44 offen sc1
    v_mfma_f32_16x16x32_bf16 v[218:221], v[138:141], a[200:203], v[218:221]
    v_mfma_f32_16x16x32_bf16 v[218:221], v[158:161], a[216:219], v[218:221]
    v_mfma_f32_16x16x32_bf16 v[238:241], v[158:161], a[220:223], v[238:241]
    v_mfma_f32_16x16x32_bf16 v[238:241], v[138:141], a[204:207], v[238:241]
    v_mfma_f32_16x16x32_bf16 v[182:185], v[142:145], a[192:195], v[182:185]
    v_mfma_f32_16x16x32_bf16 v[182:185], v[162:165], a[208:211], v[182:185]
    v_mfma_f32_16x16x32_bf16 v[202:205], v[162:165], a[212:215], v[202:205]
    v_mfma_f32_16x16x32_bf16 v[202:205], v[142:145], a[196:199], v[202:205]
    v_mfma_f32_16x16x32_bf16 v[222:225], v[142:145], a[200:203], v[222:225]
    v_mfma_f32_16x16x32_bf16 v[222:225], v[162:165], a[216:219], v[222:225]
    v_mfma_f32_16x16x32_bf16 v[242:245], v[162:165], a[220:223], v[242:245]
    v_mfma_f32_16x16x32_bf16 v[242:245], v[142:145], a[204:207], v[242:245]
    s_waitcnt vmcnt(8)
    v_mfma_f32_16x16x32_bf16 v[166:169], v[46:49], a[224:227], v[166:169]
    v_mfma_f32_16x16x32_bf16 v[166:169], v[66:69], a[240:243], v[166:169]
    s_add_u32 s44, s30, 163840
    buffer_load_dwordx4 a[192:195], v4, s[8:11], s44 offen sc1
    s_lshl_b32 s36, s2, 5
    v_mfma_f32_16x16x32_bf16 v[186:189], v[66:69], a[244:247], v[186:189]
    ds_read_b128 v[126:129], v9 offset:0
    v_mfma_f32_16x16x32_bf16 v[186:189], v[46:49], a[228:231], v[186:189]
    s_add_u32 s36, s36, s5
    v_mfma_f32_16x16x32_bf16 v[206:209], v[46:49], a[232:235], v[206:209]
    buffer_load_dwordx4 a[196:199], v5, s[8:11], s44 offen sc1
    v_mfma_f32_16x16x32_bf16 v[206:209], v[66:69], a[248:251], v[206:209]
    ds_read_b128 v[130:133], v9 offset:1024
    s_lshl_b32 s36, s36, 2
    v_mfma_f32_16x16x32_bf16 v[226:229], v[66:69], a[252:255], v[226:229]
    s_add_u32 s36, s36, 0x2a0000
    v_mfma_f32_16x16x32_bf16 v[226:229], v[46:49], a[236:239], v[226:229]
    ds_read_b128 v[134:137], v9 offset:2048
    v_mfma_f32_16x16x32_bf16 v[170:173], v[50:53], a[224:227], v[170:173]
    buffer_load_dwordx4 a[200:203], v6, s[8:11], s44 offen sc1
    s_xor_b32 s37, s36, 1024
    v_mfma_f32_16x16x32_bf16 v[170:173], v[70:73], a[240:243], v[170:173]
    v_mfma_f32_16x16x32_bf16 v[190:193], v[70:73], a[244:247], v[190:193]
    ds_read_b128 v[138:141], v9 offset:3072
    s_sub_u32 s40, s5, 1
    v_mfma_f32_16x16x32_bf16 v[190:193], v[50:53], a[228:231], v[190:193]
    v_mfma_f32_16x16x32_bf16 v[210:213], v[50:53], a[232:235], v[210:213]
    buffer_load_dwordx4 a[204:207], v7, s[8:11], s44 offen sc1
    s_and_b32 s40, s40, 3
    v_mfma_f32_16x16x32_bf16 v[210:213], v[70:73], a[248:251], v[210:213]
    ds_read_b128 v[142:145], v9 offset:4096
    s_mul_i32 s40, s40, 20480
    v_mfma_f32_16x16x32_bf16 v[230:233], v[70:73], a[252:255], v[230:233]
    v_mfma_f32_16x16x32_bf16 v[230:233], v[50:53], a[236:239], v[230:233]
    ds_read_b128 v[146:149], v9 offset:5120
    v_lshl_add_u32 v13, v19, 4, s40
    v_mfma_f32_16x16x32_bf16 v[174:177], v[54:57], a[224:227], v[174:177]
    s_add_u32 s44, s30, 180224
    buffer_load_dwordx4 a[208:211], v4, s[8:11], s44 offen sc1
    v_mfma_f32_16x16x32_bf16 v[174:177], v[74:77], a[240:243], v[174:177]
    s_sub_u32 s40, s5, 2
    v_mfma_f32_16x16x32_bf16 v[194:197], v[74:77], a[244:247], v[194:197]
    ds_read_b128 v[150:153], v9 offset:6144
    v_mfma_f32_16x16x32_bf16 v[194:197], v[54:57], a[228:231], v[194:197]
    buffer_load_dwordx4 a[212:215], v5, s[8:11], s44 offen sc1
    s_and_b32 s40, s40, 3
    v_mfma_f32_16x16x32_bf16 v[214:217], v[54:57], a[232:235], v[214:217]
    s_mul_i32 s40, s40, 20480
    v_mfma_f32_16x16x32_bf16 v[214:217], v[74:77], a[248:251], v[214:217]
    ds_read_b128 v[154:157], v9 offset:7168
    v_mfma_f32_16x16x32_bf16 v[234:237], v[74:77], a[252:255], v[234:237]
    v_lshl_add_u32 v14, v19, 4, s40
    v_mfma_f32_16x16x32_bf16 v[234:237], v[54:57], a[236:239], v[234:237]
    buffer_load_dwordx4 a[216:219], v6, s[8:11], s44 offen sc1
    v_mfma_f32_16x16x32_bf16 v[178:181], v[58:61], a[224:227], v[178:181]
    ds_read_b128 v[158:161], v9 offset:8192
    s_sub_u32 s40, s5, 3
    v_mfma_f32_16x16x32_bf16 v[178:181], v[78:81], a[240:243], v[178:181]
    v_mfma_f32_16x16x32_bf16 v[198:201], v[78:81], a[244:247], v[198:201]
    ds_read_b128 v[162:165], v9 offset:9216
    s_and_b32 s40, s40, 3
    v_mfma_f32_16x16x32_bf16 v[198:201], v[58:61], a[228:231], v[198:201]
    buffer_load_dwordx4 a[220:223], v7, s[8:11], s44 offen sc1
    s_mul_i32 s40, s40, 20480
    v_mfma_f32_16x16x32_bf16 v[218:221], v[58:61], a[232:235], v[218:221]
    v_mfma_f32_16x16x32_bf16 v[218:221], v[78:81], a[248:251], v[218:221]
    v_lshl_add_u32 v15, v19, 4, s40
    v_mfma_f32_16x16x32_bf16 v[238:241], v[78:81], a[252:255], v[238:241]
    v_mfma_f32_16x16x32_bf16 v[238:241], v[58:61], a[236:239], v[238:241]
    s_lshl_b32 s40, s2, 2
    v_mfma_f32_16x16x32_bf16 v[182:185], v[62:65], a[224:227], v[182:185]
    v_mfma_f32_16x16x32_bf16 v[182:185], v[82:85], a[240:243], v[182:185]
    s_add_u32 s40, s40, s5
    v_mfma_f32_16x16x32_bf16 v[202:205], v[82:85], a[244:247], v[202:205]
    s_mul_i32 s40, s40, 5120
    v_mfma_f32_16x16x32_bf16 v[202:205], v[62:65], a[228:231], v[202:205]
    v_mfma_f32_16x16x32_bf16 v[222:225], v[62:65], a[232:235], v[222:225]
    s_add_u32 s40, s40, 0x2000000
    v_mfma_f32_16x16x32_bf16 v[222:225], v[82:85], a[248:251], v[222:225]
    v_mfma_f32_16x16x32_bf16 v[242:245], v[82:85], a[252:255], v[242:245]
    v_lshl_add_u32 v18, v19, 4, s40
    v_mfma_f32_16x16x32_bf16 v[242:245], v[62:65], a[236:239], v[242:245]
    s_mov_b32 s41, 4096
    s_waitcnt vmcnt(8) lgkmcnt(0)
    v_mfma_f32_16x16x32_bf16 v[166:169], v[126:129], a[96:99], v[166:169]
    v_mfma_f32_16x16x32_bf16 v[166:169], v[146:149], a[112:115], v[166:169]
    s_add_u32 s44, s31, 0
    buffer_load_dwordx4 a[224:227], v4, s[8:11], s44 offen sc1
    v_mfma_f32_16x16x32_bf16 v[186:189], v[146:149], a[116:119], v[186:189]
    v_mfma_f32_16x16x32_bf16 v[186:189], v[126:129], a[100:103], v[186:189]
    v_mfma_f32_16x16x32_bf16 v[206:209], v[126:129], a[104:107], v[206:209]
    buffer_load_dwordx4 a[228:231], v5, s[8:11], s44 offen sc1
    v_mfma_f32_16x16x32_bf16 v[206:209], v[146:149], a[120:123], v[206:209]
    v_mfma_f32_16x16x32_bf16 v[226:229], v[146:149], a[124:127], v[226:229]
    v_mfma_f32_16x16x32_bf16 v[226:229], v[126:129], a[108:111], v[226:229]
    v_mfma_f32_16x16x32_bf16 v[170:173], v[130:133], a[96:99], v[170:173]
    buffer_load_dwordx4 a[232:235], v6, s[8:11], s44 offen sc1
    v_mfma_f32_16x16x32_bf16 v[170:173], v[150:153], a[112:115], v[170:173]
    v_mfma_f32_16x16x32_bf16 v[190:193], v[150:153], a[116:119], v[190:193]
    v_mfma_f32_16x16x32_bf16 v[190:193], v[130:133], a[100:103], v[190:193]
    v_mfma_f32_16x16x32_bf16 v[210:213], v[130:133], a[104:107], v[210:213]
    buffer_load_dwordx4 a[236:239], v7, s[8:11], s44 offen sc1
    v_mfma_f32_16x16x32_bf16 v[210:213], v[150:153], a[120:123], v[210:213]
    v_mfma_f32_16x16x32_bf16 v[230:233], v[150:153], a[124:127], v[230:233]
    v_mfma_f32_16x16x32_bf16 v[230:233], v[130:133], a[108:111], v[230:233]
    v_mfma_f32_16x16x32_bf16 v[174:177], v[134:137], a[96:99], v[174:177]
    s_add_u32 s44, s31, 16384
    buffer_load_dwordx4 a[240:243], v4, s[8:11], s44 offen sc1
    v_mfma_f32_16x16x32_bf16 v[174:177], v[154:157], a[112:115], v[174:177]
    v_mfma_f32_16x16x32_bf16 v[194:197], v[154:157], a[116:119], v[194:197]
    v_mfma_f32_16x16x32_bf16 v[194:197], v[134:137], a[100:103], v[194:197]
    buffer_load_dwordx4 a[244:247], v5, s[8:11], s44 offen sc1
    v_mfma_f32_16x16x32_bf16 v[214:217], v[134:137], a[104:107], v[214:217]
    v_mfma_f32_16x16x32_bf16 v[214:217], v[154:157], a[120:123], v[214:217]
    v_mfma_f32_16x16x32_bf16 v[234:237], v[154:157], a[124:127], v[234:237]
    v_mfma_f32_16x16x32_bf16 v[234:237], v[134:137], a[108:111], v[234:237]
    buffer_load_dwordx4 a[248:251], v6, s[8:11], s44 offen sc1
    v_mfma_f32_16x16x32_bf16 v[178:181], v[138:141], a[96:99], v[178:181]
    v_mfma_f32_16x16x32_bf16 v[178:181], v[158:161], a[112:115], v[178:181]
    v_mfma_f32_16x16x32_bf16 v[198:201], v[158:161], a[116:119], v[198:201]
    v_mfma_f32_16x16x32_bf16 v[198:201], v[138:141], a[100:103], v[198:201]
    buffer_load_dwordx4 a[252:255], v7, s[8:11], s44 offen sc1
    v_mfma_f32_16x16x32_bf16 v[218:221], v[138:141], a[104:107], v[218:221]
    v_mfma_f32_16x16x32_bf16 v[218:221], v[158:161], a[120:123], v[218:221]
    v_mfma_f32_16x16x32_bf16 v[238:241], v[158:161], a[124:127], v[238:241]
    v_mfma_f32_16x16x32_bf16 v[238:241], v[138:141], a[108:111], v[238:241]
    v_mfma_f32_16x16x32_bf16 v[182:185], v[142:145], a[96:99], v[182:185]
    v_mfma_f32_16x16x32_bf16 v[182:185], v[162:165], a[112:115], v[182:185]
    v_mfma_f32_16x16x32_bf16 v[202:205], v[162:165], a[116:119], v[202:205]
    v_mfma_f32_16x16x32_bf16 v[202:205], v[142:145], a[100:103], v[202:205]
    v_mfma_f32_16x16x32_bf16 v[222:225], v[142:145], a[104:107], v[222:225]
    v_mfma_f32_16x16x32_bf16 v[222:225], v[162:165], a[120:123], v[222:225]
    v_mfma_f32_16x16x32_bf16 v[242:245], v[162:165], a[124:127], v[242:245]
    v_mfma_f32_16x16x32_bf16 v[242:245], v[142:145], a[108:111], v[242:245]
    s_waitcnt vmcnt(8)
    v_mfma_f32_16x16x32_bf16 v[186:189], v[86:89], a[196:199], v[186:189]
    v_mfma_f32_16x16x32_bf16 v[186:189], v[106:109], a[212:215], v[186:189]
    s_add_u32 s44, s31, 32768
    buffer_load_dwordx4 a[96:99], v4, s[8:11], s44 offen sc1
    v_mfma_f32_16x16x32_bf16 v[190:193], v[110:113], a[212:215], v[190:193]
    v_mfma_f32_16x16x32_bf16 v[190:193], v[90:93], a[196:199], v[190:193]
    v_mfma_f32_16x16x32_bf16 v[194:197], v[94:97], a[196:199], v[194:197]
    buffer_load_dwordx4 a[100:103], v5, s[8:11], s44 offen sc1
    v_mfma_f32_16x16x32_bf16 v[194:197], v[114:117], a[212:215], v[194:197]
    v_mfma_f32_16x16x32_bf16 v[198:201], v[118:121], a[212:215], v[198:201]
    v_mfma_f32_16x16x32_bf16 v[198:201], v[98:101], a[196:199], v[198:201]
    v_mfma_f32_16x16x32_bf16 v[202:205], v[102:105], a[196:199], v[202:205]
    buffer_load_dwordx4 a[104:107], v6, s[8:11], s44 offen sc1
    v_mfma_f32_16x16x32_bf16 v[202:205], v[122:125], a[212:215], v[202:205]
    ds_write_b128 v10, v[186:189] offset:0
    v_mfma_f32_16x16x32_bf16 v[206:209], v[106:109], a[216:219], v[206:209]
    v_mfma_f32_16x16x32_bf16 v[206:209], v[86:89], a[200:203], v[206:209]
    ds_write_b128 v10, v[190:193] offset:1024
    v_mfma_f32_16x16x32_bf16 v[210:213], v[90:93], a[200:203], v[210:213]
    buffer_load_dwordx4 a[108:111], v7, s[8:11], s44 offen sc1
    v_mfma_f32_16x16x32_bf16 v[210:213], v[110:113], a[216:219], v[210:213]
    ds_write_b128 v10, v[194:197] offset:2048
    v_mfma_f32_16x16x32_bf16 v[214:217], v[114:117], a[216:219], v[214:217]
    v_mfma_f32_16x16x32_bf16 v[214:217], v[94:97], a[200:203], v[214:217]
    ds_write_b128 v10, v[198:201] offset:3072
    v_mfma_f32_16x16x32_bf16 v[218:221], v[98:101], a[200:203], v[218:221]
    s_add_u32 s44, s31, 49152
    buffer_load_dwordx4 a[112:115], v4, s[8:11], s44 offen sc1
    v_mfma_f32_16x16x32_bf16 v[218:221], v[118:121], a[216:219], v[218:221]
    ds_write_b128 v10, v[202:205] offset:4096
    v_mfma_f32_16x16x32_bf16 v[222:225], v[122:125], a[216:219], v[222:225]
    v_mfma_f32_16x16x32_bf16 v[222:225], v[102:105], a[200:203], v[222:225]
    ds_write_b128 v10, v[206:209] offset:5120
    buffer_load_dwordx4 a[116:119], v5, s[8:11], s44 offen sc1
    v_mfma_f32_16x16x32_bf16 v[226:229], v[86:89], a[204:207], v[226:229]
    v_mfma_f32_16x16x32_bf16 v[226:229], v[106:109], a[220:223], v[226:229]
    ds_write_b128 v10, v[210:213] offset:6144
    v_mfma_f32_16x16x32_bf16 v[230:233], v[110:113], a[220:223], v[230:233]
    v_mfma_f32_16x16x32_bf16 v[230:233], v[90:93], a[204:207], v[230:233]
    ds_write_b128 v10, v[214:217] offset:7168
    buffer_load_dwordx4 a[120:123], v6, s[8:11], s44 offen sc1
    v_mfma_f32_16x16x32_bf16 v[234:237], v[94:97], a[204:207], v[234:237]
    v_mfma_f32_16x16x32_bf16 v[234:237], v[114:117], a[220:223], v[234:237]
    ds_write_b128 v10, v[218:221] offset:8192
    v_mfma_f32_16x16x32_bf16 v[238:241], v[118:121], a[220:223], v[238:241]
    v_mfma_f32_16x16x32_bf16 v[238:241], v[98:101], a[204:207], v[238:241]
    ds_write_b128 v10, v[222:225] offset:9216
    buffer_load_dwordx4 a[124:127], v7, s[8:11], s44 offen sc1
    v_mfma_f32_16x16x32_bf16 v[242:245], v[102:105], a[204:207], v[242:245]
    v_mfma_f32_16x16x32_bf16 v[242:245], v[122:125], a[220:223], v[242:245]
    ds_write_b128 v10, v[226:229] offset:10240
    v_mfma_f32_16x16x32_bf16 v[166:169], v[106:109], a[208:211], v[166:169]
    v_mfma_f32_16x16x32_bf16 v[166:169], v[86:89], a[192:195], v[166:169]
    ds_write_b128 v10, v[230:233] offset:11264
    v_mfma_f32_16x16x32_bf16 v[170:173], v[90:93], a[192:195], v[170:173]
    v_mfma_f32_16x16x32_bf16 v[170:173], v[110:113], a[208:211], v[170:173]
    ds_write_b128 v10, v[234:237] offset:12288
    v_mfma_f32_16x16x32_bf16 v[174:177], v[114:117], a[208:211], v[174:177]
    v_mfma_f32_16x16x32_bf16 v[174:177], v[94:97], a[192:195], v[174:177]
    ds_write_b128 v10, v[238:241] offset:13312
    v_mfma_f32_16x16x32_bf16 v[178:181], v[98:101], a[192:195], v[178:181]
    v_mfma_f32_16x16x32_bf16 v[178:181], v[118:121], a[208:211], v[178:181]
    ds_write_b128 v10, v[242:245] offset:14336
    v_mfma_f32_16x16x32_bf16 v[182:185], v[122:125], a[208:211], v[182:185]
    v_mfma_f32_16x16x32_bf16 v[182:185], v[102:105], a[192:195], v[182:185]
    s_waitcnt vmcnt(8)
    v_mfma_f32_16x16x32_bf16 v[186:189], a[128:131], a[228:231], 0
    s_nop 0
    v_mov_b32 v126, v166
    v_mfma_f32_16x16x32_bf16 v[186:189], a[148:151], a[244:247], v[186:189]
    s_add_u32 s44, s31, 65536
    buffer_load_dwordx4 a[192:195], v4, s[8:11], s44 offen sc1
    v_mov_b32 v127, v167
    v_mov_b32 v128, v168
    v_mov_b32 v129, v169
    v_mfma_f32_16x16x32_bf16 v[190:193], a[152:155], a[244:247], 0
    v_mov_b32 v130, v170
    v_mov_b32 v131, v171
    v_mov_b32 v132, v172
    v_mfma_f32_16x16x32_bf16 v[190:193], a[132:135], a[228:231], v[190:193]
    v_mov_b32 v133, v173
    s_waitcnt lgkmcnt(0)
    s_barrier
    v_mfma_f32_16x16x32_bf16 v[194:197], a[136:139], a[228:231], 0
    buffer_load_dwordx4 a[196:199], v5, s[8:11], s44 offen sc1
    ds_read_b128 v[146:149], v13 offset:0
    ds_read_b128 v[150:153], v13 offset:1024
    v_mfma_f32_16x16x32_bf16 v[194:197], a[156:159], a[244:247], v[194:197]
    ds_read_b128 v[154:157], v13 offset:2048
    ds_read_b128 v[158:161], v13 offset:3072
    ds_read_b128 v[162:165], v13 offset:4096
    v_mfma_f32_16x16x32_bf16 v[198:201], a[160:163], a[244:247], 0
    v_mov_b32 v134, v174
    v_mov_b32 v135, v175
    v_mov_b32 v136, v176
    v_mfma_f32_16x16x32_bf16 v[198:201], a[140:143], a[228:231], v[198:201]
    v_mov_b32 v137, v177
    v_mov_b32 v138, v178
    v_mov_b32 v139, v179
    v_mfma_f32_16x16x32_bf16 v[202:205], a[144:147], a[228:231], 0
    buffer_load_dwordx4 a[200:203], v6, s[8:11], s44 offen sc1
    v_mov_b32 v140, v180
    v_mov_b32 v141, v181
    v_mfma_f32_16x16x32_bf16 v[202:205], a[164:167], a[244:247], v[202:205]
    v_mov_b32 v142, v182
    v_mov_b32 v143, v183
    v_mov_b32 v144, v184
    v_mfma_f32_16x16x32_bf16 v[206:209], a[148:151], a[248:251], 0
    v_mov_b32 v145, v185
    s_waitcnt lgkmcnt(4)
    v_add_f32 v126, v126, v146
    v_mfma_f32_16x16x32_bf16 v[206:209], a[128:131], a[232:235], v[206:209]
    v_add_f32 v127, v127, v147
    v_add_f32 v128, v128, v148
    v_add_f32 v129, v129, v149
    v_mfma_f32_16x16x32_bf16 v[210:213], a[132:135], a[232:235], 0
    buffer_load_dwordx4 a[204:207], v7, s[8:11], s44 offen sc1
    ds_read_b128 v[146:149], v14 offset:5120
    s_waitcnt lgkmcnt(4)
    v_mfma_f32_16x16x32_bf16 v[210:213], a[152:155], a[248:251], v[210:213]
    v_add_f32 v130, v130, v150
    v_add_f32 v131, v131, v151
    v_add_f32 v132, v132, v152
    v_mfma_f32_16x16x32_bf16 v[214:217], a[156:159], a[248:251], 0
    v_add_f32 v133, v133, v153
    ds_read_b128 v[150:153], v14 offset:6144
    s_waitcnt lgkmcnt(4)
    v_mfma_f32_16x16x32_bf16 v[214:217], a[136:139], a[232:235], v[214:217]
    v_add_f32 v134, v134, v154
    v_add_f32 v135, v135, v155
    v_add_f32 v136, v136, v156
    v_mfma_f32_16x16x32_bf16 v[218:221], a[140:143], a[232:235], 0
    s_add_u32 s44, s31, 81920
    buffer_load_dwordx4 a[208:211], v4, s[8:11], s44 offen sc1
    v_add_f32 v137, v137, v157
    ds_read_b128 v[154:157], v14 offset:7168
    v_mfma_f32_16x16x32_bf16 v[218:221], a[160:163], a[248:251], v[218:221]
    s_waitcnt lgkmcnt(4)
    v_add_f32 v138, v138, v158
    v_add_f32 v139, v139, v159
    v_mfma_f32_16x16x32_bf16 v[222:225], a[164:167], a[248:251], 0
    v_add_f32 v140, v140, v160
    v_add_f32 v141, v141, v161
    ds_read_b128 v[158:161], v14 offset:8192
    v_mfma_f32_16x16x32_bf16 v[222:225], a[144:147], a[232:235], v[222:225]
    buffer_load_dwordx4 a[212:215], v5, s[8:11], s44 offen sc1
    s_waitcnt lgkmcnt(4)
    v_add_f32 v142, v142, v162
    v_add_f32 v143, v143, v163
    v_mfma_f32_16x16x32_bf16 v[226:229], a[128:131], a[236:239], 0
    v_add_f32 v144, v144, v164
    v_add_f32 v145, v145, v165
    v_mfma_f32_16x16x32_bf16 v[226:229], a[148:151], a[252:255], v[226:229]
    ds_read_b128 v[162:165], v14 offset:9216
    s_waitcnt lgkmcnt(4)
    v_add_f32 v126, v126, v146
    v_mfma_f32_16x16x32_bf16 v[230:233], a[152:155], a[252:255], 0
    v_add_f32 v127, v127, v147
    v_add_f32 v128, v128, v148
    v_add_f32 v129, v129, v149
    v_mfma_f32_16x16x32_bf16 v[230:233], a[132:135], a[236:239], v[230:233]
    buffer_load_dwordx4 a[216:219], v6, s[8:11], s44 offen sc1
    ds_read_b128 v[146:149], v15 offset:10240
    s_waitcnt lgkmcnt(4)
    v_add_f32 v130, v130, v150
    v_mfma_f32_16x16x32_bf16 v[234:237], a[136:139], a[236:239], 0
    v_add_f32 v131, v131, v151
    v_add_f32 v132, v132, v152
    v_mfma_f32_16x16x32_bf16 v[234:237], a[156:159], a[252:255], v[234:237]
    v_add_f32 v133, v133, v153
    ds_read_b128 v[150:153], v15 offset:11264
    s_waitcnt lgkmcnt(4)
    v_mfma_f32_16x16x32_bf16 v[238:241], a[160:163], a[252:255], 0
    v_add_f32 v134, v134, v154
    v_add_f32 v135, v135, v155
    v_add_f32 v136, v136, v156
    v_mfma_f32_16x16x32_bf16 v[238:241], a[140:143], a[236:239], v[238:241]
    buffer_load_dwordx4 a[220:223], v7, s[8:11], s44 offen sc1
    v_add_f32 v137, v137, v157
    ds_read_b128 v[154:157], v15 offset:12288
    s_waitcnt lgkmcnt(4)
    v_mfma_f32_16x16x32_bf16 v[242:245], a[144:147], a[236:239], 0
    v_add_f32 v138, v138, v158
    v_add_f32 v139, v139, v159
    v_mfma_f32_16x16x32_bf16 v[242:245], a[164:167], a[252:255], v[242:245]
    v_add_f32 v140, v140, v160
    v_add_f32 v141, v141, v161
    ds_read_b128 v[158:161], v15 offset:13312
    v_mfma_f32_16x16x32_bf16 v[166:169], a[148:151], a[240:243], 0
    s_waitcnt lgkmcnt(4)
    v_add_f32 v142, v142, v162
    v_add_f32 v143, v143, v163
    v_mfma_f32_16x16x32_bf16 v[166:169], a[128:131], a[224:227], v[166:169]
    v_add_f32 v144, v144, v164
    v_add_f32 v145, v145, v165
    ds_read_b128 v[162:165], v15 offset:14336
    v_mfma_f32_16x16x32_bf16 v[170:173], a[132:135], a[224:227], 0
    s_waitcnt lgkmcnt(4)
    v_add_f32 v126, v126, v146
    v_mfma_f32_16x16x32_bf16 v[170:173], a[152:155], a[240:243], v[170:173]
    v_add_f32 v127, v127, v147
    v_add_f32 v128, v128, v148
    v_add_f32 v129, v129, v149
    v_mfma_f32_16x16x32_bf16 v[174:177], a[156:159], a[240:243], 0
    s_waitcnt lgkmcnt(3)
    v_add_f32 v130, v130, v150
    v_add_f32 v131, v131, v151
    v_mfma_f32_16x16x32_bf16 v[174:177], a[136:139], a[224:227], v[174:177]
    v_add_f32 v132, v132, v152
    v_add_f32 v133, v133, v153
    s_waitcnt lgkmcnt(2)
    v_mfma_f32_16x16x32_bf16 v[178:181], a[140:143], a[224:227], 0
    v_add_f32 v134, v134, v154
    v_add_f32 v135, v135, v155
    v_mfma_f32_16x16x32_bf16 v[178:181], a[160:163], a[240:243], v[178:181]
    v_add_f32 v136, v136, v156
    v_add_f32 v137, v137, v157
    s_waitcnt lgkmcnt(1)
    v_mfma_f32_16x16x32_bf16 v[182:185], a[164:167], a[240:243], 0
    v_add_f32 v138, v138, v158
    v_add_f32 v139, v139, v159
    v_add_f32 v140, v140, v160
    v_mfma_f32_16x16x32_bf16 v[182:185], a[144:147], a[224:227], v[182:185]
    v_add_f32 v141, v141, v161
    s_waitcnt lgkmcnt(0)
    v_add_f32 v142, v142, v162
    s_waitcnt vmcnt(8)
    v_mfma_f32_16x16x32_bf16 v[166:169], a[168:171], a[96:99], v[166:169]
    v_mfma_f32_16x16x32_bf16 v[166:169], a[188:191], a[112:115], v[166:169]
    s_add_u32 s44, s31, 196608
    buffer_load_dwordx4 a[224:227], v4, s[8:11], s44 offen sc1
    v_mfma_f32_16x16x32_bf16 v[186:189], a[188:191], a[116:119], v[186:189]
    buffer_load_dwordx4 a[228:231], v5, s[8:11], s44 offen sc1
    v_mfma_f32_16x16x32_bf16 v[186:189], a[168:171], a[100:103], v[186:189]
    buffer_load_dwordx4 a[232:235], v6, s[8:11], s44 offen sc1
    v_add_f32 v143, v143, v163
    v_mfma_f32_16x16x32_bf16 v[206:209], a[168:171], a[104:107], v[206:209]
    buffer_load_dwordx4 a[236:239], v7, s[8:11], s44 offen sc1
    v_mfma_f32_16x16x32_bf16 v[206:209], a[188:191], a[120:123], v[206:209]
    v_mfma_f32_16x16x32_bf16 v[226:229], a[188:191], a[124:127], v[226:229]
    s_add_u32 s44, s31, 212992
    buffer_load_dwordx4 a[240:243], v4, s[8:11], s44 offen sc1
    v_add_f32 v144, v144, v164
    v_mfma_f32_16x16x32_bf16 v[226:229], a[168:171], a[108:111], v[226:229]
    buffer_load_dwordx4 a[244:247], v5, s[8:11], s44 offen sc1
    v_mfma_f32_16x16x32_bf16 v[170:173], a[172:175], a[96:99], v[170:173]
    buffer_load_dwordx4 a[248:251], v6, s[8:11], s44 offen sc1
    v_mfma_f32_16x16x32_bf16 v[170:173], a[0:3], a[112:115], v[170:173]
    buffer_load_dwordx4 a[252:255], v7, s[8:11], s44 offen sc1
    v_add_f32 v145, v145, v165
    v_mfma_f32_16x16x32_bf16 v[190:193], a[0:3], a[116:119], v[190:193]
    v_mfma_f32_16x16x32_bf16 v[190:193], a[172:175], a[100:103], v[190:193]
    v_mfma_f32_16x16x32_bf16 v[210:213], a[172:175], a[104:107], v[210:213]
    buffer_store_dwordx4 v[126:129], v18, s[76:79], 0 offen offset:0 sc1
    v_mfma_f32_16x16x32_bf16 v[210:213], a[0:3], a[120:123], v[210:213]
    v_mfma_f32_16x16x32_bf16 v[230:233], a[0:3], a[124:127], v[230:233]
    v_mfma_f32_16x16x32_bf16 v[230:233], a[172:175], a[108:111], v[230:233]
    v_mfma_f32_16x16x32_bf16 v[174:177], a[176:179], a[96:99], v[174:177]
    v_mfma_f32_16x16x32_bf16 v[174:177], a[4:7], a[112:115], v[174:177]
    v_mfma_f32_16x16x32_bf16 v[194:197], a[4:7], a[116:119], v[194:197]
    buffer_store_dwordx4 v[130:133], v18, s[76:79], 0 offen offset:1024 sc1
    v_mfma_f32_16x16x32_bf16 v[194:197], a[176:179], a[100:103], v[194:197]
    v_mfma_f32_16x16x32_bf16 v[214:217], a[176:179], a[104:107], v[214:217]
    v_mfma_f32_16x16x32_bf16 v[214:217], a[4:7], a[120:123], v[214:217]
    v_mfma_f32_16x16x32_bf16 v[234:237], a[4:7], a[124:127], v[234:237]
    v_mfma_f32_16x16x32_bf16 v[234:237], a[176:179], a[108:111], v[234:237]
    v_mfma_f32_16x16x32_bf16 v[178:181], a[180:183], a[96:99], v[178:181]
    buffer_store_dwordx4 v[134:137], v18, s[76:79], 0 offen offset:2048 sc1
    v_mfma_f32_16x16x32_bf16 v[178:181], a[8:11], a[112:115], v[178:181]
    v_mfma_f32_16x16x32_bf16 v[198:201], a[8:11], a[116:119], v[198:201]
    v_mfma_f32_16x16x32_bf16 v[198:201], a[180:183], a[100:103], v[198:201]
    v_mfma_f32_16x16x32_bf16 v[218:221], a[180:183], a[104:107], v[218:221]
    v_mfma_f32_16x16x32_bf16 v[218:221], a[8:11], a[120:123], v[218:221]
    v_mfma_f32_16x16x32_bf16 v[238:241], a[8:11], a[124:127], v[238:241]
    buffer_store_dwordx4 v[138:141], v18, s[76:79], 0 offen offset:3072 sc1
    v_mfma_f32_16x16x32_bf16 v[238:241], a[180:183], a[108:111], v[238:241]
    v_mfma_f32_16x16x32_bf16 v[182:185], a[184:187], a[96:99], v[182:185]
    v_mfma_f32_16x16x32_bf16 v[182:185], a[12:15], a[112:115], v[182:185]
    v_mfma_f32_16x16x32_bf16 v[202:205], a[12:15], a[116:119], v[202:205]
    v_mfma_f32_16x16x32_bf16 v[202:205], a[184:187], a[100:103], v[202:205]
    v_mfma_f32_16x16x32_bf16 v[222:225], a[184:187], a[104:107], v[222:225]
    buffer_store_dwordx4 v[142:145], v18, s[76:79], s41 offen offset:0 sc1
    v_mfma_f32_16x16x32_bf16 v[222:225], a[12:15], a[120:123], v[222:225]
    v_mfma_f32_16x16x32_bf16 v[242:245], a[12:15], a[124:127], v[242:245]
    v_mfma_f32_16x16x32_bf16 v[242:245], a[184:187], a[108:111], v[242:245]
    s_waitcnt vmcnt(13)
    v_mfma_f32_16x16x32_bf16 v[166:169], a[16:19], a[192:195], v[166:169]
    v_mfma_f32_16x16x32_bf16 v[166:169], a[36:39], a[208:211], v[166:169]
    s_add_u32 s44, s31, 98304
    buffer_load_dwordx4 a[96:99], v4, s[8:11], s44 offen sc1
    v_mfma_f32_16x16x32_bf16 v[186:189], a[36:39], a[212:215], v[186:189]
    v_mfma_f32_16x16x32_bf16 v[186:189], a[16:19], a[196:199], v[186:189]
    v_mfma_f32_16x16x32_bf16 v[206:209], a[16:19], a[200:203], v[206:209]
    buffer_load_dwordx4 a[100:103], v5, s[8:11], s44 offen sc1
    v_mfma_f32_16x16x32_bf16 v[206:209], a[36:39], a[216:219], v[206:209]
    v_mfma_f32_16x16x32_bf16 v[226:229], a[36:39], a[220:223], v[226:229]
    v_mfma_f32_16x16x32_bf16 v[226:229], a[16:19], a[204:207], v[226:229]
    v_mfma_f32_16x16x32_bf16 v[170:173], a[20:23], a[192:195], v[170:173]
    buffer_load_dwordx4 a[104:107], v6, s[8:11], s44 offen sc1
    v_mfma_f32_16x16x32_bf16 v[170:173], a[40:43], a[208:211], v[170:173]
    v_mfma_f32_16x16x32_bf16 v[190:193], a[40:43], a[212:215], v[190:193]
    v_mfma_f32_16x16x32_bf16 v[190:193], a[20:23], a[196:199], v[190:193]
    v_mfma_f32_16x16x32_bf16 v[210:213], a[20:23], a[200:203], v[210:213]
    buffer_load_dwordx4 a[108:111], v7, s[8:11], s44 offen sc1
    v_mfma_f32_16x16x32_bf16 v[210:213], a[40:43], a[216:219], v[210:213]
    v_mfma_f32_16x16x32_bf16 v[230:233], a[40:43], a[220:223], v[230:233]
    v_mfma_f32_16x16x32_bf16 v[230:233], a[20:23], a[204:207], v[230:233]
    ds_read_b128 v[126:129], v8 offset:0
    v_mfma_f32_16x16x32_bf16 v[174:177], a[24:27], a[192:195], v[174:177]
    s_add_u32 s44, s31, 114688
    buffer_load_dwordx4 a[112:115], v4, s[8:11], s44 offen sc1
    v_mfma_f32_16x16x32_bf16 v[174:177], a[44:47], a[208:211], v[174:177]
    v_mfma_f32_16x16x32_bf16 v[194:197], a[44:47], a[212:215], v[194:197]
    ds_read_b128 v[130:133], v8 offset:1024
    v_mfma_f32_16x16x32_bf16 v[194:197], a[24:27], a[196:199], v[194:197]
    buffer_load_dwordx4 a[116:119], v5, s[8:11], s44 offen sc1
    v_mfma_f32_16x16x32_bf16 v[214:217], a[24:27], a[200:203], v[214:217]
    v_mfma_f32_16x16x32_bf16 v[214:217], a[44:47], a[216:219], v[214:217]
    ds_read_b128 v[134:137], v8 offset:2048
    v_mfma_f32_16x16x32_bf16 v[234:237], a[44:47], a[220:223], v[234:237]
    v_mfma_f32_16x16x32_bf16 v[234:237], a[24:27], a[204:207], v[234:237]
    buffer_load_dwordx4 a[120:123], v6, s[8:11], s44 offen sc1
    v_mfma_f32_16x16x32_bf16 v[178:181], a[28:31], a[192:195], v[178:181]
    ds_read_b128 v[138:141], v8 offset:3072
    v_mfma_f32_16x16x32_bf16 v[178:181], a[48:51], a[208:211], v[178:181]
    v_mfma_f32_16x16x32_bf16 v[198:201], a[48:51], a[212:215], v[198:201]
    ds_read_b128 v[142:145], v8 offset:4096
    v_mfma_f32_16x16x32_bf16 v[198:201], a[28:31], a[196:199], v[198:201]
    buffer_load_dwordx4 a[124:127], v7, s[8:11], s44 offen sc1
    v_mfma_f32_16x16x32_bf16 v[218:221], a[28:31], a[200:203], v[218:221]
    v_mfma_f32_16x16x32_bf16 v[218:221], a[48:51], a[216:219], v[218:221]
    ds_read_b128 v[146:149], v8 offset:5120
    v_mfma_f32_16x16x32_bf16 v[238:241], a[48:51], a[220:223], v[238:241]
    v_mfma_f32_16x16x32_bf16 v[238:241], a[28:31], a[204:207], v[238:241]
    ds_read_b128 v[150:153], v8 offset:6144
    v_mfma_f32_16x16x32_bf16 v[182:185], a[32:35], a[192:195], v[182:185]
    v_mfma_f32_16x16x32_bf16 v[182:185], a[52:55], a[208:211], v[182:185]
    ds_read_b128 v[154:157], v8 offset:7168
    v_mfma_f32_16x16x32_bf16 v[202:205], a[52:55], a[212:215], v[202:205]
    v_mfma_f32_16x16x32_bf16 v[202:205], a[32:35], a[196:199], v[202:205]
    ds_read_b128 v[158:161], v8 offset:8192
    v_mfma_f32_16x16x32_bf16 v[222:225], a[32:35], a[200:203], v[222:225]
    v_mfma_f32_16x16x32_bf16 v[222:225], a[52:55], a[216:219], v[222:225]
    ds_read_b128 v[162:165], v8 offset:9216
    v_mfma_f32_16x16x32_bf16 v[242:245], a[52:55], a[220:223], v[242:245]
    v_mfma_f32_16x16x32_bf16 v[242:245], a[32:35], a[204:207], v[242:245]
    s_waitcnt vmcnt(13) lgkmcnt(0)
    v_mfma_f32_16x16x32_bf16 v[166:169], v[126:129], a[224:227], v[166:169]
    s_waitcnt vmcnt(8)
    s_mov_b64 exec, 1
    buffer_store_dword v2, off, s[76:79], s36 sc1
    s_mov_b64 exec, -1
    v_mfma_f32_16x16x32_bf16 v[166:169], v[146:149], a[240:243], v[166:169]
    s_add_u32 s44, s31, 229376
    buffer_load_dwordx4 a[192:195], v4, s[8:11], s44 offen sc1
    v_mfma_f32_16x16x32_bf16 v[186:189], v[146:149], a[244:247], v[186:189]
    v_mfma_f32_16x16x32_bf16 v[186:189], v[126:129], a[228:231], v[186:189]
    v_mfma_f32_16x16x32_bf16 v[206:209], v[126:129], a[232:235], v[206:209]
    buffer_load_dwordx4 a[196:199], v5, s[8:11], s44 offen sc1
    v_mfma_f32_16x16x32_bf16 v[206:209], v[146:149], a[248:251], v[206:209]
    v_mfma_f32_16x16x32_bf16 v[226:229], v[146:149], a[252:255], v[226:229]
    v_mfma_f32_16x16x32_bf16 v[226:229], v[126:129], a[236:239], v[226:229]
    v_mfma_f32_16x16x32_bf16 v[170:173], v[130:133], a[224:227], v[170:173]
    buffer_load_dwordx4 a[200:203], v6, s[8:11], s44 offen sc1
    v_mfma_f32_16x16x32_bf16 v[170:173], v[150:153], a[240:243], v[170:173]
    v_mfma_f32_16x16x32_bf16 v[190:193], v[150:153], a[244:247], v[190:193]
    v_mfma_f32_16x16x32_bf16 v[190:193], v[130:133], a[228:231], v[190:193]
    v_mfma_f32_16x16x32_bf16 v[210:213], v[130:133], a[232:235], v[210:213]
    buffer_load_dwordx4 a[204:207], v7, s[8:11], s44 offen sc1
    v_mfma_f32_16x16x32_bf16 v[210:213], v[150:153], a[248:251], v[210:213]
    v_mfma_f32_16x16x32_bf16 v[230:233], v[150:153], a[252:255], v[230:233]
    v_mfma_f32_16x16x32_bf16 v[230:233], v[130:133], a[236:239], v[230:233]
    v_mfma_f32_16x16x32_bf16 v[174:177], v[134:137], a[224:227], v[174:177]
    s_add_u32 s44, s31, 245760
    buffer_load_dwordx4 a[208:211], v4, s[8:11], s44 offen sc1
    v_mfma_f32_16x16x32_bf16 v[174:177], v[154:157], a[240:243], v[174:177]
    v_mfma_f32_16x16x32_bf16 v[194:197], v[154:157], a[244:247], v[194:197]
    v_mfma_f32_16x16x32_bf16 v[194:197], v[134:137], a[228:231], v[194:197]
    buffer_load_dwordx4 a[212:215], v5, s[8:11], s44 offen sc1
    v_mfma_f32_16x16x32_bf16 v[214:217], v[134:137], a[232:235], v[214:217]
    v_mfma_f32_16x16x32_bf16 v[214:217], v[154:157], a[248:251], v[214:217]
    v_mfma_f32_16x16x32_bf16 v[234:237], v[154:157], a[252:255], v[234:237]
    v_mfma_f32_16x16x32_bf16 v[234:237], v[134:137], a[236:239], v[234:237]
    buffer_load_dwordx4 a[216:219], v6, s[8:11], s44 offen sc1
    v_mfma_f32_16x16x32_bf16 v[178:181], v[138:141], a[224:227], v[178:181]
    v_mfma_f32_16x16x32_bf16 v[178:181], v[158:161], a[240:243], v[178:181]
    v_mfma_f32_16x16x32_bf16 v[198:201], v[158:161], a[244:247], v[198:201]
    v_mfma_f32_16x16x32_bf16 v[198:201], v[138:141], a[228:231], v[198:201]
    buffer_load_dwordx4 a[220:223], v7, s[8:11], s44 offen sc1
    v_mfma_f32_16x16x32_bf16 v[218:221], v[138:141], a[232:235], v[218:221]
    v_mfma_f32_16x16x32_bf16 v[218:221], v[158:161], a[248:251], v[218:221]
    v_mfma_f32_16x16x32_bf16 v[238:241], v[158:161], a[252:255], v[238:241]
    v_mfma_f32_16x16x32_bf16 v[238:241], v[138:141], a[236:239], v[238:241]
    v_mfma_f32_16x16x32_bf16 v[182:185], v[142:145], a[224:227], v[182:185]
    v_mfma_f32_16x16x32_bf16 v[182:185], v[162:165], a[240:243], v[182:185]
    v_mfma_f32_16x16x32_bf16 v[202:205], v[162:165], a[244:247], v[202:205]
    v_mfma_f32_16x16x32_bf16 v[202:205], v[142:145], a[228:231], v[202:205]
    v_mfma_f32_16x16x32_bf16 v[222:225], v[142:145], a[232:235], v[222:225]
    v_mfma_f32_16x16x32_bf16 v[222:225], v[162:165], a[248:251], v[222:225]
    v_mfma_f32_16x16x32_bf16 v[242:245], v[162:165], a[252:255], v[242:245]
    v_mfma_f32_16x16x32_bf16 v[242:245], v[142:145], a[236:239], v[242:245]
    s_waitcnt vmcnt(9)
    v_mfma_f32_16x16x32_bf16 v[166:169], a[56:59], a[96:99], v[166:169]
    v_mfma_f32_16x16x32_bf16 v[166:169], a[76:79], a[112:115], v[166:169]
    s_add_u32 s44, s31, 131072
    buffer_load_dwordx4 a[224:227], v4, s[8:11], s44 offen sc1
    v_mfma_f32_16x16x32_bf16 v[186:189], a[76:79], a[116:119], v[186:189]
    ds_read_b128 v[126:129], v9 offset:0
    v_mfma_f32_16x16x32_bf16 v[186:189], a[56:59], a[100:103], v[186:189]
    v_mfma_f32_16x16x32_bf16 v[206:209], a[56:59], a[104:107], v[206:209]
    buffer_load_dwordx4 a[228:231], v5, s[8:11], s44 offen sc1
    v_mfma_f32_16x16x32_bf16 v[206:209], a[76:79], a[120:123], v[206:209]
    ds_read_b128 v[130:133], v9 offset:1024
    v_mfma_f32_16x16x32_bf16 v[226:229], a[76:79], a[124:127], v[226:229]
    v_mfma_f32_16x16x32_bf16 v[226:229], a[56:59], a[108:111], v[226:229]
    ds_read_b128 v[134:137], v9 offset:2048
    v_mfma_f32_16x16x32_bf16 v[170:173], a[60:63], a[96:99], v[170:173]
    buffer_load_dwordx4 a[232:235], v6, s[8:11], s44 offen sc1
    v_mfma_f32_16x16x32_bf16 v[170:173], a[80:83], a[112:115], v[170:173]
    v_mfma_f32_16x16x32_bf16 v[190:193], a[80:83], a[116:119], v[190:193]
    ds_read_b128 v[138:141], v9 offset:3072
    v_mfma_f32_16x16x32_bf16 v[190:193], a[60:63], a[100:103], v[190:193]
    v_mfma_f32_16x16x32_bf16 v[210:213], a[60:63], a[104:107], v[210:213]
    buffer_load_dwordx4 a[236:239], v7, s[8:11], s44 offen sc1
    v_mfma_f32_16x16x32_bf16 v[210:213], a[80:83], a[120:123], v[210:213]
    ds_read_b128 v[142:145], v9 offset:4096
    v_mfma_f32_16x16x32_bf16 v[230:233], a[80:83], a[124:127], v[230:233]
    v_mfma_f32_16x16x32_bf16 v[230:233], a[60:63], a[108:111], v[230:233]
    ds_read_b128 v[146:149], v9 offset:5120
    v_mfma_f32_16x16x32_bf16 v[174:177], a[64:67], a[96:99], v[174:177]
    s_add_u32 s44, s31, 147456
    buffer_load_dwordx4 a[240:243], v4, s[8:11], s44 offen sc1
    v_mfma_f32_16x16x32_bf16 v[174:177], a[84:87], a[112:115], v[174:177]
    v_mfma_f32_16x16x32_bf16 v[194:197], a[84:87], a[116:119], v[194:197]
    ds_read_b128 v[150:153], v9 offset:6144
    v_mfma_f32_16x16x32_bf16 v[194:197], a[64:67], a[100:103], v[194:197]
    buffer_load_dwordx4 a[244:247], v5, s[8:11], s44 offen sc1
    v_mfma_f32_16x16x32_bf16 v[214:217], a[64:67], a[104:107], v[214:217]
    v_mfma_f32_16x16x32_bf16 v[214:217], a[84:87], a[120:123], v[214:217]
    ds_read_b128 v[154:157], v9 offset:7168
    v_mfma_f32_16x16x32_bf16 v[234:237], a[84:87], a[124:127], v[234:237]
    v_mfma_f32_16x16x32_bf16 v[234:237], a[64:67], a[108:111], v[234:237]
    buffer_load_dwordx4 a[248:251], v6, s[8:11], s44 offen sc1
    v_mfma_f32_16x16x32_bf16 v[178:181], a[68:71], a[96:99], v[178:181]
    ds_read_b128 v[158:161], v9 offset:8192
    v_mfma_f32_16x16x32_bf16 v[178:181], a[88:91], a[112:115], v[178:181]
    v_mfma_f32_16x16x32_bf16 v[198:201], a[88:91], a[116:119], v[198:201]
    ds_read_b128 v[162:165], v9 offset:9216
    v_mfma_f32_16x16x32_bf16 v[198:201], a[68:71], a[100:103], v[198:201]
    buffer_load_dwordx4 a[252:255], v7, s[8:11], s44 offen sc1
    v_mfma_f32_16x16x32_bf16 v[218:221], a[68:71], a[104:107], v[218:221]
    v_mfma_f32_16x16x32_bf16 v[218:221], a[88:91], a[120:123], v[218:221]
    v_mfma_f32_16x16x32_bf16 v[238:241], a[88:91], a[124:127], v[238:241]
    v_mfma_f32_16x16x32_bf16 v[238:241], a[68:71], a[108:111], v[238:241]
    v_mfma_f32_16x16x32_bf16 v[182:185], a[72:75], a[96:99], v[182:185]
    v_mfma_f32_16x16x32_bf16 v[182:185], a[92:95], a[112:115], v[182:185]
    v_mfma_f32_16x16x32_bf16 v[202:205], a[92:95], a[116:119], v[202:205]
    v_mfma_f32_16x16x32_bf16 v[202:205], a[72:75], a[100:103], v[202:205]
    v_mfma_f32_16x16x32_bf16 v[222:225], a[72:75], a[104:107], v[222:225]
    v_mfma_f32_16x16x32_bf16 v[222:225], a[92:95], a[120:123], v[222:225]
    v_mfma_f32_16x16x32_bf16 v[242:245], a[92:95], a[124:127], v[242:245]
    v_mfma_f32_16x16x32_bf16 v[242:245], a[72:75], a[108:111], v[242:245]
    s_waitcnt vmcnt(8) lgkmcnt(0)
    v_mfma_f32_16x16x32_bf16 v[166:169], v[126:129], a[192:195], v[166:169]
    v_mfma_f32_16x16x32_bf16 v[166:169], v[146:149], a[208:211], v[166:169]
    s_add_u32 s44, s31, 163840
    buffer_load_dwordx4 a[96:99], v4, s[8:11], s44 offen sc1
    v_mfma_f32_16x16x32_bf16 v[186:189], v[146:149], a[212:215], v[186:189]
    v_mfma_f32_16x16x32_bf16 v[186:189], v[126:129], a[196:199], v[186:189]
    v_mfma_f32_16x16x32_bf16 v[206:209], v[126:129], a[200:203], v[206:209]
    buffer_load_dwordx4 a[100:103], v5, s[8:11], s44 offen sc1
    v_mfma_f32_16x16x32_bf16 v[206:209], v[146:149], a[216:219], v[206:209]
    v_mfma_f32_16x16x32_bf16 v[226:229], v[146:149], a[220:223], v[226:229]
    v_mfma_f32_16x16x32_bf16 v[226:229], v[126:129], a[204:207], v[226:229]
    v_mfma_f32_16x16x32_bf16 v[170:173], v[130:133], a[192:195], v[170:173]
    buffer_load_dwordx4 a[104:107], v6, s[8:11], s44 offen sc1
    v_mfma_f32_16x16x32_bf16 v[170:173], v[150:153], a[208:211], v[170:173]
    v_mfma_f32_16x16x32_bf16 v[190:193], v[150:153], a[212:215], v[190:193]
    v_mfma_f32_16x16x32_bf16 v[190:193], v[130:133], a[196:199], v[190:193]
    v_mfma_f32_16x16x32_bf16 v[210:213], v[130:133], a[200:203], v[210:213]
    buffer_load_dwordx4 a[108:111], v7, s[8:11], s44 offen sc1
    v_mfma_f32_16x16x32_bf16 v[210:213], v[150:153], a[216:219], v[210:213]
    v_mfma_f32_16x16x32_bf16 v[230:233], v[150:153], a[220:223], v[230:233]
    v_mfma_f32_16x16x32_bf16 v[230:233], v[130:133], a[204:207], v[230:233]
    v_mfma_f32_16x16x32_bf16 v[174:177], v[134:137], a[192:195], v[174:177]
    s_add_u32 s44, s31, 180224
    buffer_load_dwordx4 a[112:115], v4, s[8:11], s44 offen sc1
    v_mfma_f32_16x16x32_bf16 v[174:177], v[154:157], a[208:211], v[174:177]
    v_mfma_f32_16x16x32_bf16 v[194:197], v[154:157], a[212:215], v[194:197]
    v_mfma_f32_16x16x32_bf16 v[194:197], v[134:137], a[196:199], v[194:197]
    buffer_load_dwordx4 a[116:119], v5, s[8:11], s44 offen sc1
    v_mfma_f32_16x16x32_bf16 v[214:217], v[134:137], a[200:203], v[214:217]
    v_mfma_f32_16x16x32_bf16 v[214:217], v[154:157], a[216:219], v[214:217]
    v_mfma_f32_16x16x32_bf16 v[234:237], v[154:157], a[220:223], v[234:237]
    v_mfma_f32_16x16x32_bf16 v[234:237], v[134:137], a[204:207], v[234:237]
    buffer_load_dwordx4 a[120:123], v6, s[8:11], s44 offen sc1
    v_mfma_f32_16x16x32_bf16 v[178:181], v[138:141], a[192:195], v[178:181]
    v_mfma_f32_16x16x32_bf16 v[178:181], v[158:161], a[208:211], v[178:181]
    v_mfma_f32_16x16x32_bf16 v[198:201], v[158:161], a[212:215], v[198:201]
    v_mfma_f32_16x16x32_bf16 v[198:201], v[138:141], a[196:199], v[198:201]
    buffer_load_dwordx4 a[124:127], v7, s[8:11], s44 offen sc1
    v_mfma_f32_16x16x32_bf16 v[218:221], v[138:141], a[200:203], v[218:221]
    v_mfma_f32_16x16x32_bf16 v[218:221], v[158:161], a[216:219], v[218:221]
    v_mfma_f32_16x16x32_bf16 v[238:241], v[158:161], a[220:223], v[238:241]
    v_mfma_f32_16x16x32_bf16 v[238:241], v[138:141], a[204:207], v[238:241]
    v_mfma_f32_16x16x32_bf16 v[182:185], v[142:145], a[192:195], v[182:185]
    v_mfma_f32_16x16x32_bf16 v[182:185], v[162:165], a[208:211], v[182:185]
    v_mfma_f32_16x16x32_bf16 v[202:205], v[162:165], a[212:215], v[202:205]
    v_mfma_f32_16x16x32_bf16 v[202:205], v[142:145], a[196:199], v[202:205]
    v_mfma_f32_16x16x32_bf16 v[222:225], v[142:145], a[200:203], v[222:225]
    v_mfma_f32_16x16x32_bf16 v[222:225], v[162:165], a[216:219], v[222:225]
    v_mfma_f32_16x16x32_bf16 v[242:245], v[162:165], a[220:223], v[242:245]
    s_sub_u32 s40, s5, 1
    s_and_b32 s40, s40, 3
    s_mul_i32 s40, s40, 10240
    s_add_u32 s40, s40, 122880
    v_lshl_add_u32 v5, v19, 4, s40
    s_sub_u32 s40, s5, 2
    s_and_b32 s40, s40, 3
    s_mul_i32 s40, s40, 10240
    s_add_u32 s40, s40, 122880
    v_lshl_add_u32 v6, v19, 4, s40
    s_sub_u32 s40, s5, 3
    s_and_b32 s40, s40, 3
    s_mul_i32 s40, s40, 10240
    s_add_u32 s40, s40, 81920
    v_lshl_add_u32 v7, v19, 4, s40
    buffer_load_dword v1, off, s[76:79], s37 sc1
    v_mfma_f32_16x16x32_bf16 v[242:245], v[142:145], a[204:207], v[242:245]
    s_waitcnt vmcnt(9)
    v_mfma_f32_16x16x32_bf16 v[166:169], v[46:49], a[224:227], v[166:169]
    v_lshlrev_b32 v126, 16, v36
    v_mfma_f32_16x16x32_bf16 v[166:169], v[66:69], a[240:243], v[166:169]
    v_and_b32 v127, 0xffff0000, v36
    v_mfma_f32_16x16x32_bf16 v[186:189], v[66:69], a[244:247], v[186:189]
    v_lshlrev_b32 v146, 16, v22
    v_mfma_f32_16x16x32_bf16 v[186:189], v[46:49], a[228:231], v[186:189]
    v_and_b32 v147, 0xffff0000, v22
    v_mfma_f32_16x16x32_bf16 v[206:209], v[46:49], a[232:235], v[206:209]
    v_lshlrev_b32 v128, 16, v37
    v_mfma_f32_16x16x32_bf16 v[206:209], v[66:69], a[248:251], v[206:209]
    v_and_b32 v129, 0xffff0000, v37
    v_mfma_f32_16x16x32_bf16 v[226:229], v[66:69], a[252:255], v[226:229]
    v_lshlrev_b32 v148, 16, v23
    v_mfma_f32_16x16x32_bf16 v[226:229], v[46:49], a[236:239], v[226:229]
    v_and_b32 v149, 0xffff0000, v23
    v_mfma_f32_16x16x32_bf16 v[170:173], v[50:53], a[224:227], v[170:173]
    v_lshlrev_b32 v130, 16, v38
    v_mfma_f32_16x16x32_bf16 v[170:173], v[70:73], a[240:243], v[170:173]
    v_and_b32 v131, 0xffff0000, v38
    v_mfma_f32_16x16x32_bf16 v[190:193], v[70:73], a[244:247], v[190:193]
    v_lshlrev_b32 v150, 16, v24
    v_mfma_f32_16x16x32_bf16 v[190:193], v[50:53], a[228:231], v[190:193]
    v_and_b32 v151, 0xffff0000, v24
    v_mfma_f32_16x16x32_bf16 v[210:213], v[50:53], a[232:235], v[210:213]
    v_lshlrev_b32 v132, 16, v39
    v_mfma_f32_16x16x32_bf16 v[210:213], v[70:73], a[248:251], v[210:213]
    v_and_b32 v133, 0xffff0000, v39
    v_mfma_f32_16x16x32_bf16 v[230:233], v[70:73], a[252:255], v[230:233]
    v_lshlrev_b32 v152, 16, v25
    v_mfma_f32_16x16x32_bf16 v[230:233], v[50:53], a[236:239], v[230:233]
    v_and_b32 v153, 0xffff0000, v25
    v_mfma_f32_16x16x32_bf16 v[174:177], v[54:57], a[224:227], v[174:177]
    v_lshlrev_b32 v134, 16, v40
    v_mfma_f32_16x16x32_bf16 v[174:177], v[74:77], a[240:243], v[174:177]
    v_and_b32 v135, 0xffff0000, v40
    v_mfma_f32_16x16x32_bf16 v[194:197], v[74:77], a[244:247], v[194:197]
    v_lshlrev_b32 v154, 16, v26
    v_mfma_f32_16x16x32_bf16 v[194:197], v[54:57], a[228:231], v[194:197]
    v_and_b32 v155, 0xffff0000, v26
    v_mfma_f32_16x16x32_bf16 v[214:217], v[54:57], a[232:235], v[214:217]
    v_lshlrev_b32 v136, 16, v41
    v_mfma_f32_16x16x32_bf16 v[214:217], v[74:77], a[248:251], v[214:217]
    v_and_b32 v137, 0xffff0000, v41
    v_mfma_f32_16x16x32_bf16 v[234:237], v[74:77], a[252:255], v[234:237]
    v_lshlrev_b32 v156, 16, v27
    v_mfma_f32_16x16x32_bf16 v[234:237], v[54:57], a[236:239], v[234:237]
    v_and_b32 v157, 0xffff0000, v27
    v_mfma_f32_16x16x32_bf16 v[178:181], v[58:61], a[224:227], v[178:181]
    v_lshlrev_b32 v138, 16, v42
    v_mfma_f32_16x16x32_bf16 v[178:181], v[78:81], a[240:243], v[178:181]
    v_and_b32 v139, 0xffff0000, v42
    v_mfma_f32_16x16x32_bf16 v[198:201], v[78:81], a[244:247], v[198:201]
    v_lshlrev_b32 v158, 16, v28
    v_mfma_f32_16x16x32_bf16 v[198:201], v[58:61], a[228:231], v[198:201]
    v_and_b32 v159, 0xffff0000, v28
    v_mfma_f32_16x16x32_bf16 v[218:221], v[58:61], a[232:235], v[218:221]
    v_lshlrev_b32 v140, 16, v43
    v_mfma_f32_16x16x32_bf16 v[218:221], v[78:81], a[248:251], v[218:221]
    v_and_b32 v141, 0xffff0000, v43
    v_mfma_f32_16x16x32_bf16 v[238:241], v[78:81], a[252:255], v[238:241]
    v_lshlrev_b32 v160, 16, v29
    v_mfma_f32_16x16x32_bf16 v[238:241], v[58:61], a[236:239], v[238:241]
    v_and_b32 v161, 0xffff0000, v29
    v_mfma_f32_16x16x32_bf16 v[182:185], v[62:65], a[224:227], v[182:185]
    v_lshlrev_b32 v142, 16, v44
    v_mfma_f32_16x16x32_bf16 v[182:185], v[82:85], a[240:243], v[182:185]
    v_and_b32 v143, 0xffff0000, v44
    v_mfma_f32_16x16x32_bf16 v[202:205], v[82:85], a[244:247], v[202:205]
    v_lshlrev_b32 v162, 16, v30
    v_mfma_f32_16x16x32_bf16 v[202:205], v[62:65], a[228:231], v[202:205]
    v_and_b32 v163, 0xffff0000, v30
    v_mfma_f32_16x16x32_bf16 v[222:225], v[62:65], a[232:235], v[222:225]
    v_lshlrev_b32 v144, 16, v45
    v_mfma_f32_16x16x32_bf16 v[222:225], v[82:85], a[248:251], v[222:225]
    v_and_b32 v145, 0xffff0000, v45
    v_mfma_f32_16x16x32_bf16 v[242:245], v[82:85], a[252:255], v[242:245]
    v_lshlrev_b32 v164, 16, v31
    v_mfma_f32_16x16x32_bf16 v[242:245], v[62:65], a[236:239], v[242:245]
    v_and_b32 v165, 0xffff0000, v31
    s_waitcnt vmcnt(1)
    v_mfma_f32_16x16x32_bf16 v[186:189], v[86:89], a[100:103], v[186:189]
    s_waitcnt vmcnt(0)
    v_cmp_ne_u32 vcc, 3, v1
    s_and_b64 vcc, vcc, exec
    s_cbranch_scc1 L_spin_half
L_back_half:
    s_xor_b32 s40, s2, 8
    s_sub_u32 s40, s40, s2
    s_mul_i32 s40, s40, 20480
    v_add_u32 v18, s40, v18
    s_mov_b32 s41, 4096
    buffer_load_dwordx4 v[46:49], v18, s[76:79], 0 offen offset:0 sc1
    buffer_load_dwordx4 v[50:53], v18, s[76:79], 0 offen offset:1024 sc1
    buffer_load_dwordx4 v[54:57], v18, s[76:79], 0 offen offset:2048 sc1
    buffer_load_dwordx4 v[58:61], v18, s[76:79], 0 offen offset:3072 sc1
    buffer_load_dwordx4 v[62:65], v18, s[76:79], s41 offen offset:0 sc1
    v_mfma_f32_16x16x32_bf16 v[186:189], v[106:109], a[116:119], v[186:189]
    v_mfma_f32_16x16x32_bf16 v[190:193], v[110:113], a[116:119], v[190:193]
    v_mfma_f32_16x16x32_bf16 v[190:193], v[90:93], a[100:103], v[190:193]
    v_mfma_f32_16x16x32_bf16 v[194:197], v[94:97], a[100:103], v[194:197]
    v_mfma_f32_16x16x32_bf16 v[194:197], v[114:117], a[116:119], v[194:197]
    v_mfma_f32_16x16x32_bf16 v[198:201], v[118:121], a[116:119], v[198:201]
    v_mfma_f32_16x16x32_bf16 v[198:201], v[98:101], a[100:103], v[198:201]
    v_mfma_f32_16x16x32_bf16 v[202:205], v[102:105], a[100:103], v[202:205]
    v_mfma_f32_16x16x32_bf16 v[202:205], v[122:125], a[116:119], v[202:205]
    ds_write_b128 v8, v[186:189] offset:0
    v_mfma_f32_16x16x32_bf16 v[206:209], v[106:109], a[120:123], v[206:209]
    v_mfma_f32_16x16x32_bf16 v[206:209], v[86:89], a[104:107], v[206:209]
    ds_write_b128 v8, v[190:193] offset:1024
    v_mfma_f32_16x16x32_bf16 v[210:213], v[90:93], a[104:107], v[210:213]
    v_mfma_f32_16x16x32_bf16 v[210:213], v[110:113], a[120:123], v[210:213]
    ds_write_b128 v8, v[194:197] offset:2048
    v_mfma_f32_16x16x32_bf16 v[214:217], v[114:117], a[120:123], v[214:217]
    v_mfma_f32_16x16x32_bf16 v[214:217], v[94:97], a[104:107], v[214:217]
    ds_write_b128 v8, v[198:201] offset:3072
    v_mfma_f32_16x16x32_bf16 v[218:221], v[98:101], a[104:107], v[218:221]
    v_mfma_f32_16x16x32_bf16 v[218:221], v[118:121], a[120:123], v[218:221]
    ds_write_b128 v8, v[202:205] offset:4096
    v_mfma_f32_16x16x32_bf16 v[222:225], v[122:125], a[120:123], v[222:225]
    v_mfma_f32_16x16x32_bf16 v[222:225], v[102:105], a[104:107], v[222:225]
    ds_write_b128 v8, v[206:209] offset:5120
    v_mfma_f32_16x16x32_bf16 v[226:229], v[86:89], a[108:111], v[226:229]
    v_mfma_f32_16x16x32_bf16 v[226:229], v[106:109], a[124:127], v[226:229]
    ds_write_b128 v8, v[210:213] offset:6144
    v_mfma_f32_16x16x32_bf16 v[230:233], v[110:113], a[124:127], v[230:233]
    v_mfma_f32_16x16x32_bf16 v[230:233], v[90:93], a[108:111], v[230:233]
    ds_write_b128 v8, v[214:217] offset:7168
    v_mfma_f32_16x16x32_bf16 v[234:237], v[94:97], a[108:111], v[234:237]
    v_mfma_f32_16x16x32_bf16 v[234:237], v[114:117], a[124:127], v[234:237]
    ds_write_b128 v8, v[218:221] offset:8192
    v_mfma_f32_16x16x32_bf16 v[238:241], v[118:121], a[124:127], v[238:241]
    v_mfma_f32_16x16x32_bf16 v[238:241], v[98:101], a[108:111], v[238:241]
    ds_write_b128 v8, v[222:225] offset:9216
    v_mfma_f32_16x16x32_bf16 v[242:245], v[102:105], a[108:111], v[242:245]
    v_mfma_f32_16x16x32_bf16 v[242:245], v[122:125], a[124:127], v[242:245]
    ds_write_b128 v9, v[226:229] offset:0
    v_mfma_f32_16x16x32_bf16 v[166:169], v[106:109], a[112:115], v[166:169]
    v_mfma_f32_16x16x32_bf16 v[166:169], v[86:89], a[96:99], v[166:169]
    ds_write_b128 v9, v[230:233] offset:1024
    v_mfma_f32_16x16x32_bf16 v[170:173], v[90:93], a[96:99], v[170:173]
    v_mfma_f32_16x16x32_bf16 v[170:173], v[110:113], a[112:115], v[170:173]
    ds_write_b128 v9, v[234:237] offset:2048
    v_mfma_f32_16x16x32_bf16 v[174:177], v[114:117], a[112:115], v[174:177]
    v_mfma_f32_16x16x32_bf16 v[174:177], v[94:97], a[96:99], v[174:177]
    ds_write_b128 v9, v[238:241] offset:3072
    v_mfma_f32_16x16x32_bf16 v[178:181], v[98:101], a[96:99], v[178:181]
    v_mfma_f32_16x16x32_bf16 v[178:181], v[118:121], a[112:115], v[178:181]
    ds_write_b128 v9, v[242:245] offset:4096
    v_mfma_f32_16x16x32_bf16 v[182:185], v[122:125], a[112:115], v[182:185]
    v_mfma_f32_16x16x32_bf16 v[182:185], v[102:105], a[96:99], v[182:185]
    s_waitcnt lgkmcnt(0)
    s_barrier
    ds_read_b128 v[186:189], v5 offset:0
    ds_read_b128 v[190:193], v5 offset:1024
    ds_read_b128 v[194:197], v5 offset:2048
    ds_read_b128 v[198:201], v5 offset:3072
    ds_read_b128 v[202:205], v5 offset:4096
    ds_read_b128 v[206:209], v6 offset:5120
    ds_read_b128 v[210:213], v6 offset:6144
    ds_read_b128 v[214:217], v6 offset:7168
    ds_read_b128 v[218:221], v6 offset:8192
    ds_read_b128 v[222:225], v6 offset:9216
    ds_read_b128 v[226:229], v7 offset:0
    ds_read_b128 v[230:233], v7 offset:1024
    ds_read_b128 v[234:237], v7 offset:2048
    ds_read_b128 v[238:241], v7 offset:3072
    ds_read_b128 v[242:245], v7 offset:4096
    s_waitcnt lgkmcnt(10)
    v_pk_add_f32 v[166:167], v[166:167], v[186:187]
    v_pk_add_f32 v[168:169], v[168:169], v[188:189]
    v_pk_add_f32 v[170:171], v[170:171], v[190:191]
    v_pk_add_f32 v[172:173], v[172:173], v[192:193]
    v_pk_add_f32 v[174:175], v[174:175], v[194:195]
    v_pk_add_f32 v[176:177], v[176:177], v[196:197]
    v_pk_add_f32 v[178:179], v[178:179], v[198:199]
    v_pk_add_f32 v[180:181], v[180:181], v[200:201]
    v_pk_add_f32 v[182:183], v[182:183], v[202:203]
    v_pk_add_f32 v[184:185], v[184:185], v[204:205]
    s_waitcnt lgkmcnt(5)
    v_pk_add_f32 v[166:167], v[166:167], v[206:207]
    v_pk_add_f32 v[168:169], v[168:169], v[208:209]
    v_pk_add_f32 v[170:171], v[170:171], v[210:211]
    v_pk_add_f32 v[172:173], v[172:173], v[212:213]
    v_pk_add_f32 v[174:175], v[174:175], v[214:215]
    v_pk_add_f32 v[176:177], v[176:177], v[216:217]
    v_pk_add_f32 v[178:179], v[178:179], v[218:219]
    v_pk_add_f32 v[180:181], v[180:181], v[220:221]
    v_pk_add_f32 v[182:183], v[182:183], v[222:223]
    v_pk_add_f32 v[184:185], v[184:185], v[224:225]
    s_waitcnt lgkmcnt(0)
    v_pk_add_f32 v[166:167], v[166:167], v[226:227]
    v_pk_add_f32 v[168:169], v[168:169], v[228:229]
    v_pk_add_f32 v[170:171], v[170:171], v[230:231]
    v_pk_add_f32 v[172:173], v[172:173], v[232:233]
    v_pk_add_f32 v[174:175], v[174:175], v[234:235]
    v_pk_add_f32 v[176:177], v[176:177], v[236:237]
    v_pk_add_f32 v[178:179], v[178:179], v[238:239]
    v_pk_add_f32 v[180:181], v[180:181], v[240:241]
    v_pk_add_f32 v[182:183], v[182:183], v[242:243]
    v_pk_add_f32 v[184:185], v[184:185], v[244:245]
    s_waitcnt vmcnt(0)
    v_pk_add_f32 v[166:167], v[166:167], v[46:47]
    v_pk_add_f32 v[168:169], v[168:169], v[48:49]
    v_pk_add_f32 v[170:171], v[170:171], v[50:51]
    v_pk_add_f32 v[172:173], v[172:173], v[52:53]
    v_pk_add_f32 v[174:175], v[174:175], v[54:55]
    v_pk_add_f32 v[176:177], v[176:177], v[56:57]
    v_pk_add_f32 v[178:179], v[178:179], v[58:59]
    v_pk_add_f32 v[180:181], v[180:181], v[60:61]
    v_pk_add_f32 v[182:183], v[182:183], v[62:63]
    v_pk_add_f32 v[184:185], v[184:185], v[64:65]
    v_cvt_pk_bf16_f32 v66, v166, v167
    v_cvt_pk_bf16_f32 v67, v168, v169
    v_cvt_pk_bf16_f32 v68, v170, v171
    v_cvt_pk_bf16_f32 v69, v172, v173
    v_cvt_pk_bf16_f32 v70, v174, v175
    v_cvt_pk_bf16_f32 v71, v176, v177
    v_cvt_pk_bf16_f32 v72, v178, v179
    v_cvt_pk_bf16_f32 v73, v180, v181
    v_cvt_pk_bf16_f32 v74, v182, v183
    v_cvt_pk_bf16_f32 v75, v184, v185
    v_lshlrev_b32 v166, 16, v66
    v_and_b32 v167, 0xffff0000, v66
    v_lshlrev_b32 v168, 16, v67
    v_and_b32 v169, 0xffff0000, v67
    v_lshlrev_b32 v170, 16, v68
    v_and_b32 v171, 0xffff0000, v68
    v_lshlrev_b32 v172, 16, v69
    v_and_b32 v173, 0xffff0000, v69
    v_lshlrev_b32 v174, 16, v70
    v_and_b32 v175, 0xffff0000, v70
    v_lshlrev_b32 v176, 16, v71
    v_and_b32 v177, 0xffff0000, v71
    v_lshlrev_b32 v178, 16, v72
    v_and_b32 v179, 0xffff0000, v72
    v_lshlrev_b32 v180, 16, v73
    v_and_b32 v181, 0xffff0000, v73
    v_lshlrev_b32 v182, 16, v74
    v_and_b32 v183, 0xffff0000, v74
    v_lshlrev_b32 v184, 16, v75
    v_and_b32 v185, 0xffff0000, v75
    v_pk_mul_f32 v[166:167], v[166:167], v[126:127]
    v_pk_mul_f32 v[168:169], v[168:169], v[128:129]
    v_pk_mul_f32 v[170:171], v[170:171], v[130:131]
    v_pk_mul_f32 v[172:173], v[172:173], v[132:133]
    v_pk_mul_f32 v[174:175], v[174:175], v[134:135]
    v_pk_mul_f32 v[176:177], v[176:177], v[136:137]
    v_pk_mul_f32 v[178:179], v[178:179], v[138:139]
    v_pk_mul_f32 v[180:181], v[180:181], v[140:141]
    v_pk_mul_f32 v[182:183], v[182:183], v[142:143]
    v_pk_mul_f32 v[184:185], v[184:185], v[144:145]
    v_cvt_pk_bf16_f32 v66, v166, v167
    v_cvt_pk_bf16_f32 v67, v168, v169
    v_cvt_pk_bf16_f32 v68, v170, v171
    v_cvt_pk_bf16_f32 v69, v172, v173
    v_cvt_pk_bf16_f32 v70, v174, v175
    v_cvt_pk_bf16_f32 v71, v176, v177
    v_cvt_pk_bf16_f32 v72, v178, v179
    v_cvt_pk_bf16_f32 v73, v180, v181
    v_cvt_pk_bf16_f32 v74, v182, v183
    v_cvt_pk_bf16_f32 v75, v184, v185
    v_lshlrev_b32 v166, 16, v66
    v_and_b32 v167, 0xffff0000, v66
    v_lshlrev_b32 v168, 16, v67
    v_and_b32 v169, 0xffff0000, v67
    v_lshlrev_b32 v170, 16, v68
    v_and_b32 v171, 0xffff0000, v68
    v_lshlrev_b32 v172, 16, v69
    v_and_b32 v173, 0xffff0000, v69
    v_lshlrev_b32 v174, 16, v70
    v_and_b32 v175, 0xffff0000, v70
    v_lshlrev_b32 v176, 16, v71
    v_and_b32 v177, 0xffff0000, v71
    v_lshlrev_b32 v178, 16, v72
    v_and_b32 v179, 0xffff0000, v72
    v_lshlrev_b32 v180, 16, v73
    v_and_b32 v181, 0xffff0000, v73
    v_lshlrev_b32 v182, 16, v74
    v_and_b32 v183, 0xffff0000, v74
    v_lshlrev_b32 v184, 16, v75
    v_and_b32 v185, 0xffff0000, v75
    v_pk_add_f32 v[166:167], v[166:167], v[146:147]
    v_pk_add_f32 v[168:169], v[168:169], v[148:149]
    v_pk_add_f32 v[170:171], v[170:171], v[150:151]
    v_pk_add_f32 v[172:173], v[172:173], v[152:153]
    v_pk_add_f32 v[174:175], v[174:175], v[154:155]
    v_pk_add_f32 v[176:177], v[176:177], v[156:157]
    v_pk_add_f32 v[178:179], v[178:179], v[158:159]
    v_pk_add_f32 v[180:181], v[180:181], v[160:161]
    v_pk_add_f32 v[182:183], v[182:183], v[162:163]
    v_pk_add_f32 v[184:185], v[184:185], v[164:165]
    v_cvt_pk_bf16_f32 v66, v166, v167
    v_cvt_pk_bf16_f32 v67, v168, v169
    buffer_store_dwordx2 v[66:67], v34, s[12:15], 0 offen offset:0
    v_cvt_pk_bf16_f32 v68, v170, v171
    v_cvt_pk_bf16_f32 v69, v172, v173
    buffer_store_dwordx2 v[68:69], v34, s[12:15], 0 offen offset:32
    v_cvt_pk_bf16_f32 v70, v174, v175
    v_cvt_pk_bf16_f32 v71, v176, v177
    buffer_store_dwordx2 v[70:71], v34, s[12:15], 0 offen offset:64
    v_cvt_pk_bf16_f32 v72, v178, v179
    v_cvt_pk_bf16_f32 v73, v180, v181
    buffer_store_dwordx2 v[72:73], v34, s[12:15], 0 offen offset:96
    v_cvt_pk_bf16_f32 v74, v182, v183
    v_cvt_pk_bf16_f32 v75, v184, v185
    buffer_store_dwordx2 v[74:75], v34, s[12:15], 0 offen offset:128
L_end:
    s_endpgm
L_slow:
    s_lshl_b32 s40, s5, 12
    v_subrev_u32 v13, s40, v13
    v_subrev_u32 v14, s40, v14
    v_subrev_u32 v15, s40, v15
    v_subrev_u32 v16, s40, v16
    v_subrev_u32 v17, s40, v17
    v_subrev_u32 v18, s40, v18
    s_and_b32 s40, s5, 1
    s_lshr_b32 s41, s5, 1
    s_mul_i32 s41, s41, 3
    s_add_u32 s40, s40, s41
    s_add_u32 s40, s40, 1
    s_lshl_b32 s34, s40, 13
    s_sub_u32 s40, s34, 98304
    v_add_u32 v1, s40, v1
    v_add_u32 v2, s40, v2
    v_add_u32 v3, s40, v3
    v_add_u32 v4, s40, v4
    v_add_u32 v5, s34, v5
    v_add_u32 v6, s34, v6
    v_add_u32 v7, s34, v7
    v_add_u32 v8, s34, v8
    v_add_u32 v9, s34, v9
    v_add_u32 v10, s34, v10
    v_add_u32 v11, s34, v11
    v_add_u32 v12, s34, v12
    v_mov_b32 v212, 0xff800000
    v_mov_b32 v216, 0
    v_mov_b32 v213, 0xff800000
    v_mov_b32 v217, 0
    v_mov_b32 v214, 0xff800000
    v_mov_b32 v218, 0
    v_mov_b32 v215, 0xff800000
    v_mov_b32 v219, 0
    v_accvgpr_write_b32 a0, 0
    v_accvgpr_write_b32 a1, 0
    v_accvgpr_write_b32 a2, 0
    v_accvgpr_write_b32 a3, 0
    v_accvgpr_write_b32 a4, 0
    v_accvgpr_write_b32 a5, 0
    v_accvgpr_write_b32 a6, 0
    v_accvgpr_write_b32 a7, 0
    v_accvgpr_write_b32 a8, 0
    v_accvgpr_write_b32 a9, 0
    v_accvgpr_write_b32 a10, 0
    v_accvgpr_write_b32 a11, 0
    v_accvgpr_write_b32 a12, 0
    v_accvgpr_write_b32 a13, 0
    v_accvgpr_write_b32 a14, 0
    v_accvgpr_write_b32 a15, 0
    v_accvgpr_write_b32 a16, 0
    v_accvgpr_write_b32 a17, 0
    v_accvgpr_write_b32 a18, 0
    v_accvgpr_write_b32 a19, 0
    v_accvgpr_write_b32 a20, 0
    v_accvgpr_write_b32 a21, 0
    v_accvgpr_write_b32 a22, 0
    v_accvgpr_write_b32 a23, 0
    v_accvgpr_write_b32 a24, 0
    v_accvgpr_write_b32 a25, 0
    v_accvgpr_write_b32 a26, 0
    v_accvgpr_write_b32 a27, 0
    v_accvgpr_write_b32 a28, 0
    v_accvgpr_write_b32 a29, 0
    v_accvgpr_write_b32 a30, 0
    v_accvgpr_write_b32 a31, 0
    v_accvgpr_write_b32 a32, 0
    v_accvgpr_write_b32 a33, 0
    v_accvgpr_write_b32 a34, 0
    v_accvgpr_write_b32 a35, 0
    v_accvgpr_write_b32 a36, 0
    v_accvgpr_write_b32 a37, 0
    v_accvgpr_write_b32 a38, 0
    v_accvgpr_write_b32 a39, 0
    v_accvgpr_write_b32 a40, 0
    v_accvgpr_write_b32 a41, 0
    v_accvgpr_write_b32 a42, 0
    v_accvgpr_write_b32 a43, 0
    v_accvgpr_write_b32 a44, 0
    v_accvgpr_write_b32 a45, 0
    v_accvgpr_write_b32 a46, 0
    v_accvgpr_write_b32 a47, 0
    v_accvgpr_write_b32 a48, 0
    v_accvgpr_write_b32 a49, 0
    v_accvgpr_write_b32 a50, 0
    v_accvgpr_write_b32 a51, 0
    v_accvgpr_write_b32 a52, 0
    v_accvgpr_write_b32 a53, 0
    v_accvgpr_write_b32 a54, 0
    v_accvgpr_write_b32 a55, 0
    v_accvgpr_write_b32 a56, 0
    v_accvgpr_write_b32 a57, 0
    v_accvgpr_write_b32 a58, 0
    v_accvgpr_write_b32 a59, 0
    v_accvgpr_write_b32 a60, 0
    v_accvgpr_write_b32 a61, 0
    v_accvgpr_write_b32 a62, 0
    v_accvgpr_write_b32 a63, 0
    v_accvgpr_write_b32 a64, 0
    v_accvgpr_write_b32 a65, 0
    v_accvgpr_write_b32 a66, 0
    v_accvgpr_write_b32 a67, 0
    v_accvgpr_write_b32 a68, 0
    v_accvgpr_write_b32 a69, 0
    v_accvgpr_write_b32 a70, 0
    v_accvgpr_write_b32 a71, 0
    v_accvgpr_write_b32 a72, 0
    v_accvgpr_write_b32 a73, 0
    v_accvgpr_write_b32 a74, 0
    v_accvgpr_write_b32 a75, 0
    v_accvgpr_write_b32 a76, 0
    v_accvgpr_write_b32 a77, 0
    v_accvgpr_write_b32 a78, 0
    v_accvgpr_write_b32 a79, 0
    v_accvgpr_write_b32 a80, 0
    v_accvgpr_write_b32 a81, 0
    v_accvgpr_write_b32 a82, 0
    v_accvgpr_write_b32 a83, 0
    v_accvgpr_write_b32 a84, 0
    v_accvgpr_write_b32 a85, 0
    v_accvgpr_write_b32 a86, 0
    v_accvgpr_write_b32 a87, 0
    v_accvgpr_write_b32 a88, 0
    v_accvgpr_write_b32 a89, 0
    v_accvgpr_write_b32 a90, 0
    v_accvgpr_write_b32 a91, 0
    v_accvgpr_write_b32 a92, 0
    v_accvgpr_write_b32 a93, 0
    v_accvgpr_write_b32 a94, 0
    v_accvgpr_write_b32 a95, 0
    v_accvgpr_write_b32 a96, 0
    v_accvgpr_write_b32 a97, 0
    v_accvgpr_write_b32 a98, 0
    v_accvgpr_write_b32 a99, 0
    v_accvgpr_write_b32 a100, 0
    v_accvgpr_write_b32 a101, 0
    v_accvgpr_write_b32 a102, 0
    v_accvgpr_write_b32 a103, 0
    v_accvgpr_write_b32 a104, 0
    v_accvgpr_write_b32 a105, 0
    v_accvgpr_write_b32 a106, 0
    v_accvgpr_write_b32 a107, 0
    v_accvgpr_write_b32 a108, 0
    v_accvgpr_write_b32 a109, 0
    v_accvgpr_write_b32 a110, 0
    v_accvgpr_write_b32 a111, 0
    v_accvgpr_write_b32 a112, 0
    v_accvgpr_write_b32 a113, 0
    v_accvgpr_write_b32 a114, 0
    v_accvgpr_write_b32 a115, 0
    v_accvgpr_write_b32 a116, 0
    v_accvgpr_write_b32 a117, 0
    v_accvgpr_write_b32 a118, 0
    v_accvgpr_write_b32 a119, 0
    v_accvgpr_write_b32 a120, 0
    v_accvgpr_write_b32 a121, 0
    v_accvgpr_write_b32 a122, 0
    v_accvgpr_write_b32 a123, 0
    v_accvgpr_write_b32 a124, 0
    v_accvgpr_write_b32 a125, 0
    v_accvgpr_write_b32 a126, 0
    v_accvgpr_write_b32 a127, 0
    s_mov_b32 s28, 0
L_slow_loop:
    s_add_u32 m0, s34, 0
    s_add_u32 s40, s28, 0
    buffer_load_dwordx4 v13, s[8:11], s40 offen offset:0 lds
    buffer_load_dwordx4 v14, s[8:11], s40 offen offset:1024 lds
    buffer_load_dwordx4 v15, s[8:11], s40 offen offset:2048 lds
    buffer_load_dwordx4 v16, s[8:11], s40 offen offset:3072 lds
    s_add_u32 m0, s34, 4096
    s_add_u32 s40, s28, 4096
    buffer_load_dwordx4 v13, s[8:11], s40 offen offset:0 lds
    buffer_load_dwordx4 v14, s[8:11], s40 offen offset:1024 lds
    buffer_load_dwordx4 v15, s[8:11], s40 offen offset:2048 lds
    buffer_load_dwordx4 v16, s[8:11], s40 offen offset:3072 lds
    s_waitcnt vmcnt(0)
    ds_read_b128 v[148:151], v1 offset:0
    ds_read_b128 v[152:155], v2 offset:0
    ds_read_b128 v[156:159], v3 offset:0
    ds_read_b128 v[160:163], v4 offset:0
    ds_read_b128 v[164:167], v1 offset:4096
    ds_read_b128 v[168:171], v2 offset:4096
    ds_read_b128 v[172:175], v3 offset:4096
    ds_read_b128 v[176:179], v4 offset:4096
    s_waitcnt lgkmcnt(0)
    s_add_u32 m0, s34, 0
    s_add_u32 s40, s28, 0
    buffer_load_dwordx4 v17, s[12:15], s40 offen offset:0 lds
    buffer_load_dwordx4 v18, s[12:15], s40 offen offset:1024 lds
    buffer_load_dwordx4 v17, s[12:15], s40 offen offset:2048 lds
    buffer_load_dwordx4 v18, s[12:15], s40 offen offset:3072 lds
    s_add_u32 m0, s34, 4096
    s_add_u32 s40, s28, 4096
    buffer_load_dwordx4 v17, s[12:15], s40 offen offset:0 lds
    buffer_load_dwordx4 v18, s[12:15], s40 offen offset:1024 lds
    buffer_load_dwordx4 v17, s[12:15], s40 offen offset:2048 lds
    buffer_load_dwordx4 v18, s[12:15], s40 offen offset:3072 lds
    s_waitcnt vmcnt(0)
    ds_read_b64_tr_b16 v[196:197], v5 offset:0
    ds_read_b64_tr_b16 v[198:199], v5 offset:4096
    ds_read_b64_tr_b16 v[200:201], v6 offset:0
    ds_read_b64_tr_b16 v[202:203], v6 offset:4096
    ds_read_b64_tr_b16 v[204:205], v7 offset:0
    ds_read_b64_tr_b16 v[206:207], v7 offset:4096
    ds_read_b64_tr_b16 v[208:209], v8 offset:0
    ds_read_b64_tr_b16 v[210:211], v8 offset:4096
    ds_read_b64_tr_b16 v[228:229], v9 offset:0
    ds_read_b64_tr_b16 v[230:231], v9 offset:4096
    ds_read_b64_tr_b16 v[232:233], v10 offset:0
    ds_read_b64_tr_b16 v[234:235], v10 offset:4096
    ds_read_b64_tr_b16 v[236:237], v11 offset:0
    ds_read_b64_tr_b16 v[238:239], v11 offset:4096
    ds_read_b64_tr_b16 v[240:241], v12 offset:0
    ds_read_b64_tr_b16 v[242:243], v12 offset:4096
    v_mfma_f32_16x16x32_bf16 v[116:119], v[148:151], v[36:39], 0
    v_mfma_f32_16x16x32_bf16 v[116:119], v[152:155], v[40:43], v[116:119]
    v_mfma_f32_16x16x32_bf16 v[116:119], v[156:159], v[44:47], v[116:119]
    v_mfma_f32_16x16x32_bf16 v[116:119], v[160:163], v[48:51], v[116:119]
    v_mfma_f32_16x16x32_bf16 v[132:135], v[164:167], v[36:39], 0
    v_mfma_f32_16x16x32_bf16 v[132:135], v[168:171], v[40:43], v[132:135]
    v_mfma_f32_16x16x32_bf16 v[132:135], v[172:175], v[44:47], v[132:135]
    v_mfma_f32_16x16x32_bf16 v[132:135], v[176:179], v[48:51], v[132:135]
    v_mfma_f32_16x16x32_bf16 v[120:123], v[160:163], v[64:67], 0
    v_mfma_f32_16x16x32_bf16 v[120:123], v[156:159], v[60:63], v[120:123]
    v_mfma_f32_16x16x32_bf16 v[120:123], v[152:155], v[56:59], v[120:123]
    v_mfma_f32_16x16x32_bf16 v[120:123], v[148:151], v[52:55], v[120:123]
    v_mfma_f32_16x16x32_bf16 v[136:139], v[176:179], v[64:67], 0
    v_mfma_f32_16x16x32_bf16 v[136:139], v[172:175], v[60:63], v[136:139]
    v_mfma_f32_16x16x32_bf16 v[136:139], v[168:171], v[56:59], v[136:139]
    v_mfma_f32_16x16x32_bf16 v[136:139], v[164:167], v[52:55], v[136:139]
    v_mfma_f32_16x16x32_bf16 v[124:127], v[148:151], v[68:71], 0
    v_mfma_f32_16x16x32_bf16 v[124:127], v[152:155], v[72:75], v[124:127]
    v_mfma_f32_16x16x32_bf16 v[124:127], v[156:159], v[76:79], v[124:127]
    v_mfma_f32_16x16x32_bf16 v[124:127], v[160:163], v[80:83], v[124:127]
    v_mfma_f32_16x16x32_bf16 v[140:143], v[164:167], v[68:71], 0
    v_mfma_f32_16x16x32_bf16 v[140:143], v[168:171], v[72:75], v[140:143]
    v_mfma_f32_16x16x32_bf16 v[140:143], v[172:175], v[76:79], v[140:143]
    v_mfma_f32_16x16x32_bf16 v[140:143], v[176:179], v[80:83], v[140:143]
    v_mfma_f32_16x16x32_bf16 v[128:131], v[160:163], v[96:99], 0
    v_mfma_f32_16x16x32_bf16 v[128:131], v[156:159], v[92:95], v[128:131]
    v_mfma_f32_16x16x32_bf16 v[128:131], v[152:155], v[88:91], v[128:131]
    v_mfma_f32_16x16x32_bf16 v[128:131], v[148:151], v[84:87], v[128:131]
    v_mfma_f32_16x16x32_bf16 v[144:147], v[176:179], v[96:99], 0
    v_mfma_f32_16x16x32_bf16 v[144:147], v[172:175], v[92:95], v[144:147]
    v_mfma_f32_16x16x32_bf16 v[144:147], v[168:171], v[88:91], v[144:147]
    v_mfma_f32_16x16x32_bf16 v[144:147], v[164:167], v[84:87], v[144:147]
    s_waitcnt lgkmcnt(0)
    s_nop 7
    v_max3_f32 v224, v116, v117, v118
    v_max3_f32 v224, v224, v119, v132
    v_max3_f32 v224, v224, v133, v134
    v_max3_f32 v224, v224, v135, v212
    v_mov_b32 v225, v224
    s_nop 1
    v_permlane32_swap_b32 v224, v225
    v_max_f32 v224, v224, v225
    v_mov_b32 v225, v224
    s_nop 1
    v_permlane16_swap_b32 v224, v225
    v_max_f32 v224, v224, v225
    v_sub_f32 v220, v212, v224
    v_exp_f32 v220, v220
    v_mov_b32 v212, v224
    v_sub_f32 v116, v116, v224
    v_sub_f32 v117, v117, v224
    v_sub_f32 v118, v118, v224
    v_sub_f32 v119, v119, v224
    v_sub_f32 v132, v132, v224
    v_sub_f32 v133, v133, v224
    v_sub_f32 v134, v134, v224
    v_sub_f32 v135, v135, v224
    v_mul_f32 v216, v216, v220
    v_exp_f32 v116, v116
    v_exp_f32 v117, v117
    v_exp_f32 v118, v118
    v_exp_f32 v119, v119
    v_exp_f32 v132, v132
    v_exp_f32 v133, v133
    v_exp_f32 v134, v134
    v_exp_f32 v135, v135
    v_accvgpr_read_b32 v224, a0
    v_accvgpr_read_b32 v225, a1
    v_accvgpr_read_b32 v226, a2
    v_accvgpr_read_b32 v227, a3
    v_mul_f32 v224, v224, v220
    v_mul_f32 v225, v225, v220
    v_mul_f32 v226, v226, v220
    v_mul_f32 v227, v227, v220
    v_accvgpr_write_b32 a0, v224
    v_accvgpr_write_b32 a1, v225
    v_accvgpr_write_b32 a2, v226
    v_accvgpr_write_b32 a3, v227
    v_accvgpr_read_b32 v224, a16
    v_accvgpr_read_b32 v225, a17
    v_accvgpr_read_b32 v226, a18
    v_accvgpr_read_b32 v227, a19
    v_mul_f32 v224, v224, v220
    v_mul_f32 v225, v225, v220
    v_mul_f32 v226, v226, v220
    v_mul_f32 v227, v227, v220
    v_accvgpr_write_b32 a16, v224
    v_accvgpr_write_b32 a17, v225
    v_accvgpr_write_b32 a18, v226
    v_accvgpr_write_b32 a19, v227
    v_accvgpr_read_b32 v224, a32
    v_accvgpr_read_b32 v225, a33
    v_accvgpr_read_b32 v226, a34
    v_accvgpr_read_b32 v227, a35
    v_mul_f32 v224, v224, v220
    v_mul_f32 v225, v225, v220
    v_mul_f32 v226, v226, v220
    v_mul_f32 v227, v227, v220
    v_accvgpr_write_b32 a32, v224
    v_accvgpr_write_b32 a33, v225
    v_accvgpr_write_b32 a34, v226
    v_accvgpr_write_b32 a35, v227
    v_accvgpr_read_b32 v224, a48
    v_accvgpr_read_b32 v225, a49
    v_accvgpr_read_b32 v226, a50
    v_accvgpr_read_b32 v227, a51
    v_mul_f32 v224, v224, v220
    v_mul_f32 v225, v225, v220
    v_mul_f32 v226, v226, v220
    v_mul_f32 v227, v227, v220
    v_accvgpr_write_b32 a48, v224
    v_accvgpr_write_b32 a49, v225
    v_accvgpr_write_b32 a50, v226
    v_accvgpr_write_b32 a51, v227
    v_accvgpr_read_b32 v224, a64
    v_accvgpr_read_b32 v225, a65
    v_accvgpr_read_b32 v226, a66
    v_accvgpr_read_b32 v227, a67
    v_mul_f32 v224, v224, v220
    v_mul_f32 v225, v225, v220
    v_mul_f32 v226, v226, v220
    v_mul_f32 v227, v227, v220
    v_accvgpr_write_b32 a64, v224
    v_accvgpr_write_b32 a65, v225
    v_accvgpr_write_b32 a66, v226
    v_accvgpr_write_b32 a67, v227
    v_accvgpr_read_b32 v224, a80
    v_accvgpr_read_b32 v225, a81
    v_accvgpr_read_b32 v226, a82
    v_accvgpr_read_b32 v227, a83
    v_mul_f32 v224, v224, v220
    v_mul_f32 v225, v225, v220
    v_mul_f32 v226, v226, v220
    v_mul_f32 v227, v227, v220
    v_accvgpr_write_b32 a80, v224
    v_accvgpr_write_b32 a81, v225
    v_accvgpr_write_b32 a82, v226
    v_accvgpr_write_b32 a83, v227
    v_accvgpr_read_b32 v224, a96
    v_accvgpr_read_b32 v225, a97
    v_accvgpr_read_b32 v226, a98
    v_accvgpr_read_b32 v227, a99
    v_mul_f32 v224, v224, v220
    v_mul_f32 v225, v225, v220
    v_mul_f32 v226, v226, v220
    v_mul_f32 v227, v227, v220
    v_accvgpr_write_b32 a96, v224
    v_accvgpr_write_b32 a97, v225
    v_accvgpr_write_b32 a98, v226
    v_accvgpr_write_b32 a99, v227
    v_accvgpr_read_b32 v224, a112
    v_accvgpr_read_b32 v225, a113
    v_accvgpr_read_b32 v226, a114
    v_accvgpr_read_b32 v227, a115
    v_mul_f32 v224, v224, v220
    v_mul_f32 v225, v225, v220
    v_mul_f32 v226, v226, v220
    v_mul_f32 v227, v227, v220
    v_accvgpr_write_b32 a112, v224
    v_accvgpr_write_b32 a113, v225
    v_accvgpr_write_b32 a114, v226
    v_accvgpr_write_b32 a115, v227
    v_add_f32 v216, v216, v116
    v_add_f32 v216, v216, v117
    v_add_f32 v216, v216, v118
    v_add_f32 v216, v216, v119
    v_add_f32 v216, v216, v132
    v_add_f32 v216, v216, v133
    v_add_f32 v216, v216, v134
    v_add_f32 v216, v216, v135
    v_cvt_pk_bf16_f32 v180, v116, v117
    v_cvt_pk_bf16_f32 v181, v118, v119
    v_cvt_pk_bf16_f32 v182, v132, v133
    v_cvt_pk_bf16_f32 v183, v134, v135
    s_nop 1
    v_mfma_f32_16x16x32_bf16 a[0:3], v[196:199], v[180:183], a[0:3]
    v_mfma_f32_16x16x32_bf16 a[16:19], v[200:203], v[180:183], a[16:19]
    v_mfma_f32_16x16x32_bf16 a[32:35], v[204:207], v[180:183], a[32:35]
    v_mfma_f32_16x16x32_bf16 a[48:51], v[208:211], v[180:183], a[48:51]
    v_mfma_f32_16x16x32_bf16 a[64:67], v[228:231], v[180:183], a[64:67]
    v_mfma_f32_16x16x32_bf16 a[80:83], v[232:235], v[180:183], a[80:83]
    v_mfma_f32_16x16x32_bf16 a[96:99], v[236:239], v[180:183], a[96:99]
    v_mfma_f32_16x16x32_bf16 a[112:115], v[240:243], v[180:183], a[112:115]
    v_max3_f32 v224, v120, v121, v122
    v_max3_f32 v224, v224, v123, v136
    v_max3_f32 v224, v224, v137, v138
    v_max3_f32 v224, v224, v139, v213
    v_mov_b32 v225, v224
    s_nop 1
    v_permlane32_swap_b32 v224, v225
    v_max_f32 v224, v224, v225
    v_mov_b32 v225, v224
    s_nop 1
    v_permlane16_swap_b32 v224, v225
    v_max_f32 v224, v224, v225
    v_sub_f32 v220, v213, v224
    v_exp_f32 v220, v220
    v_mov_b32 v213, v224
    v_sub_f32 v120, v120, v224
    v_sub_f32 v121, v121, v224
    v_sub_f32 v122, v122, v224
    v_sub_f32 v123, v123, v224
    v_sub_f32 v136, v136, v224
    v_sub_f32 v137, v137, v224
    v_sub_f32 v138, v138, v224
    v_sub_f32 v139, v139, v224
    v_mul_f32 v217, v217, v220
    v_exp_f32 v120, v120
    v_exp_f32 v121, v121
    v_exp_f32 v122, v122
    v_exp_f32 v123, v123
    v_exp_f32 v136, v136
    v_exp_f32 v137, v137
    v_exp_f32 v138, v138
    v_exp_f32 v139, v139
    v_accvgpr_read_b32 v224, a4
    v_accvgpr_read_b32 v225, a5
    v_accvgpr_read_b32 v226, a6
    v_accvgpr_read_b32 v227, a7
    v_mul_f32 v224, v224, v220
    v_mul_f32 v225, v225, v220
    v_mul_f32 v226, v226, v220
    v_mul_f32 v227, v227, v220
    v_accvgpr_write_b32 a4, v224
    v_accvgpr_write_b32 a5, v225
    v_accvgpr_write_b32 a6, v226
    v_accvgpr_write_b32 a7, v227
    v_accvgpr_read_b32 v224, a20
    v_accvgpr_read_b32 v225, a21
    v_accvgpr_read_b32 v226, a22
    v_accvgpr_read_b32 v227, a23
    v_mul_f32 v224, v224, v220
    v_mul_f32 v225, v225, v220
    v_mul_f32 v226, v226, v220
    v_mul_f32 v227, v227, v220
    v_accvgpr_write_b32 a20, v224
    v_accvgpr_write_b32 a21, v225
    v_accvgpr_write_b32 a22, v226
    v_accvgpr_write_b32 a23, v227
    v_accvgpr_read_b32 v224, a36
    v_accvgpr_read_b32 v225, a37
    v_accvgpr_read_b32 v226, a38
    v_accvgpr_read_b32 v227, a39
    v_mul_f32 v224, v224, v220
    v_mul_f32 v225, v225, v220
    v_mul_f32 v226, v226, v220
    v_mul_f32 v227, v227, v220
    v_accvgpr_write_b32 a36, v224
    v_accvgpr_write_b32 a37, v225
    v_accvgpr_write_b32 a38, v226
    v_accvgpr_write_b32 a39, v227
    v_accvgpr_read_b32 v224, a52
    v_accvgpr_read_b32 v225, a53
    v_accvgpr_read_b32 v226, a54
    v_accvgpr_read_b32 v227, a55
    v_mul_f32 v224, v224, v220
    v_mul_f32 v225, v225, v220
    v_mul_f32 v226, v226, v220
    v_mul_f32 v227, v227, v220
    v_accvgpr_write_b32 a52, v224
    v_accvgpr_write_b32 a53, v225
    v_accvgpr_write_b32 a54, v226
    v_accvgpr_write_b32 a55, v227
    v_accvgpr_read_b32 v224, a68
    v_accvgpr_read_b32 v225, a69
    v_accvgpr_read_b32 v226, a70
    v_accvgpr_read_b32 v227, a71
    v_mul_f32 v224, v224, v220
    v_mul_f32 v225, v225, v220
    v_mul_f32 v226, v226, v220
    v_mul_f32 v227, v227, v220
    v_accvgpr_write_b32 a68, v224
    v_accvgpr_write_b32 a69, v225
    v_accvgpr_write_b32 a70, v226
    v_accvgpr_write_b32 a71, v227
    v_accvgpr_read_b32 v224, a84
    v_accvgpr_read_b32 v225, a85
    v_accvgpr_read_b32 v226, a86
    v_accvgpr_read_b32 v227, a87
    v_mul_f32 v224, v224, v220
    v_mul_f32 v225, v225, v220
    v_mul_f32 v226, v226, v220
    v_mul_f32 v227, v227, v220
    v_accvgpr_write_b32 a84, v224
    v_accvgpr_write_b32 a85, v225
    v_accvgpr_write_b32 a86, v226
    v_accvgpr_write_b32 a87, v227
    v_accvgpr_read_b32 v224, a100
    v_accvgpr_read_b32 v225, a101
    v_accvgpr_read_b32 v226, a102
    v_accvgpr_read_b32 v227, a103
    v_mul_f32 v224, v224, v220
    v_mul_f32 v225, v225, v220
    v_mul_f32 v226, v226, v220
    v_mul_f32 v227, v227, v220
    v_accvgpr_write_b32 a100, v224
    v_accvgpr_write_b32 a101, v225
    v_accvgpr_write_b32 a102, v226
    v_accvgpr_write_b32 a103, v227
    v_accvgpr_read_b32 v224, a116
    v_accvgpr_read_b32 v225, a117
    v_accvgpr_read_b32 v226, a118
    v_accvgpr_read_b32 v227, a119
    v_mul_f32 v224, v224, v220
    v_mul_f32 v225, v225, v220
    v_mul_f32 v226, v226, v220
    v_mul_f32 v227, v227, v220
    v_accvgpr_write_b32 a116, v224
    v_accvgpr_write_b32 a117, v225
    v_accvgpr_write_b32 a118, v226
    v_accvgpr_write_b32 a119, v227
    v_add_f32 v217, v217, v120
    v_add_f32 v217, v217, v121
    v_add_f32 v217, v217, v122
    v_add_f32 v217, v217, v123
    v_add_f32 v217, v217, v136
    v_add_f32 v217, v217, v137
    v_add_f32 v217, v217, v138
    v_add_f32 v217, v217, v139
    v_cvt_pk_bf16_f32 v184, v120, v121
    v_cvt_pk_bf16_f32 v185, v122, v123
    v_cvt_pk_bf16_f32 v186, v136, v137
    v_cvt_pk_bf16_f32 v187, v138, v139
    s_nop 1
    v_mfma_f32_16x16x32_bf16 a[4:7], v[196:199], v[184:187], a[4:7]
    v_mfma_f32_16x16x32_bf16 a[20:23], v[200:203], v[184:187], a[20:23]
    v_mfma_f32_16x16x32_bf16 a[36:39], v[204:207], v[184:187], a[36:39]
    v_mfma_f32_16x16x32_bf16 a[52:55], v[208:211], v[184:187], a[52:55]
    v_mfma_f32_16x16x32_bf16 a[68:71], v[228:231], v[184:187], a[68:71]
    v_mfma_f32_16x16x32_bf16 a[84:87], v[232:235], v[184:187], a[84:87]
    v_mfma_f32_16x16x32_bf16 a[100:103], v[236:239], v[184:187], a[100:103]
    v_mfma_f32_16x16x32_bf16 a[116:119], v[240:243], v[184:187], a[116:119]
    v_max3_f32 v224, v124, v125, v126
    v_max3_f32 v224, v224, v127, v140
    v_max3_f32 v224, v224, v141, v142
    v_max3_f32 v224, v224, v143, v214
    v_mov_b32 v225, v224
    s_nop 1
    v_permlane32_swap_b32 v224, v225
    v_max_f32 v224, v224, v225
    v_mov_b32 v225, v224
    s_nop 1
    v_permlane16_swap_b32 v224, v225
    v_max_f32 v224, v224, v225
    v_sub_f32 v220, v214, v224
    v_exp_f32 v220, v220
    v_mov_b32 v214, v224
    v_sub_f32 v124, v124, v224
    v_sub_f32 v125, v125, v224
    v_sub_f32 v126, v126, v224
    v_sub_f32 v127, v127, v224
    v_sub_f32 v140, v140, v224
    v_sub_f32 v141, v141, v224
    v_sub_f32 v142, v142, v224
    v_sub_f32 v143, v143, v224
    v_mul_f32 v218, v218, v220
    v_exp_f32 v124, v124
    v_exp_f32 v125, v125
    v_exp_f32 v126, v126
    v_exp_f32 v127, v127
    v_exp_f32 v140, v140
    v_exp_f32 v141, v141
    v_exp_f32 v142, v142
    v_exp_f32 v143, v143
    v_accvgpr_read_b32 v224, a8
    v_accvgpr_read_b32 v225, a9
    v_accvgpr_read_b32 v226, a10
    v_accvgpr_read_b32 v227, a11
    v_mul_f32 v224, v224, v220
    v_mul_f32 v225, v225, v220
    v_mul_f32 v226, v226, v220
    v_mul_f32 v227, v227, v220
    v_accvgpr_write_b32 a8, v224
    v_accvgpr_write_b32 a9, v225
    v_accvgpr_write_b32 a10, v226
    v_accvgpr_write_b32 a11, v227
    v_accvgpr_read_b32 v224, a24
    v_accvgpr_read_b32 v225, a25
    v_accvgpr_read_b32 v226, a26
    v_accvgpr_read_b32 v227, a27
    v_mul_f32 v224, v224, v220
    v_mul_f32 v225, v225, v220
    v_mul_f32 v226, v226, v220
    v_mul_f32 v227, v227, v220
    v_accvgpr_write_b32 a24, v224
    v_accvgpr_write_b32 a25, v225
    v_accvgpr_write_b32 a26, v226
    v_accvgpr_write_b32 a27, v227
    v_accvgpr_read_b32 v224, a40
    v_accvgpr_read_b32 v225, a41
    v_accvgpr_read_b32 v226, a42
    v_accvgpr_read_b32 v227, a43
    v_mul_f32 v224, v224, v220
    v_mul_f32 v225, v225, v220
    v_mul_f32 v226, v226, v220
    v_mul_f32 v227, v227, v220
    v_accvgpr_write_b32 a40, v224
    v_accvgpr_write_b32 a41, v225
    v_accvgpr_write_b32 a42, v226
    v_accvgpr_write_b32 a43, v227
    v_accvgpr_read_b32 v224, a56
    v_accvgpr_read_b32 v225, a57
    v_accvgpr_read_b32 v226, a58
    v_accvgpr_read_b32 v227, a59
    v_mul_f32 v224, v224, v220
    v_mul_f32 v225, v225, v220
    v_mul_f32 v226, v226, v220
    v_mul_f32 v227, v227, v220
    v_accvgpr_write_b32 a56, v224
    v_accvgpr_write_b32 a57, v225
    v_accvgpr_write_b32 a58, v226
    v_accvgpr_write_b32 a59, v227
    v_accvgpr_read_b32 v224, a72
    v_accvgpr_read_b32 v225, a73
    v_accvgpr_read_b32 v226, a74
    v_accvgpr_read_b32 v227, a75
    v_mul_f32 v224, v224, v220
    v_mul_f32 v225, v225, v220
    v_mul_f32 v226, v226, v220
    v_mul_f32 v227, v227, v220
    v_accvgpr_write_b32 a72, v224
    v_accvgpr_write_b32 a73, v225
    v_accvgpr_write_b32 a74, v226
    v_accvgpr_write_b32 a75, v227
    v_accvgpr_read_b32 v224, a88
    v_accvgpr_read_b32 v225, a89
    v_accvgpr_read_b32 v226, a90
    v_accvgpr_read_b32 v227, a91
    v_mul_f32 v224, v224, v220
    v_mul_f32 v225, v225, v220
    v_mul_f32 v226, v226, v220
    v_mul_f32 v227, v227, v220
    v_accvgpr_write_b32 a88, v224
    v_accvgpr_write_b32 a89, v225
    v_accvgpr_write_b32 a90, v226
    v_accvgpr_write_b32 a91, v227
    v_accvgpr_read_b32 v224, a104
    v_accvgpr_read_b32 v225, a105
    v_accvgpr_read_b32 v226, a106
    v_accvgpr_read_b32 v227, a107
    v_mul_f32 v224, v224, v220
    v_mul_f32 v225, v225, v220
    v_mul_f32 v226, v226, v220
    v_mul_f32 v227, v227, v220
    v_accvgpr_write_b32 a104, v224
    v_accvgpr_write_b32 a105, v225
    v_accvgpr_write_b32 a106, v226
    v_accvgpr_write_b32 a107, v227
    v_accvgpr_read_b32 v224, a120
    v_accvgpr_read_b32 v225, a121
    v_accvgpr_read_b32 v226, a122
    v_accvgpr_read_b32 v227, a123
    v_mul_f32 v224, v224, v220
    v_mul_f32 v225, v225, v220
    v_mul_f32 v226, v226, v220
    v_mul_f32 v227, v227, v220
    v_accvgpr_write_b32 a120, v224
    v_accvgpr_write_b32 a121, v225
    v_accvgpr_write_b32 a122, v226
    v_accvgpr_write_b32 a123, v227
    v_add_f32 v218, v218, v124
    v_add_f32 v218, v218, v125
    v_add_f32 v218, v218, v126
    v_add_f32 v218, v218, v127
    v_add_f32 v218, v218, v140
    v_add_f32 v218, v218, v141
    v_add_f32 v218, v218, v142
    v_add_f32 v218, v218, v143
    v_cvt_pk_bf16_f32 v188, v124, v125
    v_cvt_pk_bf16_f32 v189, v126, v127
    v_cvt_pk_bf16_f32 v190, v140, v141
    v_cvt_pk_bf16_f32 v191, v142, v143
    s_nop 1
    v_mfma_f32_16x16x32_bf16 a[8:11], v[196:199], v[188:191], a[8:11]
    v_mfma_f32_16x16x32_bf16 a[24:27], v[200:203], v[188:191], a[24:27]
    v_mfma_f32_16x16x32_bf16 a[40:43], v[204:207], v[188:191], a[40:43]
    v_mfma_f32_16x16x32_bf16 a[56:59], v[208:211], v[188:191], a[56:59]
    v_mfma_f32_16x16x32_bf16 a[72:75], v[228:231], v[188:191], a[72:75]
    v_mfma_f32_16x16x32_bf16 a[88:91], v[232:235], v[188:191], a[88:91]
    v_mfma_f32_16x16x32_bf16 a[104:107], v[236:239], v[188:191], a[104:107]
    v_mfma_f32_16x16x32_bf16 a[120:123], v[240:243], v[188:191], a[120:123]
    v_max3_f32 v224, v128, v129, v130
    v_max3_f32 v224, v224, v131, v144
    v_max3_f32 v224, v224, v145, v146
    v_max3_f32 v224, v224, v147, v215
    v_mov_b32 v225, v224
    s_nop 1
    v_permlane32_swap_b32 v224, v225
    v_max_f32 v224, v224, v225
    v_mov_b32 v225, v224
    s_nop 1
    v_permlane16_swap_b32 v224, v225
    v_max_f32 v224, v224, v225
    v_sub_f32 v220, v215, v224
    v_exp_f32 v220, v220
    v_mov_b32 v215, v224
    v_sub_f32 v128, v128, v224
    v_sub_f32 v129, v129, v224
    v_sub_f32 v130, v130, v224
    v_sub_f32 v131, v131, v224
    v_sub_f32 v144, v144, v224
    v_sub_f32 v145, v145, v224
    v_sub_f32 v146, v146, v224
    v_sub_f32 v147, v147, v224
    v_mul_f32 v219, v219, v220
    v_exp_f32 v128, v128
    v_exp_f32 v129, v129
    v_exp_f32 v130, v130
    v_exp_f32 v131, v131
    v_exp_f32 v144, v144
    v_exp_f32 v145, v145
    v_exp_f32 v146, v146
    v_exp_f32 v147, v147
    v_accvgpr_read_b32 v224, a12
    v_accvgpr_read_b32 v225, a13
    v_accvgpr_read_b32 v226, a14
    v_accvgpr_read_b32 v227, a15
    v_mul_f32 v224, v224, v220
    v_mul_f32 v225, v225, v220
    v_mul_f32 v226, v226, v220
    v_mul_f32 v227, v227, v220
    v_accvgpr_write_b32 a12, v224
    v_accvgpr_write_b32 a13, v225
    v_accvgpr_write_b32 a14, v226
    v_accvgpr_write_b32 a15, v227
    v_accvgpr_read_b32 v224, a28
    v_accvgpr_read_b32 v225, a29
    v_accvgpr_read_b32 v226, a30
    v_accvgpr_read_b32 v227, a31
    v_mul_f32 v224, v224, v220
    v_mul_f32 v225, v225, v220
    v_mul_f32 v226, v226, v220
    v_mul_f32 v227, v227, v220
    v_accvgpr_write_b32 a28, v224
    v_accvgpr_write_b32 a29, v225
    v_accvgpr_write_b32 a30, v226
    v_accvgpr_write_b32 a31, v227
    v_accvgpr_read_b32 v224, a44
    v_accvgpr_read_b32 v225, a45
    v_accvgpr_read_b32 v226, a46
    v_accvgpr_read_b32 v227, a47
    v_mul_f32 v224, v224, v220
    v_mul_f32 v225, v225, v220
    v_mul_f32 v226, v226, v220
    v_mul_f32 v227, v227, v220
    v_accvgpr_write_b32 a44, v224
    v_accvgpr_write_b32 a45, v225
    v_accvgpr_write_b32 a46, v226
    v_accvgpr_write_b32 a47, v227
    v_accvgpr_read_b32 v224, a60
    v_accvgpr_read_b32 v225, a61
    v_accvgpr_read_b32 v226, a62
    v_accvgpr_read_b32 v227, a63
    v_mul_f32 v224, v224, v220
    v_mul_f32 v225, v225, v220
    v_mul_f32 v226, v226, v220
    v_mul_f32 v227, v227, v220
    v_accvgpr_write_b32 a60, v224
    v_accvgpr_write_b32 a61, v225
    v_accvgpr_write_b32 a62, v226
    v_accvgpr_write_b32 a63, v227
    v_accvgpr_read_b32 v224, a76
    v_accvgpr_read_b32 v225, a77
    v_accvgpr_read_b32 v226, a78
    v_accvgpr_read_b32 v227, a79
    v_mul_f32 v224, v224, v220
    v_mul_f32 v225, v225, v220
    v_mul_f32 v226, v226, v220
    v_mul_f32 v227, v227, v220
    v_accvgpr_write_b32 a76, v224
    v_accvgpr_write_b32 a77, v225
    v_accvgpr_write_b32 a78, v226
    v_accvgpr_write_b32 a79, v227
    v_accvgpr_read_b32 v224, a92
    v_accvgpr_read_b32 v225, a93
    v_accvgpr_read_b32 v226, a94
    v_accvgpr_read_b32 v227, a95
    v_mul_f32 v224, v224, v220
    v_mul_f32 v225, v225, v220
    v_mul_f32 v226, v226, v220
    v_mul_f32 v227, v227, v220
    v_accvgpr_write_b32 a92, v224
    v_accvgpr_write_b32 a93, v225
    v_accvgpr_write_b32 a94, v226
    v_accvgpr_write_b32 a95, v227
    v_accvgpr_read_b32 v224, a108
    v_accvgpr_read_b32 v225, a109
    v_accvgpr_read_b32 v226, a110
    v_accvgpr_read_b32 v227, a111
    v_mul_f32 v224, v224, v220
    v_mul_f32 v225, v225, v220
    v_mul_f32 v226, v226, v220
    v_mul_f32 v227, v227, v220
    v_accvgpr_write_b32 a108, v224
    v_accvgpr_write_b32 a109, v225
    v_accvgpr_write_b32 a110, v226
    v_accvgpr_write_b32 a111, v227
    v_accvgpr_read_b32 v224, a124
    v_accvgpr_read_b32 v225, a125
    v_accvgpr_read_b32 v226, a126
    v_accvgpr_read_b32 v227, a127
    v_mul_f32 v224, v224, v220
    v_mul_f32 v225, v225, v220
    v_mul_f32 v226, v226, v220
    v_mul_f32 v227, v227, v220
    v_accvgpr_write_b32 a124, v224
    v_accvgpr_write_b32 a125, v225
    v_accvgpr_write_b32 a126, v226
    v_accvgpr_write_b32 a127, v227
    v_add_f32 v219, v219, v128
    v_add_f32 v219, v219, v129
    v_add_f32 v219, v219, v130
    v_add_f32 v219, v219, v131
    v_add_f32 v219, v219, v144
    v_add_f32 v219, v219, v145
    v_add_f32 v219, v219, v146
    v_add_f32 v219, v219, v147
    v_cvt_pk_bf16_f32 v192, v128, v129
    v_cvt_pk_bf16_f32 v193, v130, v131
    v_cvt_pk_bf16_f32 v194, v144, v145
    v_cvt_pk_bf16_f32 v195, v146, v147
    s_nop 1
    v_mfma_f32_16x16x32_bf16 a[12:15], v[196:199], v[192:195], a[12:15]
    v_mfma_f32_16x16x32_bf16 a[28:31], v[200:203], v[192:195], a[28:31]
    v_mfma_f32_16x16x32_bf16 a[44:47], v[204:207], v[192:195], a[44:47]
    v_mfma_f32_16x16x32_bf16 a[60:63], v[208:211], v[192:195], a[60:63]
    v_mfma_f32_16x16x32_bf16 a[76:79], v[228:231], v[192:195], a[76:79]
    v_mfma_f32_16x16x32_bf16 a[92:95], v[232:235], v[192:195], a[92:95]
    v_mfma_f32_16x16x32_bf16 a[108:111], v[236:239], v[192:195], a[108:111]
    v_mfma_f32_16x16x32_bf16 a[124:127], v[240:243], v[192:195], a[124:127]
    s_add_u32 s28, s28, 8192
    s_cmp_lt_u32 s28, 524288
    s_cbranch_scc1 L_slow_loop
    v_mov_b32 v224, v216
    s_nop 1
    v_permlane32_swap_b32 v216, v224
    v_add_f32 v216, v216, v224
    v_mov_b32 v224, v216
    s_nop 1
    v_permlane16_swap_b32 v216, v224
    v_add_f32 v216, v216, v224
    v_rcp_f32 v100, v216
    v_mov_b32 v224, v217
    s_nop 1
    v_permlane32_swap_b32 v217, v224
    v_add_f32 v217, v217, v224
    v_mov_b32 v224, v217
    s_nop 1
    v_permlane16_swap_b32 v217, v224
    v_add_f32 v217, v217, v224
    v_rcp_f32 v101, v217
    v_mov_b32 v224, v218
    s_nop 1
    v_permlane32_swap_b32 v218, v224
    v_add_f32 v218, v218, v224
    v_mov_b32 v224, v218
    s_nop 1
    v_permlane16_swap_b32 v218, v224
    v_add_f32 v218, v218, v224
    v_rcp_f32 v102, v218
    v_mov_b32 v224, v219
    s_nop 1
    v_permlane32_swap_b32 v219, v224
    v_add_f32 v219, v219, v224
    v_mov_b32 v224, v219
    s_nop 1
    v_permlane16_swap_b32 v219, v224
    v_add_f32 v219, v219, v224
    v_rcp_f32 v103, v219
    s_mov_b32 s36, 0
    v_accvgpr_read_b32 v120, a0
    v_accvgpr_read_b32 v121, a1
    v_accvgpr_read_b32 v122, a2
    v_accvgpr_read_b32 v123, a3
    v_accvgpr_read_b32 v124, a16
    v_accvgpr_read_b32 v125, a17
    v_accvgpr_read_b32 v126, a18
    v_accvgpr_read_b32 v127, a19
    v_mul_f32 v120, v120, v100
    v_mul_f32 v121, v121, v100
    v_mul_f32 v122, v122, v100
    v_mul_f32 v123, v123, v100
    v_mul_f32 v124, v124, v100
    v_mul_f32 v125, v125, v100
    v_mul_f32 v126, v126, v100
    v_mul_f32 v127, v127, v100
    v_cvt_pk_bf16_f32 v152, v120, v121
    v_cvt_pk_bf16_f32 v153, v122, v123
    v_cvt_pk_bf16_f32 v154, v124, v125
    v_cvt_pk_bf16_f32 v155, v126, v127
    buffer_store_dwordx4 v[152:155], v110, s[24:27], s36 offen offset:0 sc1
    v_accvgpr_read_b32 v128, a4
    v_accvgpr_read_b32 v129, a5
    v_accvgpr_read_b32 v130, a6
    v_accvgpr_read_b32 v131, a7
    v_accvgpr_read_b32 v132, a20
    v_accvgpr_read_b32 v133, a21
    v_accvgpr_read_b32 v134, a22
    v_accvgpr_read_b32 v135, a23
    v_mul_f32 v128, v128, v101
    v_mul_f32 v129, v129, v101
    v_mul_f32 v130, v130, v101
    v_mul_f32 v131, v131, v101
    v_mul_f32 v132, v132, v101
    v_mul_f32 v133, v133, v101
    v_mul_f32 v134, v134, v101
    v_mul_f32 v135, v135, v101
    v_cvt_pk_bf16_f32 v156, v128, v129
    v_cvt_pk_bf16_f32 v157, v130, v131
    v_cvt_pk_bf16_f32 v158, v132, v133
    v_cvt_pk_bf16_f32 v159, v134, v135
    buffer_store_dwordx4 v[156:159], v110, s[24:27], s36 offen offset:1024 sc1
    v_accvgpr_read_b32 v136, a8
    v_accvgpr_read_b32 v137, a9
    v_accvgpr_read_b32 v138, a10
    v_accvgpr_read_b32 v139, a11
    v_accvgpr_read_b32 v140, a24
    v_accvgpr_read_b32 v141, a25
    v_accvgpr_read_b32 v142, a26
    v_accvgpr_read_b32 v143, a27
    v_mul_f32 v136, v136, v102
    v_mul_f32 v137, v137, v102
    v_mul_f32 v138, v138, v102
    v_mul_f32 v139, v139, v102
    v_mul_f32 v140, v140, v102
    v_mul_f32 v141, v141, v102
    v_mul_f32 v142, v142, v102
    v_mul_f32 v143, v143, v102
    v_cvt_pk_bf16_f32 v160, v136, v137
    v_cvt_pk_bf16_f32 v161, v138, v139
    v_cvt_pk_bf16_f32 v162, v140, v141
    v_cvt_pk_bf16_f32 v163, v142, v143
    buffer_store_dwordx4 v[160:163], v110, s[24:27], s36 offen offset:2048 sc1
    v_accvgpr_read_b32 v144, a12
    v_accvgpr_read_b32 v145, a13
    v_accvgpr_read_b32 v146, a14
    v_accvgpr_read_b32 v147, a15
    v_accvgpr_read_b32 v148, a28
    v_accvgpr_read_b32 v149, a29
    v_accvgpr_read_b32 v150, a30
    v_accvgpr_read_b32 v151, a31
    v_mul_f32 v144, v144, v103
    v_mul_f32 v145, v145, v103
    v_mul_f32 v146, v146, v103
    v_mul_f32 v147, v147, v103
    v_mul_f32 v148, v148, v103
    v_mul_f32 v149, v149, v103
    v_mul_f32 v150, v150, v103
    v_mul_f32 v151, v151, v103
    v_cvt_pk_bf16_f32 v164, v144, v145
    v_cvt_pk_bf16_f32 v165, v146, v147
    v_cvt_pk_bf16_f32 v166, v148, v149
    v_cvt_pk_bf16_f32 v167, v150, v151
    buffer_store_dwordx4 v[164:167], v110, s[24:27], s36 offen offset:3072 sc1
    s_mov_b32 s36, 4096
    v_accvgpr_read_b32 v120, a32
    v_accvgpr_read_b32 v121, a33
    v_accvgpr_read_b32 v122, a34
    v_accvgpr_read_b32 v123, a35
    v_accvgpr_read_b32 v124, a48
    v_accvgpr_read_b32 v125, a49
    v_accvgpr_read_b32 v126, a50
    v_accvgpr_read_b32 v127, a51
    v_mul_f32 v120, v120, v100
    v_mul_f32 v121, v121, v100
    v_mul_f32 v122, v122, v100
    v_mul_f32 v123, v123, v100
    v_mul_f32 v124, v124, v100
    v_mul_f32 v125, v125, v100
    v_mul_f32 v126, v126, v100
    v_mul_f32 v127, v127, v100
    v_cvt_pk_bf16_f32 v152, v120, v121
    v_cvt_pk_bf16_f32 v153, v122, v123
    v_cvt_pk_bf16_f32 v154, v124, v125
    v_cvt_pk_bf16_f32 v155, v126, v127
    buffer_store_dwordx4 v[152:155], v110, s[24:27], s36 offen offset:0 sc1
    v_accvgpr_read_b32 v128, a36
    v_accvgpr_read_b32 v129, a37
    v_accvgpr_read_b32 v130, a38
    v_accvgpr_read_b32 v131, a39
    v_accvgpr_read_b32 v132, a52
    v_accvgpr_read_b32 v133, a53
    v_accvgpr_read_b32 v134, a54
    v_accvgpr_read_b32 v135, a55
    v_mul_f32 v128, v128, v101
    v_mul_f32 v129, v129, v101
    v_mul_f32 v130, v130, v101
    v_mul_f32 v131, v131, v101
    v_mul_f32 v132, v132, v101
    v_mul_f32 v133, v133, v101
    v_mul_f32 v134, v134, v101
    v_mul_f32 v135, v135, v101
    v_cvt_pk_bf16_f32 v156, v128, v129
    v_cvt_pk_bf16_f32 v157, v130, v131
    v_cvt_pk_bf16_f32 v158, v132, v133
    v_cvt_pk_bf16_f32 v159, v134, v135
    buffer_store_dwordx4 v[156:159], v110, s[24:27], s36 offen offset:1024 sc1
    v_accvgpr_read_b32 v136, a40
    v_accvgpr_read_b32 v137, a41
    v_accvgpr_read_b32 v138, a42
    v_accvgpr_read_b32 v139, a43
    v_accvgpr_read_b32 v140, a56
    v_accvgpr_read_b32 v141, a57
    v_accvgpr_read_b32 v142, a58
    v_accvgpr_read_b32 v143, a59
    v_mul_f32 v136, v136, v102
    v_mul_f32 v137, v137, v102
    v_mul_f32 v138, v138, v102
    v_mul_f32 v139, v139, v102
    v_mul_f32 v140, v140, v102
    v_mul_f32 v141, v141, v102
    v_mul_f32 v142, v142, v102
    v_mul_f32 v143, v143, v102
    v_cvt_pk_bf16_f32 v160, v136, v137
    v_cvt_pk_bf16_f32 v161, v138, v139
    v_cvt_pk_bf16_f32 v162, v140, v141
    v_cvt_pk_bf16_f32 v163, v142, v143
    buffer_store_dwordx4 v[160:163], v110, s[24:27], s36 offen offset:2048 sc1
    v_accvgpr_read_b32 v144, a44
    v_accvgpr_read_b32 v145, a45
    v_accvgpr_read_b32 v146, a46
    v_accvgpr_read_b32 v147, a47
    v_accvgpr_read_b32 v148, a60
    v_accvgpr_read_b32 v149, a61
    v_accvgpr_read_b32 v150, a62
    v_accvgpr_read_b32 v151, a63
    v_mul_f32 v144, v144, v103
    v_mul_f32 v145, v145, v103
    v_mul_f32 v146, v146, v103
    v_mul_f32 v147, v147, v103
    v_mul_f32 v148, v148, v103
    v_mul_f32 v149, v149, v103
    v_mul_f32 v150, v150, v103
    v_mul_f32 v151, v151, v103
    v_cvt_pk_bf16_f32 v164, v144, v145
    v_cvt_pk_bf16_f32 v165, v146, v147
    v_cvt_pk_bf16_f32 v166, v148, v149
    v_cvt_pk_bf16_f32 v167, v150, v151
    buffer_store_dwordx4 v[164:167], v110, s[24:27], s36 offen offset:3072 sc1
    s_mov_b32 s36, 8192
    v_accvgpr_read_b32 v120, a64
    v_accvgpr_read_b32 v121, a65
    v_accvgpr_read_b32 v122, a66
    v_accvgpr_read_b32 v123, a67
    v_accvgpr_read_b32 v124, a80
    v_accvgpr_read_b32 v125, a81
    v_accvgpr_read_b32 v126, a82
    v_accvgpr_read_b32 v127, a83
    v_mul_f32 v120, v120, v100
    v_mul_f32 v121, v121, v100
    v_mul_f32 v122, v122, v100
    v_mul_f32 v123, v123, v100
    v_mul_f32 v124, v124, v100
    v_mul_f32 v125, v125, v100
    v_mul_f32 v126, v126, v100
    v_mul_f32 v127, v127, v100
    v_cvt_pk_bf16_f32 v152, v120, v121
    v_cvt_pk_bf16_f32 v153, v122, v123
    v_cvt_pk_bf16_f32 v154, v124, v125
    v_cvt_pk_bf16_f32 v155, v126, v127
    buffer_store_dwordx4 v[152:155], v110, s[24:27], s36 offen offset:0 sc1
    v_accvgpr_read_b32 v128, a68
    v_accvgpr_read_b32 v129, a69
    v_accvgpr_read_b32 v130, a70
    v_accvgpr_read_b32 v131, a71
    v_accvgpr_read_b32 v132, a84
    v_accvgpr_read_b32 v133, a85
    v_accvgpr_read_b32 v134, a86
    v_accvgpr_read_b32 v135, a87
    v_mul_f32 v128, v128, v101
    v_mul_f32 v129, v129, v101
    v_mul_f32 v130, v130, v101
    v_mul_f32 v131, v131, v101
    v_mul_f32 v132, v132, v101
    v_mul_f32 v133, v133, v101
    v_mul_f32 v134, v134, v101
    v_mul_f32 v135, v135, v101
    v_cvt_pk_bf16_f32 v156, v128, v129
    v_cvt_pk_bf16_f32 v157, v130, v131
    v_cvt_pk_bf16_f32 v158, v132, v133
    v_cvt_pk_bf16_f32 v159, v134, v135
    buffer_store_dwordx4 v[156:159], v110, s[24:27], s36 offen offset:1024 sc1
    v_accvgpr_read_b32 v136, a72
    v_accvgpr_read_b32 v137, a73
    v_accvgpr_read_b32 v138, a74
    v_accvgpr_read_b32 v139, a75
    v_accvgpr_read_b32 v140, a88
    v_accvgpr_read_b32 v141, a89
    v_accvgpr_read_b32 v142, a90
    v_accvgpr_read_b32 v143, a91
    v_mul_f32 v136, v136, v102
    v_mul_f32 v137, v137, v102
    v_mul_f32 v138, v138, v102
    v_mul_f32 v139, v139, v102
    v_mul_f32 v140, v140, v102
    v_mul_f32 v141, v141, v102
    v_mul_f32 v142, v142, v102
    v_mul_f32 v143, v143, v102
    v_cvt_pk_bf16_f32 v160, v136, v137
    v_cvt_pk_bf16_f32 v161, v138, v139
    v_cvt_pk_bf16_f32 v162, v140, v141
    v_cvt_pk_bf16_f32 v163, v142, v143
    buffer_store_dwordx4 v[160:163], v110, s[24:27], s36 offen offset:2048 sc1
    v_accvgpr_read_b32 v144, a76
    v_accvgpr_read_b32 v145, a77
    v_accvgpr_read_b32 v146, a78
    v_accvgpr_read_b32 v147, a79
    v_accvgpr_read_b32 v148, a92
    v_accvgpr_read_b32 v149, a93
    v_accvgpr_read_b32 v150, a94
    v_accvgpr_read_b32 v151, a95
    v_mul_f32 v144, v144, v103
    v_mul_f32 v145, v145, v103
    v_mul_f32 v146, v146, v103
    v_mul_f32 v147, v147, v103
    v_mul_f32 v148, v148, v103
    v_mul_f32 v149, v149, v103
    v_mul_f32 v150, v150, v103
    v_mul_f32 v151, v151, v103
    v_cvt_pk_bf16_f32 v164, v144, v145
    v_cvt_pk_bf16_f32 v165, v146, v147
    v_cvt_pk_bf16_f32 v166, v148, v149
    v_cvt_pk_bf16_f32 v167, v150, v151
    buffer_store_dwordx4 v[164:167], v110, s[24:27], s36 offen offset:3072 sc1
    s_mov_b32 s36, 12288
    v_accvgpr_read_b32 v120, a96
    v_accvgpr_read_b32 v121, a97
    v_accvgpr_read_b32 v122, a98
    v_accvgpr_read_b32 v123, a99
    v_accvgpr_read_b32 v124, a112
    v_accvgpr_read_b32 v125, a113
    v_accvgpr_read_b32 v126, a114
    v_accvgpr_read_b32 v127, a115
    v_mul_f32 v120, v120, v100
    v_mul_f32 v121, v121, v100
    v_mul_f32 v122, v122, v100
    v_mul_f32 v123, v123, v100
    v_mul_f32 v124, v124, v100
    v_mul_f32 v125, v125, v100
    v_mul_f32 v126, v126, v100
    v_mul_f32 v127, v127, v100
    v_cvt_pk_bf16_f32 v152, v120, v121
    v_cvt_pk_bf16_f32 v153, v122, v123
    v_cvt_pk_bf16_f32 v154, v124, v125
    v_cvt_pk_bf16_f32 v155, v126, v127
    buffer_store_dwordx4 v[152:155], v110, s[24:27], s36 offen offset:0 sc1
    v_accvgpr_read_b32 v128, a100
    v_accvgpr_read_b32 v129, a101
    v_accvgpr_read_b32 v130, a102
    v_accvgpr_read_b32 v131, a103
    v_accvgpr_read_b32 v132, a116
    v_accvgpr_read_b32 v133, a117
    v_accvgpr_read_b32 v134, a118
    v_accvgpr_read_b32 v135, a119
    v_mul_f32 v128, v128, v101
    v_mul_f32 v129, v129, v101
    v_mul_f32 v130, v130, v101
    v_mul_f32 v131, v131, v101
    v_mul_f32 v132, v132, v101
    v_mul_f32 v133, v133, v101
    v_mul_f32 v134, v134, v101
    v_mul_f32 v135, v135, v101
    v_cvt_pk_bf16_f32 v156, v128, v129
    v_cvt_pk_bf16_f32 v157, v130, v131
    v_cvt_pk_bf16_f32 v158, v132, v133
    v_cvt_pk_bf16_f32 v159, v134, v135
    buffer_store_dwordx4 v[156:159], v110, s[24:27], s36 offen offset:1024 sc1
    v_accvgpr_read_b32 v136, a104
    v_accvgpr_read_b32 v137, a105
    v_accvgpr_read_b32 v138, a106
    v_accvgpr_read_b32 v139, a107
    v_accvgpr_read_b32 v140, a120
    v_accvgpr_read_b32 v141, a121
    v_accvgpr_read_b32 v142, a122
    v_accvgpr_read_b32 v143, a123
    v_mul_f32 v136, v136, v102
    v_mul_f32 v137, v137, v102
    v_mul_f32 v138, v138, v102
    v_mul_f32 v139, v139, v102
    v_mul_f32 v140, v140, v102
    v_mul_f32 v141, v141, v102
    v_mul_f32 v142, v142, v102
    v_mul_f32 v143, v143, v102
    v_cvt_pk_bf16_f32 v160, v136, v137
    v_cvt_pk_bf16_f32 v161, v138, v139
    v_cvt_pk_bf16_f32 v162, v140, v141
    v_cvt_pk_bf16_f32 v163, v142, v143
    buffer_store_dwordx4 v[160:163], v110, s[24:27], s36 offen offset:2048 sc1
    v_accvgpr_read_b32 v144, a108
    v_accvgpr_read_b32 v145, a109
    v_accvgpr_read_b32 v146, a110
    v_accvgpr_read_b32 v147, a111
    v_accvgpr_read_b32 v148, a124
    v_accvgpr_read_b32 v149, a125
    v_accvgpr_read_b32 v150, a126
    v_accvgpr_read_b32 v151, a127
    v_mul_f32 v144, v144, v103
    v_mul_f32 v145, v145, v103
    v_mul_f32 v146, v146, v103
    v_mul_f32 v147, v147, v103
    v_mul_f32 v148, v148, v103
    v_mul_f32 v149, v149, v103
    v_mul_f32 v150, v150, v103
    v_mul_f32 v151, v151, v103
    v_cvt_pk_bf16_f32 v164, v144, v145
    v_cvt_pk_bf16_f32 v165, v146, v147
    v_cvt_pk_bf16_f32 v166, v148, v149
    v_cvt_pk_bf16_f32 v167, v150, v151
    buffer_store_dwordx4 v[164:167], v110, s[24:27], s36 offen offset:3072 sc1
    s_mov_b32 s45, 61440
    buffer_load_dwordx4 a[0:3], v114, s[20:23], s45 offen offset:1024 sc1
    s_mov_b32 s45, 61440
    buffer_load_dwordx4 a[4:7], v114, s[20:23], s45 offen offset:2048 sc1
    s_mov_b32 s45, 61440
    buffer_load_dwordx4 a[8:11], v114, s[20:23], s45 offen offset:3072 sc1
    s_mov_b32 s45, 61440
    buffer_load_dwordx4 a[12:15], v115, s[20:23], s45 offen offset:0 sc1
    s_mov_b32 s45, 81920
    buffer_load_dwordx4 a[16:19], v114, s[20:23], s45 offen offset:0 sc1
    s_mov_b32 s45, 81920
    buffer_load_dwordx4 a[20:23], v114, s[20:23], s45 offen offset:1024 sc1
    s_mov_b32 s45, 81920
    buffer_load_dwordx4 a[24:27], v114, s[20:23], s45 offen offset:2048 sc1
    s_mov_b32 s45, 81920
    buffer_load_dwordx4 a[28:31], v114, s[20:23], s45 offen offset:3072 sc1
    s_mov_b32 s45, 81920
    buffer_load_dwordx4 a[32:35], v115, s[20:23], s45 offen offset:0 sc1
    s_mov_b32 s45, 102400
    buffer_load_dwordx4 a[36:39], v114, s[20:23], s45 offen offset:0 sc1
    s_mov_b32 s45, 102400
    buffer_load_dwordx4 a[40:43], v114, s[20:23], s45 offen offset:1024 sc1
    s_mov_b32 s45, 102400
    buffer_load_dwordx4 a[44:47], v114, s[20:23], s45 offen offset:2048 sc1
    s_mov_b32 s45, 102400
    buffer_load_dwordx4 a[48:51], v114, s[20:23], s45 offen offset:3072 sc1
    s_mov_b32 s45, 102400
    buffer_load_dwordx4 a[52:55], v115, s[20:23], s45 offen offset:0 sc1
    s_mov_b32 s45, 122880
    buffer_load_dwordx4 a[56:59], v114, s[20:23], s45 offen offset:0 sc1
    s_mov_b32 s45, 122880
    buffer_load_dwordx4 a[60:63], v114, s[20:23], s45 offen offset:1024 sc1
    s_mov_b32 s45, 122880
    buffer_load_dwordx4 a[64:67], v114, s[20:23], s45 offen offset:2048 sc1
    s_mov_b32 s45, 122880
    buffer_load_dwordx4 a[68:71], v114, s[20:23], s45 offen offset:3072 sc1
    s_mov_b32 s45, 122880
    buffer_load_dwordx4 a[72:75], v115, s[20:23], s45 offen offset:0 sc1
    s_mov_b32 s45, 143360
    buffer_load_dwordx4 a[76:79], v114, s[20:23], s45 offen offset:0 sc1
    s_mov_b32 s45, 143360
    buffer_load_dwordx4 a[80:83], v114, s[20:23], s45 offen offset:1024 sc1
    s_mov_b32 s45, 143360
    buffer_load_dwordx4 a[84:87], v114, s[20:23], s45 offen offset:2048 sc1
    s_mov_b32 s45, 143360
    buffer_load_dwordx4 a[88:91], v114, s[20:23], s45 offen offset:3072 sc1
    s_mov_b32 s45, 143360
    buffer_load_dwordx4 a[92:95], v115, s[20:23], s45 offen offset:0 sc1
    s_waitcnt vmcnt(0)
    s_branch L_published
L_spin_rows:
    s_mov_b32 s7, 262144
L_retry_rows:
    s_sleep 4
    buffer_load_dword v252, off, s[92:95], s74 sc1
    s_waitcnt vmcnt(0)
    v_cmp_gt_u32 vcc, 32, v252
    s_and_b64 vcc, vcc, exec
    s_cbranch_scc0 L_back_rows
    s_sub_u32 s7, s7, 1
    s_cbranch_scc0 L_retry_rows
    s_branch L_back_rows
L_spin_all:
    s_mov_b32 s7, 262144
L_retry_all:
    s_sleep 4
    buffer_load_dword v252, v253, s[92:95], 0 offen sc1
    s_waitcnt vmcnt(0)
    v_cmp_gt_u32 vcc, 32, v252
    s_and_b64 vcc, vcc, exec
    s_cbranch_scc0 L_back_all
    s_sub_u32 s7, s7, 1
    s_cbranch_scc0 L_retry_all
    s_branch L_back_all
L_rt_keys:
    s_lshl_b32 s40, s5, 13
    s_add_u32 s40, s40, 0x280008
    v_lshlrev_b32 v253, 4, v19
    buffer_load_dword v28, v253, s[76:79], s40 offen offset:0 sc1
    buffer_load_dword v29, v253, s[76:79], s40 offen offset:1024 sc1
    buffer_load_dword v30, v253, s[76:79], s40 offen offset:2048 sc1
    buffer_load_dword v31, v253, s[76:79], s40 offen offset:3072 sc1
    s_add_u32 s40, s40, 4096
    buffer_load_dword v32, v253, s[76:79], s40 offen offset:0 sc1
    buffer_load_dword v33, v253, s[76:79], s40 offen offset:1024 sc1
    buffer_load_dword v34, v253, s[76:79], s40 offen offset:2048 sc1
    buffer_load_dword v35, v253, s[76:79], s40 offen offset:3072 sc1
    s_branch L_rt_back_keys
L_rt_local:
    s_waitcnt vmcnt(11)
    s_mov_b32 s42, -1
    v_sub_u32 v20, s42, v28
    v_sub_u32 v21, s42, v29
    v_sub_u32 v22, s42, v30
    v_min3_u32 v20, v20, v21, v22
    v_sub_u32 v21, s42, v31
    v_sub_u32 v22, s42, v32
    v_min3_u32 v20, v20, v21, v22
    v_sub_u32 v21, s42, v33
    v_sub_u32 v22, s42, v34
    v_min3_u32 v20, v20, v21, v22
    v_sub_u32 v21, s42, v35
    v_min_u32 v20, v20, v21
    s_nop 1
    v_min_u32_dpp v20, v20, v20 row_shr:1 row_mask:0xf bank_mask:0xf
    s_nop 1
    v_min_u32_dpp v20, v20, v20 row_shr:2 row_mask:0xf bank_mask:0xf
    s_nop 1
    v_min_u32_dpp v20, v20, v20 row_shr:4 row_mask:0xf bank_mask:0xf
    s_nop 1
    v_min_u32_dpp v20, v20, v20 row_shr:8 row_mask:0xf bank_mask:0xf
    s_nop 1
    v_min_u32_dpp v20, v20, v20 row_bcast:15 row_mask:0xa bank_mask:0xf
    s_nop 1
    v_min_u32_dpp v20, v20, v20 row_bcast:31 row_mask:0xc bank_mask:0xf
    s_nop 0
    v_readlane_b32 s50, v20, 63
    s_sub_u32 s50, s42, s50
    s_sub_u32 s42, s50, 1
    v_sub_u32 v20, s42, v28
    v_sub_u32 v21, s42, v29
    v_sub_u32 v22, s42, v30
    v_min3_u32 v20, v20, v21, v22
    v_sub_u32 v21, s42, v31
    v_sub_u32 v22, s42, v32
    v_min3_u32 v20, v20, v21, v22
    v_sub_u32 v21, s42, v33
    v_sub_u32 v22, s42, v34
    v_min3_u32 v20, v20, v21, v22
    v_sub_u32 v21, s42, v35
    v_min_u32 v20, v20, v21
    s_nop 1
    v_min_u32_dpp v20, v20, v20 row_shr:1 row_mask:0xf bank_mask:0xf
    s_nop 1
    v_min_u32_dpp v20, v20, v20 row_shr:2 row_mask:0xf bank_mask:0xf
    s_nop 1
    v_min_u32_dpp v20, v20, v20 row_shr:4 row_mask:0xf bank_mask:0xf
    s_nop 1
    v_min_u32_dpp v20, v20, v20 row_shr:8 row_mask:0xf bank_mask:0xf
    s_nop 1
    v_min_u32_dpp v20, v20, v20 row_bcast:15 row_mask:0xa bank_mask:0xf
    s_nop 1
    v_min_u32_dpp v20, v20, v20 row_bcast:31 row_mask:0xc bank_mask:0xf
    s_nop 0
    v_readlane_b32 s51, v20, 63
    s_sub_u32 s51, s42, s51
    s_sub_u32 s42, s51, 1
    v_sub_u32 v20, s42, v28
    v_sub_u32 v21, s42, v29
    v_sub_u32 v22, s42, v30
    v_min3_u32 v20, v20, v21, v22
    v_sub_u32 v21, s42, v31
    v_sub_u32 v22, s42, v32
    v_min3_u32 v20, v20, v21, v22
    v_sub_u32 v21, s42, v33
    v_sub_u32 v22, s42, v34
    v_min3_u32 v20, v20, v21, v22
    v_sub_u32 v21, s42, v35
    v_min_u32 v20, v20, v21
    s_nop 1
    v_min_u32_dpp v20, v20, v20 row_shr:1 row_mask:0xf bank_mask:0xf
    s_nop 1
    v_min_u32_dpp v20, v20, v20 row_shr:2 row_mask:0xf bank_mask:0xf
    s_nop 1
    v_min_u32_dpp v20, v20, v20 row_shr:4 row_mask:0xf bank_mask:0xf
    s_nop 1
    v_min_u32_dpp v20, v20, v20 row_shr:8 row_mask:0xf bank_mask:0xf
    s_nop 1
    v_min_u32_dpp v20, v20, v20 row_bcast:15 row_mask:0xa bank_mask:0xf
    s_nop 1
    v_min_u32_dpp v20, v20, v20 row_bcast:31 row_mask:0xc bank_mask:0xf
    s_nop 0
    v_readlane_b32 s52, v20, 63
    s_sub_u32 s52, s42, s52
    s_sub_u32 s42, s52, 1
    v_sub_u32 v20, s42, v28
    v_sub_u32 v21, s42, v29
    v_sub_u32 v22, s42, v30
    v_min3_u32 v20, v20, v21, v22
    v_sub_u32 v21, s42, v31
    v_sub_u32 v22, s42, v32
    v_min3_u32 v20, v20, v21, v22
    v_sub_u32 v21, s42, v33
    v_sub_u32 v22, s42, v34
    v_min3_u32 v20, v20, v21, v22
    v_sub_u32 v21, s42, v35
    v_min_u32 v20, v20, v21
    s_nop 1
    v_min_u32_dpp v20, v20, v20 row_shr:1 row_mask:0xf bank_mask:0xf
    s_nop 1
    v_min_u32_dpp v20, v20, v20 row_shr:2 row_mask:0xf bank_mask:0xf
    s_nop 1
    v_min_u32_dpp v20, v20, v20 row_shr:4 row_mask:0xf bank_mask:0xf
    s_nop 1
    v_min_u32_dpp v20, v20, v20 row_shr:8 row_mask:0xf bank_mask:0xf
    s_nop 1
    v_min_u32_dpp v20, v20, v20 row_bcast:15 row_mask:0xa bank_mask:0xf
    s_nop 1
    v_min_u32_dpp v20, v20, v20 row_bcast:31 row_mask:0xc bank_mask:0xf
    s_nop 0
    v_readlane_b32 s53, v20, 63
    s_sub_u32 s53, s42, s53
    s_sub_u32 s42, s53, 1
    v_sub_u32 v20, s42, v28
    v_sub_u32 v21, s42, v29
    v_sub_u32 v22, s42, v30
    v_min3_u32 v20, v20, v21, v22
    v_sub_u32 v21, s42, v31
    v_sub_u32 v22, s42, v32
    v_min3_u32 v20, v20, v21, v22
    v_sub_u32 v21, s42, v33
    v_sub_u32 v22, s42, v34
    v_min3_u32 v20, v20, v21, v22
    v_sub_u32 v21, s42, v35
    v_min_u32 v20, v20, v21
    s_nop 1
    v_min_u32_dpp v20, v20, v20 row_shr:1 row_mask:0xf bank_mask:0xf
    s_nop 1
    v_min_u32_dpp v20, v20, v20 row_shr:2 row_mask:0xf bank_mask:0xf
    s_nop 1
    v_min_u32_dpp v20, v20, v20 row_shr:4 row_mask:0xf bank_mask:0xf
    s_nop 1
    v_min_u32_dpp v20, v20, v20 row_shr:8 row_mask:0xf bank_mask:0xf
    s_nop 1
    v_min_u32_dpp v20, v20, v20 row_bcast:15 row_mask:0xa bank_mask:0xf
    s_nop 1
    v_min_u32_dpp v20, v20, v20 row_bcast:31 row_mask:0xc bank_mask:0xf
    s_nop 0
    v_readlane_b32 s54, v20, 63
    s_sub_u32 s54, s42, s54
    s_sub_u32 s42, s54, 1
    v_sub_u32 v20, s42, v28
    v_sub_u32 v21, s42, v29
    v_sub_u32 v22, s42, v30
    v_min3_u32 v20, v20, v21, v22
    v_sub_u32 v21, s42, v31
    v_sub_u32 v22, s42, v32
    v_min3_u32 v20, v20, v21, v22
    v_sub_u32 v21, s42, v33
    v_sub_u32 v22, s42, v34
    v_min3_u32 v20, v20, v21, v22
    v_sub_u32 v21, s42, v35
    v_min_u32 v20, v20, v21
    s_nop 1
    v_min_u32_dpp v20, v20, v20 row_shr:1 row_mask:0xf bank_mask:0xf
    s_nop 1
    v_min_u32_dpp v20, v20, v20 row_shr:2 row_mask:0xf bank_mask:0xf
    s_nop 1
    v_min_u32_dpp v20, v20, v20 row_shr:4 row_mask:0xf bank_mask:0xf
    s_nop 1
    v_min_u32_dpp v20, v20, v20 row_shr:8 row_mask:0xf bank_mask:0xf
    s_nop 1
    v_min_u32_dpp v20, v20, v20 row_bcast:15 row_mask:0xa bank_mask:0xf
    s_nop 1
    v_min_u32_dpp v20, v20, v20 row_bcast:31 row_mask:0xc bank_mask:0xf
    s_nop 0
    v_readlane_b32 s55, v20, 63
    s_sub_u32 s55, s42, s55
    s_sub_u32 s42, s55, 1
    v_sub_u32 v20, s42, v28
    v_sub_u32 v21, s42, v29
    v_sub_u32 v22, s42, v30
    v_min3_u32 v20, v20, v21, v22
    v_sub_u32 v21, s42, v31
    v_sub_u32 v22, s42, v32
    v_min3_u32 v20, v20, v21, v22
    v_sub_u32 v21, s42, v33
    v_sub_u32 v22, s42, v34
    v_min3_u32 v20, v20, v21, v22
    v_sub_u32 v21, s42, v35
    v_min_u32 v20, v20, v21
    s_nop 1
    v_min_u32_dpp v20, v20, v20 row_shr:1 row_mask:0xf bank_mask:0xf
    s_nop 1
    v_min_u32_dpp v20, v20, v20 row_shr:2 row_mask:0xf bank_mask:0xf
    s_nop 1
    v_min_u32_dpp v20, v20, v20 row_shr:4 row_mask:0xf bank_mask:0xf
    s_nop 1
    v_min_u32_dpp v20, v20, v20 row_shr:8 row_mask:0xf bank_mask:0xf
    s_nop 1
    v_min_u32_dpp v20, v20, v20 row_bcast:15 row_mask:0xa bank_mask:0xf
    s_nop 1
    v_min_u32_dpp v20, v20, v20 row_bcast:31 row_mask:0xc bank_mask:0xf
    s_nop 0
    v_readlane_b32 s56, v20, 63
    s_sub_u32 s56, s42, s56
    s_sub_u32 s42, s56, 1
    v_sub_u32 v20, s42, v28
    v_sub_u32 v21, s42, v29
    v_sub_u32 v22, s42, v30
    v_min3_u32 v20, v20, v21, v22
    v_sub_u32 v21, s42, v31
    v_sub_u32 v22, s42, v32
    v_min3_u32 v20, v20, v21, v22
    v_sub_u32 v21, s42, v33
    v_sub_u32 v22, s42, v34
    v_min3_u32 v20, v20, v21, v22
    v_sub_u32 v21, s42, v35
    v_min_u32 v20, v20, v21
    s_nop 1
    v_min_u32_dpp v20, v20, v20 row_shr:1 row_mask:0xf bank_mask:0xf
    s_nop 1
    v_min_u32_dpp v20, v20, v20 row_shr:2 row_mask:0xf bank_mask:0xf
    s_nop 1
    v_min_u32_dpp v20, v20, v20 row_shr:4 row_mask:0xf bank_mask:0xf
    s_nop 1
    v_min_u32_dpp v20, v20, v20 row_shr:8 row_mask:0xf bank_mask:0xf
    s_nop 1
    v_min_u32_dpp v20, v20, v20 row_bcast:15 row_mask:0xa bank_mask:0xf
    s_nop 1
    v_min_u32_dpp v20, v20, v20 row_bcast:31 row_mask:0xc bank_mask:0xf
    s_nop 0
    v_readlane_b32 s57, v20, 63
    s_sub_u32 s57, s42, s57
    s_sub_u32 s42, s57, 1
    v_mov_b32 v20, s50
    v_writelane_b32 v20, s51, 1
    v_writelane_b32 v20, s52, 2
    v_writelane_b32 v20, s53, 3
    v_writelane_b32 v20, s54, 4
    v_writelane_b32 v20, s55, 5
    v_writelane_b32 v20, s56, 6
    v_writelane_b32 v20, s57, 7
    s_lshl_b32 s42, s5, 8
    s_add_u32 s42, s42, 86016
    v_lshl_add_u32 v21, v19, 2, s42
    ds_write_b32 v21, v20
    s_waitcnt lgkmcnt(0)
    s_branch L_rt_back_local
L_rt_merge:
    v_bfe_u32 v21, v19, 3, 2
    v_lshlrev_b32 v21, 8, v21
    v_and_b32 v20, 7, v19
    v_lshl_add_u32 v21, v20, 2, v21
    v_add_u32 v21, 86016, v21
    ds_read_b32 v20, v21
    s_waitcnt lgkmcnt(0)
    s_mov_b32 s42, -1
    v_sub_u32 v21, s42, v20
    s_nop 1
    v_min_u32_dpp v21, v21, v21 row_shr:1 row_mask:0xf bank_mask:0xf
    s_nop 1
    v_min_u32_dpp v21, v21, v21 row_shr:2 row_mask:0xf bank_mask:0xf
    s_nop 1
    v_min_u32_dpp v21, v21, v21 row_shr:4 row_mask:0xf bank_mask:0xf
    s_nop 1
    v_min_u32_dpp v21, v21, v21 row_shr:8 row_mask:0xf bank_mask:0xf
    s_nop 1
    v_min_u32_dpp v21, v21, v21 row_bcast:15 row_mask:0xa bank_mask:0xf
    s_nop 1
    v_min_u32_dpp v21, v21, v21 row_bcast:31 row_mask:0xc bank_mask:0xf
    s_nop 0
    v_readlane_b32 s50, v21, 63
    s_sub_u32 s50, s42, s50
    s_sub_u32 s42, s50, 1
    v_sub_u32 v21, s42, v20
    s_nop 1
    v_min_u32_dpp v21, v21, v21 row_shr:1 row_mask:0xf bank_mask:0xf
    s_nop 1
    v_min_u32_dpp v21, v21, v21 row_shr:2 row_mask:0xf bank_mask:0xf
    s_nop 1
    v_min_u32_dpp v21, v21, v21 row_shr:4 row_mask:0xf bank_mask:0xf
    s_nop 1
    v_min_u32_dpp v21, v21, v21 row_shr:8 row_mask:0xf bank_mask:0xf
    s_nop 1
    v_min_u32_dpp v21, v21, v21 row_bcast:15 row_mask:0xa bank_mask:0xf
    s_nop 1
    v_min_u32_dpp v21, v21, v21 row_bcast:31 row_mask:0xc bank_mask:0xf
    s_nop 0
    v_readlane_b32 s51, v21, 63
    s_sub_u32 s51, s42, s51
    s_sub_u32 s42, s51, 1
    v_sub_u32 v21, s42, v20
    s_nop 1
    v_min_u32_dpp v21, v21, v21 row_shr:1 row_mask:0xf bank_mask:0xf
    s_nop 1
    v_min_u32_dpp v21, v21, v21 row_shr:2 row_mask:0xf bank_mask:0xf
    s_nop 1
    v_min_u32_dpp v21, v21, v21 row_shr:4 row_mask:0xf bank_mask:0xf
    s_nop 1
    v_min_u32_dpp v21, v21, v21 row_shr:8 row_mask:0xf bank_mask:0xf
    s_nop 1
    v_min_u32_dpp v21, v21, v21 row_bcast:15 row_mask:0xa bank_mask:0xf
    s_nop 1
    v_min_u32_dpp v21, v21, v21 row_bcast:31 row_mask:0xc bank_mask:0xf
    s_nop 0
    v_readlane_b32 s52, v21, 63
    s_sub_u32 s52, s42, s52
    s_sub_u32 s42, s52, 1
    v_sub_u32 v21, s42, v20
    s_nop 1
    v_min_u32_dpp v21, v21, v21 row_shr:1 row_mask:0xf bank_mask:0xf
    s_nop 1
    v_min_u32_dpp v21, v21, v21 row_shr:2 row_mask:0xf bank_mask:0xf
    s_nop 1
    v_min_u32_dpp v21, v21, v21 row_shr:4 row_mask:0xf bank_mask:0xf
    s_nop 1
    v_min_u32_dpp v21, v21, v21 row_shr:8 row_mask:0xf bank_mask:0xf
    s_nop 1
    v_min_u32_dpp v21, v21, v21 row_bcast:15 row_mask:0xa bank_mask:0xf
    s_nop 1
    v_min_u32_dpp v21, v21, v21 row_bcast:31 row_mask:0xc bank_mask:0xf
    s_nop 0
    v_readlane_b32 s53, v21, 63
    s_sub_u32 s53, s42, s53
    s_sub_u32 s42, s53, 1
    v_sub_u32 v21, s42, v20
    s_nop 1
    v_min_u32_dpp v21, v21, v21 row_shr:1 row_mask:0xf bank_mask:0xf
    s_nop 1
    v_min_u32_dpp v21, v21, v21 row_shr:2 row_mask:0xf bank_mask:0xf
    s_nop 1
    v_min_u32_dpp v21, v21, v21 row_shr:4 row_mask:0xf bank_mask:0xf
    s_nop 1
    v_min_u32_dpp v21, v21, v21 row_shr:8 row_mask:0xf bank_mask:0xf
    s_nop 1
    v_min_u32_dpp v21, v21, v21 row_bcast:15 row_mask:0xa bank_mask:0xf
    s_nop 1
    v_min_u32_dpp v21, v21, v21 row_bcast:31 row_mask:0xc bank_mask:0xf
    s_nop 0
    v_readlane_b32 s54, v21, 63
    s_sub_u32 s54, s42, s54
    s_sub_u32 s42, s54, 1
    v_sub_u32 v21, s42, v20
    s_nop 1
    v_min_u32_dpp v21, v21, v21 row_shr:1 row_mask:0xf bank_mask:0xf
    s_nop 1
    v_min_u32_dpp v21, v21, v21 row_shr:2 row_mask:0xf bank_mask:0xf
    s_nop 1
    v_min_u32_dpp v21, v21, v21 row_shr:4 row_mask:0xf bank_mask:0xf
    s_nop 1
    v_min_u32_dpp v21, v21, v21 row_shr:8 row_mask:0xf bank_mask:0xf
    s_nop 1
    v_min_u32_dpp v21, v21, v21 row_bcast:15 row_mask:0xa bank_mask:0xf
    s_nop 1
    v_min_u32_dpp v21, v21, v21 row_bcast:31 row_mask:0xc bank_mask:0xf
    s_nop 0
    v_readlane_b32 s55, v21, 63
    s_sub_u32 s55, s42, s55
    s_sub_u32 s42, s55, 1
    v_sub_u32 v21, s42, v20
    s_nop 1
    v_min_u32_dpp v21, v21, v21 row_shr:1 row_mask:0xf bank_mask:0xf
    s_nop 1
    v_min_u32_dpp v21, v21, v21 row_shr:2 row_mask:0xf bank_mask:0xf
    s_nop 1
    v_min_u32_dpp v21, v21, v21 row_shr:4 row_mask:0xf bank_mask:0xf
    s_nop 1
    v_min_u32_dpp v21, v21, v21 row_shr:8 row_mask:0xf bank_mask:0xf
    s_nop 1
    v_min_u32_dpp v21, v21, v21 row_bcast:15 row_mask:0xa bank_mask:0xf
    s_nop 1
    v_min_u32_dpp v21, v21, v21 row_bcast:31 row_mask:0xc bank_mask:0xf
    s_nop 0
    v_readlane_b32 s56, v21, 63
    s_sub_u32 s56, s42, s56
    s_sub_u32 s42, s56, 1
    v_sub_u32 v21, s42, v20
    s_nop 1
    v_min_u32_dpp v21, v21, v21 row_shr:1 row_mask:0xf bank_mask:0xf
    s_nop 1
    v_min_u32_dpp v21, v21, v21 row_shr:2 row_mask:0xf bank_mask:0xf
    s_nop 1
    v_min_u32_dpp v21, v21, v21 row_shr:4 row_mask:0xf bank_mask:0xf
    s_nop 1
    v_min_u32_dpp v21, v21, v21 row_shr:8 row_mask:0xf bank_mask:0xf
    s_nop 1
    v_min_u32_dpp v21, v21, v21 row_bcast:15 row_mask:0xa bank_mask:0xf
    s_nop 1
    v_min_u32_dpp v21, v21, v21 row_bcast:31 row_mask:0xc bank_mask:0xf
    s_nop 0
    v_readlane_b32 s57, v21, 63
    s_sub_u32 s57, s42, s57
    s_sub_u32 s42, s57, 1
    v_mov_b32 v20, s50
    v_writelane_b32 v20, s51, 1
    v_writelane_b32 v20, s52, 2
    v_writelane_b32 v20, s53, 3
    v_writelane_b32 v20, s54, 4
    v_writelane_b32 v20, s55, 5
    v_writelane_b32 v20, s56, 6
    v_writelane_b32 v20, s57, 7
    v_lshlrev_b32 v21, 2, v19
    s_mov_b32 s42, 0x29b000
    s_mov_b64 exec, 0xff
    buffer_store_dword v20, v21, s[76:79], s42 offen sc1
    s_mov_b64 exec, -1
    s_branch L_rt_back_merge
L_site0:
    s_mov_b32 s43, m0
    s_mov_b32 m0, s38
    s_add_u32 s38, s38, 1024
    buffer_load_dwordx4 v24, s[16:19], s37 offen lds
    s_mov_b32 m0, s43
    s_add_u32 s37, s37, 221184
    s_branch L_site_back0
L_site1:
    s_mov_b32 s43, m0
    s_mov_b32 m0, s38
    s_add_u32 s38, s38, 1024
    buffer_load_dwordx4 v24, s[16:19], s37 offen lds
    s_mov_b32 m0, s43
    s_add_u32 s37, s37, 221184
    s_branch L_site_back1
L_site2:
    s_mov_b32 s43, m0
    s_mov_b32 m0, s38
    s_add_u32 s38, s38, 1024
    buffer_load_dwordx4 v24, s[16:19], s37 offen lds
    s_mov_b32 m0, s43
    s_add_u32 s37, s37, 221184
    s_branch L_site_back2
L_site3:
    s_mov_b32 s43, m0
    s_mov_b32 m0, s38
    s_add_u32 s38, s38, 1024
    buffer_load_dwordx4 v24, s[16:19], s37 offen lds
    s_mov_b32 m0, s43
    s_add_u32 s37, s37, 221184
    s_branch L_site_back3
L_spin_sel:
    s_mov_b32 s7, 262144
L_retry_sel:
    s_sleep 4
    buffer_load_dword v249, v21, s[76:79], 0 offen sc1
    s_waitcnt vmcnt(0)
    v_cmp_eq_u32 vcc, 0, v249
    s_and_b64 vcc, vcc, exec
    s_cbranch_scc0 L_back_sel
    s_sub_u32 s7, s7, 1
    s_cbranch_scc0 L_retry_sel
    s_branch L_back_sel
L_spin_ffn:
    s_mov_b32 s7, 262144
L_retry_ffn:
    s_sleep 4
    buffer_load_dwordx4 v[28:31], v32, s[76:79], 0 offen sc1
    s_waitcnt vmcnt(0)
    v_min3_u32 v28, v28, v29, v30
    v_min_u32 v28, v28, v31
    v_cmp_gt_u32 vcc, 1, v28
    s_and_b64 vcc, vcc, exec
    s_cbranch_scc0 L_back_ffn
    s_sub_u32 s7, s7, 1
    s_cbranch_scc0 L_retry_ffn
    s_branch L_back_ffn
L_spin_upd:
    s_mov_b32 s7, 262144
L_retry_upd:
    s_sleep 4
    buffer_load_dwordx2 v[20:21], v11, s[76:79], 0 offen offset:0 sc1
    buffer_load_dwordx2 v[246:247], v11, s[76:79], 0 offen offset:32 sc1
    buffer_load_dwordx2 v[248:249], v11, s[76:79], 0 offen offset:64 sc1
    buffer_load_dwordx2 v[252:253], v11, s[76:79], 0 offen offset:96 sc1
    buffer_load_dwordx2 v[254:255], v11, s[76:79], 0 offen offset:128 sc1
    s_waitcnt vmcnt(0)
    v_max3_u32 v3, v20, v21, v246
    v_max3_u32 v3, v3, v247, v248
    v_max3_u32 v3, v3, v249, v252
    v_max3_u32 v3, v3, v253, v254
    v_max_u32 v3, v3, v255
    v_cmp_eq_u32 vcc, -1, v3
    s_and_b64 vcc, vcc, exec
    s_cbranch_scc0 L_back_upd
    s_sub_u32 s7, s7, 1
    s_cbranch_scc0 L_retry_upd
    s_branch L_back_upd
L_spin_o:
    s_mov_b32 s7, 262144
L_retry_o:
    s_sleep 4
    buffer_load_dwordx4 v[126:129], v1, s[76:79], 0 offen sc1
    s_waitcnt vmcnt(0)
    v_min3_u32 v126, v126, v127, v128
    v_min_u32 v126, v126, v129
    v_cmp_gt_u32 vcc, 1, v126
    s_and_b64 vcc, vcc, exec
    s_cbranch_scc0 L_back_o
    s_sub_u32 s7, s7, 1
    s_cbranch_scc0 L_retry_o
    s_branch L_back_o
L_spin_half:
    s_mov_b32 s7, 262144
L_retry_half:
    s_sleep 4
    buffer_load_dword v1, off, s[76:79], s37 sc1
    s_waitcnt vmcnt(0)
    v_cmp_ne_u32 vcc, 3, v1
    s_and_b64 vcc, vcc, exec
    s_cbranch_scc0 L_back_half
    s_sub_u32 s7, s7, 1
    s_cbranch_scc0 L_retry_half
    s_branch L_back_half
L_code_end:
    s_endpgm

.section .rodata,"a"
.p2align 6
.amdhsa_kernel recurrent_scan__mha_block_cached__moe_arch_mod__prompt_kernel
  .amdhsa_next_free_vgpr 512
  .amdhsa_next_free_sgpr 102
  .amdhsa_accum_offset 256
  .amdhsa_group_segment_fixed_size 0
  .amdhsa_kernarg_size 104
  .amdhsa_user_sgpr_count 2
  .amdhsa_user_sgpr_kernarg_segment_ptr 1
  .amdhsa_system_sgpr_workgroup_id_x 1
  .amdhsa_float_denorm_mode_32 3
.end_amdhsa_kernel
```

```asm
; @launch grid=(256,1,1) block=(256,1,1) lds=163840
.amdgcn_target "amdgcn-amd-amdhsa--gfx950"
.text
.globl recurrent_scan__mha_block_cached__moe_arch_mod__prompt_kernel
.p2align 8
.type recurrent_scan__mha_block_cached__moe_arch_mod__prompt_kernel,@function
recurrent_scan__mha_block_cached__moe_arch_mod__prompt_kernel:
    s_cmp_ge_u32 s2, 256
    s_cbranch_scc1 L_end
    s_load_dwordx16 s[48:63], s[0:1], 0
    s_load_dwordx8 s[64:71], s[0:1], 64
    s_load_dwordx2 s[72:73], s[0:1], 96
    s_getpc_b64 s[40:41]
L_touch:
    s_bfe_u32 s42, s2, 0x20003
    s_lshl_b32 s42, s42, 8
    v_add_u32 v252, s42, v0
    v_min_u32 v252, (L_code_end - L_touch) / 128, v252
    v_lshlrev_b32 v252, 7, v252
    global_load_dword a120, v252, s[40:41]
    v_lshrrev_b32 v116, 6, v0
    v_and_b32 v19, 63, v0
    s_and_b32 s40, s2, 7
    v_readfirstlane_b32 s5, v116
    s_lshl_b32 s40, s40, 2
    s_bfe_u32 s41, s2, 0x20003
    s_add_u32 s3, s40, s41
    s_lshr_b32 s4, s2, 5
    s_lshl_b32 s74, s4, 5
    s_add_u32 s6, s74, s3
    v_lshrrev_b32 v118, 4, v19
    v_and_b32 v117, 15, v19
    v_lshlrev_b32 v119, 1, v118
    v_xor_b32 v119, v117, v119
    s_lshl_b32 s42, s5, 4
    v_add_u32 v120, s42, v118
    v_lshlrev_b32 v121, 4, v119
    v_xor_b32 v122, 0x80, v121
    v_lshl_add_u32 v123, v120, 13, v121
    v_lshl_add_u32 v116, v120, 13, v122
    v_add_u32 v44, 0, v123
    v_add_u32 v45, 31744, v123
    v_add_u32 v46, 63488, v116
    v_add_u32 v47, 95232, v116
    v_lshl_add_u32 v17, v120, 8, v121
    v_lshl_add_u32 v18, v120, 8, v122
    v_xor_b32 v117, v117, v118
    v_xor_b32 v121, 0, v117
    v_lshlrev_b32 v121, 4, v121
    v_lshl_add_u32 v13, v120, 8, v121
    v_xor_b32 v121, 4, v117
    v_lshlrev_b32 v121, 4, v121
    v_lshl_add_u32 v14, v120, 8, v121
    v_xor_b32 v121, 8, v117
    v_lshlrev_b32 v121, 4, v121
    v_lshl_add_u32 v15, v120, 8, v121
    v_xor_b32 v121, 12, v117
    v_lshlrev_b32 v121, 4, v121
    v_lshl_add_u32 v16, v120, 8, v121
    v_lshrrev_b32 v116, 3, v19
    v_and_b32 v117, 7, v19
    v_xor_b32 v117, v117, v118
    v_mul_u32_u24 v116, 1280, v116
    s_mul_i32 s42, s5, 81920
    v_lshl_add_u32 v119, v117, 4, v116
    v_xor_b32 v117, 4, v117
    v_lshl_add_u32 v120, v117, 4, v116
    v_add_u32 v119, s42, v119
    v_add_u32 v120, s42, v120
    v_add_u32 v36, 0, v119
    v_add_u32 v37, 9216, v120
    v_add_u32 v38, 18432, v119
    v_add_u32 v39, 27648, v120
    v_add_u32 v40, 40960, v119
    v_add_u32 v41, 50176, v120
    v_add_u32 v42, 59392, v119
    v_add_u32 v43, 68608, v120
    s_lshl_b32 s43, s6, 2
    s_add_u32 s43, s43, s5
    s_lshl_b32 s43, s43, 1
    s_mul_i32 s38, s5, 24576
    s_lshl_b32 s40, s5, 12
    s_add_u32 s39, s40, 98304
    s_mov_b32 s34, s39
    s_mov_b32 s28, 0
    s_mov_b32 s29, 0
    s_and_b32 s40, s3, 31
    s_mul_i32 s40, s40, 10
    s_lshr_b32 s40, s40, 5
    s_lshl_b32 s36, s40, 7
    s_waitcnt lgkmcnt(0)
    s_mov_b32 s88, s48
    s_mov_b32 s89, s49
    s_mov_b32 s90, 0x280000
    s_mov_b32 s91, 0x20000
    s_mov_b32 s92, s60
    s_mov_b32 s93, s61
    s_mov_b32 s94, 0x500
    s_mov_b32 s95, 0x20000
    s_lshl_b32 s40, s3, 8
    s_add_u32 s20, s54, s40
    s_addc_u32 s21, s55, 0
    s_mov_b32 s22, 0x4fe100
    s_mov_b32 s23, 0x20000
    s_mul_i32 s40, s4, 327680
    s_add_u32 s16, s48, s40
    s_addc_u32 s17, s49, 0
    s_mov_b32 s18, 0x50000
    s_mov_b32 s19, 0x20000
    s_add_u32 m0, s39, 0
    s_mov_b32 s37, 0
    buffer_load_dwordx4 v44, s[20:23], s37 offen offset:0 lds
    buffer_load_dwordx4 v45, s[20:23], s37 offen offset:1024 lds
    buffer_load_dwordx4 v46, s[20:23], s37 offen offset:2048 lds
    buffer_load_dwordx4 v47, s[20:23], s37 offen offset:3072 lds
    s_add_u32 m0, s38, 0
    s_mov_b32 s36, 0
    buffer_load_dwordx4 v36, s[16:19], s36 offen offset:0 lds
    buffer_load_dwordx4 v37, s[16:19], s36 offen offset:1024 lds
    buffer_load_dwordx4 v38, s[16:19], s36 offen offset:2048 lds
    buffer_load_dwordx4 v39, s[16:19], s36 offen offset:3072 lds
    s_add_u32 m0, s38, 4096
    s_nop 0
    buffer_load_dwordx4 v40, s[16:19], s36 offen offset:0 lds
    buffer_load_dwordx4 v41, s[16:19], s36 offen offset:1024 lds
    buffer_load_dwordx4 v42, s[16:19], s36 offen offset:2048 lds
    buffer_load_dwordx4 v43, s[16:19], s36 offen offset:3072 lds
    v_lshrrev_b32 v108, 5, v19
    v_add_u32 v108, s43, v108
    v_and_b32 v110, 31, v19
    v_lshlrev_b32 v110, 3, v110
    v_mul_u32_u24 v109, 1280, v108
    v_add_u32 v109, v109, v110
    buffer_load_dwordx2 v[60:61], v109, s[88:91], 0 offen offset:0
    buffer_load_dwordx2 v[62:63], v109, s[88:91], 0 offen offset:256
    buffer_load_dwordx2 v[64:65], v109, s[88:91], 0 offen offset:512
    buffer_load_dwordx2 v[66:67], v109, s[88:91], 0 offen offset:768
    buffer_load_dwordx2 v[68:69], v109, s[88:91], 0 offen offset:1024
    buffer_load_dwordx2 v[70:71], v110, s[92:95], 0 offen offset:0
    buffer_load_dwordx2 v[72:73], v110, s[92:95], 0 offen offset:256
    buffer_load_dwordx2 v[74:75], v110, s[92:95], 0 offen offset:512
    buffer_load_dwordx2 v[76:77], v110, s[92:95], 0 offen offset:768
    buffer_load_dwordx2 v[78:79], v110, s[92:95], 0 offen offset:1024
    s_lshl_b32 s40, s3, 19
    s_add_u32 s8, s50, s40
    s_addc_u32 s9, s51, 0
    s_mov_b32 s10, 0x80000
    s_mov_b32 s11, 0x20000
    s_add_u32 s12, s52, s40
    s_addc_u32 s13, s53, 0
    s_mov_b32 s14, 0x80000
    s_mov_b32 s15, 0x20000
    s_and_b32 s40, s5, 1
    s_lshl_b32 s40, s40, 12
    s_cmp_ge_u32 s5, 2
    s_cselect_b32 s30, 32, 8
    s_cselect_b32 s31, 40, 16
    s_cselect_b32 s32, 0, 56
    s_cselect_b32 s33, 48, 24
    s_lshl_b32 s30, s30, 10
    s_add_u32 s30, s30, s40
    s_lshl_b32 s31, s31, 10
    s_add_u32 s31, s31, s40
    s_lshl_b32 s32, s32, 10
    s_add_u32 s32, s32, s40
    s_lshl_b32 s33, s33, 10
    s_add_u32 s33, s33, s40
    s_mov_b32 s44, 0x3e0293ee
    s_mov_b32 s45, 4096
    s_mov_b32 s76, s72
    s_mov_b32 s77, s73
    s_mov_b32 s78, 0x2500000
    s_mov_b32 s79, 0x20000
    s_mov_b32 s92, s70
    s_mov_b32 s93, s71
    s_mov_b32 s94, 0x100
    s_mov_b32 s95, 0x20000
    s_lshl_b32 s41, s4, 2
    s_add_u32 s41, s41, s5
    s_lshl_b32 s40, s41, 5
    s_add_u32 s40, s40, s3
    s_lshl_b32 s40, s40, 14
    s_add_u32 s40, s40, 0x400000
    s_add_u32 s24, s72, s40
    s_addc_u32 s25, s73, 0
    s_mov_b32 s26, 0x4000
    s_mov_b32 s27, 0x20000
    s_and_b32 s42, s3, 3
    s_lshl_b32 s42, s42, 2
    s_lshr_b32 s40, s6, 2
    s_lshl_b32 s40, s40, 7
    s_add_u32 s40, s40, s42
    s_add_u32 s75, s40, 0x290000
    s_lshr_b32 s40, s3, 2
    s_lshl_b32 s40, s40, 7
    s_add_u32 s40, s40, s42
    s_lshl_b32 s42, s41, 10
    s_add_u32 s40, s40, s42
    s_add_u32 s58, s40, 0x292000
    s_lshl_b32 s41, s41, 10
    s_add_u32 s46, s41, 0x280000
    v_lshrrev_b32 v116, 4, v19
    v_and_b32 v117, 15, v19
    v_lshlrev_b32 v59, 4, v117
    v_xor_b32 v118, v116, v117
    v_lshlrev_b32 v119, 8, v117
    v_add_u32 v119, 98304, v119
    s_add_u32 s41, s5, 0
    s_and_b32 s41, s41, 3
    s_lshl_b32 s41, s41, 2
    v_xor_b32 v120, s41, v118
    v_lshl_add_u32 v1, v120, 4, v119
    s_add_u32 s41, s5, 1
    s_and_b32 s41, s41, 3
    s_lshl_b32 s41, s41, 2
    v_xor_b32 v120, s41, v118
    v_lshl_add_u32 v2, v120, 4, v119
    s_add_u32 s41, s5, 2
    s_and_b32 s41, s41, 3
    s_lshl_b32 s41, s41, 2
    v_xor_b32 v120, s41, v118
    v_lshl_add_u32 v3, v120, 4, v119
    s_add_u32 s41, s5, 3
    s_and_b32 s41, s41, 3
    s_lshl_b32 s41, s41, 2
    v_xor_b32 v120, s41, v118
    v_lshl_add_u32 v4, v120, 4, v119
    v_lshrrev_b32 v118, 1, v117
    v_xor_b32 v118, v116, v118
    v_lshlrev_b32 v119, 7, v117
    v_add_u32 v119, s38, v119
    v_xor_b32 v120, 0, v118
    v_lshl_add_u32 v48, v120, 4, v119
    v_xor_b32 v120, 4, v118
    v_lshl_add_u32 v49, v120, 4, v119
    v_bfe_u32 v118, v19, 2, 2
    v_bfe_u32 v119, v19, 2, 3
    v_and_b32 v120, 3, v19
    v_lshlrev_b32 v120, 3, v120
    v_lshl_add_u32 v121, v116, 2, v118
    v_lshl_add_u32 v121, v121, 8, v120
    v_lshl_add_u32 v122, v116, 3, v118
    v_lshl_add_u32 v122, v122, 8, v120
    v_add_u32 v122, 98304, v122
    v_xor_b32 v123, 0, v119
    v_lshl_add_u32 v5, v123, 5, v121
    v_xor_b32 v123, 1, v119
    v_lshl_add_u32 v6, v123, 5, v121
    v_xor_b32 v123, 2, v119
    v_lshl_add_u32 v7, v123, 5, v121
    v_xor_b32 v123, 3, v119
    v_lshl_add_u32 v8, v123, 5, v121
    v_xor_b32 v123, 4, v119
    v_lshl_add_u32 v9, v123, 5, v121
    v_xor_b32 v123, 5, v119
    v_lshl_add_u32 v10, v123, 5, v121
    v_xor_b32 v123, 6, v119
    v_lshl_add_u32 v11, v123, 5, v121
    v_xor_b32 v123, 7, v119
    v_lshl_add_u32 v12, v123, 5, v121
    s_lshl_b32 s42, s5, 1
    s_add_u32 s41, s42, 0
    s_and_b32 s41, s41, 7
    v_xor_b32 v123, s41, v119
    v_lshl_add_u32 v50, v123, 5, v122
    s_add_u32 s41, s42, 1
    s_and_b32 s41, s41, 7
    v_xor_b32 v123, s41, v119
    v_lshl_add_u32 v51, v123, 5, v122
    s_add_u32 s41, s42, 2
    s_and_b32 s41, s41, 7
    v_xor_b32 v123, s41, v119
    v_lshl_add_u32 v52, v123, 5, v122
    s_add_u32 s41, s42, 3
    s_and_b32 s41, s41, 7
    v_xor_b32 v123, s41, v119
    v_lshl_add_u32 v53, v123, 5, v122
    s_add_u32 s41, s42, 4
    s_and_b32 s41, s41, 7
    v_xor_b32 v123, s41, v119
    v_lshl_add_u32 v54, v123, 5, v122
    s_add_u32 s41, s42, 5
    s_and_b32 s41, s41, 7
    v_xor_b32 v123, s41, v119
    v_lshl_add_u32 v55, v123, 5, v122
    s_add_u32 s41, s42, 6
    s_and_b32 s41, s41, 7
    v_xor_b32 v123, s41, v119
    v_lshl_add_u32 v56, v123, 5, v122
    s_add_u32 s41, s42, 7
    s_and_b32 s41, s41, 7
    v_xor_b32 v123, s41, v119
    v_lshl_add_u32 v57, v123, 5, v122
    s_lshl_b32 s41, s5, 7
    s_add_u32 s41, s41, 86016
    v_lshl_add_u32 v58, v116, 4, s41
    v_mov_b32 v32, 0x3f803f80
    v_mov_b32 v33, 0x3f803f80
    v_mov_b32 v34, 0x3f803f80
    v_mov_b32 v35, 0x3f803f80
    v_and_b32 v120, 1, v19
    v_cmp_eq_u32 vcc, 0, v120
    v_mov_b32 v121, 0x44444444
    v_mov_b32 v122, 0xeeeeeeee
    v_cndmask_b32 v248, v122, v121, vcc
    v_and_b32 v120, 2, v19
    v_cmp_eq_u32 vcc, 0, v120
    v_mov_b32 v27, 1
    v_mov_b32 v28, 0
    v_cndmask_b32 v244, 0, v32, vcc
    v_cndmask_b32 v245, 0, v32, vcc
    v_cndmask_b32 v246, 0, v32, vcc
    v_cndmask_b32 v247, 0, v32, vcc
    v_accvgpr_write_b32 a224, 0
    v_accvgpr_write_b32 a225, 0
    v_accvgpr_write_b32 a226, 0
    v_accvgpr_write_b32 a227, 0
    v_accvgpr_write_b32 a228, 0
    v_accvgpr_write_b32 a229, 0
    v_accvgpr_write_b32 a230, 0
    v_accvgpr_write_b32 a231, 0
    v_accvgpr_write_b32 a232, 0
    v_accvgpr_write_b32 a233, 0
    v_accvgpr_write_b32 a234, 0
    v_accvgpr_write_b32 a235, 0
    v_accvgpr_write_b32 a236, 0
    v_accvgpr_write_b32 a237, 0
    v_accvgpr_write_b32 a238, 0
    v_accvgpr_write_b32 a239, 0
    s_mul_i32 s47, s5, 5120
    s_mov_b32 s96, s56
    s_mov_b32 s97, s57
    s_mov_b32 s98, 0x500000
    s_mov_b32 s99, 0x20000
    s_lshr_b32 s40, s6, 1
    s_and_b32 s41, s6, 1
    s_lshl_b32 s41, s41, 2
    s_add_u32 s41, s41, s5
    s_add_u32 s47, s47, 65536
    s_mul_i32 s42, s40, 40960
    s_mul_i32 s43, s41, 160
    s_add_u32 s42, s42, s43
    v_add_u32 v25, 0, v19
    v_mul_u32_u24 v26, 6554, v25
    v_lshrrev_b32 v26, 16, v26
    v_mul_u32_u24 v20, 1120, v26
    v_lshl_add_u32 v20, v25, 4, v20
    v_add_u32 v20, s42, v20
    v_add_u32 v25, 64, v19
    v_mul_u32_u24 v26, 6554, v25
    v_lshrrev_b32 v26, 16, v26
    v_mul_u32_u24 v21, 1120, v26
    v_lshl_add_u32 v21, v25, 4, v21
    v_add_u32 v21, s42, v21
    v_add_u32 v25, 128, v19
    v_mul_u32_u24 v26, 6554, v25
    v_lshrrev_b32 v26, 16, v26
    v_mul_u32_u24 v22, 1120, v26
    v_lshl_add_u32 v22, v25, 4, v22
    v_add_u32 v22, s42, v22
    v_add_u32 v25, 192, v19
    v_mul_u32_u24 v26, 6554, v25
    v_lshrrev_b32 v26, 16, v26
    v_mul_u32_u24 v23, 1120, v26
    v_lshl_add_u32 v23, v25, 4, v23
    v_add_u32 v23, s42, v23
    v_add_u32 v25, 256, v19
    v_mul_u32_u24 v26, 6554, v25
    v_lshrrev_b32 v26, 16, v26
    v_mul_u32_u24 v24, 1120, v26
    v_lshl_add_u32 v24, v25, 4, v24
    v_add_u32 v24, s42, v24
    v_lshrrev_b32 v25, 2, v19
    v_mul_u32_u24 v25, 160, v25
    v_and_b32 v26, 3, v19
    v_lshl_add_u32 v25, v26, 3, v25
    v_add_u32 v25, s47, v25
    s_lshl_b32 s42, s41, 7
    s_add_u32 s42, s42, s40
    s_mul_i32 s42, s42, 5120
    s_add_u32 s42, s42, 0x1400000
    v_lshlrev_b32 v26, 4, v19
    v_add_u32 v26, s42, v26
    s_add_u32 m0, s39, 16384
    s_mov_b32 s37, 524288
    buffer_load_dwordx4 v44, s[20:23], s37 offen offset:0 lds
    buffer_load_dwordx4 v45, s[20:23], s37 offen offset:1024 lds
    buffer_load_dwordx4 v46, s[20:23], s37 offen offset:2048 lds
    buffer_load_dwordx4 v47, s[20:23], s37 offen offset:3072 lds
    s_add_u32 m0, s38, 8192
    s_mov_b32 s36, 128
    buffer_load_dwordx4 v36, s[16:19], s36 offen offset:0 lds
    buffer_load_dwordx4 v37, s[16:19], s36 offen offset:1024 lds
    buffer_load_dwordx4 v38, s[16:19], s36 offen offset:2048 lds
    buffer_load_dwordx4 v39, s[16:19], s36 offen offset:3072 lds
    s_add_u32 m0, s38, 12288
    s_nop 0
    buffer_load_dwordx4 v40, s[16:19], s36 offen offset:0 lds
    buffer_load_dwordx4 v41, s[16:19], s36 offen offset:1024 lds
    buffer_load_dwordx4 v42, s[16:19], s36 offen offset:2048 lds
    buffer_load_dwordx4 v43, s[16:19], s36 offen offset:3072 lds
    s_add_u32 m0, s39, 32768
    s_mov_b32 s37, 1048576
    buffer_load_dwordx4 v44, s[20:23], s37 offen offset:0 lds
    buffer_load_dwordx4 v45, s[20:23], s37 offen offset:1024 lds
    buffer_load_dwordx4 v46, s[20:23], s37 offen offset:2048 lds
    buffer_load_dwordx4 v47, s[20:23], s37 offen offset:3072 lds
    s_waitcnt vmcnt(26)
    s_barrier
    ds_read_b64_tr_b16 a[0:1], v50 offset:0
    ds_read_b64_tr_b16 a[2:3], v50 offset:1024
    ds_read_b128 a[32:35], v48 offset:0
    ds_read_b128 a[36:39], v48 offset:2048
    ds_read_b128 a[40:43], v48 offset:4096
    ds_read_b128 a[44:47], v48 offset:6144
    ds_read_b64_tr_b16 a[4:5], v51 offset:0
    ds_read_b64_tr_b16 a[6:7], v51 offset:1024
    ds_read_b64_tr_b16 a[8:9], v52 offset:0
    ds_read_b64_tr_b16 a[10:11], v52 offset:1024
    ds_read_b64_tr_b16 a[12:13], v53 offset:0
    ds_read_b64_tr_b16 a[14:15], v53 offset:1024
    ds_read_b64_tr_b16 a[16:17], v54 offset:0
    ds_read_b64_tr_b16 a[18:19], v54 offset:1024
    ds_read_b64_tr_b16 a[20:21], v55 offset:0
    ds_read_b64_tr_b16 a[22:23], v55 offset:1024
    ds_read_b64_tr_b16 a[24:25], v56 offset:0
    ds_read_b64_tr_b16 a[26:27], v56 offset:1024
    ds_read_b64_tr_b16 a[28:29], v57 offset:0
    ds_read_b64_tr_b16 a[30:31], v57 offset:1024
    s_waitcnt lgkmcnt(0)
    v_mfma_f32_16x16x32_bf16 v[100:103], a[0:3], v[32:35], 0
    s_waitcnt vmcnt(16)
    ds_read_b64_tr_b16 a[48:49], v50 offset:8192
    v_mfma_f32_16x16x32_bf16 v[104:107], a[4:7], v[32:35], 0
    s_add_u32 m0, s38, 16384
    s_mov_b32 s36, 256
    ds_read_b64_tr_b16 a[50:51], v50 offset:9216
    v_mfma_f32_16x16x32_bf16 v[116:119], a[0:3], a[32:35], 0
    s_lshl_b32 s40, s6, 7
    buffer_load_dwordx4 v36, s[16:19], s36 offen offset:0 lds
    v_mfma_f32_16x16x32_bf16 v[148:151], a[0:3], a[36:39], 0
    s_add_u32 s41, s40, 0x292000
    ds_read_b128 a[80:83], v49 offset:0
    v_mfma_f32_16x16x32_bf16 v[180:183], a[0:3], a[40:43], 0
    s_add_u32 s40, s40, 0x290000
    ds_read_b128 a[84:87], v49 offset:2048
    v_mfma_f32_16x16x32_bf16 v[212:215], a[0:3], a[44:47], 0
    s_cmp_lt_u32 s6, 64
    s_cselect_b32 s40, s40, 0x2500000
    buffer_load_dwordx4 v37, s[16:19], s36 offen offset:1024 lds
    v_mfma_f32_16x16x32_bf16 v[216:219], a[4:7], a[44:47], 0
    s_cmp_eq_u32 s5, 1
    s_cselect_b32 s40, s40, 0x2500000
    ds_read_b128 a[88:91], v49 offset:4096
    v_mfma_f32_16x16x32_bf16 v[184:187], a[4:7], a[40:43], 0
    s_cmp_eq_u32 s5, 0
    s_cselect_b32 s40, s41, s40
    ds_read_b128 a[92:95], v49 offset:6144
    v_mfma_f32_16x16x32_bf16 v[152:155], a[4:7], a[36:39], 0
    s_add_u32 s41, s41, 0xe000
    ds_read_b64_tr_b16 a[52:53], v51 offset:8192
    v_mfma_f32_16x16x32_bf16 v[120:123], a[4:7], a[32:35], 0
    s_cmp_eq_u32 s5, 3
    s_cselect_b32 s40, s41, s40
    buffer_load_dwordx4 v38, s[16:19], s36 offen offset:2048 lds
    v_mfma_f32_16x16x32_bf16 v[124:127], a[8:11], a[32:35], 0
    s_lshl_b32 s41, s6, 2
    ds_read_b64_tr_b16 a[54:55], v51 offset:9216
    v_mfma_f32_16x16x32_bf16 v[156:159], a[8:11], a[36:39], 0
    s_add_u32 s41, s41, s5
    ds_read_b64_tr_b16 a[56:57], v52 offset:8192
    v_mfma_f32_16x16x32_bf16 v[188:191], a[8:11], a[40:43], 0
    s_cmp_eq_u32 s41, 962
    s_cselect_b32 s40, 0x29b000, s40
    ds_read_b64_tr_b16 a[58:59], v52 offset:9216
    v_mfma_f32_16x16x32_bf16 v[220:223], a[8:11], a[44:47], 0
    s_lshl_b32 s41, s6, 7
    buffer_load_dwordx4 v39, s[16:19], s36 offen offset:3072 lds
    v_mfma_f32_16x16x32_bf16 v[224:227], a[12:15], a[44:47], 0
    s_add_u32 s41, s41, 0x29c000
    ds_read_b64_tr_b16 a[60:61], v53 offset:8192
    v_mfma_f32_16x16x32_bf16 v[192:195], a[12:15], a[40:43], 0
    s_xor_b32 s42, s5, 2
    ds_read_b64_tr_b16 a[62:63], v53 offset:9216
    v_mfma_f32_16x16x32_bf16 v[160:163], a[12:15], a[36:39], 0
    s_add_u32 m0, s38, 20480
    ds_read_b64_tr_b16 a[64:65], v54 offset:8192
    v_mfma_f32_16x16x32_bf16 v[128:131], a[12:15], a[32:35], 0
    s_lshl_b32 s42, s42, 8
    buffer_load_dwordx4 v40, s[16:19], s36 offen offset:0 lds
    v_mfma_f32_16x16x32_bf16 v[132:135], a[16:19], a[32:35], 0
    s_add_u32 s42, s42, s6
    ds_read_b64_tr_b16 a[66:67], v54 offset:9216
    v_mfma_f32_16x16x32_bf16 v[164:167], a[16:19], a[36:39], 0
    s_cmp_lt_u32 s42, 80
    s_cselect_b32 s40, s41, s40
    s_cselect_b32 s41, -1, 0
    ds_read_b64_tr_b16 a[68:69], v55 offset:8192
    v_mov_b32 v28, s41
    v_lshlrev_b32 v29, 2, v19
    v_mfma_f32_16x16x32_bf16 v[196:199], a[16:19], a[40:43], 0
    buffer_load_dwordx4 v41, s[16:19], s36 offen offset:1024 lds
    s_mov_b32 exec_hi, 0
    buffer_store_dword v28, v29, s[76:79], s40 offen sc1
    s_mov_b32 exec_hi, -1
    v_lshlrev_b32 v80, 16, v60
    v_and_b32 v81, 0xffff0000, v60
    v_lshlrev_b32 v82, 16, v61
    v_and_b32 v83, 0xffff0000, v61
    v_lshlrev_b32 v84, 16, v62
    v_and_b32 v85, 0xffff0000, v62
    v_mfma_f32_16x16x32_bf16 v[228:231], a[16:19], a[44:47], 0
    ds_read_b64_tr_b16 a[70:71], v55 offset:9216
    v_lshlrev_b32 v86, 16, v63
    v_mfma_f32_16x16x32_bf16 v[232:235], a[20:23], a[44:47], 0
    ds_read_b64_tr_b16 a[72:73], v56 offset:8192
    v_and_b32 v87, 0xffff0000, v63
    v_lshlrev_b32 v88, 16, v64
    v_mfma_f32_16x16x32_bf16 v[200:203], a[20:23], a[40:43], 0
    ds_read_b64_tr_b16 a[74:75], v56 offset:9216
    v_and_b32 v89, 0xffff0000, v64
    v_mfma_f32_16x16x32_bf16 v[168:171], a[20:23], a[36:39], 0
    buffer_load_dwordx4 v42, s[16:19], s36 offen offset:2048 lds
    v_lshlrev_b32 v90, 16, v65
    v_mfma_f32_16x16x32_bf16 v[136:139], a[20:23], a[32:35], 0
    ds_read_b64_tr_b16 a[76:77], v57 offset:8192
    v_and_b32 v91, 0xffff0000, v65
    v_lshlrev_b32 v92, 16, v66
    v_mfma_f32_16x16x32_bf16 v[140:143], a[24:27], a[32:35], 0
    ds_read_b64_tr_b16 a[78:79], v57 offset:9216
    v_and_b32 v93, 0xffff0000, v66
    v_mfma_f32_16x16x32_bf16 v[172:175], a[24:27], a[36:39], 0
    v_lshlrev_b32 v94, 16, v67
    v_and_b32 v95, 0xffff0000, v67
    v_mfma_f32_16x16x32_bf16 v[204:207], a[24:27], a[40:43], 0
    buffer_load_dwordx4 v43, s[16:19], s36 offen offset:3072 lds
    v_lshlrev_b32 v96, 16, v68
    v_mfma_f32_16x16x32_bf16 v[236:239], a[24:27], a[44:47], 0
    v_and_b32 v97, 0xffff0000, v68
    v_lshlrev_b32 v98, 16, v69
    v_mfma_f32_16x16x32_bf16 v[240:243], a[28:31], a[44:47], 0
    v_and_b32 v99, 0xffff0000, v69
    v_add_f32 v109, v80, v81
    v_mfma_f32_16x16x32_bf16 v[208:211], a[28:31], a[40:43], 0
    v_add_f32 v110, v82, v83
    v_add_f32 v109, v109, v84
    v_mfma_f32_16x16x32_bf16 v[176:179], a[28:31], a[36:39], 0
    v_add_f32 v110, v110, v85
    v_add_f32 v109, v109, v86
    v_mfma_f32_16x16x32_bf16 v[144:147], a[28:31], a[32:35], 0
    v_add_f32 v110, v110, v87
    v_add_f32 v109, v109, v88
    s_waitcnt vmcnt(13) lgkmcnt(0)
    s_barrier
    v_mfma_f32_16x16x32_bf16 v[100:103], a[48:51], v[32:35], v[100:103]
    ds_read_b64_tr_b16 a[0:1], v50 offset:16384
    v_add_f32 v110, v110, v89
    v_mfma_f32_16x16x32_bf16 v[104:107], a[52:55], v[32:35], v[104:107]
    s_add_u32 m0, s39, 0
    s_mov_b32 s37, 1572864
    ds_read_b64_tr_b16 a[2:3], v50 offset:17408
    v_add_f32 v109, v109, v90
    v_mfma_f32_16x16x32_bf16 v[116:119], a[48:51], a[80:83], v[116:119]
    buffer_load_dwordx4 v44, s[20:23], s37 offen offset:0 lds
    v_mfma_f32_16x16x32_bf16 v[148:151], a[48:51], a[84:87], v[148:151]
    ds_read_b128 a[32:35], v48 offset:8192
    v_add_f32 v110, v110, v91
    v_mfma_f32_16x16x32_bf16 v[180:183], a[48:51], a[88:91], v[180:183]
    ds_read_b128 a[36:39], v48 offset:10240
    v_add_f32 v109, v109, v92
    v_mfma_f32_16x16x32_bf16 v[212:215], a[48:51], a[92:95], v[212:215]
    ds_read_b128 a[40:43], v48 offset:12288
    v_add_f32 v110, v110, v93
    v_mfma_f32_16x16x32_bf16 v[216:219], a[52:55], a[92:95], v[216:219]
    ds_read_b128 a[44:47], v48 offset:14336
    v_add_f32 v109, v109, v94
    v_mfma_f32_16x16x32_bf16 v[184:187], a[52:55], a[88:91], v[184:187]
    buffer_load_dwordx4 v45, s[20:23], s37 offen offset:1024 lds
    v_add_f32 v110, v110, v95
    v_mfma_f32_16x16x32_bf16 v[152:155], a[52:55], a[84:87], v[152:155]
    ds_read_b64_tr_b16 a[4:5], v51 offset:16384
    v_add_f32 v109, v109, v96
    v_add_f32 v110, v110, v97
    v_mfma_f32_16x16x32_bf16 v[120:123], a[52:55], a[80:83], v[120:123]
    ds_read_b64_tr_b16 a[6:7], v51 offset:17408
    v_add_f32 v109, v109, v98
    v_mfma_f32_16x16x32_bf16 v[124:127], a[56:59], a[80:83], v[124:127]
    ds_read_b64_tr_b16 a[8:9], v52 offset:16384
    v_add_f32 v110, v110, v99
    v_mfma_f32_16x16x32_bf16 v[156:159], a[56:59], a[84:87], v[156:159]
    ds_read_b64_tr_b16 a[10:11], v52 offset:17408
    v_add_f32 v109, v109, v110
    v_mfma_f32_16x16x32_bf16 v[188:191], a[56:59], a[88:91], v[188:191]
    buffer_load_dwordx4 v46, s[20:23], s37 offen offset:2048 lds
    v_add_f32_dpp v109, v109, v109 quad_perm:[1,0,3,2] row_mask:0xf bank_mask:0xf
    v_mfma_f32_16x16x32_bf16 v[220:223], a[56:59], a[92:95], v[220:223]
    ds_read_b64_tr_b16 a[12:13], v53 offset:16384
    v_add_f32_dpp v109, v109, v109 quad_perm:[2,3,0,1] row_mask:0xf bank_mask:0xf
    v_mfma_f32_16x16x32_bf16 v[224:227], a[60:63], a[92:95], v[224:227]
    ds_read_b64_tr_b16 a[14:15], v53 offset:17408
    v_add_f32_dpp v109, v109, v109 row_half_mirror row_mask:0xf bank_mask:0xf
    v_mfma_f32_16x16x32_bf16 v[192:195], a[60:63], a[88:91], v[192:195]
    ds_read_b64_tr_b16 a[16:17], v54 offset:16384
    v_add_f32_dpp v109, v109, v109 row_mirror row_mask:0xf bank_mask:0xf
    v_mov_b32 v110, v109
    v_mfma_f32_16x16x32_bf16 v[160:163], a[60:63], a[84:87], v[160:163]
    ds_read_b64_tr_b16 a[18:19], v54 offset:17408
    v_permlane16_swap_b32 v109, v110
    v_add_f32 v109, v109, v110
    v_mul_f32 v111, 0x3acccccd, v109
    v_mfma_f32_16x16x32_bf16 v[128:131], a[60:63], a[80:83], v[128:131]
    buffer_load_dwordx4 v47, s[20:23], s37 offen offset:3072 lds
    v_sub_f32 v60, v80, v111
    v_mfma_f32_16x16x32_bf16 v[132:135], a[64:67], a[80:83], v[132:135]
    ds_read_b64_tr_b16 a[20:21], v55 offset:16384
    v_mul_f32 v109, v60, v60
    v_mfma_f32_16x16x32_bf16 v[164:167], a[64:67], a[84:87], v[164:167]
    ds_read_b64_tr_b16 a[22:23], v55 offset:17408
    v_sub_f32 v61, v81, v111
    v_mul_f32 v112, v61, v61
    v_mfma_f32_16x16x32_bf16 v[196:199], a[64:67], a[88:91], v[196:199]
    ds_read_b64_tr_b16 a[24:25], v56 offset:16384
    v_sub_f32 v60, v82, v111
    v_mfma_f32_16x16x32_bf16 v[228:231], a[64:67], a[92:95], v[228:231]
    s_add_u32 m0, s38, 0
    s_mov_b32 s36, 384
    ds_read_b64_tr_b16 a[26:27], v56 offset:17408
    v_fmac_f32 v109, v60, v60
    v_mfma_f32_16x16x32_bf16 v[232:235], a[68:71], a[92:95], v[232:235]
    buffer_load_dwordx4 v36, s[16:19], s36 offen offset:0 lds
    v_sub_f32 v61, v83, v111
    v_fmac_f32 v112, v61, v61
    v_mfma_f32_16x16x32_bf16 v[200:203], a[68:71], a[88:91], v[200:203]
    ds_read_b64_tr_b16 a[28:29], v57 offset:16384
    v_sub_f32 v60, v84, v111
    v_mfma_f32_16x16x32_bf16 v[168:171], a[68:71], a[84:87], v[168:171]
    ds_read_b64_tr_b16 a[30:31], v57 offset:17408
    v_fmac_f32 v109, v60, v60
    v_mfma_f32_16x16x32_bf16 v[136:139], a[68:71], a[80:83], v[136:139]
    v_sub_f32 v61, v85, v111
    v_fmac_f32 v112, v61, v61
    v_mfma_f32_16x16x32_bf16 v[140:143], a[72:75], a[80:83], v[140:143]
    v_sub_f32 v60, v86, v111
    v_fmac_f32 v109, v60, v60
    v_mfma_f32_16x16x32_bf16 v[172:175], a[72:75], a[84:87], v[172:175]
    buffer_load_dwordx4 v37, s[16:19], s36 offen offset:1024 lds
    v_sub_f32 v61, v87, v111
    v_mfma_f32_16x16x32_bf16 v[204:207], a[72:75], a[88:91], v[204:207]
    v_fmac_f32 v112, v61, v61
    v_sub_f32 v60, v88, v111
    v_mfma_f32_16x16x32_bf16 v[236:239], a[72:75], a[92:95], v[236:239]
    v_fmac_f32 v109, v60, v60
    v_sub_f32 v61, v89, v111
    v_mfma_f32_16x16x32_bf16 v[240:243], a[76:79], a[92:95], v[240:243]
    v_fmac_f32 v112, v61, v61
    v_sub_f32 v60, v90, v111
    v_mfma_f32_16x16x32_bf16 v[208:211], a[76:79], a[88:91], v[208:211]
    v_fmac_f32 v109, v60, v60
    v_sub_f32 v61, v91, v111
    v_mfma_f32_16x16x32_bf16 v[176:179], a[76:79], a[84:87], v[176:179]
    v_fmac_f32 v112, v61, v61
    v_sub_f32 v60, v92, v111
    v_mfma_f32_16x16x32_bf16 v[144:147], a[76:79], a[80:83], v[144:147]
    v_fmac_f32 v109, v60, v60
    v_sub_f32 v61, v93, v111
    s_waitcnt lgkmcnt(0)
    v_mfma_f32_16x16x32_bf16 v[100:103], a[0:3], v[32:35], v[100:103]
    ds_read_b64_tr_b16 a[48:49], v50 offset:24576
    v_fmac_f32 v112, v61, v61
    v_mfma_f32_16x16x32_bf16 v[104:107], a[4:7], v[32:35], v[104:107]
    ds_read_b64_tr_b16 a[50:51], v50 offset:25600
    v_sub_f32 v60, v94, v111
    v_mfma_f32_16x16x32_bf16 v[116:119], a[0:3], a[32:35], v[116:119]
    buffer_load_dwordx4 v38, s[16:19], s36 offen offset:2048 lds
    v_mfma_f32_16x16x32_bf16 v[148:151], a[0:3], a[36:39], v[148:151]
    ds_read_b128 a[80:83], v49 offset:8192
    v_fmac_f32 v109, v60, v60
    v_mfma_f32_16x16x32_bf16 v[180:183], a[0:3], a[40:43], v[180:183]
    ds_read_b128 a[84:87], v49 offset:10240
    v_sub_f32 v61, v95, v111
    v_mfma_f32_16x16x32_bf16 v[212:215], a[0:3], a[44:47], v[212:215]
    ds_read_b128 a[88:91], v49 offset:12288
    v_fmac_f32 v112, v61, v61
    v_mfma_f32_16x16x32_bf16 v[216:219], a[4:7], a[44:47], v[216:219]
    ds_read_b128 a[92:95], v49 offset:14336
    v_sub_f32 v60, v96, v111
    v_mfma_f32_16x16x32_bf16 v[184:187], a[4:7], a[40:43], v[184:187]
    buffer_load_dwordx4 v39, s[16:19], s36 offen offset:3072 lds
    v_fmac_f32 v109, v60, v60
    v_mfma_f32_16x16x32_bf16 v[152:155], a[4:7], a[36:39], v[152:155]
    ds_read_b64_tr_b16 a[52:53], v51 offset:24576
    v_sub_f32 v61, v97, v111
    v_mfma_f32_16x16x32_bf16 v[120:123], a[4:7], a[32:35], v[120:123]
    ds_read_b64_tr_b16 a[54:55], v51 offset:25600
    v_fmac_f32 v112, v61, v61
    v_mfma_f32_16x16x32_bf16 v[124:127], a[8:11], a[32:35], v[124:127]
    ds_read_b64_tr_b16 a[56:57], v52 offset:24576
    v_sub_f32 v60, v98, v111
    v_mfma_f32_16x16x32_bf16 v[156:159], a[8:11], a[36:39], v[156:159]
    s_add_u32 m0, s38, 4096
    ds_read_b64_tr_b16 a[58:59], v52 offset:25600
    v_fmac_f32 v109, v60, v60
    v_sub_f32 v61, v99, v111
    v_mfma_f32_16x16x32_bf16 v[188:191], a[8:11], a[40:43], v[188:191]
    buffer_load_dwordx4 v40, s[16:19], s36 offen offset:0 lds
    v_fmac_f32 v112, v61, v61
    v_mfma_f32_16x16x32_bf16 v[220:223], a[8:11], a[44:47], v[220:223]
    ds_read_b64_tr_b16 a[60:61], v53 offset:24576
    v_add_f32 v109, v109, v112
    v_mfma_f32_16x16x32_bf16 v[224:227], a[12:15], a[44:47], v[224:227]
    ds_read_b64_tr_b16 a[62:63], v53 offset:25600
    v_add_f32_dpp v109, v109, v109 quad_perm:[1,0,3,2] row_mask:0xf bank_mask:0xf
    v_mfma_f32_16x16x32_bf16 v[192:195], a[12:15], a[40:43], v[192:195]
    ds_read_b64_tr_b16 a[64:65], v54 offset:24576
    v_add_f32_dpp v109, v109, v109 quad_perm:[2,3,0,1] row_mask:0xf bank_mask:0xf
    v_mfma_f32_16x16x32_bf16 v[160:163], a[12:15], a[36:39], v[160:163]
    ds_read_b64_tr_b16 a[66:67], v54 offset:25600
    v_add_f32_dpp v109, v109, v109 row_half_mirror row_mask:0xf bank_mask:0xf
    v_mfma_f32_16x16x32_bf16 v[128:131], a[12:15], a[32:35], v[128:131]
    buffer_load_dwordx4 v41, s[16:19], s36 offen offset:1024 lds
    v_add_f32_dpp v109, v109, v109 row_mirror row_mask:0xf bank_mask:0xf
    v_mov_b32 v110, v109
    v_mfma_f32_16x16x32_bf16 v[132:135], a[16:19], a[32:35], v[132:135]
    ds_read_b64_tr_b16 a[68:69], v55 offset:24576
    v_permlane16_swap_b32 v109, v110
    v_add_f32 v109, v109, v110
    v_mfma_f32_16x16x32_bf16 v[164:167], a[16:19], a[36:39], v[164:167]
    ds_read_b64_tr_b16 a[70:71], v55 offset:25600
    v_mul_f32 v109, 0x3acccccd, v109
    v_cvt_pk_bf16_f32 v110, v111, v109
    v_mfma_f32_16x16x32_bf16 v[196:199], a[16:19], a[40:43], v[196:199]
    ds_read_b64_tr_b16 a[72:73], v56 offset:24576
    v_lshlrev_b32 v111, 16, v110
    v_mfma_f32_16x16x32_bf16 v[228:231], a[16:19], a[44:47], v[228:231]
    ds_read_b64_tr_b16 a[74:75], v56 offset:25600
    v_and_b32 v109, 0xffff0000, v110
    v_mfma_f32_16x16x32_bf16 v[232:235], a[20:23], a[44:47], v[232:235]
    buffer_load_dwordx4 v42, s[16:19], s36 offen offset:2048 lds
    v_add_f32 v109, 0x3727c5ac, v109
    v_cvt_pk_bf16_f32 v109, v109, v109
    v_mfma_f32_16x16x32_bf16 v[200:203], a[20:23], a[40:43], v[200:203]
    ds_read_b64_tr_b16 a[76:77], v57 offset:24576
    v_lshlrev_b32 v109, 16, v109
    v_mfma_f32_16x16x32_bf16 v[168:171], a[20:23], a[36:39], v[168:171]
    ds_read_b64_tr_b16 a[78:79], v57 offset:25600
    v_sqrt_f32 v109, v109
    v_mfma_f32_16x16x32_bf16 v[136:139], a[20:23], a[32:35], v[136:139]
    v_sub_f32 v80, v80, v111
    v_sub_f32 v81, v81, v111
    v_mfma_f32_16x16x32_bf16 v[140:143], a[24:27], a[32:35], v[140:143]
    v_sub_f32 v82, v82, v111
    v_sub_f32 v83, v83, v111
    v_mfma_f32_16x16x32_bf16 v[172:175], a[24:27], a[36:39], v[172:175]
    buffer_load_dwordx4 v43, s[16:19], s36 offen offset:3072 lds
    v_sub_f32 v84, v84, v111
    v_mfma_f32_16x16x32_bf16 v[204:207], a[24:27], a[40:43], v[204:207]
    v_sub_f32 v85, v85, v111
    v_sub_f32 v86, v86, v111
    v_mfma_f32_16x16x32_bf16 v[236:239], a[24:27], a[44:47], v[236:239]
    v_sub_f32 v87, v87, v111
    v_sub_f32 v88, v88, v111
    v_mfma_f32_16x16x32_bf16 v[240:243], a[28:31], a[44:47], v[240:243]
    v_sub_f32 v89, v89, v111
    v_sub_f32 v90, v90, v111
    v_mfma_f32_16x16x32_bf16 v[208:211], a[28:31], a[40:43], v[208:211]
    v_sub_f32 v91, v91, v111
    v_sub_f32 v92, v92, v111
    v_mfma_f32_16x16x32_bf16 v[176:179], a[28:31], a[36:39], v[176:179]
    v_sub_f32 v93, v93, v111
    v_sub_f32 v94, v94, v111
    v_mfma_f32_16x16x32_bf16 v[144:147], a[28:31], a[32:35], v[144:147]
    v_sub_f32 v95, v95, v111
    v_sub_f32 v96, v96, v111
    s_waitcnt vmcnt(12) lgkmcnt(0)
    s_barrier
    v_mfma_f32_16x16x32_bf16 v[100:103], a[48:51], v[32:35], v[100:103]
    ds_read_b64_tr_b16 a[0:1], v50 offset:32768
    v_sub_f32 v97, v97, v111
    v_mfma_f32_16x16x32_bf16 v[104:107], a[52:55], v[32:35], v[104:107]
    s_add_u32 m0, s39, 16384
    s_mov_b32 s37, 2097152
    ds_read_b64_tr_b16 a[2:3], v50 offset:33792
    v_sub_f32 v98, v98, v111
    v_mfma_f32_16x16x32_bf16 v[116:119], a[48:51], a[80:83], v[116:119]
    buffer_load_dwordx4 v44, s[20:23], s37 offen offset:0 lds
    v_mfma_f32_16x16x32_bf16 v[148:151], a[48:51], a[84:87], v[148:151]
    ds_read_b128 a[32:35], v48 offset:16384
    v_sub_f32 v99, v99, v111
    v_mfma_f32_16x16x32_bf16 v[180:183], a[48:51], a[88:91], v[180:183]
    ds_read_b128 a[36:39], v48 offset:18432
    v_cvt_pk_bf16_f32 v109, v109, v109
    v_mfma_f32_16x16x32_bf16 v[212:215], a[48:51], a[92:95], v[212:215]
    ds_read_b128 a[40:43], v48 offset:20480
    v_lshlrev_b32 v109, 16, v109
    v_mfma_f32_16x16x32_bf16 v[216:219], a[52:55], a[92:95], v[216:219]
    ds_read_b128 a[44:47], v48 offset:22528
    v_rcp_f32 v112, v109
    v_mfma_f32_16x16x32_bf16 v[184:187], a[52:55], a[88:91], v[184:187]
    buffer_load_dwordx4 v45, s[20:23], s37 offen offset:1024 lds
    v_cvt_pk_bf16_f32 v60, v80, v81
    v_mfma_f32_16x16x32_bf16 v[152:155], a[52:55], a[84:87], v[152:155]
    ds_read_b64_tr_b16 a[4:5], v51 offset:32768
    v_cvt_pk_bf16_f32 v61, v82, v83
    v_mfma_f32_16x16x32_bf16 v[120:123], a[52:55], a[80:83], v[120:123]
    ds_read_b64_tr_b16 a[6:7], v51 offset:33792
    v_cvt_pk_bf16_f32 v62, v84, v85
    v_mfma_f32_16x16x32_bf16 v[124:127], a[56:59], a[80:83], v[124:127]
    ds_read_b64_tr_b16 a[8:9], v52 offset:32768
    v_cvt_pk_bf16_f32 v63, v86, v87
    v_mfma_f32_16x16x32_bf16 v[156:159], a[56:59], a[84:87], v[156:159]
    ds_read_b64_tr_b16 a[10:11], v52 offset:33792
    v_cvt_pk_bf16_f32 v64, v88, v89
    v_cvt_pk_bf16_f32 v65, v90, v91
    v_mfma_f32_16x16x32_bf16 v[188:191], a[56:59], a[88:91], v[188:191]
    buffer_load_dwordx4 v46, s[20:23], s37 offen offset:2048 lds
    v_cvt_pk_bf16_f32 v66, v92, v93
    v_mfma_f32_16x16x32_bf16 v[220:223], a[56:59], a[92:95], v[220:223]
    ds_read_b64_tr_b16 a[12:13], v53 offset:32768
    v_cvt_pk_bf16_f32 v67, v94, v95
    v_mfma_f32_16x16x32_bf16 v[224:227], a[60:63], a[92:95], v[224:227]
    ds_read_b64_tr_b16 a[14:15], v53 offset:33792
    v_cvt_pk_bf16_f32 v68, v96, v97
    v_cvt_pk_bf16_f32 v69, v98, v99
    v_mfma_f32_16x16x32_bf16 v[192:195], a[60:63], a[88:91], v[192:195]
    ds_read_b64_tr_b16 a[16:17], v54 offset:32768
    v_lshlrev_b32 v80, 16, v60
    v_mfma_f32_16x16x32_bf16 v[160:163], a[60:63], a[84:87], v[160:163]
    ds_read_b64_tr_b16 a[18:19], v54 offset:33792
    v_and_b32 v81, 0xffff0000, v60
    v_lshlrev_b32 v82, 16, v61
    v_mfma_f32_16x16x32_bf16 v[128:131], a[60:63], a[80:83], v[128:131]
    buffer_load_dwordx4 v47, s[20:23], s37 offen offset:3072 lds
    v_and_b32 v83, 0xffff0000, v61
    v_mfma_f32_16x16x32_bf16 v[132:135], a[64:67], a[80:83], v[132:135]
    ds_read_b64_tr_b16 a[20:21], v55 offset:32768
    v_lshlrev_b32 v84, 16, v62
    v_mfma_f32_16x16x32_bf16 v[164:167], a[64:67], a[84:87], v[164:167]
    ds_read_b64_tr_b16 a[22:23], v55 offset:33792
    v_and_b32 v85, 0xffff0000, v62
    v_lshlrev_b32 v86, 16, v63
    v_mfma_f32_16x16x32_bf16 v[196:199], a[64:67], a[88:91], v[196:199]
    ds_read_b64_tr_b16 a[24:25], v56 offset:32768
    v_and_b32 v87, 0xffff0000, v63
    v_mfma_f32_16x16x32_bf16 v[228:231], a[64:67], a[92:95], v[228:231]
    s_add_u32 m0, s38, 8192
    s_mov_b32 s36, 512
    ds_read_b64_tr_b16 a[26:27], v56 offset:33792
    v_lshlrev_b32 v88, 16, v64
    v_mfma_f32_16x16x32_bf16 v[232:235], a[68:71], a[92:95], v[232:235]
    buffer_load_dwordx4 v36, s[16:19], s36 offen offset:0 lds
    v_and_b32 v89, 0xffff0000, v64
    v_lshlrev_b32 v90, 16, v65
    v_mfma_f32_16x16x32_bf16 v[200:203], a[68:71], a[88:91], v[200:203]
    ds_read_b64_tr_b16 a[28:29], v57 offset:32768
    v_and_b32 v91, 0xffff0000, v65
    v_mfma_f32_16x16x32_bf16 v[168:171], a[68:71], a[84:87], v[168:171]
    ds_read_b64_tr_b16 a[30:31], v57 offset:33792
    v_lshlrev_b32 v92, 16, v66
    v_mfma_f32_16x16x32_bf16 v[136:139], a[68:71], a[80:83], v[136:139]
    v_and_b32 v93, 0xffff0000, v66
    v_lshlrev_b32 v94, 16, v67
    v_mfma_f32_16x16x32_bf16 v[140:143], a[72:75], a[80:83], v[140:143]
    v_and_b32 v95, 0xffff0000, v67
    v_lshlrev_b32 v96, 16, v68
    v_mfma_f32_16x16x32_bf16 v[172:175], a[72:75], a[84:87], v[172:175]
    buffer_load_dwordx4 v37, s[16:19], s36 offen offset:1024 lds
    v_and_b32 v97, 0xffff0000, v68
    v_mfma_f32_16x16x32_bf16 v[204:207], a[72:75], a[88:91], v[204:207]
    v_lshlrev_b32 v98, 16, v69
    v_and_b32 v99, 0xffff0000, v69
    v_mfma_f32_16x16x32_bf16 v[236:239], a[72:75], a[92:95], v[236:239]
    v_mul_f32 v80, v80, v112
    v_mul_f32 v81, v81, v112
    v_mfma_f32_16x16x32_bf16 v[240:243], a[76:79], a[92:95], v[240:243]
    v_mul_f32 v82, v82, v112
    v_mul_f32 v83, v83, v112
    v_mfma_f32_16x16x32_bf16 v[208:211], a[76:79], a[88:91], v[208:211]
    v_mul_f32 v84, v84, v112
    v_mul_f32 v85, v85, v112
    v_mfma_f32_16x16x32_bf16 v[176:179], a[76:79], a[84:87], v[176:179]
    v_mul_f32 v86, v86, v112
    v_mul_f32 v87, v87, v112
    v_mfma_f32_16x16x32_bf16 v[144:147], a[76:79], a[80:83], v[144:147]
    v_mul_f32 v88, v88, v112
    v_mul_f32 v89, v89, v112
    s_waitcnt lgkmcnt(0)
    v_mfma_f32_16x16x32_bf16 v[100:103], a[0:3], v[32:35], v[100:103]
    ds_read_b64_tr_b16 a[48:49], v50 offset:40960
    v_mul_f32 v90, v90, v112
    v_mfma_f32_16x16x32_bf16 v[104:107], a[4:7], v[32:35], v[104:107]
    ds_read_b64_tr_b16 a[50:51], v50 offset:41984
    v_mul_f32 v91, v91, v112
    v_mfma_f32_16x16x32_bf16 v[116:119], a[0:3], a[32:35], v[116:119]
    buffer_load_dwordx4 v38, s[16:19], s36 offen offset:2048 lds
    v_mfma_f32_16x16x32_bf16 v[148:151], a[0:3], a[36:39], v[148:151]
    ds_read_b128 a[80:83], v49 offset:16384
    v_mul_f32 v92, v92, v112
    v_mfma_f32_16x16x32_bf16 v[180:183], a[0:3], a[40:43], v[180:183]
    ds_read_b128 a[84:87], v49 offset:18432
    v_mul_f32 v93, v93, v112
    v_mfma_f32_16x16x32_bf16 v[212:215], a[0:3], a[44:47], v[212:215]
    ds_read_b128 a[88:91], v49 offset:20480
    v_mul_f32 v94, v94, v112
    v_mfma_f32_16x16x32_bf16 v[216:219], a[4:7], a[44:47], v[216:219]
    ds_read_b128 a[92:95], v49 offset:22528
    v_mul_f32 v95, v95, v112
    v_mfma_f32_16x16x32_bf16 v[184:187], a[4:7], a[40:43], v[184:187]
    buffer_load_dwordx4 v39, s[16:19], s36 offen offset:3072 lds
    v_mul_f32 v96, v96, v112
    v_mfma_f32_16x16x32_bf16 v[152:155], a[4:7], a[36:39], v[152:155]
    ds_read_b64_tr_b16 a[52:53], v51 offset:40960
    v_mul_f32 v97, v97, v112
    v_mfma_f32_16x16x32_bf16 v[120:123], a[4:7], a[32:35], v[120:123]
    ds_read_b64_tr_b16 a[54:55], v51 offset:41984
    v_mul_f32 v98, v98, v112
    v_mfma_f32_16x16x32_bf16 v[124:127], a[8:11], a[32:35], v[124:127]
    ds_read_b64_tr_b16 a[56:57], v52 offset:40960
    v_mul_f32 v99, v99, v112
    v_mfma_f32_16x16x32_bf16 v[156:159], a[8:11], a[36:39], v[156:159]
    s_add_u32 m0, s38, 12288
    ds_read_b64_tr_b16 a[58:59], v52 offset:41984
    v_cvt_pk_bf16_f32 v60, v80, v81
    v_cvt_pk_bf16_f32 v61, v82, v83
    v_mfma_f32_16x16x32_bf16 v[188:191], a[8:11], a[40:43], v[188:191]
    buffer_load_dwordx4 v40, s[16:19], s36 offen offset:0 lds
    v_cvt_pk_bf16_f32 v62, v84, v85
    v_mfma_f32_16x16x32_bf16 v[220:223], a[8:11], a[44:47], v[220:223]
    ds_read_b64_tr_b16 a[60:61], v53 offset:40960
    v_cvt_pk_bf16_f32 v63, v86, v87
    v_mfma_f32_16x16x32_bf16 v[224:227], a[12:15], a[44:47], v[224:227]
    ds_read_b64_tr_b16 a[62:63], v53 offset:41984
    v_cvt_pk_bf16_f32 v64, v88, v89
    v_cvt_pk_bf16_f32 v65, v90, v91
    v_mfma_f32_16x16x32_bf16 v[192:195], a[12:15], a[40:43], v[192:195]
    ds_read_b64_tr_b16 a[64:65], v54 offset:40960
    v_cvt_pk_bf16_f32 v66, v92, v93
    v_mfma_f32_16x16x32_bf16 v[160:163], a[12:15], a[36:39], v[160:163]
    ds_read_b64_tr_b16 a[66:67], v54 offset:41984
    v_cvt_pk_bf16_f32 v67, v94, v95
    v_cvt_pk_bf16_f32 v68, v96, v97
    v_mfma_f32_16x16x32_bf16 v[128:131], a[12:15], a[32:35], v[128:131]
    buffer_load_dwordx4 v41, s[16:19], s36 offen offset:1024 lds
    v_cvt_pk_bf16_f32 v69, v98, v99
    v_mfma_f32_16x16x32_bf16 v[132:135], a[16:19], a[32:35], v[132:135]
    ds_read_b64_tr_b16 a[68:69], v55 offset:40960
    v_mov_b32 v109, 0
    v_mfma_f32_16x16x32_bf16 v[164:167], a[16:19], a[36:39], v[164:167]
    ds_read_b64_tr_b16 a[70:71], v55 offset:41984
    v_dot2c_f32_bf16 v109, v60, v70
    v_dot2c_f32_bf16 v109, v61, v71
    v_dot2c_f32_bf16 v109, v62, v72
    v_dot2c_f32_bf16 v109, v63, v73
    v_dot2c_f32_bf16 v109, v64, v74
    v_dot2c_f32_bf16 v109, v65, v75
    v_dot2c_f32_bf16 v109, v66, v76
    v_dot2c_f32_bf16 v109, v67, v77
    v_dot2c_f32_bf16 v109, v68, v78
    v_dot2c_f32_bf16 v109, v69, v79
    s_nop 2
    v_mfma_f32_16x16x32_bf16 v[196:199], a[16:19], a[40:43], v[196:199]
    ds_read_b64_tr_b16 a[72:73], v56 offset:40960
    v_add_f32_dpp v109, v109, v109 quad_perm:[1,0,3,2] row_mask:0xf bank_mask:0xf
    v_mfma_f32_16x16x32_bf16 v[228:231], a[16:19], a[44:47], v[228:231]
    ds_read_b64_tr_b16 a[74:75], v56 offset:41984
    v_add_f32_dpp v109, v109, v109 quad_perm:[2,3,0,1] row_mask:0xf bank_mask:0xf
    v_mfma_f32_16x16x32_bf16 v[232:235], a[20:23], a[44:47], v[232:235]
    buffer_load_dwordx4 v42, s[16:19], s36 offen offset:2048 lds
    v_add_f32_dpp v109, v109, v109 row_half_mirror row_mask:0xf bank_mask:0xf
    v_mfma_f32_16x16x32_bf16 v[200:203], a[20:23], a[40:43], v[200:203]
    ds_read_b64_tr_b16 a[76:77], v57 offset:40960
    v_add_f32_dpp v109, v109, v109 row_mirror row_mask:0xf bank_mask:0xf
    v_mov_b32 v110, v109
    v_mfma_f32_16x16x32_bf16 v[168:171], a[20:23], a[36:39], v[168:171]
    ds_read_b64_tr_b16 a[78:79], v57 offset:41984
    v_permlane16_swap_b32 v109, v110
    v_add_f32 v109, v109, v110
    v_mfma_f32_16x16x32_bf16 v[136:139], a[20:23], a[32:35], v[136:139]
    v_cvt_pk_bf16_f32 v109, v109, v109
    v_lshlrev_b32 v109, 16, v109
    v_mfma_f32_16x16x32_bf16 v[140:143], a[24:27], a[32:35], v[140:143]
    v_ashrrev_i32 v110, 31, v109
    v_or_b32 v110, 0x80000000, v110
    v_mfma_f32_16x16x32_bf16 v[172:175], a[24:27], a[36:39], v[172:175]
    buffer_load_dwordx4 v43, s[16:19], s36 offen offset:3072 lds
    v_xor_b32 v109, v109, v110
    v_mfma_f32_16x16x32_bf16 v[204:207], a[24:27], a[40:43], v[204:207]
    v_and_b32 v109, 0xffff0000, v109
    v_sub_u32 v110, 0xffff, v108
    v_mfma_f32_16x16x32_bf16 v[236:239], a[24:27], a[44:47], v[236:239]
    v_or_b32 v62, v109, v110
    v_mov_b32 v60, v111
    v_mfma_f32_16x16x32_bf16 v[240:243], a[28:31], a[44:47], v[240:243]
    v_mov_b32 v61, v112
    v_mov_b32 v63, 0
    v_mfma_f32_16x16x32_bf16 v[208:211], a[28:31], a[40:43], v[208:211]
    v_lshlrev_b32 v110, 4, v108
    v_mfma_f32_16x16x32_bf16 v[176:179], a[28:31], a[36:39], v[176:179]
    s_mov_b32 s40, 0x280000
    s_mov_b32 exec_lo, 1
    s_mov_b32 exec_hi, 1
    buffer_store_dwordx4 v[60:63], v110, s[76:79], s40 offen sc1
    s_mov_b64 exec, -1
    v_mfma_f32_16x16x32_bf16 v[144:147], a[28:31], a[32:35], v[144:147]
    s_waitcnt vmcnt(13) lgkmcnt(0)
    s_barrier
    v_mfma_f32_16x16x32_bf16 v[100:103], a[48:51], v[32:35], v[100:103]
    ds_read_b64_tr_b16 a[0:1], v50 offset:0
    v_mfma_f32_16x16x32_bf16 v[104:107], a[52:55], v[32:35], v[104:107]
    s_add_u32 m0, s39, 32768
    s_mov_b32 s37, 2621440
    ds_read_b64_tr_b16 a[2:3], v50 offset:1024
    v_mfma_f32_16x16x32_bf16 v[116:119], a[48:51], a[80:83], v[116:119]
    buffer_load_dwordx4 v44, s[20:23], s37 offen offset:0 lds
    v_mfma_f32_16x16x32_bf16 v[148:151], a[48:51], a[84:87], v[148:151]
    ds_read_b128 a[32:35], v48 offset:0
    v_mfma_f32_16x16x32_bf16 v[180:183], a[48:51], a[88:91], v[180:183]
    ds_read_b128 a[36:39], v48 offset:2048
    v_mfma_f32_16x16x32_bf16 v[212:215], a[48:51], a[92:95], v[212:215]
    ds_read_b128 a[40:43], v48 offset:4096
    v_mfma_f32_16x16x32_bf16 v[216:219], a[52:55], a[92:95], v[216:219]
    ds_read_b128 a[44:47], v48 offset:6144
    v_mfma_f32_16x16x32_bf16 v[184:187], a[52:55], a[88:91], v[184:187]
    buffer_load_dwordx4 v45, s[20:23], s37 offen offset:1024 lds
    v_mfma_f32_16x16x32_bf16 v[152:155], a[52:55], a[84:87], v[152:155]
    ds_read_b64_tr_b16 a[4:5], v51 offset:0
    v_mfma_f32_16x16x32_bf16 v[120:123], a[52:55], a[80:83], v[120:123]
    ds_read_b64_tr_b16 a[6:7], v51 offset:1024
    v_mfma_f32_16x16x32_bf16 v[124:127], a[56:59], a[80:83], v[124:127]
    ds_read_b64_tr_b16 a[8:9], v52 offset:0
    v_mfma_f32_16x16x32_bf16 v[156:159], a[56:59], a[84:87], v[156:159]
    ds_read_b64_tr_b16 a[10:11], v52 offset:1024
    v_mfma_f32_16x16x32_bf16 v[188:191], a[56:59], a[88:91], v[188:191]
    buffer_load_dwordx4 v46, s[20:23], s37 offen offset:2048 lds
    v_mfma_f32_16x16x32_bf16 v[220:223], a[56:59], a[92:95], v[220:223]
    ds_read_b64_tr_b16 a[12:13], v53 offset:0
    v_mfma_f32_16x16x32_bf16 v[224:227], a[60:63], a[92:95], v[224:227]
    ds_read_b64_tr_b16 a[14:15], v53 offset:1024
    v_mfma_f32_16x16x32_bf16 v[192:195], a[60:63], a[88:91], v[192:195]
    ds_read_b64_tr_b16 a[16:17], v54 offset:0
    v_mfma_f32_16x16x32_bf16 v[160:163], a[60:63], a[84:87], v[160:163]
    ds_read_b64_tr_b16 a[18:19], v54 offset:1024
    v_mfma_f32_16x16x32_bf16 v[128:131], a[60:63], a[80:83], v[128:131]
    buffer_load_dwordx4 v47, s[20:23], s37 offen offset:3072 lds
    v_mfma_f32_16x16x32_bf16 v[132:135], a[64:67], a[80:83], v[132:135]
    ds_read_b64_tr_b16 a[20:21], v55 offset:0
    v_mfma_f32_16x16x32_bf16 v[164:167], a[64:67], a[84:87], v[164:167]
    ds_read_b64_tr_b16 a[22:23], v55 offset:1024
    v_mfma_f32_16x16x32_bf16 v[196:199], a[64:67], a[88:91], v[196:199]
    ds_read_b64_tr_b16 a[24:25], v56 offset:0
    v_mfma_f32_16x16x32_bf16 v[228:231], a[64:67], a[92:95], v[228:231]
    s_add_u32 m0, s38, 16384
    s_mov_b32 s36, 640
    ds_read_b64_tr_b16 a[26:27], v56 offset:1024
    v_mfma_f32_16x16x32_bf16 v[232:235], a[68:71], a[92:95], v[232:235]
    buffer_load_dwordx4 v36, s[16:19], s36 offen offset:0 lds
    v_mfma_f32_16x16x32_bf16 v[200:203], a[68:71], a[88:91], v[200:203]
    ds_read_b64_tr_b16 a[28:29], v57 offset:0
    v_mfma_f32_16x16x32_bf16 v[168:171], a[68:71], a[84:87], v[168:171]
    ds_read_b64_tr_b16 a[30:31], v57 offset:1024
    v_mfma_f32_16x16x32_bf16 v[136:139], a[68:71], a[80:83], v[136:139]
    v_mfma_f32_16x16x32_bf16 v[140:143], a[72:75], a[80:83], v[140:143]
    v_mfma_f32_16x16x32_bf16 v[172:175], a[72:75], a[84:87], v[172:175]
    buffer_load_dwordx4 v37, s[16:19], s36 offen offset:1024 lds
    v_mfma_f32_16x16x32_bf16 v[204:207], a[72:75], a[88:91], v[204:207]
    v_mfma_f32_16x16x32_bf16 v[236:239], a[72:75], a[92:95], v[236:239]
    v_mfma_f32_16x16x32_bf16 v[240:243], a[76:79], a[92:95], v[240:243]
    v_mfma_f32_16x16x32_bf16 v[208:211], a[76:79], a[88:91], v[208:211]
    v_mfma_f32_16x16x32_bf16 v[176:179], a[76:79], a[84:87], v[176:179]
    v_mfma_f32_16x16x32_bf16 v[144:147], a[76:79], a[80:83], v[144:147]
    s_waitcnt lgkmcnt(0)
    v_mfma_f32_16x16x32_bf16 v[100:103], a[0:3], v[32:35], v[100:103]
    ds_read_b64_tr_b16 a[48:49], v50 offset:8192
    v_mfma_f32_16x16x32_bf16 v[104:107], a[4:7], v[32:35], v[104:107]
    ds_read_b64_tr_b16 a[50:51], v50 offset:9216
    v_mfma_f32_16x16x32_bf16 v[116:119], a[0:3], a[32:35], v[116:119]
    buffer_load_dwordx4 v38, s[16:19], s36 offen offset:2048 lds
    v_mfma_f32_16x16x32_bf16 v[148:151], a[0:3], a[36:39], v[148:151]
    ds_read_b128 a[80:83], v49 offset:0
    v_mfma_f32_16x16x32_bf16 v[180:183], a[0:3], a[40:43], v[180:183]
    ds_read_b128 a[84:87], v49 offset:2048
    v_mfma_f32_16x16x32_bf16 v[212:215], a[0:3], a[44:47], v[212:215]
    ds_read_b128 a[88:91], v49 offset:4096
    v_mfma_f32_16x16x32_bf16 v[216:219], a[4:7], a[44:47], v[216:219]
    ds_read_b128 a[92:95], v49 offset:6144
    v_mfma_f32_16x16x32_bf16 v[184:187], a[4:7], a[40:43], v[184:187]
    buffer_load_dwordx4 v39, s[16:19], s36 offen offset:3072 lds
    v_mfma_f32_16x16x32_bf16 v[152:155], a[4:7], a[36:39], v[152:155]
    ds_read_b64_tr_b16 a[52:53], v51 offset:8192
    v_mfma_f32_16x16x32_bf16 v[120:123], a[4:7], a[32:35], v[120:123]
    ds_read_b64_tr_b16 a[54:55], v51 offset:9216
    v_mfma_f32_16x16x32_bf16 v[124:127], a[8:11], a[32:35], v[124:127]
    ds_read_b64_tr_b16 a[56:57], v52 offset:8192
    v_mfma_f32_16x16x32_bf16 v[156:159], a[8:11], a[36:39], v[156:159]
    s_add_u32 m0, s38, 20480
    ds_read_b64_tr_b16 a[58:59], v52 offset:9216
    v_mfma_f32_16x16x32_bf16 v[188:191], a[8:11], a[40:43], v[188:191]
    buffer_load_dwordx4 v40, s[16:19], s36 offen offset:0 lds
    v_mfma_f32_16x16x32_bf16 v[220:223], a[8:11], a[44:47], v[220:223]
    ds_read_b64_tr_b16 a[60:61], v53 offset:8192
    v_mfma_f32_16x16x32_bf16 v[224:227], a[12:15], a[44:47], v[224:227]
    ds_read_b64_tr_b16 a[62:63], v53 offset:9216
    v_mfma_f32_16x16x32_bf16 v[192:195], a[12:15], a[40:43], v[192:195]
    ds_read_b64_tr_b16 a[64:65], v54 offset:8192
    v_mfma_f32_16x16x32_bf16 v[160:163], a[12:15], a[36:39], v[160:163]
    ds_read_b64_tr_b16 a[66:67], v54 offset:9216
    v_mfma_f32_16x16x32_bf16 v[128:131], a[12:15], a[32:35], v[128:131]
    buffer_load_dwordx4 v41, s[16:19], s36 offen offset:1024 lds
    v_mfma_f32_16x16x32_bf16 v[132:135], a[16:19], a[32:35], v[132:135]
    ds_read_b64_tr_b16 a[68:69], v55 offset:8192
    v_mfma_f32_16x16x32_bf16 v[164:167], a[16:19], a[36:39], v[164:167]
    ds_read_b64_tr_b16 a[70:71], v55 offset:9216
    v_mfma_f32_16x16x32_bf16 v[196:199], a[16:19], a[40:43], v[196:199]
    ds_read_b64_tr_b16 a[72:73], v56 offset:8192
    v_mfma_f32_16x16x32_bf16 v[228:231], a[16:19], a[44:47], v[228:231]
    ds_read_b64_tr_b16 a[74:75], v56 offset:9216
    v_mfma_f32_16x16x32_bf16 v[232:235], a[20:23], a[44:47], v[232:235]
    buffer_load_dwordx4 v42, s[16:19], s36 offen offset:2048 lds
    v_mfma_f32_16x16x32_bf16 v[200:203], a[20:23], a[40:43], v[200:203]
    ds_read_b64_tr_b16 a[76:77], v57 offset:8192
    v_mfma_f32_16x16x32_bf16 v[168:171], a[20:23], a[36:39], v[168:171]
    ds_read_b64_tr_b16 a[78:79], v57 offset:9216
    v_mfma_f32_16x16x32_bf16 v[136:139], a[20:23], a[32:35], v[136:139]
    v_mfma_f32_16x16x32_bf16 v[140:143], a[24:27], a[32:35], v[140:143]
    v_mfma_f32_16x16x32_bf16 v[172:175], a[24:27], a[36:39], v[172:175]
    buffer_load_dwordx4 v43, s[16:19], s36 offen offset:3072 lds
    v_mfma_f32_16x16x32_bf16 v[204:207], a[24:27], a[40:43], v[204:207]
    v_mfma_f32_16x16x32_bf16 v[236:239], a[24:27], a[44:47], v[236:239]
    v_mfma_f32_16x16x32_bf16 v[240:243], a[28:31], a[44:47], v[240:243]
    v_mfma_f32_16x16x32_bf16 v[208:211], a[28:31], a[40:43], v[208:211]
    v_mfma_f32_16x16x32_bf16 v[176:179], a[28:31], a[36:39], v[176:179]
    v_mfma_f32_16x16x32_bf16 v[144:147], a[28:31], a[32:35], v[144:147]
    s_waitcnt vmcnt(13) lgkmcnt(0)
    s_barrier
    v_mfma_f32_16x16x32_bf16 v[100:103], a[48:51], v[32:35], v[100:103]
    ds_read_b64_tr_b16 a[0:1], v50 offset:16384
    v_mfma_f32_16x16x32_bf16 v[104:107], a[52:55], v[32:35], v[104:107]
    s_add_u32 m0, s39, 0
    s_mov_b32 s37, 3145728
    ds_read_b64_tr_b16 a[2:3], v50 offset:17408
    v_mfma_f32_16x16x32_bf16 v[116:119], a[48:51], a[80:83], v[116:119]
    buffer_load_dwordx4 v44, s[20:23], s37 offen offset:0 lds
    v_mfma_f32_16x16x32_bf16 v[148:151], a[48:51], a[84:87], v[148:151]
    ds_read_b128 a[32:35], v48 offset:8192
    v_mfma_f32_16x16x32_bf16 v[180:183], a[48:51], a[88:91], v[180:183]
    ds_read_b128 a[36:39], v48 offset:10240
    v_mfma_f32_16x16x32_bf16 v[212:215], a[48:51], a[92:95], v[212:215]
    ds_read_b128 a[40:43], v48 offset:12288
    v_mfma_f32_16x16x32_bf16 v[216:219], a[52:55], a[92:95], v[216:219]
    ds_read_b128 a[44:47], v48 offset:14336
    v_mfma_f32_16x16x32_bf16 v[184:187], a[52:55], a[88:91], v[184:187]
    buffer_load_dwordx4 v45, s[20:23], s37 offen offset:1024 lds
    v_mfma_f32_16x16x32_bf16 v[152:155], a[52:55], a[84:87], v[152:155]
    ds_read_b64_tr_b16 a[4:5], v51 offset:16384
    v_mfma_f32_16x16x32_bf16 v[120:123], a[52:55], a[80:83], v[120:123]
    ds_read_b64_tr_b16 a[6:7], v51 offset:17408
    v_mfma_f32_16x16x32_bf16 v[124:127], a[56:59], a[80:83], v[124:127]
    ds_read_b64_tr_b16 a[8:9], v52 offset:16384
    v_mfma_f32_16x16x32_bf16 v[156:159], a[56:59], a[84:87], v[156:159]
    ds_read_b64_tr_b16 a[10:11], v52 offset:17408
    v_mfma_f32_16x16x32_bf16 v[188:191], a[56:59], a[88:91], v[188:191]
    buffer_load_dwordx4 v46, s[20:23], s37 offen offset:2048 lds
    v_mfma_f32_16x16x32_bf16 v[220:223], a[56:59], a[92:95], v[220:223]
    ds_read_b64_tr_b16 a[12:13], v53 offset:16384
    v_mfma_f32_16x16x32_bf16 v[224:227], a[60:63], a[92:95], v[224:227]
    ds_read_b64_tr_b16 a[14:15], v53 offset:17408
    v_mfma_f32_16x16x32_bf16 v[192:195], a[60:63], a[88:91], v[192:195]
    ds_read_b64_tr_b16 a[16:17], v54 offset:16384
    v_mfma_f32_16x16x32_bf16 v[160:163], a[60:63], a[84:87], v[160:163]
    ds_read_b64_tr_b16 a[18:19], v54 offset:17408
    v_mfma_f32_16x16x32_bf16 v[128:131], a[60:63], a[80:83], v[128:131]
    buffer_load_dwordx4 v47, s[20:23], s37 offen offset:3072 lds
    v_mfma_f32_16x16x32_bf16 v[132:135], a[64:67], a[80:83], v[132:135]
    ds_read_b64_tr_b16 a[20:21], v55 offset:16384
    v_mfma_f32_16x16x32_bf16 v[164:167], a[64:67], a[84:87], v[164:167]
    ds_read_b64_tr_b16 a[22:23], v55 offset:17408
    v_mfma_f32_16x16x32_bf16 v[196:199], a[64:67], a[88:91], v[196:199]
    ds_read_b64_tr_b16 a[24:25], v56 offset:16384
    v_mfma_f32_16x16x32_bf16 v[228:231], a[64:67], a[92:95], v[228:231]
    s_add_u32 m0, s38, 0
    s_mov_b32 s36, 768
    ds_read_b64_tr_b16 a[26:27], v56 offset:17408
    v_mfma_f32_16x16x32_bf16 v[232:235], a[68:71], a[92:95], v[232:235]
    buffer_load_dwordx4 v36, s[16:19], s36 offen offset:0 lds
    v_mfma_f32_16x16x32_bf16 v[200:203], a[68:71], a[88:91], v[200:203]
    ds_read_b64_tr_b16 a[28:29], v57 offset:16384
    v_mfma_f32_16x16x32_bf16 v[168:171], a[68:71], a[84:87], v[168:171]
    ds_read_b64_tr_b16 a[30:31], v57 offset:17408
    v_mfma_f32_16x16x32_bf16 v[136:139], a[68:71], a[80:83], v[136:139]
    v_mfma_f32_16x16x32_bf16 v[140:143], a[72:75], a[80:83], v[140:143]
    v_mfma_f32_16x16x32_bf16 v[172:175], a[72:75], a[84:87], v[172:175]
    buffer_load_dwordx4 v37, s[16:19], s36 offen offset:1024 lds
    v_mfma_f32_16x16x32_bf16 v[204:207], a[72:75], a[88:91], v[204:207]
    v_mfma_f32_16x16x32_bf16 v[236:239], a[72:75], a[92:95], v[236:239]
    v_mfma_f32_16x16x32_bf16 v[240:243], a[76:79], a[92:95], v[240:243]
    v_mfma_f32_16x16x32_bf16 v[208:211], a[76:79], a[88:91], v[208:211]
    v_mfma_f32_16x16x32_bf16 v[176:179], a[76:79], a[84:87], v[176:179]
    v_mfma_f32_16x16x32_bf16 v[144:147], a[76:79], a[80:83], v[144:147]
    s_waitcnt lgkmcnt(0)
    v_mfma_f32_16x16x32_bf16 v[100:103], a[0:3], v[32:35], v[100:103]
    ds_read_b64_tr_b16 a[48:49], v50 offset:24576
    v_mfma_f32_16x16x32_bf16 v[104:107], a[4:7], v[32:35], v[104:107]
    ds_read_b64_tr_b16 a[50:51], v50 offset:25600
    v_mfma_f32_16x16x32_bf16 v[116:119], a[0:3], a[32:35], v[116:119]
    buffer_load_dwordx4 v38, s[16:19], s36 offen offset:2048 lds
    v_mfma_f32_16x16x32_bf16 v[148:151], a[0:3], a[36:39], v[148:151]
    ds_read_b128 a[80:83], v49 offset:8192
    v_mfma_f32_16x16x32_bf16 v[180:183], a[0:3], a[40:43], v[180:183]
    ds_read_b128 a[84:87], v49 offset:10240
    v_mfma_f32_16x16x32_bf16 v[212:215], a[0:3], a[44:47], v[212:215]
    ds_read_b128 a[88:91], v49 offset:12288
    v_mfma_f32_16x16x32_bf16 v[216:219], a[4:7], a[44:47], v[216:219]
    ds_read_b128 a[92:95], v49 offset:14336
    v_mfma_f32_16x16x32_bf16 v[184:187], a[4:7], a[40:43], v[184:187]
    buffer_load_dwordx4 v39, s[16:19], s36 offen offset:3072 lds
    v_mfma_f32_16x16x32_bf16 v[152:155], a[4:7], a[36:39], v[152:155]
    ds_read_b64_tr_b16 a[52:53], v51 offset:24576
    v_mfma_f32_16x16x32_bf16 v[120:123], a[4:7], a[32:35], v[120:123]
    ds_read_b64_tr_b16 a[54:55], v51 offset:25600
    v_mfma_f32_16x16x32_bf16 v[124:127], a[8:11], a[32:35], v[124:127]
    ds_read_b64_tr_b16 a[56:57], v52 offset:24576
    v_mfma_f32_16x16x32_bf16 v[156:159], a[8:11], a[36:39], v[156:159]
    s_add_u32 m0, s38, 4096
    ds_read_b64_tr_b16 a[58:59], v52 offset:25600
    v_mfma_f32_16x16x32_bf16 v[188:191], a[8:11], a[40:43], v[188:191]
    buffer_load_dwordx4 v40, s[16:19], s36 offen offset:0 lds
    v_mfma_f32_16x16x32_bf16 v[220:223], a[8:11], a[44:47], v[220:223]
    ds_read_b64_tr_b16 a[60:61], v53 offset:24576
    v_mfma_f32_16x16x32_bf16 v[224:227], a[12:15], a[44:47], v[224:227]
    ds_read_b64_tr_b16 a[62:63], v53 offset:25600
    v_mfma_f32_16x16x32_bf16 v[192:195], a[12:15], a[40:43], v[192:195]
    ds_read_b64_tr_b16 a[64:65], v54 offset:24576
    v_mfma_f32_16x16x32_bf16 v[160:163], a[12:15], a[36:39], v[160:163]
    ds_read_b64_tr_b16 a[66:67], v54 offset:25600
    v_mfma_f32_16x16x32_bf16 v[128:131], a[12:15], a[32:35], v[128:131]
    buffer_load_dwordx4 v41, s[16:19], s36 offen offset:1024 lds
    v_mfma_f32_16x16x32_bf16 v[132:135], a[16:19], a[32:35], v[132:135]
    ds_read_b64_tr_b16 a[68:69], v55 offset:24576
    v_mfma_f32_16x16x32_bf16 v[164:167], a[16:19], a[36:39], v[164:167]
    ds_read_b64_tr_b16 a[70:71], v55 offset:25600
    v_mfma_f32_16x16x32_bf16 v[196:199], a[16:19], a[40:43], v[196:199]
    ds_read_b64_tr_b16 a[72:73], v56 offset:24576
    v_mfma_f32_16x16x32_bf16 v[228:231], a[16:19], a[44:47], v[228:231]
    ds_read_b64_tr_b16 a[74:75], v56 offset:25600
    v_mfma_f32_16x16x32_bf16 v[232:235], a[20:23], a[44:47], v[232:235]
    buffer_load_dwordx4 v42, s[16:19], s36 offen offset:2048 lds
    v_mfma_f32_16x16x32_bf16 v[200:203], a[20:23], a[40:43], v[200:203]
    ds_read_b64_tr_b16 a[76:77], v57 offset:24576
    v_mfma_f32_16x16x32_bf16 v[168:171], a[20:23], a[36:39], v[168:171]
    ds_read_b64_tr_b16 a[78:79], v57 offset:25600
    v_mfma_f32_16x16x32_bf16 v[136:139], a[20:23], a[32:35], v[136:139]
    v_mfma_f32_16x16x32_bf16 v[140:143], a[24:27], a[32:35], v[140:143]
    v_mfma_f32_16x16x32_bf16 v[172:175], a[24:27], a[36:39], v[172:175]
    buffer_load_dwordx4 v43, s[16:19], s36 offen offset:3072 lds
    v_mfma_f32_16x16x32_bf16 v[204:207], a[24:27], a[40:43], v[204:207]
    v_mfma_f32_16x16x32_bf16 v[236:239], a[24:27], a[44:47], v[236:239]
    v_mfma_f32_16x16x32_bf16 v[240:243], a[28:31], a[44:47], v[240:243]
    v_mfma_f32_16x16x32_bf16 v[208:211], a[28:31], a[40:43], v[208:211]
    v_mfma_f32_16x16x32_bf16 v[176:179], a[28:31], a[36:39], v[176:179]
    v_mfma_f32_16x16x32_bf16 v[144:147], a[28:31], a[32:35], v[144:147]
    s_waitcnt vmcnt(12) lgkmcnt(0)
    s_barrier
    s_cmp_lg_u32 s5, 0
    s_cbranch_scc1 L_signalled
    s_mov_b64 exec, 1
    buffer_atomic_add v27, off, s[92:95], s74 sc1
    s_mov_b64 exec, -1
L_signalled:
    v_mfma_f32_16x16x32_bf16 v[100:103], a[48:51], v[32:35], v[100:103]
    ds_read_b64_tr_b16 a[0:1], v50 offset:32768
    v_mfma_f32_16x16x32_bf16 v[104:107], a[52:55], v[32:35], v[104:107]
    s_add_u32 m0, s39, 16384
    s_mov_b32 s37, 3670016
    ds_read_b64_tr_b16 a[2:3], v50 offset:33792
    v_mfma_f32_16x16x32_bf16 v[116:119], a[48:51], a[80:83], v[116:119]
    buffer_load_dwordx4 v44, s[20:23], s37 offen offset:0 lds
    v_mfma_f32_16x16x32_bf16 v[148:151], a[48:51], a[84:87], v[148:151]
    ds_read_b128 a[32:35], v48 offset:16384
    v_mfma_f32_16x16x32_bf16 v[180:183], a[48:51], a[88:91], v[180:183]
    ds_read_b128 a[36:39], v48 offset:18432
    v_mfma_f32_16x16x32_bf16 v[212:215], a[48:51], a[92:95], v[212:215]
    buffer_load_dwordx4 v45, s[20:23], s37 offen offset:1024 lds
    v_mfma_f32_16x16x32_bf16 v[216:219], a[52:55], a[92:95], v[216:219]
    ds_read_b128 a[40:43], v48 offset:20480
    v_mfma_f32_16x16x32_bf16 v[184:187], a[52:55], a[88:91], v[184:187]
    ds_read_b128 a[44:47], v48 offset:22528
    v_mfma_f32_16x16x32_bf16 v[152:155], a[52:55], a[84:87], v[152:155]
    ds_read_b64_tr_b16 a[4:5], v51 offset:32768
    v_mfma_f32_16x16x32_bf16 v[120:123], a[52:55], a[80:83], v[120:123]
    buffer_load_dwordx4 v46, s[20:23], s37 offen offset:2048 lds
    v_mfma_f32_16x16x32_bf16 v[124:127], a[56:59], a[80:83], v[124:127]
    ds_read_b64_tr_b16 a[6:7], v51 offset:33792
    v_mfma_f32_16x16x32_bf16 v[156:159], a[56:59], a[84:87], v[156:159]
    ds_read_b64_tr_b16 a[8:9], v52 offset:32768
    v_mfma_f32_16x16x32_bf16 v[188:191], a[56:59], a[88:91], v[188:191]
    ds_read_b64_tr_b16 a[10:11], v52 offset:33792
    v_mfma_f32_16x16x32_bf16 v[220:223], a[56:59], a[92:95], v[220:223]
    buffer_load_dwordx4 v47, s[20:23], s37 offen offset:3072 lds
    v_mfma_f32_16x16x32_bf16 v[224:227], a[60:63], a[92:95], v[224:227]
    ds_read_b64_tr_b16 a[12:13], v53 offset:32768
    v_mfma_f32_16x16x32_bf16 v[192:195], a[60:63], a[88:91], v[192:195]
    ds_read_b64_tr_b16 a[14:15], v53 offset:33792
    v_mfma_f32_16x16x32_bf16 v[160:163], a[60:63], a[84:87], v[160:163]
    s_add_u32 m0, s38, 8192
    s_mov_b32 s36, 896
    ds_read_b64_tr_b16 a[16:17], v54 offset:32768
    v_mfma_f32_16x16x32_bf16 v[128:131], a[60:63], a[80:83], v[128:131]
    buffer_load_dwordx4 v36, s[16:19], s36 offen offset:0 lds
    v_mfma_f32_16x16x32_bf16 v[132:135], a[64:67], a[80:83], v[132:135]
    ds_read_b64_tr_b16 a[18:19], v54 offset:33792
    v_mfma_f32_16x16x32_bf16 v[164:167], a[64:67], a[84:87], v[164:167]
    ds_read_b64_tr_b16 a[20:21], v55 offset:32768
    v_mfma_f32_16x16x32_bf16 v[196:199], a[64:67], a[88:91], v[196:199]
    buffer_load_dwordx4 v37, s[16:19], s36 offen offset:1024 lds
    v_mfma_f32_16x16x32_bf16 v[228:231], a[64:67], a[92:95], v[228:231]
    ds_read_b64_tr_b16 a[22:23], v55 offset:33792
    v_mfma_f32_16x16x32_bf16 v[232:235], a[68:71], a[92:95], v[232:235]
    ds_read_b64_tr_b16 a[24:25], v56 offset:32768
    v_mfma_f32_16x16x32_bf16 v[200:203], a[68:71], a[88:91], v[200:203]
    ds_read_b64_tr_b16 a[26:27], v56 offset:33792
    v_mfma_f32_16x16x32_bf16 v[168:171], a[68:71], a[84:87], v[168:171]
    buffer_load_dwordx4 v38, s[16:19], s36 offen offset:2048 lds
    v_mfma_f32_16x16x32_bf16 v[136:139], a[68:71], a[80:83], v[136:139]
    ds_read_b64_tr_b16 a[28:29], v57 offset:32768
    v_mfma_f32_16x16x32_bf16 v[140:143], a[72:75], a[80:83], v[140:143]
    ds_read_b64_tr_b16 a[30:31], v57 offset:33792
    v_mfma_f32_16x16x32_bf16 v[172:175], a[72:75], a[84:87], v[172:175]
    v_mfma_f32_16x16x32_bf16 v[204:207], a[72:75], a[88:91], v[204:207]
    buffer_load_dwordx4 v39, s[16:19], s36 offen offset:3072 lds
    v_mfma_f32_16x16x32_bf16 v[236:239], a[72:75], a[92:95], v[236:239]
    v_mfma_f32_16x16x32_bf16 v[240:243], a[76:79], a[92:95], v[240:243]
    v_mfma_f32_16x16x32_bf16 v[208:211], a[76:79], a[88:91], v[208:211]
    v_mfma_f32_16x16x32_bf16 v[176:179], a[76:79], a[84:87], v[176:179]
    v_mfma_f32_16x16x32_bf16 v[144:147], a[76:79], a[80:83], v[144:147]
    s_waitcnt lgkmcnt(0)
    v_mfma_f32_16x16x32_bf16 v[100:103], a[0:3], v[32:35], v[100:103]
    ds_read_b64_tr_b16 a[48:49], v50 offset:40960
    v_mfma_f32_16x16x32_bf16 v[104:107], a[4:7], v[32:35], v[104:107]
    s_add_u32 m0, s38, 12288
    ds_read_b64_tr_b16 a[50:51], v50 offset:41984
    v_mfma_f32_16x16x32_bf16 v[116:119], a[0:3], a[32:35], v[116:119]
    buffer_load_dwordx4 v40, s[16:19], s36 offen offset:0 lds
    v_mfma_f32_16x16x32_bf16 v[148:151], a[0:3], a[36:39], v[148:151]
    ds_read_b128 a[80:83], v49 offset:16384
    v_mfma_f32_16x16x32_bf16 v[180:183], a[0:3], a[40:43], v[180:183]
    ds_read_b128 a[84:87], v49 offset:18432
    v_mfma_f32_16x16x32_bf16 v[212:215], a[0:3], a[44:47], v[212:215]
    buffer_load_dwordx4 v41, s[16:19], s36 offen offset:1024 lds
    v_mfma_f32_16x16x32_bf16 v[216:219], a[4:7], a[44:47], v[216:219]
    ds_read_b128 a[88:91], v49 offset:20480
    v_mfma_f32_16x16x32_bf16 v[184:187], a[4:7], a[40:43], v[184:187]
    ds_read_b128 a[92:95], v49 offset:22528
    v_mfma_f32_16x16x32_bf16 v[152:155], a[4:7], a[36:39], v[152:155]
    ds_read_b64_tr_b16 a[52:53], v51 offset:40960
    v_mfma_f32_16x16x32_bf16 v[120:123], a[4:7], a[32:35], v[120:123]
    buffer_load_dwordx4 v42, s[16:19], s36 offen offset:2048 lds
    v_mfma_f32_16x16x32_bf16 v[124:127], a[8:11], a[32:35], v[124:127]
    ds_read_b64_tr_b16 a[54:55], v51 offset:41984
    v_mfma_f32_16x16x32_bf16 v[156:159], a[8:11], a[36:39], v[156:159]
    ds_read_b64_tr_b16 a[56:57], v52 offset:40960
    v_mfma_f32_16x16x32_bf16 v[188:191], a[8:11], a[40:43], v[188:191]
    ds_read_b64_tr_b16 a[58:59], v52 offset:41984
    v_mfma_f32_16x16x32_bf16 v[220:223], a[8:11], a[44:47], v[220:223]
    buffer_load_dwordx4 v43, s[16:19], s36 offen offset:3072 lds
    v_mfma_f32_16x16x32_bf16 v[224:227], a[12:15], a[44:47], v[224:227]
    ds_read_b64_tr_b16 a[60:61], v53 offset:40960
    v_mfma_f32_16x16x32_bf16 v[192:195], a[12:15], a[40:43], v[192:195]
    ds_read_b64_tr_b16 a[62:63], v53 offset:41984
    v_mfma_f32_16x16x32_bf16 v[160:163], a[12:15], a[36:39], v[160:163]
    s_add_u32 m0, s34, 49152
    ds_read_b64_tr_b16 a[64:65], v54 offset:40960
    v_mfma_f32_16x16x32_bf16 v[128:131], a[12:15], a[32:35], v[128:131]
    buffer_load_dwordx4 v13, s[8:11], s28 offen offset:0 lds
    v_mfma_f32_16x16x32_bf16 v[132:135], a[16:19], a[32:35], v[132:135]
    ds_read_b64_tr_b16 a[66:67], v54 offset:41984
    v_mfma_f32_16x16x32_bf16 v[164:167], a[16:19], a[36:39], v[164:167]
    ds_read_b64_tr_b16 a[68:69], v55 offset:40960
    v_mfma_f32_16x16x32_bf16 v[196:199], a[16:19], a[40:43], v[196:199]
    buffer_load_dwordx4 v14, s[8:11], s28 offen offset:1024 lds
    v_mfma_f32_16x16x32_bf16 v[228:231], a[16:19], a[44:47], v[228:231]
    ds_read_b64_tr_b16 a[70:71], v55 offset:41984
    v_mfma_f32_16x16x32_bf16 v[232:235], a[20:23], a[44:47], v[232:235]
    ds_read_b64_tr_b16 a[72:73], v56 offset:40960
    v_mfma_f32_16x16x32_bf16 v[200:203], a[20:23], a[40:43], v[200:203]
    ds_read_b64_tr_b16 a[74:75], v56 offset:41984
    v_mfma_f32_16x16x32_bf16 v[168:171], a[20:23], a[36:39], v[168:171]
    buffer_load_dwordx4 v15, s[8:11], s28 offen offset:2048 lds
    v_mfma_f32_16x16x32_bf16 v[136:139], a[20:23], a[32:35], v[136:139]
    ds_read_b64_tr_b16 a[76:77], v57 offset:40960
    v_mfma_f32_16x16x32_bf16 v[140:143], a[24:27], a[32:35], v[140:143]
    ds_read_b64_tr_b16 a[78:79], v57 offset:41984
    v_mfma_f32_16x16x32_bf16 v[172:175], a[24:27], a[36:39], v[172:175]
    v_mfma_f32_16x16x32_bf16 v[204:207], a[24:27], a[40:43], v[204:207]
    buffer_load_dwordx4 v16, s[8:11], s28 offen offset:3072 lds
    v_mfma_f32_16x16x32_bf16 v[236:239], a[24:27], a[44:47], v[236:239]
    v_mfma_f32_16x16x32_bf16 v[240:243], a[28:31], a[44:47], v[240:243]
    v_mfma_f32_16x16x32_bf16 v[208:211], a[28:31], a[40:43], v[208:211]
    v_mfma_f32_16x16x32_bf16 v[176:179], a[28:31], a[36:39], v[176:179]
    v_mfma_f32_16x16x32_bf16 v[144:147], a[28:31], a[32:35], v[144:147]
    s_add_u32 s28, s28, 16384
    s_waitcnt vmcnt(16) lgkmcnt(0)
    s_barrier
    v_mfma_f32_16x16x32_bf16 v[100:103], a[48:51], v[32:35], v[100:103]
    ds_read_b64_tr_b16 a[0:1], v50 offset:0
    v_mfma_f32_16x16x32_bf16 v[104:107], a[52:55], v[32:35], v[104:107]
    s_add_u32 m0, s39, 32768
    s_mov_b32 s37, 4194304
    ds_read_b64_tr_b16 a[2:3], v50 offset:1024
    v_mfma_f32_16x16x32_bf16 v[116:119], a[48:51], a[80:83], v[116:119]
    buffer_load_dwordx4 v44, s[20:23], s37 offen offset:0 lds
    v_mfma_f32_16x16x32_bf16 v[148:151], a[48:51], a[84:87], v[148:151]
    ds_read_b128 a[32:35], v48 offset:0
    v_mfma_f32_16x16x32_bf16 v[180:183], a[48:51], a[88:91], v[180:183]
    ds_read_b128 a[36:39], v48 offset:2048
    v_mfma_f32_16x16x32_bf16 v[212:215], a[48:51], a[92:95], v[212:215]
    ds_read_b128 a[40:43], v48 offset:4096
    v_mfma_f32_16x16x32_bf16 v[216:219], a[52:55], a[92:95], v[216:219]
    ds_read_b128 a[44:47], v48 offset:6144
    v_mfma_f32_16x16x32_bf16 v[184:187], a[52:55], a[88:91], v[184:187]
    buffer_load_dwordx4 v45, s[20:23], s37 offen offset:1024 lds
    v_mfma_f32_16x16x32_bf16 v[152:155], a[52:55], a[84:87], v[152:155]
    ds_read_b64_tr_b16 a[4:5], v51 offset:0
    v_mfma_f32_16x16x32_bf16 v[120:123], a[52:55], a[80:83], v[120:123]
    ds_read_b64_tr_b16 a[6:7], v51 offset:1024
    v_mfma_f32_16x16x32_bf16 v[124:127], a[56:59], a[80:83], v[124:127]
    ds_read_b64_tr_b16 a[8:9], v52 offset:0
    v_mfma_f32_16x16x32_bf16 v[156:159], a[56:59], a[84:87], v[156:159]
    ds_read_b64_tr_b16 a[10:11], v52 offset:1024
    v_mfma_f32_16x16x32_bf16 v[188:191], a[56:59], a[88:91], v[188:191]
    buffer_load_dwordx4 v46, s[20:23], s37 offen offset:2048 lds
    v_mfma_f32_16x16x32_bf16 v[220:223], a[56:59], a[92:95], v[220:223]
    ds_read_b64_tr_b16 a[12:13], v53 offset:0
    v_mfma_f32_16x16x32_bf16 v[224:227], a[60:63], a[92:95], v[224:227]
    ds_read_b64_tr_b16 a[14:15], v53 offset:1024
    v_mfma_f32_16x16x32_bf16 v[192:195], a[60:63], a[88:91], v[192:195]
    ds_read_b64_tr_b16 a[16:17], v54 offset:0
    v_mfma_f32_16x16x32_bf16 v[160:163], a[60:63], a[84:87], v[160:163]
    ds_read_b64_tr_b16 a[18:19], v54 offset:1024
    v_mfma_f32_16x16x32_bf16 v[128:131], a[60:63], a[80:83], v[128:131]
    buffer_load_dwordx4 v47, s[20:23], s37 offen offset:3072 lds
    v_mfma_f32_16x16x32_bf16 v[132:135], a[64:67], a[80:83], v[132:135]
    ds_read_b64_tr_b16 a[20:21], v55 offset:0
    v_mfma_f32_16x16x32_bf16 v[164:167], a[64:67], a[84:87], v[164:167]
    ds_read_b64_tr_b16 a[22:23], v55 offset:1024
    v_mfma_f32_16x16x32_bf16 v[196:199], a[64:67], a[88:91], v[196:199]
    ds_read_b64_tr_b16 a[24:25], v56 offset:0
    v_mfma_f32_16x16x32_bf16 v[228:231], a[64:67], a[92:95], v[228:231]
    s_add_u32 m0, s38, 16384
    s_mov_b32 s36, 1024
    ds_read_b64_tr_b16 a[26:27], v56 offset:1024
    v_mfma_f32_16x16x32_bf16 v[232:235], a[68:71], a[92:95], v[232:235]
    buffer_load_dwordx4 v36, s[16:19], s36 offen offset:0 lds
    v_mfma_f32_16x16x32_bf16 v[200:203], a[68:71], a[88:91], v[200:203]
    ds_read_b64_tr_b16 a[28:29], v57 offset:0
    v_mfma_f32_16x16x32_bf16 v[168:171], a[68:71], a[84:87], v[168:171]
    ds_read_b64_tr_b16 a[30:31], v57 offset:1024
    v_mfma_f32_16x16x32_bf16 v[136:139], a[68:71], a[80:83], v[136:139]
    v_mfma_f32_16x16x32_bf16 v[140:143], a[72:75], a[80:83], v[140:143]
    v_mfma_f32_16x16x32_bf16 v[172:175], a[72:75], a[84:87], v[172:175]
    buffer_load_dwordx4 v37, s[16:19], s36 offen offset:1024 lds
    v_mfma_f32_16x16x32_bf16 v[204:207], a[72:75], a[88:91], v[204:207]
    v_mfma_f32_16x16x32_bf16 v[236:239], a[72:75], a[92:95], v[236:239]
    v_mfma_f32_16x16x32_bf16 v[240:243], a[76:79], a[92:95], v[240:243]
    v_mfma_f32_16x16x32_bf16 v[208:211], a[76:79], a[88:91], v[208:211]
    v_mfma_f32_16x16x32_bf16 v[176:179], a[76:79], a[84:87], v[176:179]
    v_mfma_f32_16x16x32_bf16 v[144:147], a[76:79], a[80:83], v[144:147]
    s_waitcnt lgkmcnt(0)
    v_mfma_f32_16x16x32_bf16 v[100:103], a[0:3], v[32:35], v[100:103]
    ds_read_b64_tr_b16 a[48:49], v50 offset:8192
    v_mfma_f32_16x16x32_bf16 v[104:107], a[4:7], v[32:35], v[104:107]
    ds_read_b64_tr_b16 a[50:51], v50 offset:9216
    v_mfma_f32_16x16x32_bf16 v[116:119], a[0:3], a[32:35], v[116:119]
    buffer_load_dwordx4 v38, s[16:19], s36 offen offset:2048 lds
    v_mfma_f32_16x16x32_bf16 v[148:151], a[0:3], a[36:39], v[148:151]
    ds_read_b128 a[80:83], v49 offset:0
    v_mfma_f32_16x16x32_bf16 v[180:183], a[0:3], a[40:43], v[180:183]
    ds_read_b128 a[84:87], v49 offset:2048
    v_mfma_f32_16x16x32_bf16 v[212:215], a[0:3], a[44:47], v[212:215]
    ds_read_b128 a[88:91], v49 offset:4096
    v_mfma_f32_16x16x32_bf16 v[216:219], a[4:7], a[44:47], v[216:219]
    ds_read_b128 a[92:95], v49 offset:6144
    v_mfma_f32_16x16x32_bf16 v[184:187], a[4:7], a[40:43], v[184:187]
    buffer_load_dwordx4 v39, s[16:19], s36 offen offset:3072 lds
    v_mfma_f32_16x16x32_bf16 v[152:155], a[4:7], a[36:39], v[152:155]
    ds_read_b64_tr_b16 a[52:53], v51 offset:8192
    v_mfma_f32_16x16x32_bf16 v[120:123], a[4:7], a[32:35], v[120:123]
    ds_read_b64_tr_b16 a[54:55], v51 offset:9216
    v_mfma_f32_16x16x32_bf16 v[124:127], a[8:11], a[32:35], v[124:127]
    ds_read_b64_tr_b16 a[56:57], v52 offset:8192
    v_mfma_f32_16x16x32_bf16 v[156:159], a[8:11], a[36:39], v[156:159]
    s_add_u32 m0, s38, 20480
    ds_read_b64_tr_b16 a[58:59], v52 offset:9216
    v_mfma_f32_16x16x32_bf16 v[188:191], a[8:11], a[40:43], v[188:191]
    buffer_load_dwordx4 v40, s[16:19], s36 offen offset:0 lds
    v_mfma_f32_16x16x32_bf16 v[220:223], a[8:11], a[44:47], v[220:223]
    ds_read_b64_tr_b16 a[60:61], v53 offset:8192
    v_mfma_f32_16x16x32_bf16 v[224:227], a[12:15], a[44:47], v[224:227]
    ds_read_b64_tr_b16 a[62:63], v53 offset:9216
    v_mfma_f32_16x16x32_bf16 v[192:195], a[12:15], a[40:43], v[192:195]
    ds_read_b64_tr_b16 a[64:65], v54 offset:8192
    v_mfma_f32_16x16x32_bf16 v[160:163], a[12:15], a[36:39], v[160:163]
    ds_read_b64_tr_b16 a[66:67], v54 offset:9216
    v_mfma_f32_16x16x32_bf16 v[128:131], a[12:15], a[32:35], v[128:131]
    buffer_load_dwordx4 v41, s[16:19], s36 offen offset:1024 lds
    v_mfma_f32_16x16x32_bf16 v[132:135], a[16:19], a[32:35], v[132:135]
    ds_read_b64_tr_b16 a[68:69], v55 offset:8192
    v_mfma_f32_16x16x32_bf16 v[164:167], a[16:19], a[36:39], v[164:167]
    ds_read_b64_tr_b16 a[70:71], v55 offset:9216
    v_mfma_f32_16x16x32_bf16 v[196:199], a[16:19], a[40:43], v[196:199]
    ds_read_b64_tr_b16 a[72:73], v56 offset:8192
    v_mfma_f32_16x16x32_bf16 v[228:231], a[16:19], a[44:47], v[228:231]
    ds_read_b64_tr_b16 a[74:75], v56 offset:9216
    v_mfma_f32_16x16x32_bf16 v[232:235], a[20:23], a[44:47], v[232:235]
    buffer_load_dwordx4 v42, s[16:19], s36 offen offset:2048 lds
    v_mfma_f32_16x16x32_bf16 v[200:203], a[20:23], a[40:43], v[200:203]
    ds_read_b64_tr_b16 a[76:77], v57 offset:8192
    v_mfma_f32_16x16x32_bf16 v[168:171], a[20:23], a[36:39], v[168:171]
    ds_read_b64_tr_b16 a[78:79], v57 offset:9216
    v_mfma_f32_16x16x32_bf16 v[136:139], a[20:23], a[32:35], v[136:139]
    v_mfma_f32_16x16x32_bf16 v[140:143], a[24:27], a[32:35], v[140:143]
    v_mfma_f32_16x16x32_bf16 v[172:175], a[24:27], a[36:39], v[172:175]
    buffer_load_dwordx4 v43, s[16:19], s36 offen offset:3072 lds
    v_mfma_f32_16x16x32_bf16 v[204:207], a[24:27], a[40:43], v[204:207]
    v_mfma_f32_16x16x32_bf16 v[236:239], a[24:27], a[44:47], v[236:239]
    v_mfma_f32_16x16x32_bf16 v[240:243], a[28:31], a[44:47], v[240:243]
    v_mfma_f32_16x16x32_bf16 v[208:211], a[28:31], a[40:43], v[208:211]
    v_mfma_f32_16x16x32_bf16 v[176:179], a[28:31], a[36:39], v[176:179]
    v_mfma_f32_16x16x32_bf16 v[144:147], a[28:31], a[32:35], v[144:147]
    s_waitcnt vmcnt(16) lgkmcnt(0)
    s_barrier
    v_mfma_f32_16x16x32_bf16 v[100:103], a[48:51], v[32:35], v[100:103]
    ds_read_b64_tr_b16 a[0:1], v50 offset:16384
    v_mfma_f32_16x16x32_bf16 v[104:107], a[52:55], v[32:35], v[104:107]
    s_add_u32 m0, s39, 0
    s_mov_b32 s37, 4718592
    ds_read_b64_tr_b16 a[2:3], v50 offset:17408
    v_mfma_f32_16x16x32_bf16 v[116:119], a[48:51], a[80:83], v[116:119]
    buffer_load_dwordx4 v44, s[20:23], s37 offen offset:0 lds
    v_mfma_f32_16x16x32_bf16 v[148:151], a[48:51], a[84:87], v[148:151]
    ds_read_b128 a[32:35], v48 offset:8192
    v_mfma_f32_16x16x32_bf16 v[180:183], a[48:51], a[88:91], v[180:183]
    ds_read_b128 a[36:39], v48 offset:10240
    v_mfma_f32_16x16x32_bf16 v[212:215], a[48:51], a[92:95], v[212:215]
    ds_read_b128 a[40:43], v48 offset:12288
    v_mfma_f32_16x16x32_bf16 v[216:219], a[52:55], a[92:95], v[216:219]
    ds_read_b128 a[44:47], v48 offset:14336
    v_mfma_f32_16x16x32_bf16 v[184:187], a[52:55], a[88:91], v[184:187]
    buffer_load_dwordx4 v45, s[20:23], s37 offen offset:1024 lds
    v_mfma_f32_16x16x32_bf16 v[152:155], a[52:55], a[84:87], v[152:155]
    ds_read_b64_tr_b16 a[4:5], v51 offset:16384
    v_mfma_f32_16x16x32_bf16 v[120:123], a[52:55], a[80:83], v[120:123]
    ds_read_b64_tr_b16 a[6:7], v51 offset:17408
    v_mfma_f32_16x16x32_bf16 v[124:127], a[56:59], a[80:83], v[124:127]
    ds_read_b64_tr_b16 a[8:9], v52 offset:16384
    v_mfma_f32_16x16x32_bf16 v[156:159], a[56:59], a[84:87], v[156:159]
    ds_read_b64_tr_b16 a[10:11], v52 offset:17408
    v_mfma_f32_16x16x32_bf16 v[188:191], a[56:59], a[88:91], v[188:191]
    buffer_load_dwordx4 v46, s[20:23], s37 offen offset:2048 lds
    v_mfma_f32_16x16x32_bf16 v[220:223], a[56:59], a[92:95], v[220:223]
    ds_read_b64_tr_b16 a[12:13], v53 offset:16384
    v_mfma_f32_16x16x32_bf16 v[224:227], a[60:63], a[92:95], v[224:227]
    ds_read_b64_tr_b16 a[14:15], v53 offset:17408
    v_mfma_f32_16x16x32_bf16 v[192:195], a[60:63], a[88:91], v[192:195]
    ds_read_b64_tr_b16 a[16:17], v54 offset:16384
    v_mfma_f32_16x16x32_bf16 v[160:163], a[60:63], a[84:87], v[160:163]
    ds_read_b64_tr_b16 a[18:19], v54 offset:17408
    v_mfma_f32_16x16x32_bf16 v[128:131], a[60:63], a[80:83], v[128:131]
    buffer_load_dwordx4 v47, s[20:23], s37 offen offset:3072 lds
    v_mfma_f32_16x16x32_bf16 v[132:135], a[64:67], a[80:83], v[132:135]
    ds_read_b64_tr_b16 a[20:21], v55 offset:16384
    v_mfma_f32_16x16x32_bf16 v[164:167], a[64:67], a[84:87], v[164:167]
    ds_read_b64_tr_b16 a[22:23], v55 offset:17408
    v_mfma_f32_16x16x32_bf16 v[196:199], a[64:67], a[88:91], v[196:199]
    ds_read_b64_tr_b16 a[24:25], v56 offset:16384
    v_mfma_f32_16x16x32_bf16 v[228:231], a[64:67], a[92:95], v[228:231]
    s_add_u32 m0, s38, 0
    s_mov_b32 s36, 1152
    ds_read_b64_tr_b16 a[26:27], v56 offset:17408
    v_mfma_f32_16x16x32_bf16 v[232:235], a[68:71], a[92:95], v[232:235]
    buffer_load_dword v252, off, s[92:95], s74 sc1
    buffer_load_dwordx4 v36, s[16:19], s36 offen offset:0 lds
    v_mfma_f32_16x16x32_bf16 v[200:203], a[68:71], a[88:91], v[200:203]
    ds_read_b64_tr_b16 a[28:29], v57 offset:16384
    v_mfma_f32_16x16x32_bf16 v[168:171], a[68:71], a[84:87], v[168:171]
    ds_read_b64_tr_b16 a[30:31], v57 offset:17408
    v_mfma_f32_16x16x32_bf16 v[136:139], a[68:71], a[80:83], v[136:139]
    v_mfma_f32_16x16x32_bf16 v[140:143], a[72:75], a[80:83], v[140:143]
    v_mfma_f32_16x16x32_bf16 v[172:175], a[72:75], a[84:87], v[172:175]
    buffer_load_dwordx4 v37, s[16:19], s36 offen offset:1024 lds
    v_mfma_f32_16x16x32_bf16 v[204:207], a[72:75], a[88:91], v[204:207]
    v_mfma_f32_16x16x32_bf16 v[236:239], a[72:75], a[92:95], v[236:239]
    v_mfma_f32_16x16x32_bf16 v[240:243], a[76:79], a[92:95], v[240:243]
    v_mfma_f32_16x16x32_bf16 v[208:211], a[76:79], a[88:91], v[208:211]
    v_mfma_f32_16x16x32_bf16 v[176:179], a[76:79], a[84:87], v[176:179]
    v_mfma_f32_16x16x32_bf16 v[144:147], a[76:79], a[80:83], v[144:147]
    s_waitcnt lgkmcnt(0)
    v_mfma_f32_16x16x32_bf16 v[100:103], a[0:3], v[32:35], v[100:103]
    ds_read_b64_tr_b16 a[48:49], v50 offset:24576
    v_mfma_f32_16x16x32_bf16 v[104:107], a[4:7], v[32:35], v[104:107]
    ds_read_b64_tr_b16 a[50:51], v50 offset:25600
    v_mfma_f32_16x16x32_bf16 v[116:119], a[0:3], a[32:35], v[116:119]
    buffer_load_dwordx4 v38, s[16:19], s36 offen offset:2048 lds
    v_mfma_f32_16x16x32_bf16 v[148:151], a[0:3], a[36:39], v[148:151]
    ds_read_b128 a[80:83], v49 offset:8192
    v_mfma_f32_16x16x32_bf16 v[180:183], a[0:3], a[40:43], v[180:183]
    ds_read_b128 a[84:87], v49 offset:10240
    v_mfma_f32_16x16x32_bf16 v[212:215], a[0:3], a[44:47], v[212:215]
    ds_read_b128 a[88:91], v49 offset:12288
    v_mfma_f32_16x16x32_bf16 v[216:219], a[4:7], a[44:47], v[216:219]
    ds_read_b128 a[92:95], v49 offset:14336
    v_mfma_f32_16x16x32_bf16 v[184:187], a[4:7], a[40:43], v[184:187]
    buffer_load_dwordx4 v39, s[16:19], s36 offen offset:3072 lds
    v_mfma_f32_16x16x32_bf16 v[152:155], a[4:7], a[36:39], v[152:155]
    ds_read_b64_tr_b16 a[52:53], v51 offset:24576
    v_mfma_f32_16x16x32_bf16 v[120:123], a[4:7], a[32:35], v[120:123]
    ds_read_b64_tr_b16 a[54:55], v51 offset:25600
    v_mfma_f32_16x16x32_bf16 v[124:127], a[8:11], a[32:35], v[124:127]
    ds_read_b64_tr_b16 a[56:57], v52 offset:24576
    v_mfma_f32_16x16x32_bf16 v[156:159], a[8:11], a[36:39], v[156:159]
    s_add_u32 m0, s38, 4096
    ds_read_b64_tr_b16 a[58:59], v52 offset:25600
    v_mfma_f32_16x16x32_bf16 v[188:191], a[8:11], a[40:43], v[188:191]
    buffer_load_dwordx4 v40, s[16:19], s36 offen offset:0 lds
    v_mfma_f32_16x16x32_bf16 v[220:223], a[8:11], a[44:47], v[220:223]
    ds_read_b64_tr_b16 a[60:61], v53 offset:24576
    v_mfma_f32_16x16x32_bf16 v[224:227], a[12:15], a[44:47], v[224:227]
    ds_read_b64_tr_b16 a[62:63], v53 offset:25600
    v_mfma_f32_16x16x32_bf16 v[192:195], a[12:15], a[40:43], v[192:195]
    ds_read_b64_tr_b16 a[64:65], v54 offset:24576
    v_mfma_f32_16x16x32_bf16 v[160:163], a[12:15], a[36:39], v[160:163]
    ds_read_b64_tr_b16 a[66:67], v54 offset:25600
    v_mfma_f32_16x16x32_bf16 v[128:131], a[12:15], a[32:35], v[128:131]
    buffer_load_dwordx4 v41, s[16:19], s36 offen offset:1024 lds
    v_mfma_f32_16x16x32_bf16 v[132:135], a[16:19], a[32:35], v[132:135]
    ds_read_b64_tr_b16 a[68:69], v55 offset:24576
    v_mfma_f32_16x16x32_bf16 v[164:167], a[16:19], a[36:39], v[164:167]
    ds_read_b64_tr_b16 a[70:71], v55 offset:25600
    v_mfma_f32_16x16x32_bf16 v[196:199], a[16:19], a[40:43], v[196:199]
    ds_read_b64_tr_b16 a[72:73], v56 offset:24576
    v_mfma_f32_16x16x32_bf16 v[228:231], a[16:19], a[44:47], v[228:231]
    ds_read_b64_tr_b16 a[74:75], v56 offset:25600
    v_mfma_f32_16x16x32_bf16 v[232:235], a[20:23], a[44:47], v[232:235]
    buffer_load_dwordx4 v42, s[16:19], s36 offen offset:2048 lds
    v_mfma_f32_16x16x32_bf16 v[200:203], a[20:23], a[40:43], v[200:203]
    ds_read_b64_tr_b16 a[76:77], v57 offset:24576
    v_mfma_f32_16x16x32_bf16 v[168:171], a[20:23], a[36:39], v[168:171]
    ds_read_b64_tr_b16 a[78:79], v57 offset:25600
    v_mfma_f32_16x16x32_bf16 v[136:139], a[20:23], a[32:35], v[136:139]
    v_mfma_f32_16x16x32_bf16 v[140:143], a[24:27], a[32:35], v[140:143]
    v_mfma_f32_16x16x32_bf16 v[172:175], a[24:27], a[36:39], v[172:175]
    buffer_load_dwordx4 v43, s[16:19], s36 offen offset:3072 lds
    v_mfma_f32_16x16x32_bf16 v[204:207], a[24:27], a[40:43], v[204:207]
    v_mfma_f32_16x16x32_bf16 v[236:239], a[24:27], a[44:47], v[236:239]
    v_mfma_f32_16x16x32_bf16 v[240:243], a[28:31], a[44:47], v[240:243]
    v_mfma_f32_16x16x32_bf16 v[208:211], a[28:31], a[40:43], v[208:211]
    v_mfma_f32_16x16x32_bf16 v[176:179], a[28:31], a[36:39], v[176:179]
    v_mfma_f32_16x16x32_bf16 v[144:147], a[28:31], a[32:35], v[144:147]
    s_waitcnt vmcnt(13) lgkmcnt(0)
    s_barrier
    v_mfma_f32_16x16x32_bf16 v[100:103], a[48:51], v[32:35], v[100:103]
    ds_read_b64_tr_b16 a[0:1], v50 offset:32768
    v_mfma_f32_16x16x32_bf16 v[104:107], a[52:55], v[32:35], v[104:107]
    s_add_u32 m0, s34, 16384
    ds_read_b64_tr_b16 a[2:3], v50 offset:33792
    v_mfma_f32_16x16x32_bf16 v[116:119], a[48:51], a[80:83], v[116:119]
    buffer_load_dwordx4 v13, s[8:11], s28 offen offset:0 lds
    v_mfma_f32_16x16x32_bf16 v[148:151], a[48:51], a[84:87], v[148:151]
    ds_read_b128 a[32:35], v48 offset:16384
    v_mfma_f32_16x16x32_bf16 v[180:183], a[48:51], a[88:91], v[180:183]
    ds_read_b128 a[36:39], v48 offset:18432
    v_mfma_f32_16x16x32_bf16 v[212:215], a[48:51], a[92:95], v[212:215]
    ds_read_b128 a[40:43], v48 offset:20480
    v_mfma_f32_16x16x32_bf16 v[216:219], a[52:55], a[92:95], v[216:219]
    ds_read_b128 a[44:47], v48 offset:22528
    v_mfma_f32_16x16x32_bf16 v[184:187], a[52:55], a[88:91], v[184:187]
    ds_read_b64_tr_b16 a[4:5], v51 offset:32768
    v_mfma_f32_16x16x32_bf16 v[152:155], a[52:55], a[84:87], v[152:155]
    ds_read_b64_tr_b16 a[6:7], v51 offset:33792
    v_mfma_f32_16x16x32_bf16 v[120:123], a[52:55], a[80:83], v[120:123]
    ds_read_b64_tr_b16 a[8:9], v52 offset:32768
    v_mfma_f32_16x16x32_bf16 v[124:127], a[56:59], a[80:83], v[124:127]
    ds_read_b64_tr_b16 a[10:11], v52 offset:33792
    v_mfma_f32_16x16x32_bf16 v[156:159], a[56:59], a[84:87], v[156:159]
    ds_read_b64_tr_b16 a[12:13], v53 offset:32768
    v_mfma_f32_16x16x32_bf16 v[188:191], a[56:59], a[88:91], v[188:191]
    ds_read_b64_tr_b16 a[14:15], v53 offset:33792
    v_mfma_f32_16x16x32_bf16 v[220:223], a[56:59], a[92:95], v[220:223]
    ds_read_b64_tr_b16 a[16:17], v54 offset:32768
    v_mfma_f32_16x16x32_bf16 v[224:227], a[60:63], a[92:95], v[224:227]
    ds_read_b64_tr_b16 a[18:19], v54 offset:33792
    v_mfma_f32_16x16x32_bf16 v[192:195], a[60:63], a[88:91], v[192:195]
    ds_read_b64_tr_b16 a[20:21], v55 offset:32768
    v_mfma_f32_16x16x32_bf16 v[160:163], a[60:63], a[84:87], v[160:163]
    ds_read_b64_tr_b16 a[22:23], v55 offset:33792
    v_mfma_f32_16x16x32_bf16 v[128:131], a[60:63], a[80:83], v[128:131]
    buffer_load_dwordx4 v14, s[8:11], s28 offen offset:1024 lds
    v_mfma_f32_16x16x32_bf16 v[132:135], a[64:67], a[80:83], v[132:135]
    ds_read_b64_tr_b16 a[24:25], v56 offset:32768
    v_mfma_f32_16x16x32_bf16 v[164:167], a[64:67], a[84:87], v[164:167]
    ds_read_b64_tr_b16 a[26:27], v56 offset:33792
    v_mfma_f32_16x16x32_bf16 v[196:199], a[64:67], a[88:91], v[196:199]
    ds_read_b64_tr_b16 a[28:29], v57 offset:32768
    v_mfma_f32_16x16x32_bf16 v[228:231], a[64:67], a[92:95], v[228:231]
    s_waitcnt vmcnt(10)
    v_cmp_gt_u32 vcc, 32, v252
    s_and_b64 vcc, vcc, exec
    s_cbranch_scc1 L_spin_rows
L_back_rows:
    buffer_load_dwordx2 v[108:109], v59, s[76:79], s46 offen offset:0 sc1
    buffer_load_dwordx2 v[110:111], v59, s[76:79], s46 offen offset:256 sc1
    buffer_load_dwordx2 v[112:113], v59, s[76:79], s46 offen offset:512 sc1
    buffer_load_dwordx2 v[114:115], v59, s[76:79], s46 offen offset:768 sc1
    ds_read_b64_tr_b16 a[30:31], v57 offset:33792
    v_mfma_f32_16x16x32_bf16 v[232:235], a[68:71], a[92:95], v[232:235]
    v_mfma_f32_16x16x32_bf16 v[200:203], a[68:71], a[88:91], v[200:203]
    v_mfma_f32_16x16x32_bf16 v[168:171], a[68:71], a[84:87], v[168:171]
    v_mfma_f32_16x16x32_bf16 v[136:139], a[68:71], a[80:83], v[136:139]
    v_mfma_f32_16x16x32_bf16 v[140:143], a[72:75], a[80:83], v[140:143]
    v_mfma_f32_16x16x32_bf16 v[172:175], a[72:75], a[84:87], v[172:175]
    v_mfma_f32_16x16x32_bf16 v[204:207], a[72:75], a[88:91], v[204:207]
    v_mfma_f32_16x16x32_bf16 v[236:239], a[72:75], a[92:95], v[236:239]
    v_mfma_f32_16x16x32_bf16 v[240:243], a[76:79], a[92:95], v[240:243]
    v_mfma_f32_16x16x32_bf16 v[208:211], a[76:79], a[88:91], v[208:211]
    v_mfma_f32_16x16x32_bf16 v[176:179], a[76:79], a[84:87], v[176:179]
    v_mfma_f32_16x16x32_bf16 v[144:147], a[76:79], a[80:83], v[144:147]
    s_waitcnt lgkmcnt(0)
    v_mfma_f32_16x16x32_bf16 v[100:103], a[0:3], v[32:35], v[100:103]
    ds_read_b64_tr_b16 a[48:49], v50 offset:40960
    v_mfma_f32_16x16x32_bf16 v[104:107], a[4:7], v[32:35], v[104:107]
    ds_read_b64_tr_b16 a[50:51], v50 offset:41984
    v_mfma_f32_16x16x32_bf16 v[116:119], a[0:3], a[32:35], v[116:119]
    buffer_load_dwordx4 v15, s[8:11], s28 offen offset:2048 lds
    v_mfma_f32_16x16x32_bf16 v[148:151], a[0:3], a[36:39], v[148:151]
    ds_read_b128 a[80:83], v49 offset:16384
    v_mfma_f32_16x16x32_bf16 v[180:183], a[0:3], a[40:43], v[180:183]
    ds_read_b128 a[84:87], v49 offset:18432
    v_mfma_f32_16x16x32_bf16 v[212:215], a[0:3], a[44:47], v[212:215]
    ds_read_b128 a[88:91], v49 offset:20480
    v_mfma_f32_16x16x32_bf16 v[216:219], a[4:7], a[44:47], v[216:219]
    ds_read_b128 a[92:95], v49 offset:22528
    v_mfma_f32_16x16x32_bf16 v[184:187], a[4:7], a[40:43], v[184:187]
    ds_read_b64_tr_b16 a[52:53], v51 offset:40960
    v_mfma_f32_16x16x32_bf16 v[152:155], a[4:7], a[36:39], v[152:155]
    ds_read_b64_tr_b16 a[54:55], v51 offset:41984
    v_mfma_f32_16x16x32_bf16 v[120:123], a[4:7], a[32:35], v[120:123]
    ds_read_b64_tr_b16 a[56:57], v52 offset:40960
    v_mfma_f32_16x16x32_bf16 v[124:127], a[8:11], a[32:35], v[124:127]
    ds_read_b64_tr_b16 a[58:59], v52 offset:41984
    v_mfma_f32_16x16x32_bf16 v[156:159], a[8:11], a[36:39], v[156:159]
    ds_read_b64_tr_b16 a[60:61], v53 offset:40960
    v_mfma_f32_16x16x32_bf16 v[188:191], a[8:11], a[40:43], v[188:191]
    ds_read_b64_tr_b16 a[62:63], v53 offset:41984
    v_mfma_f32_16x16x32_bf16 v[220:223], a[8:11], a[44:47], v[220:223]
    ds_read_b64_tr_b16 a[64:65], v54 offset:40960
    v_mfma_f32_16x16x32_bf16 v[224:227], a[12:15], a[44:47], v[224:227]
    ds_read_b64_tr_b16 a[66:67], v54 offset:41984
    v_mfma_f32_16x16x32_bf16 v[192:195], a[12:15], a[40:43], v[192:195]
    ds_read_b64_tr_b16 a[68:69], v55 offset:40960
    v_mfma_f32_16x16x32_bf16 v[160:163], a[12:15], a[36:39], v[160:163]
    ds_read_b64_tr_b16 a[70:71], v55 offset:41984
    v_mfma_f32_16x16x32_bf16 v[128:131], a[12:15], a[32:35], v[128:131]
    buffer_load_dwordx4 v16, s[8:11], s28 offen offset:3072 lds
    v_mfma_f32_16x16x32_bf16 v[132:135], a[16:19], a[32:35], v[132:135]
    ds_read_b64_tr_b16 a[72:73], v56 offset:40960
    v_mfma_f32_16x16x32_bf16 v[164:167], a[16:19], a[36:39], v[164:167]
    ds_read_b64_tr_b16 a[74:75], v56 offset:41984
    v_mfma_f32_16x16x32_bf16 v[196:199], a[16:19], a[40:43], v[196:199]
    ds_read_b64_tr_b16 a[76:77], v57 offset:40960
    v_mfma_f32_16x16x32_bf16 v[228:231], a[16:19], a[44:47], v[228:231]
    ds_read_b64_tr_b16 a[78:79], v57 offset:41984
    v_mfma_f32_16x16x32_bf16 v[232:235], a[20:23], a[44:47], v[232:235]
    v_mfma_f32_16x16x32_bf16 v[200:203], a[20:23], a[40:43], v[200:203]
    v_mfma_f32_16x16x32_bf16 v[168:171], a[20:23], a[36:39], v[168:171]
    v_mfma_f32_16x16x32_bf16 v[136:139], a[20:23], a[32:35], v[136:139]
    v_mfma_f32_16x16x32_bf16 v[140:143], a[24:27], a[32:35], v[140:143]
    v_mfma_f32_16x16x32_bf16 v[172:175], a[24:27], a[36:39], v[172:175]
    v_mfma_f32_16x16x32_bf16 v[204:207], a[24:27], a[40:43], v[204:207]
    v_mfma_f32_16x16x32_bf16 v[236:239], a[24:27], a[44:47], v[236:239]
    v_mfma_f32_16x16x32_bf16 v[240:243], a[28:31], a[44:47], v[240:243]
    v_mfma_f32_16x16x32_bf16 v[208:211], a[28:31], a[40:43], v[208:211]
    v_mfma_f32_16x16x32_bf16 v[176:179], a[28:31], a[36:39], v[176:179]
    v_mfma_f32_16x16x32_bf16 v[144:147], a[28:31], a[32:35], v[144:147]
    s_add_u32 s28, s28, 16384
    s_waitcnt vmcnt(8) lgkmcnt(0)
    s_barrier
    v_mfma_f32_16x16x32_bf16 v[100:103], a[48:51], v[32:35], v[100:103]
    ds_read_b64_tr_b16 a[0:1], v50 offset:0
    v_mfma_f32_16x16x32_bf16 v[104:107], a[52:55], v[32:35], v[104:107]
    s_add_u32 m0, s34, 32768
    ds_read_b64_tr_b16 a[2:3], v50 offset:1024
    v_mfma_f32_16x16x32_bf16 v[116:119], a[48:51], a[80:83], v[116:119]
    buffer_load_dwordx4 v13, s[8:11], s28 offen offset:0 lds
    v_mfma_f32_16x16x32_bf16 v[148:151], a[48:51], a[84:87], v[148:151]
    ds_read_b128 a[32:35], v48 offset:0
    v_mfma_f32_16x16x32_bf16 v[180:183], a[48:51], a[88:91], v[180:183]
    ds_read_b128 a[36:39], v48 offset:2048
    v_mfma_f32_16x16x32_bf16 v[212:215], a[48:51], a[92:95], v[212:215]
    ds_read_b128 a[40:43], v48 offset:4096
    v_mfma_f32_16x16x32_bf16 v[216:219], a[52:55], a[92:95], v[216:219]
    ds_read_b128 a[44:47], v48 offset:6144
    v_mfma_f32_16x16x32_bf16 v[184:187], a[52:55], a[88:91], v[184:187]
    ds_read_b64_tr_b16 a[4:5], v51 offset:0
    v_mfma_f32_16x16x32_bf16 v[152:155], a[52:55], a[84:87], v[152:155]
    ds_read_b64_tr_b16 a[6:7], v51 offset:1024
    v_mfma_f32_16x16x32_bf16 v[120:123], a[52:55], a[80:83], v[120:123]
    buffer_load_dwordx4 v14, s[8:11], s28 offen offset:1024 lds
    v_mfma_f32_16x16x32_bf16 v[124:127], a[56:59], a[80:83], v[124:127]
    ds_read_b64_tr_b16 a[8:9], v52 offset:0
    v_mfma_f32_16x16x32_bf16 v[156:159], a[56:59], a[84:87], v[156:159]
    ds_read_b64_tr_b16 a[10:11], v52 offset:1024
    v_mfma_f32_16x16x32_bf16 v[188:191], a[56:59], a[88:91], v[188:191]
    ds_read_b64_tr_b16 a[12:13], v53 offset:0
    v_mfma_f32_16x16x32_bf16 v[220:223], a[56:59], a[92:95], v[220:223]
    ds_read_b64_tr_b16 a[14:15], v53 offset:1024
    v_mfma_f32_16x16x32_bf16 v[224:227], a[60:63], a[92:95], v[224:227]
    ds_read_b64_tr_b16 a[16:17], v54 offset:0
    v_mfma_f32_16x16x32_bf16 v[192:195], a[60:63], a[88:91], v[192:195]
    ds_read_b64_tr_b16 a[18:19], v54 offset:1024
    v_mfma_f32_16x16x32_bf16 v[160:163], a[60:63], a[84:87], v[160:163]
    ds_read_b64_tr_b16 a[20:21], v55 offset:0
    v_mfma_f32_16x16x32_bf16 v[128:131], a[60:63], a[80:83], v[128:131]
    buffer_load_dwordx4 v15, s[8:11], s28 offen offset:2048 lds
    v_mfma_f32_16x16x32_bf16 v[132:135], a[64:67], a[80:83], v[132:135]
    ds_read_b64_tr_b16 a[22:23], v55 offset:1024
    v_mfma_f32_16x16x32_bf16 v[164:167], a[64:67], a[84:87], v[164:167]
    ds_read_b64_tr_b16 a[24:25], v56 offset:0
    v_mfma_f32_16x16x32_bf16 v[196:199], a[64:67], a[88:91], v[196:199]
    ds_read_b64_tr_b16 a[26:27], v56 offset:1024
    v_mfma_f32_16x16x32_bf16 v[228:231], a[64:67], a[92:95], v[228:231]
    ds_read_b64_tr_b16 a[28:29], v57 offset:0
    v_mfma_f32_16x16x32_bf16 v[232:235], a[68:71], a[92:95], v[232:235]
    ds_read_b64_tr_b16 a[30:31], v57 offset:1024
    v_mfma_f32_16x16x32_bf16 v[200:203], a[68:71], a[88:91], v[200:203]
    v_mfma_f32_16x16x32_bf16 v[168:171], a[68:71], a[84:87], v[168:171]
    buffer_load_dwordx4 v16, s[8:11], s28 offen offset:3072 lds
    v_mfma_f32_16x16x32_bf16 v[136:139], a[68:71], a[80:83], v[136:139]
    v_mfma_f32_16x16x32_bf16 v[140:143], a[72:75], a[80:83], v[140:143]
    v_mfma_f32_16x16x32_bf16 v[172:175], a[72:75], a[84:87], v[172:175]
    v_mfma_f32_16x16x32_bf16 v[204:207], a[72:75], a[88:91], v[204:207]
    v_mfma_f32_16x16x32_bf16 v[236:239], a[72:75], a[92:95], v[236:239]
    v_mfma_f32_16x16x32_bf16 v[240:243], a[76:79], a[92:95], v[240:243]
    v_mfma_f32_16x16x32_bf16 v[208:211], a[76:79], a[88:91], v[208:211]
    v_mfma_f32_16x16x32_bf16 v[176:179], a[76:79], a[84:87], v[176:179]
    v_mfma_f32_16x16x32_bf16 v[144:147], a[76:79], a[80:83], v[144:147]
    s_waitcnt lgkmcnt(0)
    v_mfma_f32_16x16x32_bf16 v[100:103], a[0:3], v[32:35], v[100:103]
    ds_read_b64_tr_b16 a[48:49], v50 offset:8192
    v_mfma_f32_16x16x32_bf16 v[104:107], a[4:7], v[32:35], v[104:107]
    s_add_u32 s28, s28, 16384
    s_mov_b32 m0, s30
    ds_read_b64_tr_b16 a[50:51], v50 offset:9216
    v_mfma_f32_16x16x32_bf16 v[116:119], a[0:3], a[32:35], v[116:119]
    buffer_load_dwordx4 v17, s[12:15], s29 offen offset:0 lds
    v_mfma_f32_16x16x32_bf16 v[148:151], a[0:3], a[36:39], v[148:151]
    ds_read_b64_tr_b16 a[52:53], v51 offset:8192
    v_mfma_f32_16x16x32_bf16 v[180:183], a[0:3], a[40:43], v[180:183]
    ds_read_b64_tr_b16 a[54:55], v51 offset:9216
    v_mfma_f32_16x16x32_bf16 v[212:215], a[0:3], a[44:47], v[212:215]
    ds_read_b128 a[80:83], v49 offset:0
    v_mfma_f32_16x16x32_bf16 v[216:219], a[4:7], a[44:47], v[216:219]
    ds_read_b128 a[84:87], v49 offset:2048
    v_mfma_f32_16x16x32_bf16 v[184:187], a[4:7], a[40:43], v[184:187]
    ds_read_b128 a[88:91], v49 offset:4096
    v_mfma_f32_16x16x32_bf16 v[152:155], a[4:7], a[36:39], v[152:155]
    ds_read_b128 a[92:95], v49 offset:6144
    v_mfma_f32_16x16x32_bf16 v[120:123], a[4:7], a[32:35], v[120:123]
    buffer_load_dwordx4 v18, s[12:15], s29 offen offset:1024 lds
    v_mfma_f32_16x16x32_bf16 v[124:127], a[8:11], a[32:35], v[124:127]
    ds_read_b64_tr_b16 a[56:57], v52 offset:8192
    v_mfma_f32_16x16x32_bf16 v[156:159], a[8:11], a[36:39], v[156:159]
    ds_read_b64_tr_b16 a[58:59], v52 offset:9216
    v_mfma_f32_16x16x32_bf16 v[188:191], a[8:11], a[40:43], v[188:191]
    ds_read_b64_tr_b16 a[60:61], v53 offset:8192
    v_mfma_f32_16x16x32_bf16 v[220:223], a[8:11], a[44:47], v[220:223]
    ds_read_b64_tr_b16 a[62:63], v53 offset:9216
    v_mfma_f32_16x16x32_bf16 v[224:227], a[12:15], a[44:47], v[224:227]
    ds_read_b64_tr_b16 a[64:65], v54 offset:8192
    v_mfma_f32_16x16x32_bf16 v[192:195], a[12:15], a[40:43], v[192:195]
    s_waitcnt lgkmcnt(9)
    ds_read_b64_tr_b16 a[66:67], v54 offset:9216
    v_mfma_f32_16x16x32_bf16 v[100:103], a[48:51], v[32:35], v[100:103]
    ds_read_b64_tr_b16 a[68:69], v55 offset:8192
    v_mfma_f32_16x16x32_bf16 v[104:107], a[52:55], v[32:35], v[104:107]
    buffer_load_dwordx4 v17, s[12:15], s29 offen offset:2048 lds
    v_mfma_f32_16x16x32_bf16 v[160:163], a[12:15], a[36:39], v[160:163]
    ds_read_b64_tr_b16 a[70:71], v55 offset:9216
    v_mfma_f32_16x16x32_bf16 v[128:131], a[12:15], a[32:35], v[128:131]
    ds_read_b64_tr_b16 a[72:73], v56 offset:8192
    v_mfma_f32_16x16x32_bf16 v[132:135], a[16:19], a[32:35], v[132:135]
    ds_read_b64_tr_b16 a[74:75], v56 offset:9216
    v_mfma_f32_16x16x32_bf16 v[164:167], a[16:19], a[36:39], v[164:167]
    ds_read_b64_tr_b16 a[76:77], v57 offset:8192
    v_mfma_f32_16x16x32_bf16 v[196:199], a[16:19], a[40:43], v[196:199]
    ds_read_b64_tr_b16 a[78:79], v57 offset:9216
    v_mfma_f32_16x16x32_bf16 v[228:231], a[16:19], a[44:47], v[228:231]
    ds_write_b128 v58, v[100:103] offset:0
    v_mfma_f32_16x16x32_bf16 v[232:235], a[20:23], a[44:47], v[232:235]
    buffer_load_dwordx4 v18, s[12:15], s29 offen offset:3072 lds
    v_mfma_f32_16x16x32_bf16 v[200:203], a[20:23], a[40:43], v[200:203]
    ds_write_b128 v58, v[104:107] offset:64
    v_mfma_f32_16x16x32_bf16 v[168:171], a[20:23], a[36:39], v[168:171]
    ds_write_b128 v58, v[100:103] offset:512
    v_mfma_f32_16x16x32_bf16 v[136:139], a[20:23], a[32:35], v[136:139]
    ds_write_b128 v58, v[104:107] offset:576
    v_mfma_f32_16x16x32_bf16 v[140:143], a[24:27], a[32:35], v[140:143]
    v_mfma_f32_16x16x32_bf16 v[172:175], a[24:27], a[36:39], v[172:175]
    v_mfma_f32_16x16x32_bf16 v[204:207], a[24:27], a[40:43], v[204:207]
    v_mfma_f32_16x16x32_bf16 v[236:239], a[24:27], a[44:47], v[236:239]
    v_mfma_f32_16x16x32_bf16 v[240:243], a[28:31], a[44:47], v[240:243]
    v_mfma_f32_16x16x32_bf16 v[208:211], a[28:31], a[40:43], v[208:211]
    v_mfma_f32_16x16x32_bf16 v[176:179], a[28:31], a[36:39], v[176:179]
    v_mfma_f32_16x16x32_bf16 v[144:147], a[28:31], a[32:35], v[144:147]
    s_add_u32 s29, s29, 16384
    s_waitcnt vmcnt(10) lgkmcnt(0)
    s_barrier
    v_mfma_f32_16x16x32_bf16 v[116:119], a[48:51], a[80:83], v[116:119]
    ds_read_b128 v[68:71], v58 offset:0
    v_mfma_f32_16x16x32_bf16 v[120:123], a[52:55], a[80:83], v[120:123]
    ds_read_b128 v[72:75], v58 offset:64
    v_mul_f32 v109, s44, v109
    v_mfma_f32_16x16x32_bf16 v[124:127], a[56:59], a[80:83], v[124:127]
    ds_read_b128 v[76:79], v58 offset:128
    v_mul_f32 v111, s44, v111
    v_mfma_f32_16x16x32_bf16 v[128:131], a[60:63], a[80:83], v[128:131]
    ds_read_b128 v[80:83], v58 offset:192
    v_mul_f32 v113, s44, v113
    v_mfma_f32_16x16x32_bf16 v[132:135], a[64:67], a[80:83], v[132:135]
    ds_read_b128 v[84:87], v58 offset:256
    v_mfma_f32_16x16x32_bf16 v[136:139], a[68:71], a[80:83], v[136:139]
    ds_read_b128 v[88:91], v58 offset:320
    v_mul_f32 v115, s44, v115
    v_mfma_f32_16x16x32_bf16 v[140:143], a[72:75], a[80:83], v[140:143]
    ds_read_b128 v[92:95], v58 offset:384
    v_and_b32 v253, 7, v19
    v_mfma_f32_16x16x32_bf16 v[144:147], a[76:79], a[80:83], v[144:147]
    ds_read_b128 v[96:99], v58 offset:448
    v_lshlrev_b32 v253, 5, v253
    v_mfma_f32_16x16x32_bf16 v[148:151], a[48:51], a[84:87], v[148:151]
    ds_read_b128 a[128:131], v1 offset:49152
    v_mfma_f32_16x16x32_bf16 v[152:155], a[52:55], a[84:87], v[152:155]
    ds_read_b128 a[132:135], v2 offset:49152
    v_mfma_f32_16x16x32_bf16 v[156:159], a[56:59], a[84:87], v[156:159]
    ds_read_b128 a[136:139], v3 offset:49152
    v_mfma_f32_16x16x32_bf16 v[160:163], a[60:63], a[84:87], v[160:163]
    ds_read_b128 a[140:143], v4 offset:49152
    v_mfma_f32_16x16x32_bf16 v[164:167], a[64:67], a[84:87], v[164:167]
    ds_read_b128 a[144:147], v1 offset:53248
    v_mfma_f32_16x16x32_bf16 v[168:171], a[68:71], a[84:87], v[168:171]
    ds_read_b128 a[148:151], v2 offset:53248
    v_mfma_f32_16x16x32_bf16 v[172:175], a[72:75], a[84:87], v[172:175]
    ds_read_b128 a[152:155], v3 offset:53248
    v_mfma_f32_16x16x32_bf16 v[176:179], a[76:79], a[84:87], v[176:179]
    ds_read_b128 a[156:159], v4 offset:53248
    buffer_load_dword v252, v253, s[92:95], 0 offen sc1
    s_waitcnt lgkmcnt(8)
    v_pk_fma_f32 v[116:117], v[108:109], v[68:69], v[116:117] op_sel_hi:[0,1,1] neg_lo:[1,0,0] neg_hi:[1,0,0]
    v_pk_fma_f32 v[118:119], v[108:109], v[70:71], v[118:119] op_sel_hi:[0,1,1] neg_lo:[1,0,0] neg_hi:[1,0,0]
    v_pk_fma_f32 v[120:121], v[108:109], v[72:73], v[120:121] op_sel_hi:[0,1,1] neg_lo:[1,0,0] neg_hi:[1,0,0]
    v_pk_fma_f32 v[122:123], v[108:109], v[74:75], v[122:123] op_sel_hi:[0,1,1] neg_lo:[1,0,0] neg_hi:[1,0,0]
    v_pk_fma_f32 v[124:125], v[108:109], v[76:77], v[124:125] op_sel_hi:[0,1,1] neg_lo:[1,0,0] neg_hi:[1,0,0]
    v_pk_fma_f32 v[126:127], v[108:109], v[78:79], v[126:127] op_sel_hi:[0,1,1] neg_lo:[1,0,0] neg_hi:[1,0,0]
    v_pk_fma_f32 v[128:129], v[108:109], v[80:81], v[128:129] op_sel_hi:[0,1,1] neg_lo:[1,0,0] neg_hi:[1,0,0]
    v_pk_fma_f32 v[130:131], v[108:109], v[82:83], v[130:131] op_sel_hi:[0,1,1] neg_lo:[1,0,0] neg_hi:[1,0,0]
    v_pk_fma_f32 v[132:133], v[108:109], v[84:85], v[132:133] op_sel_hi:[0,1,1] neg_lo:[1,0,0] neg_hi:[1,0,0]
    v_pk_fma_f32 v[134:135], v[108:109], v[86:87], v[134:135] op_sel_hi:[0,1,1] neg_lo:[1,0,0] neg_hi:[1,0,0]
    v_pk_fma_f32 v[136:137], v[108:109], v[88:89], v[136:137] op_sel_hi:[0,1,1] neg_lo:[1,0,0] neg_hi:[1,0,0]
    v_pk_fma_f32 v[138:139], v[108:109], v[90:91], v[138:139] op_sel_hi:[0,1,1] neg_lo:[1,0,0] neg_hi:[1,0,0]
    v_pk_fma_f32 v[140:141], v[108:109], v[92:93], v[140:141] op_sel_hi:[0,1,1] neg_lo:[1,0,0] neg_hi:[1,0,0]
    v_pk_fma_f32 v[142:143], v[108:109], v[94:95], v[142:143] op_sel_hi:[0,1,1] neg_lo:[1,0,0] neg_hi:[1,0,0]
    v_pk_fma_f32 v[144:145], v[108:109], v[96:97], v[144:145] op_sel_hi:[0,1,1] neg_lo:[1,0,0] neg_hi:[1,0,0]
    v_pk_fma_f32 v[146:147], v[108:109], v[98:99], v[146:147] op_sel_hi:[0,1,1] neg_lo:[1,0,0] neg_hi:[1,0,0]
    v_pk_mul_f32 v[116:117], v[116:117], v[108:109] op_sel:[0,1] op_sel_hi:[1,1]
    v_pk_mul_f32 v[118:119], v[118:119], v[108:109] op_sel:[0,1] op_sel_hi:[1,1]
    v_pk_mul_f32 v[120:121], v[120:121], v[108:109] op_sel:[0,1] op_sel_hi:[1,1]
    v_pk_mul_f32 v[122:123], v[122:123], v[108:109] op_sel:[0,1] op_sel_hi:[1,1]
    v_pk_mul_f32 v[124:125], v[124:125], v[108:109] op_sel:[0,1] op_sel_hi:[1,1]
    v_pk_mul_f32 v[126:127], v[126:127], v[108:109] op_sel:[0,1] op_sel_hi:[1,1]
    v_pk_mul_f32 v[128:129], v[128:129], v[108:109] op_sel:[0,1] op_sel_hi:[1,1]
    v_pk_mul_f32 v[130:131], v[130:131], v[108:109] op_sel:[0,1] op_sel_hi:[1,1]
    v_pk_mul_f32 v[132:133], v[132:133], v[108:109] op_sel:[0,1] op_sel_hi:[1,1]
    v_pk_mul_f32 v[134:135], v[134:135], v[108:109] op_sel:[0,1] op_sel_hi:[1,1]
    v_pk_mul_f32 v[136:137], v[136:137], v[108:109] op_sel:[0,1] op_sel_hi:[1,1]
    v_pk_mul_f32 v[138:139], v[138:139], v[108:109] op_sel:[0,1] op_sel_hi:[1,1]
    v_pk_mul_f32 v[140:141], v[140:141], v[108:109] op_sel:[0,1] op_sel_hi:[1,1]
    v_pk_mul_f32 v[142:143], v[142:143], v[108:109] op_sel:[0,1] op_sel_hi:[1,1]
    v_pk_mul_f32 v[144:145], v[144:145], v[108:109] op_sel:[0,1] op_sel_hi:[1,1]
    v_pk_mul_f32 v[146:147], v[146:147], v[108:109] op_sel:[0,1] op_sel_hi:[1,1]
    v_mfma_f32_16x16x32_bf16 v[180:183], a[48:51], a[88:91], v[180:183]
    ds_read_b128 a[160:163], v1 offset:57344
    v_cvt_pk_bf16_f32 v36, v116, v117
    v_cvt_pk_bf16_f32 v37, v118, v119
    v_cvt_pk_bf16_f32 v38, v120, v121
    v_cvt_pk_bf16_f32 v39, v122, v123
    v_mfma_f32_16x16x32_bf16 v[184:187], a[52:55], a[88:91], v[184:187]
    ds_read_b128 a[164:167], v2 offset:57344
    v_cvt_pk_bf16_f32 v40, v124, v125
    v_cvt_pk_bf16_f32 v41, v126, v127
    v_cvt_pk_bf16_f32 v42, v128, v129
    v_cvt_pk_bf16_f32 v43, v130, v131
    v_mfma_f32_16x16x32_bf16 v[188:191], a[56:59], a[88:91], v[188:191]
    ds_read_b128 a[168:171], v3 offset:57344
    v_cvt_pk_bf16_f32 v44, v132, v133
    v_cvt_pk_bf16_f32 v45, v134, v135
    v_cvt_pk_bf16_f32 v46, v136, v137
    v_cvt_pk_bf16_f32 v47, v138, v139
    v_mfma_f32_16x16x32_bf16 v[192:195], a[60:63], a[88:91], v[192:195]
    ds_read_b128 a[172:175], v4 offset:57344
    v_cvt_pk_bf16_f32 v48, v140, v141
    v_cvt_pk_bf16_f32 v49, v142, v143
    v_cvt_pk_bf16_f32 v50, v144, v145
    v_cvt_pk_bf16_f32 v51, v146, v147
    v_mfma_f32_16x16x32_bf16 v[196:199], a[64:67], a[88:91], v[196:199]
    ds_read_b128 a[176:179], v1 offset:61440
    v_permlane32_swap_b32 v36, v38
    v_permlane32_swap_b32 v37, v39
    v_permlane32_swap_b32 v40, v42
    v_permlane32_swap_b32 v41, v43
    v_mfma_f32_16x16x32_bf16 v[200:203], a[68:71], a[88:91], v[200:203]
    ds_read_b128 a[180:183], v2 offset:61440
    v_permlane32_swap_b32 v44, v46
    v_permlane32_swap_b32 v45, v47
    v_permlane32_swap_b32 v48, v50
    v_permlane32_swap_b32 v49, v51
    v_mfma_f32_16x16x32_bf16 v[204:207], a[72:75], a[88:91], v[204:207]
    ds_read_b128 a[184:187], v3 offset:61440
    v_permlane16_swap_b32 v36, v38
    v_permlane16_swap_b32 v37, v39
    v_permlane16_swap_b32 v40, v42
    v_permlane16_swap_b32 v41, v43
    v_mfma_f32_16x16x32_bf16 v[208:211], a[76:79], a[88:91], v[208:211]
    ds_read_b128 a[188:191], v4 offset:61440
    v_permlane16_swap_b32 v44, v46
    v_permlane16_swap_b32 v45, v47
    v_permlane16_swap_b32 v48, v50
    v_permlane16_swap_b32 v49, v51
    v_pk_fma_f32 v[148:149], v[110:111], v[68:69], v[148:149] op_sel_hi:[0,1,1] neg_lo:[1,0,0] neg_hi:[1,0,0]
    v_pk_fma_f32 v[150:151], v[110:111], v[70:71], v[150:151] op_sel_hi:[0,1,1] neg_lo:[1,0,0] neg_hi:[1,0,0]
    v_pk_fma_f32 v[152:153], v[110:111], v[72:73], v[152:153] op_sel_hi:[0,1,1] neg_lo:[1,0,0] neg_hi:[1,0,0]
    v_pk_fma_f32 v[154:155], v[110:111], v[74:75], v[154:155] op_sel_hi:[0,1,1] neg_lo:[1,0,0] neg_hi:[1,0,0]
    v_pk_fma_f32 v[156:157], v[110:111], v[76:77], v[156:157] op_sel_hi:[0,1,1] neg_lo:[1,0,0] neg_hi:[1,0,0]
    v_pk_fma_f32 v[158:159], v[110:111], v[78:79], v[158:159] op_sel_hi:[0,1,1] neg_lo:[1,0,0] neg_hi:[1,0,0]
    v_pk_fma_f32 v[160:161], v[110:111], v[80:81], v[160:161] op_sel_hi:[0,1,1] neg_lo:[1,0,0] neg_hi:[1,0,0]
    v_pk_fma_f32 v[162:163], v[110:111], v[82:83], v[162:163] op_sel_hi:[0,1,1] neg_lo:[1,0,0] neg_hi:[1,0,0]
    v_pk_fma_f32 v[164:165], v[110:111], v[84:85], v[164:165] op_sel_hi:[0,1,1] neg_lo:[1,0,0] neg_hi:[1,0,0]
    v_pk_fma_f32 v[166:167], v[110:111], v[86:87], v[166:167] op_sel_hi:[0,1,1] neg_lo:[1,0,0] neg_hi:[1,0,0]
    v_pk_fma_f32 v[168:169], v[110:111], v[88:89], v[168:169] op_sel_hi:[0,1,1] neg_lo:[1,0,0] neg_hi:[1,0,0]
    v_pk_fma_f32 v[170:171], v[110:111], v[90:91], v[170:171] op_sel_hi:[0,1,1] neg_lo:[1,0,0] neg_hi:[1,0,0]
    v_pk_fma_f32 v[172:173], v[110:111], v[92:93], v[172:173] op_sel_hi:[0,1,1] neg_lo:[1,0,0] neg_hi:[1,0,0]
    v_pk_fma_f32 v[174:175], v[110:111], v[94:95], v[174:175] op_sel_hi:[0,1,1] neg_lo:[1,0,0] neg_hi:[1,0,0]
    v_pk_fma_f32 v[176:177], v[110:111], v[96:97], v[176:177] op_sel_hi:[0,1,1] neg_lo:[1,0,0] neg_hi:[1,0,0]
    v_pk_fma_f32 v[178:179], v[110:111], v[98:99], v[178:179] op_sel_hi:[0,1,1] neg_lo:[1,0,0] neg_hi:[1,0,0]
    v_pk_mul_f32 v[148:149], v[148:149], v[110:111] op_sel:[0,1] op_sel_hi:[1,1]
    v_pk_mul_f32 v[150:151], v[150:151], v[110:111] op_sel:[0,1] op_sel_hi:[1,1]
    v_pk_mul_f32 v[152:153], v[152:153], v[110:111] op_sel:[0,1] op_sel_hi:[1,1]
    v_pk_mul_f32 v[154:155], v[154:155], v[110:111] op_sel:[0,1] op_sel_hi:[1,1]
    v_pk_mul_f32 v[156:157], v[156:157], v[110:111] op_sel:[0,1] op_sel_hi:[1,1]
    v_pk_mul_f32 v[158:159], v[158:159], v[110:111] op_sel:[0,1] op_sel_hi:[1,1]
    v_pk_mul_f32 v[160:161], v[160:161], v[110:111] op_sel:[0,1] op_sel_hi:[1,1]
    v_pk_mul_f32 v[162:163], v[162:163], v[110:111] op_sel:[0,1] op_sel_hi:[1,1]
    v_pk_mul_f32 v[164:165], v[164:165], v[110:111] op_sel:[0,1] op_sel_hi:[1,1]
    v_pk_mul_f32 v[166:167], v[166:167], v[110:111] op_sel:[0,1] op_sel_hi:[1,1]
    v_pk_mul_f32 v[168:169], v[168:169], v[110:111] op_sel:[0,1] op_sel_hi:[1,1]
    v_pk_mul_f32 v[170:171], v[170:171], v[110:111] op_sel:[0,1] op_sel_hi:[1,1]
    v_pk_mul_f32 v[172:173], v[172:173], v[110:111] op_sel:[0,1] op_sel_hi:[1,1]
    v_pk_mul_f32 v[174:175], v[174:175], v[110:111] op_sel:[0,1] op_sel_hi:[1,1]
    v_pk_mul_f32 v[176:177], v[176:177], v[110:111] op_sel:[0,1] op_sel_hi:[1,1]
    v_pk_mul_f32 v[178:179], v[178:179], v[110:111] op_sel:[0,1] op_sel_hi:[1,1]
    v_mfma_f32_16x16x32_bf16 v[212:215], a[48:51], a[92:95], v[212:215]
    s_add_u32 m0, s47, 0
    s_nop 0
    buffer_load_dwordx4 v20, s[96:99], 0 offen lds
    v_cvt_pk_bf16_f32 v52, v148, v149
    v_cvt_pk_bf16_f32 v53, v150, v151
    v_cvt_pk_bf16_f32 v54, v152, v153
    v_cvt_pk_bf16_f32 v55, v154, v155
    v_mfma_f32_16x16x32_bf16 v[216:219], a[52:55], a[92:95], v[216:219]
    s_add_u32 m0, s47, 1024
    s_nop 0
    buffer_load_dwordx4 v21, s[96:99], 0 offen lds
    v_cvt_pk_bf16_f32 v56, v156, v157
    v_cvt_pk_bf16_f32 v57, v158, v159
    v_cvt_pk_bf16_f32 v58, v160, v161
    v_cvt_pk_bf16_f32 v59, v162, v163
    v_mfma_f32_16x16x32_bf16 v[220:223], a[56:59], a[92:95], v[220:223]
    s_add_u32 m0, s47, 2048
    s_nop 0
    buffer_load_dwordx4 v22, s[96:99], 0 offen lds
    v_cvt_pk_bf16_f32 v60, v164, v165
    v_cvt_pk_bf16_f32 v61, v166, v167
    v_cvt_pk_bf16_f32 v62, v168, v169
    v_cvt_pk_bf16_f32 v63, v170, v171
    v_mfma_f32_16x16x32_bf16 v[224:227], a[60:63], a[92:95], v[224:227]
    s_add_u32 m0, s47, 3072
    s_nop 0
    buffer_load_dwordx4 v23, s[96:99], 0 offen lds
    v_cvt_pk_bf16_f32 v64, v172, v173
    v_cvt_pk_bf16_f32 v65, v174, v175
    v_cvt_pk_bf16_f32 v66, v176, v177
    v_cvt_pk_bf16_f32 v67, v178, v179
    v_mfma_f32_16x16x32_bf16 v[228:231], a[64:67], a[92:95], v[228:231]
    s_add_u32 m0, s47, 4096
    s_nop 0
    buffer_load_dwordx4 v24, s[96:99], 0 offen lds
    v_permlane32_swap_b32 v52, v54
    v_permlane32_swap_b32 v53, v55
    v_permlane32_swap_b32 v56, v58
    v_permlane32_swap_b32 v57, v59
    v_mfma_f32_16x16x32_bf16 v[232:235], a[68:71], a[92:95], v[232:235]
    v_permlane32_swap_b32 v60, v62
    v_permlane32_swap_b32 v61, v63
    v_permlane32_swap_b32 v64, v66
    v_permlane32_swap_b32 v65, v67
    v_mfma_f32_16x16x32_bf16 v[236:239], a[72:75], a[92:95], v[236:239]
    v_permlane16_swap_b32 v52, v54
    v_permlane16_swap_b32 v53, v55
    v_permlane16_swap_b32 v56, v58
    v_permlane16_swap_b32 v57, v59
    v_mfma_f32_16x16x32_bf16 v[240:243], a[76:79], a[92:95], v[240:243]
    v_permlane16_swap_b32 v60, v62
    v_permlane16_swap_b32 v61, v63
    v_permlane16_swap_b32 v64, v66
    v_permlane16_swap_b32 v65, v67
    v_pk_fma_f32 v[180:181], v[112:113], v[68:69], v[180:181] op_sel_hi:[0,1,1] neg_lo:[1,0,0] neg_hi:[1,0,0]
    v_pk_fma_f32 v[182:183], v[112:113], v[70:71], v[182:183] op_sel_hi:[0,1,1] neg_lo:[1,0,0] neg_hi:[1,0,0]
    v_pk_fma_f32 v[184:185], v[112:113], v[72:73], v[184:185] op_sel_hi:[0,1,1] neg_lo:[1,0,0] neg_hi:[1,0,0]
    v_pk_fma_f32 v[186:187], v[112:113], v[74:75], v[186:187] op_sel_hi:[0,1,1] neg_lo:[1,0,0] neg_hi:[1,0,0]
    v_pk_fma_f32 v[188:189], v[112:113], v[76:77], v[188:189] op_sel_hi:[0,1,1] neg_lo:[1,0,0] neg_hi:[1,0,0]
    v_pk_fma_f32 v[190:191], v[112:113], v[78:79], v[190:191] op_sel_hi:[0,1,1] neg_lo:[1,0,0] neg_hi:[1,0,0]
    v_pk_fma_f32 v[192:193], v[112:113], v[80:81], v[192:193] op_sel_hi:[0,1,1] neg_lo:[1,0,0] neg_hi:[1,0,0]
    v_pk_fma_f32 v[194:195], v[112:113], v[82:83], v[194:195] op_sel_hi:[0,1,1] neg_lo:[1,0,0] neg_hi:[1,0,0]
    v_pk_fma_f32 v[196:197], v[112:113], v[84:85], v[196:197] op_sel_hi:[0,1,1] neg_lo:[1,0,0] neg_hi:[1,0,0]
    v_pk_fma_f32 v[198:199], v[112:113], v[86:87], v[198:199] op_sel_hi:[0,1,1] neg_lo:[1,0,0] neg_hi:[1,0,0]
    v_pk_fma_f32 v[200:201], v[112:113], v[88:89], v[200:201] op_sel_hi:[0,1,1] neg_lo:[1,0,0] neg_hi:[1,0,0]
    v_pk_fma_f32 v[202:203], v[112:113], v[90:91], v[202:203] op_sel_hi:[0,1,1] neg_lo:[1,0,0] neg_hi:[1,0,0]
    v_pk_fma_f32 v[204:205], v[112:113], v[92:93], v[204:205] op_sel_hi:[0,1,1] neg_lo:[1,0,0] neg_hi:[1,0,0]
    v_pk_fma_f32 v[206:207], v[112:113], v[94:95], v[206:207] op_sel_hi:[0,1,1] neg_lo:[1,0,0] neg_hi:[1,0,0]
    v_pk_fma_f32 v[208:209], v[112:113], v[96:97], v[208:209] op_sel_hi:[0,1,1] neg_lo:[1,0,0] neg_hi:[1,0,0]
    v_pk_fma_f32 v[210:211], v[112:113], v[98:99], v[210:211] op_sel_hi:[0,1,1] neg_lo:[1,0,0] neg_hi:[1,0,0]
    v_pk_mul_f32 v[180:181], v[180:181], v[112:113] op_sel:[0,1] op_sel_hi:[1,1]
    v_pk_mul_f32 v[182:183], v[182:183], v[112:113] op_sel:[0,1] op_sel_hi:[1,1]
    v_pk_mul_f32 v[184:185], v[184:185], v[112:113] op_sel:[0,1] op_sel_hi:[1,1]
    v_pk_mul_f32 v[186:187], v[186:187], v[112:113] op_sel:[0,1] op_sel_hi:[1,1]
    v_pk_mul_f32 v[188:189], v[188:189], v[112:113] op_sel:[0,1] op_sel_hi:[1,1]
    v_pk_mul_f32 v[190:191], v[190:191], v[112:113] op_sel:[0,1] op_sel_hi:[1,1]
    v_pk_mul_f32 v[192:193], v[192:193], v[112:113] op_sel:[0,1] op_sel_hi:[1,1]
    v_pk_mul_f32 v[194:195], v[194:195], v[112:113] op_sel:[0,1] op_sel_hi:[1,1]
    v_pk_mul_f32 v[196:197], v[196:197], v[112:113] op_sel:[0,1] op_sel_hi:[1,1]
    v_pk_mul_f32 v[198:199], v[198:199], v[112:113] op_sel:[0,1] op_sel_hi:[1,1]
    v_pk_mul_f32 v[200:201], v[200:201], v[112:113] op_sel:[0,1] op_sel_hi:[1,1]
    v_pk_mul_f32 v[202:203], v[202:203], v[112:113] op_sel:[0,1] op_sel_hi:[1,1]
    v_pk_mul_f32 v[204:205], v[204:205], v[112:113] op_sel:[0,1] op_sel_hi:[1,1]
    v_pk_mul_f32 v[206:207], v[206:207], v[112:113] op_sel:[0,1] op_sel_hi:[1,1]
    v_pk_mul_f32 v[208:209], v[208:209], v[112:113] op_sel:[0,1] op_sel_hi:[1,1]
    v_pk_mul_f32 v[210:211], v[210:211], v[112:113] op_sel:[0,1] op_sel_hi:[1,1]
    v_pk_fma_f32 v[212:213], v[114:115], v[68:69], v[212:213] op_sel_hi:[0,1,1] neg_lo:[1,0,0] neg_hi:[1,0,0]
    v_pk_fma_f32 v[214:215], v[114:115], v[70:71], v[214:215] op_sel_hi:[0,1,1] neg_lo:[1,0,0] neg_hi:[1,0,0]
    v_pk_fma_f32 v[216:217], v[114:115], v[72:73], v[216:217] op_sel_hi:[0,1,1] neg_lo:[1,0,0] neg_hi:[1,0,0]
    v_pk_fma_f32 v[218:219], v[114:115], v[74:75], v[218:219] op_sel_hi:[0,1,1] neg_lo:[1,0,0] neg_hi:[1,0,0]
    v_pk_fma_f32 v[220:221], v[114:115], v[76:77], v[220:221] op_sel_hi:[0,1,1] neg_lo:[1,0,0] neg_hi:[1,0,0]
    v_pk_fma_f32 v[222:223], v[114:115], v[78:79], v[222:223] op_sel_hi:[0,1,1] neg_lo:[1,0,0] neg_hi:[1,0,0]
    v_pk_fma_f32 v[224:225], v[114:115], v[80:81], v[224:225] op_sel_hi:[0,1,1] neg_lo:[1,0,0] neg_hi:[1,0,0]
    v_pk_fma_f32 v[226:227], v[114:115], v[82:83], v[226:227] op_sel_hi:[0,1,1] neg_lo:[1,0,0] neg_hi:[1,0,0]
    v_pk_fma_f32 v[228:229], v[114:115], v[84:85], v[228:229] op_sel_hi:[0,1,1] neg_lo:[1,0,0] neg_hi:[1,0,0]
    v_pk_fma_f32 v[230:231], v[114:115], v[86:87], v[230:231] op_sel_hi:[0,1,1] neg_lo:[1,0,0] neg_hi:[1,0,0]
    v_pk_fma_f32 v[232:233], v[114:115], v[88:89], v[232:233] op_sel_hi:[0,1,1] neg_lo:[1,0,0] neg_hi:[1,0,0]
    v_pk_fma_f32 v[234:235], v[114:115], v[90:91], v[234:235] op_sel_hi:[0,1,1] neg_lo:[1,0,0] neg_hi:[1,0,0]
    v_pk_fma_f32 v[236:237], v[114:115], v[92:93], v[236:237] op_sel_hi:[0,1,1] neg_lo:[1,0,0] neg_hi:[1,0,0]
    v_pk_fma_f32 v[238:239], v[114:115], v[94:95], v[238:239] op_sel_hi:[0,1,1] neg_lo:[1,0,0] neg_hi:[1,0,0]
    v_pk_fma_f32 v[240:241], v[114:115], v[96:97], v[240:241] op_sel_hi:[0,1,1] neg_lo:[1,0,0] neg_hi:[1,0,0]
    v_pk_fma_f32 v[242:243], v[114:115], v[98:99], v[242:243] op_sel_hi:[0,1,1] neg_lo:[1,0,0] neg_hi:[1,0,0]
    s_waitcnt lgkmcnt(0)
    v_mfma_f32_16x16x32_bf16 v[116:119], a[128:131], v[36:39], 0
    v_cvt_pk_bf16_f32 v68, v180, v181
    v_cvt_pk_bf16_f32 v69, v182, v183
    v_cvt_pk_bf16_f32 v70, v184, v185
    v_cvt_pk_bf16_f32 v71, v186, v187
    v_mfma_f32_16x16x32_bf16 v[116:119], a[132:135], v[40:43], v[116:119]
    v_cvt_pk_bf16_f32 v72, v188, v189
    v_cvt_pk_bf16_f32 v73, v190, v191
    v_cvt_pk_bf16_f32 v74, v192, v193
    v_cvt_pk_bf16_f32 v75, v194, v195
    v_mfma_f32_16x16x32_bf16 v[116:119], a[136:139], v[44:47], v[116:119]
    v_cvt_pk_bf16_f32 v76, v196, v197
    v_cvt_pk_bf16_f32 v77, v198, v199
    v_cvt_pk_bf16_f32 v78, v200, v201
    v_cvt_pk_bf16_f32 v79, v202, v203
    v_mfma_f32_16x16x32_bf16 v[116:119], a[140:143], v[48:51], v[116:119]
    v_cvt_pk_bf16_f32 v80, v204, v205
    v_cvt_pk_bf16_f32 v81, v206, v207
    v_cvt_pk_bf16_f32 v82, v208, v209
    v_cvt_pk_bf16_f32 v83, v210, v211
    v_mfma_f32_16x16x32_bf16 v[132:135], a[144:147], v[36:39], 0
    v_permlane32_swap_b32 v68, v70
    v_permlane32_swap_b32 v69, v71
    v_permlane32_swap_b32 v72, v74
    v_permlane32_swap_b32 v73, v75
    v_mfma_f32_16x16x32_bf16 v[132:135], a[148:151], v[40:43], v[132:135]
    v_permlane32_swap_b32 v76, v78
    v_permlane32_swap_b32 v77, v79
    v_permlane32_swap_b32 v80, v82
    v_permlane32_swap_b32 v81, v83
    v_mfma_f32_16x16x32_bf16 v[132:135], a[152:155], v[44:47], v[132:135]
    v_permlane16_swap_b32 v68, v70
    v_permlane16_swap_b32 v69, v71
    v_permlane16_swap_b32 v72, v74
    v_permlane16_swap_b32 v73, v75
    v_mfma_f32_16x16x32_bf16 v[132:135], a[156:159], v[48:51], v[132:135]
    v_permlane16_swap_b32 v76, v78
    v_permlane16_swap_b32 v77, v79
    v_permlane16_swap_b32 v80, v82
    v_permlane16_swap_b32 v81, v83
    v_pk_mul_f32 v[212:213], v[212:213], v[114:115] op_sel:[0,1] op_sel_hi:[1,1]
    v_pk_mul_f32 v[214:215], v[214:215], v[114:115] op_sel:[0,1] op_sel_hi:[1,1]
    v_pk_mul_f32 v[216:217], v[216:217], v[114:115] op_sel:[0,1] op_sel_hi:[1,1]
    v_pk_mul_f32 v[218:219], v[218:219], v[114:115] op_sel:[0,1] op_sel_hi:[1,1]
    v_pk_mul_f32 v[220:221], v[220:221], v[114:115] op_sel:[0,1] op_sel_hi:[1,1]
    v_pk_mul_f32 v[222:223], v[222:223], v[114:115] op_sel:[0,1] op_sel_hi:[1,1]
    v_pk_mul_f32 v[224:225], v[224:225], v[114:115] op_sel:[0,1] op_sel_hi:[1,1]
    v_pk_mul_f32 v[226:227], v[226:227], v[114:115] op_sel:[0,1] op_sel_hi:[1,1]
    v_pk_mul_f32 v[228:229], v[228:229], v[114:115] op_sel:[0,1] op_sel_hi:[1,1]
    v_pk_mul_f32 v[230:231], v[230:231], v[114:115] op_sel:[0,1] op_sel_hi:[1,1]
    v_pk_mul_f32 v[232:233], v[232:233], v[114:115] op_sel:[0,1] op_sel_hi:[1,1]
    v_pk_mul_f32 v[234:235], v[234:235], v[114:115] op_sel:[0,1] op_sel_hi:[1,1]
    v_pk_mul_f32 v[236:237], v[236:237], v[114:115] op_sel:[0,1] op_sel_hi:[1,1]
    v_pk_mul_f32 v[238:239], v[238:239], v[114:115] op_sel:[0,1] op_sel_hi:[1,1]
    v_pk_mul_f32 v[240:241], v[240:241], v[114:115] op_sel:[0,1] op_sel_hi:[1,1]
    v_pk_mul_f32 v[242:243], v[242:243], v[114:115] op_sel:[0,1] op_sel_hi:[1,1]
    v_mfma_f32_16x16x32_bf16 v[120:123], a[140:143], v[64:67], 0
    v_cvt_pk_bf16_f32 v84, v212, v213
    v_cvt_pk_bf16_f32 v85, v214, v215
    v_cvt_pk_bf16_f32 v86, v216, v217
    v_cvt_pk_bf16_f32 v87, v218, v219
    v_mfma_f32_16x16x32_bf16 v[120:123], a[136:139], v[60:63], v[120:123]
    v_cvt_pk_bf16_f32 v88, v220, v221
    v_cvt_pk_bf16_f32 v89, v222, v223
    v_cvt_pk_bf16_f32 v90, v224, v225
    v_cvt_pk_bf16_f32 v91, v226, v227
    v_mfma_f32_16x16x32_bf16 v[120:123], a[132:135], v[56:59], v[120:123]
    v_cvt_pk_bf16_f32 v92, v228, v229
    v_cvt_pk_bf16_f32 v93, v230, v231
    v_cvt_pk_bf16_f32 v94, v232, v233
    v_cvt_pk_bf16_f32 v95, v234, v235
    v_mfma_f32_16x16x32_bf16 v[120:123], a[128:131], v[52:55], v[120:123]
    v_cvt_pk_bf16_f32 v96, v236, v237
    v_cvt_pk_bf16_f32 v97, v238, v239
    v_cvt_pk_bf16_f32 v98, v240, v241
    v_cvt_pk_bf16_f32 v99, v242, v243
    v_mfma_f32_16x16x32_bf16 v[136:139], a[156:159], v[64:67], 0
    v_permlane32_swap_b32 v84, v86
    v_permlane32_swap_b32 v85, v87
    v_permlane32_swap_b32 v88, v90
    v_permlane32_swap_b32 v89, v91
    v_mfma_f32_16x16x32_bf16 v[136:139], a[152:155], v[60:63], v[136:139]
    v_permlane32_swap_b32 v92, v94
    v_permlane32_swap_b32 v93, v95
    v_permlane32_swap_b32 v96, v98
    v_permlane32_swap_b32 v97, v99
    v_mfma_f32_16x16x32_bf16 v[136:139], a[148:151], v[56:59], v[136:139]
    v_permlane16_swap_b32 v84, v86
    v_permlane16_swap_b32 v85, v87
    v_permlane16_swap_b32 v88, v90
    v_permlane16_swap_b32 v89, v91
    v_mfma_f32_16x16x32_bf16 v[136:139], a[144:147], v[52:55], v[136:139]
    v_permlane16_swap_b32 v92, v94
    v_permlane16_swap_b32 v93, v95
    v_permlane16_swap_b32 v96, v98
    v_permlane16_swap_b32 v97, v99
    v_mfma_f32_16x16x32_bf16 v[124:127], a[128:131], v[68:71], 0
    v_max3_f32 v28, v116, v117, v118
    v_max3_f32 v30, v120, v121, v122
    v_mfma_f32_16x16x32_bf16 v[124:127], a[132:135], v[72:75], v[124:127]
    v_max3_f32 v29, v119, v132, v133
    v_max3_f32 v31, v123, v136, v137
    v_max3_f32 v28, v28, v134, v135
    v_mfma_f32_16x16x32_bf16 v[124:127], a[136:139], v[76:79], v[124:127]
    v_max3_f32 v30, v30, v138, v139
    v_max_f32 v28, v28, v29
    v_max_f32 v30, v30, v31
    v_mfma_f32_16x16x32_bf16 v[124:127], a[140:143], v[80:83], v[124:127]
    v_mov_b32 v29, v28
    v_mov_b32 v31, v30
    s_nop 0
    v_permlane32_swap_b32 v28, v29
    v_mfma_f32_16x16x32_bf16 v[140:143], a[144:147], v[68:71], 0
    v_permlane32_swap_b32 v30, v31
    v_max_f32 v28, v28, v29
    v_mfma_f32_16x16x32_bf16 v[140:143], a[148:151], v[72:75], v[140:143]
    v_max_f32 v30, v30, v31
    v_mov_b32 v29, v28
    v_mov_b32 v31, v30
    v_mfma_f32_16x16x32_bf16 v[140:143], a[152:155], v[76:79], v[140:143]
    v_permlane16_swap_b32 v28, v29
    v_permlane16_swap_b32 v30, v31
    v_max_f32 v28, v28, v29
    v_mfma_f32_16x16x32_bf16 v[140:143], a[156:159], v[80:83], v[140:143]
    v_max_f32 v30, v30, v31
    v_sub_f32 v100, 0, v28
    v_sub_f32 v104, 0, v30
    v_mfma_f32_16x16x32_bf16 v[128:131], a[140:143], v[96:99], 0
    v_sub_f32 v101, 0, v28
    v_sub_f32 v105, 0, v30
    v_mfma_f32_16x16x32_bf16 v[128:131], a[136:139], v[92:95], v[128:131]
    v_sub_f32 v102, 0, v28
    v_sub_f32 v106, 0, v30
    v_sub_f32 v103, 0, v28
    v_mfma_f32_16x16x32_bf16 v[128:131], a[132:135], v[88:91], v[128:131]
    v_sub_f32 v107, 0, v30
    v_sub_f32 v116, v116, v28
    v_sub_f32 v120, v120, v30
    v_mfma_f32_16x16x32_bf16 v[128:131], a[128:131], v[84:87], v[128:131]
    v_sub_f32 v117, v117, v28
    v_sub_f32 v121, v121, v30
    v_sub_f32 v118, v118, v28
    v_mfma_f32_16x16x32_bf16 v[144:147], a[156:159], v[96:99], 0
    v_sub_f32 v122, v122, v30
    v_sub_f32 v119, v119, v28
    v_mfma_f32_16x16x32_bf16 v[144:147], a[152:155], v[92:95], v[144:147]
    v_sub_f32 v123, v123, v30
    v_sub_f32 v132, v132, v28
    v_sub_f32 v136, v136, v30
    v_mfma_f32_16x16x32_bf16 v[144:147], a[148:151], v[88:91], v[144:147]
    v_sub_f32 v133, v133, v28
    v_sub_f32 v137, v137, v30
    v_sub_f32 v134, v134, v28
    v_mfma_f32_16x16x32_bf16 v[144:147], a[144:147], v[84:87], v[144:147]
    v_sub_f32 v138, v138, v30
    v_sub_f32 v135, v135, v28
    v_sub_f32 v139, v139, v30
    s_waitcnt vmcnt(14)
    s_barrier
    v_mfma_f32_16x16x32_bf16 v[148:151], a[160:163], v[36:39], v[100:103]
    s_add_u32 m0, s34, 0
    s_nop 3
    v_mfma_f32_16x16x32_bf16 v[148:151], a[164:167], v[40:43], v[148:151]
    ds_read_b128 a[128:131], v1 offset:16384
    v_max3_f32 v32, v124, v125, v126
    v_max3_f32 v34, v128, v129, v130
    v_mfma_f32_16x16x32_bf16 v[148:151], a[168:171], v[44:47], v[148:151]
    ds_read_b128 a[132:135], v2 offset:16384
    v_max3_f32 v33, v127, v140, v141
    v_max3_f32 v35, v131, v144, v145
    v_max3_f32 v32, v32, v142, v143
    v_mfma_f32_16x16x32_bf16 v[148:151], a[172:175], v[48:51], v[148:151]
    buffer_load_dwordx4 v13, s[8:11], s28 offen offset:0 lds
    v_max3_f32 v34, v34, v146, v147
    v_max_f32 v32, v32, v33
    v_max_f32 v34, v34, v35
    v_mfma_f32_16x16x32_bf16 v[152:155], a[172:175], v[64:67], v[104:107]
    v_mov_b32 v33, v32
    v_mov_b32 v35, v34
    s_nop 0
    v_permlane32_swap_b32 v32, v33
    v_mfma_f32_16x16x32_bf16 v[152:155], a[168:171], v[60:63], v[152:155]
    v_permlane32_swap_b32 v34, v35
    v_max_f32 v32, v32, v33
    v_max_f32 v34, v34, v35
    v_mfma_f32_16x16x32_bf16 v[152:155], a[164:167], v[56:59], v[152:155]
    v_mov_b32 v33, v32
    v_mov_b32 v35, v34
    s_nop 0
    v_permlane16_swap_b32 v32, v33
    v_mfma_f32_16x16x32_bf16 v[152:155], a[160:163], v[52:55], v[152:155]
    v_permlane16_swap_b32 v34, v35
    v_max_f32 v32, v32, v33
    v_max_f32 v34, v34, v35
    v_mfma_f32_16x16x32_bf16 v[164:167], a[176:179], v[36:39], v[100:103]
    v_sub_f32 v108, 0, v32
    v_sub_f32 v112, 0, v34
    v_sub_f32 v109, 0, v32
    v_mfma_f32_16x16x32_bf16 v[164:167], a[180:183], v[40:43], v[164:167]
    v_sub_f32 v113, 0, v34
    v_sub_f32 v110, 0, v32
    v_sub_f32 v114, 0, v34
    v_mfma_f32_16x16x32_bf16 v[164:167], a[184:187], v[44:47], v[164:167]
    v_sub_f32 v111, 0, v32
    v_sub_f32 v115, 0, v34
    v_sub_f32 v124, v124, v32
    v_mfma_f32_16x16x32_bf16 v[164:167], a[188:191], v[48:51], v[164:167]
    v_sub_f32 v128, v128, v34
    v_sub_f32 v125, v125, v32
    v_sub_f32 v129, v129, v34
    v_mfma_f32_16x16x32_bf16 v[168:171], a[188:191], v[64:67], v[104:107]
    v_sub_f32 v126, v126, v32
    v_sub_f32 v130, v130, v34
    v_sub_f32 v127, v127, v32
    v_mfma_f32_16x16x32_bf16 v[168:171], a[184:187], v[60:63], v[168:171]
    v_sub_f32 v131, v131, v34
    v_sub_f32 v140, v140, v32
    v_sub_f32 v144, v144, v34
    v_mfma_f32_16x16x32_bf16 v[168:171], a[180:183], v[56:59], v[168:171]
    v_sub_f32 v141, v141, v32
    v_sub_f32 v145, v145, v34
    v_sub_f32 v142, v142, v32
    v_mfma_f32_16x16x32_bf16 v[168:171], a[176:179], v[52:55], v[168:171]
    v_sub_f32 v146, v146, v34
    v_sub_f32 v143, v143, v32
    v_sub_f32 v147, v147, v34
    s_nop 0
    v_mfma_f32_16x16x32_bf16 v[156:159], a[160:163], v[68:71], v[108:111]
    ds_read_b128 a[136:139], v3 offset:16384
    v_mfma_f32_16x16x32_bf16 v[156:159], a[164:167], v[72:75], v[156:159]
    ds_read_b128 a[140:143], v4 offset:16384
    v_mfma_f32_16x16x32_bf16 v[156:159], a[168:171], v[76:79], v[156:159]
    buffer_load_dwordx4 v14, s[8:11], s28 offen offset:1024 lds
    v_mfma_f32_16x16x32_bf16 v[156:159], a[172:175], v[80:83], v[156:159]
    v_mfma_f32_16x16x32_bf16 v[160:163], a[172:175], v[96:99], v[112:115]
    v_mfma_f32_16x16x32_bf16 v[160:163], a[168:171], v[92:95], v[160:163]
    v_mfma_f32_16x16x32_bf16 v[160:163], a[164:167], v[88:91], v[160:163]
    v_mfma_f32_16x16x32_bf16 v[160:163], a[160:163], v[84:87], v[160:163]
    s_waitcnt lgkmcnt(2)
    v_mfma_f32_16x16x32_bf16 v[172:175], a[176:179], v[68:71], v[108:111]
    s_waitcnt vmcnt(7)
    ds_read_b128 a[144:147], v1 offset:20480
    v_exp_f32 v116, v116
    v_mfma_f32_16x16x32_bf16 v[172:175], a[180:183], v[72:75], v[172:175]
    ds_read_b128 a[148:151], v2 offset:20480
    v_exp_f32 v117, v117
    v_mfma_f32_16x16x32_bf16 v[172:175], a[184:187], v[76:79], v[172:175]
    v_cvt_pk_bf16_f32 v180, v116, v117
    v_exp_f32 v118, v118
    v_mfma_f32_16x16x32_bf16 v[172:175], a[188:191], v[80:83], v[172:175]
    v_exp_f32 v119, v119
    v_mfma_f32_16x16x32_bf16 v[176:179], a[188:191], v[96:99], v[112:115]
    v_cvt_pk_bf16_f32 v181, v118, v119
    v_exp_f32 v120, v120
    v_mfma_f32_16x16x32_bf16 v[176:179], a[184:187], v[92:95], v[176:179]
    v_exp_f32 v121, v121
    v_mfma_f32_16x16x32_bf16 v[176:179], a[180:183], v[88:91], v[176:179]
    buffer_load_dwordx4 v15, s[8:11], s28 offen offset:2048 lds
    v_cvt_pk_bf16_f32 v188, v120, v121
    v_exp_f32 v122, v122
    v_mfma_f32_16x16x32_bf16 v[176:179], a[176:179], v[84:87], v[176:179]
    s_waitcnt lgkmcnt(2)
    v_exp_f32 v123, v123
    v_mfma_f32_16x16x32_bf16 v[116:119], a[128:131], v[36:39], v[100:103]
    ds_read_b128 a[152:155], v3 offset:20480
    v_cvt_pk_bf16_f32 v189, v122, v123
    v_exp_f32 v124, v124
    v_mfma_f32_16x16x32_bf16 v[116:119], a[132:135], v[40:43], v[116:119]
    ds_read_b128 a[156:159], v4 offset:20480
    v_exp_f32 v125, v125
    v_mfma_f32_16x16x32_bf16 v[116:119], a[136:139], v[44:47], v[116:119]
    v_cvt_pk_bf16_f32 v196, v124, v125
    v_exp_f32 v126, v126
    v_cmp_gt_u32 vcc, 32, v252
    s_and_b64 vcc, vcc, exec
    s_cbranch_scc1 L_spin_all
L_back_all:
    v_mfma_f32_16x16x32_bf16 v[116:119], a[140:143], v[48:51], v[116:119]
    s_cmp_eq_u32 s6, 240
    s_cbranch_scc1 L_rt_keys
L_rt_back_keys:
    v_exp_f32 v127, v127
    v_mfma_f32_16x16x32_bf16 v[120:123], a[140:143], v[64:67], v[104:107]
    v_cvt_pk_bf16_f32 v197, v126, v127
    v_exp_f32 v128, v128
    v_mfma_f32_16x16x32_bf16 v[120:123], a[136:139], v[60:63], v[120:123]
    v_exp_f32 v129, v129
    v_mfma_f32_16x16x32_bf16 v[120:123], a[132:135], v[56:59], v[120:123]
    buffer_load_dwordx4 v16, s[8:11], s28 offen offset:3072 lds
    v_cvt_pk_bf16_f32 v204, v128, v129
    v_exp_f32 v130, v130
    v_mfma_f32_16x16x32_bf16 v[120:123], a[128:131], v[52:55], v[120:123]
    s_waitcnt lgkmcnt(2)
    v_exp_f32 v131, v131
    v_mfma_f32_16x16x32_bf16 v[124:127], a[128:131], v[68:71], v[108:111]
    ds_read_b128 a[160:163], v1 offset:24576
    v_cvt_pk_bf16_f32 v205, v130, v131
    v_exp_f32 v132, v132
    v_mfma_f32_16x16x32_bf16 v[124:127], a[132:135], v[72:75], v[124:127]
    ds_read_b128 a[164:167], v2 offset:24576
    v_exp_f32 v133, v133
    v_mfma_f32_16x16x32_bf16 v[124:127], a[136:139], v[76:79], v[124:127]
    v_cvt_pk_bf16_f32 v182, v132, v133
    v_exp_f32 v134, v134
    v_mfma_f32_16x16x32_bf16 v[124:127], a[140:143], v[80:83], v[124:127]
    v_exp_f32 v135, v135
    v_mfma_f32_16x16x32_bf16 v[128:131], a[140:143], v[96:99], v[112:115]
    v_cvt_pk_bf16_f32 v183, v134, v135
    v_exp_f32 v136, v136
    v_mfma_f32_16x16x32_bf16 v[128:131], a[136:139], v[92:95], v[128:131]
    s_add_u32 s28, s28, 16384
    s_mov_b32 m0, s31
    v_exp_f32 v137, v137
    v_mfma_f32_16x16x32_bf16 v[128:131], a[132:135], v[88:91], v[128:131]
    buffer_load_dwordx4 v17, s[12:15], s29 offen offset:0 lds
    v_cvt_pk_bf16_f32 v190, v136, v137
    v_exp_f32 v138, v138
    v_mfma_f32_16x16x32_bf16 v[128:131], a[128:131], v[84:87], v[128:131]
    s_waitcnt lgkmcnt(2)
    v_exp_f32 v139, v139
    v_mfma_f32_16x16x32_bf16 v[132:135], a[144:147], v[36:39], v[100:103]
    ds_read_b128 a[168:171], v3 offset:24576
    v_cvt_pk_bf16_f32 v191, v138, v139
    v_exp_f32 v140, v140
    v_mfma_f32_16x16x32_bf16 v[132:135], a[148:151], v[40:43], v[132:135]
    ds_read_b128 a[172:175], v4 offset:24576
    v_exp_f32 v141, v141
    v_mfma_f32_16x16x32_bf16 v[132:135], a[152:155], v[44:47], v[132:135]
    v_cvt_pk_bf16_f32 v198, v140, v141
    v_exp_f32 v142, v142
    v_mfma_f32_16x16x32_bf16 v[132:135], a[156:159], v[48:51], v[132:135]
    v_exp_f32 v143, v143
    v_mfma_f32_16x16x32_bf16 v[136:139], a[156:159], v[64:67], v[104:107]
    v_cvt_pk_bf16_f32 v199, v142, v143
    v_exp_f32 v144, v144
    v_mfma_f32_16x16x32_bf16 v[136:139], a[152:155], v[60:63], v[136:139]
    v_exp_f32 v145, v145
    v_mfma_f32_16x16x32_bf16 v[136:139], a[148:151], v[56:59], v[136:139]
    buffer_load_dwordx4 v18, s[12:15], s29 offen offset:1024 lds
    v_cvt_pk_bf16_f32 v206, v144, v145
    v_exp_f32 v146, v146
    v_mfma_f32_16x16x32_bf16 v[136:139], a[144:147], v[52:55], v[136:139]
    s_waitcnt lgkmcnt(2)
    v_exp_f32 v147, v147
    v_mfma_f32_16x16x32_bf16 v[140:143], a[144:147], v[68:71], v[108:111]
    ds_read_b128 a[176:179], v1 offset:28672
    v_cvt_pk_bf16_f32 v207, v146, v147
    v_exp_f32 v148, v148
    v_mfma_f32_16x16x32_bf16 v[140:143], a[148:151], v[72:75], v[140:143]
    ds_read_b128 a[180:183], v2 offset:28672
    v_exp_f32 v149, v149
    v_mfma_f32_16x16x32_bf16 v[140:143], a[152:155], v[76:79], v[140:143]
    v_cvt_pk_bf16_f32 v184, v148, v149
    v_exp_f32 v150, v150
    v_mfma_f32_16x16x32_bf16 v[140:143], a[156:159], v[80:83], v[140:143]
    v_exp_f32 v151, v151
    v_mfma_f32_16x16x32_bf16 v[144:147], a[156:159], v[96:99], v[112:115]
    v_cvt_pk_bf16_f32 v185, v150, v151
    v_exp_f32 v152, v152
    v_mfma_f32_16x16x32_bf16 v[144:147], a[152:155], v[92:95], v[144:147]
    v_exp_f32 v153, v153
    v_mfma_f32_16x16x32_bf16 v[144:147], a[148:151], v[88:91], v[144:147]
    buffer_load_dwordx4 v17, s[12:15], s29 offen offset:2048 lds
    v_cvt_pk_bf16_f32 v192, v152, v153
    v_exp_f32 v154, v154
    v_mfma_f32_16x16x32_bf16 v[144:147], a[144:147], v[84:87], v[144:147]
    s_waitcnt lgkmcnt(2)
    v_exp_f32 v155, v155
    v_mfma_f32_16x16x32_bf16 v[148:151], a[160:163], v[36:39], v[100:103]
    ds_read_b128 a[184:187], v3 offset:28672
    v_cvt_pk_bf16_f32 v193, v154, v155
    v_exp_f32 v156, v156
    v_mfma_f32_16x16x32_bf16 v[148:151], a[164:167], v[40:43], v[148:151]
    ds_read_b128 a[188:191], v4 offset:28672
    v_exp_f32 v157, v157
    v_mfma_f32_16x16x32_bf16 v[148:151], a[168:171], v[44:47], v[148:151]
    v_cvt_pk_bf16_f32 v200, v156, v157
    v_exp_f32 v158, v158
    v_mfma_f32_16x16x32_bf16 v[148:151], a[172:175], v[48:51], v[148:151]
    v_exp_f32 v159, v159
    v_mfma_f32_16x16x32_bf16 v[152:155], a[172:175], v[64:67], v[104:107]
    v_cvt_pk_bf16_f32 v201, v158, v159
    v_exp_f32 v160, v160
    v_mfma_f32_16x16x32_bf16 v[152:155], a[168:171], v[60:63], v[152:155]
    v_exp_f32 v161, v161
    v_mfma_f32_16x16x32_bf16 v[152:155], a[164:167], v[56:59], v[152:155]
    buffer_load_dwordx4 v18, s[12:15], s29 offen offset:3072 lds
    v_cvt_pk_bf16_f32 v208, v160, v161
    v_exp_f32 v162, v162
    v_mfma_f32_16x16x32_bf16 v[152:155], a[160:163], v[52:55], v[152:155]
    s_waitcnt vmcnt(14) lgkmcnt(2)
    s_barrier
    s_add_u32 s29, s29, 16384
    v_exp_f32 v163, v163
    v_mfma_f32_16x16x32_bf16 v[156:159], a[160:163], v[68:71], v[108:111]
    s_waitcnt vmcnt(8)
    ds_read_b64_tr_b16 a[192:193], v5 offset:8192
    v_cvt_pk_bf16_f32 v209, v162, v163
    v_exp_f32 v164, v164
    v_mfma_f32_16x16x32_bf16 v[156:159], a[164:167], v[72:75], v[156:159]
    ds_read_b64_tr_b16 a[194:195], v5 offset:12288
    v_exp_f32 v165, v165
    v_mfma_f32_16x16x32_bf16 v[156:159], a[168:171], v[76:79], v[156:159]
    ds_read_b128 a[128:131], v1 offset:32768
    ds_read_b64_tr_b16 a[240:241], v25 offset:0
    v_cvt_pk_bf16_f32 v186, v164, v165
    v_exp_f32 v166, v166
    v_mfma_f32_16x16x32_bf16 v[156:159], a[172:175], v[80:83], v[156:159]
    ds_read_b64_tr_b16 a[196:197], v5 offset:32768
    v_exp_f32 v167, v167
    v_mfma_f32_16x16x32_bf16 v[160:163], a[172:175], v[96:99], v[112:115]
    ds_read_b64_tr_b16 a[198:199], v5 offset:36864
    ds_read_b64_tr_b16 a[242:243], v25 offset:2560
    v_cvt_pk_bf16_f32 v187, v166, v167
    v_exp_f32 v168, v168
    v_mfma_f32_16x16x32_bf16 v[160:163], a[168:171], v[92:95], v[160:163]
    s_add_u32 m0, s34, 49152
    ds_read_b128 a[132:135], v2 offset:32768
    ds_read_b64_tr_b16 a[244:245], v25 offset:32
    v_exp_f32 v169, v169
    v_mfma_f32_16x16x32_bf16 v[160:163], a[164:167], v[88:91], v[160:163]
    buffer_load_dwordx4 v13, s[8:11], s28 offen offset:0 lds
    v_cvt_pk_bf16_f32 v194, v168, v169
    v_exp_f32 v170, v170
    v_mfma_f32_16x16x32_bf16 v[160:163], a[160:163], v[84:87], v[160:163]
    s_waitcnt lgkmcnt(6)
    ds_read_b64_tr_b16 a[246:247], v25 offset:2592
    v_exp_f32 v171, v171
    v_mfma_f32_16x16x32_bf16 v[164:167], a[176:179], v[36:39], v[100:103]
    ds_read_b64_tr_b16 a[200:201], v6 offset:8192
    ds_read_b64_tr_b16 a[248:249], v25 offset:64
    v_cvt_pk_bf16_f32 v195, v170, v171
    v_exp_f32 v172, v172
    v_mfma_f32_16x16x32_bf16 v[164:167], a[180:183], v[40:43], v[164:167]
    ds_read_b64_tr_b16 a[202:203], v6 offset:12288
    v_exp_f32 v173, v173
    v_mfma_f32_16x16x32_bf16 v[164:167], a[184:187], v[44:47], v[164:167]
    ds_read_b128 a[136:139], v3 offset:32768
    ds_read_b64_tr_b16 a[250:251], v25 offset:2624
    v_cvt_pk_bf16_f32 v202, v172, v173
    v_exp_f32 v174, v174
    v_mfma_f32_16x16x32_bf16 v[164:167], a[188:191], v[48:51], v[164:167]
    ds_read_b64_tr_b16 a[204:205], v6 offset:32768
    ds_read_b64_tr_b16 a[252:253], v25 offset:96
    v_exp_f32 v175, v175
    v_mfma_f32_16x16x32_bf16 v[168:171], a[188:191], v[64:67], v[104:107]
    ds_read_b64_tr_b16 a[206:207], v6 offset:36864
    v_cvt_pk_bf16_f32 v203, v174, v175
    v_exp_f32 v176, v176
    v_mfma_f32_16x16x32_bf16 v[168:171], a[184:187], v[60:63], v[168:171]
    ds_read_b128 a[140:143], v4 offset:32768
    ds_read_b64_tr_b16 a[254:255], v25 offset:2656
    v_exp_f32 v177, v177
    v_mfma_f32_16x16x32_bf16 v[168:171], a[180:183], v[56:59], v[168:171]
    buffer_load_dwordx4 v14, s[8:11], s28 offen offset:1024 lds
    ds_read_b64_tr_b16 v[252:253], v25 offset:128
    v_cvt_pk_bf16_f32 v210, v176, v177
    v_exp_f32 v178, v178
    v_mfma_f32_16x16x32_bf16 v[168:171], a[176:179], v[52:55], v[168:171]
    s_waitcnt lgkmcnt(6)
    ds_read_b64_tr_b16 v[254:255], v25 offset:2688
    v_exp_f32 v179, v179
    v_mfma_f32_16x16x32_bf16 v[172:175], a[176:179], v[68:71], v[108:111]
    s_mov_b32 s16, s62
    v_exp_f32 v116, v116
    v_mfma_f32_16x16x32_bf16 v[172:175], a[180:183], v[72:75], v[172:175]
    s_mov_b32 s17, s63
    ds_read_b64_tr_b16 a[208:209], v7 offset:8192
    v_cvt_pk_bf16_f32 v211, v178, v179
    v_mfma_f32_16x16x32_bf16 v[172:175], a[184:187], v[76:79], v[172:175]
    s_mov_b32 s18, 0x21c000
    v_exp_f32 v117, v117
    v_mfma_f32_16x16x32_bf16 v[172:175], a[188:191], v[80:83], v[172:175]
    s_mov_b32 s19, 0x20000
    ds_read_b64_tr_b16 a[210:211], v7 offset:12288
    v_mfma_f32_16x16x32_bf16 v[176:179], a[188:191], v[96:99], v[112:115]
    s_mov_b32 s20, s64
    v_exp_f32 v118, v118
    v_mfma_f32_16x16x32_bf16 v[176:179], a[184:187], v[92:95], v[176:179]
    s_mov_b32 s21, s65
    ds_read_b128 a[144:147], v1 offset:36864
    v_cvt_pk_bf16_f32 v212, v116, v117
    v_mfma_f32_16x16x32_bf16 v[176:179], a[180:183], v[88:91], v[176:179]
    s_mov_b32 s22, 0x21c000
    v_exp_f32 v119, v119
    v_mfma_f32_16x16x32_bf16 v[176:179], a[176:179], v[84:87], v[176:179]
    s_mov_b32 s23, 0x20000
    ds_read_b64_tr_b16 a[212:213], v7 offset:32768
    v_mfma_f32_16x16x32_bf16 a[0:3], a[192:195], v[180:183], 0
    s_mov_b32 s96, s66
    v_exp_f32 v120, v120
    v_mfma_f32_16x16x32_bf16 a[0:3], a[196:199], v[184:187], a[0:3]
    s_mov_b32 s97, s67
    ds_read_b64_tr_b16 a[214:215], v7 offset:36864
    v_cvt_pk_bf16_f32 v213, v118, v119
    v_mfma_f32_16x16x32_bf16 a[4:7], a[196:199], v[192:195], 0
    s_mov_b32 s98, 0x21c000
    v_exp_f32 v121, v121
    v_mfma_f32_16x16x32_bf16 a[4:7], a[192:195], v[188:191], a[4:7]
    s_mov_b32 s99, 0x20000
    ds_read_b128 a[148:151], v2 offset:36864
    v_cvt_pk_bf16_f32 v220, v120, v121
    v_mfma_f32_16x16x32_bf16 a[8:11], a[192:195], v[196:199], 0
    v_exp_f32 v122, v122
    v_mfma_f32_16x16x32_bf16 a[8:11], a[196:199], v[200:203], a[8:11]
    buffer_load_dwordx4 v15, s[8:11], s28 offen offset:2048 lds
    v_mfma_f32_16x16x32_bf16 a[12:15], a[196:199], v[208:211], 0
    v_exp_f32 v123, v123
    v_mfma_f32_16x16x32_bf16 a[12:15], a[192:195], v[204:207], a[12:15]
    s_waitcnt lgkmcnt(6)
    v_mul_u32_u24 v24, 3456, v19
    v_mfma_f32_16x16x32_bf16 v[116:119], a[128:131], v[36:39], v[100:103]
    s_lshl_b32 s40, s6, 4
    v_exp_f32 v124, v124
    v_mfma_f32_16x16x32_bf16 v[116:119], a[132:135], v[40:43], v[116:119]
    ds_read_b64_tr_b16 a[216:217], v8 offset:8192
    v_cvt_pk_bf16_f32 v221, v122, v123
    v_mfma_f32_16x16x32_bf16 v[116:119], a[136:139], v[44:47], v[116:119]
    v_exp_f32 v125, v125
    v_mfma_f32_16x16x32_bf16 v[116:119], a[140:143], v[48:51], v[116:119]
    ds_read_b64_tr_b16 a[218:219], v8 offset:12288
    v_add_u32 v24, s40, v24
    v_mfma_f32_16x16x32_bf16 v[120:123], a[140:143], v[64:67], v[104:107]
    s_cmp_ge_u32 s5, 2
    s_cselect_b32 s16, s20, s16
    s_cselect_b32 s17, s21, s17
    v_exp_f32 v126, v126
    v_mfma_f32_16x16x32_bf16 v[120:123], a[136:139], v[60:63], v[120:123]
    s_cmp_ge_u32 s6, 216
    s_cselect_b32 s18, 0, s18
    ds_read_b128 a[152:155], v3 offset:36864
    v_cvt_pk_bf16_f32 v228, v124, v125
    v_mfma_f32_16x16x32_bf16 v[120:123], a[132:135], v[56:59], v[120:123]
    s_and_b32 s40, s5, 1
    v_exp_f32 v127, v127
    v_mfma_f32_16x16x32_bf16 v[120:123], a[128:131], v[52:55], v[120:123]
    s_mul_i32 s37, s40, 1105920
    ds_read_b64_tr_b16 a[220:221], v8 offset:32768
    v_mfma_f32_16x16x32_bf16 a[16:19], a[200:203], v[180:183], 0
    s_mul_i32 s38, s5, 5120
    v_exp_f32 v128, v128
    v_mfma_f32_16x16x32_bf16 a[16:19], a[204:207], v[184:187], a[16:19]
    s_add_u32 s38, s38, 65536
    ds_read_b64_tr_b16 a[222:223], v8 offset:36864
    v_cvt_pk_bf16_f32 v229, v126, v127
    v_mfma_f32_16x16x32_bf16 a[20:23], a[204:207], v[192:195], 0
    buffer_store_dwordx4 a[240:243], v26, s[76:79], 0 offen offset:0 sc1
    v_exp_f32 v129, v129
    v_mfma_f32_16x16x32_bf16 a[20:23], a[200:203], v[188:191], a[20:23]
    ds_read_b128 a[156:159], v4 offset:36864
    v_mfma_f32_16x16x32_bf16 a[24:27], a[200:203], v[196:199], 0
    v_exp_f32 v130, v130
    v_mfma_f32_16x16x32_bf16 a[24:27], a[204:207], v[200:203], a[24:27]
    v_cvt_pk_bf16_f32 v236, v128, v129
    v_mfma_f32_16x16x32_bf16 a[28:31], a[204:207], v[208:211], 0
    v_exp_f32 v131, v131
    v_mfma_f32_16x16x32_bf16 a[28:31], a[200:203], v[204:207], a[28:31]
    buffer_load_dwordx4 v16, s[8:11], s28 offen offset:3072 lds
    v_smfmac_f32_16x16x64_bf16 a[224:227], v[244:247], v[180:187], v248
    s_waitcnt lgkmcnt(6)
    buffer_store_dwordx4 a[244:247], v26, s[76:79], 0 offen offset:1024 sc1
    v_mfma_f32_16x16x32_bf16 v[124:127], a[128:131], v[68:71], v[108:111]
    v_exp_f32 v132, v132
    v_mfma_f32_16x16x32_bf16 v[124:127], a[132:135], v[72:75], v[124:127]
    ds_read_b64_tr_b16 a[192:193], v9 offset:8192
    v_cvt_pk_bf16_f32 v237, v130, v131
    v_mfma_f32_16x16x32_bf16 v[124:127], a[136:139], v[76:79], v[124:127]
    v_exp_f32 v133, v133
    v_mfma_f32_16x16x32_bf16 v[124:127], a[140:143], v[80:83], v[124:127]
    ds_read_b64_tr_b16 a[194:195], v9 offset:12288
    v_mfma_f32_16x16x32_bf16 v[128:131], a[140:143], v[96:99], v[112:115]
    v_exp_f32 v134, v134
    v_mfma_f32_16x16x32_bf16 v[128:131], a[136:139], v[92:95], v[128:131]
    ds_read_b128 a[160:163], v1 offset:40960
    v_cvt_pk_bf16_f32 v214, v132, v133
    v_mfma_f32_16x16x32_bf16 v[128:131], a[132:135], v[88:91], v[128:131]
    v_exp_f32 v135, v135
    v_mfma_f32_16x16x32_bf16 v[128:131], a[128:131], v[84:87], v[128:131]
    ds_read_b64_tr_b16 a[196:197], v9 offset:32768
    v_mfma_f32_16x16x32_bf16 a[32:35], a[208:211], v[180:183], 0
    v_exp_f32 v136, v136
    v_mfma_f32_16x16x32_bf16 a[32:35], a[212:215], v[184:187], a[32:35]
    ds_read_b64_tr_b16 a[198:199], v9 offset:36864
    v_cvt_pk_bf16_f32 v215, v134, v135
    v_mfma_f32_16x16x32_bf16 a[36:39], a[212:215], v[192:195], 0
    v_exp_f32 v137, v137
    v_mfma_f32_16x16x32_bf16 a[36:39], a[208:211], v[188:191], a[36:39]
    ds_read_b128 a[164:167], v2 offset:40960
    v_cvt_pk_bf16_f32 v222, v136, v137
    v_mfma_f32_16x16x32_bf16 a[40:43], a[208:211], v[196:199], 0
    s_add_u32 s28, s28, 16384
    s_mov_b32 m0, s32
    buffer_store_dwordx4 a[248:251], v26, s[76:79], 0 offen offset:2048 sc1
    v_exp_f32 v138, v138
    v_mfma_f32_16x16x32_bf16 a[40:43], a[212:215], v[200:203], a[40:43]
    buffer_load_dwordx4 v17, s[12:15], s29 offen offset:0 lds
    v_mfma_f32_16x16x32_bf16 a[44:47], a[212:215], v[208:211], 0
    v_exp_f32 v139, v139
    v_mfma_f32_16x16x32_bf16 a[44:47], a[208:211], v[204:207], a[44:47]
    s_waitcnt lgkmcnt(6)
    buffer_store_dwordx4 a[252:255], v26, s[76:79], 0 offen offset:3072 sc1
    v_mfma_f32_16x16x32_bf16 v[132:135], a[144:147], v[36:39], v[100:103]
    v_exp_f32 v140, v140
    v_mfma_f32_16x16x32_bf16 v[132:135], a[148:151], v[40:43], v[132:135]
    ds_read_b64_tr_b16 a[200:201], v10 offset:8192
    v_cvt_pk_bf16_f32 v223, v138, v139
    v_mfma_f32_16x16x32_bf16 v[132:135], a[152:155], v[44:47], v[132:135]
    v_exp_f32 v141, v141
    v_mfma_f32_16x16x32_bf16 v[132:135], a[156:159], v[48:51], v[132:135]
    ds_read_b64_tr_b16 a[202:203], v10 offset:12288
    v_mfma_f32_16x16x32_bf16 v[136:139], a[156:159], v[64:67], v[104:107]
    v_exp_f32 v142, v142
    v_mfma_f32_16x16x32_bf16 v[136:139], a[152:155], v[60:63], v[136:139]
    ds_read_b128 a[168:171], v3 offset:40960
    v_cvt_pk_bf16_f32 v230, v140, v141
    v_mfma_f32_16x16x32_bf16 v[136:139], a[148:151], v[56:59], v[136:139]
    v_exp_f32 v143, v143
    v_mfma_f32_16x16x32_bf16 v[136:139], a[144:147], v[52:55], v[136:139]
    ds_read_b64_tr_b16 a[204:205], v10 offset:32768
    v_mfma_f32_16x16x32_bf16 a[48:51], a[216:219], v[180:183], 0
    v_exp_f32 v144, v144
    v_mfma_f32_16x16x32_bf16 a[48:51], a[220:223], v[184:187], a[48:51]
    ds_read_b64_tr_b16 a[206:207], v10 offset:36864
    v_cvt_pk_bf16_f32 v231, v142, v143
    v_mfma_f32_16x16x32_bf16 a[52:55], a[220:223], v[192:195], 0
    v_exp_f32 v145, v145
    v_mfma_f32_16x16x32_bf16 a[52:55], a[216:219], v[188:191], a[52:55]
    ds_read_b128 a[172:175], v4 offset:40960
    v_mfma_f32_16x16x32_bf16 a[56:59], a[216:219], v[196:199], 0
    v_exp_f32 v146, v146
    v_mfma_f32_16x16x32_bf16 a[56:59], a[220:223], v[200:203], a[56:59]
    v_cvt_pk_bf16_f32 v238, v144, v145
    v_mfma_f32_16x16x32_bf16 a[60:63], a[220:223], v[208:211], 0
    v_exp_f32 v147, v147
    v_mfma_f32_16x16x32_bf16 a[60:63], a[216:219], v[204:207], a[60:63]
    buffer_load_dwordx4 v18, s[12:15], s29 offen offset:1024 lds
    v_smfmac_f32_16x16x64_bf16 a[228:231], v[244:247], v[188:195], v248
    s_waitcnt lgkmcnt(6)
    buffer_store_dwordx4 v[252:255], v26, s[76:79], s45 offen offset:0 sc1
    v_mfma_f32_16x16x32_bf16 v[140:143], a[144:147], v[68:71], v[108:111]
    s_cmp_eq_u32 s6, 240
    s_cbranch_scc1 L_rt_local
L_rt_back_local:
    v_exp_f32 v148, v148
    v_mfma_f32_16x16x32_bf16 v[140:143], a[148:151], v[72:75], v[140:143]
    ds_read_b64_tr_b16 a[208:209], v11 offset:8192
    v_cvt_pk_bf16_f32 v239, v146, v147
    v_mfma_f32_16x16x32_bf16 v[140:143], a[152:155], v[76:79], v[140:143]
    v_exp_f32 v149, v149
    v_mfma_f32_16x16x32_bf16 v[140:143], a[156:159], v[80:83], v[140:143]
    ds_read_b64_tr_b16 a[210:211], v11 offset:12288
    v_mfma_f32_16x16x32_bf16 v[144:147], a[156:159], v[96:99], v[112:115]
    v_exp_f32 v150, v150
    v_mfma_f32_16x16x32_bf16 v[144:147], a[152:155], v[92:95], v[144:147]
    ds_read_b128 a[176:179], v1 offset:45056
    v_cvt_pk_bf16_f32 v216, v148, v149
    v_mfma_f32_16x16x32_bf16 v[144:147], a[148:151], v[88:91], v[144:147]
    v_exp_f32 v151, v151
    v_mfma_f32_16x16x32_bf16 v[144:147], a[144:147], v[84:87], v[144:147]
    ds_read_b64_tr_b16 a[212:213], v11 offset:32768
    v_mfma_f32_16x16x32_bf16 a[64:67], a[192:195], v[180:183], 0
    v_exp_f32 v152, v152
    v_mfma_f32_16x16x32_bf16 a[64:67], a[196:199], v[184:187], a[64:67]
    ds_read_b64_tr_b16 a[214:215], v11 offset:36864
    v_cvt_pk_bf16_f32 v217, v150, v151
    v_mfma_f32_16x16x32_bf16 a[68:71], a[196:199], v[192:195], 0
    v_exp_f32 v153, v153
    v_mfma_f32_16x16x32_bf16 a[68:71], a[192:195], v[188:191], a[68:71]
    ds_read_b128 a[180:183], v2 offset:45056
    v_cvt_pk_bf16_f32 v224, v152, v153
    v_mfma_f32_16x16x32_bf16 a[72:75], a[192:195], v[196:199], 0
    v_exp_f32 v154, v154
    v_mfma_f32_16x16x32_bf16 a[72:75], a[196:199], v[200:203], a[72:75]
    buffer_load_dwordx4 v17, s[12:15], s29 offen offset:2048 lds
    v_mfma_f32_16x16x32_bf16 a[76:79], a[196:199], v[208:211], 0
    v_exp_f32 v155, v155
    v_mfma_f32_16x16x32_bf16 a[76:79], a[192:195], v[204:207], a[76:79]
    s_waitcnt lgkmcnt(6)
    v_mfma_f32_16x16x32_bf16 v[148:151], a[160:163], v[36:39], v[100:103]
    v_exp_f32 v156, v156
    v_mfma_f32_16x16x32_bf16 v[148:151], a[164:167], v[40:43], v[148:151]
    ds_read_b64_tr_b16 a[216:217], v12 offset:8192
    v_cvt_pk_bf16_f32 v225, v154, v155
    v_mfma_f32_16x16x32_bf16 v[148:151], a[168:171], v[44:47], v[148:151]
    v_exp_f32 v157, v157
    v_mfma_f32_16x16x32_bf16 v[148:151], a[172:175], v[48:51], v[148:151]
    ds_read_b64_tr_b16 a[218:219], v12 offset:12288
    v_mfma_f32_16x16x32_bf16 v[152:155], a[172:175], v[64:67], v[104:107]
    v_exp_f32 v158, v158
    v_mfma_f32_16x16x32_bf16 v[152:155], a[168:171], v[60:63], v[152:155]
    ds_read_b128 a[184:187], v3 offset:45056
    v_cvt_pk_bf16_f32 v232, v156, v157
    v_mfma_f32_16x16x32_bf16 v[152:155], a[164:167], v[56:59], v[152:155]
    v_exp_f32 v159, v159
    v_mfma_f32_16x16x32_bf16 v[152:155], a[160:163], v[52:55], v[152:155]
    ds_read_b64_tr_b16 a[220:221], v12 offset:32768
    v_mfma_f32_16x16x32_bf16 a[80:83], a[200:203], v[180:183], 0
    v_exp_f32 v160, v160
    v_mfma_f32_16x16x32_bf16 a[80:83], a[204:207], v[184:187], a[80:83]
    ds_read_b64_tr_b16 a[222:223], v12 offset:36864
    v_cvt_pk_bf16_f32 v233, v158, v159
    v_mfma_f32_16x16x32_bf16 a[84:87], a[204:207], v[192:195], 0
    v_exp_f32 v161, v161
    v_mfma_f32_16x16x32_bf16 a[84:87], a[200:203], v[188:191], a[84:87]
    ds_read_b128 a[188:191], v4 offset:45056
    v_mfma_f32_16x16x32_bf16 a[88:91], a[200:203], v[196:199], 0
    v_exp_f32 v162, v162
    v_mfma_f32_16x16x32_bf16 a[88:91], a[204:207], v[200:203], a[88:91]
    v_cvt_pk_bf16_f32 v240, v160, v161
    v_mfma_f32_16x16x32_bf16 a[92:95], a[204:207], v[208:211], 0
    v_exp_f32 v163, v163
    v_mfma_f32_16x16x32_bf16 a[92:95], a[200:203], v[204:207], a[92:95]
    buffer_load_dwordx4 v18, s[12:15], s29 offen offset:3072 lds
    v_smfmac_f32_16x16x64_bf16 a[232:235], v[244:247], v[196:203], v248
    s_waitcnt vmcnt(13) lgkmcnt(6)
    s_barrier
    s_add_u32 s29, s29, 16384
    v_mfma_f32_16x16x32_bf16 v[156:159], a[160:163], v[68:71], v[108:111]
    v_exp_f32 v164, v164
    v_mfma_f32_16x16x32_bf16 v[156:159], a[164:167], v[72:75], v[156:159]
    ds_read_b64_tr_b16 a[192:193], v5 offset:16384
    v_cvt_pk_bf16_f32 v241, v162, v163
    v_mfma_f32_16x16x32_bf16 v[156:159], a[168:171], v[76:79], v[156:159]
    v_exp_f32 v165, v165
    v_mfma_f32_16x16x32_bf16 v[156:159], a[172:175], v[80:83], v[156:159]
    ds_read_b64_tr_b16 a[194:195], v5 offset:20480
    v_mfma_f32_16x16x32_bf16 v[160:163], a[172:175], v[96:99], v[112:115]
    v_exp_f32 v166, v166
    v_mfma_f32_16x16x32_bf16 v[160:163], a[168:171], v[92:95], v[160:163]
    ds_read_b128 a[128:131], v1 offset:0
    v_cvt_pk_bf16_f32 v218, v164, v165
    v_mfma_f32_16x16x32_bf16 v[160:163], a[164:167], v[88:91], v[160:163]
    v_exp_f32 v167, v167
    v_mfma_f32_16x16x32_bf16 v[160:163], a[160:163], v[84:87], v[160:163]
    ds_read_b64_tr_b16 a[196:197], v5 offset:40960
    v_mfma_f32_16x16x32_bf16 a[96:99], a[208:211], v[180:183], 0
    v_exp_f32 v168, v168
    v_mfma_f32_16x16x32_bf16 a[96:99], a[212:215], v[184:187], a[96:99]
    ds_read_b64_tr_b16 a[198:199], v5 offset:45056
    v_cvt_pk_bf16_f32 v219, v166, v167
    v_mfma_f32_16x16x32_bf16 a[100:103], a[212:215], v[192:195], 0
    v_exp_f32 v169, v169
    v_mfma_f32_16x16x32_bf16 a[100:103], a[208:211], v[188:191], a[100:103]
    ds_read_b128 a[132:135], v2 offset:0
    v_cvt_pk_bf16_f32 v226, v168, v169
    v_mfma_f32_16x16x32_bf16 a[104:107], a[208:211], v[196:199], 0
    s_add_u32 m0, s34, 16384
    v_exp_f32 v170, v170
    v_mfma_f32_16x16x32_bf16 a[104:107], a[212:215], v[200:203], a[104:107]
    buffer_load_dwordx4 v13, s[8:11], s28 offen offset:0 lds
    v_mfma_f32_16x16x32_bf16 a[108:111], a[212:215], v[208:211], 0
    v_exp_f32 v171, v171
    v_mfma_f32_16x16x32_bf16 a[108:111], a[208:211], v[204:207], a[108:111]
    s_waitcnt lgkmcnt(6)
    v_mfma_f32_16x16x32_bf16 v[164:167], a[176:179], v[36:39], v[100:103]
    s_cmp_eq_u32 s6, 240
    s_cbranch_scc1 L_rt_merge
L_rt_back_merge:
    v_exp_f32 v172, v172
    v_mfma_f32_16x16x32_bf16 v[164:167], a[180:183], v[40:43], v[164:167]
    ds_read_b64_tr_b16 a[200:201], v6 offset:16384
    v_cvt_pk_bf16_f32 v227, v170, v171
    v_mfma_f32_16x16x32_bf16 v[164:167], a[184:187], v[44:47], v[164:167]
    v_exp_f32 v173, v173
    v_mfma_f32_16x16x32_bf16 v[164:167], a[188:191], v[48:51], v[164:167]
    ds_read_b64_tr_b16 a[202:203], v6 offset:20480
    v_mfma_f32_16x16x32_bf16 v[168:171], a[188:191], v[64:67], v[104:107]
    v_exp_f32 v174, v174
    v_mfma_f32_16x16x32_bf16 v[168:171], a[184:187], v[60:63], v[168:171]
    ds_read_b128 a[136:139], v3 offset:0
    v_cvt_pk_bf16_f32 v234, v172, v173
    v_mfma_f32_16x16x32_bf16 v[168:171], a[180:183], v[56:59], v[168:171]
    v_exp_f32 v175, v175
    v_mfma_f32_16x16x32_bf16 v[168:171], a[176:179], v[52:55], v[168:171]
    ds_read_b64_tr_b16 a[204:205], v6 offset:40960
    v_mfma_f32_16x16x32_bf16 a[112:115], a[216:219], v[180:183], 0
    v_exp_f32 v176, v176
    v_mfma_f32_16x16x32_bf16 a[112:115], a[220:223], v[184:187], a[112:115]
    ds_read_b64_tr_b16 a[206:207], v6 offset:45056
    v_cvt_pk_bf16_f32 v235, v174, v175
    v_mfma_f32_16x16x32_bf16 a[116:119], a[220:223], v[192:195], 0
    v_exp_f32 v177, v177
    v_mfma_f32_16x16x32_bf16 a[116:119], a[216:219], v[188:191], a[116:119]
    ds_read_b128 a[140:143], v4 offset:0
    v_mfma_f32_16x16x32_bf16 a[120:123], a[216:219], v[196:199], 0
    v_exp_f32 v178, v178
    v_mfma_f32_16x16x32_bf16 a[120:123], a[220:223], v[200:203], a[120:123]
    v_cvt_pk_bf16_f32 v242, v176, v177
    v_mfma_f32_16x16x32_bf16 a[124:127], a[220:223], v[208:211], 0
    v_exp_f32 v179, v179
    v_mfma_f32_16x16x32_bf16 a[124:127], a[216:219], v[204:207], a[124:127]
    buffer_load_dwordx4 v14, s[8:11], s28 offen offset:1024 lds
    v_smfmac_f32_16x16x64_bf16 a[236:239], v[244:247], v[204:211], v248
    s_waitcnt lgkmcnt(6)
    s_mov_b32 s35, 4
.p2align 6
L_attn_loop:
    v_mfma_f32_16x16x32_bf16 v[172:175], a[176:179], v[68:71], v[108:111]
    v_exp_f32 v116, v116
    v_mfma_f32_16x16x32_bf16 v[172:175], a[180:183], v[72:75], v[172:175]
    ds_read_b64_tr_b16 a[208:209], v7 offset:16384
    v_cvt_pk_bf16_f32 v243, v178, v179
    v_mfma_f32_16x16x32_bf16 v[172:175], a[184:187], v[76:79], v[172:175]
    v_exp_f32 v117, v117
    v_mfma_f32_16x16x32_bf16 v[172:175], a[188:191], v[80:83], v[172:175]
    ds_read_b64_tr_b16 a[210:211], v7 offset:20480
    v_mfma_f32_16x16x32_bf16 v[176:179], a[188:191], v[96:99], v[112:115]
    v_exp_f32 v118, v118
    v_mfma_f32_16x16x32_bf16 v[176:179], a[184:187], v[92:95], v[176:179]
    ds_read_b128 a[144:147], v1 offset:4096
    v_cvt_pk_bf16_f32 v180, v116, v117
    v_mfma_f32_16x16x32_bf16 v[176:179], a[180:183], v[88:91], v[176:179]
    v_exp_f32 v119, v119
    v_mfma_f32_16x16x32_bf16 v[176:179], a[176:179], v[84:87], v[176:179]
    ds_read_b64_tr_b16 a[212:213], v7 offset:40960
    v_mfma_f32_16x16x32_bf16 a[0:3], a[192:195], v[212:215], a[0:3]
    v_exp_f32 v120, v120
    v_mfma_f32_16x16x32_bf16 a[0:3], a[196:199], v[216:219], a[0:3]
    ds_read_b64_tr_b16 a[214:215], v7 offset:45056
    v_cvt_pk_bf16_f32 v181, v118, v119
    v_mfma_f32_16x16x32_bf16 a[4:7], a[196:199], v[224:227], a[4:7]
    v_exp_f32 v121, v121
    v_mfma_f32_16x16x32_bf16 a[4:7], a[192:195], v[220:223], a[4:7]
    ds_read_b128 a[148:151], v2 offset:4096
    v_cvt_pk_bf16_f32 v188, v120, v121
    v_mfma_f32_16x16x32_bf16 a[8:11], a[192:195], v[228:231], a[8:11]
    v_exp_f32 v122, v122
    v_mfma_f32_16x16x32_bf16 a[8:11], a[196:199], v[232:235], a[8:11]
    buffer_load_dwordx4 v15, s[8:11], s28 offen offset:2048 lds
    v_mfma_f32_16x16x32_bf16 a[12:15], a[196:199], v[240:243], a[12:15]
    v_exp_f32 v123, v123
    v_mfma_f32_16x16x32_bf16 a[12:15], a[192:195], v[236:239], a[12:15]
    s_waitcnt lgkmcnt(6)
    v_mfma_f32_16x16x32_bf16 v[116:119], a[128:131], v[36:39], v[100:103]
    v_exp_f32 v124, v124
    v_mfma_f32_16x16x32_bf16 v[116:119], a[132:135], v[40:43], v[116:119]
    ds_read_b64_tr_b16 a[216:217], v8 offset:16384
    v_cvt_pk_bf16_f32 v189, v122, v123
    v_mfma_f32_16x16x32_bf16 v[116:119], a[136:139], v[44:47], v[116:119]
    v_exp_f32 v125, v125
    v_mfma_f32_16x16x32_bf16 v[116:119], a[140:143], v[48:51], v[116:119]
    ds_read_b64_tr_b16 a[218:219], v8 offset:20480
    v_mfma_f32_16x16x32_bf16 v[120:123], a[140:143], v[64:67], v[104:107]
    v_exp_f32 v126, v126
    v_mfma_f32_16x16x32_bf16 v[120:123], a[136:139], v[60:63], v[120:123]
    ds_read_b128 a[152:155], v3 offset:4096
    v_cvt_pk_bf16_f32 v196, v124, v125
    v_mfma_f32_16x16x32_bf16 v[120:123], a[132:135], v[56:59], v[120:123]
    v_exp_f32 v127, v127
    v_mfma_f32_16x16x32_bf16 v[120:123], a[128:131], v[52:55], v[120:123]
    ds_read_b64_tr_b16 a[220:221], v8 offset:40960
    v_mfma_f32_16x16x32_bf16 a[16:19], a[200:203], v[212:215], a[16:19]
    v_exp_f32 v128, v128
    v_mfma_f32_16x16x32_bf16 a[16:19], a[204:207], v[216:219], a[16:19]
    ds_read_b64_tr_b16 a[222:223], v8 offset:45056
    v_cvt_pk_bf16_f32 v197, v126, v127
    v_mfma_f32_16x16x32_bf16 a[20:23], a[204:207], v[224:227], a[20:23]
    v_exp_f32 v129, v129
    v_mfma_f32_16x16x32_bf16 a[20:23], a[200:203], v[220:223], a[20:23]
    ds_read_b128 a[156:159], v4 offset:4096
    v_mfma_f32_16x16x32_bf16 a[24:27], a[200:203], v[228:231], a[24:27]
    v_exp_f32 v130, v130
    v_mfma_f32_16x16x32_bf16 a[24:27], a[204:207], v[232:235], a[24:27]
    v_cvt_pk_bf16_f32 v204, v128, v129
    v_mfma_f32_16x16x32_bf16 a[28:31], a[204:207], v[240:243], a[28:31]
    v_exp_f32 v131, v131
    v_mfma_f32_16x16x32_bf16 a[28:31], a[200:203], v[236:239], a[28:31]
    buffer_load_dwordx4 v16, s[8:11], s28 offen offset:3072 lds
    v_smfmac_f32_16x16x64_bf16 a[224:227], v[244:247], v[212:219], v248
    s_waitcnt lgkmcnt(6)
    v_mfma_f32_16x16x32_bf16 v[124:127], a[128:131], v[68:71], v[108:111]
    s_cmp_eq_u32 s5, 0
    s_cbranch_scc1 L_site0
L_site_back0:
    v_exp_f32 v132, v132
    v_mfma_f32_16x16x32_bf16 v[124:127], a[132:135], v[72:75], v[124:127]
    ds_read_b64_tr_b16 a[192:193], v9 offset:16384
    v_cvt_pk_bf16_f32 v205, v130, v131
    v_mfma_f32_16x16x32_bf16 v[124:127], a[136:139], v[76:79], v[124:127]
    v_exp_f32 v133, v133
    v_mfma_f32_16x16x32_bf16 v[124:127], a[140:143], v[80:83], v[124:127]
    ds_read_b64_tr_b16 a[194:195], v9 offset:20480
    v_mfma_f32_16x16x32_bf16 v[128:131], a[140:143], v[96:99], v[112:115]
    v_exp_f32 v134, v134
    v_mfma_f32_16x16x32_bf16 v[128:131], a[136:139], v[92:95], v[128:131]
    ds_read_b128 a[160:163], v1 offset:8192
    v_cvt_pk_bf16_f32 v182, v132, v133
    v_mfma_f32_16x16x32_bf16 v[128:131], a[132:135], v[88:91], v[128:131]
    v_exp_f32 v135, v135
    v_mfma_f32_16x16x32_bf16 v[128:131], a[128:131], v[84:87], v[128:131]
    ds_read_b64_tr_b16 a[196:197], v9 offset:40960
    v_mfma_f32_16x16x32_bf16 a[32:35], a[208:211], v[212:215], a[32:35]
    v_exp_f32 v136, v136
    v_mfma_f32_16x16x32_bf16 a[32:35], a[212:215], v[216:219], a[32:35]
    ds_read_b64_tr_b16 a[198:199], v9 offset:45056
    v_cvt_pk_bf16_f32 v183, v134, v135
    v_mfma_f32_16x16x32_bf16 a[36:39], a[212:215], v[224:227], a[36:39]
    v_exp_f32 v137, v137
    v_mfma_f32_16x16x32_bf16 a[36:39], a[208:211], v[220:223], a[36:39]
    ds_read_b128 a[164:167], v2 offset:8192
    v_cvt_pk_bf16_f32 v190, v136, v137
    v_mfma_f32_16x16x32_bf16 a[40:43], a[208:211], v[228:231], a[40:43]
    s_add_u32 s28, s28, 16384
    s_mov_b32 m0, s33
    v_exp_f32 v138, v138
    v_mfma_f32_16x16x32_bf16 a[40:43], a[212:215], v[232:235], a[40:43]
    buffer_load_dwordx4 v17, s[12:15], s29 offen offset:0 lds
    v_mfma_f32_16x16x32_bf16 a[44:47], a[212:215], v[240:243], a[44:47]
    v_exp_f32 v139, v139
    v_mfma_f32_16x16x32_bf16 a[44:47], a[208:211], v[236:239], a[44:47]
    s_waitcnt lgkmcnt(6)
    v_mfma_f32_16x16x32_bf16 v[132:135], a[144:147], v[36:39], v[100:103]
    v_exp_f32 v140, v140
    v_mfma_f32_16x16x32_bf16 v[132:135], a[148:151], v[40:43], v[132:135]
    ds_read_b64_tr_b16 a[200:201], v10 offset:16384
    v_cvt_pk_bf16_f32 v191, v138, v139
    v_mfma_f32_16x16x32_bf16 v[132:135], a[152:155], v[44:47], v[132:135]
    v_exp_f32 v141, v141
    v_mfma_f32_16x16x32_bf16 v[132:135], a[156:159], v[48:51], v[132:135]
    ds_read_b64_tr_b16 a[202:203], v10 offset:20480
    v_mfma_f32_16x16x32_bf16 v[136:139], a[156:159], v[64:67], v[104:107]
    v_exp_f32 v142, v142
    v_mfma_f32_16x16x32_bf16 v[136:139], a[152:155], v[60:63], v[136:139]
    ds_read_b128 a[168:171], v3 offset:8192
    v_cvt_pk_bf16_f32 v198, v140, v141
    v_mfma_f32_16x16x32_bf16 v[136:139], a[148:151], v[56:59], v[136:139]
    v_exp_f32 v143, v143
    v_mfma_f32_16x16x32_bf16 v[136:139], a[144:147], v[52:55], v[136:139]
    ds_read_b64_tr_b16 a[204:205], v10 offset:40960
    v_mfma_f32_16x16x32_bf16 a[48:51], a[216:219], v[212:215], a[48:51]
    v_exp_f32 v144, v144
    v_mfma_f32_16x16x32_bf16 a[48:51], a[220:223], v[216:219], a[48:51]
    ds_read_b64_tr_b16 a[206:207], v10 offset:45056
    v_cvt_pk_bf16_f32 v199, v142, v143
    v_mfma_f32_16x16x32_bf16 a[52:55], a[220:223], v[224:227], a[52:55]
    v_exp_f32 v145, v145
    v_mfma_f32_16x16x32_bf16 a[52:55], a[216:219], v[220:223], a[52:55]
    ds_read_b128 a[172:175], v4 offset:8192
    v_mfma_f32_16x16x32_bf16 a[56:59], a[216:219], v[228:231], a[56:59]
    v_exp_f32 v146, v146
    v_mfma_f32_16x16x32_bf16 a[56:59], a[220:223], v[232:235], a[56:59]
    v_cvt_pk_bf16_f32 v206, v144, v145
    v_mfma_f32_16x16x32_bf16 a[60:63], a[220:223], v[240:243], a[60:63]
    v_exp_f32 v147, v147
    v_mfma_f32_16x16x32_bf16 a[60:63], a[216:219], v[236:239], a[60:63]
    buffer_load_dwordx4 v18, s[12:15], s29 offen offset:1024 lds
    v_smfmac_f32_16x16x64_bf16 a[228:231], v[244:247], v[220:227], v248
    s_waitcnt lgkmcnt(6)
    v_mfma_f32_16x16x32_bf16 v[140:143], a[144:147], v[68:71], v[108:111]
    v_exp_f32 v148, v148
    v_mfma_f32_16x16x32_bf16 v[140:143], a[148:151], v[72:75], v[140:143]
    ds_read_b64_tr_b16 a[208:209], v11 offset:16384
    v_cvt_pk_bf16_f32 v207, v146, v147
    v_mfma_f32_16x16x32_bf16 v[140:143], a[152:155], v[76:79], v[140:143]
    v_exp_f32 v149, v149
    v_mfma_f32_16x16x32_bf16 v[140:143], a[156:159], v[80:83], v[140:143]
    ds_read_b64_tr_b16 a[210:211], v11 offset:20480
    v_mfma_f32_16x16x32_bf16 v[144:147], a[156:159], v[96:99], v[112:115]
    v_exp_f32 v150, v150
    v_mfma_f32_16x16x32_bf16 v[144:147], a[152:155], v[92:95], v[144:147]
    ds_read_b128 a[176:179], v1 offset:12288
    v_cvt_pk_bf16_f32 v184, v148, v149
    v_mfma_f32_16x16x32_bf16 v[144:147], a[148:151], v[88:91], v[144:147]
    v_exp_f32 v151, v151
    v_mfma_f32_16x16x32_bf16 v[144:147], a[144:147], v[84:87], v[144:147]
    ds_read_b64_tr_b16 a[212:213], v11 offset:40960
    v_mfma_f32_16x16x32_bf16 a[64:67], a[192:195], v[212:215], a[64:67]
    v_exp_f32 v152, v152
    v_mfma_f32_16x16x32_bf16 a[64:67], a[196:199], v[216:219], a[64:67]
    ds_read_b64_tr_b16 a[214:215], v11 offset:45056
    v_cvt_pk_bf16_f32 v185, v150, v151
    v_mfma_f32_16x16x32_bf16 a[68:71], a[196:199], v[224:227], a[68:71]
    v_exp_f32 v153, v153
    v_mfma_f32_16x16x32_bf16 a[68:71], a[192:195], v[220:223], a[68:71]
    ds_read_b128 a[180:183], v2 offset:12288
    v_cvt_pk_bf16_f32 v192, v152, v153
    v_mfma_f32_16x16x32_bf16 a[72:75], a[192:195], v[228:231], a[72:75]
    v_exp_f32 v154, v154
    v_mfma_f32_16x16x32_bf16 a[72:75], a[196:199], v[232:235], a[72:75]
    buffer_load_dwordx4 v17, s[12:15], s29 offen offset:2048 lds
    v_mfma_f32_16x16x32_bf16 a[76:79], a[196:199], v[240:243], a[76:79]
    v_exp_f32 v155, v155
    v_mfma_f32_16x16x32_bf16 a[76:79], a[192:195], v[236:239], a[76:79]
    s_waitcnt lgkmcnt(6)
    v_mfma_f32_16x16x32_bf16 v[148:151], a[160:163], v[36:39], v[100:103]
    v_exp_f32 v156, v156
    v_mfma_f32_16x16x32_bf16 v[148:151], a[164:167], v[40:43], v[148:151]
    ds_read_b64_tr_b16 a[216:217], v12 offset:16384
    v_cvt_pk_bf16_f32 v193, v154, v155
    v_mfma_f32_16x16x32_bf16 v[148:151], a[168:171], v[44:47], v[148:151]
    v_exp_f32 v157, v157
    v_mfma_f32_16x16x32_bf16 v[148:151], a[172:175], v[48:51], v[148:151]
    ds_read_b64_tr_b16 a[218:219], v12 offset:20480
    v_mfma_f32_16x16x32_bf16 v[152:155], a[172:175], v[64:67], v[104:107]
    v_exp_f32 v158, v158
    v_mfma_f32_16x16x32_bf16 v[152:155], a[168:171], v[60:63], v[152:155]
    ds_read_b128 a[184:187], v3 offset:12288
    v_cvt_pk_bf16_f32 v200, v156, v157
    v_mfma_f32_16x16x32_bf16 v[152:155], a[164:167], v[56:59], v[152:155]
    v_exp_f32 v159, v159
    v_mfma_f32_16x16x32_bf16 v[152:155], a[160:163], v[52:55], v[152:155]
    ds_read_b64_tr_b16 a[220:221], v12 offset:40960
    v_mfma_f32_16x16x32_bf16 a[80:83], a[200:203], v[212:215], a[80:83]
    v_exp_f32 v160, v160
    v_mfma_f32_16x16x32_bf16 a[80:83], a[204:207], v[216:219], a[80:83]
    ds_read_b64_tr_b16 a[222:223], v12 offset:45056
    v_cvt_pk_bf16_f32 v201, v158, v159
    v_mfma_f32_16x16x32_bf16 a[84:87], a[204:207], v[224:227], a[84:87]
    v_exp_f32 v161, v161
    v_mfma_f32_16x16x32_bf16 a[84:87], a[200:203], v[220:223], a[84:87]
    ds_read_b128 a[188:191], v4 offset:12288
    v_mfma_f32_16x16x32_bf16 a[88:91], a[200:203], v[228:231], a[88:91]
    v_exp_f32 v162, v162
    v_mfma_f32_16x16x32_bf16 a[88:91], a[204:207], v[232:235], a[88:91]
    v_cvt_pk_bf16_f32 v208, v160, v161
    v_mfma_f32_16x16x32_bf16 a[92:95], a[204:207], v[240:243], a[92:95]
    v_exp_f32 v163, v163
    v_mfma_f32_16x16x32_bf16 a[92:95], a[200:203], v[236:239], a[92:95]
    buffer_load_dwordx4 v18, s[12:15], s29 offen offset:3072 lds
    v_smfmac_f32_16x16x64_bf16 a[232:235], v[244:247], v[228:235], v248
    s_waitcnt vmcnt(8) lgkmcnt(6)
    s_barrier
    s_add_u32 s29, s29, 16384
    v_mfma_f32_16x16x32_bf16 v[156:159], a[160:163], v[68:71], v[108:111]
    v_exp_f32 v164, v164
    v_mfma_f32_16x16x32_bf16 v[156:159], a[164:167], v[72:75], v[156:159]
    ds_read_b64_tr_b16 a[192:193], v5 offset:57344
    v_cvt_pk_bf16_f32 v209, v162, v163
    v_mfma_f32_16x16x32_bf16 v[156:159], a[168:171], v[76:79], v[156:159]
    v_exp_f32 v165, v165
    v_mfma_f32_16x16x32_bf16 v[156:159], a[172:175], v[80:83], v[156:159]
    ds_read_b64_tr_b16 a[194:195], v5 offset:61440
    v_mfma_f32_16x16x32_bf16 v[160:163], a[172:175], v[96:99], v[112:115]
    v_exp_f32 v166, v166
    v_mfma_f32_16x16x32_bf16 v[160:163], a[168:171], v[92:95], v[160:163]
    ds_read_b128 a[128:131], v1 offset:49152
    v_cvt_pk_bf16_f32 v186, v164, v165
    v_mfma_f32_16x16x32_bf16 v[160:163], a[164:167], v[88:91], v[160:163]
    v_exp_f32 v167, v167
    v_mfma_f32_16x16x32_bf16 v[160:163], a[160:163], v[84:87], v[160:163]
    ds_read_b64_tr_b16 a[196:197], v5 offset:0
    v_mfma_f32_16x16x32_bf16 a[96:99], a[208:211], v[212:215], a[96:99]
    v_exp_f32 v168, v168
    v_mfma_f32_16x16x32_bf16 a[96:99], a[212:215], v[216:219], a[96:99]
    ds_read_b64_tr_b16 a[198:199], v5 offset:4096
    v_cvt_pk_bf16_f32 v187, v166, v167
    v_mfma_f32_16x16x32_bf16 a[100:103], a[212:215], v[224:227], a[100:103]
    v_exp_f32 v169, v169
    v_mfma_f32_16x16x32_bf16 a[100:103], a[208:211], v[220:223], a[100:103]
    ds_read_b128 a[132:135], v2 offset:49152
    v_cvt_pk_bf16_f32 v194, v168, v169
    v_mfma_f32_16x16x32_bf16 a[104:107], a[208:211], v[228:231], a[104:107]
    s_add_u32 m0, s34, 32768
    v_exp_f32 v170, v170
    v_mfma_f32_16x16x32_bf16 a[104:107], a[212:215], v[232:235], a[104:107]
    buffer_load_dwordx4 v13, s[8:11], s28 offen offset:0 lds
    v_mfma_f32_16x16x32_bf16 a[108:111], a[212:215], v[240:243], a[108:111]
    v_exp_f32 v171, v171
    v_mfma_f32_16x16x32_bf16 a[108:111], a[208:211], v[236:239], a[108:111]
    s_waitcnt lgkmcnt(6)
    v_mfma_f32_16x16x32_bf16 v[164:167], a[176:179], v[36:39], v[100:103]
    v_exp_f32 v172, v172
    v_mfma_f32_16x16x32_bf16 v[164:167], a[180:183], v[40:43], v[164:167]
    ds_read_b64_tr_b16 a[200:201], v6 offset:57344
    v_cvt_pk_bf16_f32 v195, v170, v171
    v_mfma_f32_16x16x32_bf16 v[164:167], a[184:187], v[44:47], v[164:167]
    v_exp_f32 v173, v173
    v_mfma_f32_16x16x32_bf16 v[164:167], a[188:191], v[48:51], v[164:167]
    ds_read_b64_tr_b16 a[202:203], v6 offset:61440
    v_mfma_f32_16x16x32_bf16 v[168:171], a[188:191], v[64:67], v[104:107]
    v_exp_f32 v174, v174
    v_mfma_f32_16x16x32_bf16 v[168:171], a[184:187], v[60:63], v[168:171]
    ds_read_b128 a[136:139], v3 offset:49152
    v_cvt_pk_bf16_f32 v202, v172, v173
    v_mfma_f32_16x16x32_bf16 v[168:171], a[180:183], v[56:59], v[168:171]
    v_exp_f32 v175, v175
    v_mfma_f32_16x16x32_bf16 v[168:171], a[176:179], v[52:55], v[168:171]
    ds_read_b64_tr_b16 a[204:205], v6 offset:0
    v_mfma_f32_16x16x32_bf16 a[112:115], a[216:219], v[212:215], a[112:115]
    v_exp_f32 v176, v176
    v_mfma_f32_16x16x32_bf16 a[112:115], a[220:223], v[216:219], a[112:115]
    ds_read_b64_tr_b16 a[206:207], v6 offset:4096
    v_cvt_pk_bf16_f32 v203, v174, v175
    v_mfma_f32_16x16x32_bf16 a[116:119], a[220:223], v[224:227], a[116:119]
    v_exp_f32 v177, v177
    v_mfma_f32_16x16x32_bf16 a[116:119], a[216:219], v[220:223], a[116:119]
    ds_read_b128 a[140:143], v4 offset:49152
    v_mfma_f32_16x16x32_bf16 a[120:123], a[216:219], v[228:231], a[120:123]
    v_exp_f32 v178, v178
    v_mfma_f32_16x16x32_bf16 a[120:123], a[220:223], v[232:235], a[120:123]
    v_cvt_pk_bf16_f32 v210, v176, v177
    v_mfma_f32_16x16x32_bf16 a[124:127], a[220:223], v[240:243], a[124:127]
    v_exp_f32 v179, v179
    v_mfma_f32_16x16x32_bf16 a[124:127], a[216:219], v[236:239], a[124:127]
    buffer_load_dwordx4 v14, s[8:11], s28 offen offset:1024 lds
    v_smfmac_f32_16x16x64_bf16 a[236:239], v[244:247], v[236:243], v248
    s_waitcnt lgkmcnt(6)
    v_mfma_f32_16x16x32_bf16 v[172:175], a[176:179], v[68:71], v[108:111]
    v_exp_f32 v116, v116
    v_mfma_f32_16x16x32_bf16 v[172:175], a[180:183], v[72:75], v[172:175]
    ds_read_b64_tr_b16 a[208:209], v7 offset:57344
    v_cvt_pk_bf16_f32 v211, v178, v179
    v_mfma_f32_16x16x32_bf16 v[172:175], a[184:187], v[76:79], v[172:175]
    v_exp_f32 v117, v117
    v_mfma_f32_16x16x32_bf16 v[172:175], a[188:191], v[80:83], v[172:175]
    ds_read_b64_tr_b16 a[210:211], v7 offset:61440
    v_mfma_f32_16x16x32_bf16 v[176:179], a[188:191], v[96:99], v[112:115]
    v_exp_f32 v118, v118
    v_mfma_f32_16x16x32_bf16 v[176:179], a[184:187], v[92:95], v[176:179]
    ds_read_b128 a[144:147], v1 offset:53248
    v_cvt_pk_bf16_f32 v212, v116, v117
    v_mfma_f32_16x16x32_bf16 v[176:179], a[180:183], v[88:91], v[176:179]
    v_exp_f32 v119, v119
    v_mfma_f32_16x16x32_bf16 v[176:179], a[176:179], v[84:87], v[176:179]
    ds_read_b64_tr_b16 a[212:213], v7 offset:0
    v_mfma_f32_16x16x32_bf16 a[0:3], a[192:195], v[180:183], a[0:3]
    v_exp_f32 v120, v120
    v_mfma_f32_16x16x32_bf16 a[0:3], a[196:199], v[184:187], a[0:3]
    ds_read_b64_tr_b16 a[214:215], v7 offset:4096
    v_cvt_pk_bf16_f32 v213, v118, v119
    v_mfma_f32_16x16x32_bf16 a[4:7], a[196:199], v[192:195], a[4:7]
    v_exp_f32 v121, v121
    v_mfma_f32_16x16x32_bf16 a[4:7], a[192:195], v[188:191], a[4:7]
    ds_read_b128 a[148:151], v2 offset:53248
    v_cvt_pk_bf16_f32 v220, v120, v121
    v_mfma_f32_16x16x32_bf16 a[8:11], a[192:195], v[196:199], a[8:11]
    v_exp_f32 v122, v122
    v_mfma_f32_16x16x32_bf16 a[8:11], a[196:199], v[200:203], a[8:11]
    buffer_load_dwordx4 v15, s[8:11], s28 offen offset:2048 lds
    v_mfma_f32_16x16x32_bf16 a[12:15], a[196:199], v[208:211], a[12:15]
    v_exp_f32 v123, v123
    v_mfma_f32_16x16x32_bf16 a[12:15], a[192:195], v[204:207], a[12:15]
    s_waitcnt lgkmcnt(6)
    v_mfma_f32_16x16x32_bf16 v[116:119], a[128:131], v[36:39], v[100:103]
    v_exp_f32 v124, v124
    v_mfma_f32_16x16x32_bf16 v[116:119], a[132:135], v[40:43], v[116:119]
    ds_read_b64_tr_b16 a[216:217], v8 offset:57344
    v_cvt_pk_bf16_f32 v221, v122, v123
    v_mfma_f32_16x16x32_bf16 v[116:119], a[136:139], v[44:47], v[116:119]
    v_exp_f32 v125, v125
    v_mfma_f32_16x16x32_bf16 v[116:119], a[140:143], v[48:51], v[116:119]
    ds_read_b64_tr_b16 a[218:219], v8 offset:61440
    v_mfma_f32_16x16x32_bf16 v[120:123], a[140:143], v[64:67], v[104:107]
    v_exp_f32 v126, v126
    v_mfma_f32_16x16x32_bf16 v[120:123], a[136:139], v[60:63], v[120:123]
    ds_read_b128 a[152:155], v3 offset:53248
    v_cvt_pk_bf16_f32 v228, v124, v125
    v_mfma_f32_16x16x32_bf16 v[120:123], a[132:135], v[56:59], v[120:123]
    v_exp_f32 v127, v127
    v_mfma_f32_16x16x32_bf16 v[120:123], a[128:131], v[52:55], v[120:123]
    ds_read_b64_tr_b16 a[220:221], v8 offset:0
    v_mfma_f32_16x16x32_bf16 a[16:19], a[200:203], v[180:183], a[16:19]
    v_exp_f32 v128, v128
    v_mfma_f32_16x16x32_bf16 a[16:19], a[204:207], v[184:187], a[16:19]
    ds_read_b64_tr_b16 a[222:223], v8 offset:4096
    v_cvt_pk_bf16_f32 v229, v126, v127
    v_mfma_f32_16x16x32_bf16 a[20:23], a[204:207], v[192:195], a[20:23]
    v_exp_f32 v129, v129
    v_mfma_f32_16x16x32_bf16 a[20:23], a[200:203], v[188:191], a[20:23]
    ds_read_b128 a[156:159], v4 offset:53248
    v_mfma_f32_16x16x32_bf16 a[24:27], a[200:203], v[196:199], a[24:27]
    v_exp_f32 v130, v130
    v_mfma_f32_16x16x32_bf16 a[24:27], a[204:207], v[200:203], a[24:27]
    v_cvt_pk_bf16_f32 v236, v128, v129
    v_mfma_f32_16x16x32_bf16 a[28:31], a[204:207], v[208:211], a[28:31]
    v_exp_f32 v131, v131
    v_mfma_f32_16x16x32_bf16 a[28:31], a[200:203], v[204:207], a[28:31]
    buffer_load_dwordx4 v16, s[8:11], s28 offen offset:3072 lds
    v_smfmac_f32_16x16x64_bf16 a[224:227], v[244:247], v[180:187], v248
    s_waitcnt lgkmcnt(6)
    v_mfma_f32_16x16x32_bf16 v[124:127], a[128:131], v[68:71], v[108:111]
    s_cmp_eq_u32 s5, 1
    s_cbranch_scc1 L_site1
L_site_back1:
    v_exp_f32 v132, v132
    v_mfma_f32_16x16x32_bf16 v[124:127], a[132:135], v[72:75], v[124:127]
    ds_read_b64_tr_b16 a[192:193], v9 offset:57344
    v_cvt_pk_bf16_f32 v237, v130, v131
    v_mfma_f32_16x16x32_bf16 v[124:127], a[136:139], v[76:79], v[124:127]
    v_exp_f32 v133, v133
    v_mfma_f32_16x16x32_bf16 v[124:127], a[140:143], v[80:83], v[124:127]
    ds_read_b64_tr_b16 a[194:195], v9 offset:61440
    v_mfma_f32_16x16x32_bf16 v[128:131], a[140:143], v[96:99], v[112:115]
    v_exp_f32 v134, v134
    v_mfma_f32_16x16x32_bf16 v[128:131], a[136:139], v[92:95], v[128:131]
    ds_read_b128 a[160:163], v1 offset:57344
    v_cvt_pk_bf16_f32 v214, v132, v133
    v_mfma_f32_16x16x32_bf16 v[128:131], a[132:135], v[88:91], v[128:131]
    v_exp_f32 v135, v135
    v_mfma_f32_16x16x32_bf16 v[128:131], a[128:131], v[84:87], v[128:131]
    ds_read_b64_tr_b16 a[196:197], v9 offset:0
    v_mfma_f32_16x16x32_bf16 a[32:35], a[208:211], v[180:183], a[32:35]
    v_exp_f32 v136, v136
    v_mfma_f32_16x16x32_bf16 a[32:35], a[212:215], v[184:187], a[32:35]
    ds_read_b64_tr_b16 a[198:199], v9 offset:4096
    v_cvt_pk_bf16_f32 v215, v134, v135
    v_mfma_f32_16x16x32_bf16 a[36:39], a[212:215], v[192:195], a[36:39]
    v_exp_f32 v137, v137
    v_mfma_f32_16x16x32_bf16 a[36:39], a[208:211], v[188:191], a[36:39]
    ds_read_b128 a[164:167], v2 offset:57344
    v_cvt_pk_bf16_f32 v222, v136, v137
    v_mfma_f32_16x16x32_bf16 a[40:43], a[208:211], v[196:199], a[40:43]
    s_add_u32 s28, s28, 16384
    s_mov_b32 m0, s30
    v_exp_f32 v138, v138
    v_mfma_f32_16x16x32_bf16 a[40:43], a[212:215], v[200:203], a[40:43]
    buffer_load_dwordx4 v17, s[12:15], s29 offen offset:0 lds
    v_mfma_f32_16x16x32_bf16 a[44:47], a[212:215], v[208:211], a[44:47]
    v_exp_f32 v139, v139
    v_mfma_f32_16x16x32_bf16 a[44:47], a[208:211], v[204:207], a[44:47]
    s_waitcnt lgkmcnt(6)
    v_mfma_f32_16x16x32_bf16 v[132:135], a[144:147], v[36:39], v[100:103]
    v_exp_f32 v140, v140
    v_mfma_f32_16x16x32_bf16 v[132:135], a[148:151], v[40:43], v[132:135]
    ds_read_b64_tr_b16 a[200:201], v10 offset:57344
    v_cvt_pk_bf16_f32 v223, v138, v139
    v_mfma_f32_16x16x32_bf16 v[132:135], a[152:155], v[44:47], v[132:135]
    v_exp_f32 v141, v141
    v_mfma_f32_16x16x32_bf16 v[132:135], a[156:159], v[48:51], v[132:135]
    ds_read_b64_tr_b16 a[202:203], v10 offset:61440
    v_mfma_f32_16x16x32_bf16 v[136:139], a[156:159], v[64:67], v[104:107]
    v_exp_f32 v142, v142
    v_mfma_f32_16x16x32_bf16 v[136:139], a[152:155], v[60:63], v[136:139]
    ds_read_b128 a[168:171], v3 offset:57344
    v_cvt_pk_bf16_f32 v230, v140, v141
    v_mfma_f32_16x16x32_bf16 v[136:139], a[148:151], v[56:59], v[136:139]
    v_exp_f32 v143, v143
    v_mfma_f32_16x16x32_bf16 v[136:139], a[144:147], v[52:55], v[136:139]
    ds_read_b64_tr_b16 a[204:205], v10 offset:0
    v_mfma_f32_16x16x32_bf16 a[48:51], a[216:219], v[180:183], a[48:51]
    v_exp_f32 v144, v144
    v_mfma_f32_16x16x32_bf16 a[48:51], a[220:223], v[184:187], a[48:51]
    ds_read_b64_tr_b16 a[206:207], v10 offset:4096
    v_cvt_pk_bf16_f32 v231, v142, v143
    v_mfma_f32_16x16x32_bf16 a[52:55], a[220:223], v[192:195], a[52:55]
    v_exp_f32 v145, v145
    v_mfma_f32_16x16x32_bf16 a[52:55], a[216:219], v[188:191], a[52:55]
    ds_read_b128 a[172:175], v4 offset:57344
    v_mfma_f32_16x16x32_bf16 a[56:59], a[216:219], v[196:199], a[56:59]
    v_exp_f32 v146, v146
    v_mfma_f32_16x16x32_bf16 a[56:59], a[220:223], v[200:203], a[56:59]
    v_cvt_pk_bf16_f32 v238, v144, v145
    v_mfma_f32_16x16x32_bf16 a[60:63], a[220:223], v[208:211], a[60:63]
    v_exp_f32 v147, v147
    v_mfma_f32_16x16x32_bf16 a[60:63], a[216:219], v[204:207], a[60:63]
    buffer_load_dwordx4 v18, s[12:15], s29 offen offset:1024 lds
    v_smfmac_f32_16x16x64_bf16 a[228:231], v[244:247], v[188:195], v248
    s_waitcnt lgkmcnt(6)
    v_mfma_f32_16x16x32_bf16 v[140:143], a[144:147], v[68:71], v[108:111]
    v_exp_f32 v148, v148
    v_mfma_f32_16x16x32_bf16 v[140:143], a[148:151], v[72:75], v[140:143]
    ds_read_b64_tr_b16 a[208:209], v11 offset:57344
    v_cvt_pk_bf16_f32 v239, v146, v147
    v_mfma_f32_16x16x32_bf16 v[140:143], a[152:155], v[76:79], v[140:143]
    v_exp_f32 v149, v149
    v_mfma_f32_16x16x32_bf16 v[140:143], a[156:159], v[80:83], v[140:143]
    ds_read_b64_tr_b16 a[210:211], v11 offset:61440
    v_mfma_f32_16x16x32_bf16 v[144:147], a[156:159], v[96:99], v[112:115]
    v_exp_f32 v150, v150
    v_mfma_f32_16x16x32_bf16 v[144:147], a[152:155], v[92:95], v[144:147]
    ds_read_b128 a[176:179], v1 offset:61440
    v_cvt_pk_bf16_f32 v216, v148, v149
    v_mfma_f32_16x16x32_bf16 v[144:147], a[148:151], v[88:91], v[144:147]
    v_exp_f32 v151, v151
    v_mfma_f32_16x16x32_bf16 v[144:147], a[144:147], v[84:87], v[144:147]
    ds_read_b64_tr_b16 a[212:213], v11 offset:0
    v_mfma_f32_16x16x32_bf16 a[64:67], a[192:195], v[180:183], a[64:67]
    v_exp_f32 v152, v152
    v_mfma_f32_16x16x32_bf16 a[64:67], a[196:199], v[184:187], a[64:67]
    ds_read_b64_tr_b16 a[214:215], v11 offset:4096
    v_cvt_pk_bf16_f32 v217, v150, v151
    v_mfma_f32_16x16x32_bf16 a[68:71], a[196:199], v[192:195], a[68:71]
    v_exp_f32 v153, v153
    v_mfma_f32_16x16x32_bf16 a[68:71], a[192:195], v[188:191], a[68:71]
    ds_read_b128 a[180:183], v2 offset:61440
    v_cvt_pk_bf16_f32 v224, v152, v153
    v_mfma_f32_16x16x32_bf16 a[72:75], a[192:195], v[196:199], a[72:75]
    v_exp_f32 v154, v154
    v_mfma_f32_16x16x32_bf16 a[72:75], a[196:199], v[200:203], a[72:75]
    buffer_load_dwordx4 v17, s[12:15], s29 offen offset:2048 lds
    v_mfma_f32_16x16x32_bf16 a[76:79], a[196:199], v[208:211], a[76:79]
    v_exp_f32 v155, v155
    v_mfma_f32_16x16x32_bf16 a[76:79], a[192:195], v[204:207], a[76:79]
    s_waitcnt lgkmcnt(6)
    v_mfma_f32_16x16x32_bf16 v[148:151], a[160:163], v[36:39], v[100:103]
    v_exp_f32 v156, v156
    v_mfma_f32_16x16x32_bf16 v[148:151], a[164:167], v[40:43], v[148:151]
    ds_read_b64_tr_b16 a[216:217], v12 offset:57344
    v_cvt_pk_bf16_f32 v225, v154, v155
    v_mfma_f32_16x16x32_bf16 v[148:151], a[168:171], v[44:47], v[148:151]
    v_exp_f32 v157, v157
    v_mfma_f32_16x16x32_bf16 v[148:151], a[172:175], v[48:51], v[148:151]
    ds_read_b64_tr_b16 a[218:219], v12 offset:61440
    v_mfma_f32_16x16x32_bf16 v[152:155], a[172:175], v[64:67], v[104:107]
    v_exp_f32 v158, v158
    v_mfma_f32_16x16x32_bf16 v[152:155], a[168:171], v[60:63], v[152:155]
    ds_read_b128 a[184:187], v3 offset:61440
    v_cvt_pk_bf16_f32 v232, v156, v157
    v_mfma_f32_16x16x32_bf16 v[152:155], a[164:167], v[56:59], v[152:155]
    v_exp_f32 v159, v159
    v_mfma_f32_16x16x32_bf16 v[152:155], a[160:163], v[52:55], v[152:155]
    ds_read_b64_tr_b16 a[220:221], v12 offset:0
    v_mfma_f32_16x16x32_bf16 a[80:83], a[200:203], v[180:183], a[80:83]
    v_exp_f32 v160, v160
    v_mfma_f32_16x16x32_bf16 a[80:83], a[204:207], v[184:187], a[80:83]
    ds_read_b64_tr_b16 a[222:223], v12 offset:4096
    v_cvt_pk_bf16_f32 v233, v158, v159
    v_mfma_f32_16x16x32_bf16 a[84:87], a[204:207], v[192:195], a[84:87]
    v_exp_f32 v161, v161
    v_mfma_f32_16x16x32_bf16 a[84:87], a[200:203], v[188:191], a[84:87]
    ds_read_b128 a[188:191], v4 offset:61440
    v_mfma_f32_16x16x32_bf16 a[88:91], a[200:203], v[196:199], a[88:91]
    v_exp_f32 v162, v162
    v_mfma_f32_16x16x32_bf16 a[88:91], a[204:207], v[200:203], a[88:91]
    v_cvt_pk_bf16_f32 v240, v160, v161
    v_mfma_f32_16x16x32_bf16 a[92:95], a[204:207], v[208:211], a[92:95]
    v_exp_f32 v163, v163
    v_mfma_f32_16x16x32_bf16 a[92:95], a[200:203], v[204:207], a[92:95]
    buffer_load_dwordx4 v18, s[12:15], s29 offen offset:3072 lds
    v_smfmac_f32_16x16x64_bf16 a[232:235], v[244:247], v[196:203], v248
    s_waitcnt vmcnt(8) lgkmcnt(6)
    s_barrier
    s_add_u32 s29, s29, 16384
    v_mfma_f32_16x16x32_bf16 v[156:159], a[160:163], v[68:71], v[108:111]
    v_exp_f32 v164, v164
    v_mfma_f32_16x16x32_bf16 v[156:159], a[164:167], v[72:75], v[156:159]
    ds_read_b64_tr_b16 a[192:193], v5 offset:24576
    v_cvt_pk_bf16_f32 v241, v162, v163
    v_mfma_f32_16x16x32_bf16 v[156:159], a[168:171], v[76:79], v[156:159]
    v_exp_f32 v165, v165
    v_mfma_f32_16x16x32_bf16 v[156:159], a[172:175], v[80:83], v[156:159]
    ds_read_b64_tr_b16 a[194:195], v5 offset:28672
    v_mfma_f32_16x16x32_bf16 v[160:163], a[172:175], v[96:99], v[112:115]
    v_exp_f32 v166, v166
    v_mfma_f32_16x16x32_bf16 v[160:163], a[168:171], v[92:95], v[160:163]
    ds_read_b128 a[128:131], v1 offset:16384
    v_cvt_pk_bf16_f32 v218, v164, v165
    v_mfma_f32_16x16x32_bf16 v[160:163], a[164:167], v[88:91], v[160:163]
    v_exp_f32 v167, v167
    v_mfma_f32_16x16x32_bf16 v[160:163], a[160:163], v[84:87], v[160:163]
    ds_read_b64_tr_b16 a[196:197], v5 offset:49152
    v_mfma_f32_16x16x32_bf16 a[96:99], a[208:211], v[180:183], a[96:99]
    v_exp_f32 v168, v168
    v_mfma_f32_16x16x32_bf16 a[96:99], a[212:215], v[184:187], a[96:99]
    ds_read_b64_tr_b16 a[198:199], v5 offset:53248
    v_cvt_pk_bf16_f32 v219, v166, v167
    v_mfma_f32_16x16x32_bf16 a[100:103], a[212:215], v[192:195], a[100:103]
    v_exp_f32 v169, v169
    v_mfma_f32_16x16x32_bf16 a[100:103], a[208:211], v[188:191], a[100:103]
    ds_read_b128 a[132:135], v2 offset:16384
    v_cvt_pk_bf16_f32 v226, v168, v169
    v_mfma_f32_16x16x32_bf16 a[104:107], a[208:211], v[196:199], a[104:107]
    s_add_u32 m0, s34, 0
    v_exp_f32 v170, v170
    v_mfma_f32_16x16x32_bf16 a[104:107], a[212:215], v[200:203], a[104:107]
    buffer_load_dwordx4 v13, s[8:11], s28 offen offset:0 lds
    v_mfma_f32_16x16x32_bf16 a[108:111], a[212:215], v[208:211], a[108:111]
    v_exp_f32 v171, v171
    v_mfma_f32_16x16x32_bf16 a[108:111], a[208:211], v[204:207], a[108:111]
    s_waitcnt lgkmcnt(6)
    v_mfma_f32_16x16x32_bf16 v[164:167], a[176:179], v[36:39], v[100:103]
    v_exp_f32 v172, v172
    v_mfma_f32_16x16x32_bf16 v[164:167], a[180:183], v[40:43], v[164:167]
    ds_read_b64_tr_b16 a[200:201], v6 offset:24576
    v_cvt_pk_bf16_f32 v227, v170, v171
    v_mfma_f32_16x16x32_bf16 v[164:167], a[184:187], v[44:47], v[164:167]
    v_exp_f32 v173, v173
    v_mfma_f32_16x16x32_bf16 v[164:167], a[188:191], v[48:51], v[164:167]
    ds_read_b64_tr_b16 a[202:203], v6 offset:28672
    v_mfma_f32_16x16x32_bf16 v[168:171], a[188:191], v[64:67], v[104:107]
    v_exp_f32 v174, v174
    v_mfma_f32_16x16x32_bf16 v[168:171], a[184:187], v[60:63], v[168:171]
    ds_read_b128 a[136:139], v3 offset:16384
    v_cvt_pk_bf16_f32 v234, v172, v173
    v_mfma_f32_16x16x32_bf16 v[168:171], a[180:183], v[56:59], v[168:171]
    v_exp_f32 v175, v175
    v_mfma_f32_16x16x32_bf16 v[168:171], a[176:179], v[52:55], v[168:171]
    ds_read_b64_tr_b16 a[204:205], v6 offset:49152
    v_mfma_f32_16x16x32_bf16 a[112:115], a[216:219], v[180:183], a[112:115]
    v_exp_f32 v176, v176
    v_mfma_f32_16x16x32_bf16 a[112:115], a[220:223], v[184:187], a[112:115]
    ds_read_b64_tr_b16 a[206:207], v6 offset:53248
    v_cvt_pk_bf16_f32 v235, v174, v175
    v_mfma_f32_16x16x32_bf16 a[116:119], a[220:223], v[192:195], a[116:119]
    v_exp_f32 v177, v177
    v_mfma_f32_16x16x32_bf16 a[116:119], a[216:219], v[188:191], a[116:119]
    ds_read_b128 a[140:143], v4 offset:16384
    v_mfma_f32_16x16x32_bf16 a[120:123], a[216:219], v[196:199], a[120:123]
    v_exp_f32 v178, v178
    v_mfma_f32_16x16x32_bf16 a[120:123], a[220:223], v[200:203], a[120:123]
    v_cvt_pk_bf16_f32 v242, v176, v177
    v_mfma_f32_16x16x32_bf16 a[124:127], a[220:223], v[208:211], a[124:127]
    v_exp_f32 v179, v179
    v_mfma_f32_16x16x32_bf16 a[124:127], a[216:219], v[204:207], a[124:127]
    buffer_load_dwordx4 v14, s[8:11], s28 offen offset:1024 lds
    v_smfmac_f32_16x16x64_bf16 a[236:239], v[244:247], v[204:211], v248
    s_waitcnt lgkmcnt(6)
    v_mfma_f32_16x16x32_bf16 v[172:175], a[176:179], v[68:71], v[108:111]
    v_exp_f32 v116, v116
    v_mfma_f32_16x16x32_bf16 v[172:175], a[180:183], v[72:75], v[172:175]
    ds_read_b64_tr_b16 a[208:209], v7 offset:24576
    v_cvt_pk_bf16_f32 v243, v178, v179
    v_mfma_f32_16x16x32_bf16 v[172:175], a[184:187], v[76:79], v[172:175]
    v_exp_f32 v117, v117
    v_mfma_f32_16x16x32_bf16 v[172:175], a[188:191], v[80:83], v[172:175]
    ds_read_b64_tr_b16 a[210:211], v7 offset:28672
    v_mfma_f32_16x16x32_bf16 v[176:179], a[188:191], v[96:99], v[112:115]
    v_exp_f32 v118, v118
    v_mfma_f32_16x16x32_bf16 v[176:179], a[184:187], v[92:95], v[176:179]
    ds_read_b128 a[144:147], v1 offset:20480
    v_cvt_pk_bf16_f32 v180, v116, v117
    v_mfma_f32_16x16x32_bf16 v[176:179], a[180:183], v[88:91], v[176:179]
    v_exp_f32 v119, v119
    v_mfma_f32_16x16x32_bf16 v[176:179], a[176:179], v[84:87], v[176:179]
    ds_read_b64_tr_b16 a[212:213], v7 offset:49152
    v_mfma_f32_16x16x32_bf16 a[0:3], a[192:195], v[212:215], a[0:3]
    v_exp_f32 v120, v120
    v_mfma_f32_16x16x32_bf16 a[0:3], a[196:199], v[216:219], a[0:3]
    ds_read_b64_tr_b16 a[214:215], v7 offset:53248
    v_cvt_pk_bf16_f32 v181, v118, v119
    v_mfma_f32_16x16x32_bf16 a[4:7], a[196:199], v[224:227], a[4:7]
    v_exp_f32 v121, v121
    v_mfma_f32_16x16x32_bf16 a[4:7], a[192:195], v[220:223], a[4:7]
    ds_read_b128 a[148:151], v2 offset:20480
    v_cvt_pk_bf16_f32 v188, v120, v121
    v_mfma_f32_16x16x32_bf16 a[8:11], a[192:195], v[228:231], a[8:11]
    v_exp_f32 v122, v122
    v_mfma_f32_16x16x32_bf16 a[8:11], a[196:199], v[232:235], a[8:11]
    buffer_load_dwordx4 v15, s[8:11], s28 offen offset:2048 lds
    v_mfma_f32_16x16x32_bf16 a[12:15], a[196:199], v[240:243], a[12:15]
    v_exp_f32 v123, v123
    v_mfma_f32_16x16x32_bf16 a[12:15], a[192:195], v[236:239], a[12:15]
    s_waitcnt lgkmcnt(6)
    v_mfma_f32_16x16x32_bf16 v[116:119], a[128:131], v[36:39], v[100:103]
    v_exp_f32 v124, v124
    v_mfma_f32_16x16x32_bf16 v[116:119], a[132:135], v[40:43], v[116:119]
    ds_read_b64_tr_b16 a[216:217], v8 offset:24576
    v_cvt_pk_bf16_f32 v189, v122, v123
    v_mfma_f32_16x16x32_bf16 v[116:119], a[136:139], v[44:47], v[116:119]
    v_exp_f32 v125, v125
    v_mfma_f32_16x16x32_bf16 v[116:119], a[140:143], v[48:51], v[116:119]
    ds_read_b64_tr_b16 a[218:219], v8 offset:28672
    v_mfma_f32_16x16x32_bf16 v[120:123], a[140:143], v[64:67], v[104:107]
    v_exp_f32 v126, v126
    v_mfma_f32_16x16x32_bf16 v[120:123], a[136:139], v[60:63], v[120:123]
    ds_read_b128 a[152:155], v3 offset:20480
    v_cvt_pk_bf16_f32 v196, v124, v125
    v_mfma_f32_16x16x32_bf16 v[120:123], a[132:135], v[56:59], v[120:123]
    v_exp_f32 v127, v127
    v_mfma_f32_16x16x32_bf16 v[120:123], a[128:131], v[52:55], v[120:123]
    ds_read_b64_tr_b16 a[220:221], v8 offset:49152
    v_mfma_f32_16x16x32_bf16 a[16:19], a[200:203], v[212:215], a[16:19]
    v_exp_f32 v128, v128
    v_mfma_f32_16x16x32_bf16 a[16:19], a[204:207], v[216:219], a[16:19]
    ds_read_b64_tr_b16 a[222:223], v8 offset:53248
    v_cvt_pk_bf16_f32 v197, v126, v127
    v_mfma_f32_16x16x32_bf16 a[20:23], a[204:207], v[224:227], a[20:23]
    v_exp_f32 v129, v129
    v_mfma_f32_16x16x32_bf16 a[20:23], a[200:203], v[220:223], a[20:23]
    ds_read_b128 a[156:159], v4 offset:20480
    v_mfma_f32_16x16x32_bf16 a[24:27], a[200:203], v[228:231], a[24:27]
    v_exp_f32 v130, v130
    v_mfma_f32_16x16x32_bf16 a[24:27], a[204:207], v[232:235], a[24:27]
    v_cvt_pk_bf16_f32 v204, v128, v129
    v_mfma_f32_16x16x32_bf16 a[28:31], a[204:207], v[240:243], a[28:31]
    v_exp_f32 v131, v131
    v_mfma_f32_16x16x32_bf16 a[28:31], a[200:203], v[236:239], a[28:31]
    buffer_load_dwordx4 v16, s[8:11], s28 offen offset:3072 lds
    v_smfmac_f32_16x16x64_bf16 a[224:227], v[244:247], v[212:219], v248
    s_waitcnt lgkmcnt(6)
    v_mfma_f32_16x16x32_bf16 v[124:127], a[128:131], v[68:71], v[108:111]
    s_cmp_eq_u32 s5, 2
    s_cbranch_scc1 L_site2
L_site_back2:
    v_exp_f32 v132, v132
    v_mfma_f32_16x16x32_bf16 v[124:127], a[132:135], v[72:75], v[124:127]
    ds_read_b64_tr_b16 a[192:193], v9 offset:24576
    v_cvt_pk_bf16_f32 v205, v130, v131
    v_mfma_f32_16x16x32_bf16 v[124:127], a[136:139], v[76:79], v[124:127]
    v_exp_f32 v133, v133
    v_mfma_f32_16x16x32_bf16 v[124:127], a[140:143], v[80:83], v[124:127]
    ds_read_b64_tr_b16 a[194:195], v9 offset:28672
    v_mfma_f32_16x16x32_bf16 v[128:131], a[140:143], v[96:99], v[112:115]
    v_exp_f32 v134, v134
    v_mfma_f32_16x16x32_bf16 v[128:131], a[136:139], v[92:95], v[128:131]
    ds_read_b128 a[160:163], v1 offset:24576
    v_cvt_pk_bf16_f32 v182, v132, v133
    v_mfma_f32_16x16x32_bf16 v[128:131], a[132:135], v[88:91], v[128:131]
    v_exp_f32 v135, v135
    v_mfma_f32_16x16x32_bf16 v[128:131], a[128:131], v[84:87], v[128:131]
    ds_read_b64_tr_b16 a[196:197], v9 offset:49152
    v_mfma_f32_16x16x32_bf16 a[32:35], a[208:211], v[212:215], a[32:35]
    v_exp_f32 v136, v136
    v_mfma_f32_16x16x32_bf16 a[32:35], a[212:215], v[216:219], a[32:35]
    ds_read_b64_tr_b16 a[198:199], v9 offset:53248
    v_cvt_pk_bf16_f32 v183, v134, v135
    v_mfma_f32_16x16x32_bf16 a[36:39], a[212:215], v[224:227], a[36:39]
    v_exp_f32 v137, v137
    v_mfma_f32_16x16x32_bf16 a[36:39], a[208:211], v[220:223], a[36:39]
    ds_read_b128 a[164:167], v2 offset:24576
    v_cvt_pk_bf16_f32 v190, v136, v137
    v_mfma_f32_16x16x32_bf16 a[40:43], a[208:211], v[228:231], a[40:43]
    s_add_u32 s28, s28, 16384
    s_mov_b32 m0, s31
    v_exp_f32 v138, v138
    v_mfma_f32_16x16x32_bf16 a[40:43], a[212:215], v[232:235], a[40:43]
    buffer_load_dwordx4 v17, s[12:15], s29 offen offset:0 lds
    v_mfma_f32_16x16x32_bf16 a[44:47], a[212:215], v[240:243], a[44:47]
    v_exp_f32 v139, v139
    v_mfma_f32_16x16x32_bf16 a[44:47], a[208:211], v[236:239], a[44:47]
    s_waitcnt lgkmcnt(6)
    v_mfma_f32_16x16x32_bf16 v[132:135], a[144:147], v[36:39], v[100:103]
    v_exp_f32 v140, v140
    v_mfma_f32_16x16x32_bf16 v[132:135], a[148:151], v[40:43], v[132:135]
    ds_read_b64_tr_b16 a[200:201], v10 offset:24576
    v_cvt_pk_bf16_f32 v191, v138, v139
    v_mfma_f32_16x16x32_bf16 v[132:135], a[152:155], v[44:47], v[132:135]
    v_exp_f32 v141, v141
    v_mfma_f32_16x16x32_bf16 v[132:135], a[156:159], v[48:51], v[132:135]
    ds_read_b64_tr_b16 a[202:203], v10 offset:28672
    v_mfma_f32_16x16x32_bf16 v[136:139], a[156:159], v[64:67], v[104:107]
    v_exp_f32 v142, v142
    v_mfma_f32_16x16x32_bf16 v[136:139], a[152:155], v[60:63], v[136:139]
    ds_read_b128 a[168:171], v3 offset:24576
    v_cvt_pk_bf16_f32 v198, v140, v141
    v_mfma_f32_16x16x32_bf16 v[136:139], a[148:151], v[56:59], v[136:139]
    v_exp_f32 v143, v143
    v_mfma_f32_16x16x32_bf16 v[136:139], a[144:147], v[52:55], v[136:139]
    ds_read_b64_tr_b16 a[204:205], v10 offset:49152
    v_mfma_f32_16x16x32_bf16 a[48:51], a[216:219], v[212:215], a[48:51]
    v_exp_f32 v144, v144
    v_mfma_f32_16x16x32_bf16 a[48:51], a[220:223], v[216:219], a[48:51]
    ds_read_b64_tr_b16 a[206:207], v10 offset:53248
    v_cvt_pk_bf16_f32 v199, v142, v143
    v_mfma_f32_16x16x32_bf16 a[52:55], a[220:223], v[224:227], a[52:55]
    v_exp_f32 v145, v145
    v_mfma_f32_16x16x32_bf16 a[52:55], a[216:219], v[220:223], a[52:55]
    ds_read_b128 a[172:175], v4 offset:24576
    v_mfma_f32_16x16x32_bf16 a[56:59], a[216:219], v[228:231], a[56:59]
    v_exp_f32 v146, v146
    v_mfma_f32_16x16x32_bf16 a[56:59], a[220:223], v[232:235], a[56:59]
    v_cvt_pk_bf16_f32 v206, v144, v145
    v_mfma_f32_16x16x32_bf16 a[60:63], a[220:223], v[240:243], a[60:63]
    v_exp_f32 v147, v147
    v_mfma_f32_16x16x32_bf16 a[60:63], a[216:219], v[236:239], a[60:63]
    buffer_load_dwordx4 v18, s[12:15], s29 offen offset:1024 lds
    v_smfmac_f32_16x16x64_bf16 a[228:231], v[244:247], v[220:227], v248
    s_waitcnt lgkmcnt(6)
    v_mfma_f32_16x16x32_bf16 v[140:143], a[144:147], v[68:71], v[108:111]
    v_exp_f32 v148, v148
    v_mfma_f32_16x16x32_bf16 v[140:143], a[148:151], v[72:75], v[140:143]
    ds_read_b64_tr_b16 a[208:209], v11 offset:24576
    v_cvt_pk_bf16_f32 v207, v146, v147
    v_mfma_f32_16x16x32_bf16 v[140:143], a[152:155], v[76:79], v[140:143]
    v_exp_f32 v149, v149
    v_mfma_f32_16x16x32_bf16 v[140:143], a[156:159], v[80:83], v[140:143]
    ds_read_b64_tr_b16 a[210:211], v11 offset:28672
    v_mfma_f32_16x16x32_bf16 v[144:147], a[156:159], v[96:99], v[112:115]
    v_exp_f32 v150, v150
    v_mfma_f32_16x16x32_bf16 v[144:147], a[152:155], v[92:95], v[144:147]
    ds_read_b128 a[176:179], v1 offset:28672
    v_cvt_pk_bf16_f32 v184, v148, v149
    v_mfma_f32_16x16x32_bf16 v[144:147], a[148:151], v[88:91], v[144:147]
    v_exp_f32 v151, v151
    v_mfma_f32_16x16x32_bf16 v[144:147], a[144:147], v[84:87], v[144:147]
    ds_read_b64_tr_b16 a[212:213], v11 offset:49152
    v_mfma_f32_16x16x32_bf16 a[64:67], a[192:195], v[212:215], a[64:67]
    v_exp_f32 v152, v152
    v_mfma_f32_16x16x32_bf16 a[64:67], a[196:199], v[216:219], a[64:67]
    ds_read_b64_tr_b16 a[214:215], v11 offset:53248
    v_cvt_pk_bf16_f32 v185, v150, v151
    v_mfma_f32_16x16x32_bf16 a[68:71], a[196:199], v[224:227], a[68:71]
    v_exp_f32 v153, v153
    v_mfma_f32_16x16x32_bf16 a[68:71], a[192:195], v[220:223], a[68:71]
    ds_read_b128 a[180:183], v2 offset:28672
    v_cvt_pk_bf16_f32 v192, v152, v153
    v_mfma_f32_16x16x32_bf16 a[72:75], a[192:195], v[228:231], a[72:75]
    v_exp_f32 v154, v154
    v_mfma_f32_16x16x32_bf16 a[72:75], a[196:199], v[232:235], a[72:75]
    buffer_load_dwordx4 v17, s[12:15], s29 offen offset:2048 lds
    v_mfma_f32_16x16x32_bf16 a[76:79], a[196:199], v[240:243], a[76:79]
    v_exp_f32 v155, v155
    v_mfma_f32_16x16x32_bf16 a[76:79], a[192:195], v[236:239], a[76:79]
    s_waitcnt lgkmcnt(6)
    v_mfma_f32_16x16x32_bf16 v[148:151], a[160:163], v[36:39], v[100:103]
    v_exp_f32 v156, v156
    v_mfma_f32_16x16x32_bf16 v[148:151], a[164:167], v[40:43], v[148:151]
    ds_read_b64_tr_b16 a[216:217], v12 offset:24576
    v_cvt_pk_bf16_f32 v193, v154, v155
    v_mfma_f32_16x16x32_bf16 v[148:151], a[168:171], v[44:47], v[148:151]
    v_exp_f32 v157, v157
    v_mfma_f32_16x16x32_bf16 v[148:151], a[172:175], v[48:51], v[148:151]
    ds_read_b64_tr_b16 a[218:219], v12 offset:28672
    v_mfma_f32_16x16x32_bf16 v[152:155], a[172:175], v[64:67], v[104:107]
    v_exp_f32 v158, v158
    v_mfma_f32_16x16x32_bf16 v[152:155], a[168:171], v[60:63], v[152:155]
    ds_read_b128 a[184:187], v3 offset:28672
    v_cvt_pk_bf16_f32 v200, v156, v157
    v_mfma_f32_16x16x32_bf16 v[152:155], a[164:167], v[56:59], v[152:155]
    v_exp_f32 v159, v159
    v_mfma_f32_16x16x32_bf16 v[152:155], a[160:163], v[52:55], v[152:155]
    ds_read_b64_tr_b16 a[220:221], v12 offset:49152
    v_mfma_f32_16x16x32_bf16 a[80:83], a[200:203], v[212:215], a[80:83]
    v_exp_f32 v160, v160
    v_mfma_f32_16x16x32_bf16 a[80:83], a[204:207], v[216:219], a[80:83]
    ds_read_b64_tr_b16 a[222:223], v12 offset:53248
    v_cvt_pk_bf16_f32 v201, v158, v159
    v_mfma_f32_16x16x32_bf16 a[84:87], a[204:207], v[224:227], a[84:87]
    v_exp_f32 v161, v161
    v_mfma_f32_16x16x32_bf16 a[84:87], a[200:203], v[220:223], a[84:87]
    ds_read_b128 a[188:191], v4 offset:28672
    v_mfma_f32_16x16x32_bf16 a[88:91], a[200:203], v[228:231], a[88:91]
    v_exp_f32 v162, v162
    v_mfma_f32_16x16x32_bf16 a[88:91], a[204:207], v[232:235], a[88:91]
    v_cvt_pk_bf16_f32 v208, v160, v161
    v_mfma_f32_16x16x32_bf16 a[92:95], a[204:207], v[240:243], a[92:95]
    v_exp_f32 v163, v163
    v_mfma_f32_16x16x32_bf16 a[92:95], a[200:203], v[236:239], a[92:95]
    buffer_load_dwordx4 v18, s[12:15], s29 offen offset:3072 lds
    v_smfmac_f32_16x16x64_bf16 a[232:235], v[244:247], v[228:235], v248
    s_waitcnt vmcnt(8) lgkmcnt(6)
    s_barrier
    s_add_u32 s29, s29, 16384
    v_mfma_f32_16x16x32_bf16 v[156:159], a[160:163], v[68:71], v[108:111]
    v_exp_f32 v164, v164
    v_mfma_f32_16x16x32_bf16 v[156:159], a[164:167], v[72:75], v[156:159]
    ds_read_b64_tr_b16 a[192:193], v5 offset:8192
    v_cvt_pk_bf16_f32 v209, v162, v163
    v_mfma_f32_16x16x32_bf16 v[156:159], a[168:171], v[76:79], v[156:159]
    v_exp_f32 v165, v165
    v_mfma_f32_16x16x32_bf16 v[156:159], a[172:175], v[80:83], v[156:159]
    ds_read_b64_tr_b16 a[194:195], v5 offset:12288
    v_mfma_f32_16x16x32_bf16 v[160:163], a[172:175], v[96:99], v[112:115]
    v_exp_f32 v166, v166
    v_mfma_f32_16x16x32_bf16 v[160:163], a[168:171], v[92:95], v[160:163]
    ds_read_b128 a[128:131], v1 offset:32768
    v_cvt_pk_bf16_f32 v186, v164, v165
    v_mfma_f32_16x16x32_bf16 v[160:163], a[164:167], v[88:91], v[160:163]
    v_exp_f32 v167, v167
    v_mfma_f32_16x16x32_bf16 v[160:163], a[160:163], v[84:87], v[160:163]
    ds_read_b64_tr_b16 a[196:197], v5 offset:32768
    v_mfma_f32_16x16x32_bf16 a[96:99], a[208:211], v[212:215], a[96:99]
    v_exp_f32 v168, v168
    v_mfma_f32_16x16x32_bf16 a[96:99], a[212:215], v[216:219], a[96:99]
    ds_read_b64_tr_b16 a[198:199], v5 offset:36864
    v_cvt_pk_bf16_f32 v187, v166, v167
    v_mfma_f32_16x16x32_bf16 a[100:103], a[212:215], v[224:227], a[100:103]
    v_exp_f32 v169, v169
    v_mfma_f32_16x16x32_bf16 a[100:103], a[208:211], v[220:223], a[100:103]
    ds_read_b128 a[132:135], v2 offset:32768
    v_cvt_pk_bf16_f32 v194, v168, v169
    v_mfma_f32_16x16x32_bf16 a[104:107], a[208:211], v[228:231], a[104:107]
    s_add_u32 m0, s34, 49152
    v_exp_f32 v170, v170
    v_mfma_f32_16x16x32_bf16 a[104:107], a[212:215], v[232:235], a[104:107]
    buffer_load_dwordx4 v13, s[8:11], s28 offen offset:0 lds
    v_mfma_f32_16x16x32_bf16 a[108:111], a[212:215], v[240:243], a[108:111]
    v_exp_f32 v171, v171
    v_mfma_f32_16x16x32_bf16 a[108:111], a[208:211], v[236:239], a[108:111]
    s_waitcnt lgkmcnt(6)
    v_mfma_f32_16x16x32_bf16 v[164:167], a[176:179], v[36:39], v[100:103]
    v_exp_f32 v172, v172
    v_mfma_f32_16x16x32_bf16 v[164:167], a[180:183], v[40:43], v[164:167]
    ds_read_b64_tr_b16 a[200:201], v6 offset:8192
    v_cvt_pk_bf16_f32 v195, v170, v171
    v_mfma_f32_16x16x32_bf16 v[164:167], a[184:187], v[44:47], v[164:167]
    v_exp_f32 v173, v173
    v_mfma_f32_16x16x32_bf16 v[164:167], a[188:191], v[48:51], v[164:167]
    ds_read_b64_tr_b16 a[202:203], v6 offset:12288
    v_mfma_f32_16x16x32_bf16 v[168:171], a[188:191], v[64:67], v[104:107]
    v_exp_f32 v174, v174
    v_mfma_f32_16x16x32_bf16 v[168:171], a[184:187], v[60:63], v[168:171]
    ds_read_b128 a[136:139], v3 offset:32768
    v_cvt_pk_bf16_f32 v202, v172, v173
    v_mfma_f32_16x16x32_bf16 v[168:171], a[180:183], v[56:59], v[168:171]
    v_exp_f32 v175, v175
    v_mfma_f32_16x16x32_bf16 v[168:171], a[176:179], v[52:55], v[168:171]
    ds_read_b64_tr_b16 a[204:205], v6 offset:32768
    v_mfma_f32_16x16x32_bf16 a[112:115], a[216:219], v[212:215], a[112:115]
    v_exp_f32 v176, v176
    v_mfma_f32_16x16x32_bf16 a[112:115], a[220:223], v[216:219], a[112:115]
    ds_read_b64_tr_b16 a[206:207], v6 offset:36864
    v_cvt_pk_bf16_f32 v203, v174, v175
    v_mfma_f32_16x16x32_bf16 a[116:119], a[220:223], v[224:227], a[116:119]
    v_exp_f32 v177, v177
    v_mfma_f32_16x16x32_bf16 a[116:119], a[216:219], v[220:223], a[116:119]
    ds_read_b128 a[140:143], v4 offset:32768
    v_mfma_f32_16x16x32_bf16 a[120:123], a[216:219], v[228:231], a[120:123]
    v_exp_f32 v178, v178
    v_mfma_f32_16x16x32_bf16 a[120:123], a[220:223], v[232:235], a[120:123]
    v_cvt_pk_bf16_f32 v210, v176, v177
    v_mfma_f32_16x16x32_bf16 a[124:127], a[220:223], v[240:243], a[124:127]
    v_exp_f32 v179, v179
    v_mfma_f32_16x16x32_bf16 a[124:127], a[216:219], v[236:239], a[124:127]
    buffer_load_dwordx4 v14, s[8:11], s28 offen offset:1024 lds
    v_smfmac_f32_16x16x64_bf16 a[236:239], v[244:247], v[236:243], v248
    s_waitcnt lgkmcnt(6)
    v_mfma_f32_16x16x32_bf16 v[172:175], a[176:179], v[68:71], v[108:111]
    v_exp_f32 v116, v116
    v_mfma_f32_16x16x32_bf16 v[172:175], a[180:183], v[72:75], v[172:175]
    ds_read_b64_tr_b16 a[208:209], v7 offset:8192
    v_cvt_pk_bf16_f32 v211, v178, v179
    v_mfma_f32_16x16x32_bf16 v[172:175], a[184:187], v[76:79], v[172:175]
    v_exp_f32 v117, v117
    v_mfma_f32_16x16x32_bf16 v[172:175], a[188:191], v[80:83], v[172:175]
    ds_read_b64_tr_b16 a[210:211], v7 offset:12288
    v_mfma_f32_16x16x32_bf16 v[176:179], a[188:191], v[96:99], v[112:115]
    v_exp_f32 v118, v118
    v_mfma_f32_16x16x32_bf16 v[176:179], a[184:187], v[92:95], v[176:179]
    ds_read_b128 a[144:147], v1 offset:36864
    v_cvt_pk_bf16_f32 v212, v116, v117
    v_mfma_f32_16x16x32_bf16 v[176:179], a[180:183], v[88:91], v[176:179]
    v_exp_f32 v119, v119
    v_mfma_f32_16x16x32_bf16 v[176:179], a[176:179], v[84:87], v[176:179]
    ds_read_b64_tr_b16 a[212:213], v7 offset:32768
    v_mfma_f32_16x16x32_bf16 a[0:3], a[192:195], v[180:183], a[0:3]
    v_exp_f32 v120, v120
    v_mfma_f32_16x16x32_bf16 a[0:3], a[196:199], v[184:187], a[0:3]
    ds_read_b64_tr_b16 a[214:215], v7 offset:36864
    v_cvt_pk_bf16_f32 v213, v118, v119
    v_mfma_f32_16x16x32_bf16 a[4:7], a[196:199], v[192:195], a[4:7]
    v_exp_f32 v121, v121
    v_mfma_f32_16x16x32_bf16 a[4:7], a[192:195], v[188:191], a[4:7]
    ds_read_b128 a[148:151], v2 offset:36864
    v_cvt_pk_bf16_f32 v220, v120, v121
    v_mfma_f32_16x16x32_bf16 a[8:11], a[192:195], v[196:199], a[8:11]
    v_exp_f32 v122, v122
    v_mfma_f32_16x16x32_bf16 a[8:11], a[196:199], v[200:203], a[8:11]
    buffer_load_dwordx4 v15, s[8:11], s28 offen offset:2048 lds
    v_mfma_f32_16x16x32_bf16 a[12:15], a[196:199], v[208:211], a[12:15]
    v_exp_f32 v123, v123
    v_mfma_f32_16x16x32_bf16 a[12:15], a[192:195], v[204:207], a[12:15]
    s_waitcnt lgkmcnt(6)
    v_mfma_f32_16x16x32_bf16 v[116:119], a[128:131], v[36:39], v[100:103]
    v_exp_f32 v124, v124
    v_mfma_f32_16x16x32_bf16 v[116:119], a[132:135], v[40:43], v[116:119]
    ds_read_b64_tr_b16 a[216:217], v8 offset:8192
    v_cvt_pk_bf16_f32 v221, v122, v123
    v_mfma_f32_16x16x32_bf16 v[116:119], a[136:139], v[44:47], v[116:119]
    v_exp_f32 v125, v125
    v_mfma_f32_16x16x32_bf16 v[116:119], a[140:143], v[48:51], v[116:119]
    ds_read_b64_tr_b16 a[218:219], v8 offset:12288
    v_mfma_f32_16x16x32_bf16 v[120:123], a[140:143], v[64:67], v[104:107]
    v_exp_f32 v126, v126
    v_mfma_f32_16x16x32_bf16 v[120:123], a[136:139], v[60:63], v[120:123]
    ds_read_b128 a[152:155], v3 offset:36864
    v_cvt_pk_bf16_f32 v228, v124, v125
    v_mfma_f32_16x16x32_bf16 v[120:123], a[132:135], v[56:59], v[120:123]
    v_exp_f32 v127, v127
    v_mfma_f32_16x16x32_bf16 v[120:123], a[128:131], v[52:55], v[120:123]
    ds_read_b64_tr_b16 a[220:221], v8 offset:32768
    v_mfma_f32_16x16x32_bf16 a[16:19], a[200:203], v[180:183], a[16:19]
    v_exp_f32 v128, v128
    v_mfma_f32_16x16x32_bf16 a[16:19], a[204:207], v[184:187], a[16:19]
    ds_read_b64_tr_b16 a[222:223], v8 offset:36864
    v_cvt_pk_bf16_f32 v229, v126, v127
    v_mfma_f32_16x16x32_bf16 a[20:23], a[204:207], v[192:195], a[20:23]
    v_exp_f32 v129, v129
    v_mfma_f32_16x16x32_bf16 a[20:23], a[200:203], v[188:191], a[20:23]
    ds_read_b128 a[156:159], v4 offset:36864
    v_mfma_f32_16x16x32_bf16 a[24:27], a[200:203], v[196:199], a[24:27]
    v_exp_f32 v130, v130
    v_mfma_f32_16x16x32_bf16 a[24:27], a[204:207], v[200:203], a[24:27]
    v_cvt_pk_bf16_f32 v236, v128, v129
    v_mfma_f32_16x16x32_bf16 a[28:31], a[204:207], v[208:211], a[28:31]
    v_exp_f32 v131, v131
    v_mfma_f32_16x16x32_bf16 a[28:31], a[200:203], v[204:207], a[28:31]
    buffer_load_dwordx4 v16, s[8:11], s28 offen offset:3072 lds
    v_smfmac_f32_16x16x64_bf16 a[224:227], v[244:247], v[180:187], v248
    s_waitcnt lgkmcnt(6)
    v_mfma_f32_16x16x32_bf16 v[124:127], a[128:131], v[68:71], v[108:111]
    s_cmp_eq_u32 s5, 3
    s_cbranch_scc1 L_site3
L_site_back3:
    v_exp_f32 v132, v132
    v_mfma_f32_16x16x32_bf16 v[124:127], a[132:135], v[72:75], v[124:127]
    ds_read_b64_tr_b16 a[192:193], v9 offset:8192
    v_cvt_pk_bf16_f32 v237, v130, v131
    v_mfma_f32_16x16x32_bf16 v[124:127], a[136:139], v[76:79], v[124:127]
    v_exp_f32 v133, v133
    v_mfma_f32_16x16x32_bf16 v[124:127], a[140:143], v[80:83], v[124:127]
    ds_read_b64_tr_b16 a[194:195], v9 offset:12288
    v_mfma_f32_16x16x32_bf16 v[128:131], a[140:143], v[96:99], v[112:115]
    v_exp_f32 v134, v134
    v_mfma_f32_16x16x32_bf16 v[128:131], a[136:139], v[92:95], v[128:131]
    ds_read_b128 a[160:163], v1 offset:40960
    v_cvt_pk_bf16_f32 v214, v132, v133
    v_mfma_f32_16x16x32_bf16 v[128:131], a[132:135], v[88:91], v[128:131]
    v_exp_f32 v135, v135
    v_mfma_f32_16x16x32_bf16 v[128:131], a[128:131], v[84:87], v[128:131]
    ds_read_b64_tr_b16 a[196:197], v9 offset:32768
    v_mfma_f32_16x16x32_bf16 a[32:35], a[208:211], v[180:183], a[32:35]
    v_exp_f32 v136, v136
    v_mfma_f32_16x16x32_bf16 a[32:35], a[212:215], v[184:187], a[32:35]
    ds_read_b64_tr_b16 a[198:199], v9 offset:36864
    v_cvt_pk_bf16_f32 v215, v134, v135
    v_mfma_f32_16x16x32_bf16 a[36:39], a[212:215], v[192:195], a[36:39]
    v_exp_f32 v137, v137
    v_mfma_f32_16x16x32_bf16 a[36:39], a[208:211], v[188:191], a[36:39]
    ds_read_b128 a[164:167], v2 offset:40960
    v_cvt_pk_bf16_f32 v222, v136, v137
    v_mfma_f32_16x16x32_bf16 a[40:43], a[208:211], v[196:199], a[40:43]
    s_add_u32 s28, s28, 16384
    s_mov_b32 m0, s32
    v_exp_f32 v138, v138
    v_mfma_f32_16x16x32_bf16 a[40:43], a[212:215], v[200:203], a[40:43]
    buffer_load_dwordx4 v17, s[12:15], s29 offen offset:0 lds
    v_mfma_f32_16x16x32_bf16 a[44:47], a[212:215], v[208:211], a[44:47]
    v_exp_f32 v139, v139
    v_mfma_f32_16x16x32_bf16 a[44:47], a[208:211], v[204:207], a[44:47]
    s_waitcnt lgkmcnt(6)
    v_mfma_f32_16x16x32_bf16 v[132:135], a[144:147], v[36:39], v[100:103]
    v_exp_f32 v140, v140
    v_mfma_f32_16x16x32_bf16 v[132:135], a[148:151], v[40:43], v[132:135]
    ds_read_b64_tr_b16 a[200:201], v10 offset:8192
    v_cvt_pk_bf16_f32 v223, v138, v139
    v_mfma_f32_16x16x32_bf16 v[132:135], a[152:155], v[44:47], v[132:135]
    v_exp_f32 v141, v141
    v_mfma_f32_16x16x32_bf16 v[132:135], a[156:159], v[48:51], v[132:135]
    ds_read_b64_tr_b16 a[202:203], v10 offset:12288
    v_mfma_f32_16x16x32_bf16 v[136:139], a[156:159], v[64:67], v[104:107]
    v_exp_f32 v142, v142
    v_mfma_f32_16x16x32_bf16 v[136:139], a[152:155], v[60:63], v[136:139]
    ds_read_b128 a[168:171], v3 offset:40960
    v_cvt_pk_bf16_f32 v230, v140, v141
    v_mfma_f32_16x16x32_bf16 v[136:139], a[148:151], v[56:59], v[136:139]
    v_exp_f32 v143, v143
    v_mfma_f32_16x16x32_bf16 v[136:139], a[144:147], v[52:55], v[136:139]
    ds_read_b64_tr_b16 a[204:205], v10 offset:32768
    v_mfma_f32_16x16x32_bf16 a[48:51], a[216:219], v[180:183], a[48:51]
    v_exp_f32 v144, v144
    v_mfma_f32_16x16x32_bf16 a[48:51], a[220:223], v[184:187], a[48:51]
    ds_read_b64_tr_b16 a[206:207], v10 offset:36864
    v_cvt_pk_bf16_f32 v231, v142, v143
    v_mfma_f32_16x16x32_bf16 a[52:55], a[220:223], v[192:195], a[52:55]
    v_exp_f32 v145, v145
    v_mfma_f32_16x16x32_bf16 a[52:55], a[216:219], v[188:191], a[52:55]
    ds_read_b128 a[172:175], v4 offset:40960
    v_mfma_f32_16x16x32_bf16 a[56:59], a[216:219], v[196:199], a[56:59]
    v_exp_f32 v146, v146
    v_mfma_f32_16x16x32_bf16 a[56:59], a[220:223], v[200:203], a[56:59]
    v_cvt_pk_bf16_f32 v238, v144, v145
    v_mfma_f32_16x16x32_bf16 a[60:63], a[220:223], v[208:211], a[60:63]
    v_exp_f32 v147, v147
    v_mfma_f32_16x16x32_bf16 a[60:63], a[216:219], v[204:207], a[60:63]
    buffer_load_dwordx4 v18, s[12:15], s29 offen offset:1024 lds
    v_smfmac_f32_16x16x64_bf16 a[228:231], v[244:247], v[188:195], v248
    s_waitcnt lgkmcnt(6)
    v_mfma_f32_16x16x32_bf16 v[140:143], a[144:147], v[68:71], v[108:111]
    v_exp_f32 v148, v148
    v_mfma_f32_16x16x32_bf16 v[140:143], a[148:151], v[72:75], v[140:143]
    ds_read_b64_tr_b16 a[208:209], v11 offset:8192
    v_cvt_pk_bf16_f32 v239, v146, v147
    v_mfma_f32_16x16x32_bf16 v[140:143], a[152:155], v[76:79], v[140:143]
    v_exp_f32 v149, v149
    v_mfma_f32_16x16x32_bf16 v[140:143], a[156:159], v[80:83], v[140:143]
    ds_read_b64_tr_b16 a[210:211], v11 offset:12288
    v_mfma_f32_16x16x32_bf16 v[144:147], a[156:159], v[96:99], v[112:115]
    v_exp_f32 v150, v150
    v_mfma_f32_16x16x32_bf16 v[144:147], a[152:155], v[92:95], v[144:147]
    ds_read_b128 a[176:179], v1 offset:45056
    v_cvt_pk_bf16_f32 v216, v148, v149
    v_mfma_f32_16x16x32_bf16 v[144:147], a[148:151], v[88:91], v[144:147]
    v_exp_f32 v151, v151
    v_mfma_f32_16x16x32_bf16 v[144:147], a[144:147], v[84:87], v[144:147]
    ds_read_b64_tr_b16 a[212:213], v11 offset:32768
    v_mfma_f32_16x16x32_bf16 a[64:67], a[192:195], v[180:183], a[64:67]
    v_exp_f32 v152, v152
    v_mfma_f32_16x16x32_bf16 a[64:67], a[196:199], v[184:187], a[64:67]
    ds_read_b64_tr_b16 a[214:215], v11 offset:36864
    v_cvt_pk_bf16_f32 v217, v150, v151
    v_mfma_f32_16x16x32_bf16 a[68:71], a[196:199], v[192:195], a[68:71]
    v_exp_f32 v153, v153
    v_mfma_f32_16x16x32_bf16 a[68:71], a[192:195], v[188:191], a[68:71]
    ds_read_b128 a[180:183], v2 offset:45056
    v_cvt_pk_bf16_f32 v224, v152, v153
    v_mfma_f32_16x16x32_bf16 a[72:75], a[192:195], v[196:199], a[72:75]
    v_exp_f32 v154, v154
    v_mfma_f32_16x16x32_bf16 a[72:75], a[196:199], v[200:203], a[72:75]
    buffer_load_dwordx4 v17, s[12:15], s29 offen offset:2048 lds
    v_mfma_f32_16x16x32_bf16 a[76:79], a[196:199], v[208:211], a[76:79]
    v_exp_f32 v155, v155
    v_mfma_f32_16x16x32_bf16 a[76:79], a[192:195], v[204:207], a[76:79]
    s_waitcnt lgkmcnt(6)
    v_mfma_f32_16x16x32_bf16 v[148:151], a[160:163], v[36:39], v[100:103]
    v_exp_f32 v156, v156
    v_mfma_f32_16x16x32_bf16 v[148:151], a[164:167], v[40:43], v[148:151]
    ds_read_b64_tr_b16 a[216:217], v12 offset:8192
    v_cvt_pk_bf16_f32 v225, v154, v155
    v_mfma_f32_16x16x32_bf16 v[148:151], a[168:171], v[44:47], v[148:151]
    v_exp_f32 v157, v157
    v_mfma_f32_16x16x32_bf16 v[148:151], a[172:175], v[48:51], v[148:151]
    ds_read_b64_tr_b16 a[218:219], v12 offset:12288
    v_mfma_f32_16x16x32_bf16 v[152:155], a[172:175], v[64:67], v[104:107]
    v_exp_f32 v158, v158
    v_mfma_f32_16x16x32_bf16 v[152:155], a[168:171], v[60:63], v[152:155]
    ds_read_b128 a[184:187], v3 offset:45056
    v_cvt_pk_bf16_f32 v232, v156, v157
    v_mfma_f32_16x16x32_bf16 v[152:155], a[164:167], v[56:59], v[152:155]
    v_exp_f32 v159, v159
    v_mfma_f32_16x16x32_bf16 v[152:155], a[160:163], v[52:55], v[152:155]
    ds_read_b64_tr_b16 a[220:221], v12 offset:32768
    v_mfma_f32_16x16x32_bf16 a[80:83], a[200:203], v[180:183], a[80:83]
    v_exp_f32 v160, v160
    v_mfma_f32_16x16x32_bf16 a[80:83], a[204:207], v[184:187], a[80:83]
    ds_read_b64_tr_b16 a[222:223], v12 offset:36864
    v_cvt_pk_bf16_f32 v233, v158, v159
    v_mfma_f32_16x16x32_bf16 a[84:87], a[204:207], v[192:195], a[84:87]
    v_exp_f32 v161, v161
    v_mfma_f32_16x16x32_bf16 a[84:87], a[200:203], v[188:191], a[84:87]
    ds_read_b128 a[188:191], v4 offset:45056
    v_mfma_f32_16x16x32_bf16 a[88:91], a[200:203], v[196:199], a[88:91]
    v_exp_f32 v162, v162
    v_mfma_f32_16x16x32_bf16 a[88:91], a[204:207], v[200:203], a[88:91]
    v_cvt_pk_bf16_f32 v240, v160, v161
    v_mfma_f32_16x16x32_bf16 a[92:95], a[204:207], v[208:211], a[92:95]
    v_exp_f32 v163, v163
    v_mfma_f32_16x16x32_bf16 a[92:95], a[200:203], v[204:207], a[92:95]
    buffer_load_dwordx4 v18, s[12:15], s29 offen offset:3072 lds
    v_smfmac_f32_16x16x64_bf16 a[232:235], v[244:247], v[196:203], v248
    s_waitcnt vmcnt(8) lgkmcnt(6)
    s_barrier
    s_add_u32 s29, s29, 16384
    v_mfma_f32_16x16x32_bf16 v[156:159], a[160:163], v[68:71], v[108:111]
    v_exp_f32 v164, v164
    v_mfma_f32_16x16x32_bf16 v[156:159], a[164:167], v[72:75], v[156:159]
    ds_read_b64_tr_b16 a[192:193], v5 offset:16384
    v_cvt_pk_bf16_f32 v241, v162, v163
    v_mfma_f32_16x16x32_bf16 v[156:159], a[168:171], v[76:79], v[156:159]
    v_exp_f32 v165, v165
    v_mfma_f32_16x16x32_bf16 v[156:159], a[172:175], v[80:83], v[156:159]
    ds_read_b64_tr_b16 a[194:195], v5 offset:20480
    v_mfma_f32_16x16x32_bf16 v[160:163], a[172:175], v[96:99], v[112:115]
    v_exp_f32 v166, v166
    v_mfma_f32_16x16x32_bf16 v[160:163], a[168:171], v[92:95], v[160:163]
    ds_read_b128 a[128:131], v1 offset:0
    v_cvt_pk_bf16_f32 v218, v164, v165
    v_mfma_f32_16x16x32_bf16 v[160:163], a[164:167], v[88:91], v[160:163]
    v_exp_f32 v167, v167
    v_mfma_f32_16x16x32_bf16 v[160:163], a[160:163], v[84:87], v[160:163]
    ds_read_b64_tr_b16 a[196:197], v5 offset:40960
    v_mfma_f32_16x16x32_bf16 a[96:99], a[208:211], v[180:183], a[96:99]
    v_exp_f32 v168, v168
    v_mfma_f32_16x16x32_bf16 a[96:99], a[212:215], v[184:187], a[96:99]
    ds_read_b64_tr_b16 a[198:199], v5 offset:45056
    v_cvt_pk_bf16_f32 v219, v166, v167
    v_mfma_f32_16x16x32_bf16 a[100:103], a[212:215], v[192:195], a[100:103]
    v_exp_f32 v169, v169
    v_mfma_f32_16x16x32_bf16 a[100:103], a[208:211], v[188:191], a[100:103]
    ds_read_b128 a[132:135], v2 offset:0
    v_cvt_pk_bf16_f32 v226, v168, v169
    v_mfma_f32_16x16x32_bf16 a[104:107], a[208:211], v[196:199], a[104:107]
    s_add_u32 m0, s34, 16384
    v_exp_f32 v170, v170
    v_mfma_f32_16x16x32_bf16 a[104:107], a[212:215], v[200:203], a[104:107]
    buffer_load_dwordx4 v13, s[8:11], s28 offen offset:0 lds
    v_mfma_f32_16x16x32_bf16 a[108:111], a[212:215], v[208:211], a[108:111]
    v_exp_f32 v171, v171
    v_mfma_f32_16x16x32_bf16 a[108:111], a[208:211], v[204:207], a[108:111]
    s_waitcnt lgkmcnt(6)
    v_mfma_f32_16x16x32_bf16 v[164:167], a[176:179], v[36:39], v[100:103]
    v_exp_f32 v172, v172
    v_mfma_f32_16x16x32_bf16 v[164:167], a[180:183], v[40:43], v[164:167]
    ds_read_b64_tr_b16 a[200:201], v6 offset:16384
    v_cvt_pk_bf16_f32 v227, v170, v171
    v_mfma_f32_16x16x32_bf16 v[164:167], a[184:187], v[44:47], v[164:167]
    v_exp_f32 v173, v173
    v_mfma_f32_16x16x32_bf16 v[164:167], a[188:191], v[48:51], v[164:167]
    ds_read_b64_tr_b16 a[202:203], v6 offset:20480
    v_mfma_f32_16x16x32_bf16 v[168:171], a[188:191], v[64:67], v[104:107]
    v_exp_f32 v174, v174
    v_mfma_f32_16x16x32_bf16 v[168:171], a[184:187], v[60:63], v[168:171]
    ds_read_b128 a[136:139], v3 offset:0
    v_cvt_pk_bf16_f32 v234, v172, v173
    v_mfma_f32_16x16x32_bf16 v[168:171], a[180:183], v[56:59], v[168:171]
    v_exp_f32 v175, v175
    v_mfma_f32_16x16x32_bf16 v[168:171], a[176:179], v[52:55], v[168:171]
    ds_read_b64_tr_b16 a[204:205], v6 offset:40960
    v_mfma_f32_16x16x32_bf16 a[112:115], a[216:219], v[180:183], a[112:115]
    v_exp_f32 v176, v176
    v_mfma_f32_16x16x32_bf16 a[112:115], a[220:223], v[184:187], a[112:115]
    ds_read_b64_tr_b16 a[206:207], v6 offset:45056
    v_cvt_pk_bf16_f32 v235, v174, v175
    v_mfma_f32_16x16x32_bf16 a[116:119], a[220:223], v[192:195], a[116:119]
    v_exp_f32 v177, v177
    v_mfma_f32_16x16x32_bf16 a[116:119], a[216:219], v[188:191], a[116:119]
    ds_read_b128 a[140:143], v4 offset:0
    v_mfma_f32_16x16x32_bf16 a[120:123], a[216:219], v[196:199], a[120:123]
    v_exp_f32 v178, v178
    v_mfma_f32_16x16x32_bf16 a[120:123], a[220:223], v[200:203], a[120:123]
    v_cvt_pk_bf16_f32 v242, v176, v177
    v_mfma_f32_16x16x32_bf16 a[124:127], a[220:223], v[208:211], a[124:127]
    v_exp_f32 v179, v179
    v_mfma_f32_16x16x32_bf16 a[124:127], a[216:219], v[204:207], a[124:127]
    buffer_load_dwordx4 v14, s[8:11], s28 offen offset:1024 lds
    v_smfmac_f32_16x16x64_bf16 a[236:239], v[244:247], v[204:211], v248
    s_waitcnt lgkmcnt(6)
    s_sub_u32 s35, s35, 1
    s_cbranch_scc0 L_attn_loop
    v_mfma_f32_16x16x32_bf16 v[172:175], a[176:179], v[68:71], v[108:111]
    s_bfe_u32 s47, s2, 0x10003
    v_exp_f32 v116, v116
    v_mfma_f32_16x16x32_bf16 v[172:175], a[180:183], v[72:75], v[172:175]
    s_bfe_u32 s40, s2, 0x20001
    ds_read_b64_tr_b16 a[208:209], v7 offset:16384
    v_cvt_pk_bf16_f32 v243, v178, v179
    v_mfma_f32_16x16x32_bf16 v[172:175], a[184:187], v[76:79], v[172:175]
    s_lshl_b32 s40, s40, 3
    v_exp_f32 v117, v117
    v_mfma_f32_16x16x32_bf16 v[172:175], a[188:191], v[80:83], v[172:175]
    s_bfe_u32 s41, s2, 0x30003
    ds_read_b64_tr_b16 a[210:211], v7 offset:20480
    v_and_b32 v21, 7, v19
    v_mfma_f32_16x16x32_bf16 v[176:179], a[188:191], v[96:99], v[112:115]
    s_add_u32 s87, s40, s41
    v_exp_f32 v118, v118
    v_mfma_f32_16x16x32_bf16 v[176:179], a[184:187], v[92:95], v[176:179]
    s_and_b32 s40, s2, 1
    ds_read_b128 a[144:147], v1 offset:4096
    v_cvt_pk_bf16_f32 v180, v116, v117
    v_mfma_f32_16x16x32_bf16 v[176:179], a[180:183], v[88:91], v[176:179]
    s_lshl_b32 s40, s40, 2
    v_exp_f32 v119, v119
    v_mfma_f32_16x16x32_bf16 v[176:179], a[176:179], v[84:87], v[176:179]
    s_lshr_b32 s41, s2, 6
    ds_read_b64_tr_b16 a[212:213], v7 offset:40960
    v_lshlrev_b32 v21, 2, v21
    v_mfma_f32_16x16x32_bf16 a[0:3], a[192:195], v[212:215], a[0:3]
    s_add_u32 s100, s40, s41
    v_exp_f32 v120, v120
    v_mfma_f32_16x16x32_bf16 a[0:3], a[196:199], v[216:219], a[0:3]
    s_add_u32 s16, s72, 0x1a00000
    s_addc_u32 s17, s73, 0
    ds_read_b64_tr_b16 a[214:215], v7 offset:45056
    v_cvt_pk_bf16_f32 v181, v118, v119
    v_mfma_f32_16x16x32_bf16 a[4:7], a[196:199], v[224:227], a[4:7]
    s_mov_b32 s18, 0x438000
    v_exp_f32 v121, v121
    v_mfma_f32_16x16x32_bf16 a[4:7], a[192:195], v[220:223], a[4:7]
    s_mov_b32 s19, 0x20000
    ds_read_b128 a[148:151], v2 offset:4096
    v_cvt_pk_bf16_f32 v188, v120, v121
    v_mfma_f32_16x16x32_bf16 a[8:11], a[192:195], v[228:231], a[8:11]
    v_exp_f32 v122, v122
    v_mfma_f32_16x16x32_bf16 a[8:11], a[196:199], v[232:235], a[8:11]
    buffer_load_dwordx4 v15, s[8:11], s28 offen offset:2048 lds
    v_mfma_f32_16x16x32_bf16 a[12:15], a[196:199], v[240:243], a[12:15]
    v_exp_f32 v123, v123
    v_mfma_f32_16x16x32_bf16 a[12:15], a[192:195], v[236:239], a[12:15]
    s_waitcnt lgkmcnt(6)
    v_add_u32 v21, 0x29b000, v21
    v_mfma_f32_16x16x32_bf16 v[116:119], a[128:131], v[36:39], v[100:103]
    v_exp_f32 v124, v124
    v_mfma_f32_16x16x32_bf16 v[116:119], a[132:135], v[40:43], v[116:119]
    ds_read_b64_tr_b16 a[216:217], v8 offset:16384
    v_cvt_pk_bf16_f32 v189, v122, v123
    v_mfma_f32_16x16x32_bf16 v[116:119], a[136:139], v[44:47], v[116:119]
    v_exp_f32 v125, v125
    v_mfma_f32_16x16x32_bf16 v[116:119], a[140:143], v[48:51], v[116:119]
    ds_read_b64_tr_b16 a[218:219], v8 offset:20480
    v_mfma_f32_16x16x32_bf16 v[120:123], a[140:143], v[64:67], v[104:107]
    v_exp_f32 v126, v126
    v_mfma_f32_16x16x32_bf16 v[120:123], a[136:139], v[60:63], v[120:123]
    ds_read_b128 a[152:155], v3 offset:4096
    v_cvt_pk_bf16_f32 v196, v124, v125
    v_mfma_f32_16x16x32_bf16 v[120:123], a[132:135], v[56:59], v[120:123]
    v_exp_f32 v127, v127
    v_mfma_f32_16x16x32_bf16 v[120:123], a[128:131], v[52:55], v[120:123]
    ds_read_b64_tr_b16 a[220:221], v8 offset:40960
    v_mfma_f32_16x16x32_bf16 a[16:19], a[200:203], v[212:215], a[16:19]
    v_exp_f32 v128, v128
    v_mfma_f32_16x16x32_bf16 a[16:19], a[204:207], v[216:219], a[16:19]
    ds_read_b64_tr_b16 a[222:223], v8 offset:45056
    v_cvt_pk_bf16_f32 v197, v126, v127
    v_mfma_f32_16x16x32_bf16 a[20:23], a[204:207], v[224:227], a[20:23]
    v_exp_f32 v129, v129
    v_mfma_f32_16x16x32_bf16 a[20:23], a[200:203], v[220:223], a[20:23]
    ds_read_b128 a[156:159], v4 offset:4096
    v_mfma_f32_16x16x32_bf16 a[24:27], a[200:203], v[228:231], a[24:27]
    v_exp_f32 v130, v130
    v_mfma_f32_16x16x32_bf16 a[24:27], a[204:207], v[232:235], a[24:27]
    v_cvt_pk_bf16_f32 v204, v128, v129
    v_mfma_f32_16x16x32_bf16 a[28:31], a[204:207], v[240:243], a[28:31]
    v_exp_f32 v131, v131
    v_mfma_f32_16x16x32_bf16 a[28:31], a[200:203], v[236:239], a[28:31]
    buffer_load_dwordx4 v16, s[8:11], s28 offen offset:3072 lds
    v_smfmac_f32_16x16x64_bf16 a[224:227], v[244:247], v[212:219], v248
    s_waitcnt lgkmcnt(6)
    buffer_load_dword v249, v21, s[76:79], 0 offen sc1
    v_mfma_f32_16x16x32_bf16 v[124:127], a[128:131], v[68:71], v[108:111]
    v_exp_f32 v132, v132
    v_mfma_f32_16x16x32_bf16 v[124:127], a[132:135], v[72:75], v[124:127]
    ds_read_b64_tr_b16 a[192:193], v9 offset:16384
    v_cvt_pk_bf16_f32 v205, v130, v131
    v_mfma_f32_16x16x32_bf16 v[124:127], a[136:139], v[76:79], v[124:127]
    v_exp_f32 v133, v133
    v_mfma_f32_16x16x32_bf16 v[124:127], a[140:143], v[80:83], v[124:127]
    ds_read_b64_tr_b16 a[194:195], v9 offset:20480
    v_mov_b32 v24, 0x3f803f80
    v_mfma_f32_16x16x32_bf16 v[128:131], a[140:143], v[96:99], v[112:115]
    v_exp_f32 v134, v134
    v_mfma_f32_16x16x32_bf16 v[128:131], a[136:139], v[92:95], v[128:131]
    ds_read_b128 a[160:163], v1 offset:8192
    v_cvt_pk_bf16_f32 v182, v132, v133
    v_mfma_f32_16x16x32_bf16 v[128:131], a[132:135], v[88:91], v[128:131]
    v_exp_f32 v135, v135
    v_accvgpr_write_b32 a240, v24
    v_mfma_f32_16x16x32_bf16 v[128:131], a[128:131], v[84:87], v[128:131]
    ds_read_b64_tr_b16 a[196:197], v9 offset:40960
    v_accvgpr_write_b32 a241, v24
    v_mfma_f32_16x16x32_bf16 a[32:35], a[208:211], v[212:215], a[32:35]
    v_exp_f32 v136, v136
    v_mfma_f32_16x16x32_bf16 a[32:35], a[212:215], v[216:219], a[32:35]
    ds_read_b64_tr_b16 a[198:199], v9 offset:45056
    v_cvt_pk_bf16_f32 v183, v134, v135
    v_lshlrev_b32 v25, 4, v19
    v_mfma_f32_16x16x32_bf16 a[36:39], a[212:215], v[224:227], a[36:39]
    s_mul_i32 s40, s5, 3072
    v_exp_f32 v137, v137
    v_mfma_f32_16x16x32_bf16 a[36:39], a[208:211], v[220:223], a[36:39]
    s_mul_i32 s41, s6, 10240
    ds_read_b128 a[164:167], v2 offset:8192
    v_cvt_pk_bf16_f32 v190, v136, v137
    v_mfma_f32_16x16x32_bf16 a[40:43], a[208:211], v[228:231], a[40:43]
    s_add_u32 s28, s28, 16384
    s_mov_b32 m0, s33
    v_exp_f32 v138, v138
    v_accvgpr_write_b32 a242, v24
    v_mfma_f32_16x16x32_bf16 a[40:43], a[212:215], v[232:235], a[40:43]
    s_add_u32 s41, s41, s40
    buffer_load_dwordx4 v17, s[12:15], s29 offen offset:0 lds
    v_mfma_f32_16x16x32_bf16 a[44:47], a[212:215], v[240:243], a[44:47]
    v_exp_f32 v139, v139
    v_mfma_f32_16x16x32_bf16 a[44:47], a[208:211], v[236:239], a[44:47]
    s_waitcnt lgkmcnt(6)
    v_accvgpr_write_b32 a243, v24
    v_accvgpr_write_b32 a244, v24
    v_mfma_f32_16x16x32_bf16 v[132:135], a[144:147], v[36:39], v[100:103]
    v_exp_f32 v140, v140
    v_mfma_f32_16x16x32_bf16 v[132:135], a[148:151], v[40:43], v[132:135]
    ds_read_b64_tr_b16 a[200:201], v10 offset:16384
    v_cvt_pk_bf16_f32 v191, v138, v139
    v_mfma_f32_16x16x32_bf16 v[132:135], a[152:155], v[44:47], v[132:135]
    v_exp_f32 v141, v141
    v_mfma_f32_16x16x32_bf16 v[132:135], a[156:159], v[48:51], v[132:135]
    ds_read_b64_tr_b16 a[202:203], v10 offset:20480
    v_accvgpr_write_b32 a245, v24
    v_mfma_f32_16x16x32_bf16 v[136:139], a[156:159], v[64:67], v[104:107]
    v_exp_f32 v142, v142
    v_mfma_f32_16x16x32_bf16 v[136:139], a[152:155], v[60:63], v[136:139]
    ds_read_b128 a[168:171], v3 offset:8192
    v_cvt_pk_bf16_f32 v198, v140, v141
    v_mfma_f32_16x16x32_bf16 v[136:139], a[148:151], v[56:59], v[136:139]
    v_exp_f32 v143, v143
    v_mfma_f32_16x16x32_bf16 v[136:139], a[144:147], v[52:55], v[136:139]
    ds_read_b64_tr_b16 a[204:205], v10 offset:40960
    v_accvgpr_write_b32 a246, v24
    v_mfma_f32_16x16x32_bf16 a[48:51], a[216:219], v[212:215], a[48:51]
    v_exp_f32 v144, v144
    v_mfma_f32_16x16x32_bf16 a[48:51], a[220:223], v[216:219], a[48:51]
    ds_read_b64_tr_b16 a[206:207], v10 offset:45056
    v_cvt_pk_bf16_f32 v199, v142, v143
    v_mfma_f32_16x16x32_bf16 a[52:55], a[220:223], v[224:227], a[52:55]
    v_exp_f32 v145, v145
    v_mfma_f32_16x16x32_bf16 a[52:55], a[216:219], v[220:223], a[52:55]
    ds_read_b128 a[172:175], v4 offset:8192
    v_accvgpr_write_b32 a247, v24
    v_mfma_f32_16x16x32_bf16 a[56:59], a[216:219], v[228:231], a[56:59]
    v_exp_f32 v146, v146
    v_mfma_f32_16x16x32_bf16 a[56:59], a[220:223], v[232:235], a[56:59]
    v_cvt_pk_bf16_f32 v206, v144, v145
    v_accvgpr_write_b32 a248, v24
    v_mfma_f32_16x16x32_bf16 a[60:63], a[220:223], v[240:243], a[60:63]
    v_exp_f32 v147, v147
    v_mfma_f32_16x16x32_bf16 a[60:63], a[216:219], v[236:239], a[60:63]
    buffer_load_dwordx4 v18, s[12:15], s29 offen offset:1024 lds
    v_smfmac_f32_16x16x64_bf16 a[228:231], v[244:247], v[220:227], v248
    s_waitcnt lgkmcnt(6)
    v_accvgpr_write_b32 a249, v24
    v_accvgpr_write_b32 a250, v24
    v_mfma_f32_16x16x32_bf16 v[140:143], a[144:147], v[68:71], v[108:111]
    v_exp_f32 v148, v148
    v_mfma_f32_16x16x32_bf16 v[140:143], a[148:151], v[72:75], v[140:143]
    ds_read_b64_tr_b16 a[208:209], v11 offset:16384
    v_cvt_pk_bf16_f32 v207, v146, v147
    v_mfma_f32_16x16x32_bf16 v[140:143], a[152:155], v[76:79], v[140:143]
    v_exp_f32 v149, v149
    v_mfma_f32_16x16x32_bf16 v[140:143], a[156:159], v[80:83], v[140:143]
    ds_read_b64_tr_b16 a[210:211], v11 offset:20480
    v_accvgpr_write_b32 a251, v24
    v_mfma_f32_16x16x32_bf16 v[144:147], a[156:159], v[96:99], v[112:115]
    v_exp_f32 v150, v150
    v_mfma_f32_16x16x32_bf16 v[144:147], a[152:155], v[92:95], v[144:147]
    ds_read_b128 a[176:179], v1 offset:12288
    v_cvt_pk_bf16_f32 v184, v148, v149
    v_mfma_f32_16x16x32_bf16 v[144:147], a[148:151], v[88:91], v[144:147]
    v_exp_f32 v151, v151
    v_mfma_f32_16x16x32_bf16 v[144:147], a[144:147], v[84:87], v[144:147]
    ds_read_b64_tr_b16 a[212:213], v11 offset:40960
    v_accvgpr_write_b32 a252, v24
    v_mfma_f32_16x16x32_bf16 a[64:67], a[192:195], v[212:215], a[64:67]
    v_exp_f32 v152, v152
    v_mfma_f32_16x16x32_bf16 a[64:67], a[196:199], v[216:219], a[64:67]
    ds_read_b64_tr_b16 a[214:215], v11 offset:45056
    v_cvt_pk_bf16_f32 v185, v150, v151
    v_mfma_f32_16x16x32_bf16 a[68:71], a[196:199], v[224:227], a[68:71]
    v_exp_f32 v153, v153
    v_mfma_f32_16x16x32_bf16 a[68:71], a[192:195], v[220:223], a[68:71]
    ds_read_b128 a[180:183], v2 offset:12288
    v_cvt_pk_bf16_f32 v192, v152, v153
    v_mfma_f32_16x16x32_bf16 a[72:75], a[192:195], v[228:231], a[72:75]
    v_exp_f32 v154, v154
    v_mfma_f32_16x16x32_bf16 a[72:75], a[196:199], v[232:235], a[72:75]
    buffer_load_dwordx4 v17, s[12:15], s29 offen offset:2048 lds
    s_mov_b32 s43, m0
    s_add_u32 m0, s40, 86016
    s_nop 0
    buffer_load_dwordx4 v25, s[96:99], s41 offen offset:0 lds
    s_mov_b32 m0, s43
    v_accvgpr_write_b32 a253, v24
    v_mfma_f32_16x16x32_bf16 a[76:79], a[196:199], v[240:243], a[76:79]
    v_exp_f32 v155, v155
    v_mfma_f32_16x16x32_bf16 a[76:79], a[192:195], v[236:239], a[76:79]
    s_waitcnt lgkmcnt(6)
    v_accvgpr_write_b32 a254, v24
    v_accvgpr_write_b32 a255, v24
    v_mfma_f32_16x16x32_bf16 v[148:151], a[160:163], v[36:39], v[100:103]
    v_exp_f32 v156, v156
    v_mfma_f32_16x16x32_bf16 v[148:151], a[164:167], v[40:43], v[148:151]
    ds_read_b64_tr_b16 a[216:217], v12 offset:16384
    v_cvt_pk_bf16_f32 v193, v154, v155
    v_mfma_f32_16x16x32_bf16 v[148:151], a[168:171], v[44:47], v[148:151]
    v_exp_f32 v157, v157
    v_mfma_f32_16x16x32_bf16 v[148:151], a[172:175], v[48:51], v[148:151]
    ds_read_b64_tr_b16 a[218:219], v12 offset:20480
    v_mov_b32 v252, v24
    v_mfma_f32_16x16x32_bf16 v[152:155], a[172:175], v[64:67], v[104:107]
    v_exp_f32 v158, v158
    v_mfma_f32_16x16x32_bf16 v[152:155], a[168:171], v[60:63], v[152:155]
    ds_read_b128 a[184:187], v3 offset:12288
    v_cvt_pk_bf16_f32 v200, v156, v157
    v_mfma_f32_16x16x32_bf16 v[152:155], a[164:167], v[56:59], v[152:155]
    v_exp_f32 v159, v159
    v_mfma_f32_16x16x32_bf16 v[152:155], a[160:163], v[52:55], v[152:155]
    ds_read_b64_tr_b16 a[220:221], v12 offset:40960
    s_mov_b32 s43, m0
    s_add_u32 m0, s40, 86016
    s_nop 0
    buffer_load_dwordx4 v25, s[96:99], s41 offen offset:1024 lds
    s_mov_b32 m0, s43
    v_mov_b32 v253, v24
    v_mfma_f32_16x16x32_bf16 a[80:83], a[200:203], v[212:215], a[80:83]
    v_exp_f32 v160, v160
    v_mfma_f32_16x16x32_bf16 a[80:83], a[204:207], v[216:219], a[80:83]
    ds_read_b64_tr_b16 a[222:223], v12 offset:45056
    v_cvt_pk_bf16_f32 v201, v158, v159
    v_mfma_f32_16x16x32_bf16 a[84:87], a[204:207], v[224:227], a[84:87]
    v_exp_f32 v161, v161
    v_mfma_f32_16x16x32_bf16 a[84:87], a[200:203], v[220:223], a[84:87]
    ds_read_b128 a[188:191], v4 offset:12288
    v_mov_b32 v254, v24
    v_mfma_f32_16x16x32_bf16 a[88:91], a[200:203], v[228:231], a[88:91]
    v_exp_f32 v162, v162
    v_mfma_f32_16x16x32_bf16 a[88:91], a[204:207], v[232:235], a[88:91]
    v_cvt_pk_bf16_f32 v208, v160, v161
    v_mov_b32 v255, v24
    v_mfma_f32_16x16x32_bf16 a[92:95], a[204:207], v[240:243], a[92:95]
    v_exp_f32 v163, v163
    v_mfma_f32_16x16x32_bf16 a[92:95], a[200:203], v[236:239], a[92:95]
    buffer_load_dwordx4 v18, s[12:15], s29 offen offset:3072 lds
    v_smfmac_f32_16x16x64_bf16 a[232:235], v[244:247], v[228:235], v248
    s_waitcnt vmcnt(11) lgkmcnt(6)
    s_barrier
    s_add_u32 s29, s29, 16384
    s_mov_b32 s43, m0
    s_add_u32 m0, s40, 86016
    s_nop 0
    buffer_load_dwordx4 v25, s[96:99], s41 offen offset:2048 lds
    s_mov_b32 m0, s43
    v_mfma_f32_16x16x32_bf16 v[156:159], a[160:163], v[68:71], v[108:111]
    v_exp_f32 v164, v164
    v_mfma_f32_16x16x32_bf16 v[156:159], a[164:167], v[72:75], v[156:159]
    ds_read_b64_tr_b16 a[192:193], v5 offset:57344
    v_cvt_pk_bf16_f32 v209, v162, v163
    v_mfma_f32_16x16x32_bf16 v[156:159], a[168:171], v[76:79], v[156:159]
    v_exp_f32 v165, v165
    v_mfma_f32_16x16x32_bf16 v[156:159], a[172:175], v[80:83], v[156:159]
    ds_read_b64_tr_b16 a[194:195], v5 offset:61440
    v_mfma_f32_16x16x32_bf16 v[160:163], a[172:175], v[96:99], v[112:115]
    v_exp_f32 v166, v166
    v_mfma_f32_16x16x32_bf16 v[160:163], a[168:171], v[92:95], v[160:163]
    ds_read_b128 a[128:131], v1 offset:49152
    v_cvt_pk_bf16_f32 v186, v164, v165
    v_mfma_f32_16x16x32_bf16 v[160:163], a[164:167], v[88:91], v[160:163]
    v_exp_f32 v167, v167
    v_mfma_f32_16x16x32_bf16 v[160:163], a[160:163], v[84:87], v[160:163]
    ds_read_b64_tr_b16 a[196:197], v5 offset:0
    v_mfma_f32_16x16x32_bf16 a[96:99], a[208:211], v[212:215], a[96:99]
    v_exp_f32 v168, v168
    v_mfma_f32_16x16x32_bf16 a[96:99], a[212:215], v[216:219], a[96:99]
    ds_read_b64_tr_b16 a[198:199], v5 offset:4096
    v_cvt_pk_bf16_f32 v187, v166, v167
    v_mfma_f32_16x16x32_bf16 a[100:103], a[212:215], v[224:227], a[100:103]
    v_exp_f32 v169, v169
    v_mfma_f32_16x16x32_bf16 a[100:103], a[208:211], v[220:223], a[100:103]
    ds_read_b128 a[132:135], v2 offset:49152
    v_cvt_pk_bf16_f32 v194, v168, v169
    v_mfma_f32_16x16x32_bf16 a[104:107], a[208:211], v[228:231], a[104:107]
    s_add_u32 m0, s34, 32768
    v_exp_f32 v170, v170
    v_mfma_f32_16x16x32_bf16 a[104:107], a[212:215], v[232:235], a[104:107]
    buffer_load_dwordx4 v13, s[8:11], s28 offen offset:0 lds
    v_mfma_f32_16x16x32_bf16 a[108:111], a[212:215], v[240:243], a[108:111]
    v_exp_f32 v171, v171
    v_mfma_f32_16x16x32_bf16 a[108:111], a[208:211], v[236:239], a[108:111]
    s_waitcnt lgkmcnt(6)
    v_mfma_f32_16x16x32_bf16 v[164:167], a[176:179], v[36:39], v[100:103]
    s_waitcnt vmcnt(8)
    v_exp_f32 v172, v172
    v_mfma_f32_16x16x32_bf16 v[164:167], a[180:183], v[40:43], v[164:167]
    ds_read_b64_tr_b16 a[200:201], v6 offset:57344
    v_cvt_pk_bf16_f32 v195, v170, v171
    v_mfma_f32_16x16x32_bf16 v[164:167], a[184:187], v[44:47], v[164:167]
    v_exp_f32 v173, v173
    v_mfma_f32_16x16x32_bf16 v[164:167], a[188:191], v[48:51], v[164:167]
    ds_read_b64_tr_b16 a[202:203], v6 offset:61440
    v_cmp_eq_u32 vcc, 0, v249
    s_and_b64 vcc, vcc, exec
    s_cbranch_scc1 L_spin_sel
L_back_sel:
    v_mfma_f32_16x16x32_bf16 v[168:171], a[188:191], v[64:67], v[104:107]
    v_exp_f32 v174, v174
    v_mfma_f32_16x16x32_bf16 v[168:171], a[184:187], v[60:63], v[168:171]
    ds_read_b128 a[136:139], v3 offset:49152
    v_cvt_pk_bf16_f32 v202, v172, v173
    v_mfma_f32_16x16x32_bf16 v[168:171], a[180:183], v[56:59], v[168:171]
    v_exp_f32 v175, v175
    v_mfma_f32_16x16x32_bf16 v[168:171], a[176:179], v[52:55], v[168:171]
    ds_read_b64_tr_b16 a[204:205], v6 offset:0
    v_mfma_f32_16x16x32_bf16 a[112:115], a[216:219], v[212:215], a[112:115]
    v_exp_f32 v176, v176
    v_mfma_f32_16x16x32_bf16 a[112:115], a[220:223], v[216:219], a[112:115]
    ds_read_b64_tr_b16 a[206:207], v6 offset:4096
    v_cvt_pk_bf16_f32 v203, v174, v175
    v_mfma_f32_16x16x32_bf16 a[116:119], a[220:223], v[224:227], a[116:119]
    v_exp_f32 v177, v177
    v_mfma_f32_16x16x32_bf16 a[116:119], a[216:219], v[220:223], a[116:119]
    ds_read_b128 a[140:143], v4 offset:49152
    v_mfma_f32_16x16x32_bf16 a[120:123], a[216:219], v[228:231], a[120:123]
    v_exp_f32 v178, v178
    v_mfma_f32_16x16x32_bf16 a[120:123], a[220:223], v[232:235], a[120:123]
    v_cvt_pk_bf16_f32 v210, v176, v177
    v_mfma_f32_16x16x32_bf16 a[124:127], a[220:223], v[240:243], a[124:127]
    v_exp_f32 v179, v179
    v_mfma_f32_16x16x32_bf16 a[124:127], a[216:219], v[236:239], a[124:127]
    buffer_load_dwordx4 v14, s[8:11], s28 offen offset:1024 lds
    v_smfmac_f32_16x16x64_bf16 a[236:239], v[244:247], v[236:243], v248
    s_waitcnt lgkmcnt(6)
    v_mfma_f32_16x16x32_bf16 v[172:175], a[176:179], v[68:71], v[108:111]
    v_exp_f32 v116, v116
    v_mfma_f32_16x16x32_bf16 v[172:175], a[180:183], v[72:75], v[172:175]
    ds_read_b64_tr_b16 a[208:209], v7 offset:57344
    v_cvt_pk_bf16_f32 v211, v178, v179
    v_mfma_f32_16x16x32_bf16 v[172:175], a[184:187], v[76:79], v[172:175]
    v_exp_f32 v117, v117
    v_mfma_f32_16x16x32_bf16 v[172:175], a[188:191], v[80:83], v[172:175]
    ds_read_b64_tr_b16 a[210:211], v7 offset:61440
    v_mov_b32 v22, v249
    v_mfma_f32_16x16x32_bf16 v[176:179], a[188:191], v[96:99], v[112:115]
    v_exp_f32 v118, v118
    v_mfma_f32_16x16x32_bf16 v[176:179], a[184:187], v[92:95], v[176:179]
    ds_read_b128 a[144:147], v1 offset:53248
    v_cvt_pk_bf16_f32 v212, v116, v117
    v_mfma_f32_16x16x32_bf16 v[176:179], a[180:183], v[88:91], v[176:179]
    v_exp_f32 v119, v119
    v_mfma_f32_16x16x32_bf16 v[176:179], a[176:179], v[84:87], v[176:179]
    ds_read_b64_tr_b16 a[212:213], v7 offset:0
    v_not_b32 v22, v22
    v_mfma_f32_16x16x32_bf16 a[0:3], a[192:195], v[180:183], a[0:3]
    v_exp_f32 v120, v120
    v_mfma_f32_16x16x32_bf16 a[0:3], a[196:199], v[184:187], a[0:3]
    ds_read_b64_tr_b16 a[214:215], v7 offset:4096
    v_cvt_pk_bf16_f32 v213, v118, v119
    v_mfma_f32_16x16x32_bf16 a[4:7], a[196:199], v[192:195], a[4:7]
    v_exp_f32 v121, v121
    v_mfma_f32_16x16x32_bf16 a[4:7], a[192:195], v[188:191], a[4:7]
    ds_read_b128 a[148:151], v2 offset:53248
    v_cvt_pk_bf16_f32 v220, v120, v121
    v_mfma_f32_16x16x32_bf16 a[8:11], a[192:195], v[196:199], a[8:11]
    v_exp_f32 v122, v122
    v_and_b32 v22, 0x7ff, v22
    v_mfma_f32_16x16x32_bf16 a[8:11], a[196:199], v[200:203], a[8:11]
    buffer_load_dwordx4 v15, s[8:11], s28 offen offset:2048 lds
    v_mfma_f32_16x16x32_bf16 a[12:15], a[196:199], v[208:211], a[12:15]
    v_exp_f32 v123, v123
    v_mfma_f32_16x16x32_bf16 a[12:15], a[192:195], v[204:207], a[12:15]
    s_waitcnt lgkmcnt(6)
    v_lshrrev_b32 v24, 4, v19
    v_lshlrev_b32 v23, 4, v22
    v_mfma_f32_16x16x32_bf16 v[116:119], a[128:131], v[36:39], v[100:103]
    v_exp_f32 v124, v124
    v_mfma_f32_16x16x32_bf16 v[116:119], a[132:135], v[40:43], v[116:119]
    ds_read_b64_tr_b16 a[216:217], v8 offset:57344
    v_cvt_pk_bf16_f32 v221, v122, v123
    v_mfma_f32_16x16x32_bf16 v[116:119], a[136:139], v[44:47], v[116:119]
    v_exp_f32 v125, v125
    v_mfma_f32_16x16x32_bf16 v[116:119], a[140:143], v[48:51], v[116:119]
    ds_read_b64_tr_b16 a[218:219], v8 offset:61440
    v_mul_u32_u24 v22, 1280, v22
    v_mfma_f32_16x16x32_bf16 v[120:123], a[140:143], v[64:67], v[104:107]
    v_exp_f32 v126, v126
    v_mfma_f32_16x16x32_bf16 v[120:123], a[136:139], v[60:63], v[120:123]
    ds_read_b128 a[152:155], v3 offset:53248
    v_cvt_pk_bf16_f32 v228, v124, v125
    v_mfma_f32_16x16x32_bf16 v[120:123], a[132:135], v[56:59], v[120:123]
    v_exp_f32 v127, v127
    v_mfma_f32_16x16x32_bf16 v[120:123], a[128:131], v[52:55], v[120:123]
    ds_read_b64_tr_b16 a[220:221], v8 offset:0
    v_lshl_add_u32 v22, v24, 4, v22
    v_mfma_f32_16x16x32_bf16 a[16:19], a[200:203], v[180:183], a[16:19]
    s_mul_i32 s40, s5, 320
    v_exp_f32 v128, v128
    v_mfma_f32_16x16x32_bf16 a[16:19], a[204:207], v[184:187], a[16:19]
    s_mov_b32 s41, 0x280000
    ds_read_b64_tr_b16 a[222:223], v8 offset:4096
    v_cvt_pk_bf16_f32 v229, v126, v127
    v_mfma_f32_16x16x32_bf16 a[20:23], a[204:207], v[192:195], a[20:23]
    v_exp_f32 v129, v129
    v_mfma_f32_16x16x32_bf16 a[20:23], a[200:203], v[188:191], a[20:23]
    ds_read_b128 a[156:159], v4 offset:53248
    v_mfma_f32_16x16x32_bf16 a[24:27], a[200:203], v[196:199], a[24:27]
    v_exp_f32 v130, v130
    v_mfma_f32_16x16x32_bf16 a[24:27], a[204:207], v[200:203], a[24:27]
    v_cvt_pk_bf16_f32 v236, v128, v129
    v_mfma_f32_16x16x32_bf16 a[28:31], a[204:207], v[208:211], a[28:31]
    v_exp_f32 v131, v131
    v_mfma_f32_16x16x32_bf16 a[28:31], a[200:203], v[204:207], a[28:31]
    buffer_load_dwordx4 v16, s[8:11], s28 offen offset:3072 lds
    v_smfmac_f32_16x16x64_bf16 a[224:227], v[244:247], v[180:187], v248
    s_waitcnt lgkmcnt(6)
    buffer_load_dwordx2 v[20:21], v23, s[76:79], s41 offen sc1
    v_mfma_f32_16x16x32_bf16 v[124:127], a[128:131], v[68:71], v[108:111]
    v_exp_f32 v132, v132
    v_mfma_f32_16x16x32_bf16 v[124:127], a[132:135], v[72:75], v[124:127]
    ds_read_b64_tr_b16 a[192:193], v9 offset:57344
    v_cvt_pk_bf16_f32 v237, v130, v131
    v_mfma_f32_16x16x32_bf16 v[124:127], a[136:139], v[76:79], v[124:127]
    v_exp_f32 v133, v133
    v_mfma_f32_16x16x32_bf16 v[124:127], a[140:143], v[80:83], v[124:127]
    ds_read_b64_tr_b16 a[194:195], v9 offset:61440
    v_mfma_f32_16x16x32_bf16 v[128:131], a[140:143], v[96:99], v[112:115]
    v_exp_f32 v134, v134
    v_mfma_f32_16x16x32_bf16 v[128:131], a[136:139], v[92:95], v[128:131]
    ds_read_b128 a[160:163], v1 offset:57344
    v_cvt_pk_bf16_f32 v214, v132, v133
    v_mfma_f32_16x16x32_bf16 v[128:131], a[132:135], v[88:91], v[128:131]
    v_exp_f32 v135, v135
    v_mfma_f32_16x16x32_bf16 v[128:131], a[128:131], v[84:87], v[128:131]
    ds_read_b64_tr_b16 a[196:197], v9 offset:0
    v_mfma_f32_16x16x32_bf16 a[32:35], a[208:211], v[180:183], a[32:35]
    v_exp_f32 v136, v136
    v_mfma_f32_16x16x32_bf16 a[32:35], a[212:215], v[184:187], a[32:35]
    ds_read_b64_tr_b16 a[198:199], v9 offset:4096
    v_cvt_pk_bf16_f32 v215, v134, v135
    v_mfma_f32_16x16x32_bf16 a[36:39], a[212:215], v[192:195], a[36:39]
    v_exp_f32 v137, v137
    v_mfma_f32_16x16x32_bf16 a[36:39], a[208:211], v[188:191], a[36:39]
    ds_read_b128 a[164:167], v2 offset:57344
    v_cvt_pk_bf16_f32 v222, v136, v137
    v_mfma_f32_16x16x32_bf16 a[40:43], a[208:211], v[196:199], a[40:43]
    s_add_u32 s28, s28, 16384
    s_mov_b32 m0, s30
    v_exp_f32 v138, v138
    v_mfma_f32_16x16x32_bf16 a[40:43], a[212:215], v[200:203], a[40:43]
    buffer_load_dwordx4 v17, s[12:15], s29 offen offset:0 lds
    v_mfma_f32_16x16x32_bf16 a[44:47], a[212:215], v[208:211], a[44:47]
    s_mov_b32 exec_lo, 0x00ff00ff
    s_mov_b32 exec_hi, 0x00ff00ff
    buffer_load_dwordx4 a[240:243], v22, s[88:91], s40 offen offset:0
    s_mov_b64 exec, -1
    v_exp_f32 v139, v139
    v_mfma_f32_16x16x32_bf16 a[44:47], a[208:211], v[204:207], a[44:47]
    s_waitcnt lgkmcnt(6)
    s_mov_b32 exec_lo, 0x00ff00ff
    s_mov_b32 exec_hi, 0x00ff00ff
    buffer_load_dwordx4 a[244:247], v22, s[88:91], s40 offen offset:64
    s_mov_b64 exec, -1
    v_mfma_f32_16x16x32_bf16 v[132:135], a[144:147], v[36:39], v[100:103]
    v_exp_f32 v140, v140
    v_mfma_f32_16x16x32_bf16 v[132:135], a[148:151], v[40:43], v[132:135]
    ds_read_b64_tr_b16 a[200:201], v10 offset:57344
    v_cvt_pk_bf16_f32 v223, v138, v139
    v_mfma_f32_16x16x32_bf16 v[132:135], a[152:155], v[44:47], v[132:135]
    v_exp_f32 v141, v141
    v_mfma_f32_16x16x32_bf16 v[132:135], a[156:159], v[48:51], v[132:135]
    ds_read_b64_tr_b16 a[202:203], v10 offset:61440
    v_mfma_f32_16x16x32_bf16 v[136:139], a[156:159], v[64:67], v[104:107]
    v_exp_f32 v142, v142
    v_mfma_f32_16x16x32_bf16 v[136:139], a[152:155], v[60:63], v[136:139]
    ds_read_b128 a[168:171], v3 offset:57344
    v_cvt_pk_bf16_f32 v230, v140, v141
    v_mfma_f32_16x16x32_bf16 v[136:139], a[148:151], v[56:59], v[136:139]
    v_exp_f32 v143, v143
    v_mfma_f32_16x16x32_bf16 v[136:139], a[144:147], v[52:55], v[136:139]
    ds_read_b64_tr_b16 a[204:205], v10 offset:0
    s_mov_b32 exec_lo, 0x00ff00ff
    s_mov_b32 exec_hi, 0x00ff00ff
    buffer_load_dwordx4 a[248:251], v22, s[88:91], s40 offen offset:128
    s_mov_b64 exec, -1
    v_mfma_f32_16x16x32_bf16 a[48:51], a[216:219], v[180:183], a[48:51]
    v_exp_f32 v144, v144
    v_mfma_f32_16x16x32_bf16 a[48:51], a[220:223], v[184:187], a[48:51]
    ds_read_b64_tr_b16 a[206:207], v10 offset:4096
    v_cvt_pk_bf16_f32 v231, v142, v143
    v_mfma_f32_16x16x32_bf16 a[52:55], a[220:223], v[192:195], a[52:55]
    v_exp_f32 v145, v145
    v_mfma_f32_16x16x32_bf16 a[52:55], a[216:219], v[188:191], a[52:55]
    ds_read_b128 a[172:175], v4 offset:57344
    v_mfma_f32_16x16x32_bf16 a[56:59], a[216:219], v[196:199], a[56:59]
    s_mov_b32 exec_lo, 0x00ff00ff
    s_mov_b32 exec_hi, 0x00ff00ff
    buffer_load_dwordx4 a[252:255], v22, s[88:91], s40 offen offset:192
    s_mov_b64 exec, -1
    v_exp_f32 v146, v146
    v_mfma_f32_16x16x32_bf16 a[56:59], a[220:223], v[200:203], a[56:59]
    v_cvt_pk_bf16_f32 v238, v144, v145
    v_mfma_f32_16x16x32_bf16 a[60:63], a[220:223], v[208:211], a[60:63]
    v_exp_f32 v147, v147
    v_mfma_f32_16x16x32_bf16 a[60:63], a[216:219], v[204:207], a[60:63]
    buffer_load_dwordx4 v18, s[12:15], s29 offen offset:1024 lds
    v_smfmac_f32_16x16x64_bf16 a[228:231], v[244:247], v[188:195], v248
    s_waitcnt lgkmcnt(6)
    s_mov_b32 exec_lo, 0x00ff00ff
    s_mov_b32 exec_hi, 0x00ff00ff
    buffer_load_dwordx4 v[252:255], v22, s[88:91], s40 offen offset:256
    s_mov_b64 exec, -1
    v_mfma_f32_16x16x32_bf16 v[140:143], a[144:147], v[68:71], v[108:111]
    v_exp_f32 v148, v148
    v_mfma_f32_16x16x32_bf16 v[140:143], a[148:151], v[72:75], v[140:143]
    ds_read_b64_tr_b16 a[208:209], v11 offset:57344
    v_cvt_pk_bf16_f32 v239, v146, v147
    v_mfma_f32_16x16x32_bf16 v[140:143], a[152:155], v[76:79], v[140:143]
    v_exp_f32 v149, v149
    v_lshrrev_b32 v22, 4, v19
    v_mfma_f32_16x16x32_bf16 v[140:143], a[156:159], v[80:83], v[140:143]
    ds_read_b64_tr_b16 a[210:211], v11 offset:61440
    v_bfe_u32 v24, v19, 2, 2
    v_mfma_f32_16x16x32_bf16 v[144:147], a[156:159], v[96:99], v[112:115]
    v_exp_f32 v150, v150
    v_mfma_f32_16x16x32_bf16 v[144:147], a[152:155], v[92:95], v[144:147]
    ds_read_b128 a[176:179], v1 offset:61440
    v_cvt_pk_bf16_f32 v216, v148, v149
    v_mfma_f32_16x16x32_bf16 v[144:147], a[148:151], v[88:91], v[144:147]
    v_exp_f32 v151, v151
    v_lshl_add_u32 v22, v22, 3, v24
    v_mfma_f32_16x16x32_bf16 v[144:147], a[144:147], v[84:87], v[144:147]
    ds_read_b64_tr_b16 a[212:213], v11 offset:0
    v_and_b32 v24, 1, v19
    v_mfma_f32_16x16x32_bf16 a[64:67], a[192:195], v[180:183], a[64:67]
    v_exp_f32 v152, v152
    v_mfma_f32_16x16x32_bf16 a[64:67], a[196:199], v[184:187], a[64:67]
    ds_read_b64_tr_b16 a[214:215], v11 offset:4096
    v_cvt_pk_bf16_f32 v217, v150, v151
    v_mfma_f32_16x16x32_bf16 a[68:71], a[196:199], v[192:195], a[68:71]
    v_exp_f32 v153, v153
    v_mfma_f32_16x16x32_bf16 a[68:71], a[192:195], v[188:191], a[68:71]
    ds_read_b128 a[180:183], v2 offset:61440
    v_cvt_pk_bf16_f32 v224, v152, v153
    v_lshl_add_u32 v22, v22, 1, v24
    v_mfma_f32_16x16x32_bf16 a[72:75], a[192:195], v[196:199], a[72:75]
    v_exp_f32 v154, v154
    v_mfma_f32_16x16x32_bf16 a[72:75], a[196:199], v[200:203], a[72:75]
    buffer_load_dwordx4 v17, s[12:15], s29 offen offset:2048 lds
    v_bfe_u32 v24, v19, 1, 1
    v_mfma_f32_16x16x32_bf16 a[76:79], a[196:199], v[208:211], a[76:79]
    v_exp_f32 v155, v155
    v_mfma_f32_16x16x32_bf16 a[76:79], a[192:195], v[204:207], a[76:79]
    s_waitcnt lgkmcnt(6)
    v_mul_u32_u24 v24, 10240, v24
    v_lshl_add_u32 v22, v22, 3, v24
    v_mfma_f32_16x16x32_bf16 v[148:151], a[160:163], v[36:39], v[100:103]
    s_mul_i32 s42, s5, 2560
    v_exp_f32 v156, v156
    v_mfma_f32_16x16x32_bf16 v[148:151], a[164:167], v[40:43], v[148:151]
    s_add_u32 s42, s42, 65536
    ds_read_b64_tr_b16 a[216:217], v12 offset:57344
    v_cvt_pk_bf16_f32 v225, v154, v155
    v_mfma_f32_16x16x32_bf16 v[148:151], a[168:171], v[44:47], v[148:151]
    v_exp_f32 v157, v157
    v_mfma_f32_16x16x32_bf16 v[148:151], a[172:175], v[48:51], v[148:151]
    ds_read_b64_tr_b16 a[218:219], v12 offset:61440
    v_add_u32 v22, s42, v22
    v_mfma_f32_16x16x32_bf16 v[152:155], a[172:175], v[64:67], v[104:107]
    s_mov_b32 s42, 65536
    v_exp_f32 v158, v158
    v_mfma_f32_16x16x32_bf16 v[152:155], a[168:171], v[60:63], v[152:155]
    ds_read_b128 a[184:187], v3 offset:61440
    v_cvt_pk_bf16_f32 v232, v156, v157
    v_mfma_f32_16x16x32_bf16 v[152:155], a[164:167], v[56:59], v[152:155]
    v_exp_f32 v159, v159
    v_mfma_f32_16x16x32_bf16 v[152:155], a[160:163], v[52:55], v[152:155]
    ds_read_b64_tr_b16 a[220:221], v12 offset:0
    v_lshl_add_u32 v23, v19, 4, s42
    v_mfma_f32_16x16x32_bf16 a[80:83], a[200:203], v[180:183], a[80:83]
    v_exp_f32 v160, v160
    v_mfma_f32_16x16x32_bf16 a[80:83], a[204:207], v[184:187], a[80:83]
    ds_read_b64_tr_b16 a[222:223], v12 offset:4096
    v_cvt_pk_bf16_f32 v233, v158, v159
    v_mfma_f32_16x16x32_bf16 a[84:87], a[204:207], v[192:195], a[84:87]
    v_exp_f32 v161, v161
    v_mfma_f32_16x16x32_bf16 a[84:87], a[200:203], v[188:191], a[84:87]
    ds_read_b128 a[188:191], v4 offset:61440
    v_readlane_b32 s50, v249, 0
    v_mfma_f32_16x16x32_bf16 a[88:91], a[200:203], v[196:199], a[88:91]
    v_exp_f32 v162, v162
    v_mfma_f32_16x16x32_bf16 a[88:91], a[204:207], v[200:203], a[88:91]
    v_cvt_pk_bf16_f32 v240, v160, v161
    v_readlane_b32 s51, v249, 1
    v_mfma_f32_16x16x32_bf16 a[92:95], a[204:207], v[208:211], a[92:95]
    v_exp_f32 v163, v163
    v_mfma_f32_16x16x32_bf16 a[92:95], a[200:203], v[204:207], a[92:95]
    buffer_load_dwordx4 v18, s[12:15], s29 offen offset:3072 lds
    v_smfmac_f32_16x16x64_bf16 a[232:235], v[244:247], v[196:203], v248
    s_waitcnt vmcnt(15) lgkmcnt(6)
    s_barrier
    s_add_u32 s29, s29, 16384
    v_readlane_b32 s52, v249, 2
    v_mfma_f32_16x16x32_bf16 v[156:159], a[160:163], v[68:71], v[108:111]
    v_exp_f32 v164, v164
    v_mfma_f32_16x16x32_bf16 v[156:159], a[164:167], v[72:75], v[156:159]
    ds_read_b64_tr_b16 a[192:193], v5 offset:24576
    v_cvt_pk_bf16_f32 v241, v162, v163
    v_mfma_f32_16x16x32_bf16 v[156:159], a[168:171], v[76:79], v[156:159]
    v_exp_f32 v165, v165
    v_mfma_f32_16x16x32_bf16 v[156:159], a[172:175], v[80:83], v[156:159]
    ds_read_b64_tr_b16 a[194:195], v5 offset:28672
    v_readlane_b32 s53, v249, 3
    v_mfma_f32_16x16x32_bf16 v[160:163], a[172:175], v[96:99], v[112:115]
    v_exp_f32 v166, v166
    v_mfma_f32_16x16x32_bf16 v[160:163], a[168:171], v[92:95], v[160:163]
    ds_read_b128 a[128:131], v1 offset:16384
    v_cvt_pk_bf16_f32 v218, v164, v165
    v_mfma_f32_16x16x32_bf16 v[160:163], a[164:167], v[88:91], v[160:163]
    v_exp_f32 v167, v167
    v_mfma_f32_16x16x32_bf16 v[160:163], a[160:163], v[84:87], v[160:163]
    ds_read_b64_tr_b16 a[196:197], v5 offset:49152
    v_readlane_b32 s54, v249, 4
    v_mfma_f32_16x16x32_bf16 a[96:99], a[208:211], v[180:183], a[96:99]
    v_exp_f32 v168, v168
    v_mfma_f32_16x16x32_bf16 a[96:99], a[212:215], v[184:187], a[96:99]
    ds_read_b64_tr_b16 a[198:199], v5 offset:53248
    v_cvt_pk_bf16_f32 v219, v166, v167
    v_mfma_f32_16x16x32_bf16 a[100:103], a[212:215], v[192:195], a[100:103]
    v_exp_f32 v169, v169
    v_mfma_f32_16x16x32_bf16 a[100:103], a[208:211], v[188:191], a[100:103]
    ds_read_b128 a[132:135], v2 offset:16384
    v_cvt_pk_bf16_f32 v226, v168, v169
    v_readlane_b32 s55, v249, 5
    v_mfma_f32_16x16x32_bf16 a[104:107], a[208:211], v[196:199], a[104:107]
    s_add_u32 m0, s34, 0
    v_exp_f32 v170, v170
    v_mfma_f32_16x16x32_bf16 a[104:107], a[212:215], v[200:203], a[104:107]
    buffer_load_dwordx4 v13, s[8:11], s28 offen offset:0 lds
    v_readlane_b32 s56, v249, 6
    v_mfma_f32_16x16x32_bf16 a[108:111], a[212:215], v[208:211], a[108:111]
    v_exp_f32 v171, v171
    v_mfma_f32_16x16x32_bf16 a[108:111], a[208:211], v[204:207], a[108:111]
    s_waitcnt lgkmcnt(6)
    v_readlane_b32 s57, v249, 7
    v_mfma_f32_16x16x32_bf16 v[164:167], a[176:179], v[36:39], v[100:103]
    v_exp_f32 v172, v172
    v_mfma_f32_16x16x32_bf16 v[164:167], a[180:183], v[40:43], v[164:167]
    ds_read_b64_tr_b16 a[200:201], v6 offset:24576
    v_cvt_pk_bf16_f32 v227, v170, v171
    v_mfma_f32_16x16x32_bf16 v[164:167], a[184:187], v[44:47], v[164:167]
    v_exp_f32 v173, v173
    v_mfma_f32_16x16x32_bf16 v[164:167], a[188:191], v[48:51], v[164:167]
    ds_read_b64_tr_b16 a[202:203], v6 offset:28672
    v_mfma_f32_16x16x32_bf16 v[168:171], a[188:191], v[64:67], v[104:107]
    v_exp_f32 v174, v174
    v_mfma_f32_16x16x32_bf16 v[168:171], a[184:187], v[60:63], v[168:171]
    ds_read_b128 a[136:139], v3 offset:16384
    v_cvt_pk_bf16_f32 v234, v172, v173
    v_mfma_f32_16x16x32_bf16 v[168:171], a[180:183], v[56:59], v[168:171]
    v_exp_f32 v175, v175
    v_mfma_f32_16x16x32_bf16 v[168:171], a[176:179], v[52:55], v[168:171]
    ds_read_b64_tr_b16 a[204:205], v6 offset:49152
    ds_read_b64_tr_b16 v[24:25], v22 offset:0
    v_mfma_f32_16x16x32_bf16 a[112:115], a[216:219], v[180:183], a[112:115]
    v_exp_f32 v176, v176
    v_mfma_f32_16x16x32_bf16 a[112:115], a[220:223], v[184:187], a[112:115]
    ds_read_b64_tr_b16 a[206:207], v6 offset:53248
    v_cvt_pk_bf16_f32 v235, v174, v175
    v_mfma_f32_16x16x32_bf16 a[116:119], a[220:223], v[192:195], a[116:119]
    v_exp_f32 v177, v177
    v_mfma_f32_16x16x32_bf16 a[116:119], a[216:219], v[188:191], a[116:119]
    ds_read_b128 a[140:143], v4 offset:16384
    ds_read_b64_tr_b16 v[26:27], v22 offset:64
    v_mfma_f32_16x16x32_bf16 a[120:123], a[216:219], v[196:199], a[120:123]
    v_exp_f32 v178, v178
    v_mfma_f32_16x16x32_bf16 a[120:123], a[220:223], v[200:203], a[120:123]
    ds_read_b64_tr_b16 v[28:29], v22 offset:512
    v_cvt_pk_bf16_f32 v242, v176, v177
    v_mfma_f32_16x16x32_bf16 a[124:127], a[220:223], v[208:211], a[124:127]
    v_exp_f32 v179, v179
    v_mfma_f32_16x16x32_bf16 a[124:127], a[216:219], v[204:207], a[124:127]
    buffer_load_dwordx4 v14, s[8:11], s28 offen offset:1024 lds
    v_smfmac_f32_16x16x64_bf16 a[236:239], v[244:247], v[204:211], v248
    s_waitcnt lgkmcnt(6)
    ds_read_b64_tr_b16 v[30:31], v22 offset:576
    v_mfma_f32_16x16x32_bf16 v[172:175], a[176:179], v[68:71], v[108:111]
    v_exp_f32 v116, v116
    v_mfma_f32_16x16x32_bf16 v[172:175], a[180:183], v[72:75], v[172:175]
    ds_read_b64_tr_b16 a[208:209], v7 offset:24576
    v_cvt_pk_bf16_f32 v243, v178, v179
    v_mfma_f32_16x16x32_bf16 v[172:175], a[184:187], v[76:79], v[172:175]
    v_exp_f32 v117, v117
    v_mfma_f32_16x16x32_bf16 v[172:175], a[188:191], v[80:83], v[172:175]
    ds_read_b64_tr_b16 a[210:211], v7 offset:28672
    v_mfma_f32_16x16x32_bf16 v[176:179], a[188:191], v[96:99], v[112:115]
    v_exp_f32 v118, v118
    v_mfma_f32_16x16x32_bf16 v[176:179], a[184:187], v[92:95], v[176:179]
    ds_read_b128 a[144:147], v1 offset:20480
    v_cvt_pk_bf16_f32 v180, v116, v117
    v_mfma_f32_16x16x32_bf16 v[176:179], a[180:183], v[88:91], v[176:179]
    v_exp_f32 v119, v119
    v_mfma_f32_16x16x32_bf16 v[176:179], a[176:179], v[84:87], v[176:179]
    ds_read_b64_tr_b16 a[212:213], v7 offset:49152
    v_mfma_f32_16x16x32_bf16 a[0:3], a[192:195], v[212:215], a[0:3]
    v_exp_f32 v120, v120
    v_mfma_f32_16x16x32_bf16 a[0:3], a[196:199], v[216:219], a[0:3]
    ds_read_b64_tr_b16 a[214:215], v7 offset:53248
    v_cvt_pk_bf16_f32 v181, v118, v119
    v_mfma_f32_16x16x32_bf16 a[4:7], a[196:199], v[224:227], a[4:7]
    v_exp_f32 v121, v121
    v_mfma_f32_16x16x32_bf16 a[4:7], a[192:195], v[220:223], a[4:7]
    ds_read_b128 a[148:151], v2 offset:20480
    v_cvt_pk_bf16_f32 v188, v120, v121
    v_mfma_f32_16x16x32_bf16 a[8:11], a[192:195], v[228:231], a[8:11]
    v_exp_f32 v122, v122
    v_mfma_f32_16x16x32_bf16 a[8:11], a[196:199], v[232:235], a[8:11]
    buffer_load_dwordx4 v15, s[8:11], s28 offen offset:2048 lds
    v_mfma_f32_16x16x32_bf16 a[12:15], a[196:199], v[240:243], a[12:15]
    v_exp_f32 v123, v123
    v_mfma_f32_16x16x32_bf16 a[12:15], a[192:195], v[236:239], a[12:15]
    s_waitcnt lgkmcnt(6)
    v_mfma_f32_16x16x32_bf16 v[116:119], a[128:131], v[36:39], v[100:103]
    s_waitcnt vmcnt(5)
    v_exp_f32 v124, v124
    v_mfma_f32_16x16x32_bf16 v[32:35], v[24:27], a[240:243], 0
    v_mfma_f32_16x16x32_bf16 v[32:35], v[28:31], a[244:247], v[32:35]
    ds_read_b64_tr_b16 v[24:25], v22 offset:1024
    v_mfma_f32_16x16x32_bf16 v[116:119], a[132:135], v[40:43], v[116:119]
    ds_read_b64_tr_b16 a[216:217], v8 offset:24576
    v_cvt_pk_bf16_f32 v189, v122, v123
    v_mfma_f32_16x16x32_bf16 v[116:119], a[136:139], v[44:47], v[116:119]
    v_exp_f32 v125, v125
    v_mfma_f32_16x16x32_bf16 v[116:119], a[140:143], v[48:51], v[116:119]
    ds_read_b64_tr_b16 a[218:219], v8 offset:28672
    v_mfma_f32_16x16x32_bf16 v[120:123], a[140:143], v[64:67], v[104:107]
    v_exp_f32 v126, v126
    v_mfma_f32_16x16x32_bf16 v[120:123], a[136:139], v[60:63], v[120:123]
    ds_read_b128 a[152:155], v3 offset:20480
    v_cvt_pk_bf16_f32 v196, v124, v125
    v_mfma_f32_16x16x32_bf16 v[120:123], a[132:135], v[56:59], v[120:123]
    v_exp_f32 v127, v127
    v_mfma_f32_16x16x32_bf16 v[120:123], a[128:131], v[52:55], v[120:123]
    ds_read_b64_tr_b16 a[220:221], v8 offset:49152
    v_mfma_f32_16x16x32_bf16 a[16:19], a[200:203], v[212:215], a[16:19]
    v_exp_f32 v128, v128
    v_mfma_f32_16x16x32_bf16 a[16:19], a[204:207], v[216:219], a[16:19]
    ds_read_b64_tr_b16 a[222:223], v8 offset:53248
    v_cvt_pk_bf16_f32 v197, v126, v127
    v_mfma_f32_16x16x32_bf16 a[20:23], a[204:207], v[224:227], a[20:23]
    v_exp_f32 v129, v129
    v_mfma_f32_16x16x32_bf16 a[20:23], a[200:203], v[220:223], a[20:23]
    ds_read_b128 a[156:159], v4 offset:20480
    v_mfma_f32_16x16x32_bf16 a[24:27], a[200:203], v[228:231], a[24:27]
    v_exp_f32 v130, v130
    v_mfma_f32_16x16x32_bf16 a[24:27], a[204:207], v[232:235], a[24:27]
    ds_read_b64_tr_b16 v[26:27], v22 offset:1088
    v_cvt_pk_bf16_f32 v204, v128, v129
    v_mfma_f32_16x16x32_bf16 a[28:31], a[204:207], v[240:243], a[28:31]
    v_exp_f32 v131, v131
    v_mfma_f32_16x16x32_bf16 a[28:31], a[200:203], v[236:239], a[28:31]
    buffer_load_dwordx4 v16, s[8:11], s28 offen offset:3072 lds
    v_smfmac_f32_16x16x64_bf16 a[224:227], v[244:247], v[212:219], v248
    s_waitcnt lgkmcnt(6)
    ds_read_b64_tr_b16 v[28:29], v22 offset:1536
    ds_read_b64_tr_b16 v[30:31], v22 offset:1600
    v_mfma_f32_16x16x32_bf16 v[124:127], a[128:131], v[68:71], v[108:111]
    s_mul_i32 s40, s5, 2560
    v_exp_f32 v132, v132
    v_mfma_f32_16x16x32_bf16 v[124:127], a[132:135], v[72:75], v[124:127]
    ds_read_b64_tr_b16 a[192:193], v9 offset:24576
    v_cvt_pk_bf16_f32 v205, v130, v131
    v_mfma_f32_16x16x32_bf16 v[124:127], a[136:139], v[76:79], v[124:127]
    v_exp_f32 v133, v133
    v_add_u32 v0, s40, v23
    v_mfma_f32_16x16x32_bf16 v[124:127], a[140:143], v[80:83], v[124:127]
    ds_read_b64_tr_b16 a[194:195], v9 offset:28672
    v_mfma_f32_16x16x32_bf16 v[128:131], a[140:143], v[96:99], v[112:115]
    v_exp_f32 v134, v134
    v_mfma_f32_16x16x32_bf16 v[128:131], a[136:139], v[92:95], v[128:131]
    ds_read_b128 a[160:163], v1 offset:24576
    v_cvt_pk_bf16_f32 v182, v132, v133
    v_mfma_f32_16x16x32_bf16 v[128:131], a[132:135], v[88:91], v[128:131]
    v_exp_f32 v135, v135
    v_mfma_f32_16x16x32_bf16 v[128:131], a[128:131], v[84:87], v[128:131]
    ds_read_b64_tr_b16 a[196:197], v9 offset:49152
    v_mfma_f32_16x16x32_bf16 a[32:35], a[208:211], v[212:215], a[32:35]
    v_exp_f32 v136, v136
    v_mfma_f32_16x16x32_bf16 a[32:35], a[212:215], v[216:219], a[32:35]
    s_waitcnt lgkmcnt(4)
    ds_read_b64_tr_b16 a[198:199], v9 offset:53248
    v_cvt_pk_bf16_f32 v183, v134, v135
    v_mfma_f32_16x16x32_bf16 v[32:35], v[24:27], a[248:251], v[32:35]
    v_mfma_f32_16x16x32_bf16 v[32:35], v[28:31], a[252:255], v[32:35]
    ds_read_b64_tr_b16 v[24:25], v22 offset:2048
    v_mfma_f32_16x16x32_bf16 a[36:39], a[212:215], v[224:227], a[36:39]
    v_exp_f32 v137, v137
    v_mfma_f32_16x16x32_bf16 a[36:39], a[208:211], v[220:223], a[36:39]
    ds_read_b128 a[164:167], v2 offset:24576
    v_cvt_pk_bf16_f32 v190, v136, v137
    v_mfma_f32_16x16x32_bf16 a[40:43], a[208:211], v[228:231], a[40:43]
    s_add_u32 s28, s28, 16384
    s_mov_b32 m0, s31
    v_exp_f32 v138, v138
    v_mfma_f32_16x16x32_bf16 a[40:43], a[212:215], v[232:235], a[40:43]
    buffer_load_dwordx4 v17, s[12:15], s29 offen offset:0 lds
    v_mfma_f32_16x16x32_bf16 a[44:47], a[212:215], v[240:243], a[44:47]
    v_exp_f32 v139, v139
    v_mfma_f32_16x16x32_bf16 a[44:47], a[208:211], v[236:239], a[44:47]
    s_waitcnt lgkmcnt(6)
    ds_read_b64_tr_b16 v[26:27], v22 offset:2112
    v_mfma_f32_16x16x32_bf16 v[132:135], a[144:147], v[36:39], v[100:103]
    v_exp_f32 v140, v140
    v_mfma_f32_16x16x32_bf16 v[132:135], a[148:151], v[40:43], v[132:135]
    ds_read_b64_tr_b16 a[200:201], v10 offset:24576
    v_cvt_pk_bf16_f32 v191, v138, v139
    v_mfma_f32_16x16x32_bf16 v[132:135], a[152:155], v[44:47], v[132:135]
    v_exp_f32 v141, v141
    v_mfma_f32_16x16x32_bf16 v[132:135], a[156:159], v[48:51], v[132:135]
    ds_read_b64_tr_b16 a[202:203], v10 offset:28672
    v_mfma_f32_16x16x32_bf16 v[136:139], a[156:159], v[64:67], v[104:107]
    v_exp_f32 v142, v142
    v_mfma_f32_16x16x32_bf16 v[136:139], a[152:155], v[60:63], v[136:139]
    ds_read_b128 a[168:171], v3 offset:24576
    v_cvt_pk_bf16_f32 v198, v140, v141
    v_mfma_f32_16x16x32_bf16 v[136:139], a[148:151], v[56:59], v[136:139]
    v_exp_f32 v143, v143
    v_mfma_f32_16x16x32_bf16 v[136:139], a[144:147], v[52:55], v[136:139]
    ds_read_b64_tr_b16 a[204:205], v10 offset:49152
    v_mfma_f32_16x16x32_bf16 a[48:51], a[216:219], v[212:215], a[48:51]
    s_waitcnt lgkmcnt(4)
    v_exp_f32 v144, v144
    v_mfma_f32_16x16x32_bf16 v[32:35], v[24:27], v[252:255], v[32:35]
    v_mfma_f32_16x16x32_bf16 a[48:51], a[220:223], v[216:219], a[48:51]
    ds_read_b64_tr_b16 a[206:207], v10 offset:53248
    v_cvt_pk_bf16_f32 v199, v142, v143
    v_mfma_f32_16x16x32_bf16 a[52:55], a[220:223], v[224:227], a[52:55]
    v_exp_f32 v145, v145
    v_mfma_f32_16x16x32_bf16 a[52:55], a[216:219], v[220:223], a[52:55]
    ds_read_b128 a[172:175], v4 offset:24576
    v_mfma_f32_16x16x32_bf16 a[56:59], a[216:219], v[228:231], a[56:59]
    v_exp_f32 v146, v146
    v_mfma_f32_16x16x32_bf16 a[56:59], a[220:223], v[232:235], a[56:59]
    v_cvt_pk_bf16_f32 v206, v144, v145
    v_mfma_f32_16x16x32_bf16 a[60:63], a[220:223], v[240:243], a[60:63]
    v_exp_f32 v147, v147
    v_mfma_f32_16x16x32_bf16 a[60:63], a[216:219], v[236:239], a[60:63]
    buffer_load_dwordx4 v18, s[12:15], s29 offen offset:1024 lds
    v_smfmac_f32_16x16x64_bf16 a[228:231], v[244:247], v[220:227], v248
    s_waitcnt lgkmcnt(6)
    v_mfma_f32_16x16x32_bf16 v[140:143], a[144:147], v[68:71], v[108:111]
    v_exp_f32 v148, v148
    v_mfma_f32_16x16x32_bf16 v[140:143], a[148:151], v[72:75], v[140:143]
    ds_read_b64_tr_b16 a[208:209], v11 offset:24576
    v_cvt_pk_bf16_f32 v207, v146, v147
    v_mfma_f32_16x16x32_bf16 v[140:143], a[152:155], v[76:79], v[140:143]
    v_exp_f32 v149, v149
    v_mfma_f32_16x16x32_bf16 v[140:143], a[156:159], v[80:83], v[140:143]
    ds_read_b64_tr_b16 a[210:211], v11 offset:28672
    v_mfma_f32_16x16x32_bf16 v[144:147], a[156:159], v[96:99], v[112:115]
    v_exp_f32 v150, v150
    v_mfma_f32_16x16x32_bf16 v[144:147], a[152:155], v[92:95], v[144:147]
    ds_read_b128 a[176:179], v1 offset:28672
    v_cvt_pk_bf16_f32 v184, v148, v149
    v_mfma_f32_16x16x32_bf16 v[144:147], a[148:151], v[88:91], v[144:147]
    v_exp_f32 v151, v151
    v_mfma_f32_16x16x32_bf16 v[144:147], a[144:147], v[84:87], v[144:147]
    ds_read_b64_tr_b16 a[212:213], v11 offset:49152
    ds_write_b128 v0, v[32:35]
    v_bfe_u32 v22, v19, 2, 3
    v_mfma_f32_16x16x32_bf16 a[64:67], a[192:195], v[212:215], a[64:67]
    v_exp_f32 v152, v152
    v_mul_u32_u24 v22, 160, v22
    v_mfma_f32_16x16x32_bf16 a[64:67], a[196:199], v[216:219], a[64:67]
    ds_read_b64_tr_b16 a[214:215], v11 offset:53248
    v_cvt_pk_bf16_f32 v185, v150, v151
    v_mfma_f32_16x16x32_bf16 a[68:71], a[196:199], v[224:227], a[68:71]
    v_exp_f32 v153, v153
    v_and_b32 v28, 3, v19
    v_mfma_f32_16x16x32_bf16 a[68:71], a[192:195], v[220:223], a[68:71]
    ds_read_b128 a[180:183], v2 offset:28672
    v_cvt_pk_bf16_f32 v192, v152, v153
    v_add_u32 v22, v22, v28
    v_mfma_f32_16x16x32_bf16 a[72:75], a[192:195], v[228:231], a[72:75]
    s_mul_i32 s42, s5, 320
    v_exp_f32 v154, v154
    v_mfma_f32_16x16x32_bf16 a[72:75], a[196:199], v[232:235], a[72:75]
    s_add_u32 s42, s42, 86016
    buffer_load_dwordx4 v17, s[12:15], s29 offen offset:2048 lds
    v_mfma_f32_16x16x32_bf16 a[76:79], a[196:199], v[240:243], a[76:79]
    v_exp_f32 v155, v155
    v_mfma_f32_16x16x32_bf16 a[76:79], a[192:195], v[236:239], a[76:79]
    s_waitcnt lgkmcnt(6)
    v_lshl_add_u32 v22, v22, 3, s42
    v_mfma_f32_16x16x32_bf16 v[148:151], a[160:163], v[36:39], v[100:103]
    v_exp_f32 v156, v156
    v_mfma_f32_16x16x32_bf16 v[148:151], a[164:167], v[40:43], v[148:151]
    ds_read_b64_tr_b16 a[216:217], v12 offset:24576
    v_cvt_pk_bf16_f32 v193, v154, v155
    v_mfma_f32_16x16x32_bf16 v[148:151], a[168:171], v[44:47], v[148:151]
    v_exp_f32 v157, v157
    v_mfma_f32_16x16x32_bf16 v[148:151], a[172:175], v[48:51], v[148:151]
    ds_read_b64_tr_b16 a[218:219], v12 offset:28672
    v_mfma_f32_16x16x32_bf16 v[152:155], a[172:175], v[64:67], v[104:107]
    v_exp_f32 v158, v158
    v_mfma_f32_16x16x32_bf16 v[152:155], a[168:171], v[60:63], v[152:155]
    ds_read_b128 a[184:187], v3 offset:28672
    v_cvt_pk_bf16_f32 v200, v156, v157
    v_mfma_f32_16x16x32_bf16 v[152:155], a[164:167], v[56:59], v[152:155]
    v_exp_f32 v159, v159
    v_mfma_f32_16x16x32_bf16 v[152:155], a[160:163], v[52:55], v[152:155]
    ds_read_b64_tr_b16 a[220:221], v12 offset:49152
    v_mfma_f32_16x16x32_bf16 a[80:83], a[200:203], v[212:215], a[80:83]
    v_exp_f32 v160, v160
    v_mfma_f32_16x16x32_bf16 a[80:83], a[204:207], v[216:219], a[80:83]
    ds_read_b64_tr_b16 a[222:223], v12 offset:53248
    v_cvt_pk_bf16_f32 v201, v158, v159
    v_mfma_f32_16x16x32_bf16 a[84:87], a[204:207], v[224:227], a[84:87]
    v_exp_f32 v161, v161
    v_mfma_f32_16x16x32_bf16 a[84:87], a[200:203], v[220:223], a[84:87]
    ds_read_b128 a[188:191], v4 offset:28672
    v_mfma_f32_16x16x32_bf16 a[88:91], a[200:203], v[228:231], a[88:91]
    v_exp_f32 v162, v162
    v_mfma_f32_16x16x32_bf16 a[88:91], a[204:207], v[232:235], a[88:91]
    v_cvt_pk_bf16_f32 v208, v160, v161
    v_mfma_f32_16x16x32_bf16 a[92:95], a[204:207], v[240:243], a[92:95]
    v_exp_f32 v163, v163
    v_mfma_f32_16x16x32_bf16 a[92:95], a[200:203], v[236:239], a[92:95]
    buffer_load_dwordx4 v18, s[12:15], s29 offen offset:3072 lds
    v_smfmac_f32_16x16x64_bf16 a[232:235], v[244:247], v[228:235], v248
    s_waitcnt vmcnt(8) lgkmcnt(6)
    s_barrier
    s_add_u32 s29, s29, 16384
    v_mfma_f32_16x16x32_bf16 v[156:159], a[160:163], v[68:71], v[108:111]
    v_exp_f32 v164, v164
    v_mfma_f32_16x16x32_bf16 v[156:159], a[164:167], v[72:75], v[156:159]
    ds_read_b64_tr_b16 a[192:193], v5 offset:8192
    v_cvt_pk_bf16_f32 v209, v162, v163
    v_mfma_f32_16x16x32_bf16 v[156:159], a[168:171], v[76:79], v[156:159]
    v_exp_f32 v165, v165
    v_mfma_f32_16x16x32_bf16 v[156:159], a[172:175], v[80:83], v[156:159]
    ds_read_b64_tr_b16 a[194:195], v5 offset:12288
    ds_read_b128 v[24:27], v23 offset:0
    v_mfma_f32_16x16x32_bf16 v[160:163], a[172:175], v[96:99], v[112:115]
    v_exp_f32 v166, v166
    v_mfma_f32_16x16x32_bf16 v[160:163], a[168:171], v[92:95], v[160:163]
    ds_read_b128 a[128:131], v1 offset:32768
    v_cvt_pk_bf16_f32 v186, v164, v165
    v_mfma_f32_16x16x32_bf16 v[160:163], a[164:167], v[88:91], v[160:163]
    v_exp_f32 v167, v167
    v_mfma_f32_16x16x32_bf16 v[160:163], a[160:163], v[84:87], v[160:163]
    ds_read_b64_tr_b16 a[196:197], v5 offset:32768
    ds_read_b128 v[28:31], v23 offset:2560
    v_mfma_f32_16x16x32_bf16 a[96:99], a[208:211], v[212:215], a[96:99]
    v_exp_f32 v168, v168
    v_mfma_f32_16x16x32_bf16 a[96:99], a[212:215], v[216:219], a[96:99]
    ds_read_b64_tr_b16 a[198:199], v5 offset:36864
    v_cvt_pk_bf16_f32 v187, v166, v167
    v_mfma_f32_16x16x32_bf16 a[100:103], a[212:215], v[224:227], a[100:103]
    v_exp_f32 v169, v169
    v_mfma_f32_16x16x32_bf16 a[100:103], a[208:211], v[220:223], a[100:103]
    ds_read_b128 a[132:135], v2 offset:32768
    v_cvt_pk_bf16_f32 v194, v168, v169
    v_mfma_f32_16x16x32_bf16 a[104:107], a[208:211], v[228:231], a[104:107]
    s_add_u32 m0, s34, 49152
    v_exp_f32 v170, v170
    v_mfma_f32_16x16x32_bf16 a[104:107], a[212:215], v[232:235], a[104:107]
    buffer_load_dwordx4 v13, s[8:11], s28 offen offset:0 lds
    v_mfma_f32_16x16x32_bf16 a[108:111], a[212:215], v[240:243], a[108:111]
    v_exp_f32 v171, v171
    v_mfma_f32_16x16x32_bf16 a[108:111], a[208:211], v[236:239], a[108:111]
    s_waitcnt lgkmcnt(6)
    ds_read_b128 v[32:35], v23 offset:5120
    ds_read_b128 v[252:255], v23 offset:7680
    v_mfma_f32_16x16x32_bf16 v[164:167], a[176:179], v[36:39], v[100:103]
    v_exp_f32 v172, v172
    v_mfma_f32_16x16x32_bf16 v[164:167], a[180:183], v[40:43], v[164:167]
    ds_read_b64_tr_b16 a[200:201], v6 offset:8192
    v_cvt_pk_bf16_f32 v195, v170, v171
    v_mfma_f32_16x16x32_bf16 v[164:167], a[184:187], v[44:47], v[164:167]
    v_exp_f32 v173, v173
    v_mfma_f32_16x16x32_bf16 v[164:167], a[188:191], v[48:51], v[164:167]
    ds_read_b64_tr_b16 a[202:203], v6 offset:12288
    v_mfma_f32_16x16x32_bf16 v[168:171], a[188:191], v[64:67], v[104:107]
    v_exp_f32 v174, v174
    v_mfma_f32_16x16x32_bf16 v[168:171], a[184:187], v[60:63], v[168:171]
    ds_read_b128 a[136:139], v3 offset:32768
    v_cvt_pk_bf16_f32 v202, v172, v173
    v_mfma_f32_16x16x32_bf16 v[168:171], a[180:183], v[56:59], v[168:171]
    v_exp_f32 v175, v175
    v_mfma_f32_16x16x32_bf16 v[168:171], a[176:179], v[52:55], v[168:171]
    ds_read_b64_tr_b16 a[204:205], v6 offset:32768
    ds_read_b64_tr_b16 a[240:241], v22 offset:0
    v_mfma_f32_16x16x32_bf16 a[112:115], a[216:219], v[212:215], a[112:115]
    v_exp_f32 v176, v176
    v_mfma_f32_16x16x32_bf16 a[112:115], a[220:223], v[216:219], a[112:115]
    ds_read_b64_tr_b16 a[206:207], v6 offset:36864
    v_cvt_pk_bf16_f32 v203, v174, v175
    v_mfma_f32_16x16x32_bf16 a[116:119], a[220:223], v[224:227], a[116:119]
    v_exp_f32 v177, v177
    v_mfma_f32_16x16x32_bf16 a[116:119], a[216:219], v[220:223], a[116:119]
    ds_read_b128 a[140:143], v4 offset:32768
    ds_read_b64_tr_b16 a[242:243], v22 offset:32
    v_mfma_f32_16x16x32_bf16 a[120:123], a[216:219], v[228:231], a[120:123]
    v_exp_f32 v178, v178
    v_mfma_f32_16x16x32_bf16 a[120:123], a[220:223], v[232:235], a[120:123]
    ds_read_b64_tr_b16 a[244:245], v22 offset:64
    v_cvt_pk_bf16_f32 v210, v176, v177
    v_mfma_f32_16x16x32_bf16 a[124:127], a[220:223], v[240:243], a[124:127]
    v_exp_f32 v179, v179
    v_mfma_f32_16x16x32_bf16 a[124:127], a[216:219], v[236:239], a[124:127]
    buffer_load_dwordx4 v14, s[8:11], s28 offen offset:1024 lds
    v_smfmac_f32_16x16x64_bf16 a[236:239], v[244:247], v[236:243], v248
    s_waitcnt lgkmcnt(6)
    ds_read_b64_tr_b16 a[246:247], v22 offset:96
    v_mfma_f32_16x16x32_bf16 v[172:175], a[176:179], v[68:71], v[108:111]
    v_exp_f32 v116, v116
    v_mfma_f32_16x16x32_bf16 v[172:175], a[180:183], v[72:75], v[172:175]
    ds_read_b64_tr_b16 a[208:209], v7 offset:8192
    v_cvt_pk_bf16_f32 v211, v178, v179
    v_add_f32 v24, v24, v28
    v_mfma_f32_16x16x32_bf16 v[172:175], a[184:187], v[76:79], v[172:175]
    v_exp_f32 v117, v117
    v_mfma_f32_16x16x32_bf16 v[172:175], a[188:191], v[80:83], v[172:175]
    ds_read_b64_tr_b16 a[210:211], v7 offset:12288
    v_add_f32 v25, v25, v29
    v_mfma_f32_16x16x32_bf16 v[176:179], a[188:191], v[96:99], v[112:115]
    v_exp_f32 v118, v118
    v_add_f32 v26, v26, v30
    v_mfma_f32_16x16x32_bf16 v[176:179], a[184:187], v[92:95], v[176:179]
    ds_read_b128 a[144:147], v1 offset:36864
    v_cvt_pk_bf16_f32 v212, v116, v117
    v_mfma_f32_16x16x32_bf16 v[176:179], a[180:183], v[88:91], v[176:179]
    v_exp_f32 v119, v119
    v_add_f32 v27, v27, v31
    v_mfma_f32_16x16x32_bf16 v[176:179], a[176:179], v[84:87], v[176:179]
    ds_read_b64_tr_b16 a[212:213], v7 offset:32768
    v_add_f32 v24, v24, v32
    v_mfma_f32_16x16x32_bf16 a[0:3], a[192:195], v[180:183], a[0:3]
    v_exp_f32 v120, v120
    v_mfma_f32_16x16x32_bf16 a[0:3], a[196:199], v[184:187], a[0:3]
    ds_read_b64_tr_b16 a[214:215], v7 offset:36864
    v_cvt_pk_bf16_f32 v213, v118, v119
    v_add_f32 v25, v25, v33
    v_mfma_f32_16x16x32_bf16 a[4:7], a[196:199], v[192:195], a[4:7]
    v_exp_f32 v121, v121
    v_add_f32 v26, v26, v34
    v_mfma_f32_16x16x32_bf16 a[4:7], a[192:195], v[188:191], a[4:7]
    ds_read_b128 a[148:151], v2 offset:36864
    v_cvt_pk_bf16_f32 v220, v120, v121
    v_mfma_f32_16x16x32_bf16 a[8:11], a[192:195], v[196:199], a[8:11]
    v_exp_f32 v122, v122
    v_add_f32 v27, v27, v35
    v_mfma_f32_16x16x32_bf16 a[8:11], a[196:199], v[200:203], a[8:11]
    buffer_load_dwordx4 v15, s[8:11], s28 offen offset:2048 lds
    v_add_f32 v24, v24, v252
    v_mfma_f32_16x16x32_bf16 a[12:15], a[196:199], v[208:211], a[12:15]
    v_exp_f32 v123, v123
    v_mfma_f32_16x16x32_bf16 a[12:15], a[192:195], v[204:207], a[12:15]
    s_waitcnt lgkmcnt(6)
    v_add_f32 v25, v25, v253
    v_add_f32 v26, v26, v254
    v_mfma_f32_16x16x32_bf16 v[116:119], a[128:131], v[36:39], v[100:103]
    v_exp_f32 v124, v124
    v_mfma_f32_16x16x32_bf16 v[116:119], a[132:135], v[40:43], v[116:119]
    ds_read_b64_tr_b16 a[216:217], v8 offset:8192
    v_cvt_pk_bf16_f32 v221, v122, v123
    v_mfma_f32_16x16x32_bf16 v[116:119], a[136:139], v[44:47], v[116:119]
    v_exp_f32 v125, v125
    v_add_f32 v27, v27, v255
    v_mfma_f32_16x16x32_bf16 v[116:119], a[140:143], v[48:51], v[116:119]
    ds_read_b64_tr_b16 a[218:219], v8 offset:12288
    v_mov_b32_dpp v28, v24 row_newbcast:8 row_mask:0xf bank_mask:0xf
    v_mfma_f32_16x16x32_bf16 v[120:123], a[140:143], v[64:67], v[104:107]
    v_exp_f32 v126, v126
    v_mfma_f32_16x16x32_bf16 v[120:123], a[136:139], v[60:63], v[120:123]
    ds_read_b128 a[152:155], v3 offset:36864
    v_cvt_pk_bf16_f32 v228, v124, v125
    v_mov_b32_dpp v29, v25 row_newbcast:8 row_mask:0xf bank_mask:0xf
    v_mfma_f32_16x16x32_bf16 v[120:123], a[132:135], v[56:59], v[120:123]
    v_exp_f32 v127, v127
    v_mfma_f32_16x16x32_bf16 v[120:123], a[128:131], v[52:55], v[120:123]
    ds_read_b64_tr_b16 a[220:221], v8 offset:32768
    v_mov_b32_dpp v30, v26 row_newbcast:8 row_mask:0xf bank_mask:0xf
    v_mfma_f32_16x16x32_bf16 a[16:19], a[200:203], v[180:183], a[16:19]
    v_exp_f32 v128, v128
    v_mov_b32_dpp v31, v27 row_newbcast:8 row_mask:0xf bank_mask:0xf
    v_mfma_f32_16x16x32_bf16 a[16:19], a[204:207], v[184:187], a[16:19]
    ds_read_b64_tr_b16 a[222:223], v8 offset:36864
    v_cvt_pk_bf16_f32 v229, v126, v127
    v_mfma_f32_16x16x32_bf16 a[20:23], a[204:207], v[192:195], a[20:23]
    v_exp_f32 v129, v129
    v_fma_f32 v24, -v20, v28, v24
    v_mfma_f32_16x16x32_bf16 a[20:23], a[200:203], v[188:191], a[20:23]
    ds_read_b128 a[156:159], v4 offset:36864
    v_fma_f32 v25, -v20, v29, v25
    v_mfma_f32_16x16x32_bf16 a[24:27], a[200:203], v[196:199], a[24:27]
    v_exp_f32 v130, v130
    v_mfma_f32_16x16x32_bf16 a[24:27], a[204:207], v[200:203], a[24:27]
    v_cvt_pk_bf16_f32 v236, v128, v129
    v_fma_f32 v26, -v20, v30, v26
    v_mfma_f32_16x16x32_bf16 a[28:31], a[204:207], v[208:211], a[28:31]
    v_exp_f32 v131, v131
    v_mfma_f32_16x16x32_bf16 a[28:31], a[200:203], v[204:207], a[28:31]
    buffer_load_dwordx4 v16, s[8:11], s28 offen offset:3072 lds
    v_fma_f32 v27, -v20, v31, v27
    v_smfmac_f32_16x16x64_bf16 a[224:227], v[244:247], v[180:187], v248
    s_waitcnt lgkmcnt(6)
    ds_read_b64_tr_b16 a[248:249], v22 offset:128
    ds_read_b64_tr_b16 a[250:251], v22 offset:160
    ds_read_b64_tr_b16 a[252:253], v22 offset:192
    ds_read_b64_tr_b16 a[254:255], v22 offset:224
    v_mul_f32 v24, v24, v21
    v_mul_f32 v25, v25, v21
    v_mfma_f32_16x16x32_bf16 v[124:127], a[128:131], v[68:71], v[108:111]
    v_exp_f32 v132, v132
    v_mfma_f32_16x16x32_bf16 v[124:127], a[132:135], v[72:75], v[124:127]
    ds_read_b64_tr_b16 a[192:193], v9 offset:8192
    v_cvt_pk_bf16_f32 v237, v130, v131
    v_mfma_f32_16x16x32_bf16 v[124:127], a[136:139], v[76:79], v[124:127]
    v_exp_f32 v133, v133
    v_mfma_f32_16x16x32_bf16 v[124:127], a[140:143], v[80:83], v[124:127]
    ds_read_b64_tr_b16 a[194:195], v9 offset:12288
    v_mul_f32 v26, v26, v21
    v_mfma_f32_16x16x32_bf16 v[128:131], a[140:143], v[96:99], v[112:115]
    v_exp_f32 v134, v134
    v_mul_f32 v27, v27, v21
    v_mfma_f32_16x16x32_bf16 v[128:131], a[136:139], v[92:95], v[128:131]
    ds_read_b128 a[160:163], v1 offset:40960
    v_cvt_pk_bf16_f32 v214, v132, v133
    v_mfma_f32_16x16x32_bf16 v[128:131], a[132:135], v[88:91], v[128:131]
    v_exp_f32 v135, v135
    v_cvt_pk_bf16_f32 v28, v24, v25
    v_mfma_f32_16x16x32_bf16 v[128:131], a[128:131], v[84:87], v[128:131]
    ds_read_b64_tr_b16 a[196:197], v9 offset:32768
    v_cvt_pk_bf16_f32 v29, v26, v27
    v_mfma_f32_16x16x32_bf16 a[32:35], a[208:211], v[180:183], a[32:35]
    v_exp_f32 v136, v136
    v_mfma_f32_16x16x32_bf16 a[32:35], a[212:215], v[184:187], a[32:35]
    ds_read_b64_tr_b16 a[198:199], v9 offset:36864
    v_cvt_pk_bf16_f32 v215, v134, v135
    v_lshlrev_b32 v24, 16, v28
    v_mfma_f32_16x16x32_bf16 a[36:39], a[212:215], v[192:195], a[36:39]
    v_exp_f32 v137, v137
    v_and_b32 v25, 0xffff0000, v28
    v_mfma_f32_16x16x32_bf16 a[36:39], a[208:211], v[188:191], a[36:39]
    ds_read_b128 a[164:167], v2 offset:40960
    v_cvt_pk_bf16_f32 v222, v136, v137
    v_mfma_f32_16x16x32_bf16 a[40:43], a[208:211], v[196:199], a[40:43]
    s_add_u32 s28, s28, 16384
    s_mov_b32 m0, s32
    v_exp_f32 v138, v138
    v_lshlrev_b32 v26, 16, v29
    v_mfma_f32_16x16x32_bf16 a[40:43], a[212:215], v[200:203], a[40:43]
    buffer_load_dwordx4 v17, s[12:15], s29 offen offset:0 lds
    v_and_b32 v27, 0xffff0000, v29
    v_mfma_f32_16x16x32_bf16 a[44:47], a[212:215], v[208:211], a[44:47]
    v_exp_f32 v139, v139
    v_mfma_f32_16x16x32_bf16 a[44:47], a[208:211], v[204:207], a[44:47]
    s_waitcnt lgkmcnt(6)
    v_mov_b32 v32, v24
    v_mov_b32 v33, v25
    v_mfma_f32_16x16x32_bf16 v[132:135], a[144:147], v[36:39], v[100:103]
    v_exp_f32 v140, v140
    v_mfma_f32_16x16x32_bf16 v[132:135], a[148:151], v[40:43], v[132:135]
    ds_read_b64_tr_b16 a[200:201], v10 offset:8192
    v_cvt_pk_bf16_f32 v223, v138, v139
    v_mfma_f32_16x16x32_bf16 v[132:135], a[152:155], v[44:47], v[132:135]
    v_exp_f32 v141, v141
    v_mov_b32 v34, v26
    v_mfma_f32_16x16x32_bf16 v[132:135], a[156:159], v[48:51], v[132:135]
    ds_read_b64_tr_b16 a[202:203], v10 offset:12288
    v_mov_b32 v35, v27
    v_mfma_f32_16x16x32_bf16 v[136:139], a[156:159], v[64:67], v[104:107]
    v_exp_f32 v142, v142
    v_mfma_f32_16x16x32_bf16 v[136:139], a[152:155], v[60:63], v[136:139]
    ds_read_b128 a[168:171], v3 offset:40960
    v_cvt_pk_bf16_f32 v230, v140, v141
    v_permlane32_swap_b32 v24, v32
    v_mfma_f32_16x16x32_bf16 v[136:139], a[148:151], v[56:59], v[136:139]
    v_exp_f32 v143, v143
    v_mfma_f32_16x16x32_bf16 v[136:139], a[144:147], v[52:55], v[136:139]
    ds_read_b64_tr_b16 a[204:205], v10 offset:32768
    v_permlane32_swap_b32 v25, v33
    v_mfma_f32_16x16x32_bf16 a[48:51], a[216:219], v[180:183], a[48:51]
    v_exp_f32 v144, v144
    v_permlane32_swap_b32 v26, v34
    v_mfma_f32_16x16x32_bf16 a[48:51], a[220:223], v[184:187], a[48:51]
    ds_read_b64_tr_b16 a[206:207], v10 offset:36864
    v_cvt_pk_bf16_f32 v231, v142, v143
    v_mfma_f32_16x16x32_bf16 a[52:55], a[220:223], v[192:195], a[52:55]
    v_exp_f32 v145, v145
    v_permlane32_swap_b32 v27, v35
    v_mfma_f32_16x16x32_bf16 a[52:55], a[216:219], v[188:191], a[52:55]
    ds_read_b128 a[172:175], v4 offset:40960
    v_mul_f32 v28, 0xbfb8aa3b, v24
    v_mfma_f32_16x16x32_bf16 a[56:59], a[216:219], v[196:199], a[56:59]
    v_exp_f32 v146, v146
    v_mfma_f32_16x16x32_bf16 a[56:59], a[220:223], v[200:203], a[56:59]
    v_cvt_pk_bf16_f32 v238, v144, v145
    v_mul_f32 v29, 0xbfb8aa3b, v25
    v_mfma_f32_16x16x32_bf16 a[60:63], a[220:223], v[208:211], a[60:63]
    v_exp_f32 v147, v147
    v_mfma_f32_16x16x32_bf16 a[60:63], a[216:219], v[204:207], a[60:63]
    buffer_load_dwordx4 v18, s[12:15], s29 offen offset:1024 lds
    v_mul_f32 v30, 0xbfb8aa3b, v26
    v_smfmac_f32_16x16x64_bf16 a[228:231], v[244:247], v[188:195], v248
    s_waitcnt lgkmcnt(6)
    v_mul_f32 v31, 0xbfb8aa3b, v27
    v_mfma_f32_16x16x32_bf16 v[140:143], a[144:147], v[68:71], v[108:111]
    v_exp_f32 v148, v148
    v_mfma_f32_16x16x32_bf16 v[140:143], a[148:151], v[72:75], v[140:143]
    ds_read_b64_tr_b16 a[208:209], v11 offset:8192
    v_cvt_pk_bf16_f32 v239, v146, v147
    v_exp_f32 v28, v28
    v_mfma_f32_16x16x32_bf16 v[140:143], a[152:155], v[76:79], v[140:143]
    v_exp_f32 v149, v149
    v_mfma_f32_16x16x32_bf16 v[140:143], a[156:159], v[80:83], v[140:143]
    ds_read_b64_tr_b16 a[210:211], v11 offset:12288
    v_exp_f32 v29, v29
    v_mfma_f32_16x16x32_bf16 v[144:147], a[156:159], v[96:99], v[112:115]
    v_exp_f32 v150, v150
    v_exp_f32 v30, v30
    v_mfma_f32_16x16x32_bf16 v[144:147], a[152:155], v[92:95], v[144:147]
    ds_read_b128 a[176:179], v1 offset:45056
    v_cvt_pk_bf16_f32 v216, v148, v149
    v_mfma_f32_16x16x32_bf16 v[144:147], a[148:151], v[88:91], v[144:147]
    v_exp_f32 v151, v151
    v_exp_f32 v31, v31
    v_mfma_f32_16x16x32_bf16 v[144:147], a[144:147], v[84:87], v[144:147]
    ds_read_b64_tr_b16 a[212:213], v11 offset:32768
    v_add_f32 v28, 1.0, v28
    v_mfma_f32_16x16x32_bf16 a[64:67], a[192:195], v[180:183], a[64:67]
    v_exp_f32 v152, v152
    v_mfma_f32_16x16x32_bf16 a[64:67], a[196:199], v[184:187], a[64:67]
    ds_read_b64_tr_b16 a[214:215], v11 offset:36864
    v_cvt_pk_bf16_f32 v217, v150, v151
    v_add_f32 v29, 1.0, v29
    v_mfma_f32_16x16x32_bf16 a[68:71], a[196:199], v[192:195], a[68:71]
    v_exp_f32 v153, v153
    v_add_f32 v30, 1.0, v30
    v_mfma_f32_16x16x32_bf16 a[68:71], a[192:195], v[188:191], a[68:71]
    ds_read_b128 a[180:183], v2 offset:45056
    v_cvt_pk_bf16_f32 v224, v152, v153
    v_mfma_f32_16x16x32_bf16 a[72:75], a[192:195], v[196:199], a[72:75]
    v_exp_f32 v154, v154
    v_add_f32 v31, 1.0, v31
    v_mfma_f32_16x16x32_bf16 a[72:75], a[196:199], v[200:203], a[72:75]
    buffer_load_dwordx4 v17, s[12:15], s29 offen offset:2048 lds
    v_rcp_f32 v28, v28
    v_mfma_f32_16x16x32_bf16 a[76:79], a[196:199], v[208:211], a[76:79]
    v_exp_f32 v155, v155
    v_mfma_f32_16x16x32_bf16 a[76:79], a[192:195], v[204:207], a[76:79]
    s_waitcnt lgkmcnt(6)
    v_rcp_f32 v29, v29
    v_mfma_f32_16x16x32_bf16 v[148:151], a[160:163], v[36:39], v[100:103]
    v_exp_f32 v156, v156
    v_rcp_f32 v30, v30
    v_mfma_f32_16x16x32_bf16 v[148:151], a[164:167], v[40:43], v[148:151]
    ds_read_b64_tr_b16 a[216:217], v12 offset:8192
    v_cvt_pk_bf16_f32 v225, v154, v155
    v_mfma_f32_16x16x32_bf16 v[148:151], a[168:171], v[44:47], v[148:151]
    v_exp_f32 v157, v157
    v_rcp_f32 v31, v31
    v_mfma_f32_16x16x32_bf16 v[148:151], a[172:175], v[48:51], v[148:151]
    ds_read_b64_tr_b16 a[218:219], v12 offset:12288
    v_mul_f32 v24, v24, v28
    v_mfma_f32_16x16x32_bf16 v[152:155], a[172:175], v[64:67], v[104:107]
    v_exp_f32 v158, v158
    v_mfma_f32_16x16x32_bf16 v[152:155], a[168:171], v[60:63], v[152:155]
    ds_read_b128 a[184:187], v3 offset:45056
    v_cvt_pk_bf16_f32 v232, v156, v157
    v_mul_f32 v25, v25, v29
    v_mfma_f32_16x16x32_bf16 v[152:155], a[164:167], v[56:59], v[152:155]
    v_exp_f32 v159, v159
    v_mfma_f32_16x16x32_bf16 v[152:155], a[160:163], v[52:55], v[152:155]
    ds_read_b64_tr_b16 a[220:221], v12 offset:32768
    v_mul_f32 v26, v26, v30
    v_mfma_f32_16x16x32_bf16 a[80:83], a[200:203], v[180:183], a[80:83]
    v_exp_f32 v160, v160
    v_mul_f32 v27, v27, v31
    v_mfma_f32_16x16x32_bf16 a[80:83], a[204:207], v[184:187], a[80:83]
    ds_read_b64_tr_b16 a[222:223], v12 offset:36864
    v_cvt_pk_bf16_f32 v233, v158, v159
    v_mfma_f32_16x16x32_bf16 a[84:87], a[204:207], v[192:195], a[84:87]
    v_exp_f32 v161, v161
    v_cvt_pk_bf16_f32 v28, v24, v25
    v_mfma_f32_16x16x32_bf16 a[84:87], a[200:203], v[188:191], a[84:87]
    ds_read_b128 a[188:191], v4 offset:45056
    v_cvt_pk_bf16_f32 v29, v26, v27
    v_mfma_f32_16x16x32_bf16 a[88:91], a[200:203], v[196:199], a[88:91]
    v_exp_f32 v162, v162
    v_mfma_f32_16x16x32_bf16 a[88:91], a[204:207], v[200:203], a[88:91]
    v_cvt_pk_bf16_f32 v240, v160, v161
    v_lshlrev_b32 v24, 16, v28
    v_mfma_f32_16x16x32_bf16 a[92:95], a[204:207], v[208:211], a[92:95]
    v_exp_f32 v163, v163
    v_mfma_f32_16x16x32_bf16 a[92:95], a[200:203], v[204:207], a[92:95]
    buffer_load_dwordx4 v18, s[12:15], s29 offen offset:3072 lds
    v_and_b32 v25, 0xffff0000, v28
    v_smfmac_f32_16x16x64_bf16 a[232:235], v[244:247], v[196:203], v248
    s_waitcnt vmcnt(8) lgkmcnt(6)
    s_barrier
    s_add_u32 s29, s29, 16384
    v_lshlrev_b32 v26, 16, v29
    v_and_b32 v27, 0xffff0000, v29
    v_mfma_f32_16x16x32_bf16 v[156:159], a[160:163], v[68:71], v[108:111]
    v_exp_f32 v164, v164
    v_mfma_f32_16x16x32_bf16 v[156:159], a[164:167], v[72:75], v[156:159]
    ds_read_b64_tr_b16 a[192:193], v5 offset:16384
    v_cvt_pk_bf16_f32 v241, v162, v163
    v_mfma_f32_16x16x32_bf16 v[156:159], a[168:171], v[76:79], v[156:159]
    v_exp_f32 v165, v165
    v_mfma_f32_16x16x32_bf16 v[156:159], a[172:175], v[80:83], v[156:159]
    ds_read_b64_tr_b16 a[194:195], v5 offset:20480
    v_mul_f32 v24, v24, v32
    v_mfma_f32_16x16x32_bf16 v[160:163], a[172:175], v[96:99], v[112:115]
    v_exp_f32 v166, v166
    v_mul_f32 v25, v25, v33
    v_mfma_f32_16x16x32_bf16 v[160:163], a[168:171], v[92:95], v[160:163]
    ds_read_b128 a[128:131], v1 offset:0
    v_cvt_pk_bf16_f32 v218, v164, v165
    v_mfma_f32_16x16x32_bf16 v[160:163], a[164:167], v[88:91], v[160:163]
    v_exp_f32 v167, v167
    v_mul_f32 v26, v26, v34
    v_mfma_f32_16x16x32_bf16 v[160:163], a[160:163], v[84:87], v[160:163]
    ds_read_b64_tr_b16 a[196:197], v5 offset:40960
    v_mul_f32 v27, v27, v35
    v_mfma_f32_16x16x32_bf16 a[96:99], a[208:211], v[180:183], a[96:99]
    v_exp_f32 v168, v168
    v_mfma_f32_16x16x32_bf16 a[96:99], a[212:215], v[184:187], a[96:99]
    ds_read_b64_tr_b16 a[198:199], v5 offset:45056
    v_cvt_pk_bf16_f32 v219, v166, v167
    v_cmp_gt_u32 vcc, 32, v19
    v_mfma_f32_16x16x32_bf16 a[100:103], a[212:215], v[192:195], a[100:103]
    v_exp_f32 v169, v169
    v_cvt_pk_bf16_f32 v252, v24, v25
    v_mfma_f32_16x16x32_bf16 a[100:103], a[208:211], v[188:191], a[100:103]
    ds_read_b128 a[132:135], v2 offset:0
    v_cvt_pk_bf16_f32 v226, v168, v169
    v_mfma_f32_16x16x32_bf16 a[104:107], a[208:211], v[196:199], a[104:107]
    s_add_u32 m0, s34, 16384
    v_exp_f32 v170, v170
    v_cvt_pk_bf16_f32 v253, v26, v27
    v_mfma_f32_16x16x32_bf16 a[104:107], a[212:215], v[200:203], a[104:107]
    buffer_load_dwordx4 v13, s[8:11], s28 offen offset:0 lds
    v_cndmask_b32 v252, 0, v252, vcc
    v_mfma_f32_16x16x32_bf16 a[108:111], a[212:215], v[208:211], a[108:111]
    v_exp_f32 v171, v171
    v_mfma_f32_16x16x32_bf16 a[108:111], a[208:211], v[204:207], a[108:111]
    s_waitcnt lgkmcnt(6)
    v_cndmask_b32 v253, 0, v253, vcc
    v_and_b32 v23, 7, v19
    v_mfma_f32_16x16x32_bf16 v[164:167], a[176:179], v[36:39], v[100:103]
    v_exp_f32 v172, v172
    v_mfma_f32_16x16x32_bf16 v[164:167], a[180:183], v[40:43], v[164:167]
    ds_read_b64_tr_b16 a[200:201], v6 offset:16384
    v_cvt_pk_bf16_f32 v227, v170, v171
    v_mfma_f32_16x16x32_bf16 v[164:167], a[184:187], v[44:47], v[164:167]
    v_exp_f32 v173, v173
    v_mul_u32_u24 v23, 34560, v23
    v_mfma_f32_16x16x32_bf16 v[164:167], a[188:191], v[48:51], v[164:167]
    ds_read_b64_tr_b16 a[202:203], v6 offset:20480
    v_lshrrev_b32 v0, 4, v19
    v_mfma_f32_16x16x32_bf16 v[168:171], a[188:191], v[64:67], v[104:107]
    v_exp_f32 v174, v174
    v_mfma_f32_16x16x32_bf16 v[168:171], a[184:187], v[60:63], v[168:171]
    ds_read_b128 a[136:139], v3 offset:0
    v_cvt_pk_bf16_f32 v234, v172, v173
    v_add_u32 v23, v23, v0
    v_mfma_f32_16x16x32_bf16 v[168:171], a[180:183], v[56:59], v[168:171]
    v_exp_f32 v175, v175
    v_mfma_f32_16x16x32_bf16 v[168:171], a[176:179], v[52:55], v[168:171]
    ds_read_b64_tr_b16 a[204:205], v6 offset:40960
    v_and_b32 v0, 8, v19
    v_mfma_f32_16x16x32_bf16 a[112:115], a[216:219], v[180:183], a[112:115]
    v_exp_f32 v176, v176
    v_lshrrev_b32 v0, 1, v0
    v_mfma_f32_16x16x32_bf16 a[112:115], a[220:223], v[184:187], a[112:115]
    ds_read_b64_tr_b16 a[206:207], v6 offset:45056
    v_cvt_pk_bf16_f32 v235, v174, v175
    v_mfma_f32_16x16x32_bf16 a[116:119], a[220:223], v[192:195], a[116:119]
    v_exp_f32 v177, v177
    v_add_lshl_u32 v23, v23, v0, 4
    v_mfma_f32_16x16x32_bf16 a[116:119], a[216:219], v[188:191], a[116:119]
    s_mul_i32 s42, s5, 1080
    ds_read_b128 a[140:143], v4 offset:0
    v_mfma_f32_16x16x32_bf16 a[120:123], a[216:219], v[196:199], a[120:123]
    s_add_u32 s42, s42, s6
    v_exp_f32 v178, v178
    v_mfma_f32_16x16x32_bf16 a[120:123], a[220:223], v[200:203], a[120:123]
    s_lshl_b32 s42, s42, 7
    v_cvt_pk_bf16_f32 v242, v176, v177
    v_mfma_f32_16x16x32_bf16 a[124:127], a[220:223], v[208:211], a[124:127]
    s_cmp_lt_u32 s6, 216
    s_cselect_b32 s42, s42, 0x438000
    v_exp_f32 v179, v179
    v_mfma_f32_16x16x32_bf16 a[124:127], a[216:219], v[204:207], a[124:127]
    buffer_load_dwordx4 v14, s[8:11], s28 offen offset:1024 lds
    v_smfmac_f32_16x16x64_bf16 a[236:239], v[244:247], v[204:211], v248
    s_waitcnt lgkmcnt(6)
    v_mfma_f32_16x16x32_bf16 v[172:175], a[176:179], v[68:71], v[108:111]
    v_exp_f32 v116, v116
    v_mfma_f32_16x16x16_bf16 v[24:27], a[240:241], v[252:253], 0
    v_mfma_f32_16x16x16_bf16 v[28:31], a[242:243], v[252:253], 0
    v_mfma_f32_16x16x32_bf16 v[172:175], a[180:183], v[72:75], v[172:175]
    ds_read_b64_tr_b16 a[208:209], v7 offset:16384
    v_cvt_pk_bf16_f32 v243, v178, v179
    v_mfma_f32_16x16x32_bf16 v[172:175], a[184:187], v[76:79], v[172:175]
    v_exp_f32 v117, v117
    v_mfma_f32_16x16x32_bf16 v[172:175], a[188:191], v[80:83], v[172:175]
    ds_read_b64_tr_b16 a[210:211], v7 offset:20480
    v_mfma_f32_16x16x32_bf16 v[176:179], a[188:191], v[96:99], v[112:115]
    v_exp_f32 v118, v118
    v_mfma_f32_16x16x32_bf16 v[176:179], a[184:187], v[92:95], v[176:179]
    ds_read_b128 a[144:147], v1 offset:4096
    v_cvt_pk_bf16_f32 v180, v116, v117
    v_mfma_f32_16x16x32_bf16 v[176:179], a[180:183], v[88:91], v[176:179]
    v_exp_f32 v119, v119
    v_mfma_f32_16x16x32_bf16 v[176:179], a[176:179], v[84:87], v[176:179]
    ds_read_b64_tr_b16 a[212:213], v7 offset:40960
    v_mov_b32_dpp v24, v28 row_shr:8 row_mask:0xf bank_mask:0xc
    v_mfma_f32_16x16x32_bf16 a[0:3], a[192:195], v[212:215], a[0:3]
    v_exp_f32 v120, v120
    v_mfma_f32_16x16x32_bf16 a[0:3], a[196:199], v[216:219], a[0:3]
    ds_read_b64_tr_b16 a[214:215], v7 offset:45056
    v_cvt_pk_bf16_f32 v181, v118, v119
    v_mov_b32_dpp v25, v29 row_shr:8 row_mask:0xf bank_mask:0xc
    v_mfma_f32_16x16x32_bf16 a[4:7], a[196:199], v[224:227], a[4:7]
    v_exp_f32 v121, v121
    v_mov_b32_dpp v26, v30 row_shr:8 row_mask:0xf bank_mask:0xc
    v_mfma_f32_16x16x32_bf16 a[4:7], a[192:195], v[220:223], a[4:7]
    ds_read_b128 a[148:151], v2 offset:4096
    v_cvt_pk_bf16_f32 v188, v120, v121
    v_mov_b32_dpp v27, v31 row_shr:8 row_mask:0xf bank_mask:0xc
    v_mfma_f32_16x16x32_bf16 a[8:11], a[192:195], v[228:231], a[8:11]
    buffer_store_dwordx4 v[24:27], v23, s[16:19], s42 offen sc1
    v_exp_f32 v122, v122
    v_mfma_f32_16x16x32_bf16 a[8:11], a[196:199], v[232:235], a[8:11]
    s_add_u32 s42, s42, 27648
    buffer_load_dwordx4 v15, s[8:11], s28 offen offset:2048 lds
    v_mfma_f32_16x16x32_bf16 a[12:15], a[196:199], v[240:243], a[12:15]
    v_exp_f32 v123, v123
    v_mfma_f32_16x16x32_bf16 a[12:15], a[192:195], v[236:239], a[12:15]
    s_waitcnt lgkmcnt(6)
    ds_read_b64_tr_b16 a[240:241], v22 offset:256
    ds_read_b64_tr_b16 a[242:243], v22 offset:288
    v_mfma_f32_16x16x32_bf16 v[116:119], a[128:131], v[36:39], v[100:103]
    v_exp_f32 v124, v124
    v_mfma_f32_16x16x16_bf16 v[32:35], a[244:245], v[252:253], 0
    v_mfma_f32_16x16x16_bf16 v[28:31], a[246:247], v[252:253], 0
    v_mfma_f32_16x16x32_bf16 v[116:119], a[132:135], v[40:43], v[116:119]
    ds_read_b64_tr_b16 a[216:217], v8 offset:16384
    v_cvt_pk_bf16_f32 v189, v122, v123
    v_mfma_f32_16x16x32_bf16 v[116:119], a[136:139], v[44:47], v[116:119]
    v_exp_f32 v125, v125
    v_mfma_f32_16x16x32_bf16 v[116:119], a[140:143], v[48:51], v[116:119]
    ds_read_b64_tr_b16 a[218:219], v8 offset:20480
    v_mfma_f32_16x16x32_bf16 v[120:123], a[140:143], v[64:67], v[104:107]
    v_exp_f32 v126, v126
    v_mfma_f32_16x16x32_bf16 v[120:123], a[136:139], v[60:63], v[120:123]
    ds_read_b128 a[152:155], v3 offset:4096
    v_cvt_pk_bf16_f32 v196, v124, v125
    v_mfma_f32_16x16x32_bf16 v[120:123], a[132:135], v[56:59], v[120:123]
    v_exp_f32 v127, v127
    v_mfma_f32_16x16x32_bf16 v[120:123], a[128:131], v[52:55], v[120:123]
    ds_read_b64_tr_b16 a[220:221], v8 offset:40960
    v_mov_b32_dpp v32, v28 row_shr:8 row_mask:0xf bank_mask:0xc
    v_mfma_f32_16x16x32_bf16 a[16:19], a[200:203], v[212:215], a[16:19]
    v_exp_f32 v128, v128
    v_mfma_f32_16x16x32_bf16 a[16:19], a[204:207], v[216:219], a[16:19]
    ds_read_b64_tr_b16 a[222:223], v8 offset:45056
    v_cvt_pk_bf16_f32 v197, v126, v127
    v_mfma_f32_16x16x32_bf16 a[20:23], a[204:207], v[224:227], a[20:23]
    v_exp_f32 v129, v129
    v_mfma_f32_16x16x32_bf16 a[20:23], a[200:203], v[220:223], a[20:23]
    ds_read_b128 a[156:159], v4 offset:4096
    v_mov_b32_dpp v33, v29 row_shr:8 row_mask:0xf bank_mask:0xc
    v_mfma_f32_16x16x32_bf16 a[24:27], a[200:203], v[228:231], a[24:27]
    v_exp_f32 v130, v130
    v_mfma_f32_16x16x32_bf16 a[24:27], a[204:207], v[232:235], a[24:27]
    v_cvt_pk_bf16_f32 v204, v128, v129
    v_mov_b32_dpp v34, v30 row_shr:8 row_mask:0xf bank_mask:0xc
    v_mfma_f32_16x16x32_bf16 a[28:31], a[204:207], v[240:243], a[28:31]
    v_exp_f32 v131, v131
    v_mov_b32_dpp v35, v31 row_shr:8 row_mask:0xf bank_mask:0xc
    v_mfma_f32_16x16x32_bf16 a[28:31], a[200:203], v[236:239], a[28:31]
    buffer_load_dwordx4 v16, s[8:11], s28 offen offset:3072 lds
    buffer_store_dwordx4 v[32:35], v23, s[16:19], s42 offen sc1
    v_smfmac_f32_16x16x64_bf16 a[224:227], v[244:247], v[212:219], v248
    s_waitcnt lgkmcnt(6)
    s_add_u32 s42, s42, 27648
    v_mfma_f32_16x16x32_bf16 v[124:127], a[128:131], v[68:71], v[108:111]
    v_exp_f32 v132, v132
    v_mfma_f32_16x16x16_bf16 v[24:27], a[248:249], v[252:253], 0
    v_mfma_f32_16x16x16_bf16 v[28:31], a[250:251], v[252:253], 0
    v_mfma_f32_16x16x32_bf16 v[124:127], a[132:135], v[72:75], v[124:127]
    ds_read_b64_tr_b16 a[192:193], v9 offset:16384
    v_cvt_pk_bf16_f32 v205, v130, v131
    v_mfma_f32_16x16x32_bf16 v[124:127], a[136:139], v[76:79], v[124:127]
    v_exp_f32 v133, v133
    v_mfma_f32_16x16x32_bf16 v[124:127], a[140:143], v[80:83], v[124:127]
    ds_read_b64_tr_b16 a[194:195], v9 offset:20480
    v_mfma_f32_16x16x32_bf16 v[128:131], a[140:143], v[96:99], v[112:115]
    v_exp_f32 v134, v134
    v_mfma_f32_16x16x32_bf16 v[128:131], a[136:139], v[92:95], v[128:131]
    ds_read_b128 a[160:163], v1 offset:8192
    v_cvt_pk_bf16_f32 v182, v132, v133
    v_mfma_f32_16x16x32_bf16 v[128:131], a[132:135], v[88:91], v[128:131]
    v_exp_f32 v135, v135
    v_mfma_f32_16x16x32_bf16 v[128:131], a[128:131], v[84:87], v[128:131]
    ds_read_b64_tr_b16 a[196:197], v9 offset:40960
    v_mov_b32_dpp v24, v28 row_shr:8 row_mask:0xf bank_mask:0xc
    v_mfma_f32_16x16x32_bf16 a[32:35], a[208:211], v[212:215], a[32:35]
    v_exp_f32 v136, v136
    v_mfma_f32_16x16x32_bf16 a[32:35], a[212:215], v[216:219], a[32:35]
    ds_read_b64_tr_b16 a[198:199], v9 offset:45056
    v_cvt_pk_bf16_f32 v183, v134, v135
    v_mfma_f32_16x16x32_bf16 a[36:39], a[212:215], v[224:227], a[36:39]
    v_exp_f32 v137, v137
    v_mfma_f32_16x16x32_bf16 a[36:39], a[208:211], v[220:223], a[36:39]
    ds_read_b128 a[164:167], v2 offset:8192
    v_cvt_pk_bf16_f32 v190, v136, v137
    v_mov_b32_dpp v25, v29 row_shr:8 row_mask:0xf bank_mask:0xc
    v_mfma_f32_16x16x32_bf16 a[40:43], a[208:211], v[228:231], a[40:43]
    s_add_u32 s28, s28, 16384
    s_mov_b32 m0, s33
    v_exp_f32 v138, v138
    v_mov_b32_dpp v26, v30 row_shr:8 row_mask:0xf bank_mask:0xc
    v_mfma_f32_16x16x32_bf16 a[40:43], a[212:215], v[232:235], a[40:43]
    buffer_load_dwordx4 v17, s[12:15], s29 offen offset:0 lds
    v_mov_b32_dpp v27, v31 row_shr:8 row_mask:0xf bank_mask:0xc
    v_mfma_f32_16x16x32_bf16 a[44:47], a[212:215], v[240:243], a[44:47]
    buffer_store_dwordx4 v[24:27], v23, s[16:19], s42 offen sc1
    v_exp_f32 v139, v139
    v_mfma_f32_16x16x32_bf16 a[44:47], a[208:211], v[236:239], a[44:47]
    s_waitcnt lgkmcnt(6)
    s_add_u32 s42, s42, 27648
    v_mfma_f32_16x16x32_bf16 v[132:135], a[144:147], v[36:39], v[100:103]
    v_exp_f32 v140, v140
    v_mfma_f32_16x16x16_bf16 v[32:35], a[252:253], v[252:253], 0
    v_mfma_f32_16x16x16_bf16 v[28:31], a[254:255], v[252:253], 0
    v_mfma_f32_16x16x32_bf16 v[132:135], a[148:151], v[40:43], v[132:135]
    ds_read_b64_tr_b16 a[200:201], v10 offset:16384
    v_cvt_pk_bf16_f32 v191, v138, v139
    v_mfma_f32_16x16x32_bf16 v[132:135], a[152:155], v[44:47], v[132:135]
    v_exp_f32 v141, v141
    v_mfma_f32_16x16x32_bf16 v[132:135], a[156:159], v[48:51], v[132:135]
    ds_read_b64_tr_b16 a[202:203], v10 offset:20480
    v_mfma_f32_16x16x32_bf16 v[136:139], a[156:159], v[64:67], v[104:107]
    v_exp_f32 v142, v142
    v_mfma_f32_16x16x32_bf16 v[136:139], a[152:155], v[60:63], v[136:139]
    ds_read_b128 a[168:171], v3 offset:8192
    v_cvt_pk_bf16_f32 v198, v140, v141
    v_mfma_f32_16x16x32_bf16 v[136:139], a[148:151], v[56:59], v[136:139]
    v_exp_f32 v143, v143
    v_mfma_f32_16x16x32_bf16 v[136:139], a[144:147], v[52:55], v[136:139]
    ds_read_b64_tr_b16 a[204:205], v10 offset:40960
    v_mov_b32_dpp v32, v28 row_shr:8 row_mask:0xf bank_mask:0xc
    v_mfma_f32_16x16x32_bf16 a[48:51], a[216:219], v[212:215], a[48:51]
    v_exp_f32 v144, v144
    v_mfma_f32_16x16x32_bf16 a[48:51], a[220:223], v[216:219], a[48:51]
    ds_read_b64_tr_b16 a[206:207], v10 offset:45056
    v_cvt_pk_bf16_f32 v199, v142, v143
    v_mfma_f32_16x16x32_bf16 a[52:55], a[220:223], v[224:227], a[52:55]
    v_exp_f32 v145, v145
    v_mfma_f32_16x16x32_bf16 a[52:55], a[216:219], v[220:223], a[52:55]
    ds_read_b128 a[172:175], v4 offset:8192
    v_mov_b32_dpp v33, v29 row_shr:8 row_mask:0xf bank_mask:0xc
    v_mfma_f32_16x16x32_bf16 a[56:59], a[216:219], v[228:231], a[56:59]
    v_exp_f32 v146, v146
    v_mfma_f32_16x16x32_bf16 a[56:59], a[220:223], v[232:235], a[56:59]
    v_cvt_pk_bf16_f32 v206, v144, v145
    v_mov_b32_dpp v34, v30 row_shr:8 row_mask:0xf bank_mask:0xc
    v_mfma_f32_16x16x32_bf16 a[60:63], a[220:223], v[240:243], a[60:63]
    v_exp_f32 v147, v147
    v_mov_b32_dpp v35, v31 row_shr:8 row_mask:0xf bank_mask:0xc
    v_mfma_f32_16x16x32_bf16 a[60:63], a[216:219], v[236:239], a[60:63]
    buffer_load_dwordx4 v18, s[12:15], s29 offen offset:1024 lds
    buffer_store_dwordx4 v[32:35], v23, s[16:19], s42 offen sc1
    v_smfmac_f32_16x16x64_bf16 a[228:231], v[244:247], v[220:227], v248
    s_waitcnt lgkmcnt(6)
    s_add_u32 s42, s42, 27648
    v_mfma_f32_16x16x32_bf16 v[140:143], a[144:147], v[68:71], v[108:111]
    v_exp_f32 v148, v148
    v_mfma_f32_16x16x16_bf16 v[24:27], a[240:241], v[252:253], 0
    v_mfma_f32_16x16x16_bf16 v[28:31], a[242:243], v[252:253], 0
    v_mfma_f32_16x16x32_bf16 v[140:143], a[148:151], v[72:75], v[140:143]
    ds_read_b64_tr_b16 a[208:209], v11 offset:16384
    v_cvt_pk_bf16_f32 v207, v146, v147
    v_mfma_f32_16x16x32_bf16 v[140:143], a[152:155], v[76:79], v[140:143]
    v_exp_f32 v149, v149
    v_mfma_f32_16x16x32_bf16 v[140:143], a[156:159], v[80:83], v[140:143]
    ds_read_b64_tr_b16 a[210:211], v11 offset:20480
    v_mfma_f32_16x16x32_bf16 v[144:147], a[156:159], v[96:99], v[112:115]
    v_exp_f32 v150, v150
    v_mfma_f32_16x16x32_bf16 v[144:147], a[152:155], v[92:95], v[144:147]
    ds_read_b128 a[176:179], v1 offset:12288
    v_cvt_pk_bf16_f32 v184, v148, v149
    v_mfma_f32_16x16x32_bf16 v[144:147], a[148:151], v[88:91], v[144:147]
    v_exp_f32 v151, v151
    v_mfma_f32_16x16x32_bf16 v[144:147], a[144:147], v[84:87], v[144:147]
    ds_read_b64_tr_b16 a[212:213], v11 offset:40960
    v_mov_b32_dpp v24, v28 row_shr:8 row_mask:0xf bank_mask:0xc
    v_mfma_f32_16x16x32_bf16 a[64:67], a[192:195], v[212:215], a[64:67]
    v_exp_f32 v152, v152
    v_mfma_f32_16x16x32_bf16 a[64:67], a[196:199], v[216:219], a[64:67]
    ds_read_b64_tr_b16 a[214:215], v11 offset:45056
    v_cvt_pk_bf16_f32 v185, v150, v151
    v_mfma_f32_16x16x32_bf16 a[68:71], a[196:199], v[224:227], a[68:71]
    v_exp_f32 v153, v153
    v_mfma_f32_16x16x32_bf16 a[68:71], a[192:195], v[220:223], a[68:71]
    ds_read_b128 a[180:183], v2 offset:12288
    v_cvt_pk_bf16_f32 v192, v152, v153
    v_mov_b32_dpp v25, v29 row_shr:8 row_mask:0xf bank_mask:0xc
    v_mfma_f32_16x16x32_bf16 a[72:75], a[192:195], v[228:231], a[72:75]
    v_exp_f32 v154, v154
    v_mov_b32_dpp v26, v30 row_shr:8 row_mask:0xf bank_mask:0xc
    v_mfma_f32_16x16x32_bf16 a[72:75], a[196:199], v[232:235], a[72:75]
    buffer_load_dwordx4 v17, s[12:15], s29 offen offset:2048 lds
    v_mov_b32_dpp v27, v31 row_shr:8 row_mask:0xf bank_mask:0xc
    v_mfma_f32_16x16x32_bf16 a[76:79], a[196:199], v[240:243], a[76:79]
    buffer_store_dwordx4 v[24:27], v23, s[16:19], s42 offen sc1
    v_exp_f32 v155, v155
    v_mfma_f32_16x16x32_bf16 a[76:79], a[192:195], v[236:239], a[76:79]
    s_waitcnt lgkmcnt(6)
    s_add_u32 s42, s42, 27648
    v_mfma_f32_16x16x32_bf16 v[148:151], a[160:163], v[36:39], v[100:103]
    v_exp_f32 v156, v156
    v_mfma_f32_16x16x32_bf16 v[148:151], a[164:167], v[40:43], v[148:151]
    ds_read_b64_tr_b16 a[216:217], v12 offset:16384
    v_cvt_pk_bf16_f32 v193, v154, v155
    v_mfma_f32_16x16x32_bf16 v[148:151], a[168:171], v[44:47], v[148:151]
    v_exp_f32 v157, v157
    v_mfma_f32_16x16x32_bf16 v[148:151], a[172:175], v[48:51], v[148:151]
    ds_read_b64_tr_b16 a[218:219], v12 offset:20480
    v_mfma_f32_16x16x32_bf16 v[152:155], a[172:175], v[64:67], v[104:107]
    v_exp_f32 v158, v158
    v_mfma_f32_16x16x32_bf16 v[152:155], a[168:171], v[60:63], v[152:155]
    ds_read_b128 a[184:187], v3 offset:12288
    v_cvt_pk_bf16_f32 v200, v156, v157
    v_mfma_f32_16x16x32_bf16 v[152:155], a[164:167], v[56:59], v[152:155]
    v_exp_f32 v159, v159
    v_mfma_f32_16x16x32_bf16 v[152:155], a[160:163], v[52:55], v[152:155]
    ds_read_b64_tr_b16 a[220:221], v12 offset:40960
    v_mfma_f32_16x16x32_bf16 a[80:83], a[200:203], v[212:215], a[80:83]
    v_exp_f32 v160, v160
    v_mfma_f32_16x16x32_bf16 a[80:83], a[204:207], v[216:219], a[80:83]
    ds_read_b64_tr_b16 a[222:223], v12 offset:45056
    v_cvt_pk_bf16_f32 v201, v158, v159
    v_mfma_f32_16x16x32_bf16 a[84:87], a[204:207], v[224:227], a[84:87]
    v_exp_f32 v161, v161
    v_mfma_f32_16x16x32_bf16 a[84:87], a[200:203], v[220:223], a[84:87]
    ds_read_b128 a[188:191], v4 offset:12288
    v_mfma_f32_16x16x32_bf16 a[88:91], a[200:203], v[228:231], a[88:91]
    v_exp_f32 v162, v162
    v_mfma_f32_16x16x32_bf16 a[88:91], a[204:207], v[232:235], a[88:91]
    v_cvt_pk_bf16_f32 v208, v160, v161
    v_mfma_f32_16x16x32_bf16 a[92:95], a[204:207], v[240:243], a[92:95]
    v_exp_f32 v163, v163
    v_mfma_f32_16x16x32_bf16 a[92:95], a[200:203], v[236:239], a[92:95]
    buffer_load_dwordx4 v18, s[12:15], s29 offen offset:3072 lds
    v_smfmac_f32_16x16x64_bf16 a[232:235], v[244:247], v[228:235], v248
    s_waitcnt vmcnt(13) lgkmcnt(6)
    s_barrier
    s_add_u32 s29, s29, 16384
    v_mfma_f32_16x16x32_bf16 v[156:159], a[160:163], v[68:71], v[108:111]
    v_exp_f32 v164, v164
    v_mfma_f32_16x16x32_bf16 v[156:159], a[164:167], v[72:75], v[156:159]
    ds_read_b64_tr_b16 a[192:193], v5 offset:57344
    v_cvt_pk_bf16_f32 v209, v162, v163
    v_mfma_f32_16x16x32_bf16 v[156:159], a[168:171], v[76:79], v[156:159]
    v_exp_f32 v165, v165
    v_mfma_f32_16x16x32_bf16 v[156:159], a[172:175], v[80:83], v[156:159]
    ds_read_b64_tr_b16 a[194:195], v5 offset:61440
    v_mfma_f32_16x16x32_bf16 v[160:163], a[172:175], v[96:99], v[112:115]
    v_exp_f32 v166, v166
    v_mfma_f32_16x16x32_bf16 v[160:163], a[168:171], v[92:95], v[160:163]
    ds_read_b128 a[128:131], v1 offset:49152
    v_cvt_pk_bf16_f32 v186, v164, v165
    v_mfma_f32_16x16x32_bf16 v[160:163], a[164:167], v[88:91], v[160:163]
    v_exp_f32 v167, v167
    v_mfma_f32_16x16x32_bf16 v[160:163], a[160:163], v[84:87], v[160:163]
    ds_read_b64_tr_b16 a[196:197], v5 offset:0
    v_mfma_f32_16x16x32_bf16 a[96:99], a[208:211], v[212:215], a[96:99]
    v_exp_f32 v168, v168
    v_mfma_f32_16x16x32_bf16 a[96:99], a[212:215], v[216:219], a[96:99]
    ds_read_b64_tr_b16 a[198:199], v5 offset:4096
    v_cvt_pk_bf16_f32 v187, v166, v167
    v_mfma_f32_16x16x32_bf16 a[100:103], a[212:215], v[224:227], a[100:103]
    v_exp_f32 v169, v169
    v_mfma_f32_16x16x32_bf16 a[100:103], a[208:211], v[220:223], a[100:103]
    ds_read_b128 a[132:135], v2 offset:49152
    v_cvt_pk_bf16_f32 v194, v168, v169
    v_mfma_f32_16x16x32_bf16 a[104:107], a[208:211], v[228:231], a[104:107]
    s_add_u32 m0, s34, 32768
    v_exp_f32 v170, v170
    v_mfma_f32_16x16x32_bf16 a[104:107], a[212:215], v[232:235], a[104:107]
    buffer_load_dwordx4 v13, s[8:11], s28 offen offset:0 lds
    v_mfma_f32_16x16x32_bf16 a[108:111], a[212:215], v[240:243], a[108:111]
    v_exp_f32 v171, v171
    v_mfma_f32_16x16x32_bf16 a[108:111], a[208:211], v[236:239], a[108:111]
    s_waitcnt lgkmcnt(6)
    v_mfma_f32_16x16x32_bf16 v[164:167], a[176:179], v[36:39], v[100:103]
    v_exp_f32 v172, v172
    v_mfma_f32_16x16x32_bf16 v[164:167], a[180:183], v[40:43], v[164:167]
    ds_read_b64_tr_b16 a[200:201], v6 offset:57344
    v_cvt_pk_bf16_f32 v195, v170, v171
    v_mfma_f32_16x16x32_bf16 v[164:167], a[184:187], v[44:47], v[164:167]
    v_exp_f32 v173, v173
    v_mfma_f32_16x16x32_bf16 v[164:167], a[188:191], v[48:51], v[164:167]
    ds_read_b64_tr_b16 a[202:203], v6 offset:61440
    v_mfma_f32_16x16x32_bf16 v[168:171], a[188:191], v[64:67], v[104:107]
    v_exp_f32 v174, v174
    v_mfma_f32_16x16x32_bf16 v[168:171], a[184:187], v[60:63], v[168:171]
    ds_read_b128 a[136:139], v3 offset:49152
    v_cvt_pk_bf16_f32 v202, v172, v173
    v_mfma_f32_16x16x32_bf16 v[168:171], a[180:183], v[56:59], v[168:171]
    v_exp_f32 v175, v175
    v_mfma_f32_16x16x32_bf16 v[168:171], a[176:179], v[52:55], v[168:171]
    ds_read_b64_tr_b16 a[204:205], v6 offset:0
    v_mfma_f32_16x16x32_bf16 a[112:115], a[216:219], v[212:215], a[112:115]
    v_exp_f32 v176, v176
    v_mfma_f32_16x16x32_bf16 a[112:115], a[220:223], v[216:219], a[112:115]
    ds_read_b64_tr_b16 a[206:207], v6 offset:4096
    v_cvt_pk_bf16_f32 v203, v174, v175
    v_mfma_f32_16x16x32_bf16 a[116:119], a[220:223], v[224:227], a[116:119]
    v_exp_f32 v177, v177
    v_mfma_f32_16x16x32_bf16 a[116:119], a[216:219], v[220:223], a[116:119]
    ds_read_b128 a[140:143], v4 offset:49152
    v_mfma_f32_16x16x32_bf16 a[120:123], a[216:219], v[228:231], a[120:123]
    v_exp_f32 v178, v178
    v_mfma_f32_16x16x32_bf16 a[120:123], a[220:223], v[232:235], a[120:123]
    v_cvt_pk_bf16_f32 v210, v176, v177
    v_mfma_f32_16x16x32_bf16 a[124:127], a[220:223], v[240:243], a[124:127]
    v_exp_f32 v179, v179
    v_mfma_f32_16x16x32_bf16 a[124:127], a[216:219], v[236:239], a[124:127]
    buffer_load_dwordx4 v14, s[8:11], s28 offen offset:1024 lds
    v_smfmac_f32_16x16x64_bf16 a[236:239], v[244:247], v[236:243], v248
    s_waitcnt lgkmcnt(6)
    v_mfma_f32_16x16x32_bf16 v[172:175], a[176:179], v[68:71], v[108:111]
    v_exp_f32 v116, v116
    v_mfma_f32_16x16x32_bf16 v[172:175], a[180:183], v[72:75], v[172:175]
    ds_read_b64_tr_b16 a[208:209], v7 offset:57344
    v_cvt_pk_bf16_f32 v211, v178, v179
    v_mfma_f32_16x16x32_bf16 v[172:175], a[184:187], v[76:79], v[172:175]
    v_exp_f32 v117, v117
    v_mfma_f32_16x16x32_bf16 v[172:175], a[188:191], v[80:83], v[172:175]
    ds_read_b64_tr_b16 a[210:211], v7 offset:61440
    v_mov_b32 v0, 1
    v_mfma_f32_16x16x32_bf16 v[176:179], a[188:191], v[96:99], v[112:115]
    v_exp_f32 v118, v118
    v_mfma_f32_16x16x32_bf16 v[176:179], a[184:187], v[92:95], v[176:179]
    ds_read_b128 a[144:147], v1 offset:53248
    v_cvt_pk_bf16_f32 v212, v116, v117
    v_mfma_f32_16x16x32_bf16 v[176:179], a[180:183], v[88:91], v[176:179]
    v_exp_f32 v119, v119
    v_mfma_f32_16x16x32_bf16 v[176:179], a[176:179], v[84:87], v[176:179]
    ds_read_b64_tr_b16 a[212:213], v7 offset:0
    v_mfma_f32_16x16x32_bf16 a[0:3], a[192:195], v[180:183], a[0:3]
    v_exp_f32 v120, v120
    v_mfma_f32_16x16x32_bf16 a[0:3], a[196:199], v[184:187], a[0:3]
    ds_read_b64_tr_b16 a[214:215], v7 offset:4096
    v_cvt_pk_bf16_f32 v213, v118, v119
    v_mfma_f32_16x16x32_bf16 a[4:7], a[196:199], v[192:195], a[4:7]
    v_exp_f32 v121, v121
    v_mfma_f32_16x16x32_bf16 a[4:7], a[192:195], v[188:191], a[4:7]
    ds_read_b128 a[148:151], v2 offset:53248
    v_cvt_pk_bf16_f32 v220, v120, v121
    v_mfma_f32_16x16x32_bf16 a[8:11], a[192:195], v[196:199], a[8:11]
    v_exp_f32 v122, v122
    v_mfma_f32_16x16x32_bf16 a[8:11], a[196:199], v[200:203], a[8:11]
    buffer_load_dwordx4 v15, s[8:11], s28 offen offset:2048 lds
    v_mfma_f32_16x16x32_bf16 a[12:15], a[196:199], v[208:211], a[12:15]
    v_exp_f32 v123, v123
    v_mfma_f32_16x16x32_bf16 a[12:15], a[192:195], v[204:207], a[12:15]
    s_waitcnt lgkmcnt(6)
    v_mfma_f32_16x16x32_bf16 v[116:119], a[128:131], v[36:39], v[100:103]
    v_exp_f32 v124, v124
    v_mfma_f32_16x16x32_bf16 v[116:119], a[132:135], v[40:43], v[116:119]
    ds_read_b64_tr_b16 a[216:217], v8 offset:57344
    v_cvt_pk_bf16_f32 v221, v122, v123
    v_mfma_f32_16x16x32_bf16 v[116:119], a[136:139], v[44:47], v[116:119]
    v_exp_f32 v125, v125
    v_mfma_f32_16x16x32_bf16 v[116:119], a[140:143], v[48:51], v[116:119]
    ds_read_b64_tr_b16 a[218:219], v8 offset:61440
    v_mfma_f32_16x16x32_bf16 v[120:123], a[140:143], v[64:67], v[104:107]
    v_exp_f32 v126, v126
    v_mfma_f32_16x16x32_bf16 v[120:123], a[136:139], v[60:63], v[120:123]
    ds_read_b128 a[152:155], v3 offset:53248
    v_cvt_pk_bf16_f32 v228, v124, v125
    v_mfma_f32_16x16x32_bf16 v[120:123], a[132:135], v[56:59], v[120:123]
    v_exp_f32 v127, v127
    v_mfma_f32_16x16x32_bf16 v[120:123], a[128:131], v[52:55], v[120:123]
    ds_read_b64_tr_b16 a[220:221], v8 offset:0
    v_mfma_f32_16x16x32_bf16 a[16:19], a[200:203], v[180:183], a[16:19]
    v_exp_f32 v128, v128
    v_mfma_f32_16x16x32_bf16 a[16:19], a[204:207], v[184:187], a[16:19]
    ds_read_b64_tr_b16 a[222:223], v8 offset:4096
    v_cvt_pk_bf16_f32 v229, v126, v127
    v_mfma_f32_16x16x32_bf16 a[20:23], a[204:207], v[192:195], a[20:23]
    v_exp_f32 v129, v129
    v_mfma_f32_16x16x32_bf16 a[20:23], a[200:203], v[188:191], a[20:23]
    ds_read_b128 a[156:159], v4 offset:53248
    v_mfma_f32_16x16x32_bf16 a[24:27], a[200:203], v[196:199], a[24:27]
    v_exp_f32 v130, v130
    v_mfma_f32_16x16x32_bf16 a[24:27], a[204:207], v[200:203], a[24:27]
    v_cvt_pk_bf16_f32 v236, v128, v129
    v_mfma_f32_16x16x32_bf16 a[28:31], a[204:207], v[208:211], a[28:31]
    v_exp_f32 v131, v131
    v_mfma_f32_16x16x32_bf16 a[28:31], a[200:203], v[204:207], a[28:31]
    buffer_load_dwordx4 v16, s[8:11], s28 offen offset:3072 lds
    v_smfmac_f32_16x16x64_bf16 a[224:227], v[244:247], v[180:187], v248
    s_waitcnt lgkmcnt(6)
    v_mfma_f32_16x16x32_bf16 v[124:127], a[128:131], v[68:71], v[108:111]
    v_exp_f32 v132, v132
    v_mfma_f32_16x16x32_bf16 v[124:127], a[132:135], v[72:75], v[124:127]
    ds_read_b64_tr_b16 a[192:193], v9 offset:57344
    v_cvt_pk_bf16_f32 v237, v130, v131
    v_mfma_f32_16x16x32_bf16 v[124:127], a[136:139], v[76:79], v[124:127]
    v_exp_f32 v133, v133
    v_mfma_f32_16x16x32_bf16 v[124:127], a[140:143], v[80:83], v[124:127]
    ds_read_b64_tr_b16 a[194:195], v9 offset:61440
    v_mfma_f32_16x16x32_bf16 v[128:131], a[140:143], v[96:99], v[112:115]
    v_exp_f32 v134, v134
    v_mfma_f32_16x16x32_bf16 v[128:131], a[136:139], v[92:95], v[128:131]
    ds_read_b128 a[160:163], v1 offset:57344
    v_cvt_pk_bf16_f32 v214, v132, v133
    v_mfma_f32_16x16x32_bf16 v[128:131], a[132:135], v[88:91], v[128:131]
    v_exp_f32 v135, v135
    v_mfma_f32_16x16x32_bf16 v[128:131], a[128:131], v[84:87], v[128:131]
    ds_read_b64_tr_b16 a[196:197], v9 offset:0
    v_mfma_f32_16x16x32_bf16 a[32:35], a[208:211], v[180:183], a[32:35]
    v_exp_f32 v136, v136
    v_mfma_f32_16x16x32_bf16 a[32:35], a[212:215], v[184:187], a[32:35]
    ds_read_b64_tr_b16 a[198:199], v9 offset:4096
    v_cvt_pk_bf16_f32 v215, v134, v135
    v_mfma_f32_16x16x32_bf16 a[36:39], a[212:215], v[192:195], a[36:39]
    v_exp_f32 v137, v137
    v_mfma_f32_16x16x32_bf16 a[36:39], a[208:211], v[188:191], a[36:39]
    ds_read_b128 a[164:167], v2 offset:57344
    v_cvt_pk_bf16_f32 v222, v136, v137
    v_mfma_f32_16x16x32_bf16 a[40:43], a[208:211], v[196:199], a[40:43]
    s_add_u32 s28, s28, 16384
    s_mov_b32 m0, s30
    v_exp_f32 v138, v138
    v_mfma_f32_16x16x32_bf16 a[40:43], a[212:215], v[200:203], a[40:43]
    buffer_load_dwordx4 v17, s[12:15], s29 offen offset:0 lds
    v_mfma_f32_16x16x32_bf16 a[44:47], a[212:215], v[208:211], a[44:47]
    v_exp_f32 v139, v139
    v_mfma_f32_16x16x32_bf16 a[44:47], a[208:211], v[204:207], a[44:47]
    s_waitcnt lgkmcnt(6)
    v_mfma_f32_16x16x32_bf16 v[132:135], a[144:147], v[36:39], v[100:103]
    v_exp_f32 v140, v140
    v_mfma_f32_16x16x32_bf16 v[132:135], a[148:151], v[40:43], v[132:135]
    ds_read_b64_tr_b16 a[200:201], v10 offset:57344
    v_cvt_pk_bf16_f32 v223, v138, v139
    v_mfma_f32_16x16x32_bf16 v[132:135], a[152:155], v[44:47], v[132:135]
    v_exp_f32 v141, v141
    v_mfma_f32_16x16x32_bf16 v[132:135], a[156:159], v[48:51], v[132:135]
    ds_read_b64_tr_b16 a[202:203], v10 offset:61440
    v_mfma_f32_16x16x32_bf16 v[136:139], a[156:159], v[64:67], v[104:107]
    v_exp_f32 v142, v142
    v_mfma_f32_16x16x32_bf16 v[136:139], a[152:155], v[60:63], v[136:139]
    ds_read_b128 a[168:171], v3 offset:57344
    v_cvt_pk_bf16_f32 v230, v140, v141
    v_mfma_f32_16x16x32_bf16 v[136:139], a[148:151], v[56:59], v[136:139]
    v_exp_f32 v143, v143
    v_mfma_f32_16x16x32_bf16 v[136:139], a[144:147], v[52:55], v[136:139]
    ds_read_b64_tr_b16 a[204:205], v10 offset:0
    v_mfma_f32_16x16x32_bf16 a[48:51], a[216:219], v[180:183], a[48:51]
    v_exp_f32 v144, v144
    v_mfma_f32_16x16x32_bf16 a[48:51], a[220:223], v[184:187], a[48:51]
    ds_read_b64_tr_b16 a[206:207], v10 offset:4096
    v_cvt_pk_bf16_f32 v231, v142, v143
    v_mfma_f32_16x16x32_bf16 a[52:55], a[220:223], v[192:195], a[52:55]
    v_exp_f32 v145, v145
    v_mfma_f32_16x16x32_bf16 a[52:55], a[216:219], v[188:191], a[52:55]
    ds_read_b128 a[172:175], v4 offset:57344
    v_mfma_f32_16x16x32_bf16 a[56:59], a[216:219], v[196:199], a[56:59]
    v_exp_f32 v146, v146
    v_mfma_f32_16x16x32_bf16 a[56:59], a[220:223], v[200:203], a[56:59]
    v_cvt_pk_bf16_f32 v238, v144, v145
    v_mfma_f32_16x16x32_bf16 a[60:63], a[220:223], v[208:211], a[60:63]
    v_exp_f32 v147, v147
    v_mfma_f32_16x16x32_bf16 a[60:63], a[216:219], v[204:207], a[60:63]
    buffer_load_dwordx4 v18, s[12:15], s29 offen offset:1024 lds
    v_smfmac_f32_16x16x64_bf16 a[228:231], v[244:247], v[188:195], v248
    s_waitcnt lgkmcnt(6)
    v_mfma_f32_16x16x32_bf16 v[140:143], a[144:147], v[68:71], v[108:111]
    v_exp_f32 v148, v148
    v_mfma_f32_16x16x32_bf16 v[140:143], a[148:151], v[72:75], v[140:143]
    ds_read_b64_tr_b16 a[208:209], v11 offset:57344
    v_cvt_pk_bf16_f32 v239, v146, v147
    v_mfma_f32_16x16x32_bf16 v[140:143], a[152:155], v[76:79], v[140:143]
    v_exp_f32 v149, v149
    v_mfma_f32_16x16x32_bf16 v[140:143], a[156:159], v[80:83], v[140:143]
    ds_read_b64_tr_b16 a[210:211], v11 offset:61440
    v_mfma_f32_16x16x32_bf16 v[144:147], a[156:159], v[96:99], v[112:115]
    v_exp_f32 v150, v150
    v_mfma_f32_16x16x32_bf16 v[144:147], a[152:155], v[92:95], v[144:147]
    ds_read_b128 a[176:179], v1 offset:61440
    v_cvt_pk_bf16_f32 v216, v148, v149
    v_mfma_f32_16x16x32_bf16 v[144:147], a[148:151], v[88:91], v[144:147]
    v_exp_f32 v151, v151
    v_mfma_f32_16x16x32_bf16 v[144:147], a[144:147], v[84:87], v[144:147]
    ds_read_b64_tr_b16 a[212:213], v11 offset:0
    v_mfma_f32_16x16x32_bf16 a[64:67], a[192:195], v[180:183], a[64:67]
    v_exp_f32 v152, v152
    v_mfma_f32_16x16x32_bf16 a[64:67], a[196:199], v[184:187], a[64:67]
    ds_read_b64_tr_b16 a[214:215], v11 offset:4096
    v_cvt_pk_bf16_f32 v217, v150, v151
    v_mfma_f32_16x16x32_bf16 a[68:71], a[196:199], v[192:195], a[68:71]
    v_exp_f32 v153, v153
    v_mfma_f32_16x16x32_bf16 a[68:71], a[192:195], v[188:191], a[68:71]
    ds_read_b128 a[180:183], v2 offset:61440
    v_cvt_pk_bf16_f32 v224, v152, v153
    v_mfma_f32_16x16x32_bf16 a[72:75], a[192:195], v[196:199], a[72:75]
    v_exp_f32 v154, v154
    v_mfma_f32_16x16x32_bf16 a[72:75], a[196:199], v[200:203], a[72:75]
    buffer_load_dwordx4 v17, s[12:15], s29 offen offset:2048 lds
    v_mfma_f32_16x16x32_bf16 a[76:79], a[196:199], v[208:211], a[76:79]
    v_exp_f32 v155, v155
    v_mfma_f32_16x16x32_bf16 a[76:79], a[192:195], v[204:207], a[76:79]
    s_waitcnt lgkmcnt(6)
    v_mfma_f32_16x16x32_bf16 v[148:151], a[160:163], v[36:39], v[100:103]
    v_exp_f32 v156, v156
    v_mfma_f32_16x16x32_bf16 v[148:151], a[164:167], v[40:43], v[148:151]
    ds_read_b64_tr_b16 a[216:217], v12 offset:57344
    v_cvt_pk_bf16_f32 v225, v154, v155
    v_mfma_f32_16x16x32_bf16 v[148:151], a[168:171], v[44:47], v[148:151]
    v_exp_f32 v157, v157
    v_mfma_f32_16x16x32_bf16 v[148:151], a[172:175], v[48:51], v[148:151]
    ds_read_b64_tr_b16 a[218:219], v12 offset:61440
    v_mfma_f32_16x16x32_bf16 v[152:155], a[172:175], v[64:67], v[104:107]
    v_exp_f32 v158, v158
    v_mfma_f32_16x16x32_bf16 v[152:155], a[168:171], v[60:63], v[152:155]
    ds_read_b128 a[184:187], v3 offset:61440
    v_cvt_pk_bf16_f32 v232, v156, v157
    v_mfma_f32_16x16x32_bf16 v[152:155], a[164:167], v[56:59], v[152:155]
    v_exp_f32 v159, v159
    v_mfma_f32_16x16x32_bf16 v[152:155], a[160:163], v[52:55], v[152:155]
    ds_read_b64_tr_b16 a[220:221], v12 offset:0
    v_mfma_f32_16x16x32_bf16 a[80:83], a[200:203], v[180:183], a[80:83]
    v_exp_f32 v160, v160
    v_mfma_f32_16x16x32_bf16 a[80:83], a[204:207], v[184:187], a[80:83]
    ds_read_b64_tr_b16 a[222:223], v12 offset:4096
    v_cvt_pk_bf16_f32 v233, v158, v159
    v_mfma_f32_16x16x32_bf16 a[84:87], a[204:207], v[192:195], a[84:87]
    v_exp_f32 v161, v161
    v_mfma_f32_16x16x32_bf16 a[84:87], a[200:203], v[188:191], a[84:87]
    ds_read_b128 a[188:191], v4 offset:61440
    v_mfma_f32_16x16x32_bf16 a[88:91], a[200:203], v[196:199], a[88:91]
    v_exp_f32 v162, v162
    v_mfma_f32_16x16x32_bf16 a[88:91], a[204:207], v[200:203], a[88:91]
    v_cvt_pk_bf16_f32 v240, v160, v161
    v_mfma_f32_16x16x32_bf16 a[92:95], a[204:207], v[208:211], a[92:95]
    v_exp_f32 v163, v163
    v_mfma_f32_16x16x32_bf16 a[92:95], a[200:203], v[204:207], a[92:95]
    buffer_load_dwordx4 v18, s[12:15], s29 offen offset:3072 lds
    v_smfmac_f32_16x16x64_bf16 a[232:235], v[244:247], v[196:203], v248
    s_waitcnt vmcnt(8) lgkmcnt(6)
    s_barrier
    s_add_u32 s29, s29, 16384
    v_mfma_f32_16x16x32_bf16 v[156:159], a[160:163], v[68:71], v[108:111]
    v_exp_f32 v164, v164
    v_mfma_f32_16x16x32_bf16 v[156:159], a[164:167], v[72:75], v[156:159]
    ds_read_b64_tr_b16 a[192:193], v5 offset:24576
    v_cvt_pk_bf16_f32 v241, v162, v163
    v_mfma_f32_16x16x32_bf16 v[156:159], a[168:171], v[76:79], v[156:159]
    v_exp_f32 v165, v165
    v_mfma_f32_16x16x32_bf16 v[156:159], a[172:175], v[80:83], v[156:159]
    ds_read_b64_tr_b16 a[194:195], v5 offset:28672
    v_mfma_f32_16x16x32_bf16 v[160:163], a[172:175], v[96:99], v[112:115]
    v_exp_f32 v166, v166
    v_mfma_f32_16x16x32_bf16 v[160:163], a[168:171], v[92:95], v[160:163]
    ds_read_b128 a[128:131], v1 offset:16384
    v_cvt_pk_bf16_f32 v218, v164, v165
    v_mfma_f32_16x16x32_bf16 v[160:163], a[164:167], v[88:91], v[160:163]
    v_exp_f32 v167, v167
    v_mfma_f32_16x16x32_bf16 v[160:163], a[160:163], v[84:87], v[160:163]
    ds_read_b64_tr_b16 a[196:197], v5 offset:49152
    v_mfma_f32_16x16x32_bf16 a[96:99], a[208:211], v[180:183], a[96:99]
    v_exp_f32 v168, v168
    v_mfma_f32_16x16x32_bf16 a[96:99], a[212:215], v[184:187], a[96:99]
    ds_read_b64_tr_b16 a[198:199], v5 offset:53248
    v_cvt_pk_bf16_f32 v219, v166, v167
    v_mfma_f32_16x16x32_bf16 a[100:103], a[212:215], v[192:195], a[100:103]
    v_exp_f32 v169, v169
    v_mfma_f32_16x16x32_bf16 a[100:103], a[208:211], v[188:191], a[100:103]
    ds_read_b128 a[132:135], v2 offset:16384
    v_cvt_pk_bf16_f32 v226, v168, v169
    v_mfma_f32_16x16x32_bf16 a[104:107], a[208:211], v[196:199], a[104:107]
    s_add_u32 m0, s34, 0
    v_exp_f32 v170, v170
    v_mfma_f32_16x16x32_bf16 a[104:107], a[212:215], v[200:203], a[104:107]
    buffer_load_dwordx4 v13, s[8:11], s28 offen offset:0 lds
    v_mfma_f32_16x16x32_bf16 a[108:111], a[212:215], v[208:211], a[108:111]
    v_exp_f32 v171, v171
    v_mfma_f32_16x16x32_bf16 a[108:111], a[208:211], v[204:207], a[108:111]
    s_waitcnt lgkmcnt(6)
    s_cmp_lg_u32 s5, 0
    s_cbranch_scc1 L_ffn_flagged
    s_mov_b64 exec, 1
    buffer_store_dword v0, off, s[76:79], s75 sc1
    s_mov_b64 exec, -1
L_ffn_flagged:
    v_mfma_f32_16x16x32_bf16 v[164:167], a[176:179], v[36:39], v[100:103]
    v_exp_f32 v172, v172
    v_mfma_f32_16x16x32_bf16 v[164:167], a[180:183], v[40:43], v[164:167]
    ds_read_b64_tr_b16 a[200:201], v6 offset:24576
    v_cvt_pk_bf16_f32 v227, v170, v171
    v_mfma_f32_16x16x32_bf16 v[164:167], a[184:187], v[44:47], v[164:167]
    v_exp_f32 v173, v173
    v_mfma_f32_16x16x32_bf16 v[164:167], a[188:191], v[48:51], v[164:167]
    ds_read_b64_tr_b16 a[202:203], v6 offset:28672
    v_mfma_f32_16x16x32_bf16 v[168:171], a[188:191], v[64:67], v[104:107]
    v_exp_f32 v174, v174
    v_mfma_f32_16x16x32_bf16 v[168:171], a[184:187], v[60:63], v[168:171]
    ds_read_b128 a[136:139], v3 offset:16384
    v_cvt_pk_bf16_f32 v234, v172, v173
    v_mfma_f32_16x16x32_bf16 v[168:171], a[180:183], v[56:59], v[168:171]
    v_exp_f32 v175, v175
    v_mfma_f32_16x16x32_bf16 v[168:171], a[176:179], v[52:55], v[168:171]
    ds_read_b64_tr_b16 a[204:205], v6 offset:49152
    v_mfma_f32_16x16x32_bf16 a[112:115], a[216:219], v[180:183], a[112:115]
    v_exp_f32 v176, v176
    v_mfma_f32_16x16x32_bf16 a[112:115], a[220:223], v[184:187], a[112:115]
    ds_read_b64_tr_b16 a[206:207], v6 offset:53248
    v_cvt_pk_bf16_f32 v235, v174, v175
    v_mfma_f32_16x16x32_bf16 a[116:119], a[220:223], v[192:195], a[116:119]
    v_exp_f32 v177, v177
    v_mfma_f32_16x16x32_bf16 a[116:119], a[216:219], v[188:191], a[116:119]
    ds_read_b128 a[140:143], v4 offset:16384
    v_mfma_f32_16x16x32_bf16 a[120:123], a[216:219], v[196:199], a[120:123]
    v_exp_f32 v178, v178
    v_mfma_f32_16x16x32_bf16 a[120:123], a[220:223], v[200:203], a[120:123]
    v_cvt_pk_bf16_f32 v242, v176, v177
    v_mfma_f32_16x16x32_bf16 a[124:127], a[220:223], v[208:211], a[124:127]
    v_exp_f32 v179, v179
    v_mfma_f32_16x16x32_bf16 a[124:127], a[216:219], v[204:207], a[124:127]
    buffer_load_dwordx4 v14, s[8:11], s28 offen offset:1024 lds
    v_smfmac_f32_16x16x64_bf16 a[236:239], v[244:247], v[204:211], v248
    s_waitcnt lgkmcnt(6)
    v_mfma_f32_16x16x32_bf16 v[172:175], a[176:179], v[68:71], v[108:111]
    s_mul_i32 s46, s5, 10240
    v_exp_f32 v116, v116
    v_mfma_f32_16x16x32_bf16 v[172:175], a[180:183], v[72:75], v[172:175]
    s_lshl_b32 s40, s100, 1
    ds_read_b64_tr_b16 a[208:209], v7 offset:24576
    v_cvt_pk_bf16_f32 v243, v178, v179
    v_mfma_f32_16x16x32_bf16 v[172:175], a[184:187], v[76:79], v[172:175]
    s_add_u32 s40, s40, s47
    v_exp_f32 v117, v117
    v_mfma_f32_16x16x32_bf16 v[172:175], a[188:191], v[80:83], v[172:175]
    s_mul_i32 s40, s40, 327680
    ds_read_b64_tr_b16 a[210:211], v7 offset:28672
    v_mfma_f32_16x16x32_bf16 v[176:179], a[188:191], v[96:99], v[112:115]
    s_add_u32 s40, s40, 0x1400000
    v_exp_f32 v118, v118
    v_mfma_f32_16x16x32_bf16 v[176:179], a[184:187], v[92:95], v[176:179]
    s_add_u32 s20, s72, s40
    s_addc_u32 s21, s73, 0
    ds_read_b128 a[144:147], v1 offset:20480
    v_cvt_pk_bf16_f32 v180, v116, v117
    v_mfma_f32_16x16x32_bf16 v[176:179], a[180:183], v[88:91], v[176:179]
    s_mov_b32 s22, 0x50000
    v_exp_f32 v119, v119
    v_mfma_f32_16x16x32_bf16 v[176:179], a[176:179], v[84:87], v[176:179]
    s_mov_b32 s23, 0x20000
    ds_read_b64_tr_b16 a[212:213], v7 offset:49152
    v_mfma_f32_16x16x32_bf16 a[0:3], a[192:195], v[212:215], a[0:3]
    s_mul_i32 s40, s5, 5120
    v_exp_f32 v120, v120
    v_mfma_f32_16x16x32_bf16 a[0:3], a[196:199], v[216:219], a[0:3]
    ds_read_b64_tr_b16 a[214:215], v7 offset:53248
    v_cvt_pk_bf16_f32 v181, v118, v119
    v_mfma_f32_16x16x32_bf16 a[4:7], a[196:199], v[224:227], a[4:7]
    v_exp_f32 v121, v121
    v_mfma_f32_16x16x32_bf16 a[4:7], a[192:195], v[220:223], a[4:7]
    ds_read_b128 a[148:151], v2 offset:20480
    v_cvt_pk_bf16_f32 v188, v120, v121
    v_mfma_f32_16x16x32_bf16 a[8:11], a[192:195], v[228:231], a[8:11]
    v_exp_f32 v122, v122
    v_mfma_f32_16x16x32_bf16 a[8:11], a[196:199], v[232:235], a[8:11]
    buffer_load_dwordx4 v15, s[8:11], s28 offen offset:2048 lds
    v_mfma_f32_16x16x32_bf16 a[12:15], a[196:199], v[240:243], a[12:15]
    v_exp_f32 v123, v123
    v_mfma_f32_16x16x32_bf16 a[12:15], a[192:195], v[236:239], a[12:15]
    s_waitcnt lgkmcnt(6)
    v_lshl_add_u32 v254, v19, 4, s40
    v_mfma_f32_16x16x32_bf16 v[116:119], a[128:131], v[36:39], v[100:103]
    v_exp_f32 v124, v124
    v_mfma_f32_16x16x32_bf16 v[116:119], a[132:135], v[40:43], v[116:119]
    ds_read_b64_tr_b16 a[216:217], v8 offset:24576
    v_cvt_pk_bf16_f32 v189, v122, v123
    v_mfma_f32_16x16x32_bf16 v[116:119], a[136:139], v[44:47], v[116:119]
    v_exp_f32 v125, v125
    v_mfma_f32_16x16x32_bf16 v[116:119], a[140:143], v[48:51], v[116:119]
    ds_read_b64_tr_b16 a[218:219], v8 offset:28672
    v_mfma_f32_16x16x32_bf16 v[120:123], a[140:143], v[64:67], v[104:107]
    v_exp_f32 v126, v126
    v_mfma_f32_16x16x32_bf16 v[120:123], a[136:139], v[60:63], v[120:123]
    ds_read_b128 a[152:155], v3 offset:20480
    v_cvt_pk_bf16_f32 v196, v124, v125
    v_mfma_f32_16x16x32_bf16 v[120:123], a[132:135], v[56:59], v[120:123]
    v_exp_f32 v127, v127
    v_mfma_f32_16x16x32_bf16 v[120:123], a[128:131], v[52:55], v[120:123]
    ds_read_b64_tr_b16 a[220:221], v8 offset:49152
    v_mfma_f32_16x16x32_bf16 a[16:19], a[200:203], v[212:215], a[16:19]
    v_exp_f32 v128, v128
    v_mfma_f32_16x16x32_bf16 a[16:19], a[204:207], v[216:219], a[16:19]
    ds_read_b64_tr_b16 a[222:223], v8 offset:53248
    v_cvt_pk_bf16_f32 v197, v126, v127
    v_mfma_f32_16x16x32_bf16 a[20:23], a[204:207], v[224:227], a[20:23]
    v_exp_f32 v129, v129
    v_mfma_f32_16x16x32_bf16 a[20:23], a[200:203], v[220:223], a[20:23]
    ds_read_b128 a[156:159], v4 offset:20480
    v_mfma_f32_16x16x32_bf16 a[24:27], a[200:203], v[228:231], a[24:27]
    v_exp_f32 v130, v130
    v_mfma_f32_16x16x32_bf16 a[24:27], a[204:207], v[232:235], a[24:27]
    v_cvt_pk_bf16_f32 v204, v128, v129
    v_mfma_f32_16x16x32_bf16 a[28:31], a[204:207], v[240:243], a[28:31]
    v_exp_f32 v131, v131
    v_mfma_f32_16x16x32_bf16 a[28:31], a[200:203], v[236:239], a[28:31]
    buffer_load_dwordx4 v16, s[8:11], s28 offen offset:3072 lds
    v_smfmac_f32_16x16x64_bf16 a[224:227], v[244:247], v[212:219], v248
    s_waitcnt lgkmcnt(6)
    v_mfma_f32_16x16x32_bf16 v[124:127], a[128:131], v[68:71], v[108:111]
    v_exp_f32 v132, v132
    v_mfma_f32_16x16x32_bf16 v[124:127], a[132:135], v[72:75], v[124:127]
    ds_read_b64_tr_b16 a[192:193], v9 offset:24576
    v_cvt_pk_bf16_f32 v205, v130, v131
    v_mfma_f32_16x16x32_bf16 v[124:127], a[136:139], v[76:79], v[124:127]
    v_exp_f32 v133, v133
    v_mfma_f32_16x16x32_bf16 v[124:127], a[140:143], v[80:83], v[124:127]
    ds_read_b64_tr_b16 a[194:195], v9 offset:28672
    v_mfma_f32_16x16x32_bf16 v[128:131], a[140:143], v[96:99], v[112:115]
    v_exp_f32 v134, v134
    v_mfma_f32_16x16x32_bf16 v[128:131], a[136:139], v[92:95], v[128:131]
    ds_read_b128 a[160:163], v1 offset:24576
    v_cvt_pk_bf16_f32 v182, v132, v133
    v_mfma_f32_16x16x32_bf16 v[128:131], a[132:135], v[88:91], v[128:131]
    v_exp_f32 v135, v135
    v_mfma_f32_16x16x32_bf16 v[128:131], a[128:131], v[84:87], v[128:131]
    ds_read_b64_tr_b16 a[196:197], v9 offset:49152
    v_mfma_f32_16x16x32_bf16 a[32:35], a[208:211], v[212:215], a[32:35]
    v_exp_f32 v136, v136
    v_mfma_f32_16x16x32_bf16 a[32:35], a[212:215], v[216:219], a[32:35]
    ds_read_b64_tr_b16 a[198:199], v9 offset:53248
    v_cvt_pk_bf16_f32 v183, v134, v135
    v_mfma_f32_16x16x32_bf16 a[36:39], a[212:215], v[224:227], a[36:39]
    v_exp_f32 v137, v137
    v_mfma_f32_16x16x32_bf16 a[36:39], a[208:211], v[220:223], a[36:39]
    ds_read_b128 a[164:167], v2 offset:24576
    v_cvt_pk_bf16_f32 v190, v136, v137
    v_mfma_f32_16x16x32_bf16 a[40:43], a[208:211], v[228:231], a[40:43]
    s_add_u32 s28, s28, 16384
    s_mov_b32 m0, s31
    v_exp_f32 v138, v138
    v_mfma_f32_16x16x32_bf16 a[40:43], a[212:215], v[232:235], a[40:43]
    buffer_load_dwordx4 v17, s[12:15], s29 offen offset:0 lds
    v_mfma_f32_16x16x32_bf16 a[44:47], a[212:215], v[240:243], a[44:47]
    v_exp_f32 v139, v139
    v_mfma_f32_16x16x32_bf16 a[44:47], a[208:211], v[236:239], a[44:47]
    s_waitcnt lgkmcnt(6)
    v_mfma_f32_16x16x32_bf16 v[132:135], a[144:147], v[36:39], v[100:103]
    v_exp_f32 v140, v140
    v_mfma_f32_16x16x32_bf16 v[132:135], a[148:151], v[40:43], v[132:135]
    ds_read_b64_tr_b16 a[200:201], v10 offset:24576
    v_cvt_pk_bf16_f32 v191, v138, v139
    v_mfma_f32_16x16x32_bf16 v[132:135], a[152:155], v[44:47], v[132:135]
    v_exp_f32 v141, v141
    v_mfma_f32_16x16x32_bf16 v[132:135], a[156:159], v[48:51], v[132:135]
    ds_read_b64_tr_b16 a[202:203], v10 offset:28672
    v_mfma_f32_16x16x32_bf16 v[136:139], a[156:159], v[64:67], v[104:107]
    v_exp_f32 v142, v142
    v_mfma_f32_16x16x32_bf16 v[136:139], a[152:155], v[60:63], v[136:139]
    ds_read_b128 a[168:171], v3 offset:24576
    v_cvt_pk_bf16_f32 v198, v140, v141
    v_mfma_f32_16x16x32_bf16 v[136:139], a[148:151], v[56:59], v[136:139]
    v_exp_f32 v143, v143
    v_mfma_f32_16x16x32_bf16 v[136:139], a[144:147], v[52:55], v[136:139]
    ds_read_b64_tr_b16 a[204:205], v10 offset:49152
    v_mfma_f32_16x16x32_bf16 a[48:51], a[216:219], v[212:215], a[48:51]
    v_exp_f32 v144, v144
    v_mfma_f32_16x16x32_bf16 a[48:51], a[220:223], v[216:219], a[48:51]
    ds_read_b64_tr_b16 a[206:207], v10 offset:53248
    v_cvt_pk_bf16_f32 v199, v142, v143
    v_mfma_f32_16x16x32_bf16 a[52:55], a[220:223], v[224:227], a[52:55]
    v_exp_f32 v145, v145
    v_mfma_f32_16x16x32_bf16 a[52:55], a[216:219], v[220:223], a[52:55]
    ds_read_b128 a[172:175], v4 offset:24576
    v_mfma_f32_16x16x32_bf16 a[56:59], a[216:219], v[228:231], a[56:59]
    v_exp_f32 v146, v146
    v_mfma_f32_16x16x32_bf16 a[56:59], a[220:223], v[232:235], a[56:59]
    v_cvt_pk_bf16_f32 v206, v144, v145
    v_mfma_f32_16x16x32_bf16 a[60:63], a[220:223], v[240:243], a[60:63]
    v_exp_f32 v147, v147
    v_mfma_f32_16x16x32_bf16 a[60:63], a[216:219], v[236:239], a[60:63]
    buffer_load_dwordx4 v18, s[12:15], s29 offen offset:1024 lds
    v_smfmac_f32_16x16x64_bf16 a[228:231], v[244:247], v[220:227], v248
    s_waitcnt lgkmcnt(6)
    v_mfma_f32_16x16x32_bf16 v[140:143], a[144:147], v[68:71], v[108:111]
    v_exp_f32 v148, v148
    v_mfma_f32_16x16x32_bf16 v[140:143], a[148:151], v[72:75], v[140:143]
    ds_read_b64_tr_b16 a[208:209], v11 offset:24576
    v_cvt_pk_bf16_f32 v207, v146, v147
    v_mfma_f32_16x16x32_bf16 v[140:143], a[152:155], v[76:79], v[140:143]
    v_exp_f32 v149, v149
    v_mfma_f32_16x16x32_bf16 v[140:143], a[156:159], v[80:83], v[140:143]
    ds_read_b64_tr_b16 a[210:211], v11 offset:28672
    v_mfma_f32_16x16x32_bf16 v[144:147], a[156:159], v[96:99], v[112:115]
    v_exp_f32 v150, v150
    v_mfma_f32_16x16x32_bf16 v[144:147], a[152:155], v[92:95], v[144:147]
    ds_read_b128 a[176:179], v1 offset:28672
    v_cvt_pk_bf16_f32 v184, v148, v149
    v_mfma_f32_16x16x32_bf16 v[144:147], a[148:151], v[88:91], v[144:147]
    v_exp_f32 v151, v151
    v_mfma_f32_16x16x32_bf16 v[144:147], a[144:147], v[84:87], v[144:147]
    ds_read_b64_tr_b16 a[212:213], v11 offset:49152
    v_mfma_f32_16x16x32_bf16 a[64:67], a[192:195], v[212:215], a[64:67]
    v_exp_f32 v152, v152
    v_mfma_f32_16x16x32_bf16 a[64:67], a[196:199], v[216:219], a[64:67]
    ds_read_b64_tr_b16 a[214:215], v11 offset:53248
    v_cvt_pk_bf16_f32 v185, v150, v151
    v_mfma_f32_16x16x32_bf16 a[68:71], a[196:199], v[224:227], a[68:71]
    v_exp_f32 v153, v153
    v_mfma_f32_16x16x32_bf16 a[68:71], a[192:195], v[220:223], a[68:71]
    ds_read_b128 a[180:183], v2 offset:28672
    v_cvt_pk_bf16_f32 v192, v152, v153
    v_mfma_f32_16x16x32_bf16 a[72:75], a[192:195], v[228:231], a[72:75]
    v_exp_f32 v154, v154
    v_mfma_f32_16x16x32_bf16 a[72:75], a[196:199], v[232:235], a[72:75]
    buffer_load_dwordx4 v17, s[12:15], s29 offen offset:2048 lds
    v_mfma_f32_16x16x32_bf16 a[76:79], a[196:199], v[240:243], a[76:79]
    v_exp_f32 v155, v155
    v_mfma_f32_16x16x32_bf16 a[76:79], a[192:195], v[236:239], a[76:79]
    s_waitcnt lgkmcnt(6)
    v_mfma_f32_16x16x32_bf16 v[148:151], a[160:163], v[36:39], v[100:103]
    v_exp_f32 v156, v156
    v_mfma_f32_16x16x32_bf16 v[148:151], a[164:167], v[40:43], v[148:151]
    ds_read_b64_tr_b16 a[216:217], v12 offset:24576
    v_cvt_pk_bf16_f32 v193, v154, v155
    v_mfma_f32_16x16x32_bf16 v[148:151], a[168:171], v[44:47], v[148:151]
    v_exp_f32 v157, v157
    v_mfma_f32_16x16x32_bf16 v[148:151], a[172:175], v[48:51], v[148:151]
    ds_read_b64_tr_b16 a[218:219], v12 offset:28672
    v_mfma_f32_16x16x32_bf16 v[152:155], a[172:175], v[64:67], v[104:107]
    v_exp_f32 v158, v158
    v_mfma_f32_16x16x32_bf16 v[152:155], a[168:171], v[60:63], v[152:155]
    ds_read_b128 a[184:187], v3 offset:28672
    v_cvt_pk_bf16_f32 v200, v156, v157
    v_mfma_f32_16x16x32_bf16 v[152:155], a[164:167], v[56:59], v[152:155]
    v_exp_f32 v159, v159
    v_mfma_f32_16x16x32_bf16 v[152:155], a[160:163], v[52:55], v[152:155]
    ds_read_b64_tr_b16 a[220:221], v12 offset:49152
    v_mfma_f32_16x16x32_bf16 a[80:83], a[200:203], v[212:215], a[80:83]
    v_exp_f32 v160, v160
    v_mfma_f32_16x16x32_bf16 a[80:83], a[204:207], v[216:219], a[80:83]
    ds_read_b64_tr_b16 a[222:223], v12 offset:53248
    v_cvt_pk_bf16_f32 v201, v158, v159
    v_mfma_f32_16x16x32_bf16 a[84:87], a[204:207], v[224:227], a[84:87]
    v_exp_f32 v161, v161
    v_mfma_f32_16x16x32_bf16 a[84:87], a[200:203], v[220:223], a[84:87]
    ds_read_b128 a[188:191], v4 offset:28672
    v_mfma_f32_16x16x32_bf16 a[88:91], a[200:203], v[228:231], a[88:91]
    v_exp_f32 v162, v162
    v_mfma_f32_16x16x32_bf16 a[88:91], a[204:207], v[232:235], a[88:91]
    v_cvt_pk_bf16_f32 v208, v160, v161
    v_mfma_f32_16x16x32_bf16 a[92:95], a[204:207], v[240:243], a[92:95]
    v_exp_f32 v163, v163
    v_mfma_f32_16x16x32_bf16 a[92:95], a[200:203], v[236:239], a[92:95]
    buffer_load_dwordx4 v18, s[12:15], s29 offen offset:3072 lds
    v_smfmac_f32_16x16x64_bf16 a[232:235], v[244:247], v[228:235], v248
    s_waitcnt vmcnt(8) lgkmcnt(6)
    s_barrier
    s_add_u32 s29, s29, 16384
    v_mfma_f32_16x16x32_bf16 v[156:159], a[160:163], v[68:71], v[108:111]
    v_exp_f32 v164, v164
    v_mfma_f32_16x16x32_bf16 v[156:159], a[164:167], v[72:75], v[156:159]
    ds_read_b64_tr_b16 a[192:193], v5 offset:8192
    v_cvt_pk_bf16_f32 v209, v162, v163
    v_mfma_f32_16x16x32_bf16 v[156:159], a[168:171], v[76:79], v[156:159]
    v_exp_f32 v165, v165
    v_mfma_f32_16x16x32_bf16 v[156:159], a[172:175], v[80:83], v[156:159]
    ds_read_b64_tr_b16 a[194:195], v5 offset:12288
    v_mfma_f32_16x16x32_bf16 v[160:163], a[172:175], v[96:99], v[112:115]
    v_exp_f32 v166, v166
    v_mfma_f32_16x16x32_bf16 v[160:163], a[168:171], v[92:95], v[160:163]
    ds_read_b128 a[128:131], v1 offset:32768
    v_cvt_pk_bf16_f32 v186, v164, v165
    v_mfma_f32_16x16x32_bf16 v[160:163], a[164:167], v[88:91], v[160:163]
    v_exp_f32 v167, v167
    v_mfma_f32_16x16x32_bf16 v[160:163], a[160:163], v[84:87], v[160:163]
    ds_read_b64_tr_b16 a[196:197], v5 offset:32768
    v_mfma_f32_16x16x32_bf16 a[96:99], a[208:211], v[212:215], a[96:99]
    v_exp_f32 v168, v168
    v_mfma_f32_16x16x32_bf16 a[96:99], a[212:215], v[216:219], a[96:99]
    ds_read_b64_tr_b16 a[198:199], v5 offset:36864
    v_cvt_pk_bf16_f32 v187, v166, v167
    v_mfma_f32_16x16x32_bf16 a[100:103], a[212:215], v[224:227], a[100:103]
    v_exp_f32 v169, v169
    v_mfma_f32_16x16x32_bf16 a[100:103], a[208:211], v[220:223], a[100:103]
    ds_read_b128 a[132:135], v2 offset:32768
    v_cvt_pk_bf16_f32 v194, v168, v169
    v_mfma_f32_16x16x32_bf16 a[104:107], a[208:211], v[228:231], a[104:107]
    s_mov_b32 m0, s32
    v_exp_f32 v170, v170
    v_mfma_f32_16x16x32_bf16 a[104:107], a[212:215], v[232:235], a[104:107]
    buffer_load_dwordx4 v17, s[12:15], s29 offen offset:0 lds
    v_mfma_f32_16x16x32_bf16 a[108:111], a[212:215], v[240:243], a[108:111]
    v_exp_f32 v171, v171
    v_mfma_f32_16x16x32_bf16 a[108:111], a[208:211], v[236:239], a[108:111]
    s_waitcnt lgkmcnt(6)
    v_mfma_f32_16x16x32_bf16 v[164:167], a[176:179], v[36:39], v[100:103]
    v_exp_f32 v172, v172
    v_mfma_f32_16x16x32_bf16 v[164:167], a[180:183], v[40:43], v[164:167]
    ds_read_b64_tr_b16 a[200:201], v6 offset:8192
    v_cvt_pk_bf16_f32 v195, v170, v171
    v_mfma_f32_16x16x32_bf16 v[164:167], a[184:187], v[44:47], v[164:167]
    v_exp_f32 v173, v173
    v_mfma_f32_16x16x32_bf16 v[164:167], a[188:191], v[48:51], v[164:167]
    ds_read_b64_tr_b16 a[202:203], v6 offset:12288
    v_lshlrev_b32 v32, 7, v19
    v_mfma_f32_16x16x32_bf16 v[168:171], a[188:191], v[64:67], v[104:107]
    v_exp_f32 v174, v174
    v_mfma_f32_16x16x32_bf16 v[168:171], a[184:187], v[60:63], v[168:171]
    ds_read_b128 a[136:139], v3 offset:32768
    v_cvt_pk_bf16_f32 v202, v172, v173
    v_mfma_f32_16x16x32_bf16 v[168:171], a[180:183], v[56:59], v[168:171]
    v_exp_f32 v175, v175
    v_mfma_f32_16x16x32_bf16 v[168:171], a[176:179], v[52:55], v[168:171]
    ds_read_b64_tr_b16 a[204:205], v6 offset:32768
    v_add_u32 v32, 0x290000, v32
    v_mfma_f32_16x16x32_bf16 a[112:115], a[216:219], v[212:215], a[112:115]
    v_exp_f32 v176, v176
    v_mfma_f32_16x16x32_bf16 a[112:115], a[220:223], v[216:219], a[112:115]
    ds_read_b64_tr_b16 a[206:207], v6 offset:36864
    v_cvt_pk_bf16_f32 v203, v174, v175
    v_mfma_f32_16x16x32_bf16 a[116:119], a[220:223], v[224:227], a[116:119]
    v_exp_f32 v177, v177
    v_mfma_f32_16x16x32_bf16 a[116:119], a[216:219], v[220:223], a[116:119]
    ds_read_b128 a[140:143], v4 offset:32768
    v_mfma_f32_16x16x32_bf16 a[120:123], a[216:219], v[228:231], a[120:123]
    v_exp_f32 v178, v178
    v_mfma_f32_16x16x32_bf16 a[120:123], a[220:223], v[232:235], a[120:123]
    v_cvt_pk_bf16_f32 v210, v176, v177
    v_mfma_f32_16x16x32_bf16 a[124:127], a[220:223], v[240:243], a[124:127]
    v_exp_f32 v179, v179
    v_mfma_f32_16x16x32_bf16 a[124:127], a[216:219], v[236:239], a[124:127]
    buffer_load_dwordx4 v18, s[12:15], s29 offen offset:1024 lds
    v_smfmac_f32_16x16x64_bf16 a[236:239], v[244:247], v[236:243], v248
    s_waitcnt lgkmcnt(6)
    s_cmp_lg_u32 s5, 0
    s_cbranch_scc1 L_no_ask
    buffer_load_dwordx4 v[28:31], v32, s[76:79], 0 offen sc1
L_no_ask:
    v_mfma_f32_16x16x32_bf16 v[172:175], a[176:179], v[68:71], v[108:111]
    v_exp_f32 v116, v116
    v_mfma_f32_16x16x32_bf16 v[172:175], a[180:183], v[72:75], v[172:175]
    ds_read_b64_tr_b16 a[208:209], v7 offset:8192
    v_cvt_pk_bf16_f32 v211, v178, v179
    v_mfma_f32_16x16x32_bf16 v[172:175], a[184:187], v[76:79], v[172:175]
    v_exp_f32 v117, v117
    v_mfma_f32_16x16x32_bf16 v[172:175], a[188:191], v[80:83], v[172:175]
    ds_read_b64_tr_b16 a[210:211], v7 offset:12288
    v_mfma_f32_16x16x32_bf16 v[176:179], a[188:191], v[96:99], v[112:115]
    v_exp_f32 v118, v118
    v_mfma_f32_16x16x32_bf16 v[176:179], a[184:187], v[92:95], v[176:179]
    ds_read_b128 a[144:147], v1 offset:36864
    v_cvt_pk_bf16_f32 v212, v116, v117
    v_mfma_f32_16x16x32_bf16 v[176:179], a[180:183], v[88:91], v[176:179]
    v_exp_f32 v119, v119
    v_mfma_f32_16x16x32_bf16 v[176:179], a[176:179], v[84:87], v[176:179]
    ds_read_b64_tr_b16 a[212:213], v7 offset:32768
    v_mfma_f32_16x16x32_bf16 a[0:3], a[192:195], v[180:183], a[0:3]
    v_exp_f32 v120, v120
    v_mfma_f32_16x16x32_bf16 a[0:3], a[196:199], v[184:187], a[0:3]
    ds_read_b64_tr_b16 a[214:215], v7 offset:36864
    v_cvt_pk_bf16_f32 v213, v118, v119
    v_mfma_f32_16x16x32_bf16 a[4:7], a[196:199], v[192:195], a[4:7]
    v_exp_f32 v121, v121
    v_mfma_f32_16x16x32_bf16 a[4:7], a[192:195], v[188:191], a[4:7]
    ds_read_b128 a[148:151], v2 offset:36864
    v_cvt_pk_bf16_f32 v220, v120, v121
    v_mfma_f32_16x16x32_bf16 a[8:11], a[192:195], v[196:199], a[8:11]
    v_exp_f32 v122, v122
    v_mfma_f32_16x16x32_bf16 a[8:11], a[196:199], v[200:203], a[8:11]
    buffer_load_dwordx4 v17, s[12:15], s29 offen offset:2048 lds
    v_mfma_f32_16x16x32_bf16 a[12:15], a[196:199], v[208:211], a[12:15]
    v_exp_f32 v123, v123
    v_mfma_f32_16x16x32_bf16 a[12:15], a[192:195], v[204:207], a[12:15]
    s_waitcnt lgkmcnt(6)
    v_mfma_f32_16x16x32_bf16 v[116:119], a[128:131], v[36:39], v[100:103]
    v_exp_f32 v124, v124
    v_mfma_f32_16x16x32_bf16 v[116:119], a[132:135], v[40:43], v[116:119]
    ds_read_b64_tr_b16 a[216:217], v8 offset:8192
    v_cvt_pk_bf16_f32 v221, v122, v123
    v_mfma_f32_16x16x32_bf16 v[116:119], a[136:139], v[44:47], v[116:119]
    v_exp_f32 v125, v125
    v_mfma_f32_16x16x32_bf16 v[116:119], a[140:143], v[48:51], v[116:119]
    ds_read_b64_tr_b16 a[218:219], v8 offset:12288
    v_mfma_f32_16x16x32_bf16 v[120:123], a[140:143], v[64:67], v[104:107]
    v_exp_f32 v126, v126
    v_mfma_f32_16x16x32_bf16 v[120:123], a[136:139], v[60:63], v[120:123]
    ds_read_b128 a[152:155], v3 offset:36864
    v_cvt_pk_bf16_f32 v228, v124, v125
    v_mfma_f32_16x16x32_bf16 v[120:123], a[132:135], v[56:59], v[120:123]
    v_exp_f32 v127, v127
    v_mfma_f32_16x16x32_bf16 v[120:123], a[128:131], v[52:55], v[120:123]
    ds_read_b64_tr_b16 a[220:221], v8 offset:32768
    v_mfma_f32_16x16x32_bf16 a[16:19], a[200:203], v[180:183], a[16:19]
    v_exp_f32 v128, v128
    v_mfma_f32_16x16x32_bf16 a[16:19], a[204:207], v[184:187], a[16:19]
    ds_read_b64_tr_b16 a[222:223], v8 offset:36864
    v_cvt_pk_bf16_f32 v229, v126, v127
    v_mfma_f32_16x16x32_bf16 a[20:23], a[204:207], v[192:195], a[20:23]
    v_exp_f32 v129, v129
    v_mfma_f32_16x16x32_bf16 a[20:23], a[200:203], v[188:191], a[20:23]
    ds_read_b128 a[156:159], v4 offset:36864
    v_mfma_f32_16x16x32_bf16 a[24:27], a[200:203], v[196:199], a[24:27]
    v_exp_f32 v130, v130
    v_mfma_f32_16x16x32_bf16 a[24:27], a[204:207], v[200:203], a[24:27]
    v_cvt_pk_bf16_f32 v236, v128, v129
    v_mfma_f32_16x16x32_bf16 a[28:31], a[204:207], v[208:211], a[28:31]
    v_exp_f32 v131, v131
    v_mfma_f32_16x16x32_bf16 a[28:31], a[200:203], v[204:207], a[28:31]
    buffer_load_dwordx4 v18, s[12:15], s29 offen offset:3072 lds
    v_smfmac_f32_16x16x64_bf16 a[224:227], v[244:247], v[180:187], v248
    s_waitcnt lgkmcnt(6)
    s_add_u32 s29, s29, 16384
    v_mfma_f32_16x16x32_bf16 v[124:127], a[128:131], v[68:71], v[108:111]
    v_exp_f32 v132, v132
    v_mfma_f32_16x16x32_bf16 v[124:127], a[132:135], v[72:75], v[124:127]
    ds_read_b64_tr_b16 a[192:193], v9 offset:8192
    v_cvt_pk_bf16_f32 v237, v130, v131
    v_mfma_f32_16x16x32_bf16 v[124:127], a[136:139], v[76:79], v[124:127]
    v_exp_f32 v133, v133
    v_mfma_f32_16x16x32_bf16 v[124:127], a[140:143], v[80:83], v[124:127]
    ds_read_b64_tr_b16 a[194:195], v9 offset:12288
    v_mfma_f32_16x16x32_bf16 v[128:131], a[140:143], v[96:99], v[112:115]
    v_exp_f32 v134, v134
    v_mfma_f32_16x16x32_bf16 v[128:131], a[136:139], v[92:95], v[128:131]
    ds_read_b128 a[160:163], v1 offset:40960
    v_cvt_pk_bf16_f32 v214, v132, v133
    v_mfma_f32_16x16x32_bf16 v[128:131], a[132:135], v[88:91], v[128:131]
    v_exp_f32 v135, v135
    v_mfma_f32_16x16x32_bf16 v[128:131], a[128:131], v[84:87], v[128:131]
    ds_read_b64_tr_b16 a[196:197], v9 offset:32768
    v_mfma_f32_16x16x32_bf16 a[32:35], a[208:211], v[180:183], a[32:35]
    v_exp_f32 v136, v136
    v_mfma_f32_16x16x32_bf16 a[32:35], a[212:215], v[184:187], a[32:35]
    ds_read_b64_tr_b16 a[198:199], v9 offset:36864
    v_cvt_pk_bf16_f32 v215, v134, v135
    v_mfma_f32_16x16x32_bf16 a[36:39], a[212:215], v[192:195], a[36:39]
    v_exp_f32 v137, v137
    v_mfma_f32_16x16x32_bf16 a[36:39], a[208:211], v[188:191], a[36:39]
    ds_read_b128 a[164:167], v2 offset:40960
    v_mfma_f32_16x16x32_bf16 a[40:43], a[208:211], v[196:199], a[40:43]
    v_exp_f32 v138, v138
    v_mfma_f32_16x16x32_bf16 a[40:43], a[212:215], v[200:203], a[40:43]
    v_cvt_pk_bf16_f32 v222, v136, v137
    v_mfma_f32_16x16x32_bf16 a[44:47], a[212:215], v[208:211], a[44:47]
    v_exp_f32 v139, v139
    v_mfma_f32_16x16x32_bf16 a[44:47], a[208:211], v[204:207], a[44:47]
    s_waitcnt lgkmcnt(6)
    v_mfma_f32_16x16x32_bf16 v[132:135], a[144:147], v[36:39], v[100:103]
    v_exp_f32 v140, v140
    v_mfma_f32_16x16x32_bf16 v[132:135], a[148:151], v[40:43], v[132:135]
    ds_read_b64_tr_b16 a[200:201], v10 offset:8192
    v_cvt_pk_bf16_f32 v223, v138, v139
    v_mfma_f32_16x16x32_bf16 v[132:135], a[152:155], v[44:47], v[132:135]
    v_exp_f32 v141, v141
    v_mfma_f32_16x16x32_bf16 v[132:135], a[156:159], v[48:51], v[132:135]
    ds_read_b64_tr_b16 a[202:203], v10 offset:12288
    v_mfma_f32_16x16x32_bf16 v[136:139], a[156:159], v[64:67], v[104:107]
    v_exp_f32 v142, v142
    v_mfma_f32_16x16x32_bf16 v[136:139], a[152:155], v[60:63], v[136:139]
    ds_read_b128 a[168:171], v3 offset:40960
    v_cvt_pk_bf16_f32 v230, v140, v141
    v_mfma_f32_16x16x32_bf16 v[136:139], a[148:151], v[56:59], v[136:139]
    v_exp_f32 v143, v143
    v_mfma_f32_16x16x32_bf16 v[136:139], a[144:147], v[52:55], v[136:139]
    ds_read_b64_tr_b16 a[204:205], v10 offset:32768
    v_mfma_f32_16x16x32_bf16 a[48:51], a[216:219], v[180:183], a[48:51]
    v_exp_f32 v144, v144
    v_mfma_f32_16x16x32_bf16 a[48:51], a[220:223], v[184:187], a[48:51]
    ds_read_b64_tr_b16 a[206:207], v10 offset:36864
    v_cvt_pk_bf16_f32 v231, v142, v143
    v_mfma_f32_16x16x32_bf16 a[52:55], a[220:223], v[192:195], a[52:55]
    v_exp_f32 v145, v145
    v_mfma_f32_16x16x32_bf16 a[52:55], a[216:219], v[188:191], a[52:55]
    ds_read_b128 a[172:175], v4 offset:40960
    v_mfma_f32_16x16x32_bf16 a[56:59], a[216:219], v[196:199], a[56:59]
    v_exp_f32 v146, v146
    v_mfma_f32_16x16x32_bf16 a[56:59], a[220:223], v[200:203], a[56:59]
    v_cvt_pk_bf16_f32 v238, v144, v145
    v_mfma_f32_16x16x32_bf16 a[60:63], a[220:223], v[208:211], a[60:63]
    v_exp_f32 v147, v147
    v_mfma_f32_16x16x32_bf16 a[60:63], a[216:219], v[204:207], a[60:63]
    v_smfmac_f32_16x16x64_bf16 a[228:231], v[244:247], v[188:195], v248
    s_waitcnt lgkmcnt(6)
    v_mfma_f32_16x16x32_bf16 v[140:143], a[144:147], v[68:71], v[108:111]
    v_exp_f32 v148, v148
    v_mfma_f32_16x16x32_bf16 v[140:143], a[148:151], v[72:75], v[140:143]
    ds_read_b64_tr_b16 a[208:209], v11 offset:8192
    v_cvt_pk_bf16_f32 v239, v146, v147
    v_mfma_f32_16x16x32_bf16 v[140:143], a[152:155], v[76:79], v[140:143]
    v_exp_f32 v149, v149
    v_mfma_f32_16x16x32_bf16 v[140:143], a[156:159], v[80:83], v[140:143]
    ds_read_b64_tr_b16 a[210:211], v11 offset:12288
    s_cmp_lg_u32 s5, 0
    s_cbranch_scc1 L_back_ffn
    s_waitcnt vmcnt(2)
    v_min3_u32 v28, v28, v29, v30
    v_min_u32 v28, v28, v31
    v_cmp_gt_u32 vcc, 1, v28
    s_and_b64 vcc, vcc, exec
    s_cbranch_scc1 L_spin_ffn
L_back_ffn:
    v_mfma_f32_16x16x32_bf16 v[144:147], a[156:159], v[96:99], v[112:115]
    v_exp_f32 v150, v150
    v_mfma_f32_16x16x32_bf16 v[144:147], a[152:155], v[92:95], v[144:147]
    ds_read_b128 a[176:179], v1 offset:45056
    v_cvt_pk_bf16_f32 v216, v148, v149
    v_mfma_f32_16x16x32_bf16 v[144:147], a[148:151], v[88:91], v[144:147]
    v_exp_f32 v151, v151
    v_mfma_f32_16x16x32_bf16 v[144:147], a[144:147], v[84:87], v[144:147]
    ds_read_b64_tr_b16 a[212:213], v11 offset:32768
    v_mfma_f32_16x16x32_bf16 a[64:67], a[192:195], v[180:183], a[64:67]
    v_exp_f32 v152, v152
    v_mfma_f32_16x16x32_bf16 a[64:67], a[196:199], v[184:187], a[64:67]
    ds_read_b64_tr_b16 a[214:215], v11 offset:36864
    v_cvt_pk_bf16_f32 v217, v150, v151
    v_mfma_f32_16x16x32_bf16 a[68:71], a[196:199], v[192:195], a[68:71]
    v_exp_f32 v153, v153
    v_mfma_f32_16x16x32_bf16 a[68:71], a[192:195], v[188:191], a[68:71]
    ds_read_b128 a[180:183], v2 offset:45056
    v_mfma_f32_16x16x32_bf16 a[72:75], a[192:195], v[196:199], a[72:75]
    v_exp_f32 v154, v154
    v_mfma_f32_16x16x32_bf16 a[72:75], a[196:199], v[200:203], a[72:75]
    v_cvt_pk_bf16_f32 v224, v152, v153
    v_mfma_f32_16x16x32_bf16 a[76:79], a[196:199], v[208:211], a[76:79]
    v_exp_f32 v155, v155
    v_mfma_f32_16x16x32_bf16 a[76:79], a[192:195], v[204:207], a[76:79]
    s_waitcnt lgkmcnt(6)
    v_mfma_f32_16x16x32_bf16 v[148:151], a[160:163], v[36:39], v[100:103]
    v_exp_f32 v156, v156
    v_mfma_f32_16x16x32_bf16 v[148:151], a[164:167], v[40:43], v[148:151]
    ds_read_b64_tr_b16 a[216:217], v12 offset:8192
    v_cvt_pk_bf16_f32 v225, v154, v155
    v_mfma_f32_16x16x32_bf16 v[148:151], a[168:171], v[44:47], v[148:151]
    v_exp_f32 v157, v157
    v_mfma_f32_16x16x32_bf16 v[148:151], a[172:175], v[48:51], v[148:151]
    ds_read_b64_tr_b16 a[218:219], v12 offset:12288
    v_mfma_f32_16x16x32_bf16 v[152:155], a[172:175], v[64:67], v[104:107]
    v_exp_f32 v158, v158
    v_mfma_f32_16x16x32_bf16 v[152:155], a[168:171], v[60:63], v[152:155]
    ds_read_b128 a[184:187], v3 offset:45056
    v_cvt_pk_bf16_f32 v232, v156, v157
    v_mfma_f32_16x16x32_bf16 v[152:155], a[164:167], v[56:59], v[152:155]
    v_exp_f32 v159, v159
    v_mfma_f32_16x16x32_bf16 v[152:155], a[160:163], v[52:55], v[152:155]
    ds_read_b64_tr_b16 a[220:221], v12 offset:32768
    v_mfma_f32_16x16x32_bf16 a[80:83], a[200:203], v[180:183], a[80:83]
    v_exp_f32 v160, v160
    v_mfma_f32_16x16x32_bf16 a[80:83], a[204:207], v[184:187], a[80:83]
    ds_read_b64_tr_b16 a[222:223], v12 offset:36864
    v_cvt_pk_bf16_f32 v233, v158, v159
    v_mfma_f32_16x16x32_bf16 a[84:87], a[204:207], v[192:195], a[84:87]
    v_exp_f32 v161, v161
    v_mfma_f32_16x16x32_bf16 a[84:87], a[200:203], v[188:191], a[84:87]
    ds_read_b128 a[188:191], v4 offset:45056
    v_mfma_f32_16x16x32_bf16 a[88:91], a[200:203], v[196:199], a[88:91]
    v_exp_f32 v162, v162
    v_mfma_f32_16x16x32_bf16 a[88:91], a[204:207], v[200:203], a[88:91]
    v_cvt_pk_bf16_f32 v240, v160, v161
    v_mfma_f32_16x16x32_bf16 a[92:95], a[204:207], v[208:211], a[92:95]
    v_exp_f32 v163, v163
    v_mfma_f32_16x16x32_bf16 a[92:95], a[200:203], v[204:207], a[92:95]
    v_smfmac_f32_16x16x64_bf16 a[232:235], v[244:247], v[196:203], v248
    s_waitcnt vmcnt(4) lgkmcnt(0)
    s_barrier
    v_mfma_f32_16x16x32_bf16 v[156:159], a[160:163], v[68:71], v[108:111]
    v_exp_f32 v164, v164
    v_mfma_f32_16x16x32_bf16 v[156:159], a[164:167], v[72:75], v[156:159]
    ds_read_b64_tr_b16 a[192:193], v5 offset:16384
    v_cvt_pk_bf16_f32 v241, v162, v163
    v_mfma_f32_16x16x32_bf16 v[156:159], a[168:171], v[76:79], v[156:159]
    v_exp_f32 v165, v165
    v_mfma_f32_16x16x32_bf16 v[156:159], a[172:175], v[80:83], v[156:159]
    ds_read_b64_tr_b16 a[194:195], v5 offset:20480
    v_mfma_f32_16x16x32_bf16 v[160:163], a[172:175], v[96:99], v[112:115]
    v_exp_f32 v166, v166
    v_mfma_f32_16x16x32_bf16 v[160:163], a[168:171], v[92:95], v[160:163]
    ds_read_b128 a[128:131], v1 offset:0
    v_cvt_pk_bf16_f32 v218, v164, v165
    v_mfma_f32_16x16x32_bf16 v[160:163], a[164:167], v[88:91], v[160:163]
    v_exp_f32 v167, v167
    v_mfma_f32_16x16x32_bf16 v[160:163], a[160:163], v[84:87], v[160:163]
    ds_read_b64_tr_b16 a[196:197], v5 offset:40960
    s_mul_i32 s36, s6, 27648
    s_lshl_b32 s37, s5, 10
    s_add_u32 s36, s36, s37
    v_lshlrev_b32 v0, 4, v19
    buffer_load_dwordx4 v[20:23], v0, s[16:19], s36 offen sc1
    v_mfma_f32_16x16x32_bf16 a[96:99], a[208:211], v[180:183], a[96:99]
    v_exp_f32 v168, v168
    v_mfma_f32_16x16x32_bf16 a[96:99], a[212:215], v[184:187], a[96:99]
    ds_read_b64_tr_b16 a[198:199], v5 offset:45056
    v_cvt_pk_bf16_f32 v219, v166, v167
    v_mfma_f32_16x16x32_bf16 a[100:103], a[212:215], v[192:195], a[100:103]
    v_exp_f32 v169, v169
    v_mfma_f32_16x16x32_bf16 a[100:103], a[208:211], v[188:191], a[100:103]
    ds_read_b128 a[132:135], v2 offset:0
    v_cvt_pk_bf16_f32 v226, v168, v169
    v_mfma_f32_16x16x32_bf16 a[104:107], a[208:211], v[196:199], a[104:107]
    v_exp_f32 v170, v170
    v_mfma_f32_16x16x32_bf16 a[104:107], a[212:215], v[200:203], a[104:107]
    s_mov_b32 m0, s33
    s_nop 0
    buffer_load_dwordx4 v17, s[12:15], s29 offen offset:0 lds
    v_mfma_f32_16x16x32_bf16 a[108:111], a[212:215], v[208:211], a[108:111]
    v_exp_f32 v171, v171
    v_mfma_f32_16x16x32_bf16 a[108:111], a[208:211], v[204:207], a[108:111]
    s_waitcnt lgkmcnt(6)
    s_add_u32 s36, s36, 4096
    buffer_load_dwordx4 v[24:27], v0, s[16:19], s36 offen sc1
    s_add_u32 m0, s46, 122880
    s_mov_b32 s45, 245760
    buffer_load_dwordx4 v254, s[20:23], s45 offen sc1 lds
    v_mfma_f32_16x16x32_bf16 v[164:167], a[176:179], v[36:39], v[100:103]
    v_exp_f32 v172, v172
    v_mfma_f32_16x16x32_bf16 v[164:167], a[180:183], v[40:43], v[164:167]
    ds_read_b64_tr_b16 a[200:201], v6 offset:16384
    v_cvt_pk_bf16_f32 v227, v170, v171
    v_mfma_f32_16x16x32_bf16 v[164:167], a[184:187], v[44:47], v[164:167]
    v_exp_f32 v173, v173
    v_mfma_f32_16x16x32_bf16 v[164:167], a[188:191], v[48:51], v[164:167]
    ds_read_b64_tr_b16 a[202:203], v6 offset:20480
    v_mfma_f32_16x16x32_bf16 v[168:171], a[188:191], v[64:67], v[104:107]
    v_exp_f32 v174, v174
    v_mfma_f32_16x16x32_bf16 v[168:171], a[184:187], v[60:63], v[168:171]
    ds_read_b128 a[136:139], v3 offset:0
    v_cvt_pk_bf16_f32 v234, v172, v173
    v_mfma_f32_16x16x32_bf16 v[168:171], a[180:183], v[56:59], v[168:171]
    v_exp_f32 v175, v175
    v_mfma_f32_16x16x32_bf16 v[168:171], a[176:179], v[52:55], v[168:171]
    ds_read_b64_tr_b16 a[204:205], v6 offset:40960
    v_mfma_f32_16x16x32_bf16 a[112:115], a[216:219], v[180:183], a[112:115]
    s_add_u32 s36, s36, 4096
    buffer_load_dwordx4 v[28:31], v0, s[16:19], s36 offen sc1
    v_exp_f32 v176, v176
    v_mfma_f32_16x16x32_bf16 a[112:115], a[220:223], v[184:187], a[112:115]
    ds_read_b64_tr_b16 a[206:207], v6 offset:45056
    v_cvt_pk_bf16_f32 v235, v174, v175
    v_mfma_f32_16x16x32_bf16 a[116:119], a[220:223], v[192:195], a[116:119]
    v_exp_f32 v177, v177
    v_mfma_f32_16x16x32_bf16 a[116:119], a[216:219], v[188:191], a[116:119]
    ds_read_b128 a[140:143], v4 offset:0
    v_mfma_f32_16x16x32_bf16 a[120:123], a[216:219], v[196:199], a[120:123]
    v_exp_f32 v178, v178
    v_mfma_f32_16x16x32_bf16 a[120:123], a[220:223], v[200:203], a[120:123]
    v_cvt_pk_bf16_f32 v242, v176, v177
    v_mfma_f32_16x16x32_bf16 a[124:127], a[220:223], v[208:211], a[124:127]
    v_exp_f32 v179, v179
    v_mfma_f32_16x16x32_bf16 a[124:127], a[216:219], v[204:207], a[124:127]
    s_mov_b32 m0, s33
    s_nop 0
    buffer_load_dwordx4 v18, s[12:15], s29 offen offset:1024 lds
    v_smfmac_f32_16x16x64_bf16 a[236:239], v[244:247], v[204:211], v248
    s_waitcnt lgkmcnt(6)
    s_add_u32 s36, s36, 4096
    buffer_load_dwordx4 v[32:35], v0, s[16:19], s36 offen sc1
    s_add_u32 m0, s46, 123904
    s_mov_b32 s45, 246784
    buffer_load_dwordx4 v254, s[20:23], s45 offen sc1 lds
    v_mfma_f32_16x16x32_bf16 v[172:175], a[176:179], v[68:71], v[108:111]
    v_exp_f32 v116, v116
    v_mfma_f32_16x16x32_bf16 v[172:175], a[180:183], v[72:75], v[172:175]
    ds_read_b64_tr_b16 a[208:209], v7 offset:16384
    v_cvt_pk_bf16_f32 v243, v178, v179
    v_mfma_f32_16x16x32_bf16 v[172:175], a[184:187], v[76:79], v[172:175]
    v_exp_f32 v117, v117
    v_mfma_f32_16x16x32_bf16 v[172:175], a[188:191], v[80:83], v[172:175]
    ds_read_b64_tr_b16 a[210:211], v7 offset:20480
    v_mfma_f32_16x16x32_bf16 v[176:179], a[188:191], v[96:99], v[112:115]
    v_exp_f32 v118, v118
    v_mfma_f32_16x16x32_bf16 v[176:179], a[184:187], v[92:95], v[176:179]
    ds_read_b128 a[144:147], v1 offset:4096
    v_cvt_pk_bf16_f32 v180, v116, v117
    v_mfma_f32_16x16x32_bf16 v[176:179], a[180:183], v[88:91], v[176:179]
    v_exp_f32 v119, v119
    v_mfma_f32_16x16x32_bf16 v[176:179], a[176:179], v[84:87], v[176:179]
    ds_read_b64_tr_b16 a[212:213], v7 offset:40960
    v_mfma_f32_16x16x32_bf16 a[0:3], a[192:195], v[212:215], a[0:3]
    v_exp_f32 v120, v120
    v_mfma_f32_16x16x32_bf16 a[0:3], a[196:199], v[216:219], a[0:3]
    ds_read_b64_tr_b16 a[214:215], v7 offset:45056
    v_cvt_pk_bf16_f32 v181, v118, v119
    v_mfma_f32_16x16x32_bf16 a[4:7], a[196:199], v[224:227], a[4:7]
    s_add_u32 s36, s36, 4096
    buffer_load_dwordx4 a[240:243], v0, s[16:19], s36 offen sc1
    v_exp_f32 v121, v121
    v_mfma_f32_16x16x32_bf16 a[4:7], a[192:195], v[220:223], a[4:7]
    ds_read_b128 a[148:151], v2 offset:4096
    v_cvt_pk_bf16_f32 v188, v120, v121
    v_mfma_f32_16x16x32_bf16 a[8:11], a[192:195], v[228:231], a[8:11]
    v_exp_f32 v122, v122
    v_mfma_f32_16x16x32_bf16 a[8:11], a[196:199], v[232:235], a[8:11]
    s_mov_b32 m0, s33
    s_nop 0
    buffer_load_dwordx4 v17, s[12:15], s29 offen offset:2048 lds
    v_mfma_f32_16x16x32_bf16 a[12:15], a[196:199], v[240:243], a[12:15]
    v_exp_f32 v123, v123
    v_mfma_f32_16x16x32_bf16 a[12:15], a[192:195], v[236:239], a[12:15]
    s_waitcnt lgkmcnt(6)
    s_add_u32 s36, s36, 4096
    buffer_load_dwordx4 a[244:247], v0, s[16:19], s36 offen sc1
    v_mfma_f32_16x16x32_bf16 v[116:119], a[128:131], v[36:39], v[100:103]
    v_exp_f32 v124, v124
    v_mfma_f32_16x16x32_bf16 v[116:119], a[132:135], v[40:43], v[116:119]
    ds_read_b64_tr_b16 a[216:217], v8 offset:16384
    v_cvt_pk_bf16_f32 v189, v122, v123
    v_mfma_f32_16x16x32_bf16 v[116:119], a[136:139], v[44:47], v[116:119]
    v_exp_f32 v125, v125
    v_mfma_f32_16x16x32_bf16 v[116:119], a[140:143], v[48:51], v[116:119]
    ds_read_b64_tr_b16 a[218:219], v8 offset:20480
    v_mfma_f32_16x16x32_bf16 v[120:123], a[140:143], v[64:67], v[104:107]
    v_exp_f32 v126, v126
    v_mfma_f32_16x16x32_bf16 v[120:123], a[136:139], v[60:63], v[120:123]
    ds_read_b128 a[152:155], v3 offset:4096
    v_cvt_pk_bf16_f32 v196, v124, v125
    v_mfma_f32_16x16x32_bf16 v[120:123], a[132:135], v[56:59], v[120:123]
    v_exp_f32 v127, v127
    v_mfma_f32_16x16x32_bf16 v[120:123], a[128:131], v[52:55], v[120:123]
    ds_read_b64_tr_b16 a[220:221], v8 offset:40960
    v_mfma_f32_16x16x32_bf16 a[16:19], a[200:203], v[212:215], a[16:19]
    v_exp_f32 v128, v128
    v_mfma_f32_16x16x32_bf16 a[16:19], a[204:207], v[216:219], a[16:19]
    ds_read_b64_tr_b16 a[222:223], v8 offset:45056
    v_cvt_pk_bf16_f32 v197, v126, v127
    v_mfma_f32_16x16x32_bf16 a[20:23], a[204:207], v[224:227], a[20:23]
    v_exp_f32 v129, v129
    v_mfma_f32_16x16x32_bf16 a[20:23], a[200:203], v[220:223], a[20:23]
    ds_read_b128 a[156:159], v4 offset:4096
    v_mfma_f32_16x16x32_bf16 a[24:27], a[200:203], v[228:231], a[24:27]
    v_exp_f32 v130, v130
    v_mfma_f32_16x16x32_bf16 a[24:27], a[204:207], v[232:235], a[24:27]
    v_cvt_pk_bf16_f32 v204, v128, v129
    v_mfma_f32_16x16x32_bf16 a[28:31], a[204:207], v[240:243], a[28:31]
    v_exp_f32 v131, v131
    v_mfma_f32_16x16x32_bf16 a[28:31], a[200:203], v[236:239], a[28:31]
    s_mov_b32 m0, s33
    s_nop 0
    buffer_load_dwordx4 v18, s[12:15], s29 offen offset:3072 lds
    v_smfmac_f32_16x16x64_bf16 a[224:227], v[244:247], v[212:219], v248
    s_waitcnt lgkmcnt(6)
    s_add_u32 s29, s29, 16384
    s_add_u32 s36, s36, 4096
    s_cmp_eq_u32 s5, 3
    s_cselect_b32 s36, 0x438000, s36
    buffer_load_dwordx4 a[248:251], v0, s[16:19], s36 offen sc1
    v_mfma_f32_16x16x32_bf16 v[124:127], a[128:131], v[68:71], v[108:111]
    s_add_u32 m0, s46, 124928
    v_exp_f32 v132, v132
    v_mfma_f32_16x16x32_bf16 v[124:127], a[132:135], v[72:75], v[124:127]
    s_mov_b32 s45, 247808
    ds_read_b64_tr_b16 a[192:193], v9 offset:16384
    v_cvt_pk_bf16_f32 v205, v130, v131
    v_mfma_f32_16x16x32_bf16 v[124:127], a[136:139], v[76:79], v[124:127]
    v_exp_f32 v133, v133
    v_mfma_f32_16x16x32_bf16 v[124:127], a[140:143], v[80:83], v[124:127]
    ds_read_b64_tr_b16 a[194:195], v9 offset:20480
    v_mfma_f32_16x16x32_bf16 v[128:131], a[140:143], v[96:99], v[112:115]
    v_exp_f32 v134, v134
    v_mfma_f32_16x16x32_bf16 v[128:131], a[136:139], v[92:95], v[128:131]
    ds_read_b128 a[160:163], v1 offset:8192
    v_cvt_pk_bf16_f32 v182, v132, v133
    v_mfma_f32_16x16x32_bf16 v[128:131], a[132:135], v[88:91], v[128:131]
    v_exp_f32 v135, v135
    v_mfma_f32_16x16x32_bf16 v[128:131], a[128:131], v[84:87], v[128:131]
    ds_read_b64_tr_b16 a[196:197], v9 offset:40960
    buffer_load_dwordx4 v254, s[20:23], s45 offen sc1 lds
    v_mfma_f32_16x16x32_bf16 a[32:35], a[208:211], v[212:215], a[32:35]
    s_add_u32 m0, s46, 125952
    v_exp_f32 v136, v136
    v_mfma_f32_16x16x32_bf16 a[32:35], a[212:215], v[216:219], a[32:35]
    s_mov_b32 s45, 248832
    ds_read_b64_tr_b16 a[198:199], v9 offset:45056
    v_cvt_pk_bf16_f32 v183, v134, v135
    v_mfma_f32_16x16x32_bf16 a[36:39], a[212:215], v[224:227], a[36:39]
    v_exp_f32 v137, v137
    v_mfma_f32_16x16x32_bf16 a[36:39], a[208:211], v[220:223], a[36:39]
    ds_read_b128 a[164:167], v2 offset:8192
    v_cvt_pk_bf16_f32 v190, v136, v137
    v_mfma_f32_16x16x32_bf16 a[40:43], a[208:211], v[228:231], a[40:43]
    v_exp_f32 v138, v138
    v_mfma_f32_16x16x32_bf16 a[40:43], a[212:215], v[232:235], a[40:43]
    buffer_load_dwordx4 v254, s[20:23], s45 offen sc1 lds
    v_mfma_f32_16x16x32_bf16 a[44:47], a[212:215], v[240:243], a[44:47]
    s_add_u32 m0, s46, 126976
    v_exp_f32 v139, v139
    v_mfma_f32_16x16x32_bf16 a[44:47], a[208:211], v[236:239], a[44:47]
    s_waitcnt lgkmcnt(6)
    v_mfma_f32_16x16x32_bf16 v[132:135], a[144:147], v[36:39], v[100:103]
    s_mov_b32 s45, 249856
    v_exp_f32 v140, v140
    v_mfma_f32_16x16x32_bf16 v[132:135], a[148:151], v[40:43], v[132:135]
    ds_read_b64_tr_b16 a[200:201], v10 offset:16384
    v_cvt_pk_bf16_f32 v191, v138, v139
    v_mfma_f32_16x16x32_bf16 v[132:135], a[152:155], v[44:47], v[132:135]
    v_exp_f32 v141, v141
    v_mfma_f32_16x16x32_bf16 v[132:135], a[156:159], v[48:51], v[132:135]
    ds_read_b64_tr_b16 a[202:203], v10 offset:20480
    v_mfma_f32_16x16x32_bf16 v[136:139], a[156:159], v[64:67], v[104:107]
    v_exp_f32 v142, v142
    v_mfma_f32_16x16x32_bf16 v[136:139], a[152:155], v[60:63], v[136:139]
    ds_read_b128 a[168:171], v3 offset:8192
    v_cvt_pk_bf16_f32 v198, v140, v141
    v_mfma_f32_16x16x32_bf16 v[136:139], a[148:151], v[56:59], v[136:139]
    v_exp_f32 v143, v143
    v_mfma_f32_16x16x32_bf16 v[136:139], a[144:147], v[52:55], v[136:139]
    ds_read_b64_tr_b16 a[204:205], v10 offset:40960
    v_mfma_f32_16x16x32_bf16 a[48:51], a[216:219], v[212:215], a[48:51]
    buffer_load_dwordx4 v254, s[20:23], s45 offen sc1 lds
    v_exp_f32 v144, v144
    v_mfma_f32_16x16x32_bf16 a[48:51], a[220:223], v[216:219], a[48:51]
    s_add_u32 m0, s46, 128000
    ds_read_b64_tr_b16 a[206:207], v10 offset:45056
    v_cvt_pk_bf16_f32 v199, v142, v143
    v_mfma_f32_16x16x32_bf16 a[52:55], a[220:223], v[224:227], a[52:55]
    s_mov_b32 s45, 266240
    v_exp_f32 v145, v145
    v_mfma_f32_16x16x32_bf16 a[52:55], a[216:219], v[220:223], a[52:55]
    ds_read_b128 a[172:175], v4 offset:8192
    v_cvt_pk_bf16_f32 v206, v144, v145
    v_mfma_f32_16x16x32_bf16 a[56:59], a[216:219], v[228:231], a[56:59]
    v_exp_f32 v146, v146
    v_mfma_f32_16x16x32_bf16 a[56:59], a[220:223], v[232:235], a[56:59]
    buffer_load_dwordx4 v254, s[20:23], s45 offen sc1 lds
    v_mfma_f32_16x16x32_bf16 a[60:63], a[220:223], v[240:243], a[60:63]
    s_add_u32 m0, s46, 129024
    v_exp_f32 v147, v147
    v_mfma_f32_16x16x32_bf16 a[60:63], a[216:219], v[236:239], a[60:63]
    s_mov_b32 s45, 267264
    buffer_load_dwordx4 v254, s[20:23], s45 offen sc1 lds
    v_smfmac_f32_16x16x64_bf16 a[228:231], v[244:247], v[220:227], v248
    s_waitcnt lgkmcnt(6)
    v_mfma_f32_16x16x32_bf16 v[140:143], a[144:147], v[68:71], v[108:111]
    s_add_u32 m0, s46, 130048
    v_exp_f32 v148, v148
    v_mfma_f32_16x16x32_bf16 v[140:143], a[148:151], v[72:75], v[140:143]
    s_mov_b32 s45, 268288
    ds_read_b64_tr_b16 a[208:209], v11 offset:16384
    v_cvt_pk_bf16_f32 v207, v146, v147
    v_mfma_f32_16x16x32_bf16 v[140:143], a[152:155], v[76:79], v[140:143]
    v_exp_f32 v149, v149
    v_mfma_f32_16x16x32_bf16 v[140:143], a[156:159], v[80:83], v[140:143]
    ds_read_b64_tr_b16 a[210:211], v11 offset:20480
    v_mfma_f32_16x16x32_bf16 v[144:147], a[156:159], v[96:99], v[112:115]
    v_exp_f32 v150, v150
    v_mfma_f32_16x16x32_bf16 v[144:147], a[152:155], v[92:95], v[144:147]
    ds_read_b128 a[176:179], v1 offset:12288
    v_cvt_pk_bf16_f32 v184, v148, v149
    v_mfma_f32_16x16x32_bf16 v[144:147], a[148:151], v[88:91], v[144:147]
    v_exp_f32 v151, v151
    v_mfma_f32_16x16x32_bf16 v[144:147], a[144:147], v[84:87], v[144:147]
    ds_read_b64_tr_b16 a[212:213], v11 offset:40960
    v_mfma_f32_16x16x32_bf16 a[64:67], a[192:195], v[212:215], a[64:67]
    v_exp_f32 v152, v152
    v_mfma_f32_16x16x32_bf16 a[64:67], a[196:199], v[216:219], a[64:67]
    ds_read_b64_tr_b16 a[214:215], v11 offset:45056
    v_cvt_pk_bf16_f32 v185, v150, v151
    v_mfma_f32_16x16x32_bf16 a[68:71], a[196:199], v[224:227], a[68:71]
    v_exp_f32 v153, v153
    v_mfma_f32_16x16x32_bf16 a[68:71], a[192:195], v[220:223], a[68:71]
    ds_read_b128 a[180:183], v2 offset:12288
    v_cvt_pk_bf16_f32 v192, v152, v153
    v_mfma_f32_16x16x32_bf16 a[72:75], a[192:195], v[228:231], a[72:75]
    v_exp_f32 v154, v154
    v_mfma_f32_16x16x32_bf16 a[72:75], a[196:199], v[232:235], a[72:75]
    buffer_load_dwordx4 v254, s[20:23], s45 offen sc1 lds
    v_mfma_f32_16x16x32_bf16 a[76:79], a[196:199], v[240:243], a[76:79]
    s_add_u32 m0, s46, 131072
    v_exp_f32 v155, v155
    v_mfma_f32_16x16x32_bf16 a[76:79], a[192:195], v[236:239], a[76:79]
    s_waitcnt lgkmcnt(6)
    v_mfma_f32_16x16x32_bf16 v[148:151], a[160:163], v[36:39], v[100:103]
    s_mov_b32 s45, 269312
    v_exp_f32 v156, v156
    v_mfma_f32_16x16x32_bf16 v[148:151], a[164:167], v[40:43], v[148:151]
    ds_read_b64_tr_b16 a[216:217], v12 offset:16384
    v_cvt_pk_bf16_f32 v193, v154, v155
    v_mfma_f32_16x16x32_bf16 v[148:151], a[168:171], v[44:47], v[148:151]
    v_exp_f32 v157, v157
    v_mfma_f32_16x16x32_bf16 v[148:151], a[172:175], v[48:51], v[148:151]
    ds_read_b64_tr_b16 a[218:219], v12 offset:20480
    v_mfma_f32_16x16x32_bf16 v[152:155], a[172:175], v[64:67], v[104:107]
    v_exp_f32 v158, v158
    v_mfma_f32_16x16x32_bf16 v[152:155], a[168:171], v[60:63], v[152:155]
    ds_read_b128 a[184:187], v3 offset:12288
    v_cvt_pk_bf16_f32 v200, v156, v157
    v_mfma_f32_16x16x32_bf16 v[152:155], a[164:167], v[56:59], v[152:155]
    v_exp_f32 v159, v159
    v_mfma_f32_16x16x32_bf16 v[152:155], a[160:163], v[52:55], v[152:155]
    ds_read_b64_tr_b16 a[220:221], v12 offset:40960
    v_mfma_f32_16x16x32_bf16 a[80:83], a[200:203], v[212:215], a[80:83]
    buffer_load_dwordx4 v254, s[20:23], s45 offen sc1 lds
    v_exp_f32 v160, v160
    v_mfma_f32_16x16x32_bf16 a[80:83], a[204:207], v[216:219], a[80:83]
    s_add_u32 m0, s46, 132096
    ds_read_b64_tr_b16 a[222:223], v12 offset:45056
    v_cvt_pk_bf16_f32 v201, v158, v159
    v_mfma_f32_16x16x32_bf16 a[84:87], a[204:207], v[224:227], a[84:87]
    s_mov_b32 s45, 270336
    v_exp_f32 v161, v161
    v_mfma_f32_16x16x32_bf16 a[84:87], a[200:203], v[220:223], a[84:87]
    ds_read_b128 a[188:191], v4 offset:12288
    v_cvt_pk_bf16_f32 v208, v160, v161
    v_mfma_f32_16x16x32_bf16 a[88:91], a[200:203], v[228:231], a[88:91]
    v_exp_f32 v162, v162
    v_mfma_f32_16x16x32_bf16 a[88:91], a[204:207], v[232:235], a[88:91]
    buffer_load_dwordx4 v254, s[20:23], s45 offen sc1 lds
    v_mfma_f32_16x16x32_bf16 a[92:95], a[204:207], v[240:243], a[92:95]
    v_exp_f32 v163, v163
    v_mfma_f32_16x16x32_bf16 a[92:95], a[200:203], v[236:239], a[92:95]
    v_smfmac_f32_16x16x64_bf16 a[232:235], v[244:247], v[228:235], v248
    s_waitcnt vmcnt(21) lgkmcnt(0)
    s_barrier
    v_mfma_f32_16x16x32_bf16 v[156:159], a[160:163], v[68:71], v[108:111]
    s_waitcnt vmcnt(8)
    v_exp_f32 v164, v164
    v_mfma_f32_16x16x32_bf16 v[156:159], a[164:167], v[72:75], v[156:159]
    s_add_u32 m0, s46, 81920
    ds_read_b64_tr_b16 a[192:193], v5 offset:57344
    v_cvt_pk_bf16_f32 v209, v162, v163
    v_mfma_f32_16x16x32_bf16 v[156:159], a[168:171], v[76:79], v[156:159]
    s_mov_b32 s45, 286720
    v_exp_f32 v165, v165
    v_add_f32 v20, v20, v24
    v_mfma_f32_16x16x32_bf16 v[156:159], a[172:175], v[80:83], v[156:159]
    ds_read_b64_tr_b16 a[194:195], v5 offset:61440
    v_add_f32 v21, v21, v25
    v_mfma_f32_16x16x32_bf16 v[160:163], a[172:175], v[96:99], v[112:115]
    v_exp_f32 v166, v166
    v_mfma_f32_16x16x32_bf16 v[160:163], a[168:171], v[92:95], v[160:163]
    ds_read_b64_tr_b16 a[196:197], v5 offset:0
    buffer_load_dwordx4 v254, s[20:23], s45 offen sc1 lds
    v_cvt_pk_bf16_f32 v186, v164, v165
    v_add_f32 v22, v22, v26
    v_mfma_f32_16x16x32_bf16 v[160:163], a[164:167], v[88:91], v[160:163]
    s_add_u32 m0, s46, 82944
    v_exp_f32 v167, v167
    v_add_f32 v23, v23, v27
    v_mfma_f32_16x16x32_bf16 v[160:163], a[160:163], v[84:87], v[160:163]
    s_mov_b32 s45, 287744
    ds_read_b64_tr_b16 a[198:199], v5 offset:4096
    v_add_f32 v20, v20, v28
    v_mfma_f32_16x16x32_bf16 a[96:99], a[208:211], v[212:215], a[96:99]
    v_exp_f32 v168, v168
    v_add_f32 v21, v21, v29
    v_mfma_f32_16x16x32_bf16 a[96:99], a[212:215], v[216:219], a[96:99]
    v_cvt_pk_bf16_f32 v187, v166, v167
    v_add_f32 v22, v22, v30
    v_mfma_f32_16x16x32_bf16 a[100:103], a[212:215], v[224:227], a[100:103]
    buffer_load_dwordx4 v254, s[20:23], s45 offen sc1 lds
    v_exp_f32 v169, v169
    v_mfma_f32_16x16x32_bf16 a[100:103], a[208:211], v[220:223], a[100:103]
    s_add_u32 m0, s46, 83968
    v_cvt_pk_bf16_f32 v194, v168, v169
    v_add_f32 v23, v23, v31
    v_mfma_f32_16x16x32_bf16 a[104:107], a[208:211], v[228:231], a[104:107]
    s_mov_b32 s45, 288768
    v_exp_f32 v170, v170
    v_add_f32 v20, v20, v32
    v_mfma_f32_16x16x32_bf16 a[104:107], a[212:215], v[232:235], a[104:107]
    v_add_f32 v21, v21, v33
    v_add_f32 v22, v22, v34
    v_mfma_f32_16x16x32_bf16 a[108:111], a[212:215], v[240:243], a[108:111]
    v_exp_f32 v171, v171
    v_mfma_f32_16x16x32_bf16 a[108:111], a[208:211], v[236:239], a[108:111]
    s_waitcnt lgkmcnt(4)
    buffer_load_dwordx4 v254, s[20:23], s45 offen sc1 lds
    v_add_f32 v23, v23, v35
    v_accvgpr_read_b32 v24, a240
    v_mfma_f32_16x16x32_bf16 v[164:167], a[176:179], v[36:39], v[100:103]
    s_add_u32 m0, s46, 84992
    v_exp_f32 v172, v172
    v_mfma_f32_16x16x32_bf16 v[164:167], a[180:183], v[40:43], v[164:167]
    s_mov_b32 s45, 289792
    ds_read_b64_tr_b16 a[200:201], v6 offset:57344
    v_cvt_pk_bf16_f32 v195, v170, v171
    v_mfma_f32_16x16x32_bf16 v[164:167], a[184:187], v[44:47], v[164:167]
    v_exp_f32 v173, v173
    v_mfma_f32_16x16x32_bf16 v[164:167], a[188:191], v[48:51], v[164:167]
    ds_read_b64_tr_b16 a[202:203], v6 offset:61440
    v_accvgpr_read_b32 v25, a241
    v_mfma_f32_16x16x32_bf16 v[168:171], a[188:191], v[64:67], v[104:107]
    v_exp_f32 v174, v174
    v_accvgpr_read_b32 v26, a242
    v_mfma_f32_16x16x32_bf16 v[168:171], a[184:187], v[60:63], v[168:171]
    ds_read_b64_tr_b16 a[204:205], v6 offset:0
    buffer_load_dwordx4 v254, s[20:23], s45 offen sc1 lds
    v_cvt_pk_bf16_f32 v202, v172, v173
    v_mfma_f32_16x16x32_bf16 v[168:171], a[180:183], v[56:59], v[168:171]
    s_add_u32 m0, s46, 86016
    v_exp_f32 v175, v175
    v_accvgpr_read_b32 v27, a243
    v_mfma_f32_16x16x32_bf16 v[168:171], a[176:179], v[52:55], v[168:171]
    s_mov_b32 s45, 290816
    ds_read_b64_tr_b16 a[206:207], v6 offset:4096
    v_accvgpr_read_b32 v28, a244
    v_mfma_f32_16x16x32_bf16 a[112:115], a[216:219], v[212:215], a[112:115]
    v_exp_f32 v176, v176
    v_accvgpr_read_b32 v29, a245
    v_mfma_f32_16x16x32_bf16 a[112:115], a[220:223], v[216:219], a[112:115]
    v_cvt_pk_bf16_f32 v203, v174, v175
    v_accvgpr_read_b32 v30, a246
    v_mfma_f32_16x16x32_bf16 a[116:119], a[220:223], v[224:227], a[116:119]
    v_exp_f32 v177, v177
    v_mfma_f32_16x16x32_bf16 a[116:119], a[216:219], v[220:223], a[116:119]
    buffer_load_dwordx4 v254, s[20:23], s45 offen sc1 lds
    v_cvt_pk_bf16_f32 v210, v176, v177
    v_accvgpr_read_b32 v31, a247
    v_mfma_f32_16x16x32_bf16 a[120:123], a[216:219], v[228:231], a[120:123]
    s_add_u32 m0, s46, 87040
    v_exp_f32 v178, v178
    v_accvgpr_read_b32 v32, a248
    v_mfma_f32_16x16x32_bf16 a[120:123], a[220:223], v[232:235], a[120:123]
    s_mov_b32 s45, 307200
    v_accvgpr_read_b32 v33, a249
    v_accvgpr_read_b32 v34, a250
    v_mfma_f32_16x16x32_bf16 a[124:127], a[220:223], v[240:243], a[124:127]
    v_exp_f32 v179, v179
    v_mfma_f32_16x16x32_bf16 a[124:127], a[216:219], v[236:239], a[124:127]
    v_accvgpr_read_b32 v35, a251
    v_smfmac_f32_16x16x64_bf16 a[236:239], v[244:247], v[236:243], v248
    s_waitcnt lgkmcnt(4)
    buffer_load_dwordx4 v254, s[20:23], s45 offen sc1 lds
    v_mfma_f32_16x16x32_bf16 v[172:175], a[176:179], v[68:71], v[108:111]
    s_add_u32 m0, s46, 88064
    v_exp_f32 v116, v116
    v_mfma_f32_16x16x32_bf16 v[172:175], a[180:183], v[72:75], v[172:175]
    s_mov_b32 s45, 308224
    ds_read_b64_tr_b16 a[208:209], v7 offset:57344
    v_cvt_pk_bf16_f32 v211, v178, v179
    v_add_f32 v20, v20, v24
    v_mfma_f32_16x16x32_bf16 v[172:175], a[184:187], v[76:79], v[172:175]
    v_exp_f32 v117, v117
    v_mfma_f32_16x16x32_bf16 v[172:175], a[188:191], v[80:83], v[172:175]
    ds_read_b64_tr_b16 a[210:211], v7 offset:61440
    v_add_f32 v21, v21, v25
    v_mfma_f32_16x16x32_bf16 v[176:179], a[188:191], v[96:99], v[112:115]
    v_exp_f32 v118, v118
    v_mfma_f32_16x16x32_bf16 v[176:179], a[184:187], v[92:95], v[176:179]
    ds_read_b64_tr_b16 a[212:213], v7 offset:0
    v_cvt_pk_bf16_f32 v212, v116, v117
    v_add_f32 v22, v22, v26
    v_mfma_f32_16x16x32_bf16 v[176:179], a[180:183], v[88:91], v[176:179]
    v_exp_f32 v119, v119
    v_add_f32 v23, v23, v27
    v_mfma_f32_16x16x32_bf16 v[176:179], a[176:179], v[84:87], v[176:179]
    ds_read_b64_tr_b16 a[214:215], v7 offset:4096
    v_add_f32 v20, v20, v28
    v_mfma_f32_16x16x32_bf16 a[0:3], a[192:195], v[180:183], a[0:3]
    v_exp_f32 v120, v120
    v_mfma_f32_16x16x32_bf16 a[0:3], a[196:199], v[184:187], a[0:3]
    v_cvt_pk_bf16_f32 v213, v118, v119
    v_add_f32 v21, v21, v29
    v_mfma_f32_16x16x32_bf16 a[4:7], a[196:199], v[192:195], a[4:7]
    v_exp_f32 v121, v121
    v_mfma_f32_16x16x32_bf16 a[4:7], a[192:195], v[188:191], a[4:7]
    buffer_load_dwordx4 v254, s[20:23], s45 offen sc1 lds
    v_mfma_f32_16x16x32_bf16 a[8:11], a[192:195], v[196:199], a[8:11]
    s_add_u32 m0, s46, 89088
    v_exp_f32 v122, v122
    v_add_f32 v22, v22, v30
    v_mfma_f32_16x16x32_bf16 a[8:11], a[196:199], v[200:203], a[8:11]
    s_mov_b32 s45, 309248
    v_cvt_pk_bf16_f32 v220, v120, v121
    v_add_f32 v23, v23, v31
    v_mfma_f32_16x16x32_bf16 a[12:15], a[196:199], v[208:211], a[12:15]
    v_exp_f32 v123, v123
    v_mfma_f32_16x16x32_bf16 a[12:15], a[192:195], v[204:207], a[12:15]
    s_waitcnt lgkmcnt(4)
    buffer_load_dwordx4 v254, s[20:23], s45 offen sc1 lds
    v_add_f32 v20, v20, v32
    v_mfma_f32_16x16x32_bf16 a[16:19], a[200:203], v[180:183], a[16:19]
    s_add_u32 m0, s46, 90112
    ds_read_b64_tr_b16 a[216:217], v8 offset:57344
    v_cvt_pk_bf16_f32 v221, v122, v123
    v_exp_f32 v124, v124
    v_add_f32 v21, v21, v33
    v_mfma_f32_16x16x32_bf16 a[16:19], a[204:207], v[184:187], a[16:19]
    s_mov_b32 s45, 310272
    ds_read_b64_tr_b16 a[218:219], v8 offset:61440
    v_exp_f32 v125, v125
    v_add_f32 v22, v22, v34
    v_mfma_f32_16x16x32_bf16 a[20:23], a[204:207], v[192:195], a[20:23]
    ds_read_b64_tr_b16 a[220:221], v8 offset:0
    v_cvt_pk_bf16_f32 v228, v124, v125
    v_exp_f32 v126, v126
    v_add_f32 v23, v23, v35
    v_mfma_f32_16x16x32_bf16 a[20:23], a[200:203], v[188:191], a[20:23]
    ds_read_b64_tr_b16 a[222:223], v8 offset:4096
    v_exp_f32 v127, v127
    v_add_f32_dpp v20, v20, v20 row_ror:8 row_mask:0xf bank_mask:0xf
    v_mfma_f32_16x16x32_bf16 a[24:27], a[200:203], v[196:199], a[24:27]
    v_cvt_pk_bf16_f32 v229, v126, v127
    v_exp_f32 v128, v128
    v_mov_b32 v114, v254
    v_add_f32_dpp v21, v21, v21 row_ror:8 row_mask:0xf bank_mask:0xf
    v_mfma_f32_16x16x32_bf16 a[24:27], a[204:207], v[200:203], a[24:27]
    v_exp_f32 v129, v129
    v_add_f32_dpp v22, v22, v22 row_ror:8 row_mask:0xf bank_mask:0xf
    v_mfma_f32_16x16x32_bf16 a[28:31], a[204:207], v[208:211], a[28:31]
    v_cvt_pk_bf16_f32 v236, v128, v129
    v_exp_f32 v130, v130
    v_add_f32_dpp v23, v23, v23 row_ror:8 row_mask:0xf bank_mask:0xf
    v_mfma_f32_16x16x32_bf16 a[28:31], a[200:203], v[204:207], a[28:31]
    v_exp_f32 v131, v131
    v_mov_b32 v24, v20
    v_smfmac_f32_16x16x64_bf16 a[224:227], v[244:247], v[180:187], v248
    s_waitcnt lgkmcnt(4)
    buffer_load_dwordx4 v254, s[20:23], s45 offen sc1 lds
    v_add_u32 v115, 4096, v254
    v_mov_b32 v25, v21
    v_mfma_f32_16x16x32_bf16 a[32:35], a[208:211], v[180:183], a[32:35]
    s_add_u32 m0, s46, 91136
    ds_read_b64_tr_b16 a[192:193], v9 offset:57344
    v_cvt_pk_bf16_f32 v237, v130, v131
    v_exp_f32 v132, v132
    v_mov_b32 v26, v22
    v_mfma_f32_16x16x32_bf16 a[32:35], a[212:215], v[184:187], a[32:35]
    s_mov_b32 s45, 311296
    ds_read_b64_tr_b16 a[194:195], v9 offset:61440
    v_exp_f32 v133, v133
    v_mov_b32 v27, v23
    v_mfma_f32_16x16x32_bf16 a[36:39], a[212:215], v[192:195], a[36:39]
    ds_read_b64_tr_b16 a[196:197], v9 offset:0
    v_cvt_pk_bf16_f32 v214, v132, v133
    v_exp_f32 v134, v134
    v_permlane16_swap_b32 v20, v24
    v_mfma_f32_16x16x32_bf16 a[36:39], a[208:211], v[188:191], a[36:39]
    ds_read_b64_tr_b16 a[198:199], v9 offset:4096
    v_exp_f32 v135, v135
    v_permlane16_swap_b32 v21, v25
    v_mfma_f32_16x16x32_bf16 a[40:43], a[208:211], v[196:199], a[40:43]
    v_cvt_pk_bf16_f32 v215, v134, v135
    v_exp_f32 v136, v136
    v_permlane16_swap_b32 v22, v26
    v_mfma_f32_16x16x32_bf16 a[40:43], a[212:215], v[200:203], a[40:43]
    v_exp_f32 v137, v137
    v_permlane16_swap_b32 v23, v27
    v_mfma_f32_16x16x32_bf16 a[44:47], a[212:215], v[208:211], a[44:47]
    v_cvt_pk_bf16_f32 v222, v136, v137
    v_exp_f32 v138, v138
    v_add_f32 v20, v20, v24
    v_mfma_f32_16x16x32_bf16 a[44:47], a[208:211], v[204:207], a[44:47]
    s_waitcnt lgkmcnt(4)
    buffer_load_dwordx4 v254, s[20:23], s45 offen sc1 lds
    v_exp_f32 v139, v139
    v_add_f32 v21, v21, v25
    v_mfma_f32_16x16x32_bf16 a[48:51], a[216:219], v[180:183], a[48:51]
    s_mov_b32 s45, 0
    ds_read_b64_tr_b16 a[200:201], v10 offset:57344
    v_cvt_pk_bf16_f32 v223, v138, v139
    v_exp_f32 v140, v140
    v_add_f32 v22, v22, v26
    v_mfma_f32_16x16x32_bf16 a[48:51], a[220:223], v[184:187], a[48:51]
    ds_read_b64_tr_b16 a[202:203], v10 offset:61440
    v_exp_f32 v141, v141
    v_add_f32 v23, v23, v27
    v_mfma_f32_16x16x32_bf16 a[52:55], a[220:223], v[192:195], a[52:55]
    ds_read_b64_tr_b16 a[204:205], v10 offset:0
    buffer_load_dwordx4 a[128:131], v114, s[20:23], s45 offen offset:0 sc1
    v_cvt_pk_bf16_f32 v230, v140, v141
    v_exp_f32 v142, v142
    v_mov_b32 v24, v20
    v_mfma_f32_16x16x32_bf16 a[52:55], a[216:219], v[188:191], a[52:55]
    s_mov_b32 s45, 0
    ds_read_b64_tr_b16 a[206:207], v10 offset:4096
    v_exp_f32 v143, v143
    v_mov_b32 v25, v21
    v_mfma_f32_16x16x32_bf16 a[56:59], a[216:219], v[196:199], a[56:59]
    v_cvt_pk_bf16_f32 v231, v142, v143
    v_exp_f32 v144, v144
    v_mov_b32 v26, v22
    v_mfma_f32_16x16x32_bf16 a[56:59], a[220:223], v[200:203], a[56:59]
    buffer_load_dwordx4 a[132:135], v114, s[20:23], s45 offen offset:1024 sc1
    v_exp_f32 v145, v145
    v_mov_b32 v27, v23
    v_mfma_f32_16x16x32_bf16 a[60:63], a[220:223], v[208:211], a[60:63]
    s_mov_b32 s45, 0
    v_cvt_pk_bf16_f32 v238, v144, v145
    v_exp_f32 v146, v146
    v_permlane32_swap_b32 v20, v24
    v_mfma_f32_16x16x32_bf16 a[60:63], a[216:219], v[204:207], a[60:63]
    v_exp_f32 v147, v147
    v_permlane32_swap_b32 v21, v25
    v_smfmac_f32_16x16x64_bf16 a[228:231], v[244:247], v[188:195], v248
    s_waitcnt lgkmcnt(4)
    buffer_load_dwordx4 a[136:139], v114, s[20:23], s45 offen offset:2048 sc1
    v_permlane32_swap_b32 v22, v26
    v_mfma_f32_16x16x32_bf16 a[64:67], a[192:195], v[180:183], a[64:67]
    s_mov_b32 s45, 0
    ds_read_b64_tr_b16 a[208:209], v11 offset:57344
    v_cvt_pk_bf16_f32 v239, v146, v147
    v_exp_f32 v148, v148
    v_permlane32_swap_b32 v23, v27
    v_mfma_f32_16x16x32_bf16 a[64:67], a[196:199], v[184:187], a[64:67]
    ds_read_b64_tr_b16 a[210:211], v11 offset:61440
    buffer_load_dwordx4 a[140:143], v114, s[20:23], s45 offen offset:3072 sc1
    v_exp_f32 v149, v149
    v_add_f32 v20, v20, v24
    v_add_f32 v21, v21, v25
    v_mfma_f32_16x16x32_bf16 a[68:71], a[196:199], v[192:195], a[68:71]
    s_mov_b32 s45, 0
    ds_read_b64_tr_b16 a[212:213], v11 offset:0
    v_cvt_pk_bf16_f32 v216, v148, v149
    v_exp_f32 v150, v150
    v_add_f32 v22, v22, v26
    v_mfma_f32_16x16x32_bf16 a[68:71], a[192:195], v[188:191], a[68:71]
    ds_read_b64_tr_b16 a[214:215], v11 offset:4096
    v_exp_f32 v151, v151
    v_add_f32 v23, v23, v27
    v_mfma_f32_16x16x32_bf16 a[72:75], a[192:195], v[196:199], a[72:75]
    buffer_load_dwordx4 a[144:147], v115, s[20:23], s45 offen offset:0 sc1
    v_cvt_pk_bf16_f32 v217, v150, v151
    v_exp_f32 v152, v152
    v_and_b32 v255, 7, v19
    v_mfma_f32_16x16x32_bf16 a[72:75], a[196:199], v[200:203], a[72:75]
    s_mov_b32 s45, 20480
    v_exp_f32 v153, v153
    v_lshlrev_b32 v255, 4, v255
    v_mfma_f32_16x16x32_bf16 a[76:79], a[196:199], v[208:211], a[76:79]
    buffer_load_dwordx4 a[148:151], v114, s[20:23], s45 offen offset:0 sc1
    v_cvt_pk_bf16_f32 v224, v152, v153
    v_exp_f32 v154, v154
    v_add_u32 v255, 65536, v255
    v_mfma_f32_16x16x32_bf16 a[76:79], a[192:195], v[204:207], a[76:79]
    s_waitcnt lgkmcnt(4)
    s_lshl_b32 s40, s5, 7
    v_exp_f32 v155, v155
    v_add_u32 v24, s40, v255
    ds_write_b128 v24, v[20:23]
    v_mfma_f32_16x16x32_bf16 a[80:83], a[200:203], v[180:183], a[80:83]
    s_mov_b32 s45, 20480
    ds_read_b64_tr_b16 a[216:217], v12 offset:57344
    v_cvt_pk_bf16_f32 v225, v154, v155
    v_exp_f32 v156, v156
    v_mfma_f32_16x16x32_bf16 a[80:83], a[204:207], v[184:187], a[80:83]
    ds_read_b64_tr_b16 a[218:219], v12 offset:61440
    buffer_load_dwordx4 a[152:155], v114, s[20:23], s45 offen offset:1024 sc1
    v_exp_f32 v157, v157
    v_mfma_f32_16x16x32_bf16 a[84:87], a[204:207], v[192:195], a[84:87]
    s_mov_b32 s45, 20480
    ds_read_b64_tr_b16 a[220:221], v12 offset:0
    v_cvt_pk_bf16_f32 v232, v156, v157
    v_exp_f32 v158, v158
    v_mfma_f32_16x16x32_bf16 a[84:87], a[200:203], v[188:191], a[84:87]
    ds_read_b64_tr_b16 a[222:223], v12 offset:4096
    v_exp_f32 v159, v159
    v_mfma_f32_16x16x32_bf16 a[88:91], a[200:203], v[196:199], a[88:91]
    buffer_load_dwordx4 a[156:159], v114, s[20:23], s45 offen offset:2048 sc1
    v_cvt_pk_bf16_f32 v233, v158, v159
    v_exp_f32 v160, v160
    v_mfma_f32_16x16x32_bf16 a[88:91], a[204:207], v[200:203], a[88:91]
    s_mov_b32 s45, 20480
    v_exp_f32 v161, v161
    v_mfma_f32_16x16x32_bf16 a[92:95], a[204:207], v[208:211], a[92:95]
    v_cvt_pk_bf16_f32 v240, v160, v161
    v_exp_f32 v162, v162
    v_mfma_f32_16x16x32_bf16 a[92:95], a[200:203], v[204:207], a[92:95]
    buffer_load_dwordx4 a[160:163], v114, s[20:23], s45 offen offset:3072 sc1
    v_exp_f32 v163, v163
    v_smfmac_f32_16x16x64_bf16 a[232:235], v[244:247], v[196:203], v248
    s_waitcnt vmcnt(28) lgkmcnt(0)
    s_barrier
    v_mfma_f32_16x16x32_bf16 a[96:99], a[208:211], v[180:183], a[96:99]
    s_mov_b32 s45, 20480
    ds_read_b64_tr_b16 a[192:193], v5 offset:24576
    buffer_load_dwordx4 a[164:167], v115, s[20:23], s45 offen offset:0 sc1
    ds_read_b128 v[20:23], v255 offset:0
    ds_read_b128 v[24:27], v255 offset:128
    ds_read_b128 v[28:31], v255 offset:256
    v_cvt_pk_bf16_f32 v241, v162, v163
    v_exp_f32 v164, v164
    v_mfma_f32_16x16x32_bf16 a[96:99], a[212:215], v[184:187], a[96:99]
    s_mov_b32 s45, 40960
    ds_read_b64_tr_b16 a[194:195], v5 offset:28672
    ds_read_b128 v[32:35], v255 offset:384
    v_exp_f32 v165, v165
    v_mfma_f32_16x16x32_bf16 a[100:103], a[212:215], v[192:195], a[100:103]
    s_mul_i32 s42, s6, 3277
    ds_read_b64_tr_b16 a[196:197], v5 offset:49152
    v_cvt_pk_bf16_f32 v218, v164, v165
    v_exp_f32 v166, v166
    v_mfma_f32_16x16x32_bf16 a[100:103], a[208:211], v[188:191], a[100:103]
    s_lshr_b32 s42, s42, 16
    ds_read_b64_tr_b16 a[198:199], v5 offset:53248
    buffer_load_dwordx4 a[168:171], v114, s[20:23], s45 offen offset:0 sc1
    v_exp_f32 v167, v167
    v_mfma_f32_16x16x32_bf16 a[104:107], a[208:211], v[196:199], a[104:107]
    s_mov_b32 s45, 40960
    v_cvt_pk_bf16_f32 v219, v166, v167
    v_exp_f32 v168, v168
    v_mfma_f32_16x16x32_bf16 a[104:107], a[212:215], v[200:203], a[104:107]
    s_min_u32 s42, s42, 7
    buffer_load_dwordx4 a[172:175], v114, s[20:23], s45 offen offset:1024 sc1
    v_exp_f32 v169, v169
    v_readlane_b32 s40, v249, s42
    v_mfma_f32_16x16x32_bf16 a[108:111], a[212:215], v[208:211], a[108:111]
    s_mov_b32 s45, 40960
    v_cvt_pk_bf16_f32 v226, v168, v169
    v_exp_f32 v170, v170
    v_mfma_f32_16x16x32_bf16 a[108:111], a[208:211], v[204:207], a[108:111]
    s_waitcnt lgkmcnt(4)
    v_exp_f32 v171, v171
    v_mfma_f32_16x16x32_bf16 a[112:115], a[216:219], v[180:183], a[112:115]
    s_and_b32 s40, s40, 0xffff0000
    ds_read_b64_tr_b16 a[200:201], v6 offset:24576
    buffer_load_dwordx4 a[176:179], v114, s[20:23], s45 offen offset:2048 sc1
    v_cvt_pk_bf16_f32 v227, v170, v171
    v_exp_f32 v172, v172
    v_mfma_f32_16x16x32_bf16 a[112:115], a[220:223], v[184:187], a[112:115]
    s_mov_b32 s45, 40960
    ds_read_b64_tr_b16 a[202:203], v6 offset:28672
    v_exp_f32 v173, v173
    v_mfma_f32_16x16x32_bf16 a[116:119], a[220:223], v[192:195], a[116:119]
    s_ashr_i32 s41, s40, 31
    ds_read_b64_tr_b16 a[204:205], v6 offset:49152
    v_cvt_pk_bf16_f32 v234, v172, v173
    v_exp_f32 v174, v174
    v_mfma_f32_16x16x32_bf16 a[116:119], a[216:219], v[188:191], a[116:119]
    s_andn2_b32 s41, 0x7fff0000, s41
    ds_read_b64_tr_b16 a[206:207], v6 offset:53248
    buffer_load_dwordx4 a[180:183], v114, s[20:23], s45 offen offset:3072 sc1
    v_exp_f32 v175, v175
    v_mfma_f32_16x16x32_bf16 a[120:123], a[216:219], v[196:199], a[120:123]
    s_mov_b32 s45, 40960
    v_cvt_pk_bf16_f32 v235, v174, v175
    v_exp_f32 v176, v176
    v_mfma_f32_16x16x32_bf16 a[120:123], a[220:223], v[200:203], a[120:123]
    s_or_b32 s41, s41, 0x80000000
    v_exp_f32 v177, v177
    v_mfma_f32_16x16x32_bf16 a[124:127], a[220:223], v[208:211], a[124:127]
    s_xor_b32 s40, s40, s41
    buffer_load_dwordx4 a[184:187], v115, s[20:23], s45 offen offset:0 sc1
    v_cvt_pk_bf16_f32 v242, v176, v177
    v_exp_f32 v178, v178
    v_mov_b32 v252, 0xbfb8aa3b
    v_mul_f32 v252, s40, v252
    v_exp_f32 v252, v252
    v_mfma_f32_16x16x32_bf16 a[124:127], a[216:219], v[204:207], a[124:127]
    s_mov_b32 s45, 61440
    v_exp_f32 v179, v179
    v_smfmac_f32_16x16x64_bf16 a[236:239], v[244:247], v[204:211], v248
    s_waitcnt lgkmcnt(4)
    s_nop 0
    buffer_load_dwordx4 a[188:191], v114, s[20:23], s45 offen offset:0 sc1
    v_add_f32 v252, 1.0, v252
    v_rcp_f32 v252, v252
    s_nop 0
    v_cvt_pk_bf16_f32 v252, v252, v252
    v_lshlrev_b32 v252, 16, v252
    s_lshl_b32 s40, s6, 6
    s_add_u32 s40, s40, 0x29c000
    s_lshl_b32 s41, s5, 8
    s_add_u32 s41, s41, s6
    s_cmp_lt_u32 s41, 160
    s_cselect_b32 s40, s40, 0x2500000
    v_lshlrev_b32 v253, 3, v19
    s_waitcnt lgkmcnt(0)
    v_add_f32 v20, v20, v24
    v_add_f32 v21, v21, v25
    v_add_f32 v22, v22, v26
    v_add_f32 v23, v23, v27
    v_add_f32 v20, v20, v28
    v_add_f32 v21, v21, v29
    v_add_f32 v22, v22, v30
    v_add_f32 v23, v23, v31
    v_add_f32 v20, v20, v32
    v_add_f32 v21, v21, v33
    v_add_f32 v22, v22, v34
    v_add_f32 v23, v23, v35
    v_cvt_pk_bf16_f32 v24, v20, v21
    v_cvt_pk_bf16_f32 v25, v22, v23
    v_lshlrev_b32 v20, 16, v24
    v_and_b32 v21, 0xffff0000, v24
    v_lshlrev_b32 v22, 16, v25
    v_and_b32 v23, 0xffff0000, v25
    v_mul_f32 v20, v20, v252
    v_mul_f32 v21, v21, v252
    v_mul_f32 v22, v22, v252
    v_mul_f32 v23, v23, v252
    v_cvt_pk_bf16_f32 v24, v20, v21
    v_cvt_pk_bf16_f32 v25, v22, v23
    s_mov_b64 exec, 0xff
    buffer_store_dwordx2 v[24:25], v253, s[76:79], s40 offen sc1
    s_mov_b64 exec, -1
    v_mfma_f32_16x16x32_bf16 a[0:3], a[192:195], v[212:215], a[0:3]
    s_lshl_b32 s40, s87, 2
    ds_read_b64_tr_b16 a[208:209], v7 offset:24576
    v_cvt_pk_bf16_f32 v243, v178, v179
    v_mfma_f32_16x16x32_bf16 a[0:3], a[196:199], v[216:219], a[0:3]
    s_add_u32 s40, s40, s5
    ds_read_b64_tr_b16 a[210:211], v7 offset:28672
    v_smfmac_f32_16x16x64_bf16 a[224:227], v[244:247], v[212:219], v248
    s_lshl_b32 s40, s40, 4
    ds_read_b64_tr_b16 a[212:213], v7 offset:49152
    v_and_b32 v35, 15, v19
    v_smfmac_f32_16x16x64_bf16 a[228:231], v[244:247], v[220:227], v248
    ds_read_b64_tr_b16 a[214:215], v7 offset:53248
    v_add_u32 v35, s40, v35
    v_smfmac_f32_16x16x64_bf16 a[232:235], v[244:247], v[228:235], v248
    v_mul_u32_u24 v34, 1280, v35
    v_lshrrev_b32 v116, 4, v19
    v_smfmac_f32_16x16x64_bf16 a[236:239], v[244:247], v[236:243], v248
    v_lshl_add_u32 v34, v116, 3, v34
    v_mfma_f32_16x16x32_bf16 a[4:7], a[196:199], v[224:227], a[4:7]
    s_mul_i32 s40, s100, 160
    v_add_u32 v34, s40, v34
    v_lshlrev_b32 v116, 4, v35
    v_mfma_f32_16x16x32_bf16 a[4:7], a[192:195], v[220:223], a[4:7]
    s_mov_b32 s40, 0x280000
    buffer_load_dwordx2 v[32:33], v116, s[76:79], s40 offen sc1
    v_mfma_f32_16x16x32_bf16 a[8:11], a[192:195], v[228:231], a[8:11]
    buffer_load_dwordx2 v[22:23], v34, s[88:91], 0 offen offset:0
    v_mfma_f32_16x16x32_bf16 a[8:11], a[196:199], v[232:235], a[8:11]
    buffer_load_dwordx2 v[24:25], v34, s[88:91], 0 offen offset:32
    v_mfma_f32_16x16x32_bf16 a[12:15], a[196:199], v[240:243], a[12:15]
    buffer_load_dwordx2 v[26:27], v34, s[88:91], 0 offen offset:64
    v_mfma_f32_16x16x32_bf16 a[12:15], a[192:195], v[236:239], a[12:15]
    s_waitcnt lgkmcnt(4)
    buffer_load_dwordx2 v[28:29], v34, s[88:91], 0 offen offset:96
    v_mfma_f32_16x16x32_bf16 a[16:19], a[200:203], v[212:215], a[16:19]
    ds_read_b64_tr_b16 a[216:217], v8 offset:24576
    v_accvgpr_read_b32 v100, a224
    v_mfma_f32_16x16x32_bf16 a[16:19], a[204:207], v[216:219], a[16:19]
    ds_read_b64_tr_b16 a[218:219], v8 offset:28672
    v_accvgpr_read_b32 v104, a225
    v_accvgpr_read_b32 v101, a228
    v_accvgpr_read_b32 v105, a229
    v_mfma_f32_16x16x32_bf16 a[20:23], a[204:207], v[224:227], a[20:23]
    ds_read_b64_tr_b16 a[220:221], v8 offset:49152
    v_accvgpr_read_b32 v102, a232
    v_accvgpr_read_b32 v106, a233
    v_mfma_f32_16x16x32_bf16 a[20:23], a[200:203], v[220:223], a[20:23]
    ds_read_b64_tr_b16 a[222:223], v8 offset:53248
    v_accvgpr_read_b32 v103, a236
    v_accvgpr_read_b32 v107, a237
    v_add_f32 v100, v100, v104
    v_mfma_f32_16x16x32_bf16 a[24:27], a[200:203], v[228:231], a[24:27]
    buffer_load_dwordx2 v[30:31], v34, s[88:91], 0 offen offset:128
    v_add_f32 v101, v101, v105
    v_add_f32 v102, v102, v106
    v_add_f32 v103, v103, v107
    v_mfma_f32_16x16x32_bf16 a[24:27], a[204:207], v[232:235], a[24:27]
    v_maximum3_f32 v108, v100, v101, v102
    v_maximum3_f32 v108, v108, v103, v103
    v_mfma_f32_16x16x32_bf16 a[28:31], a[204:207], v[240:243], a[28:31]
    v_mul_f32 v108, 0x4d800000, v108
    v_mov_b32 v109, 0
    v_lshlrev_b32 v110, 4, v19
    v_mfma_f32_16x16x32_bf16 a[28:31], a[200:203], v[236:239], a[28:31]
    s_waitcnt lgkmcnt(4)
    v_rcp_f32 v100, v100
    v_rcp_f32 v101, v101
    v_rcp_f32 v102, v102
    v_rcp_f32 v103, v103
    v_mfma_f32_16x16x32_bf16 a[32:35], a[208:211], v[212:215], a[32:35]
    s_mov_b32 s36, 0
    ds_read_b64_tr_b16 a[192:193], v9 offset:24576
    v_accvgpr_read_b32 v120, a0
    v_accvgpr_read_b32 v121, a1
    v_accvgpr_read_b32 v122, a2
    v_accvgpr_read_b32 v123, a3
    v_mfma_f32_16x16x32_bf16 a[32:35], a[212:215], v[216:219], a[32:35]
    ds_read_b64_tr_b16 a[194:195], v9 offset:28672
    v_accvgpr_read_b32 v124, a16
    v_accvgpr_read_b32 v125, a17
    v_accvgpr_read_b32 v126, a18
    v_accvgpr_read_b32 v127, a19
    v_maximum3_f32 v108, v108, |v120|, |v121|
    v_maximum3_f32 v109, v109, |v122|, |v123|
    v_mfma_f32_16x16x32_bf16 a[36:39], a[212:215], v[224:227], a[36:39]
    ds_read_b64_tr_b16 a[196:197], v9 offset:49152
    v_maximum3_f32 v108, v108, |v124|, |v125|
    v_maximum3_f32 v109, v109, |v126|, |v127|
    v_mul_f32 v120, v120, v100
    v_mul_f32 v121, v121, v100
    v_mul_f32 v122, v122, v100
    v_mul_f32 v123, v123, v100
    v_mfma_f32_16x16x32_bf16 a[36:39], a[208:211], v[220:223], a[36:39]
    ds_read_b64_tr_b16 a[198:199], v9 offset:53248
    v_mul_f32 v124, v124, v100
    v_mul_f32 v125, v125, v100
    v_mul_f32 v126, v126, v100
    v_mul_f32 v127, v127, v100
    v_cvt_pk_bf16_f32 v152, v120, v121
    v_cvt_pk_bf16_f32 v153, v122, v123
    v_cvt_pk_bf16_f32 v154, v124, v125
    v_mfma_f32_16x16x32_bf16 a[40:43], a[208:211], v[228:231], a[40:43]
    v_cvt_pk_bf16_f32 v155, v126, v127
    v_mfma_f32_16x16x32_bf16 a[40:43], a[212:215], v[232:235], a[40:43]
    buffer_store_dwordx4 v[152:155], v110, s[24:27], s36 offen offset:0 sc1
    v_accvgpr_read_b32 v128, a4
    v_accvgpr_read_b32 v129, a5
    v_accvgpr_read_b32 v130, a6
    v_accvgpr_read_b32 v131, a7
    v_accvgpr_read_b32 v132, a20
    v_accvgpr_read_b32 v133, a21
    v_accvgpr_read_b32 v134, a22
    v_accvgpr_read_b32 v135, a23
    v_maximum3_f32 v108, v108, |v128|, |v129|
    v_maximum3_f32 v109, v109, |v130|, |v131|
    v_mfma_f32_16x16x32_bf16 a[44:47], a[212:215], v[240:243], a[44:47]
    v_maximum3_f32 v108, v108, |v132|, |v133|
    v_maximum3_f32 v109, v109, |v134|, |v135|
    v_mul_f32 v128, v128, v101
    v_mul_f32 v129, v129, v101
    v_mul_f32 v130, v130, v101
    v_mul_f32 v131, v131, v101
    v_mul_f32 v132, v132, v101
    v_mfma_f32_16x16x32_bf16 a[44:47], a[208:211], v[236:239], a[44:47]
    s_waitcnt lgkmcnt(4)
    v_mul_f32 v133, v133, v101
    v_mul_f32 v134, v134, v101
    v_mul_f32 v135, v135, v101
    v_cvt_pk_bf16_f32 v156, v128, v129
    v_cvt_pk_bf16_f32 v157, v130, v131
    v_cvt_pk_bf16_f32 v158, v132, v133
    v_mfma_f32_16x16x32_bf16 a[48:51], a[216:219], v[212:215], a[48:51]
    ds_read_b64_tr_b16 a[200:201], v10 offset:24576
    v_cvt_pk_bf16_f32 v159, v134, v135
    v_mfma_f32_16x16x32_bf16 a[48:51], a[220:223], v[216:219], a[48:51]
    ds_read_b64_tr_b16 a[202:203], v10 offset:28672
    buffer_store_dwordx4 v[156:159], v110, s[24:27], s36 offen offset:1024 sc1
    v_accvgpr_read_b32 v136, a8
    v_accvgpr_read_b32 v137, a9
    v_accvgpr_read_b32 v138, a10
    v_accvgpr_read_b32 v139, a11
    v_accvgpr_read_b32 v140, a24
    v_accvgpr_read_b32 v141, a25
    v_accvgpr_read_b32 v142, a26
    v_accvgpr_read_b32 v143, a27
    v_maximum3_f32 v108, v108, |v136|, |v137|
    v_maximum3_f32 v109, v109, |v138|, |v139|
    v_maximum3_f32 v108, v108, |v140|, |v141|
    v_mfma_f32_16x16x32_bf16 a[52:55], a[220:223], v[224:227], a[52:55]
    ds_read_b64_tr_b16 a[204:205], v10 offset:49152
    v_maximum3_f32 v109, v109, |v142|, |v143|
    v_mul_f32 v136, v136, v102
    v_mul_f32 v137, v137, v102
    v_mul_f32 v138, v138, v102
    v_mul_f32 v139, v139, v102
    v_mul_f32 v140, v140, v102
    v_mfma_f32_16x16x32_bf16 a[52:55], a[216:219], v[220:223], a[52:55]
    ds_read_b64_tr_b16 a[206:207], v10 offset:53248
    v_mul_f32 v141, v141, v102
    v_mul_f32 v142, v142, v102
    v_mul_f32 v143, v143, v102
    v_cvt_pk_bf16_f32 v160, v136, v137
    v_cvt_pk_bf16_f32 v161, v138, v139
    v_cvt_pk_bf16_f32 v162, v140, v141
    v_mfma_f32_16x16x32_bf16 a[56:59], a[216:219], v[228:231], a[56:59]
    v_cvt_pk_bf16_f32 v163, v142, v143
    v_mfma_f32_16x16x32_bf16 a[56:59], a[220:223], v[232:235], a[56:59]
    buffer_store_dwordx4 v[160:163], v110, s[24:27], s36 offen offset:2048 sc1
    v_accvgpr_read_b32 v144, a12
    v_accvgpr_read_b32 v145, a13
    v_accvgpr_read_b32 v146, a14
    v_accvgpr_read_b32 v147, a15
    v_accvgpr_read_b32 v148, a28
    v_accvgpr_read_b32 v149, a29
    v_accvgpr_read_b32 v150, a30
    v_accvgpr_read_b32 v151, a31
    v_maximum3_f32 v108, v108, |v144|, |v145|
    v_maximum3_f32 v109, v109, |v146|, |v147|
    v_maximum3_f32 v108, v108, |v148|, |v149|
    v_mfma_f32_16x16x32_bf16 a[60:63], a[220:223], v[240:243], a[60:63]
    v_maximum3_f32 v109, v109, |v150|, |v151|
    v_mul_f32 v144, v144, v103
    v_mul_f32 v145, v145, v103
    v_mul_f32 v146, v146, v103
    v_mul_f32 v147, v147, v103
    v_mul_f32 v148, v148, v103
    v_mfma_f32_16x16x32_bf16 a[60:63], a[216:219], v[236:239], a[60:63]
    s_waitcnt lgkmcnt(4)
    v_mul_f32 v149, v149, v103
    v_mul_f32 v150, v150, v103
    v_mul_f32 v151, v151, v103
    v_cvt_pk_bf16_f32 v164, v144, v145
    v_cvt_pk_bf16_f32 v165, v146, v147
    v_cvt_pk_bf16_f32 v166, v148, v149
    v_cvt_pk_bf16_f32 v167, v150, v151
    buffer_store_dwordx4 v[164:167], v110, s[24:27], s36 offen offset:3072 sc1
    v_mfma_f32_16x16x32_bf16 a[64:67], a[192:195], v[212:215], a[64:67]
    s_mov_b32 s36, 4096
    ds_read_b64_tr_b16 a[208:209], v11 offset:24576
    v_accvgpr_read_b32 v120, a32
    v_accvgpr_read_b32 v121, a33
    v_accvgpr_read_b32 v122, a34
    v_accvgpr_read_b32 v123, a35
    v_accvgpr_read_b32 v124, a48
    v_mfma_f32_16x16x32_bf16 a[64:67], a[196:199], v[216:219], a[64:67]
    ds_read_b64_tr_b16 a[210:211], v11 offset:28672
    v_accvgpr_read_b32 v125, a49
    v_accvgpr_read_b32 v126, a50
    v_accvgpr_read_b32 v127, a51
    v_maximum3_f32 v108, v108, |v120|, |v121|
    v_maximum3_f32 v109, v109, |v122|, |v123|
    v_maximum3_f32 v108, v108, |v124|, |v125|
    v_maximum3_f32 v109, v109, |v126|, |v127|
    v_mfma_f32_16x16x32_bf16 a[68:71], a[196:199], v[224:227], a[68:71]
    ds_read_b64_tr_b16 a[212:213], v11 offset:49152
    v_mul_f32 v120, v120, v100
    v_mul_f32 v121, v121, v100
    v_mul_f32 v122, v122, v100
    v_mul_f32 v123, v123, v100
    v_mul_f32 v124, v124, v100
    v_mul_f32 v125, v125, v100
    v_mul_f32 v126, v126, v100
    v_mfma_f32_16x16x32_bf16 a[68:71], a[192:195], v[220:223], a[68:71]
    ds_read_b64_tr_b16 a[214:215], v11 offset:53248
    v_mul_f32 v127, v127, v100
    v_cvt_pk_bf16_f32 v152, v120, v121
    v_cvt_pk_bf16_f32 v153, v122, v123
    v_cvt_pk_bf16_f32 v154, v124, v125
    v_cvt_pk_bf16_f32 v155, v126, v127
    v_mfma_f32_16x16x32_bf16 a[72:75], a[192:195], v[228:231], a[72:75]
    buffer_store_dwordx4 v[152:155], v110, s[24:27], s36 offen offset:0 sc1
    v_mfma_f32_16x16x32_bf16 a[72:75], a[196:199], v[232:235], a[72:75]
    s_mov_b32 s45, 61440
    buffer_load_dwordx4 a[0:3], v114, s[20:23], s45 offen offset:1024 sc1
    v_mfma_f32_16x16x32_bf16 a[76:79], a[196:199], v[240:243], a[76:79]
    s_mov_b32 s45, 61440
    buffer_load_dwordx4 a[4:7], v114, s[20:23], s45 offen offset:2048 sc1
    v_accvgpr_read_b32 v128, a36
    v_accvgpr_read_b32 v129, a37
    v_accvgpr_read_b32 v130, a38
    v_accvgpr_read_b32 v131, a39
    v_accvgpr_read_b32 v132, a52
    v_accvgpr_read_b32 v133, a53
    v_accvgpr_read_b32 v134, a54
    v_accvgpr_read_b32 v135, a55
    v_maximum3_f32 v108, v108, |v128|, |v129|
    v_maximum3_f32 v109, v109, |v130|, |v131|
    v_maximum3_f32 v108, v108, |v132|, |v133|
    v_maximum3_f32 v109, v109, |v134|, |v135|
    v_mul_f32 v128, v128, v101
    v_mul_f32 v129, v129, v101
    v_mul_f32 v130, v130, v101
    v_mul_f32 v131, v131, v101
    v_mul_f32 v132, v132, v101
    v_mul_f32 v133, v133, v101
    v_mul_f32 v134, v134, v101
    v_mul_f32 v135, v135, v101
    v_mfma_f32_16x16x32_bf16 a[76:79], a[192:195], v[236:239], a[76:79]
    s_waitcnt lgkmcnt(4)
    v_cvt_pk_bf16_f32 v156, v128, v129
    v_cvt_pk_bf16_f32 v157, v130, v131
    v_cvt_pk_bf16_f32 v158, v132, v133
    v_cvt_pk_bf16_f32 v159, v134, v135
    v_mfma_f32_16x16x32_bf16 a[80:83], a[200:203], v[212:215], a[80:83]
    ds_read_b64_tr_b16 a[216:217], v12 offset:24576
    buffer_store_dwordx4 v[156:159], v110, s[24:27], s36 offen offset:1024 sc1
    v_mfma_f32_16x16x32_bf16 a[80:83], a[204:207], v[216:219], a[80:83]
    s_mov_b32 s45, 61440
    ds_read_b64_tr_b16 a[218:219], v12 offset:28672
    buffer_load_dwordx4 a[8:11], v114, s[20:23], s45 offen offset:3072 sc1
    v_mfma_f32_16x16x32_bf16 a[84:87], a[204:207], v[224:227], a[84:87]
    s_mov_b32 s45, 61440
    ds_read_b64_tr_b16 a[220:221], v12 offset:49152
    buffer_load_dwordx4 a[12:15], v115, s[20:23], s45 offen offset:0 sc1
    v_accvgpr_read_b32 v136, a40
    v_accvgpr_read_b32 v137, a41
    v_accvgpr_read_b32 v138, a42
    v_accvgpr_read_b32 v139, a43
    v_accvgpr_read_b32 v140, a56
    v_accvgpr_read_b32 v141, a57
    v_accvgpr_read_b32 v142, a58
    v_accvgpr_read_b32 v143, a59
    v_maximum3_f32 v108, v108, |v136|, |v137|
    v_maximum3_f32 v109, v109, |v138|, |v139|
    v_maximum3_f32 v108, v108, |v140|, |v141|
    v_maximum3_f32 v109, v109, |v142|, |v143|
    v_mul_f32 v136, v136, v102
    v_mul_f32 v137, v137, v102
    v_mul_f32 v138, v138, v102
    v_mul_f32 v139, v139, v102
    v_mul_f32 v140, v140, v102
    v_mul_f32 v141, v141, v102
    v_mul_f32 v142, v142, v102
    v_mul_f32 v143, v143, v102
    v_mfma_f32_16x16x32_bf16 a[84:87], a[200:203], v[220:223], a[84:87]
    ds_read_b64_tr_b16 a[222:223], v12 offset:53248
    v_cvt_pk_bf16_f32 v160, v136, v137
    v_cvt_pk_bf16_f32 v161, v138, v139
    v_cvt_pk_bf16_f32 v162, v140, v141
    v_cvt_pk_bf16_f32 v163, v142, v143
    v_mfma_f32_16x16x32_bf16 a[88:91], a[200:203], v[228:231], a[88:91]
    buffer_store_dwordx4 v[160:163], v110, s[24:27], s36 offen offset:2048 sc1
    v_mfma_f32_16x16x32_bf16 a[88:91], a[204:207], v[232:235], a[88:91]
    s_mov_b32 s45, 81920
    buffer_load_dwordx4 a[16:19], v114, s[20:23], s45 offen offset:0 sc1
    v_mfma_f32_16x16x32_bf16 a[92:95], a[204:207], v[240:243], a[92:95]
    s_mov_b32 s45, 81920
    buffer_load_dwordx4 a[20:23], v114, s[20:23], s45 offen offset:1024 sc1
    v_accvgpr_read_b32 v144, a44
    v_accvgpr_read_b32 v145, a45
    v_accvgpr_read_b32 v146, a46
    v_accvgpr_read_b32 v147, a47
    v_accvgpr_read_b32 v148, a60
    v_accvgpr_read_b32 v149, a61
    v_accvgpr_read_b32 v150, a62
    v_accvgpr_read_b32 v151, a63
    v_maximum3_f32 v108, v108, |v144|, |v145|
    v_maximum3_f32 v109, v109, |v146|, |v147|
    v_maximum3_f32 v108, v108, |v148|, |v149|
    v_maximum3_f32 v109, v109, |v150|, |v151|
    v_mul_f32 v144, v144, v103
    v_mul_f32 v145, v145, v103
    v_mul_f32 v146, v146, v103
    v_mul_f32 v147, v147, v103
    v_mul_f32 v148, v148, v103
    v_mul_f32 v149, v149, v103
    v_mul_f32 v150, v150, v103
    v_mul_f32 v151, v151, v103
    v_mfma_f32_16x16x32_bf16 a[92:95], a[200:203], v[236:239], a[92:95]
    s_waitcnt lgkmcnt(4)
    v_cvt_pk_bf16_f32 v164, v144, v145
    v_cvt_pk_bf16_f32 v165, v146, v147
    v_cvt_pk_bf16_f32 v166, v148, v149
    v_cvt_pk_bf16_f32 v167, v150, v151
    buffer_store_dwordx4 v[164:167], v110, s[24:27], s36 offen offset:3072 sc1
    s_mov_b32 s45, 81920
    buffer_load_dwordx4 a[24:27], v114, s[20:23], s45 offen offset:2048 sc1
    s_mov_b32 s45, 81920
    buffer_load_dwordx4 a[28:31], v114, s[20:23], s45 offen offset:3072 sc1
    v_mfma_f32_16x16x32_bf16 a[96:99], a[208:211], v[212:215], a[96:99]
    s_mov_b32 s36, 8192
    v_accvgpr_read_b32 v120, a64
    v_accvgpr_read_b32 v121, a65
    v_accvgpr_read_b32 v122, a66
    v_accvgpr_read_b32 v123, a67
    v_accvgpr_read_b32 v124, a80
    v_mfma_f32_16x16x32_bf16 a[96:99], a[212:215], v[216:219], a[96:99]
    v_accvgpr_read_b32 v125, a81
    v_accvgpr_read_b32 v126, a82
    v_accvgpr_read_b32 v127, a83
    v_maximum3_f32 v108, v108, |v120|, |v121|
    v_maximum3_f32 v109, v109, |v122|, |v123|
    v_maximum3_f32 v108, v108, |v124|, |v125|
    v_maximum3_f32 v109, v109, |v126|, |v127|
    v_mfma_f32_16x16x32_bf16 a[100:103], a[212:215], v[224:227], a[100:103]
    v_mul_f32 v120, v120, v100
    v_mul_f32 v121, v121, v100
    v_mul_f32 v122, v122, v100
    v_mul_f32 v123, v123, v100
    v_mul_f32 v124, v124, v100
    v_mul_f32 v125, v125, v100
    v_mul_f32 v126, v126, v100
    v_mfma_f32_16x16x32_bf16 a[100:103], a[208:211], v[220:223], a[100:103]
    v_mul_f32 v127, v127, v100
    v_cvt_pk_bf16_f32 v152, v120, v121
    v_cvt_pk_bf16_f32 v153, v122, v123
    v_cvt_pk_bf16_f32 v154, v124, v125
    v_cvt_pk_bf16_f32 v155, v126, v127
    v_mfma_f32_16x16x32_bf16 a[104:107], a[208:211], v[228:231], a[104:107]
    buffer_store_dwordx4 v[152:155], v110, s[24:27], s36 offen offset:0 sc1
    v_mfma_f32_16x16x32_bf16 a[104:107], a[212:215], v[232:235], a[104:107]
    s_mov_b32 s45, 81920
    buffer_load_dwordx4 a[32:35], v115, s[20:23], s45 offen offset:0 sc1
    v_mfma_f32_16x16x32_bf16 a[108:111], a[212:215], v[240:243], a[108:111]
    s_mov_b32 s45, 102400
    buffer_load_dwordx4 a[36:39], v114, s[20:23], s45 offen offset:0 sc1
    v_accvgpr_read_b32 v128, a68
    v_accvgpr_read_b32 v129, a69
    v_accvgpr_read_b32 v130, a70
    v_accvgpr_read_b32 v131, a71
    v_accvgpr_read_b32 v132, a84
    v_accvgpr_read_b32 v133, a85
    v_accvgpr_read_b32 v134, a86
    v_accvgpr_read_b32 v135, a87
    v_maximum3_f32 v108, v108, |v128|, |v129|
    v_maximum3_f32 v109, v109, |v130|, |v131|
    v_maximum3_f32 v108, v108, |v132|, |v133|
    v_maximum3_f32 v109, v109, |v134|, |v135|
    v_mul_f32 v128, v128, v101
    v_mul_f32 v129, v129, v101
    v_mul_f32 v130, v130, v101
    v_mul_f32 v131, v131, v101
    v_mul_f32 v132, v132, v101
    v_mul_f32 v133, v133, v101
    v_mul_f32 v134, v134, v101
    v_mul_f32 v135, v135, v101
    v_mfma_f32_16x16x32_bf16 a[108:111], a[208:211], v[236:239], a[108:111]
    s_waitcnt lgkmcnt(0)
    v_cvt_pk_bf16_f32 v156, v128, v129
    v_cvt_pk_bf16_f32 v157, v130, v131
    v_cvt_pk_bf16_f32 v158, v132, v133
    v_cvt_pk_bf16_f32 v159, v134, v135
    v_mfma_f32_16x16x32_bf16 a[112:115], a[216:219], v[212:215], a[112:115]
    buffer_store_dwordx4 v[156:159], v110, s[24:27], s36 offen offset:1024 sc1
    v_mfma_f32_16x16x32_bf16 a[112:115], a[220:223], v[216:219], a[112:115]
    s_mov_b32 s45, 102400
    buffer_load_dwordx4 a[40:43], v114, s[20:23], s45 offen offset:1024 sc1
    v_mfma_f32_16x16x32_bf16 a[116:119], a[220:223], v[224:227], a[116:119]
    s_mov_b32 s45, 102400
    buffer_load_dwordx4 a[44:47], v114, s[20:23], s45 offen offset:2048 sc1
    v_accvgpr_read_b32 v136, a72
    v_accvgpr_read_b32 v137, a73
    v_accvgpr_read_b32 v138, a74
    v_accvgpr_read_b32 v139, a75
    v_accvgpr_read_b32 v140, a88
    v_accvgpr_read_b32 v141, a89
    v_accvgpr_read_b32 v142, a90
    v_accvgpr_read_b32 v143, a91
    v_maximum3_f32 v108, v108, |v136|, |v137|
    v_maximum3_f32 v109, v109, |v138|, |v139|
    v_maximum3_f32 v108, v108, |v140|, |v141|
    v_maximum3_f32 v109, v109, |v142|, |v143|
    v_mul_f32 v136, v136, v102
    v_mul_f32 v137, v137, v102
    v_mul_f32 v138, v138, v102
    v_mul_f32 v139, v139, v102
    v_mul_f32 v140, v140, v102
    v_mul_f32 v141, v141, v102
    v_mul_f32 v142, v142, v102
    v_mul_f32 v143, v143, v102
    v_mfma_f32_16x16x32_bf16 a[116:119], a[216:219], v[220:223], a[116:119]
    v_cvt_pk_bf16_f32 v160, v136, v137
    v_cvt_pk_bf16_f32 v161, v138, v139
    v_cvt_pk_bf16_f32 v162, v140, v141
    v_cvt_pk_bf16_f32 v163, v142, v143
    v_mfma_f32_16x16x32_bf16 a[120:123], a[216:219], v[228:231], a[120:123]
    buffer_store_dwordx4 v[160:163], v110, s[24:27], s36 offen offset:2048 sc1
    v_mfma_f32_16x16x32_bf16 a[120:123], a[220:223], v[232:235], a[120:123]
    s_mov_b32 s45, 102400
    buffer_load_dwordx4 a[48:51], v114, s[20:23], s45 offen offset:3072 sc1
    v_mfma_f32_16x16x32_bf16 a[124:127], a[220:223], v[240:243], a[124:127]
    s_mov_b32 s45, 102400
    buffer_load_dwordx4 a[52:55], v115, s[20:23], s45 offen offset:0 sc1
    v_accvgpr_read_b32 v144, a76
    v_accvgpr_read_b32 v145, a77
    v_accvgpr_read_b32 v146, a78
    v_accvgpr_read_b32 v147, a79
    v_accvgpr_read_b32 v148, a92
    v_accvgpr_read_b32 v149, a93
    v_accvgpr_read_b32 v150, a94
    v_accvgpr_read_b32 v151, a95
    v_maximum3_f32 v108, v108, |v144|, |v145|
    v_maximum3_f32 v109, v109, |v146|, |v147|
    v_maximum3_f32 v108, v108, |v148|, |v149|
    v_maximum3_f32 v109, v109, |v150|, |v151|
    v_mul_f32 v144, v144, v103
    v_mul_f32 v145, v145, v103
    v_mul_f32 v146, v146, v103
    v_mul_f32 v147, v147, v103
    v_mul_f32 v148, v148, v103
    v_mul_f32 v149, v149, v103
    v_mul_f32 v150, v150, v103
    v_mul_f32 v151, v151, v103
    v_mfma_f32_16x16x32_bf16 a[124:127], a[216:219], v[236:239], a[124:127]
    v_cvt_pk_bf16_f32 v164, v144, v145
    v_cvt_pk_bf16_f32 v165, v146, v147
    v_cvt_pk_bf16_f32 v166, v148, v149
    v_cvt_pk_bf16_f32 v167, v150, v151
    buffer_store_dwordx4 v[164:167], v110, s[24:27], s36 offen offset:3072 sc1
    s_mov_b32 s45, 122880
    buffer_load_dwordx4 a[56:59], v114, s[20:23], s45 offen offset:0 sc1
    s_mov_b32 s45, 122880
    buffer_load_dwordx4 a[60:63], v114, s[20:23], s45 offen offset:1024 sc1
    s_mov_b32 s36, 12288
    v_accvgpr_read_b32 v120, a96
    v_accvgpr_read_b32 v121, a97
    v_accvgpr_read_b32 v122, a98
    v_accvgpr_read_b32 v123, a99
    v_accvgpr_read_b32 v124, a112
    v_accvgpr_read_b32 v125, a113
    v_accvgpr_read_b32 v126, a114
    v_accvgpr_read_b32 v127, a115
    v_maximum3_f32 v108, v108, |v120|, |v121|
    v_maximum3_f32 v109, v109, |v122|, |v123|
    v_maximum3_f32 v108, v108, |v124|, |v125|
    v_maximum3_f32 v109, v109, |v126|, |v127|
    v_mul_f32 v120, v120, v100
    v_mul_f32 v121, v121, v100
    v_mul_f32 v122, v122, v100
    v_mul_f32 v123, v123, v100
    v_mul_f32 v124, v124, v100
    v_mul_f32 v125, v125, v100
    v_mul_f32 v126, v126, v100
    v_mul_f32 v127, v127, v100
    v_cvt_pk_bf16_f32 v152, v120, v121
    v_cvt_pk_bf16_f32 v153, v122, v123
    v_cvt_pk_bf16_f32 v154, v124, v125
    v_cvt_pk_bf16_f32 v155, v126, v127
    buffer_store_dwordx4 v[152:155], v110, s[24:27], s36 offen offset:0 sc1
    s_mov_b32 s45, 122880
    buffer_load_dwordx4 a[64:67], v114, s[20:23], s45 offen offset:2048 sc1
    s_mov_b32 s45, 122880
    buffer_load_dwordx4 a[68:71], v114, s[20:23], s45 offen offset:3072 sc1
    v_accvgpr_read_b32 v128, a100
    v_accvgpr_read_b32 v129, a101
    v_accvgpr_read_b32 v130, a102
    v_accvgpr_read_b32 v131, a103
    v_accvgpr_read_b32 v132, a116
    v_accvgpr_read_b32 v133, a117
    v_accvgpr_read_b32 v134, a118
    v_accvgpr_read_b32 v135, a119
    v_maximum3_f32 v108, v108, |v128|, |v129|
    v_maximum3_f32 v109, v109, |v130|, |v131|
    v_maximum3_f32 v108, v108, |v132|, |v133|
    v_maximum3_f32 v109, v109, |v134|, |v135|
    v_mul_f32 v128, v128, v101
    v_mul_f32 v129, v129, v101
    v_mul_f32 v130, v130, v101
    v_mul_f32 v131, v131, v101
    v_mul_f32 v132, v132, v101
    v_mul_f32 v133, v133, v101
    v_mul_f32 v134, v134, v101
    v_mul_f32 v135, v135, v101
    v_cvt_pk_bf16_f32 v156, v128, v129
    v_cvt_pk_bf16_f32 v157, v130, v131
    v_cvt_pk_bf16_f32 v158, v132, v133
    v_cvt_pk_bf16_f32 v159, v134, v135
    buffer_store_dwordx4 v[156:159], v110, s[24:27], s36 offen offset:1024 sc1
    s_mov_b32 s45, 122880
    buffer_load_dwordx4 a[72:75], v115, s[20:23], s45 offen offset:0 sc1
    s_mov_b32 s45, 143360
    buffer_load_dwordx4 a[76:79], v114, s[20:23], s45 offen offset:0 sc1
    v_accvgpr_read_b32 v136, a104
    v_accvgpr_read_b32 v137, a105
    v_accvgpr_read_b32 v138, a106
    v_accvgpr_read_b32 v139, a107
    v_accvgpr_read_b32 v140, a120
    v_accvgpr_read_b32 v141, a121
    v_accvgpr_read_b32 v142, a122
    v_accvgpr_read_b32 v143, a123
    v_maximum3_f32 v108, v108, |v136|, |v137|
    v_maximum3_f32 v109, v109, |v138|, |v139|
    v_maximum3_f32 v108, v108, |v140|, |v141|
    v_maximum3_f32 v109, v109, |v142|, |v143|
    v_mul_f32 v136, v136, v102
    v_mul_f32 v137, v137, v102
    v_mul_f32 v138, v138, v102
    v_mul_f32 v139, v139, v102
    v_mul_f32 v140, v140, v102
    v_mul_f32 v141, v141, v102
    v_mul_f32 v142, v142, v102
    v_mul_f32 v143, v143, v102
    v_cvt_pk_bf16_f32 v160, v136, v137
    v_cvt_pk_bf16_f32 v161, v138, v139
    v_cvt_pk_bf16_f32 v162, v140, v141
    v_cvt_pk_bf16_f32 v163, v142, v143
    buffer_store_dwordx4 v[160:163], v110, s[24:27], s36 offen offset:2048 sc1
    s_mov_b32 s45, 143360
    buffer_load_dwordx4 a[80:83], v114, s[20:23], s45 offen offset:1024 sc1
    s_mov_b32 s45, 143360
    buffer_load_dwordx4 a[84:87], v114, s[20:23], s45 offen offset:2048 sc1
    v_accvgpr_read_b32 v144, a108
    v_accvgpr_read_b32 v145, a109
    v_accvgpr_read_b32 v146, a110
    v_accvgpr_read_b32 v147, a111
    v_accvgpr_read_b32 v148, a124
    v_accvgpr_read_b32 v149, a125
    v_accvgpr_read_b32 v150, a126
    v_accvgpr_read_b32 v151, a127
    v_maximum3_f32 v108, v108, |v144|, |v145|
    v_maximum3_f32 v109, v109, |v146|, |v147|
    v_maximum3_f32 v108, v108, |v148|, |v149|
    v_maximum3_f32 v109, v109, |v150|, |v151|
    v_mul_f32 v144, v144, v103
    v_mul_f32 v145, v145, v103
    v_mul_f32 v146, v146, v103
    v_mul_f32 v147, v147, v103
    v_mul_f32 v148, v148, v103
    v_mul_f32 v149, v149, v103
    v_mul_f32 v150, v150, v103
    v_mul_f32 v151, v151, v103
    v_cvt_pk_bf16_f32 v164, v144, v145
    v_cvt_pk_bf16_f32 v165, v146, v147
    v_cvt_pk_bf16_f32 v166, v148, v149
    v_cvt_pk_bf16_f32 v167, v150, v151
    buffer_store_dwordx4 v[164:167], v110, s[24:27], s36 offen offset:3072 sc1
    s_mov_b32 s45, 143360
    buffer_load_dwordx4 a[88:91], v114, s[20:23], s45 offen offset:3072 sc1
    s_mov_b32 s45, 143360
    buffer_load_dwordx4 a[92:95], v115, s[20:23], s45 offen offset:0 sc1
    v_maximum3_f32 v108, v108, v109, v109
    v_cmp_ngt_f32 vcc, 0x7f800000, v108
    s_and_b64 vcc, vcc, exec
    s_cbranch_scc1 L_slow
L_published:
    v_mov_b32 v16, v114
    v_mov_b32 v17, v115
    v_mov_b32 v2, 1
    v_mov_b32 v11, 0x2500000
    s_not_b32 s40, s50
    s_and_b32 s40, s40, 0x7ff
    v_cmp_eq_u32 vcc, s40, v35
    v_mov_b32 v12, 0x29c000
    s_nop 0
    v_cndmask_b32 v11, v11, v12, vcc
    s_not_b32 s40, s51
    s_and_b32 s40, s40, 0x7ff
    v_cmp_eq_u32 vcc, s40, v35
    v_mov_b32 v12, 0x29c500
    s_nop 0
    v_cndmask_b32 v11, v11, v12, vcc
    s_not_b32 s40, s52
    s_and_b32 s40, s40, 0x7ff
    v_cmp_eq_u32 vcc, s40, v35
    v_mov_b32 v12, 0x29ca00
    s_nop 0
    v_cndmask_b32 v11, v11, v12, vcc
    s_not_b32 s40, s53
    s_and_b32 s40, s40, 0x7ff
    v_cmp_eq_u32 vcc, s40, v35
    v_mov_b32 v12, 0x29cf00
    s_nop 0
    v_cndmask_b32 v11, v11, v12, vcc
    s_not_b32 s40, s54
    s_and_b32 s40, s40, 0x7ff
    v_cmp_eq_u32 vcc, s40, v35
    v_mov_b32 v12, 0x29d400
    s_nop 0
    v_cndmask_b32 v11, v11, v12, vcc
    s_not_b32 s40, s55
    s_and_b32 s40, s40, 0x7ff
    v_cmp_eq_u32 vcc, s40, v35
    v_mov_b32 v12, 0x29d900
    s_nop 0
    v_cndmask_b32 v11, v11, v12, vcc
    s_not_b32 s40, s56
    s_and_b32 s40, s40, 0x7ff
    v_cmp_eq_u32 vcc, s40, v35
    v_mov_b32 v12, 0x29de00
    s_nop 0
    v_cndmask_b32 v11, v11, v12, vcc
    s_not_b32 s40, s57
    s_and_b32 s40, s40, 0x7ff
    v_cmp_eq_u32 vcc, s40, v35
    v_mov_b32 v12, 0x29e300
    s_nop 0
    v_cndmask_b32 v11, v11, v12, vcc
    v_mul_u32_u24 v12, 1280, v35
    v_sub_u32 v12, v34, v12
    v_add_u32 v11, v11, v12
    buffer_load_dwordx2 v[20:21], v11, s[76:79], 0 offen offset:0 sc1
    buffer_load_dwordx2 v[246:247], v11, s[76:79], 0 offen offset:32 sc1
    buffer_load_dwordx2 v[248:249], v11, s[76:79], 0 offen offset:64 sc1
    buffer_load_dwordx2 v[252:253], v11, s[76:79], 0 offen offset:96 sc1
    buffer_load_dwordx2 v[254:255], v11, s[76:79], 0 offen offset:128 sc1
    s_waitcnt vmcnt(45)
    v_lshlrev_b32 v166, 16, v22
    v_and_b32 v167, 0xffff0000, v22
    v_lshlrev_b32 v168, 16, v23
    v_and_b32 v169, 0xffff0000, v23
    v_lshlrev_b32 v170, 16, v24
    v_and_b32 v171, 0xffff0000, v24
    v_lshlrev_b32 v172, 16, v25
    v_and_b32 v173, 0xffff0000, v25
    v_lshlrev_b32 v174, 16, v26
    v_and_b32 v175, 0xffff0000, v26
    v_lshlrev_b32 v176, 16, v27
    v_and_b32 v177, 0xffff0000, v27
    v_lshlrev_b32 v178, 16, v28
    v_and_b32 v179, 0xffff0000, v28
    v_lshlrev_b32 v180, 16, v29
    v_and_b32 v181, 0xffff0000, v29
    v_lshlrev_b32 v182, 16, v30
    v_and_b32 v183, 0xffff0000, v30
    v_lshlrev_b32 v184, 16, v31
    v_and_b32 v185, 0xffff0000, v31
    v_pk_add_f32 v[166:167], v[166:167], v[32:33] op_sel_hi:[1,0] neg_lo:[0,1] neg_hi:[0,1]
    v_pk_add_f32 v[168:169], v[168:169], v[32:33] op_sel_hi:[1,0] neg_lo:[0,1] neg_hi:[0,1]
    v_pk_add_f32 v[170:171], v[170:171], v[32:33] op_sel_hi:[1,0] neg_lo:[0,1] neg_hi:[0,1]
    v_pk_add_f32 v[172:173], v[172:173], v[32:33] op_sel_hi:[1,0] neg_lo:[0,1] neg_hi:[0,1]
    v_pk_add_f32 v[174:175], v[174:175], v[32:33] op_sel_hi:[1,0] neg_lo:[0,1] neg_hi:[0,1]
    v_pk_add_f32 v[176:177], v[176:177], v[32:33] op_sel_hi:[1,0] neg_lo:[0,1] neg_hi:[0,1]
    v_pk_add_f32 v[178:179], v[178:179], v[32:33] op_sel_hi:[1,0] neg_lo:[0,1] neg_hi:[0,1]
    v_pk_add_f32 v[180:181], v[180:181], v[32:33] op_sel_hi:[1,0] neg_lo:[0,1] neg_hi:[0,1]
    v_pk_add_f32 v[182:183], v[182:183], v[32:33] op_sel_hi:[1,0] neg_lo:[0,1] neg_hi:[0,1]
    v_pk_add_f32 v[184:185], v[184:185], v[32:33] op_sel_hi:[1,0] neg_lo:[0,1] neg_hi:[0,1]
    v_cvt_pk_bf16_f32 v36, v166, v167
    v_cvt_pk_bf16_f32 v37, v168, v169
    v_cvt_pk_bf16_f32 v38, v170, v171
    v_cvt_pk_bf16_f32 v39, v172, v173
    v_cvt_pk_bf16_f32 v40, v174, v175
    v_cvt_pk_bf16_f32 v41, v176, v177
    v_cvt_pk_bf16_f32 v42, v178, v179
    v_cvt_pk_bf16_f32 v43, v180, v181
    v_cvt_pk_bf16_f32 v44, v182, v183
    v_cvt_pk_bf16_f32 v45, v184, v185
    v_lshlrev_b32 v166, 16, v36
    v_and_b32 v167, 0xffff0000, v36
    v_lshlrev_b32 v168, 16, v37
    v_and_b32 v169, 0xffff0000, v37
    v_lshlrev_b32 v170, 16, v38
    v_and_b32 v171, 0xffff0000, v38
    v_lshlrev_b32 v172, 16, v39
    v_and_b32 v173, 0xffff0000, v39
    v_lshlrev_b32 v174, 16, v40
    v_and_b32 v175, 0xffff0000, v40
    v_lshlrev_b32 v176, 16, v41
    v_and_b32 v177, 0xffff0000, v41
    v_lshlrev_b32 v178, 16, v42
    v_and_b32 v179, 0xffff0000, v42
    v_lshlrev_b32 v180, 16, v43
    v_and_b32 v181, 0xffff0000, v43
    v_lshlrev_b32 v182, 16, v44
    v_and_b32 v183, 0xffff0000, v44
    v_lshlrev_b32 v184, 16, v45
    v_and_b32 v185, 0xffff0000, v45
    v_pk_mul_f32 v[166:167], v[166:167], v[32:33] op_sel:[0,1] op_sel_hi:[1,1]
    v_pk_mul_f32 v[168:169], v[168:169], v[32:33] op_sel:[0,1] op_sel_hi:[1,1]
    v_pk_mul_f32 v[170:171], v[170:171], v[32:33] op_sel:[0,1] op_sel_hi:[1,1]
    v_pk_mul_f32 v[172:173], v[172:173], v[32:33] op_sel:[0,1] op_sel_hi:[1,1]
    v_pk_mul_f32 v[174:175], v[174:175], v[32:33] op_sel:[0,1] op_sel_hi:[1,1]
    v_pk_mul_f32 v[176:177], v[176:177], v[32:33] op_sel:[0,1] op_sel_hi:[1,1]
    v_pk_mul_f32 v[178:179], v[178:179], v[32:33] op_sel:[0,1] op_sel_hi:[1,1]
    v_pk_mul_f32 v[180:181], v[180:181], v[32:33] op_sel:[0,1] op_sel_hi:[1,1]
    v_pk_mul_f32 v[182:183], v[182:183], v[32:33] op_sel:[0,1] op_sel_hi:[1,1]
    v_pk_mul_f32 v[184:185], v[184:185], v[32:33] op_sel:[0,1] op_sel_hi:[1,1]
    v_cvt_pk_bf16_f32 v36, v166, v167
    v_cvt_pk_bf16_f32 v37, v168, v169
    v_cvt_pk_bf16_f32 v38, v170, v171
    v_cvt_pk_bf16_f32 v39, v172, v173
    v_cvt_pk_bf16_f32 v40, v174, v175
    v_cvt_pk_bf16_f32 v41, v176, v177
    v_cvt_pk_bf16_f32 v42, v178, v179
    v_cvt_pk_bf16_f32 v43, v180, v181
    v_cvt_pk_bf16_f32 v44, v182, v183
    v_cvt_pk_bf16_f32 v45, v184, v185
    s_lshr_b32 s40, s87, 1
    s_lshl_b32 s40, s40, 2
    s_add_u32 s40, s40, s47
    s_lshl_b32 s40, s40, 18
    s_add_u32 s40, s40, 0x400000
    s_add_u32 s8, s72, s40
    s_addc_u32 s9, s73, 0
    s_mov_b32 s10, 0xc0000
    s_mov_b32 s11, 0x20000
    s_mov_b32 s12, s68
    s_mov_b32 s13, s69
    s_mov_b32 s14, 0x280000
    s_mov_b32 s15, 0x20000
    s_xor_b32 s40, s47, 1
    s_lshl_b32 s30, s40, 19
    s_lshl_b32 s31, s47, 19
    s_add_u32 s40, s5, 0
    s_and_b32 s40, s40, 3
    s_lshl_b32 s41, s5, 2
    s_add_u32 s41, s41, s40
    s_lshl_b32 s41, s41, 10
    v_lshl_add_u32 v4, v19, 4, s41
    s_add_u32 s40, s5, 1
    s_and_b32 s40, s40, 3
    s_lshl_b32 s41, s5, 2
    s_add_u32 s41, s41, s40
    s_lshl_b32 s41, s41, 10
    v_lshl_add_u32 v5, v19, 4, s41
    s_add_u32 s40, s5, 2
    s_and_b32 s40, s40, 3
    s_lshl_b32 s41, s5, 2
    s_add_u32 s41, s41, s40
    s_lshl_b32 s41, s41, 10
    v_lshl_add_u32 v6, v19, 4, s41
    s_add_u32 s40, s5, 3
    s_and_b32 s40, s40, 3
    s_lshl_b32 s41, s5, 2
    s_add_u32 s41, s41, s40
    s_lshl_b32 s41, s41, 10
    v_lshl_add_u32 v7, v19, 4, s41
    s_add_u32 s40, s46, 122880
    v_lshl_add_u32 v8, v19, 4, s40
    s_add_u32 s40, s46, 81920
    v_lshl_add_u32 v9, v19, 4, s40
    s_lshl_b32 s40, s46, 1
    v_lshl_add_u32 v10, v19, 4, s40
    s_and_b32 s40, s87, 30
    s_lshl_b32 s40, s40, 1
    s_add_u32 s40, s40, s47
    s_lshl_b32 s40, s40, 9
    s_add_u32 s40, s40, 0x292000
    v_bfe_u32 v1, v19, 2, 1
    v_lshlrev_b32 v1, 3, v1
    v_and_or_b32 v1, v19, 3, v1
    v_lshl_add_u32 v1, v1, 7, s40
    s_waitcnt vmcnt(7)
    s_mov_b64 exec, 1
    buffer_store_dword v2, off, s[76:79], s58 sc1
    s_mov_b64 exec, -1
    s_waitcnt vmcnt(1)
    v_max3_u32 v3, v20, v21, v246
    v_max3_u32 v3, v3, v247, v248
    v_max3_u32 v3, v3, v249, v252
    v_max3_u32 v3, v3, v253, v254
    v_max_u32 v3, v3, v255
    v_cmp_eq_u32 vcc, -1, v3
    s_and_b64 vcc, vcc, exec
    s_cbranch_scc1 L_spin_upd
L_back_upd:
    v_lshlrev_b32 v166, 16, v36
    v_and_b32 v167, 0xffff0000, v36
    v_lshlrev_b32 v186, 16, v20
    v_and_b32 v187, 0xffff0000, v20
    v_lshlrev_b32 v168, 16, v37
    v_and_b32 v169, 0xffff0000, v37
    v_lshlrev_b32 v188, 16, v21
    v_and_b32 v189, 0xffff0000, v21
    s_mov_b32 s45, 163840
    buffer_load_dwordx4 v[46:49], v16, s[20:23], s45 offen offset:0 sc1
    v_lshlrev_b32 v170, 16, v38
    v_and_b32 v171, 0xffff0000, v38
    v_lshlrev_b32 v190, 16, v246
    v_and_b32 v191, 0xffff0000, v246
    v_lshlrev_b32 v172, 16, v39
    v_and_b32 v173, 0xffff0000, v39
    v_lshlrev_b32 v192, 16, v247
    v_and_b32 v193, 0xffff0000, v247
    buffer_load_dwordx4 v[50:53], v16, s[20:23], s45 offen offset:1024 sc1
    v_lshlrev_b32 v174, 16, v40
    v_and_b32 v175, 0xffff0000, v40
    v_lshlrev_b32 v194, 16, v248
    v_and_b32 v195, 0xffff0000, v248
    v_lshlrev_b32 v176, 16, v41
    v_and_b32 v177, 0xffff0000, v41
    v_lshlrev_b32 v196, 16, v249
    v_and_b32 v197, 0xffff0000, v249
    buffer_load_dwordx4 v[54:57], v16, s[20:23], s45 offen offset:2048 sc1
    v_lshlrev_b32 v178, 16, v42
    v_and_b32 v179, 0xffff0000, v42
    v_lshlrev_b32 v198, 16, v252
    v_and_b32 v199, 0xffff0000, v252
    v_lshlrev_b32 v180, 16, v43
    v_and_b32 v181, 0xffff0000, v43
    v_lshlrev_b32 v200, 16, v253
    v_and_b32 v201, 0xffff0000, v253
    buffer_load_dwordx4 v[58:61], v16, s[20:23], s45 offen offset:3072 sc1
    v_lshlrev_b32 v182, 16, v44
    v_and_b32 v183, 0xffff0000, v44
    v_lshlrev_b32 v202, 16, v254
    v_and_b32 v203, 0xffff0000, v254
    v_lshlrev_b32 v184, 16, v45
    v_and_b32 v185, 0xffff0000, v45
    v_lshlrev_b32 v204, 16, v255
    v_and_b32 v205, 0xffff0000, v255
    buffer_load_dwordx4 v[62:65], v17, s[20:23], s45 offen offset:0 sc1
    v_pk_add_f32 v[166:167], v[166:167], v[186:187]
    v_pk_add_f32 v[168:169], v[168:169], v[188:189]
    v_pk_add_f32 v[170:171], v[170:171], v[190:191]
    v_pk_add_f32 v[172:173], v[172:173], v[192:193]
    v_pk_add_f32 v[174:175], v[174:175], v[194:195]
    v_pk_add_f32 v[176:177], v[176:177], v[196:197]
    v_pk_add_f32 v[178:179], v[178:179], v[198:199]
    v_pk_add_f32 v[180:181], v[180:181], v[200:201]
    s_mov_b32 s45, 184320
    buffer_load_dwordx4 v[66:69], v16, s[20:23], s45 offen offset:0 sc1
    v_pk_add_f32 v[182:183], v[182:183], v[202:203]
    v_pk_add_f32 v[184:185], v[184:185], v[204:205]
    v_cvt_pk_bf16_f32 v186, v166, v167
    v_cvt_pk_bf16_f32 v187, v168, v169
    v_cvt_pk_bf16_f32 v188, v170, v171
    v_cvt_pk_bf16_f32 v189, v172, v173
    v_cvt_pk_bf16_f32 v190, v174, v175
    v_cvt_pk_bf16_f32 v191, v176, v177
    buffer_load_dwordx4 v[70:73], v16, s[20:23], s45 offen offset:1024 sc1
    v_cvt_pk_bf16_f32 v192, v178, v179
    v_cvt_pk_bf16_f32 v193, v180, v181
    v_cvt_pk_bf16_f32 v194, v182, v183
    v_cvt_pk_bf16_f32 v195, v184, v185
    buffer_load_dwordx4 v[74:77], v16, s[20:23], s45 offen offset:2048 sc1
    buffer_load_dwordx4 v[78:81], v16, s[20:23], s45 offen offset:3072 sc1
    buffer_load_dwordx4 v[82:85], v17, s[20:23], s45 offen offset:0 sc1
    buffer_load_dwordx4 v[126:129], v1, s[76:79], 0 offen sc1
    v_lshlrev_b32 v166, 16, v186
    v_and_b32 v167, 0xffff0000, v186
    v_lshlrev_b32 v168, 16, v187
    v_and_b32 v169, 0xffff0000, v187
    v_lshlrev_b32 v170, 16, v188
    v_and_b32 v171, 0xffff0000, v188
    v_lshlrev_b32 v172, 16, v189
    v_and_b32 v173, 0xffff0000, v189
    v_lshlrev_b32 v174, 16, v190
    v_and_b32 v175, 0xffff0000, v190
    v_lshlrev_b32 v176, 16, v191
    v_and_b32 v177, 0xffff0000, v191
    v_lshlrev_b32 v178, 16, v192
    v_and_b32 v179, 0xffff0000, v192
    v_lshlrev_b32 v180, 16, v193
    v_and_b32 v181, 0xffff0000, v193
    s_mov_b32 s45, 204800
    buffer_load_dwordx4 v[86:89], v16, s[20:23], s45 offen offset:0 sc1
    v_lshlrev_b32 v182, 16, v194
    v_and_b32 v183, 0xffff0000, v194
    v_lshlrev_b32 v184, 16, v195
    v_and_b32 v185, 0xffff0000, v195
    v_mul_f32 v186, 0xbfb8aa3b, v166
    v_mul_f32 v187, 0xbfb8aa3b, v167
    v_mul_f32 v188, 0xbfb8aa3b, v168
    v_mul_f32 v189, 0xbfb8aa3b, v169
    v_mul_f32 v190, 0xbfb8aa3b, v170
    v_mul_f32 v191, 0xbfb8aa3b, v171
    v_mul_f32 v192, 0xbfb8aa3b, v172
    v_mul_f32 v193, 0xbfb8aa3b, v173
    v_mul_f32 v194, 0xbfb8aa3b, v174
    v_mul_f32 v195, 0xbfb8aa3b, v175
    v_mul_f32 v196, 0xbfb8aa3b, v176
    v_mul_f32 v197, 0xbfb8aa3b, v177
    buffer_load_dwordx4 v[90:93], v16, s[20:23], s45 offen offset:1024 sc1
    v_mul_f32 v198, 0xbfb8aa3b, v178
    v_mul_f32 v199, 0xbfb8aa3b, v179
    v_mul_f32 v200, 0xbfb8aa3b, v180
    v_mul_f32 v201, 0xbfb8aa3b, v181
    v_mul_f32 v202, 0xbfb8aa3b, v182
    v_mul_f32 v203, 0xbfb8aa3b, v183
    v_mul_f32 v204, 0xbfb8aa3b, v184
    v_mul_f32 v205, 0xbfb8aa3b, v185
    v_exp_f32 v186, v186
    v_exp_f32 v187, v187
    v_exp_f32 v188, v188
    v_exp_f32 v189, v189
    v_exp_f32 v190, v190
    v_exp_f32 v191, v191
    v_exp_f32 v192, v192
    v_exp_f32 v193, v193
    buffer_load_dwordx4 v[94:97], v16, s[20:23], s45 offen offset:2048 sc1
    v_exp_f32 v194, v194
    v_exp_f32 v195, v195
    v_exp_f32 v196, v196
    v_exp_f32 v197, v197
    v_exp_f32 v198, v198
    v_exp_f32 v199, v199
    v_exp_f32 v200, v200
    v_exp_f32 v201, v201
    v_exp_f32 v202, v202
    v_exp_f32 v203, v203
    v_exp_f32 v204, v204
    v_exp_f32 v205, v205
    v_add_f32 v186, 1.0, v186
    v_add_f32 v187, 1.0, v187
    v_add_f32 v188, 1.0, v188
    v_add_f32 v189, 1.0, v189
    buffer_load_dwordx4 v[98:101], v16, s[20:23], s45 offen offset:3072 sc1
    v_add_f32 v190, 1.0, v190
    v_add_f32 v191, 1.0, v191
    v_add_f32 v192, 1.0, v192
    v_add_f32 v193, 1.0, v193
    v_add_f32 v194, 1.0, v194
    v_add_f32 v195, 1.0, v195
    v_add_f32 v196, 1.0, v196
    v_add_f32 v197, 1.0, v197
    v_add_f32 v198, 1.0, v198
    v_add_f32 v199, 1.0, v199
    v_add_f32 v200, 1.0, v200
    v_add_f32 v201, 1.0, v201
    v_add_f32 v202, 1.0, v202
    v_add_f32 v203, 1.0, v203
    v_add_f32 v204, 1.0, v204
    v_add_f32 v205, 1.0, v205
    buffer_load_dwordx4 v[102:105], v17, s[20:23], s45 offen offset:0 sc1
    v_rcp_f32 v186, v186
    v_rcp_f32 v187, v187
    v_rcp_f32 v188, v188
    v_rcp_f32 v189, v189
    v_rcp_f32 v190, v190
    v_rcp_f32 v191, v191
    v_rcp_f32 v192, v192
    v_rcp_f32 v193, v193
    v_rcp_f32 v194, v194
    v_rcp_f32 v195, v195
    v_rcp_f32 v196, v196
    v_rcp_f32 v197, v197
    v_rcp_f32 v198, v198
    v_rcp_f32 v199, v199
    v_rcp_f32 v200, v200
    v_rcp_f32 v201, v201
    s_mov_b32 s45, 225280
    buffer_load_dwordx4 v[106:109], v16, s[20:23], s45 offen offset:0 sc1
    v_rcp_f32 v202, v202
    v_rcp_f32 v203, v203
    v_rcp_f32 v204, v204
    v_rcp_f32 v205, v205
    v_mul_f32 v166, v166, v186
    v_mul_f32 v167, v167, v187
    v_mul_f32 v168, v168, v188
    v_mul_f32 v169, v169, v189
    v_mul_f32 v170, v170, v190
    v_mul_f32 v171, v171, v191
    v_mul_f32 v172, v172, v192
    v_mul_f32 v173, v173, v193
    v_mul_f32 v174, v174, v194
    v_mul_f32 v175, v175, v195
    v_mul_f32 v176, v176, v196
    v_mul_f32 v177, v177, v197
    buffer_load_dwordx4 v[110:113], v16, s[20:23], s45 offen offset:1024 sc1
    v_mul_f32 v178, v178, v198
    v_mul_f32 v179, v179, v199
    v_mul_f32 v180, v180, v200
    v_mul_f32 v181, v181, v201
    v_mul_f32 v182, v182, v202
    v_mul_f32 v183, v183, v203
    v_mul_f32 v184, v184, v204
    v_mul_f32 v185, v185, v205
    v_cvt_pk_bf16_f32 v36, v166, v167
    v_cvt_pk_bf16_f32 v37, v168, v169
    v_cvt_pk_bf16_f32 v38, v170, v171
    v_cvt_pk_bf16_f32 v39, v172, v173
    v_cvt_pk_bf16_f32 v40, v174, v175
    v_cvt_pk_bf16_f32 v41, v176, v177
    v_cvt_pk_bf16_f32 v42, v178, v179
    v_cvt_pk_bf16_f32 v43, v180, v181
    buffer_load_dwordx4 v[114:117], v16, s[20:23], s45 offen offset:2048 sc1
    v_cvt_pk_bf16_f32 v44, v182, v183
    v_cvt_pk_bf16_f32 v45, v184, v185
    buffer_load_dwordx4 v[118:121], v16, s[20:23], s45 offen offset:3072 sc1
    buffer_load_dwordx4 v[122:125], v17, s[20:23], s45 offen offset:0 sc1
    v_mov_b32 v2, 3
    s_cmp_lg_u32 s5, 0
    s_cbranch_scc1 L_back_o
    s_waitcnt vmcnt(10)
    v_min3_u32 v126, v126, v127, v128
    v_min_u32 v126, v126, v129
    v_cmp_gt_u32 vcc, 1, v126
    s_and_b64 vcc, vcc, exec
    s_cbranch_scc1 L_spin_o
L_back_o:
    s_barrier
    s_add_u32 s44, s30, 0
    buffer_load_dwordx4 a[96:99], v4, s[8:11], s44 offen sc1
    buffer_load_dwordx4 a[100:103], v5, s[8:11], s44 offen sc1
    buffer_load_dwordx4 a[104:107], v6, s[8:11], s44 offen sc1
    buffer_load_dwordx4 a[108:111], v7, s[8:11], s44 offen sc1
    s_add_u32 s44, s30, 16384
    buffer_load_dwordx4 a[112:115], v4, s[8:11], s44 offen sc1
    buffer_load_dwordx4 a[116:119], v5, s[8:11], s44 offen sc1
    buffer_load_dwordx4 a[120:123], v6, s[8:11], s44 offen sc1
    buffer_load_dwordx4 a[124:127], v7, s[8:11], s44 offen sc1
    s_add_u32 s44, s30, 32768
    buffer_load_dwordx4 a[192:195], v4, s[8:11], s44 offen sc1
    buffer_load_dwordx4 a[196:199], v5, s[8:11], s44 offen sc1
    buffer_load_dwordx4 a[200:203], v6, s[8:11], s44 offen sc1
    buffer_load_dwordx4 a[204:207], v7, s[8:11], s44 offen sc1
    s_add_u32 s44, s30, 49152
    buffer_load_dwordx4 a[208:211], v4, s[8:11], s44 offen sc1
    buffer_load_dwordx4 a[212:215], v5, s[8:11], s44 offen sc1
    buffer_load_dwordx4 a[216:219], v6, s[8:11], s44 offen sc1
    buffer_load_dwordx4 a[220:223], v7, s[8:11], s44 offen sc1
    s_waitcnt vmcnt(8)
    v_mfma_f32_16x16x32_bf16 v[166:169], a[128:131], a[96:99], 0
    v_mfma_f32_16x16x32_bf16 v[166:169], a[148:151], a[112:115], v[166:169]
    s_add_u32 s44, s30, 65536
    buffer_load_dwordx4 a[224:227], v4, s[8:11], s44 offen sc1
    v_mfma_f32_16x16x32_bf16 v[186:189], a[148:151], a[116:119], 0
    v_mfma_f32_16x16x32_bf16 v[186:189], a[128:131], a[100:103], v[186:189]
    v_mfma_f32_16x16x32_bf16 v[206:209], a[128:131], a[104:107], 0
    buffer_load_dwordx4 a[228:231], v5, s[8:11], s44 offen sc1
    v_mfma_f32_16x16x32_bf16 v[206:209], a[148:151], a[120:123], v[206:209]
    v_mfma_f32_16x16x32_bf16 v[226:229], a[148:151], a[124:127], 0
    v_mfma_f32_16x16x32_bf16 v[226:229], a[128:131], a[108:111], v[226:229]
    v_mfma_f32_16x16x32_bf16 v[170:173], a[132:135], a[96:99], 0
    buffer_load_dwordx4 a[232:235], v6, s[8:11], s44 offen sc1
    v_mfma_f32_16x16x32_bf16 v[170:173], a[152:155], a[112:115], v[170:173]
    v_mfma_f32_16x16x32_bf16 v[190:193], a[152:155], a[116:119], 0
    v_mfma_f32_16x16x32_bf16 v[190:193], a[132:135], a[100:103], v[190:193]
    v_mfma_f32_16x16x32_bf16 v[210:213], a[132:135], a[104:107], 0
    buffer_load_dwordx4 a[236:239], v7, s[8:11], s44 offen sc1
    v_mfma_f32_16x16x32_bf16 v[210:213], a[152:155], a[120:123], v[210:213]
    v_mfma_f32_16x16x32_bf16 v[230:233], a[152:155], a[124:127], 0
    v_mfma_f32_16x16x32_bf16 v[230:233], a[132:135], a[108:111], v[230:233]
    v_mfma_f32_16x16x32_bf16 v[174:177], a[136:139], a[96:99], 0
    s_add_u32 s44, s30, 81920
    buffer_load_dwordx4 a[240:243], v4, s[8:11], s44 offen sc1
    v_mfma_f32_16x16x32_bf16 v[174:177], a[156:159], a[112:115], v[174:177]
    v_mfma_f32_16x16x32_bf16 v[194:197], a[156:159], a[116:119], 0
    v_mfma_f32_16x16x32_bf16 v[194:197], a[136:139], a[100:103], v[194:197]
    buffer_load_dwordx4 a[244:247], v5, s[8:11], s44 offen sc1
    v_mfma_f32_16x16x32_bf16 v[214:217], a[136:139], a[104:107], 0
    v_mfma_f32_16x16x32_bf16 v[214:217], a[156:159], a[120:123], v[214:217]
    v_mfma_f32_16x16x32_bf16 v[234:237], a[156:159], a[124:127], 0
    v_mfma_f32_16x16x32_bf16 v[234:237], a[136:139], a[108:111], v[234:237]
    buffer_load_dwordx4 a[248:251], v6, s[8:11], s44 offen sc1
    v_mfma_f32_16x16x32_bf16 v[178:181], a[140:143], a[96:99], 0
    v_mfma_f32_16x16x32_bf16 v[178:181], a[160:163], a[112:115], v[178:181]
    v_mfma_f32_16x16x32_bf16 v[198:201], a[160:163], a[116:119], 0
    v_mfma_f32_16x16x32_bf16 v[198:201], a[140:143], a[100:103], v[198:201]
    buffer_load_dwordx4 a[252:255], v7, s[8:11], s44 offen sc1
    v_mfma_f32_16x16x32_bf16 v[218:221], a[140:143], a[104:107], 0
    v_mfma_f32_16x16x32_bf16 v[218:221], a[160:163], a[120:123], v[218:221]
    v_mfma_f32_16x16x32_bf16 v[238:241], a[160:163], a[124:127], 0
    v_mfma_f32_16x16x32_bf16 v[238:241], a[140:143], a[108:111], v[238:241]
    v_mfma_f32_16x16x32_bf16 v[182:185], a[144:147], a[96:99], 0
    v_mfma_f32_16x16x32_bf16 v[182:185], a[164:167], a[112:115], v[182:185]
    v_mfma_f32_16x16x32_bf16 v[202:205], a[164:167], a[116:119], 0
    v_mfma_f32_16x16x32_bf16 v[202:205], a[144:147], a[100:103], v[202:205]
    v_mfma_f32_16x16x32_bf16 v[222:225], a[144:147], a[104:107], 0
    v_mfma_f32_16x16x32_bf16 v[222:225], a[164:167], a[120:123], v[222:225]
    v_mfma_f32_16x16x32_bf16 v[242:245], a[164:167], a[124:127], 0
    v_mfma_f32_16x16x32_bf16 v[242:245], a[144:147], a[108:111], v[242:245]
    s_waitcnt vmcnt(8)
    v_mfma_f32_16x16x32_bf16 v[166:169], a[168:171], a[192:195], v[166:169]
    v_mfma_f32_16x16x32_bf16 v[166:169], a[188:191], a[208:211], v[166:169]
    s_add_u32 s44, s30, 98304
    buffer_load_dwordx4 a[96:99], v4, s[8:11], s44 offen sc1
    v_mfma_f32_16x16x32_bf16 v[186:189], a[188:191], a[212:215], v[186:189]
    v_mfma_f32_16x16x32_bf16 v[186:189], a[168:171], a[196:199], v[186:189]
    v_mfma_f32_16x16x32_bf16 v[206:209], a[168:171], a[200:203], v[206:209]
    buffer_load_dwordx4 a[100:103], v5, s[8:11], s44 offen sc1
    v_mfma_f32_16x16x32_bf16 v[206:209], a[188:191], a[216:219], v[206:209]
    v_mfma_f32_16x16x32_bf16 v[226:229], a[188:191], a[220:223], v[226:229]
    v_mfma_f32_16x16x32_bf16 v[226:229], a[168:171], a[204:207], v[226:229]
    v_mfma_f32_16x16x32_bf16 v[170:173], a[172:175], a[192:195], v[170:173]
    buffer_load_dwordx4 a[104:107], v6, s[8:11], s44 offen sc1
    v_mfma_f32_16x16x32_bf16 v[170:173], a[0:3], a[208:211], v[170:173]
    v_mfma_f32_16x16x32_bf16 v[190:193], a[0:3], a[212:215], v[190:193]
    v_mfma_f32_16x16x32_bf16 v[190:193], a[172:175], a[196:199], v[190:193]
    v_mfma_f32_16x16x32_bf16 v[210:213], a[172:175], a[200:203], v[210:213]
    buffer_load_dwordx4 a[108:111], v7, s[8:11], s44 offen sc1
    v_mfma_f32_16x16x32_bf16 v[210:213], a[0:3], a[216:219], v[210:213]
    v_mfma_f32_16x16x32_bf16 v[230:233], a[0:3], a[220:223], v[230:233]
    v_mfma_f32_16x16x32_bf16 v[230:233], a[172:175], a[204:207], v[230:233]
    v_mfma_f32_16x16x32_bf16 v[174:177], a[176:179], a[192:195], v[174:177]
    s_add_u32 s44, s30, 114688
    buffer_load_dwordx4 a[112:115], v4, s[8:11], s44 offen sc1
    v_mfma_f32_16x16x32_bf16 v[174:177], a[4:7], a[208:211], v[174:177]
    v_mfma_f32_16x16x32_bf16 v[194:197], a[4:7], a[212:215], v[194:197]
    v_mfma_f32_16x16x32_bf16 v[194:197], a[176:179], a[196:199], v[194:197]
    buffer_load_dwordx4 a[116:119], v5, s[8:11], s44 offen sc1
    v_mfma_f32_16x16x32_bf16 v[214:217], a[176:179], a[200:203], v[214:217]
    v_mfma_f32_16x16x32_bf16 v[214:217], a[4:7], a[216:219], v[214:217]
    v_mfma_f32_16x16x32_bf16 v[234:237], a[4:7], a[220:223], v[234:237]
    v_mfma_f32_16x16x32_bf16 v[234:237], a[176:179], a[204:207], v[234:237]
    buffer_load_dwordx4 a[120:123], v6, s[8:11], s44 offen sc1
    v_mfma_f32_16x16x32_bf16 v[178:181], a[180:183], a[192:195], v[178:181]
    v_mfma_f32_16x16x32_bf16 v[178:181], a[8:11], a[208:211], v[178:181]
    v_mfma_f32_16x16x32_bf16 v[198:201], a[8:11], a[212:215], v[198:201]
    v_mfma_f32_16x16x32_bf16 v[198:201], a[180:183], a[196:199], v[198:201]
    buffer_load_dwordx4 a[124:127], v7, s[8:11], s44 offen sc1
    v_mfma_f32_16x16x32_bf16 v[218:221], a[180:183], a[200:203], v[218:221]
    v_mfma_f32_16x16x32_bf16 v[218:221], a[8:11], a[216:219], v[218:221]
    v_mfma_f32_16x16x32_bf16 v[238:241], a[8:11], a[220:223], v[238:241]
    v_mfma_f32_16x16x32_bf16 v[238:241], a[180:183], a[204:207], v[238:241]
    v_mfma_f32_16x16x32_bf16 v[182:185], a[184:187], a[192:195], v[182:185]
    v_mfma_f32_16x16x32_bf16 v[182:185], a[12:15], a[208:211], v[182:185]
    v_mfma_f32_16x16x32_bf16 v[202:205], a[12:15], a[212:215], v[202:205]
    v_mfma_f32_16x16x32_bf16 v[202:205], a[184:187], a[196:199], v[202:205]
    v_mfma_f32_16x16x32_bf16 v[222:225], a[184:187], a[200:203], v[222:225]
    v_mfma_f32_16x16x32_bf16 v[222:225], a[12:15], a[216:219], v[222:225]
    v_mfma_f32_16x16x32_bf16 v[242:245], a[12:15], a[220:223], v[242:245]
    v_mfma_f32_16x16x32_bf16 v[242:245], a[184:187], a[204:207], v[242:245]
    s_waitcnt vmcnt(8)
    v_mfma_f32_16x16x32_bf16 v[166:169], a[16:19], a[224:227], v[166:169]
    v_mfma_f32_16x16x32_bf16 v[166:169], a[36:39], a[240:243], v[166:169]
    s_add_u32 s44, s30, 196608
    buffer_load_dwordx4 a[192:195], v4, s[8:11], s44 offen sc1
    v_mfma_f32_16x16x32_bf16 v[186:189], a[36:39], a[244:247], v[186:189]
    v_mfma_f32_16x16x32_bf16 v[186:189], a[16:19], a[228:231], v[186:189]
    v_mfma_f32_16x16x32_bf16 v[206:209], a[16:19], a[232:235], v[206:209]
    buffer_load_dwordx4 a[196:199], v5, s[8:11], s44 offen sc1
    v_mfma_f32_16x16x32_bf16 v[206:209], a[36:39], a[248:251], v[206:209]
    v_mfma_f32_16x16x32_bf16 v[226:229], a[36:39], a[252:255], v[226:229]
    v_mfma_f32_16x16x32_bf16 v[226:229], a[16:19], a[236:239], v[226:229]
    v_mfma_f32_16x16x32_bf16 v[170:173], a[20:23], a[224:227], v[170:173]
    buffer_load_dwordx4 a[200:203], v6, s[8:11], s44 offen sc1
    v_mfma_f32_16x16x32_bf16 v[170:173], a[40:43], a[240:243], v[170:173]
    v_mfma_f32_16x16x32_bf16 v[190:193], a[40:43], a[244:247], v[190:193]
    v_mfma_f32_16x16x32_bf16 v[190:193], a[20:23], a[228:231], v[190:193]
    v_mfma_f32_16x16x32_bf16 v[210:213], a[20:23], a[232:235], v[210:213]
    buffer_load_dwordx4 a[204:207], v7, s[8:11], s44 offen sc1
    v_mfma_f32_16x16x32_bf16 v[210:213], a[40:43], a[248:251], v[210:213]
    v_mfma_f32_16x16x32_bf16 v[230:233], a[40:43], a[252:255], v[230:233]
    v_mfma_f32_16x16x32_bf16 v[230:233], a[20:23], a[236:239], v[230:233]
    v_mfma_f32_16x16x32_bf16 v[174:177], a[24:27], a[224:227], v[174:177]
    s_add_u32 s44, s30, 212992
    buffer_load_dwordx4 a[208:211], v4, s[8:11], s44 offen sc1
    v_mfma_f32_16x16x32_bf16 v[174:177], a[44:47], a[240:243], v[174:177]
    v_mfma_f32_16x16x32_bf16 v[194:197], a[44:47], a[244:247], v[194:197]
    v_mfma_f32_16x16x32_bf16 v[194:197], a[24:27], a[228:231], v[194:197]
    buffer_load_dwordx4 a[212:215], v5, s[8:11], s44 offen sc1
    v_mfma_f32_16x16x32_bf16 v[214:217], a[24:27], a[232:235], v[214:217]
    v_mfma_f32_16x16x32_bf16 v[214:217], a[44:47], a[248:251], v[214:217]
    v_mfma_f32_16x16x32_bf16 v[234:237], a[44:47], a[252:255], v[234:237]
    v_mfma_f32_16x16x32_bf16 v[234:237], a[24:27], a[236:239], v[234:237]
    buffer_load_dwordx4 a[216:219], v6, s[8:11], s44 offen sc1
    v_mfma_f32_16x16x32_bf16 v[178:181], a[28:31], a[224:227], v[178:181]
    v_mfma_f32_16x16x32_bf16 v[178:181], a[48:51], a[240:243], v[178:181]
    v_mfma_f32_16x16x32_bf16 v[198:201], a[48:51], a[244:247], v[198:201]
    v_mfma_f32_16x16x32_bf16 v[198:201], a[28:31], a[228:231], v[198:201]
    buffer_load_dwordx4 a[220:223], v7, s[8:11], s44 offen sc1
    v_mfma_f32_16x16x32_bf16 v[218:221], a[28:31], a[232:235], v[218:221]
    v_mfma_f32_16x16x32_bf16 v[218:221], a[48:51], a[248:251], v[218:221]
    v_mfma_f32_16x16x32_bf16 v[238:241], a[48:51], a[252:255], v[238:241]
    v_mfma_f32_16x16x32_bf16 v[238:241], a[28:31], a[236:239], v[238:241]
    v_mfma_f32_16x16x32_bf16 v[182:185], a[32:35], a[224:227], v[182:185]
    v_mfma_f32_16x16x32_bf16 v[182:185], a[52:55], a[240:243], v[182:185]
    v_mfma_f32_16x16x32_bf16 v[202:205], a[52:55], a[244:247], v[202:205]
    v_mfma_f32_16x16x32_bf16 v[202:205], a[32:35], a[228:231], v[202:205]
    v_mfma_f32_16x16x32_bf16 v[222:225], a[32:35], a[232:235], v[222:225]
    v_mfma_f32_16x16x32_bf16 v[222:225], a[52:55], a[248:251], v[222:225]
    v_mfma_f32_16x16x32_bf16 v[242:245], a[52:55], a[252:255], v[242:245]
    v_mfma_f32_16x16x32_bf16 v[242:245], a[32:35], a[236:239], v[242:245]
    s_waitcnt vmcnt(8)
    v_mfma_f32_16x16x32_bf16 v[166:169], a[56:59], a[96:99], v[166:169]
    v_mfma_f32_16x16x32_bf16 v[166:169], a[76:79], a[112:115], v[166:169]
    s_add_u32 s44, s30, 131072
    buffer_load_dwordx4 a[224:227], v4, s[8:11], s44 offen sc1
    v_mfma_f32_16x16x32_bf16 v[186:189], a[76:79], a[116:119], v[186:189]
    ds_read_b128 v[126:129], v8 offset:0
    v_mfma_f32_16x16x32_bf16 v[186:189], a[56:59], a[100:103], v[186:189]
    v_mfma_f32_16x16x32_bf16 v[206:209], a[56:59], a[104:107], v[206:209]
    buffer_load_dwordx4 a[228:231], v5, s[8:11], s44 offen sc1
    v_mfma_f32_16x16x32_bf16 v[206:209], a[76:79], a[120:123], v[206:209]
    ds_read_b128 v[130:133], v8 offset:1024
    v_mfma_f32_16x16x32_bf16 v[226:229], a[76:79], a[124:127], v[226:229]
    v_mfma_f32_16x16x32_bf16 v[226:229], a[56:59], a[108:111], v[226:229]
    ds_read_b128 v[134:137], v8 offset:2048
    v_mfma_f32_16x16x32_bf16 v[170:173], a[60:63], a[96:99], v[170:173]
    buffer_load_dwordx4 a[232:235], v6, s[8:11], s44 offen sc1
    v_mfma_f32_16x16x32_bf16 v[170:173], a[80:83], a[112:115], v[170:173]
    v_mfma_f32_16x16x32_bf16 v[190:193], a[80:83], a[116:119], v[190:193]
    ds_read_b128 v[138:141], v8 offset:3072
    v_mfma_f32_16x16x32_bf16 v[190:193], a[60:63], a[100:103], v[190:193]
    v_mfma_f32_16x16x32_bf16 v[210:213], a[60:63], a[104:107], v[210:213]
    buffer_load_dwordx4 a[236:239], v7, s[8:11], s44 offen sc1
    v_mfma_f32_16x16x32_bf16 v[210:213], a[80:83], a[120:123], v[210:213]
    ds_read_b128 v[142:145], v8 offset:4096
    v_mfma_f32_16x16x32_bf16 v[230:233], a[80:83], a[124:127], v[230:233]
    v_mfma_f32_16x16x32_bf16 v[230:233], a[60:63], a[108:111], v[230:233]
    ds_read_b128 v[146:149], v8 offset:5120
    v_mfma_f32_16x16x32_bf16 v[174:177], a[64:67], a[96:99], v[174:177]
    s_add_u32 s44, s30, 147456
    buffer_load_dwordx4 a[240:243], v4, s[8:11], s44 offen sc1
    v_mfma_f32_16x16x32_bf16 v[174:177], a[84:87], a[112:115], v[174:177]
    v_mfma_f32_16x16x32_bf16 v[194:197], a[84:87], a[116:119], v[194:197]
    ds_read_b128 v[150:153], v8 offset:6144
    v_mfma_f32_16x16x32_bf16 v[194:197], a[64:67], a[100:103], v[194:197]
    buffer_load_dwordx4 a[244:247], v5, s[8:11], s44 offen sc1
    v_mfma_f32_16x16x32_bf16 v[214:217], a[64:67], a[104:107], v[214:217]
    v_mfma_f32_16x16x32_bf16 v[214:217], a[84:87], a[120:123], v[214:217]
    ds_read_b128 v[154:157], v8 offset:7168
    v_mfma_f32_16x16x32_bf16 v[234:237], a[84:87], a[124:127], v[234:237]
    v_mfma_f32_16x16x32_bf16 v[234:237], a[64:67], a[108:111], v[234:237]
    buffer_load_dwordx4 a[248:251], v6, s[8:11], s44 offen sc1
    v_mfma_f32_16x16x32_bf16 v[178:181], a[68:71], a[96:99], v[178:181]
    ds_read_b128 v[158:161], v8 offset:8192
    v_mfma_f32_16x16x32_bf16 v[178:181], a[88:91], a[112:115], v[178:181]
    v_mfma_f32_16x16x32_bf16 v[198:201], a[88:91], a[116:119], v[198:201]
    ds_read_b128 v[162:165], v8 offset:9216
    v_mfma_f32_16x16x32_bf16 v[198:201], a[68:71], a[100:103], v[198:201]
    buffer_load_dwordx4 a[252:255], v7, s[8:11], s44 offen sc1
    v_mfma_f32_16x16x32_bf16 v[218:221], a[68:71], a[104:107], v[218:221]
    v_mfma_f32_16x16x32_bf16 v[218:221], a[88:91], a[120:123], v[218:221]
    v_mfma_f32_16x16x32_bf16 v[238:241], a[88:91], a[124:127], v[238:241]
    v_mfma_f32_16x16x32_bf16 v[238:241], a[68:71], a[108:111], v[238:241]
    v_mfma_f32_16x16x32_bf16 v[182:185], a[72:75], a[96:99], v[182:185]
    v_mfma_f32_16x16x32_bf16 v[182:185], a[92:95], a[112:115], v[182:185]
    v_mfma_f32_16x16x32_bf16 v[202:205], a[92:95], a[116:119], v[202:205]
    v_mfma_f32_16x16x32_bf16 v[202:205], a[72:75], a[100:103], v[202:205]
    v_mfma_f32_16x16x32_bf16 v[222:225], a[72:75], a[104:107], v[222:225]
    v_mfma_f32_16x16x32_bf16 v[222:225], a[92:95], a[120:123], v[222:225]
    v_mfma_f32_16x16x32_bf16 v[242:245], a[92:95], a[124:127], v[242:245]
    v_mfma_f32_16x16x32_bf16 v[242:245], a[72:75], a[108:111], v[242:245]
    s_waitcnt vmcnt(8) lgkmcnt(0)
    v_mfma_f32_16x16x32_bf16 v[166:169], v[126:129], a[192:195], v[166:169]
    v_mfma_f32_16x16x32_bf16 v[166:169], v[146:149], a[208:211], v[166:169]
    s_add_u32 s44, s30, 229376
    buffer_load_dwordx4 a[96:99], v4, s[8:11], s44 offen sc1
    v_mfma_f32_16x16x32_bf16 v[186:189], v[146:149], a[212:215], v[186:189]
    v_mfma_f32_16x16x32_bf16 v[186:189], v[126:129], a[196:199], v[186:189]
    v_mfma_f32_16x16x32_bf16 v[206:209], v[126:129], a[200:203], v[206:209]
    buffer_load_dwordx4 a[100:103], v5, s[8:11], s44 offen sc1
    v_mfma_f32_16x16x32_bf16 v[206:209], v[146:149], a[216:219], v[206:209]
    v_mfma_f32_16x16x32_bf16 v[226:229], v[146:149], a[220:223], v[226:229]
    v_mfma_f32_16x16x32_bf16 v[226:229], v[126:129], a[204:207], v[226:229]
    v_mfma_f32_16x16x32_bf16 v[170:173], v[130:133], a[192:195], v[170:173]
    buffer_load_dwordx4 a[104:107], v6, s[8:11], s44 offen sc1
    v_mfma_f32_16x16x32_bf16 v[170:173], v[150:153], a[208:211], v[170:173]
    v_mfma_f32_16x16x32_bf16 v[190:193], v[150:153], a[212:215], v[190:193]
    v_mfma_f32_16x16x32_bf16 v[190:193], v[130:133], a[196:199], v[190:193]
    v_mfma_f32_16x16x32_bf16 v[210:213], v[130:133], a[200:203], v[210:213]
    buffer_load_dwordx4 a[108:111], v7, s[8:11], s44 offen sc1
    v_mfma_f32_16x16x32_bf16 v[210:213], v[150:153], a[216:219], v[210:213]
    v_mfma_f32_16x16x32_bf16 v[230:233], v[150:153], a[220:223], v[230:233]
    v_mfma_f32_16x16x32_bf16 v[230:233], v[130:133], a[204:207], v[230:233]
    v_mfma_f32_16x16x32_bf16 v[174:177], v[134:137], a[192:195], v[174:177]
    s_add_u32 s44, s30, 245760
    buffer_load_dwordx4 a[112:115], v4, s[8:11], s44 offen sc1
    v_mfma_f32_16x16x32_bf16 v[174:177], v[154:157], a[208:211], v[174:177]
    v_mfma_f32_16x16x32_bf16 v[194:197], v[154:157], a[212:215], v[194:197]
    v_mfma_f32_16x16x32_bf16 v[194:197], v[134:137], a[196:199], v[194:197]
    buffer_load_dwordx4 a[116:119], v5, s[8:11], s44 offen sc1
    v_mfma_f32_16x16x32_bf16 v[214:217], v[134:137], a[200:203], v[214:217]
    v_mfma_f32_16x16x32_bf16 v[214:217], v[154:157], a[216:219], v[214:217]
    v_mfma_f32_16x16x32_bf16 v[234:237], v[154:157], a[220:223], v[234:237]
    v_mfma_f32_16x16x32_bf16 v[234:237], v[134:137], a[204:207], v[234:237]
    buffer_load_dwordx4 a[120:123], v6, s[8:11], s44 offen sc1
    v_mfma_f32_16x16x32_bf16 v[178:181], v[138:141], a[192:195], v[178:181]
    v_mfma_f32_16x16x32_bf16 v[178:181], v[158:161], a[208:211], v[178:181]
    v_mfma_f32_16x16x32_bf16 v[198:201], v[158:161], a[212:215], v[198:201]
    v_mfma_f32_16x16x32_bf16 v[198:201], v[138:141], a[196:199], v[198:201]
    buffer_load_dwordx4 a[124:127], v7, s[8:11], s44 offen sc1
    v_mfma_f32_16x16x32_bf16 v[218:221], v[138:141], a[200:203], v[218:221]
    v_mfma_f32_16x16x32_bf16 v[218:221], v[158:161], a[216:219], v[218:221]
    v_mfma_f32_16x16x32_bf16 v[238:241], v[158:161], a[220:223], v[238:241]
    v_mfma_f32_16x16x32_bf16 v[238:241], v[138:141], a[204:207], v[238:241]
    v_mfma_f32_16x16x32_bf16 v[182:185], v[142:145], a[192:195], v[182:185]
    v_mfma_f32_16x16x32_bf16 v[182:185], v[162:165], a[208:211], v[182:185]
    v_mfma_f32_16x16x32_bf16 v[202:205], v[162:165], a[212:215], v[202:205]
    v_mfma_f32_16x16x32_bf16 v[202:205], v[142:145], a[196:199], v[202:205]
    v_mfma_f32_16x16x32_bf16 v[222:225], v[142:145], a[200:203], v[222:225]
    v_mfma_f32_16x16x32_bf16 v[222:225], v[162:165], a[216:219], v[222:225]
    v_mfma_f32_16x16x32_bf16 v[242:245], v[162:165], a[220:223], v[242:245]
    v_mfma_f32_16x16x32_bf16 v[242:245], v[142:145], a[204:207], v[242:245]
    s_waitcnt vmcnt(8)
    v_mfma_f32_16x16x32_bf16 v[166:169], v[46:49], a[224:227], v[166:169]
    v_mfma_f32_16x16x32_bf16 v[166:169], v[66:69], a[240:243], v[166:169]
    s_add_u32 s44, s30, 163840
    buffer_load_dwordx4 a[192:195], v4, s[8:11], s44 offen sc1
    s_lshl_b32 s36, s2, 5
    v_mfma_f32_16x16x32_bf16 v[186:189], v[66:69], a[244:247], v[186:189]
    ds_read_b128 v[126:129], v9 offset:0
    v_mfma_f32_16x16x32_bf16 v[186:189], v[46:49], a[228:231], v[186:189]
    s_add_u32 s36, s36, s5
    v_mfma_f32_16x16x32_bf16 v[206:209], v[46:49], a[232:235], v[206:209]
    buffer_load_dwordx4 a[196:199], v5, s[8:11], s44 offen sc1
    v_mfma_f32_16x16x32_bf16 v[206:209], v[66:69], a[248:251], v[206:209]
    ds_read_b128 v[130:133], v9 offset:1024
    s_lshl_b32 s36, s36, 2
    v_mfma_f32_16x16x32_bf16 v[226:229], v[66:69], a[252:255], v[226:229]
    s_add_u32 s36, s36, 0x2a0000
    v_mfma_f32_16x16x32_bf16 v[226:229], v[46:49], a[236:239], v[226:229]
    ds_read_b128 v[134:137], v9 offset:2048
    v_mfma_f32_16x16x32_bf16 v[170:173], v[50:53], a[224:227], v[170:173]
    buffer_load_dwordx4 a[200:203], v6, s[8:11], s44 offen sc1
    s_xor_b32 s37, s36, 1024
    v_mfma_f32_16x16x32_bf16 v[170:173], v[70:73], a[240:243], v[170:173]
    v_mfma_f32_16x16x32_bf16 v[190:193], v[70:73], a[244:247], v[190:193]
    ds_read_b128 v[138:141], v9 offset:3072
    s_sub_u32 s40, s5, 1
    v_mfma_f32_16x16x32_bf16 v[190:193], v[50:53], a[228:231], v[190:193]
    v_mfma_f32_16x16x32_bf16 v[210:213], v[50:53], a[232:235], v[210:213]
    buffer_load_dwordx4 a[204:207], v7, s[8:11], s44 offen sc1
    s_and_b32 s40, s40, 3
    v_mfma_f32_16x16x32_bf16 v[210:213], v[70:73], a[248:251], v[210:213]
    ds_read_b128 v[142:145], v9 offset:4096
    s_mul_i32 s40, s40, 20480
    v_mfma_f32_16x16x32_bf16 v[230:233], v[70:73], a[252:255], v[230:233]
    v_mfma_f32_16x16x32_bf16 v[230:233], v[50:53], a[236:239], v[230:233]
    ds_read_b128 v[146:149], v9 offset:5120
    v_lshl_add_u32 v13, v19, 4, s40
    v_mfma_f32_16x16x32_bf16 v[174:177], v[54:57], a[224:227], v[174:177]
    s_add_u32 s44, s30, 180224
    buffer_load_dwordx4 a[208:211], v4, s[8:11], s44 offen sc1
    v_mfma_f32_16x16x32_bf16 v[174:177], v[74:77], a[240:243], v[174:177]
    s_sub_u32 s40, s5, 2
    v_mfma_f32_16x16x32_bf16 v[194:197], v[74:77], a[244:247], v[194:197]
    ds_read_b128 v[150:153], v9 offset:6144
    v_mfma_f32_16x16x32_bf16 v[194:197], v[54:57], a[228:231], v[194:197]
    buffer_load_dwordx4 a[212:215], v5, s[8:11], s44 offen sc1
    s_and_b32 s40, s40, 3
    v_mfma_f32_16x16x32_bf16 v[214:217], v[54:57], a[232:235], v[214:217]
    s_mul_i32 s40, s40, 20480
    v_mfma_f32_16x16x32_bf16 v[214:217], v[74:77], a[248:251], v[214:217]
    ds_read_b128 v[154:157], v9 offset:7168
    v_mfma_f32_16x16x32_bf16 v[234:237], v[74:77], a[252:255], v[234:237]
    v_lshl_add_u32 v14, v19, 4, s40
    v_mfma_f32_16x16x32_bf16 v[234:237], v[54:57], a[236:239], v[234:237]
    buffer_load_dwordx4 a[216:219], v6, s[8:11], s44 offen sc1
    v_mfma_f32_16x16x32_bf16 v[178:181], v[58:61], a[224:227], v[178:181]
    ds_read_b128 v[158:161], v9 offset:8192
    s_sub_u32 s40, s5, 3
    v_mfma_f32_16x16x32_bf16 v[178:181], v[78:81], a[240:243], v[178:181]
    v_mfma_f32_16x16x32_bf16 v[198:201], v[78:81], a[244:247], v[198:201]
    ds_read_b128 v[162:165], v9 offset:9216
    s_and_b32 s40, s40, 3
    v_mfma_f32_16x16x32_bf16 v[198:201], v[58:61], a[228:231], v[198:201]
    buffer_load_dwordx4 a[220:223], v7, s[8:11], s44 offen sc1
    s_mul_i32 s40, s40, 20480
    v_mfma_f32_16x16x32_bf16 v[218:221], v[58:61], a[232:235], v[218:221]
    v_mfma_f32_16x16x32_bf16 v[218:221], v[78:81], a[248:251], v[218:221]
    v_lshl_add_u32 v15, v19, 4, s40
    v_mfma_f32_16x16x32_bf16 v[238:241], v[78:81], a[252:255], v[238:241]
    v_mfma_f32_16x16x32_bf16 v[238:241], v[58:61], a[236:239], v[238:241]
    s_lshl_b32 s40, s2, 2
    v_mfma_f32_16x16x32_bf16 v[182:185], v[62:65], a[224:227], v[182:185]
    v_mfma_f32_16x16x32_bf16 v[182:185], v[82:85], a[240:243], v[182:185]
    s_add_u32 s40, s40, s5
    v_mfma_f32_16x16x32_bf16 v[202:205], v[82:85], a[244:247], v[202:205]
    s_mul_i32 s40, s40, 5120
    v_mfma_f32_16x16x32_bf16 v[202:205], v[62:65], a[228:231], v[202:205]
    v_mfma_f32_16x16x32_bf16 v[222:225], v[62:65], a[232:235], v[222:225]
    s_add_u32 s40, s40, 0x2000000
    v_mfma_f32_16x16x32_bf16 v[222:225], v[82:85], a[248:251], v[222:225]
    v_mfma_f32_16x16x32_bf16 v[242:245], v[82:85], a[252:255], v[242:245]
    v_lshl_add_u32 v18, v19, 4, s40
    v_mfma_f32_16x16x32_bf16 v[242:245], v[62:65], a[236:239], v[242:245]
    s_mov_b32 s41, 4096
    s_waitcnt vmcnt(8) lgkmcnt(0)
    v_mfma_f32_16x16x32_bf16 v[166:169], v[126:129], a[96:99], v[166:169]
    v_mfma_f32_16x16x32_bf16 v[166:169], v[146:149], a[112:115], v[166:169]
    s_add_u32 s44, s31, 0
    buffer_load_dwordx4 a[224:227], v4, s[8:11], s44 offen sc1
    v_mfma_f32_16x16x32_bf16 v[186:189], v[146:149], a[116:119], v[186:189]
    v_mfma_f32_16x16x32_bf16 v[186:189], v[126:129], a[100:103], v[186:189]
    v_mfma_f32_16x16x32_bf16 v[206:209], v[126:129], a[104:107], v[206:209]
    buffer_load_dwordx4 a[228:231], v5, s[8:11], s44 offen sc1
    v_mfma_f32_16x16x32_bf16 v[206:209], v[146:149], a[120:123], v[206:209]
    v_mfma_f32_16x16x32_bf16 v[226:229], v[146:149], a[124:127], v[226:229]
    v_mfma_f32_16x16x32_bf16 v[226:229], v[126:129], a[108:111], v[226:229]
    v_mfma_f32_16x16x32_bf16 v[170:173], v[130:133], a[96:99], v[170:173]
    buffer_load_dwordx4 a[232:235], v6, s[8:11], s44 offen sc1
    v_mfma_f32_16x16x32_bf16 v[170:173], v[150:153], a[112:115], v[170:173]
    v_mfma_f32_16x16x32_bf16 v[190:193], v[150:153], a[116:119], v[190:193]
    v_mfma_f32_16x16x32_bf16 v[190:193], v[130:133], a[100:103], v[190:193]
    v_mfma_f32_16x16x32_bf16 v[210:213], v[130:133], a[104:107], v[210:213]
    buffer_load_dwordx4 a[236:239], v7, s[8:11], s44 offen sc1
    v_mfma_f32_16x16x32_bf16 v[210:213], v[150:153], a[120:123], v[210:213]
    v_mfma_f32_16x16x32_bf16 v[230:233], v[150:153], a[124:127], v[230:233]
    v_mfma_f32_16x16x32_bf16 v[230:233], v[130:133], a[108:111], v[230:233]
    v_mfma_f32_16x16x32_bf16 v[174:177], v[134:137], a[96:99], v[174:177]
    s_add_u32 s44, s31, 16384
    buffer_load_dwordx4 a[240:243], v4, s[8:11], s44 offen sc1
    v_mfma_f32_16x16x32_bf16 v[174:177], v[154:157], a[112:115], v[174:177]
    v_mfma_f32_16x16x32_bf16 v[194:197], v[154:157], a[116:119], v[194:197]
    v_mfma_f32_16x16x32_bf16 v[194:197], v[134:137], a[100:103], v[194:197]
    buffer_load_dwordx4 a[244:247], v5, s[8:11], s44 offen sc1
    v_mfma_f32_16x16x32_bf16 v[214:217], v[134:137], a[104:107], v[214:217]
    v_mfma_f32_16x16x32_bf16 v[214:217], v[154:157], a[120:123], v[214:217]
    v_mfma_f32_16x16x32_bf16 v[234:237], v[154:157], a[124:127], v[234:237]
    v_mfma_f32_16x16x32_bf16 v[234:237], v[134:137], a[108:111], v[234:237]
    buffer_load_dwordx4 a[248:251], v6, s[8:11], s44 offen sc1
    v_mfma_f32_16x16x32_bf16 v[178:181], v[138:141], a[96:99], v[178:181]
    v_mfma_f32_16x16x32_bf16 v[178:181], v[158:161], a[112:115], v[178:181]
    v_mfma_f32_16x16x32_bf16 v[198:201], v[158:161], a[116:119], v[198:201]
    v_mfma_f32_16x16x32_bf16 v[198:201], v[138:141], a[100:103], v[198:201]
    buffer_load_dwordx4 a[252:255], v7, s[8:11], s44 offen sc1
    v_mfma_f32_16x16x32_bf16 v[218:221], v[138:141], a[104:107], v[218:221]
    v_mfma_f32_16x16x32_bf16 v[218:221], v[158:161], a[120:123], v[218:221]
    v_mfma_f32_16x16x32_bf16 v[238:241], v[158:161], a[124:127], v[238:241]
    v_mfma_f32_16x16x32_bf16 v[238:241], v[138:141], a[108:111], v[238:241]
    v_mfma_f32_16x16x32_bf16 v[182:185], v[142:145], a[96:99], v[182:185]
    v_mfma_f32_16x16x32_bf16 v[182:185], v[162:165], a[112:115], v[182:185]
    v_mfma_f32_16x16x32_bf16 v[202:205], v[162:165], a[116:119], v[202:205]
    v_mfma_f32_16x16x32_bf16 v[202:205], v[142:145], a[100:103], v[202:205]
    v_mfma_f32_16x16x32_bf16 v[222:225], v[142:145], a[104:107], v[222:225]
    v_mfma_f32_16x16x32_bf16 v[222:225], v[162:165], a[120:123], v[222:225]
    v_mfma_f32_16x16x32_bf16 v[242:245], v[162:165], a[124:127], v[242:245]
    v_mfma_f32_16x16x32_bf16 v[242:245], v[142:145], a[108:111], v[242:245]
    s_waitcnt vmcnt(8)
    v_mfma_f32_16x16x32_bf16 v[186:189], v[86:89], a[196:199], v[186:189]
    v_mfma_f32_16x16x32_bf16 v[186:189], v[106:109], a[212:215], v[186:189]
    s_add_u32 s44, s31, 32768
    buffer_load_dwordx4 a[96:99], v4, s[8:11], s44 offen sc1
    v_mfma_f32_16x16x32_bf16 v[190:193], v[110:113], a[212:215], v[190:193]
    v_mfma_f32_16x16x32_bf16 v[190:193], v[90:93], a[196:199], v[190:193]
    v_mfma_f32_16x16x32_bf16 v[194:197], v[94:97], a[196:199], v[194:197]
    buffer_load_dwordx4 a[100:103], v5, s[8:11], s44 offen sc1
    v_mfma_f32_16x16x32_bf16 v[194:197], v[114:117], a[212:215], v[194:197]
    v_mfma_f32_16x16x32_bf16 v[198:201], v[118:121], a[212:215], v[198:201]
    v_mfma_f32_16x16x32_bf16 v[198:201], v[98:101], a[196:199], v[198:201]
    v_mfma_f32_16x16x32_bf16 v[202:205], v[102:105], a[196:199], v[202:205]
    buffer_load_dwordx4 a[104:107], v6, s[8:11], s44 offen sc1
    v_mfma_f32_16x16x32_bf16 v[202:205], v[122:125], a[212:215], v[202:205]
    ds_write_b128 v10, v[186:189] offset:0
    v_mfma_f32_16x16x32_bf16 v[206:209], v[106:109], a[216:219], v[206:209]
    v_mfma_f32_16x16x32_bf16 v[206:209], v[86:89], a[200:203], v[206:209]
    ds_write_b128 v10, v[190:193] offset:1024
    v_mfma_f32_16x16x32_bf16 v[210:213], v[90:93], a[200:203], v[210:213]
    buffer_load_dwordx4 a[108:111], v7, s[8:11], s44 offen sc1
    v_mfma_f32_16x16x32_bf16 v[210:213], v[110:113], a[216:219], v[210:213]
    ds_write_b128 v10, v[194:197] offset:2048
    v_mfma_f32_16x16x32_bf16 v[214:217], v[114:117], a[216:219], v[214:217]
    v_mfma_f32_16x16x32_bf16 v[214:217], v[94:97], a[200:203], v[214:217]
    ds_write_b128 v10, v[198:201] offset:3072
    v_mfma_f32_16x16x32_bf16 v[218:221], v[98:101], a[200:203], v[218:221]
    s_add_u32 s44, s31, 49152
    buffer_load_dwordx4 a[112:115], v4, s[8:11], s44 offen sc1
    v_mfma_f32_16x16x32_bf16 v[218:221], v[118:121], a[216:219], v[218:221]
    ds_write_b128 v10, v[202:205] offset:4096
    v_mfma_f32_16x16x32_bf16 v[222:225], v[122:125], a[216:219], v[222:225]
    v_mfma_f32_16x16x32_bf16 v[222:225], v[102:105], a[200:203], v[222:225]
    ds_write_b128 v10, v[206:209] offset:5120
    buffer_load_dwordx4 a[116:119], v5, s[8:11], s44 offen sc1
    v_mfma_f32_16x16x32_bf16 v[226:229], v[86:89], a[204:207], v[226:229]
    v_mfma_f32_16x16x32_bf16 v[226:229], v[106:109], a[220:223], v[226:229]
    ds_write_b128 v10, v[210:213] offset:6144
    v_mfma_f32_16x16x32_bf16 v[230:233], v[110:113], a[220:223], v[230:233]
    v_mfma_f32_16x16x32_bf16 v[230:233], v[90:93], a[204:207], v[230:233]
    ds_write_b128 v10, v[214:217] offset:7168
    buffer_load_dwordx4 a[120:123], v6, s[8:11], s44 offen sc1
    v_mfma_f32_16x16x32_bf16 v[234:237], v[94:97], a[204:207], v[234:237]
    v_mfma_f32_16x16x32_bf16 v[234:237], v[114:117], a[220:223], v[234:237]
    ds_write_b128 v10, v[218:221] offset:8192
    v_mfma_f32_16x16x32_bf16 v[238:241], v[118:121], a[220:223], v[238:241]
    v_mfma_f32_16x16x32_bf16 v[238:241], v[98:101], a[204:207], v[238:241]
    ds_write_b128 v10, v[222:225] offset:9216
    buffer_load_dwordx4 a[124:127], v7, s[8:11], s44 offen sc1
    v_mfma_f32_16x16x32_bf16 v[242:245], v[102:105], a[204:207], v[242:245]
    v_mfma_f32_16x16x32_bf16 v[242:245], v[122:125], a[220:223], v[242:245]
    ds_write_b128 v10, v[226:229] offset:10240
    v_mfma_f32_16x16x32_bf16 v[166:169], v[106:109], a[208:211], v[166:169]
    v_mfma_f32_16x16x32_bf16 v[166:169], v[86:89], a[192:195], v[166:169]
    ds_write_b128 v10, v[230:233] offset:11264
    v_mfma_f32_16x16x32_bf16 v[170:173], v[90:93], a[192:195], v[170:173]
    v_mfma_f32_16x16x32_bf16 v[170:173], v[110:113], a[208:211], v[170:173]
    ds_write_b128 v10, v[234:237] offset:12288
    v_mfma_f32_16x16x32_bf16 v[174:177], v[114:117], a[208:211], v[174:177]
    v_mfma_f32_16x16x32_bf16 v[174:177], v[94:97], a[192:195], v[174:177]
    ds_write_b128 v10, v[238:241] offset:13312
    v_mfma_f32_16x16x32_bf16 v[178:181], v[98:101], a[192:195], v[178:181]
    v_mfma_f32_16x16x32_bf16 v[178:181], v[118:121], a[208:211], v[178:181]
    ds_write_b128 v10, v[242:245] offset:14336
    v_mfma_f32_16x16x32_bf16 v[182:185], v[122:125], a[208:211], v[182:185]
    v_mfma_f32_16x16x32_bf16 v[182:185], v[102:105], a[192:195], v[182:185]
    s_waitcnt vmcnt(8)
    v_mfma_f32_16x16x32_bf16 v[186:189], a[128:131], a[228:231], 0
    s_nop 0
    v_mov_b32 v126, v166
    v_mfma_f32_16x16x32_bf16 v[186:189], a[148:151], a[244:247], v[186:189]
    s_add_u32 s44, s31, 65536
    buffer_load_dwordx4 a[192:195], v4, s[8:11], s44 offen sc1
    v_mov_b32 v127, v167
    v_mov_b32 v128, v168
    v_mov_b32 v129, v169
    v_mfma_f32_16x16x32_bf16 v[190:193], a[152:155], a[244:247], 0
    v_mov_b32 v130, v170
    v_mov_b32 v131, v171
    v_mov_b32 v132, v172
    v_mfma_f32_16x16x32_bf16 v[190:193], a[132:135], a[228:231], v[190:193]
    v_mov_b32 v133, v173
    s_waitcnt lgkmcnt(0)
    s_barrier
    v_mfma_f32_16x16x32_bf16 v[194:197], a[136:139], a[228:231], 0
    buffer_load_dwordx4 a[196:199], v5, s[8:11], s44 offen sc1
    ds_read_b128 v[146:149], v13 offset:0
    ds_read_b128 v[150:153], v13 offset:1024
    v_mfma_f32_16x16x32_bf16 v[194:197], a[156:159], a[244:247], v[194:197]
    ds_read_b128 v[154:157], v13 offset:2048
    ds_read_b128 v[158:161], v13 offset:3072
    ds_read_b128 v[162:165], v13 offset:4096
    v_mfma_f32_16x16x32_bf16 v[198:201], a[160:163], a[244:247], 0
    v_mov_b32 v134, v174
    v_mov_b32 v135, v175
    v_mov_b32 v136, v176
    v_mfma_f32_16x16x32_bf16 v[198:201], a[140:143], a[228:231], v[198:201]
    v_mov_b32 v137, v177
    v_mov_b32 v138, v178
    v_mov_b32 v139, v179
    v_mfma_f32_16x16x32_bf16 v[202:205], a[144:147], a[228:231], 0
    buffer_load_dwordx4 a[200:203], v6, s[8:11], s44 offen sc1
    v_mov_b32 v140, v180
    v_mov_b32 v141, v181
    v_mfma_f32_16x16x32_bf16 v[202:205], a[164:167], a[244:247], v[202:205]
    v_mov_b32 v142, v182
    v_mov_b32 v143, v183
    v_mov_b32 v144, v184
    v_mfma_f32_16x16x32_bf16 v[206:209], a[148:151], a[248:251], 0
    v_mov_b32 v145, v185
    s_waitcnt lgkmcnt(4)
    v_add_f32 v126, v126, v146
    v_mfma_f32_16x16x32_bf16 v[206:209], a[128:131], a[232:235], v[206:209]
    v_add_f32 v127, v127, v147
    v_add_f32 v128, v128, v148
    v_add_f32 v129, v129, v149
    v_mfma_f32_16x16x32_bf16 v[210:213], a[132:135], a[232:235], 0
    buffer_load_dwordx4 a[204:207], v7, s[8:11], s44 offen sc1
    ds_read_b128 v[146:149], v14 offset:5120
    s_waitcnt lgkmcnt(4)
    v_mfma_f32_16x16x32_bf16 v[210:213], a[152:155], a[248:251], v[210:213]
    v_add_f32 v130, v130, v150
    v_add_f32 v131, v131, v151
    v_add_f32 v132, v132, v152
    v_mfma_f32_16x16x32_bf16 v[214:217], a[156:159], a[248:251], 0
    v_add_f32 v133, v133, v153
    ds_read_b128 v[150:153], v14 offset:6144
    s_waitcnt lgkmcnt(4)
    v_mfma_f32_16x16x32_bf16 v[214:217], a[136:139], a[232:235], v[214:217]
    v_add_f32 v134, v134, v154
    v_add_f32 v135, v135, v155
    v_add_f32 v136, v136, v156
    v_mfma_f32_16x16x32_bf16 v[218:221], a[140:143], a[232:235], 0
    s_add_u32 s44, s31, 81920
    buffer_load_dwordx4 a[208:211], v4, s[8:11], s44 offen sc1
    v_add_f32 v137, v137, v157
    ds_read_b128 v[154:157], v14 offset:7168
    v_mfma_f32_16x16x32_bf16 v[218:221], a[160:163], a[248:251], v[218:221]
    s_waitcnt lgkmcnt(4)
    v_add_f32 v138, v138, v158
    v_add_f32 v139, v139, v159
    v_mfma_f32_16x16x32_bf16 v[222:225], a[164:167], a[248:251], 0
    v_add_f32 v140, v140, v160
    v_add_f32 v141, v141, v161
    ds_read_b128 v[158:161], v14 offset:8192
    v_mfma_f32_16x16x32_bf16 v[222:225], a[144:147], a[232:235], v[222:225]
    buffer_load_dwordx4 a[212:215], v5, s[8:11], s44 offen sc1
    s_waitcnt lgkmcnt(4)
    v_add_f32 v142, v142, v162
    v_add_f32 v143, v143, v163
    v_mfma_f32_16x16x32_bf16 v[226:229], a[128:131], a[236:239], 0
    v_add_f32 v144, v144, v164
    v_add_f32 v145, v145, v165
    v_mfma_f32_16x16x32_bf16 v[226:229], a[148:151], a[252:255], v[226:229]
    ds_read_b128 v[162:165], v14 offset:9216
    s_waitcnt lgkmcnt(4)
    v_add_f32 v126, v126, v146
    v_mfma_f32_16x16x32_bf16 v[230:233], a[152:155], a[252:255], 0
    v_add_f32 v127, v127, v147
    v_add_f32 v128, v128, v148
    v_add_f32 v129, v129, v149
    v_mfma_f32_16x16x32_bf16 v[230:233], a[132:135], a[236:239], v[230:233]
    buffer_load_dwordx4 a[216:219], v6, s[8:11], s44 offen sc1
    ds_read_b128 v[146:149], v15 offset:10240
    s_waitcnt lgkmcnt(4)
    v_add_f32 v130, v130, v150
    v_mfma_f32_16x16x32_bf16 v[234:237], a[136:139], a[236:239], 0
    v_add_f32 v131, v131, v151
    v_add_f32 v132, v132, v152
    v_mfma_f32_16x16x32_bf16 v[234:237], a[156:159], a[252:255], v[234:237]
    v_add_f32 v133, v133, v153
    ds_read_b128 v[150:153], v15 offset:11264
    s_waitcnt lgkmcnt(4)
    v_mfma_f32_16x16x32_bf16 v[238:241], a[160:163], a[252:255], 0
    v_add_f32 v134, v134, v154
    v_add_f32 v135, v135, v155
    v_add_f32 v136, v136, v156
    v_mfma_f32_16x16x32_bf16 v[238:241], a[140:143], a[236:239], v[238:241]
    buffer_load_dwordx4 a[220:223], v7, s[8:11], s44 offen sc1
    v_add_f32 v137, v137, v157
    ds_read_b128 v[154:157], v15 offset:12288
    s_waitcnt lgkmcnt(4)
    v_mfma_f32_16x16x32_bf16 v[242:245], a[144:147], a[236:239], 0
    v_add_f32 v138, v138, v158
    v_add_f32 v139, v139, v159
    v_mfma_f32_16x16x32_bf16 v[242:245], a[164:167], a[252:255], v[242:245]
    v_add_f32 v140, v140, v160
    v_add_f32 v141, v141, v161
    ds_read_b128 v[158:161], v15 offset:13312
    v_mfma_f32_16x16x32_bf16 v[166:169], a[148:151], a[240:243], 0
    s_waitcnt lgkmcnt(4)
    v_add_f32 v142, v142, v162
    v_add_f32 v143, v143, v163
    v_mfma_f32_16x16x32_bf16 v[166:169], a[128:131], a[224:227], v[166:169]
    v_add_f32 v144, v144, v164
    v_add_f32 v145, v145, v165
    ds_read_b128 v[162:165], v15 offset:14336
    v_mfma_f32_16x16x32_bf16 v[170:173], a[132:135], a[224:227], 0
    s_waitcnt lgkmcnt(4)
    v_add_f32 v126, v126, v146
    v_mfma_f32_16x16x32_bf16 v[170:173], a[152:155], a[240:243], v[170:173]
    v_add_f32 v127, v127, v147
    v_add_f32 v128, v128, v148
    v_add_f32 v129, v129, v149
    v_mfma_f32_16x16x32_bf16 v[174:177], a[156:159], a[240:243], 0
    s_waitcnt lgkmcnt(3)
    v_add_f32 v130, v130, v150
    v_add_f32 v131, v131, v151
    v_mfma_f32_16x16x32_bf16 v[174:177], a[136:139], a[224:227], v[174:177]
    v_add_f32 v132, v132, v152
    v_add_f32 v133, v133, v153
    s_waitcnt lgkmcnt(2)
    v_mfma_f32_16x16x32_bf16 v[178:181], a[140:143], a[224:227], 0
    v_add_f32 v134, v134, v154
    v_add_f32 v135, v135, v155
    v_mfma_f32_16x16x32_bf16 v[178:181], a[160:163], a[240:243], v[178:181]
    v_add_f32 v136, v136, v156
    v_add_f32 v137, v137, v157
    s_waitcnt lgkmcnt(1)
    v_mfma_f32_16x16x32_bf16 v[182:185], a[164:167], a[240:243], 0
    v_add_f32 v138, v138, v158
    v_add_f32 v139, v139, v159
    v_add_f32 v140, v140, v160
    v_mfma_f32_16x16x32_bf16 v[182:185], a[144:147], a[224:227], v[182:185]
    v_add_f32 v141, v141, v161
    s_waitcnt lgkmcnt(0)
    v_add_f32 v142, v142, v162
    s_waitcnt vmcnt(8)
    v_mfma_f32_16x16x32_bf16 v[166:169], a[168:171], a[96:99], v[166:169]
    v_mfma_f32_16x16x32_bf16 v[166:169], a[188:191], a[112:115], v[166:169]
    s_add_u32 s44, s31, 196608
    buffer_load_dwordx4 a[224:227], v4, s[8:11], s44 offen sc1
    v_mfma_f32_16x16x32_bf16 v[186:189], a[188:191], a[116:119], v[186:189]
    buffer_load_dwordx4 a[228:231], v5, s[8:11], s44 offen sc1
    v_mfma_f32_16x16x32_bf16 v[186:189], a[168:171], a[100:103], v[186:189]
    buffer_load_dwordx4 a[232:235], v6, s[8:11], s44 offen sc1
    v_add_f32 v143, v143, v163
    v_mfma_f32_16x16x32_bf16 v[206:209], a[168:171], a[104:107], v[206:209]
    buffer_load_dwordx4 a[236:239], v7, s[8:11], s44 offen sc1
    v_mfma_f32_16x16x32_bf16 v[206:209], a[188:191], a[120:123], v[206:209]
    v_mfma_f32_16x16x32_bf16 v[226:229], a[188:191], a[124:127], v[226:229]
    s_add_u32 s44, s31, 212992
    buffer_load_dwordx4 a[240:243], v4, s[8:11], s44 offen sc1
    v_add_f32 v144, v144, v164
    v_mfma_f32_16x16x32_bf16 v[226:229], a[168:171], a[108:111], v[226:229]
    buffer_load_dwordx4 a[244:247], v5, s[8:11], s44 offen sc1
    v_mfma_f32_16x16x32_bf16 v[170:173], a[172:175], a[96:99], v[170:173]
    buffer_load_dwordx4 a[248:251], v6, s[8:11], s44 offen sc1
    v_mfma_f32_16x16x32_bf16 v[170:173], a[0:3], a[112:115], v[170:173]
    buffer_load_dwordx4 a[252:255], v7, s[8:11], s44 offen sc1
    v_add_f32 v145, v145, v165
    v_mfma_f32_16x16x32_bf16 v[190:193], a[0:3], a[116:119], v[190:193]
    v_mfma_f32_16x16x32_bf16 v[190:193], a[172:175], a[100:103], v[190:193]
    v_mfma_f32_16x16x32_bf16 v[210:213], a[172:175], a[104:107], v[210:213]
    buffer_store_dwordx4 v[126:129], v18, s[76:79], 0 offen offset:0 sc1
    v_mfma_f32_16x16x32_bf16 v[210:213], a[0:3], a[120:123], v[210:213]
    v_mfma_f32_16x16x32_bf16 v[230:233], a[0:3], a[124:127], v[230:233]
    v_mfma_f32_16x16x32_bf16 v[230:233], a[172:175], a[108:111], v[230:233]
    v_mfma_f32_16x16x32_bf16 v[174:177], a[176:179], a[96:99], v[174:177]
    v_mfma_f32_16x16x32_bf16 v[174:177], a[4:7], a[112:115], v[174:177]
    v_mfma_f32_16x16x32_bf16 v[194:197], a[4:7], a[116:119], v[194:197]
    buffer_store_dwordx4 v[130:133], v18, s[76:79], 0 offen offset:1024 sc1
    v_mfma_f32_16x16x32_bf16 v[194:197], a[176:179], a[100:103], v[194:197]
    v_mfma_f32_16x16x32_bf16 v[214:217], a[176:179], a[104:107], v[214:217]
    v_mfma_f32_16x16x32_bf16 v[214:217], a[4:7], a[120:123], v[214:217]
    v_mfma_f32_16x16x32_bf16 v[234:237], a[4:7], a[124:127], v[234:237]
    v_mfma_f32_16x16x32_bf16 v[234:237], a[176:179], a[108:111], v[234:237]
    v_mfma_f32_16x16x32_bf16 v[178:181], a[180:183], a[96:99], v[178:181]
    buffer_store_dwordx4 v[134:137], v18, s[76:79], 0 offen offset:2048 sc1
    v_mfma_f32_16x16x32_bf16 v[178:181], a[8:11], a[112:115], v[178:181]
    v_mfma_f32_16x16x32_bf16 v[198:201], a[8:11], a[116:119], v[198:201]
    v_mfma_f32_16x16x32_bf16 v[198:201], a[180:183], a[100:103], v[198:201]
    v_mfma_f32_16x16x32_bf16 v[218:221], a[180:183], a[104:107], v[218:221]
    v_mfma_f32_16x16x32_bf16 v[218:221], a[8:11], a[120:123], v[218:221]
    v_mfma_f32_16x16x32_bf16 v[238:241], a[8:11], a[124:127], v[238:241]
    buffer_store_dwordx4 v[138:141], v18, s[76:79], 0 offen offset:3072 sc1
    v_mfma_f32_16x16x32_bf16 v[238:241], a[180:183], a[108:111], v[238:241]
    v_mfma_f32_16x16x32_bf16 v[182:185], a[184:187], a[96:99], v[182:185]
    v_mfma_f32_16x16x32_bf16 v[182:185], a[12:15], a[112:115], v[182:185]
    v_mfma_f32_16x16x32_bf16 v[202:205], a[12:15], a[116:119], v[202:205]
    v_mfma_f32_16x16x32_bf16 v[202:205], a[184:187], a[100:103], v[202:205]
    v_mfma_f32_16x16x32_bf16 v[222:225], a[184:187], a[104:107], v[222:225]
    buffer_store_dwordx4 v[142:145], v18, s[76:79], s41 offen offset:0 sc1
    v_mfma_f32_16x16x32_bf16 v[222:225], a[12:15], a[120:123], v[222:225]
    v_mfma_f32_16x16x32_bf16 v[242:245], a[12:15], a[124:127], v[242:245]
    v_mfma_f32_16x16x32_bf16 v[242:245], a[184:187], a[108:111], v[242:245]
    s_waitcnt vmcnt(13)
    v_mfma_f32_16x16x32_bf16 v[166:169], a[16:19], a[192:195], v[166:169]
    v_mfma_f32_16x16x32_bf16 v[166:169], a[36:39], a[208:211], v[166:169]
    s_add_u32 s44, s31, 98304
    buffer_load_dwordx4 a[96:99], v4, s[8:11], s44 offen sc1
    v_mfma_f32_16x16x32_bf16 v[186:189], a[36:39], a[212:215], v[186:189]
    v_mfma_f32_16x16x32_bf16 v[186:189], a[16:19], a[196:199], v[186:189]
    v_mfma_f32_16x16x32_bf16 v[206:209], a[16:19], a[200:203], v[206:209]
    buffer_load_dwordx4 a[100:103], v5, s[8:11], s44 offen sc1
    v_mfma_f32_16x16x32_bf16 v[206:209], a[36:39], a[216:219], v[206:209]
    v_mfma_f32_16x16x32_bf16 v[226:229], a[36:39], a[220:223], v[226:229]
    v_mfma_f32_16x16x32_bf16 v[226:229], a[16:19], a[204:207], v[226:229]
    v_mfma_f32_16x16x32_bf16 v[170:173], a[20:23], a[192:195], v[170:173]
    buffer_load_dwordx4 a[104:107], v6, s[8:11], s44 offen sc1
    v_mfma_f32_16x16x32_bf16 v[170:173], a[40:43], a[208:211], v[170:173]
    v_mfma_f32_16x16x32_bf16 v[190:193], a[40:43], a[212:215], v[190:193]
    v_mfma_f32_16x16x32_bf16 v[190:193], a[20:23], a[196:199], v[190:193]
    v_mfma_f32_16x16x32_bf16 v[210:213], a[20:23], a[200:203], v[210:213]
    buffer_load_dwordx4 a[108:111], v7, s[8:11], s44 offen sc1
    v_mfma_f32_16x16x32_bf16 v[210:213], a[40:43], a[216:219], v[210:213]
    v_mfma_f32_16x16x32_bf16 v[230:233], a[40:43], a[220:223], v[230:233]
    v_mfma_f32_16x16x32_bf16 v[230:233], a[20:23], a[204:207], v[230:233]
    ds_read_b128 v[126:129], v8 offset:0
    v_mfma_f32_16x16x32_bf16 v[174:177], a[24:27], a[192:195], v[174:177]
    s_add_u32 s44, s31, 114688
    buffer_load_dwordx4 a[112:115], v4, s[8:11], s44 offen sc1
    v_mfma_f32_16x16x32_bf16 v[174:177], a[44:47], a[208:211], v[174:177]
    v_mfma_f32_16x16x32_bf16 v[194:197], a[44:47], a[212:215], v[194:197]
    ds_read_b128 v[130:133], v8 offset:1024
    v_mfma_f32_16x16x32_bf16 v[194:197], a[24:27], a[196:199], v[194:197]
    buffer_load_dwordx4 a[116:119], v5, s[8:11], s44 offen sc1
    v_mfma_f32_16x16x32_bf16 v[214:217], a[24:27], a[200:203], v[214:217]
    v_mfma_f32_16x16x32_bf16 v[214:217], a[44:47], a[216:219], v[214:217]
    ds_read_b128 v[134:137], v8 offset:2048
    v_mfma_f32_16x16x32_bf16 v[234:237], a[44:47], a[220:223], v[234:237]
    v_mfma_f32_16x16x32_bf16 v[234:237], a[24:27], a[204:207], v[234:237]
    buffer_load_dwordx4 a[120:123], v6, s[8:11], s44 offen sc1
    v_mfma_f32_16x16x32_bf16 v[178:181], a[28:31], a[192:195], v[178:181]
    ds_read_b128 v[138:141], v8 offset:3072
    v_mfma_f32_16x16x32_bf16 v[178:181], a[48:51], a[208:211], v[178:181]
    v_mfma_f32_16x16x32_bf16 v[198:201], a[48:51], a[212:215], v[198:201]
    ds_read_b128 v[142:145], v8 offset:4096
    v_mfma_f32_16x16x32_bf16 v[198:201], a[28:31], a[196:199], v[198:201]
    buffer_load_dwordx4 a[124:127], v7, s[8:11], s44 offen sc1
    v_mfma_f32_16x16x32_bf16 v[218:221], a[28:31], a[200:203], v[218:221]
    v_mfma_f32_16x16x32_bf16 v[218:221], a[48:51], a[216:219], v[218:221]
    ds_read_b128 v[146:149], v8 offset:5120
    v_mfma_f32_16x16x32_bf16 v[238:241], a[48:51], a[220:223], v[238:241]
    v_mfma_f32_16x16x32_bf16 v[238:241], a[28:31], a[204:207], v[238:241]
    ds_read_b128 v[150:153], v8 offset:6144
    v_mfma_f32_16x16x32_bf16 v[182:185], a[32:35], a[192:195], v[182:185]
    v_mfma_f32_16x16x32_bf16 v[182:185], a[52:55], a[208:211], v[182:185]
    ds_read_b128 v[154:157], v8 offset:7168
    v_mfma_f32_16x16x32_bf16 v[202:205], a[52:55], a[212:215], v[202:205]
    v_mfma_f32_16x16x32_bf16 v[202:205], a[32:35], a[196:199], v[202:205]
    ds_read_b128 v[158:161], v8 offset:8192
    v_mfma_f32_16x16x32_bf16 v[222:225], a[32:35], a[200:203], v[222:225]
    v_mfma_f32_16x16x32_bf16 v[222:225], a[52:55], a[216:219], v[222:225]
    ds_read_b128 v[162:165], v8 offset:9216
    v_mfma_f32_16x16x32_bf16 v[242:245], a[52:55], a[220:223], v[242:245]
    v_mfma_f32_16x16x32_bf16 v[242:245], a[32:35], a[204:207], v[242:245]
    s_waitcnt vmcnt(13) lgkmcnt(0)
    v_mfma_f32_16x16x32_bf16 v[166:169], v[126:129], a[224:227], v[166:169]
    s_waitcnt vmcnt(8)
    s_mov_b64 exec, 1
    buffer_store_dword v2, off, s[76:79], s36 sc1
    s_mov_b64 exec, -1
    v_mfma_f32_16x16x32_bf16 v[166:169], v[146:149], a[240:243], v[166:169]
    s_add_u32 s44, s31, 229376
    buffer_load_dwordx4 a[192:195], v4, s[8:11], s44 offen sc1
    v_mfma_f32_16x16x32_bf16 v[186:189], v[146:149], a[244:247], v[186:189]
    v_mfma_f32_16x16x32_bf16 v[186:189], v[126:129], a[228:231], v[186:189]
    v_mfma_f32_16x16x32_bf16 v[206:209], v[126:129], a[232:235], v[206:209]
    buffer_load_dwordx4 a[196:199], v5, s[8:11], s44 offen sc1
    v_mfma_f32_16x16x32_bf16 v[206:209], v[146:149], a[248:251], v[206:209]
    v_mfma_f32_16x16x32_bf16 v[226:229], v[146:149], a[252:255], v[226:229]
    v_mfma_f32_16x16x32_bf16 v[226:229], v[126:129], a[236:239], v[226:229]
    v_mfma_f32_16x16x32_bf16 v[170:173], v[130:133], a[224:227], v[170:173]
    buffer_load_dwordx4 a[200:203], v6, s[8:11], s44 offen sc1
    v_mfma_f32_16x16x32_bf16 v[170:173], v[150:153], a[240:243], v[170:173]
    v_mfma_f32_16x16x32_bf16 v[190:193], v[150:153], a[244:247], v[190:193]
    v_mfma_f32_16x16x32_bf16 v[190:193], v[130:133], a[228:231], v[190:193]
    v_mfma_f32_16x16x32_bf16 v[210:213], v[130:133], a[232:235], v[210:213]
    buffer_load_dwordx4 a[204:207], v7, s[8:11], s44 offen sc1
    v_mfma_f32_16x16x32_bf16 v[210:213], v[150:153], a[248:251], v[210:213]
    v_mfma_f32_16x16x32_bf16 v[230:233], v[150:153], a[252:255], v[230:233]
    v_mfma_f32_16x16x32_bf16 v[230:233], v[130:133], a[236:239], v[230:233]
    v_mfma_f32_16x16x32_bf16 v[174:177], v[134:137], a[224:227], v[174:177]
    s_add_u32 s44, s31, 245760
    buffer_load_dwordx4 a[208:211], v4, s[8:11], s44 offen sc1
    v_mfma_f32_16x16x32_bf16 v[174:177], v[154:157], a[240:243], v[174:177]
    v_mfma_f32_16x16x32_bf16 v[194:197], v[154:157], a[244:247], v[194:197]
    v_mfma_f32_16x16x32_bf16 v[194:197], v[134:137], a[228:231], v[194:197]
    buffer_load_dwordx4 a[212:215], v5, s[8:11], s44 offen sc1
    v_mfma_f32_16x16x32_bf16 v[214:217], v[134:137], a[232:235], v[214:217]
    v_mfma_f32_16x16x32_bf16 v[214:217], v[154:157], a[248:251], v[214:217]
    v_mfma_f32_16x16x32_bf16 v[234:237], v[154:157], a[252:255], v[234:237]
    v_mfma_f32_16x16x32_bf16 v[234:237], v[134:137], a[236:239], v[234:237]
    buffer_load_dwordx4 a[216:219], v6, s[8:11], s44 offen sc1
    v_mfma_f32_16x16x32_bf16 v[178:181], v[138:141], a[224:227], v[178:181]
    v_mfma_f32_16x16x32_bf16 v[178:181], v[158:161], a[240:243], v[178:181]
    v_mfma_f32_16x16x32_bf16 v[198:201], v[158:161], a[244:247], v[198:201]
    v_mfma_f32_16x16x32_bf16 v[198:201], v[138:141], a[228:231], v[198:201]
    buffer_load_dwordx4 a[220:223], v7, s[8:11], s44 offen sc1
    v_mfma_f32_16x16x32_bf16 v[218:221], v[138:141], a[232:235], v[218:221]
    v_mfma_f32_16x16x32_bf16 v[218:221], v[158:161], a[248:251], v[218:221]
    v_mfma_f32_16x16x32_bf16 v[238:241], v[158:161], a[252:255], v[238:241]
    v_mfma_f32_16x16x32_bf16 v[238:241], v[138:141], a[236:239], v[238:241]
    v_mfma_f32_16x16x32_bf16 v[182:185], v[142:145], a[224:227], v[182:185]
    v_mfma_f32_16x16x32_bf16 v[182:185], v[162:165], a[240:243], v[182:185]
    v_mfma_f32_16x16x32_bf16 v[202:205], v[162:165], a[244:247], v[202:205]
    v_mfma_f32_16x16x32_bf16 v[202:205], v[142:145], a[228:231], v[202:205]
    v_mfma_f32_16x16x32_bf16 v[222:225], v[142:145], a[232:235], v[222:225]
    v_mfma_f32_16x16x32_bf16 v[222:225], v[162:165], a[248:251], v[222:225]
    v_mfma_f32_16x16x32_bf16 v[242:245], v[162:165], a[252:255], v[242:245]
    v_mfma_f32_16x16x32_bf16 v[242:245], v[142:145], a[236:239], v[242:245]
    s_waitcnt vmcnt(9)
    v_mfma_f32_16x16x32_bf16 v[166:169], a[56:59], a[96:99], v[166:169]
    v_mfma_f32_16x16x32_bf16 v[166:169], a[76:79], a[112:115], v[166:169]
    s_add_u32 s44, s31, 131072
    buffer_load_dwordx4 a[224:227], v4, s[8:11], s44 offen sc1
    v_mfma_f32_16x16x32_bf16 v[186:189], a[76:79], a[116:119], v[186:189]
    ds_read_b128 v[126:129], v9 offset:0
    v_mfma_f32_16x16x32_bf16 v[186:189], a[56:59], a[100:103], v[186:189]
    v_mfma_f32_16x16x32_bf16 v[206:209], a[56:59], a[104:107], v[206:209]
    buffer_load_dwordx4 a[228:231], v5, s[8:11], s44 offen sc1
    v_mfma_f32_16x16x32_bf16 v[206:209], a[76:79], a[120:123], v[206:209]
    ds_read_b128 v[130:133], v9 offset:1024
    v_mfma_f32_16x16x32_bf16 v[226:229], a[76:79], a[124:127], v[226:229]
    v_mfma_f32_16x16x32_bf16 v[226:229], a[56:59], a[108:111], v[226:229]
    ds_read_b128 v[134:137], v9 offset:2048
    v_mfma_f32_16x16x32_bf16 v[170:173], a[60:63], a[96:99], v[170:173]
    buffer_load_dwordx4 a[232:235], v6, s[8:11], s44 offen sc1
    v_mfma_f32_16x16x32_bf16 v[170:173], a[80:83], a[112:115], v[170:173]
    v_mfma_f32_16x16x32_bf16 v[190:193], a[80:83], a[116:119], v[190:193]
    ds_read_b128 v[138:141], v9 offset:3072
    v_mfma_f32_16x16x32_bf16 v[190:193], a[60:63], a[100:103], v[190:193]
    v_mfma_f32_16x16x32_bf16 v[210:213], a[60:63], a[104:107], v[210:213]
    buffer_load_dwordx4 a[236:239], v7, s[8:11], s44 offen sc1
    v_mfma_f32_16x16x32_bf16 v[210:213], a[80:83], a[120:123], v[210:213]
    ds_read_b128 v[142:145], v9 offset:4096
    v_mfma_f32_16x16x32_bf16 v[230:233], a[80:83], a[124:127], v[230:233]
    v_mfma_f32_16x16x32_bf16 v[230:233], a[60:63], a[108:111], v[230:233]
    ds_read_b128 v[146:149], v9 offset:5120
    v_mfma_f32_16x16x32_bf16 v[174:177], a[64:67], a[96:99], v[174:177]
    s_add_u32 s44, s31, 147456
    buffer_load_dwordx4 a[240:243], v4, s[8:11], s44 offen sc1
    v_mfma_f32_16x16x32_bf16 v[174:177], a[84:87], a[112:115], v[174:177]
    v_mfma_f32_16x16x32_bf16 v[194:197], a[84:87], a[116:119], v[194:197]
    ds_read_b128 v[150:153], v9 offset:6144
    v_mfma_f32_16x16x32_bf16 v[194:197], a[64:67], a[100:103], v[194:197]
    buffer_load_dwordx4 a[244:247], v5, s[8:11], s44 offen sc1
    v_mfma_f32_16x16x32_bf16 v[214:217], a[64:67], a[104:107], v[214:217]
    v_mfma_f32_16x16x32_bf16 v[214:217], a[84:87], a[120:123], v[214:217]
    ds_read_b128 v[154:157], v9 offset:7168
    v_mfma_f32_16x16x32_bf16 v[234:237], a[84:87], a[124:127], v[234:237]
    v_mfma_f32_16x16x32_bf16 v[234:237], a[64:67], a[108:111], v[234:237]
    buffer_load_dwordx4 a[248:251], v6, s[8:11], s44 offen sc1
    v_mfma_f32_16x16x32_bf16 v[178:181], a[68:71], a[96:99], v[178:181]
    ds_read_b128 v[158:161], v9 offset:8192
    v_mfma_f32_16x16x32_bf16 v[178:181], a[88:91], a[112:115], v[178:181]
    v_mfma_f32_16x16x32_bf16 v[198:201], a[88:91], a[116:119], v[198:201]
    ds_read_b128 v[162:165], v9 offset:9216
    v_mfma_f32_16x16x32_bf16 v[198:201], a[68:71], a[100:103], v[198:201]
    buffer_load_dwordx4 a[252:255], v7, s[8:11], s44 offen sc1
    v_mfma_f32_16x16x32_bf16 v[218:221], a[68:71], a[104:107], v[218:221]
    v_mfma_f32_16x16x32_bf16 v[218:221], a[88:91], a[120:123], v[218:221]
    v_mfma_f32_16x16x32_bf16 v[238:241], a[88:91], a[124:127], v[238:241]
    v_mfma_f32_16x16x32_bf16 v[238:241], a[68:71], a[108:111], v[238:241]
    v_mfma_f32_16x16x32_bf16 v[182:185], a[72:75], a[96:99], v[182:185]
    v_mfma_f32_16x16x32_bf16 v[182:185], a[92:95], a[112:115], v[182:185]
    v_mfma_f32_16x16x32_bf16 v[202:205], a[92:95], a[116:119], v[202:205]
    v_mfma_f32_16x16x32_bf16 v[202:205], a[72:75], a[100:103], v[202:205]
    v_mfma_f32_16x16x32_bf16 v[222:225], a[72:75], a[104:107], v[222:225]
    v_mfma_f32_16x16x32_bf16 v[222:225], a[92:95], a[120:123], v[222:225]
    v_mfma_f32_16x16x32_bf16 v[242:245], a[92:95], a[124:127], v[242:245]
    v_mfma_f32_16x16x32_bf16 v[242:245], a[72:75], a[108:111], v[242:245]
    s_waitcnt vmcnt(8) lgkmcnt(0)
    v_mfma_f32_16x16x32_bf16 v[166:169], v[126:129], a[192:195], v[166:169]
    v_mfma_f32_16x16x32_bf16 v[166:169], v[146:149], a[208:211], v[166:169]
    s_add_u32 s44, s31, 163840
    buffer_load_dwordx4 a[96:99], v4, s[8:11], s44 offen sc1
    v_mfma_f32_16x16x32_bf16 v[186:189], v[146:149], a[212:215], v[186:189]
    v_mfma_f32_16x16x32_bf16 v[186:189], v[126:129], a[196:199], v[186:189]
    v_mfma_f32_16x16x32_bf16 v[206:209], v[126:129], a[200:203], v[206:209]
    buffer_load_dwordx4 a[100:103], v5, s[8:11], s44 offen sc1
    v_mfma_f32_16x16x32_bf16 v[206:209], v[146:149], a[216:219], v[206:209]
    v_mfma_f32_16x16x32_bf16 v[226:229], v[146:149], a[220:223], v[226:229]
    v_mfma_f32_16x16x32_bf16 v[226:229], v[126:129], a[204:207], v[226:229]
    v_mfma_f32_16x16x32_bf16 v[170:173], v[130:133], a[192:195], v[170:173]
    buffer_load_dwordx4 a[104:107], v6, s[8:11], s44 offen sc1
    v_mfma_f32_16x16x32_bf16 v[170:173], v[150:153], a[208:211], v[170:173]
    v_mfma_f32_16x16x32_bf16 v[190:193], v[150:153], a[212:215], v[190:193]
    v_mfma_f32_16x16x32_bf16 v[190:193], v[130:133], a[196:199], v[190:193]
    v_mfma_f32_16x16x32_bf16 v[210:213], v[130:133], a[200:203], v[210:213]
    buffer_load_dwordx4 a[108:111], v7, s[8:11], s44 offen sc1
    v_mfma_f32_16x16x32_bf16 v[210:213], v[150:153], a[216:219], v[210:213]
    v_mfma_f32_16x16x32_bf16 v[230:233], v[150:153], a[220:223], v[230:233]
    v_mfma_f32_16x16x32_bf16 v[230:233], v[130:133], a[204:207], v[230:233]
    v_mfma_f32_16x16x32_bf16 v[174:177], v[134:137], a[192:195], v[174:177]
    s_add_u32 s44, s31, 180224
    buffer_load_dwordx4 a[112:115], v4, s[8:11], s44 offen sc1
    v_mfma_f32_16x16x32_bf16 v[174:177], v[154:157], a[208:211], v[174:177]
    v_mfma_f32_16x16x32_bf16 v[194:197], v[154:157], a[212:215], v[194:197]
    v_mfma_f32_16x16x32_bf16 v[194:197], v[134:137], a[196:199], v[194:197]
    buffer_load_dwordx4 a[116:119], v5, s[8:11], s44 offen sc1
    v_mfma_f32_16x16x32_bf16 v[214:217], v[134:137], a[200:203], v[214:217]
    v_mfma_f32_16x16x32_bf16 v[214:217], v[154:157], a[216:219], v[214:217]
    v_mfma_f32_16x16x32_bf16 v[234:237], v[154:157], a[220:223], v[234:237]
    v_mfma_f32_16x16x32_bf16 v[234:237], v[134:137], a[204:207], v[234:237]
    buffer_load_dwordx4 a[120:123], v6, s[8:11], s44 offen sc1
    v_mfma_f32_16x16x32_bf16 v[178:181], v[138:141], a[192:195], v[178:181]
    v_mfma_f32_16x16x32_bf16 v[178:181], v[158:161], a[208:211], v[178:181]
    v_mfma_f32_16x16x32_bf16 v[198:201], v[158:161], a[212:215], v[198:201]
    v_mfma_f32_16x16x32_bf16 v[198:201], v[138:141], a[196:199], v[198:201]
    buffer_load_dwordx4 a[124:127], v7, s[8:11], s44 offen sc1
    v_mfma_f32_16x16x32_bf16 v[218:221], v[138:141], a[200:203], v[218:221]
    v_mfma_f32_16x16x32_bf16 v[218:221], v[158:161], a[216:219], v[218:221]
    v_mfma_f32_16x16x32_bf16 v[238:241], v[158:161], a[220:223], v[238:241]
    v_mfma_f32_16x16x32_bf16 v[238:241], v[138:141], a[204:207], v[238:241]
    v_mfma_f32_16x16x32_bf16 v[182:185], v[142:145], a[192:195], v[182:185]
    v_mfma_f32_16x16x32_bf16 v[182:185], v[162:165], a[208:211], v[182:185]
    v_mfma_f32_16x16x32_bf16 v[202:205], v[162:165], a[212:215], v[202:205]
    v_mfma_f32_16x16x32_bf16 v[202:205], v[142:145], a[196:199], v[202:205]
    v_mfma_f32_16x16x32_bf16 v[222:225], v[142:145], a[200:203], v[222:225]
    v_mfma_f32_16x16x32_bf16 v[222:225], v[162:165], a[216:219], v[222:225]
    v_mfma_f32_16x16x32_bf16 v[242:245], v[162:165], a[220:223], v[242:245]
    s_sub_u32 s40, s5, 1
    s_and_b32 s40, s40, 3
    s_mul_i32 s40, s40, 10240
    s_add_u32 s40, s40, 122880
    v_lshl_add_u32 v5, v19, 4, s40
    s_sub_u32 s40, s5, 2
    s_and_b32 s40, s40, 3
    s_mul_i32 s40, s40, 10240
    s_add_u32 s40, s40, 122880
    v_lshl_add_u32 v6, v19, 4, s40
    s_sub_u32 s40, s5, 3
    s_and_b32 s40, s40, 3
    s_mul_i32 s40, s40, 10240
    s_add_u32 s40, s40, 81920
    v_lshl_add_u32 v7, v19, 4, s40
    buffer_load_dword v1, off, s[76:79], s37 sc1
    v_mfma_f32_16x16x32_bf16 v[242:245], v[142:145], a[204:207], v[242:245]
    s_waitcnt vmcnt(9)
    v_mfma_f32_16x16x32_bf16 v[166:169], v[46:49], a[224:227], v[166:169]
    v_lshlrev_b32 v126, 16, v36
    v_mfma_f32_16x16x32_bf16 v[166:169], v[66:69], a[240:243], v[166:169]
    v_and_b32 v127, 0xffff0000, v36
    v_mfma_f32_16x16x32_bf16 v[186:189], v[66:69], a[244:247], v[186:189]
    v_lshlrev_b32 v146, 16, v22
    v_mfma_f32_16x16x32_bf16 v[186:189], v[46:49], a[228:231], v[186:189]
    v_and_b32 v147, 0xffff0000, v22
    v_mfma_f32_16x16x32_bf16 v[206:209], v[46:49], a[232:235], v[206:209]
    v_lshlrev_b32 v128, 16, v37
    v_mfma_f32_16x16x32_bf16 v[206:209], v[66:69], a[248:251], v[206:209]
    v_and_b32 v129, 0xffff0000, v37
    v_mfma_f32_16x16x32_bf16 v[226:229], v[66:69], a[252:255], v[226:229]
    v_lshlrev_b32 v148, 16, v23
    v_mfma_f32_16x16x32_bf16 v[226:229], v[46:49], a[236:239], v[226:229]
    v_and_b32 v149, 0xffff0000, v23
    v_mfma_f32_16x16x32_bf16 v[170:173], v[50:53], a[224:227], v[170:173]
    v_lshlrev_b32 v130, 16, v38
    v_mfma_f32_16x16x32_bf16 v[170:173], v[70:73], a[240:243], v[170:173]
    v_and_b32 v131, 0xffff0000, v38
    v_mfma_f32_16x16x32_bf16 v[190:193], v[70:73], a[244:247], v[190:193]
    v_lshlrev_b32 v150, 16, v24
    v_mfma_f32_16x16x32_bf16 v[190:193], v[50:53], a[228:231], v[190:193]
    v_and_b32 v151, 0xffff0000, v24
    v_mfma_f32_16x16x32_bf16 v[210:213], v[50:53], a[232:235], v[210:213]
    v_lshlrev_b32 v132, 16, v39
    v_mfma_f32_16x16x32_bf16 v[210:213], v[70:73], a[248:251], v[210:213]
    v_and_b32 v133, 0xffff0000, v39
    v_mfma_f32_16x16x32_bf16 v[230:233], v[70:73], a[252:255], v[230:233]
    v_lshlrev_b32 v152, 16, v25
    v_mfma_f32_16x16x32_bf16 v[230:233], v[50:53], a[236:239], v[230:233]
    v_and_b32 v153, 0xffff0000, v25
    v_mfma_f32_16x16x32_bf16 v[174:177], v[54:57], a[224:227], v[174:177]
    v_lshlrev_b32 v134, 16, v40
    v_mfma_f32_16x16x32_bf16 v[174:177], v[74:77], a[240:243], v[174:177]
    v_and_b32 v135, 0xffff0000, v40
    v_mfma_f32_16x16x32_bf16 v[194:197], v[74:77], a[244:247], v[194:197]
    v_lshlrev_b32 v154, 16, v26
    v_mfma_f32_16x16x32_bf16 v[194:197], v[54:57], a[228:231], v[194:197]
    v_and_b32 v155, 0xffff0000, v26
    v_mfma_f32_16x16x32_bf16 v[214:217], v[54:57], a[232:235], v[214:217]
    v_lshlrev_b32 v136, 16, v41
    v_mfma_f32_16x16x32_bf16 v[214:217], v[74:77], a[248:251], v[214:217]
    v_and_b32 v137, 0xffff0000, v41
    v_mfma_f32_16x16x32_bf16 v[234:237], v[74:77], a[252:255], v[234:237]
    v_lshlrev_b32 v156, 16, v27
    v_mfma_f32_16x16x32_bf16 v[234:237], v[54:57], a[236:239], v[234:237]
    v_and_b32 v157, 0xffff0000, v27
    v_mfma_f32_16x16x32_bf16 v[178:181], v[58:61], a[224:227], v[178:181]
    v_lshlrev_b32 v138, 16, v42
    v_mfma_f32_16x16x32_bf16 v[178:181], v[78:81], a[240:243], v[178:181]
    v_and_b32 v139, 0xffff0000, v42
    v_mfma_f32_16x16x32_bf16 v[198:201], v[78:81], a[244:247], v[198:201]
    v_lshlrev_b32 v158, 16, v28
    v_mfma_f32_16x16x32_bf16 v[198:201], v[58:61], a[228:231], v[198:201]
    v_and_b32 v159, 0xffff0000, v28
    v_mfma_f32_16x16x32_bf16 v[218:221], v[58:61], a[232:235], v[218:221]
    v_lshlrev_b32 v140, 16, v43
    v_mfma_f32_16x16x32_bf16 v[218:221], v[78:81], a[248:251], v[218:221]
    v_and_b32 v141, 0xffff0000, v43
    v_mfma_f32_16x16x32_bf16 v[238:241], v[78:81], a[252:255], v[238:241]
    v_lshlrev_b32 v160, 16, v29
    v_mfma_f32_16x16x32_bf16 v[238:241], v[58:61], a[236:239], v[238:241]
    v_and_b32 v161, 0xffff0000, v29
    v_mfma_f32_16x16x32_bf16 v[182:185], v[62:65], a[224:227], v[182:185]
    v_lshlrev_b32 v142, 16, v44
    v_mfma_f32_16x16x32_bf16 v[182:185], v[82:85], a[240:243], v[182:185]
    v_and_b32 v143, 0xffff0000, v44
    v_mfma_f32_16x16x32_bf16 v[202:205], v[82:85], a[244:247], v[202:205]
    v_lshlrev_b32 v162, 16, v30
    v_mfma_f32_16x16x32_bf16 v[202:205], v[62:65], a[228:231], v[202:205]
    v_and_b32 v163, 0xffff0000, v30
    v_mfma_f32_16x16x32_bf16 v[222:225], v[62:65], a[232:235], v[222:225]
    v_lshlrev_b32 v144, 16, v45
    v_mfma_f32_16x16x32_bf16 v[222:225], v[82:85], a[248:251], v[222:225]
    v_and_b32 v145, 0xffff0000, v45
    v_mfma_f32_16x16x32_bf16 v[242:245], v[82:85], a[252:255], v[242:245]
    v_lshlrev_b32 v164, 16, v31
    v_mfma_f32_16x16x32_bf16 v[242:245], v[62:65], a[236:239], v[242:245]
    v_and_b32 v165, 0xffff0000, v31
    s_waitcnt vmcnt(1)
    v_mfma_f32_16x16x32_bf16 v[186:189], v[86:89], a[100:103], v[186:189]
    s_waitcnt vmcnt(0)
    v_cmp_ne_u32 vcc, 3, v1
    s_and_b64 vcc, vcc, exec
    s_cbranch_scc1 L_spin_half
L_back_half:
    s_xor_b32 s40, s2, 8
    s_sub_u32 s40, s40, s2
    s_mul_i32 s40, s40, 20480
    v_add_u32 v18, s40, v18
    s_mov_b32 s41, 4096
    buffer_load_dwordx4 v[46:49], v18, s[76:79], 0 offen offset:0 sc1
    buffer_load_dwordx4 v[50:53], v18, s[76:79], 0 offen offset:1024 sc1
    buffer_load_dwordx4 v[54:57], v18, s[76:79], 0 offen offset:2048 sc1
    buffer_load_dwordx4 v[58:61], v18, s[76:79], 0 offen offset:3072 sc1
    buffer_load_dwordx4 v[62:65], v18, s[76:79], s41 offen offset:0 sc1
    v_mfma_f32_16x16x32_bf16 v[186:189], v[106:109], a[116:119], v[186:189]
    v_mfma_f32_16x16x32_bf16 v[190:193], v[110:113], a[116:119], v[190:193]
    v_mfma_f32_16x16x32_bf16 v[190:193], v[90:93], a[100:103], v[190:193]
    v_mfma_f32_16x16x32_bf16 v[194:197], v[94:97], a[100:103], v[194:197]
    v_mfma_f32_16x16x32_bf16 v[194:197], v[114:117], a[116:119], v[194:197]
    v_mfma_f32_16x16x32_bf16 v[198:201], v[118:121], a[116:119], v[198:201]
    v_mfma_f32_16x16x32_bf16 v[198:201], v[98:101], a[100:103], v[198:201]
    v_mfma_f32_16x16x32_bf16 v[202:205], v[102:105], a[100:103], v[202:205]
    v_mfma_f32_16x16x32_bf16 v[202:205], v[122:125], a[116:119], v[202:205]
    ds_write_b128 v8, v[186:189] offset:0
    v_mfma_f32_16x16x32_bf16 v[206:209], v[106:109], a[120:123], v[206:209]
    v_mfma_f32_16x16x32_bf16 v[206:209], v[86:89], a[104:107], v[206:209]
    ds_write_b128 v8, v[190:193] offset:1024
    v_mfma_f32_16x16x32_bf16 v[210:213], v[90:93], a[104:107], v[210:213]
    v_mfma_f32_16x16x32_bf16 v[210:213], v[110:113], a[120:123], v[210:213]
    ds_write_b128 v8, v[194:197] offset:2048
    v_mfma_f32_16x16x32_bf16 v[214:217], v[114:117], a[120:123], v[214:217]
    v_mfma_f32_16x16x32_bf16 v[214:217], v[94:97], a[104:107], v[214:217]
    ds_write_b128 v8, v[198:201] offset:3072
    v_mfma_f32_16x16x32_bf16 v[218:221], v[98:101], a[104:107], v[218:221]
    v_mfma_f32_16x16x32_bf16 v[218:221], v[118:121], a[120:123], v[218:221]
    ds_write_b128 v8, v[202:205] offset:4096
    v_mfma_f32_16x16x32_bf16 v[222:225], v[122:125], a[120:123], v[222:225]
    v_mfma_f32_16x16x32_bf16 v[222:225], v[102:105], a[104:107], v[222:225]
    ds_write_b128 v8, v[206:209] offset:5120
    v_mfma_f32_16x16x32_bf16 v[226:229], v[86:89], a[108:111], v[226:229]
    v_mfma_f32_16x16x32_bf16 v[226:229], v[106:109], a[124:127], v[226:229]
    ds_write_b128 v8, v[210:213] offset:6144
    v_mfma_f32_16x16x32_bf16 v[230:233], v[110:113], a[124:127], v[230:233]
    v_mfma_f32_16x16x32_bf16 v[230:233], v[90:93], a[108:111], v[230:233]
    ds_write_b128 v8, v[214:217] offset:7168
    v_mfma_f32_16x16x32_bf16 v[234:237], v[94:97], a[108:111], v[234:237]
    v_mfma_f32_16x16x32_bf16 v[234:237], v[114:117], a[124:127], v[234:237]
    ds_write_b128 v8, v[218:221] offset:8192
    v_mfma_f32_16x16x32_bf16 v[238:241], v[118:121], a[124:127], v[238:241]
    v_mfma_f32_16x16x32_bf16 v[238:241], v[98:101], a[108:111], v[238:241]
    ds_write_b128 v8, v[222:225] offset:9216
    v_mfma_f32_16x16x32_bf16 v[242:245], v[102:105], a[108:111], v[242:245]
    v_mfma_f32_16x16x32_bf16 v[242:245], v[122:125], a[124:127], v[242:245]
    ds_write_b128 v9, v[226:229] offset:0
    v_mfma_f32_16x16x32_bf16 v[166:169], v[106:109], a[112:115], v[166:169]
    v_mfma_f32_16x16x32_bf16 v[166:169], v[86:89], a[96:99], v[166:169]
    ds_write_b128 v9, v[230:233] offset:1024
    v_mfma_f32_16x16x32_bf16 v[170:173], v[90:93], a[96:99], v[170:173]
    v_mfma_f32_16x16x32_bf16 v[170:173], v[110:113], a[112:115], v[170:173]
    ds_write_b128 v9, v[234:237] offset:2048
    v_mfma_f32_16x16x32_bf16 v[174:177], v[114:117], a[112:115], v[174:177]
    v_mfma_f32_16x16x32_bf16 v[174:177], v[94:97], a[96:99], v[174:177]
    ds_write_b128 v9, v[238:241] offset:3072
    v_mfma_f32_16x16x32_bf16 v[178:181], v[98:101], a[96:99], v[178:181]
    v_mfma_f32_16x16x32_bf16 v[178:181], v[118:121], a[112:115], v[178:181]
    ds_write_b128 v9, v[242:245] offset:4096
    v_mfma_f32_16x16x32_bf16 v[182:185], v[122:125], a[112:115], v[182:185]
    v_mfma_f32_16x16x32_bf16 v[182:185], v[102:105], a[96:99], v[182:185]
    s_waitcnt lgkmcnt(0)
    s_barrier
    ds_read_b128 v[186:189], v5 offset:0
    ds_read_b128 v[190:193], v5 offset:1024
    ds_read_b128 v[194:197], v5 offset:2048
    ds_read_b128 v[198:201], v5 offset:3072
    ds_read_b128 v[202:205], v5 offset:4096
    ds_read_b128 v[206:209], v6 offset:5120
    ds_read_b128 v[210:213], v6 offset:6144
    ds_read_b128 v[214:217], v6 offset:7168
    ds_read_b128 v[218:221], v6 offset:8192
    ds_read_b128 v[222:225], v6 offset:9216
    ds_read_b128 v[226:229], v7 offset:0
    ds_read_b128 v[230:233], v7 offset:1024
    ds_read_b128 v[234:237], v7 offset:2048
    ds_read_b128 v[238:241], v7 offset:3072
    ds_read_b128 v[242:245], v7 offset:4096
    s_waitcnt lgkmcnt(10)
    v_pk_add_f32 v[166:167], v[166:167], v[186:187]
    v_pk_add_f32 v[168:169], v[168:169], v[188:189]
    v_pk_add_f32 v[170:171], v[170:171], v[190:191]
    v_pk_add_f32 v[172:173], v[172:173], v[192:193]
    v_pk_add_f32 v[174:175], v[174:175], v[194:195]
    v_pk_add_f32 v[176:177], v[176:177], v[196:197]
    v_pk_add_f32 v[178:179], v[178:179], v[198:199]
    v_pk_add_f32 v[180:181], v[180:181], v[200:201]
    v_pk_add_f32 v[182:183], v[182:183], v[202:203]
    v_pk_add_f32 v[184:185], v[184:185], v[204:205]
    s_waitcnt lgkmcnt(5)
    v_pk_add_f32 v[166:167], v[166:167], v[206:207]
    v_pk_add_f32 v[168:169], v[168:169], v[208:209]
    v_pk_add_f32 v[170:171], v[170:171], v[210:211]
    v_pk_add_f32 v[172:173], v[172:173], v[212:213]
    v_pk_add_f32 v[174:175], v[174:175], v[214:215]
    v_pk_add_f32 v[176:177], v[176:177], v[216:217]
    v_pk_add_f32 v[178:179], v[178:179], v[218:219]
    v_pk_add_f32 v[180:181], v[180:181], v[220:221]
    v_pk_add_f32 v[182:183], v[182:183], v[222:223]
    v_pk_add_f32 v[184:185], v[184:185], v[224:225]
    s_waitcnt lgkmcnt(0)
    v_pk_add_f32 v[166:167], v[166:167], v[226:227]
    v_pk_add_f32 v[168:169], v[168:169], v[228:229]
    v_pk_add_f32 v[170:171], v[170:171], v[230:231]
    v_pk_add_f32 v[172:173], v[172:173], v[232:233]
    v_pk_add_f32 v[174:175], v[174:175], v[234:235]
    v_pk_add_f32 v[176:177], v[176:177], v[236:237]
    v_pk_add_f32 v[178:179], v[178:179], v[238:239]
    v_pk_add_f32 v[180:181], v[180:181], v[240:241]
    v_pk_add_f32 v[182:183], v[182:183], v[242:243]
    v_pk_add_f32 v[184:185], v[184:185], v[244:245]
    s_waitcnt vmcnt(0)
    v_pk_add_f32 v[166:167], v[166:167], v[46:47]
    v_pk_add_f32 v[168:169], v[168:169], v[48:49]
    v_pk_add_f32 v[170:171], v[170:171], v[50:51]
    v_pk_add_f32 v[172:173], v[172:173], v[52:53]
    v_pk_add_f32 v[174:175], v[174:175], v[54:55]
    v_pk_add_f32 v[176:177], v[176:177], v[56:57]
    v_pk_add_f32 v[178:179], v[178:179], v[58:59]
    v_pk_add_f32 v[180:181], v[180:181], v[60:61]
    v_pk_add_f32 v[182:183], v[182:183], v[62:63]
    v_pk_add_f32 v[184:185], v[184:185], v[64:65]
    v_cvt_pk_bf16_f32 v66, v166, v167
    v_cvt_pk_bf16_f32 v67, v168, v169
    v_cvt_pk_bf16_f32 v68, v170, v171
    v_cvt_pk_bf16_f32 v69, v172, v173
    v_cvt_pk_bf16_f32 v70, v174, v175
    v_cvt_pk_bf16_f32 v71, v176, v177
    v_cvt_pk_bf16_f32 v72, v178, v179
    v_cvt_pk_bf16_f32 v73, v180, v181
    v_cvt_pk_bf16_f32 v74, v182, v183
    v_cvt_pk_bf16_f32 v75, v184, v185
    v_lshlrev_b32 v166, 16, v66
    v_and_b32 v167, 0xffff0000, v66
    v_lshlrev_b32 v168, 16, v67
    v_and_b32 v169, 0xffff0000, v67
    v_lshlrev_b32 v170, 16, v68
    v_and_b32 v171, 0xffff0000, v68
    v_lshlrev_b32 v172, 16, v69
    v_and_b32 v173, 0xffff0000, v69
    v_lshlrev_b32 v174, 16, v70
    v_and_b32 v175, 0xffff0000, v70
    v_lshlrev_b32 v176, 16, v71
    v_and_b32 v177, 0xffff0000, v71
    v_lshlrev_b32 v178, 16, v72
    v_and_b32 v179, 0xffff0000, v72
    v_lshlrev_b32 v180, 16, v73
    v_and_b32 v181, 0xffff0000, v73
    v_lshlrev_b32 v182, 16, v74
    v_and_b32 v183, 0xffff0000, v74
    v_lshlrev_b32 v184, 16, v75
    v_and_b32 v185, 0xffff0000, v75
    v_pk_mul_f32 v[166:167], v[166:167], v[126:127]
    v_pk_mul_f32 v[168:169], v[168:169], v[128:129]
    v_pk_mul_f32 v[170:171], v[170:171], v[130:131]
    v_pk_mul_f32 v[172:173], v[172:173], v[132:133]
    v_pk_mul_f32 v[174:175], v[174:175], v[134:135]
    v_pk_mul_f32 v[176:177], v[176:177], v[136:137]
    v_pk_mul_f32 v[178:179], v[178:179], v[138:139]
    v_pk_mul_f32 v[180:181], v[180:181], v[140:141]
    v_pk_mul_f32 v[182:183], v[182:183], v[142:143]
    v_pk_mul_f32 v[184:185], v[184:185], v[144:145]
    v_cvt_pk_bf16_f32 v66, v166, v167
    v_cvt_pk_bf16_f32 v67, v168, v169
    v_cvt_pk_bf16_f32 v68, v170, v171
    v_cvt_pk_bf16_f32 v69, v172, v173
    v_cvt_pk_bf16_f32 v70, v174, v175
    v_cvt_pk_bf16_f32 v71, v176, v177
    v_cvt_pk_bf16_f32 v72, v178, v179
    v_cvt_pk_bf16_f32 v73, v180, v181
    v_cvt_pk_bf16_f32 v74, v182, v183
    v_cvt_pk_bf16_f32 v75, v184, v185
    v_lshlrev_b32 v166, 16, v66
    v_and_b32 v167, 0xffff0000, v66
    v_lshlrev_b32 v168, 16, v67
    v_and_b32 v169, 0xffff0000, v67
    v_lshlrev_b32 v170, 16, v68
    v_and_b32 v171, 0xffff0000, v68
    v_lshlrev_b32 v172, 16, v69
    v_and_b32 v173, 0xffff0000, v69
    v_lshlrev_b32 v174, 16, v70
    v_and_b32 v175, 0xffff0000, v70
    v_lshlrev_b32 v176, 16, v71
    v_and_b32 v177, 0xffff0000, v71
    v_lshlrev_b32 v178, 16, v72
    v_and_b32 v179, 0xffff0000, v72
    v_lshlrev_b32 v180, 16, v73
    v_and_b32 v181, 0xffff0000, v73
    v_lshlrev_b32 v182, 16, v74
    v_and_b32 v183, 0xffff0000, v74
    v_lshlrev_b32 v184, 16, v75
    v_and_b32 v185, 0xffff0000, v75
    v_pk_add_f32 v[166:167], v[166:167], v[146:147]
    v_pk_add_f32 v[168:169], v[168:169], v[148:149]
    v_pk_add_f32 v[170:171], v[170:171], v[150:151]
    v_pk_add_f32 v[172:173], v[172:173], v[152:153]
    v_pk_add_f32 v[174:175], v[174:175], v[154:155]
    v_pk_add_f32 v[176:177], v[176:177], v[156:157]
    v_pk_add_f32 v[178:179], v[178:179], v[158:159]
    v_pk_add_f32 v[180:181], v[180:181], v[160:161]
    v_pk_add_f32 v[182:183], v[182:183], v[162:163]
    v_pk_add_f32 v[184:185], v[184:185], v[164:165]
    v_cvt_pk_bf16_f32 v66, v166, v167
    v_cvt_pk_bf16_f32 v67, v168, v169
    buffer_store_dwordx2 v[66:67], v34, s[12:15], 0 offen offset:0
    v_cvt_pk_bf16_f32 v68, v170, v171
    v_cvt_pk_bf16_f32 v69, v172, v173
    buffer_store_dwordx2 v[68:69], v34, s[12:15], 0 offen offset:32
    v_cvt_pk_bf16_f32 v70, v174, v175
    v_cvt_pk_bf16_f32 v71, v176, v177
    buffer_store_dwordx2 v[70:71], v34, s[12:15], 0 offen offset:64
    v_cvt_pk_bf16_f32 v72, v178, v179
    v_cvt_pk_bf16_f32 v73, v180, v181
    buffer_store_dwordx2 v[72:73], v34, s[12:15], 0 offen offset:96
    v_cvt_pk_bf16_f32 v74, v182, v183
    v_cvt_pk_bf16_f32 v75, v184, v185
    buffer_store_dwordx2 v[74:75], v34, s[12:15], 0 offen offset:128
L_end:
    s_endpgm
L_slow:
    s_lshl_b32 s40, s5, 12
    v_subrev_u32 v13, s40, v13
    v_subrev_u32 v14, s40, v14
    v_subrev_u32 v15, s40, v15
    v_subrev_u32 v16, s40, v16
    v_subrev_u32 v17, s40, v17
    v_subrev_u32 v18, s40, v18
    s_and_b32 s40, s5, 1
    s_lshr_b32 s41, s5, 1
    s_mul_i32 s41, s41, 3
    s_add_u32 s40, s40, s41
    s_add_u32 s40, s40, 1
    s_lshl_b32 s34, s40, 13
    s_sub_u32 s40, s34, 98304
    v_add_u32 v1, s40, v1
    v_add_u32 v2, s40, v2
    v_add_u32 v3, s40, v3
    v_add_u32 v4, s40, v4
    v_add_u32 v5, s34, v5
    v_add_u32 v6, s34, v6
    v_add_u32 v7, s34, v7
    v_add_u32 v8, s34, v8
    v_add_u32 v9, s34, v9
    v_add_u32 v10, s34, v10
    v_add_u32 v11, s34, v11
    v_add_u32 v12, s34, v12
    v_mov_b32 v212, 0xff800000
    v_mov_b32 v216, 0
    v_mov_b32 v213, 0xff800000
    v_mov_b32 v217, 0
    v_mov_b32 v214, 0xff800000
    v_mov_b32 v218, 0
    v_mov_b32 v215, 0xff800000
    v_mov_b32 v219, 0
    v_accvgpr_write_b32 a0, 0
    v_accvgpr_write_b32 a1, 0
    v_accvgpr_write_b32 a2, 0
    v_accvgpr_write_b32 a3, 0
    v_accvgpr_write_b32 a4, 0
    v_accvgpr_write_b32 a5, 0
    v_accvgpr_write_b32 a6, 0
    v_accvgpr_write_b32 a7, 0
    v_accvgpr_write_b32 a8, 0
    v_accvgpr_write_b32 a9, 0
    v_accvgpr_write_b32 a10, 0
    v_accvgpr_write_b32 a11, 0
    v_accvgpr_write_b32 a12, 0
    v_accvgpr_write_b32 a13, 0
    v_accvgpr_write_b32 a14, 0
    v_accvgpr_write_b32 a15, 0
    v_accvgpr_write_b32 a16, 0
    v_accvgpr_write_b32 a17, 0
    v_accvgpr_write_b32 a18, 0
    v_accvgpr_write_b32 a19, 0
    v_accvgpr_write_b32 a20, 0
    v_accvgpr_write_b32 a21, 0
    v_accvgpr_write_b32 a22, 0
    v_accvgpr_write_b32 a23, 0
    v_accvgpr_write_b32 a24, 0
    v_accvgpr_write_b32 a25, 0
    v_accvgpr_write_b32 a26, 0
    v_accvgpr_write_b32 a27, 0
    v_accvgpr_write_b32 a28, 0
    v_accvgpr_write_b32 a29, 0
    v_accvgpr_write_b32 a30, 0
    v_accvgpr_write_b32 a31, 0
    v_accvgpr_write_b32 a32, 0
    v_accvgpr_write_b32 a33, 0
    v_accvgpr_write_b32 a34, 0
    v_accvgpr_write_b32 a35, 0
    v_accvgpr_write_b32 a36, 0
    v_accvgpr_write_b32 a37, 0
    v_accvgpr_write_b32 a38, 0
    v_accvgpr_write_b32 a39, 0
    v_accvgpr_write_b32 a40, 0
    v_accvgpr_write_b32 a41, 0
    v_accvgpr_write_b32 a42, 0
    v_accvgpr_write_b32 a43, 0
    v_accvgpr_write_b32 a44, 0
    v_accvgpr_write_b32 a45, 0
    v_accvgpr_write_b32 a46, 0
    v_accvgpr_write_b32 a47, 0
    v_accvgpr_write_b32 a48, 0
    v_accvgpr_write_b32 a49, 0
    v_accvgpr_write_b32 a50, 0
    v_accvgpr_write_b32 a51, 0
    v_accvgpr_write_b32 a52, 0
    v_accvgpr_write_b32 a53, 0
    v_accvgpr_write_b32 a54, 0
    v_accvgpr_write_b32 a55, 0
    v_accvgpr_write_b32 a56, 0
    v_accvgpr_write_b32 a57, 0
    v_accvgpr_write_b32 a58, 0
    v_accvgpr_write_b32 a59, 0
    v_accvgpr_write_b32 a60, 0
    v_accvgpr_write_b32 a61, 0
    v_accvgpr_write_b32 a62, 0
    v_accvgpr_write_b32 a63, 0
    v_accvgpr_write_b32 a64, 0
    v_accvgpr_write_b32 a65, 0
    v_accvgpr_write_b32 a66, 0
    v_accvgpr_write_b32 a67, 0
    v_accvgpr_write_b32 a68, 0
    v_accvgpr_write_b32 a69, 0
    v_accvgpr_write_b32 a70, 0
    v_accvgpr_write_b32 a71, 0
    v_accvgpr_write_b32 a72, 0
    v_accvgpr_write_b32 a73, 0
    v_accvgpr_write_b32 a74, 0
    v_accvgpr_write_b32 a75, 0
    v_accvgpr_write_b32 a76, 0
    v_accvgpr_write_b32 a77, 0
    v_accvgpr_write_b32 a78, 0
    v_accvgpr_write_b32 a79, 0
    v_accvgpr_write_b32 a80, 0
    v_accvgpr_write_b32 a81, 0
    v_accvgpr_write_b32 a82, 0
    v_accvgpr_write_b32 a83, 0
    v_accvgpr_write_b32 a84, 0
    v_accvgpr_write_b32 a85, 0
    v_accvgpr_write_b32 a86, 0
    v_accvgpr_write_b32 a87, 0
    v_accvgpr_write_b32 a88, 0
    v_accvgpr_write_b32 a89, 0
    v_accvgpr_write_b32 a90, 0
    v_accvgpr_write_b32 a91, 0
    v_accvgpr_write_b32 a92, 0
    v_accvgpr_write_b32 a93, 0
    v_accvgpr_write_b32 a94, 0
    v_accvgpr_write_b32 a95, 0
    v_accvgpr_write_b32 a96, 0
    v_accvgpr_write_b32 a97, 0
    v_accvgpr_write_b32 a98, 0
    v_accvgpr_write_b32 a99, 0
    v_accvgpr_write_b32 a100, 0
    v_accvgpr_write_b32 a101, 0
    v_accvgpr_write_b32 a102, 0
    v_accvgpr_write_b32 a103, 0
    v_accvgpr_write_b32 a104, 0
    v_accvgpr_write_b32 a105, 0
    v_accvgpr_write_b32 a106, 0
    v_accvgpr_write_b32 a107, 0
    v_accvgpr_write_b32 a108, 0
    v_accvgpr_write_b32 a109, 0
    v_accvgpr_write_b32 a110, 0
    v_accvgpr_write_b32 a111, 0
    v_accvgpr_write_b32 a112, 0
    v_accvgpr_write_b32 a113, 0
    v_accvgpr_write_b32 a114, 0
    v_accvgpr_write_b32 a115, 0
    v_accvgpr_write_b32 a116, 0
    v_accvgpr_write_b32 a117, 0
    v_accvgpr_write_b32 a118, 0
    v_accvgpr_write_b32 a119, 0
    v_accvgpr_write_b32 a120, 0
    v_accvgpr_write_b32 a121, 0
    v_accvgpr_write_b32 a122, 0
    v_accvgpr_write_b32 a123, 0
    v_accvgpr_write_b32 a124, 0
    v_accvgpr_write_b32 a125, 0
    v_accvgpr_write_b32 a126, 0
    v_accvgpr_write_b32 a127, 0
    s_mov_b32 s28, 0
L_slow_loop:
    s_add_u32 m0, s34, 0
    s_add_u32 s40, s28, 0
    buffer_load_dwordx4 v13, s[8:11], s40 offen offset:0 lds
    buffer_load_dwordx4 v14, s[8:11], s40 offen offset:1024 lds
    buffer_load_dwordx4 v15, s[8:11], s40 offen offset:2048 lds
    buffer_load_dwordx4 v16, s[8:11], s40 offen offset:3072 lds
    s_add_u32 m0, s34, 4096
    s_add_u32 s40, s28, 4096
    buffer_load_dwordx4 v13, s[8:11], s40 offen offset:0 lds
    buffer_load_dwordx4 v14, s[8:11], s40 offen offset:1024 lds
    buffer_load_dwordx4 v15, s[8:11], s40 offen offset:2048 lds
    buffer_load_dwordx4 v16, s[8:11], s40 offen offset:3072 lds
    s_waitcnt vmcnt(0)
    ds_read_b128 v[148:151], v1 offset:0
    ds_read_b128 v[152:155], v2 offset:0
    ds_read_b128 v[156:159], v3 offset:0
    ds_read_b128 v[160:163], v4 offset:0
    ds_read_b128 v[164:167], v1 offset:4096
    ds_read_b128 v[168:171], v2 offset:4096
    ds_read_b128 v[172:175], v3 offset:4096
    ds_read_b128 v[176:179], v4 offset:4096
    s_waitcnt lgkmcnt(0)
    s_add_u32 m0, s34, 0
    s_add_u32 s40, s28, 0
    buffer_load_dwordx4 v17, s[12:15], s40 offen offset:0 lds
    buffer_load_dwordx4 v18, s[12:15], s40 offen offset:1024 lds
    buffer_load_dwordx4 v17, s[12:15], s40 offen offset:2048 lds
    buffer_load_dwordx4 v18, s[12:15], s40 offen offset:3072 lds
    s_add_u32 m0, s34, 4096
    s_add_u32 s40, s28, 4096
    buffer_load_dwordx4 v17, s[12:15], s40 offen offset:0 lds
    buffer_load_dwordx4 v18, s[12:15], s40 offen offset:1024 lds
    buffer_load_dwordx4 v17, s[12:15], s40 offen offset:2048 lds
    buffer_load_dwordx4 v18, s[12:15], s40 offen offset:3072 lds
    s_waitcnt vmcnt(0)
    ds_read_b64_tr_b16 v[196:197], v5 offset:0
    ds_read_b64_tr_b16 v[198:199], v5 offset:4096
    ds_read_b64_tr_b16 v[200:201], v6 offset:0
    ds_read_b64_tr_b16 v[202:203], v6 offset:4096
    ds_read_b64_tr_b16 v[204:205], v7 offset:0
    ds_read_b64_tr_b16 v[206:207], v7 offset:4096
    ds_read_b64_tr_b16 v[208:209], v8 offset:0
    ds_read_b64_tr_b16 v[210:211], v8 offset:4096
    ds_read_b64_tr_b16 v[228:229], v9 offset:0
    ds_read_b64_tr_b16 v[230:231], v9 offset:4096
    ds_read_b64_tr_b16 v[232:233], v10 offset:0
    ds_read_b64_tr_b16 v[234:235], v10 offset:4096
    ds_read_b64_tr_b16 v[236:237], v11 offset:0
    ds_read_b64_tr_b16 v[238:239], v11 offset:4096
    ds_read_b64_tr_b16 v[240:241], v12 offset:0
    ds_read_b64_tr_b16 v[242:243], v12 offset:4096
    v_mfma_f32_16x16x32_bf16 v[116:119], v[148:151], v[36:39], 0
    v_mfma_f32_16x16x32_bf16 v[116:119], v[152:155], v[40:43], v[116:119]
    v_mfma_f32_16x16x32_bf16 v[116:119], v[156:159], v[44:47], v[116:119]
    v_mfma_f32_16x16x32_bf16 v[116:119], v[160:163], v[48:51], v[116:119]
    v_mfma_f32_16x16x32_bf16 v[132:135], v[164:167], v[36:39], 0
    v_mfma_f32_16x16x32_bf16 v[132:135], v[168:171], v[40:43], v[132:135]
    v_mfma_f32_16x16x32_bf16 v[132:135], v[172:175], v[44:47], v[132:135]
    v_mfma_f32_16x16x32_bf16 v[132:135], v[176:179], v[48:51], v[132:135]
    v_mfma_f32_16x16x32_bf16 v[120:123], v[160:163], v[64:67], 0
    v_mfma_f32_16x16x32_bf16 v[120:123], v[156:159], v[60:63], v[120:123]
    v_mfma_f32_16x16x32_bf16 v[120:123], v[152:155], v[56:59], v[120:123]
    v_mfma_f32_16x16x32_bf16 v[120:123], v[148:151], v[52:55], v[120:123]
    v_mfma_f32_16x16x32_bf16 v[136:139], v[176:179], v[64:67], 0
    v_mfma_f32_16x16x32_bf16 v[136:139], v[172:175], v[60:63], v[136:139]
    v_mfma_f32_16x16x32_bf16 v[136:139], v[168:171], v[56:59], v[136:139]
    v_mfma_f32_16x16x32_bf16 v[136:139], v[164:167], v[52:55], v[136:139]
    v_mfma_f32_16x16x32_bf16 v[124:127], v[148:151], v[68:71], 0
    v_mfma_f32_16x16x32_bf16 v[124:127], v[152:155], v[72:75], v[124:127]
    v_mfma_f32_16x16x32_bf16 v[124:127], v[156:159], v[76:79], v[124:127]
    v_mfma_f32_16x16x32_bf16 v[124:127], v[160:163], v[80:83], v[124:127]
    v_mfma_f32_16x16x32_bf16 v[140:143], v[164:167], v[68:71], 0
    v_mfma_f32_16x16x32_bf16 v[140:143], v[168:171], v[72:75], v[140:143]
    v_mfma_f32_16x16x32_bf16 v[140:143], v[172:175], v[76:79], v[140:143]
    v_mfma_f32_16x16x32_bf16 v[140:143], v[176:179], v[80:83], v[140:143]
    v_mfma_f32_16x16x32_bf16 v[128:131], v[160:163], v[96:99], 0
    v_mfma_f32_16x16x32_bf16 v[128:131], v[156:159], v[92:95], v[128:131]
    v_mfma_f32_16x16x32_bf16 v[128:131], v[152:155], v[88:91], v[128:131]
    v_mfma_f32_16x16x32_bf16 v[128:131], v[148:151], v[84:87], v[128:131]
    v_mfma_f32_16x16x32_bf16 v[144:147], v[176:179], v[96:99], 0
    v_mfma_f32_16x16x32_bf16 v[144:147], v[172:175], v[92:95], v[144:147]
    v_mfma_f32_16x16x32_bf16 v[144:147], v[168:171], v[88:91], v[144:147]
    v_mfma_f32_16x16x32_bf16 v[144:147], v[164:167], v[84:87], v[144:147]
    s_waitcnt lgkmcnt(0)
    s_nop 7
    v_max3_f32 v224, v116, v117, v118
    v_max3_f32 v224, v224, v119, v132
    v_max3_f32 v224, v224, v133, v134
    v_max3_f32 v224, v224, v135, v212
    v_mov_b32 v225, v224
    s_nop 1
    v_permlane32_swap_b32 v224, v225
    v_max_f32 v224, v224, v225
    v_mov_b32 v225, v224
    s_nop 1
    v_permlane16_swap_b32 v224, v225
    v_max_f32 v224, v224, v225
    v_sub_f32 v220, v212, v224
    v_exp_f32 v220, v220
    v_mov_b32 v212, v224
    v_sub_f32 v116, v116, v224
    v_sub_f32 v117, v117, v224
    v_sub_f32 v118, v118, v224
    v_sub_f32 v119, v119, v224
    v_sub_f32 v132, v132, v224
    v_sub_f32 v133, v133, v224
    v_sub_f32 v134, v134, v224
    v_sub_f32 v135, v135, v224
    v_mul_f32 v216, v216, v220
    v_exp_f32 v116, v116
    v_exp_f32 v117, v117
    v_exp_f32 v118, v118
    v_exp_f32 v119, v119
    v_exp_f32 v132, v132
    v_exp_f32 v133, v133
    v_exp_f32 v134, v134
    v_exp_f32 v135, v135
    v_accvgpr_read_b32 v224, a0
    v_accvgpr_read_b32 v225, a1
    v_accvgpr_read_b32 v226, a2
    v_accvgpr_read_b32 v227, a3
    v_mul_f32 v224, v224, v220
    v_mul_f32 v225, v225, v220
    v_mul_f32 v226, v226, v220
    v_mul_f32 v227, v227, v220
    v_accvgpr_write_b32 a0, v224
    v_accvgpr_write_b32 a1, v225
    v_accvgpr_write_b32 a2, v226
    v_accvgpr_write_b32 a3, v227
    v_accvgpr_read_b32 v224, a16
    v_accvgpr_read_b32 v225, a17
    v_accvgpr_read_b32 v226, a18
    v_accvgpr_read_b32 v227, a19
    v_mul_f32 v224, v224, v220
    v_mul_f32 v225, v225, v220
    v_mul_f32 v226, v226, v220
    v_mul_f32 v227, v227, v220
    v_accvgpr_write_b32 a16, v224
    v_accvgpr_write_b32 a17, v225
    v_accvgpr_write_b32 a18, v226
    v_accvgpr_write_b32 a19, v227
    v_accvgpr_read_b32 v224, a32
    v_accvgpr_read_b32 v225, a33
    v_accvgpr_read_b32 v226, a34
    v_accvgpr_read_b32 v227, a35
    v_mul_f32 v224, v224, v220
    v_mul_f32 v225, v225, v220
    v_mul_f32 v226, v226, v220
    v_mul_f32 v227, v227, v220
    v_accvgpr_write_b32 a32, v224
    v_accvgpr_write_b32 a33, v225
    v_accvgpr_write_b32 a34, v226
    v_accvgpr_write_b32 a35, v227
    v_accvgpr_read_b32 v224, a48
    v_accvgpr_read_b32 v225, a49
    v_accvgpr_read_b32 v226, a50
    v_accvgpr_read_b32 v227, a51
    v_mul_f32 v224, v224, v220
    v_mul_f32 v225, v225, v220
    v_mul_f32 v226, v226, v220
    v_mul_f32 v227, v227, v220
    v_accvgpr_write_b32 a48, v224
    v_accvgpr_write_b32 a49, v225
    v_accvgpr_write_b32 a50, v226
    v_accvgpr_write_b32 a51, v227
    v_accvgpr_read_b32 v224, a64
    v_accvgpr_read_b32 v225, a65
    v_accvgpr_read_b32 v226, a66
    v_accvgpr_read_b32 v227, a67
    v_mul_f32 v224, v224, v220
    v_mul_f32 v225, v225, v220
    v_mul_f32 v226, v226, v220
    v_mul_f32 v227, v227, v220
    v_accvgpr_write_b32 a64, v224
    v_accvgpr_write_b32 a65, v225
    v_accvgpr_write_b32 a66, v226
    v_accvgpr_write_b32 a67, v227
    v_accvgpr_read_b32 v224, a80
    v_accvgpr_read_b32 v225, a81
    v_accvgpr_read_b32 v226, a82
    v_accvgpr_read_b32 v227, a83
    v_mul_f32 v224, v224, v220
    v_mul_f32 v225, v225, v220
    v_mul_f32 v226, v226, v220
    v_mul_f32 v227, v227, v220
    v_accvgpr_write_b32 a80, v224
    v_accvgpr_write_b32 a81, v225
    v_accvgpr_write_b32 a82, v226
    v_accvgpr_write_b32 a83, v227
    v_accvgpr_read_b32 v224, a96
    v_accvgpr_read_b32 v225, a97
    v_accvgpr_read_b32 v226, a98
    v_accvgpr_read_b32 v227, a99
    v_mul_f32 v224, v224, v220
    v_mul_f32 v225, v225, v220
    v_mul_f32 v226, v226, v220
    v_mul_f32 v227, v227, v220
    v_accvgpr_write_b32 a96, v224
    v_accvgpr_write_b32 a97, v225
    v_accvgpr_write_b32 a98, v226
    v_accvgpr_write_b32 a99, v227
    v_accvgpr_read_b32 v224, a112
    v_accvgpr_read_b32 v225, a113
    v_accvgpr_read_b32 v226, a114
    v_accvgpr_read_b32 v227, a115
    v_mul_f32 v224, v224, v220
    v_mul_f32 v225, v225, v220
    v_mul_f32 v226, v226, v220
    v_mul_f32 v227, v227, v220
    v_accvgpr_write_b32 a112, v224
    v_accvgpr_write_b32 a113, v225
    v_accvgpr_write_b32 a114, v226
    v_accvgpr_write_b32 a115, v227
    v_add_f32 v216, v216, v116
    v_add_f32 v216, v216, v117
    v_add_f32 v216, v216, v118
    v_add_f32 v216, v216, v119
    v_add_f32 v216, v216, v132
    v_add_f32 v216, v216, v133
    v_add_f32 v216, v216, v134
    v_add_f32 v216, v216, v135
    v_cvt_pk_bf16_f32 v180, v116, v117
    v_cvt_pk_bf16_f32 v181, v118, v119
    v_cvt_pk_bf16_f32 v182, v132, v133
    v_cvt_pk_bf16_f32 v183, v134, v135
    s_nop 1
    v_mfma_f32_16x16x32_bf16 a[0:3], v[196:199], v[180:183], a[0:3]
    v_mfma_f32_16x16x32_bf16 a[16:19], v[200:203], v[180:183], a[16:19]
    v_mfma_f32_16x16x32_bf16 a[32:35], v[204:207], v[180:183], a[32:35]
    v_mfma_f32_16x16x32_bf16 a[48:51], v[208:211], v[180:183], a[48:51]
    v_mfma_f32_16x16x32_bf16 a[64:67], v[228:231], v[180:183], a[64:67]
    v_mfma_f32_16x16x32_bf16 a[80:83], v[232:235], v[180:183], a[80:83]
    v_mfma_f32_16x16x32_bf16 a[96:99], v[236:239], v[180:183], a[96:99]
    v_mfma_f32_16x16x32_bf16 a[112:115], v[240:243], v[180:183], a[112:115]
    v_max3_f32 v224, v120, v121, v122
    v_max3_f32 v224, v224, v123, v136
    v_max3_f32 v224, v224, v137, v138
    v_max3_f32 v224, v224, v139, v213
    v_mov_b32 v225, v224
    s_nop 1
    v_permlane32_swap_b32 v224, v225
    v_max_f32 v224, v224, v225
    v_mov_b32 v225, v224
    s_nop 1
    v_permlane16_swap_b32 v224, v225
    v_max_f32 v224, v224, v225
    v_sub_f32 v220, v213, v224
    v_exp_f32 v220, v220
    v_mov_b32 v213, v224
    v_sub_f32 v120, v120, v224
    v_sub_f32 v121, v121, v224
    v_sub_f32 v122, v122, v224
    v_sub_f32 v123, v123, v224
    v_sub_f32 v136, v136, v224
    v_sub_f32 v137, v137, v224
    v_sub_f32 v138, v138, v224
    v_sub_f32 v139, v139, v224
    v_mul_f32 v217, v217, v220
    v_exp_f32 v120, v120
    v_exp_f32 v121, v121
    v_exp_f32 v122, v122
    v_exp_f32 v123, v123
    v_exp_f32 v136, v136
    v_exp_f32 v137, v137
    v_exp_f32 v138, v138
    v_exp_f32 v139, v139
    v_accvgpr_read_b32 v224, a4
    v_accvgpr_read_b32 v225, a5
    v_accvgpr_read_b32 v226, a6
    v_accvgpr_read_b32 v227, a7
    v_mul_f32 v224, v224, v220
    v_mul_f32 v225, v225, v220
    v_mul_f32 v226, v226, v220
    v_mul_f32 v227, v227, v220
    v_accvgpr_write_b32 a4, v224
    v_accvgpr_write_b32 a5, v225
    v_accvgpr_write_b32 a6, v226
    v_accvgpr_write_b32 a7, v227
    v_accvgpr_read_b32 v224, a20
    v_accvgpr_read_b32 v225, a21
    v_accvgpr_read_b32 v226, a22
    v_accvgpr_read_b32 v227, a23
    v_mul_f32 v224, v224, v220
    v_mul_f32 v225, v225, v220
    v_mul_f32 v226, v226, v220
    v_mul_f32 v227, v227, v220
    v_accvgpr_write_b32 a20, v224
    v_accvgpr_write_b32 a21, v225
    v_accvgpr_write_b32 a22, v226
    v_accvgpr_write_b32 a23, v227
    v_accvgpr_read_b32 v224, a36
    v_accvgpr_read_b32 v225, a37
    v_accvgpr_read_b32 v226, a38
    v_accvgpr_read_b32 v227, a39
    v_mul_f32 v224, v224, v220
    v_mul_f32 v225, v225, v220
    v_mul_f32 v226, v226, v220
    v_mul_f32 v227, v227, v220
    v_accvgpr_write_b32 a36, v224
    v_accvgpr_write_b32 a37, v225
    v_accvgpr_write_b32 a38, v226
    v_accvgpr_write_b32 a39, v227
    v_accvgpr_read_b32 v224, a52
    v_accvgpr_read_b32 v225, a53
    v_accvgpr_read_b32 v226, a54
    v_accvgpr_read_b32 v227, a55
    v_mul_f32 v224, v224, v220
    v_mul_f32 v225, v225, v220
    v_mul_f32 v226, v226, v220
    v_mul_f32 v227, v227, v220
    v_accvgpr_write_b32 a52, v224
    v_accvgpr_write_b32 a53, v225
    v_accvgpr_write_b32 a54, v226
    v_accvgpr_write_b32 a55, v227
    v_accvgpr_read_b32 v224, a68
    v_accvgpr_read_b32 v225, a69
    v_accvgpr_read_b32 v226, a70
    v_accvgpr_read_b32 v227, a71
    v_mul_f32 v224, v224, v220
    v_mul_f32 v225, v225, v220
    v_mul_f32 v226, v226, v220
    v_mul_f32 v227, v227, v220
    v_accvgpr_write_b32 a68, v224
    v_accvgpr_write_b32 a69, v225
    v_accvgpr_write_b32 a70, v226
    v_accvgpr_write_b32 a71, v227
    v_accvgpr_read_b32 v224, a84
    v_accvgpr_read_b32 v225, a85
    v_accvgpr_read_b32 v226, a86
    v_accvgpr_read_b32 v227, a87
    v_mul_f32 v224, v224, v220
    v_mul_f32 v225, v225, v220
    v_mul_f32 v226, v226, v220
    v_mul_f32 v227, v227, v220
    v_accvgpr_write_b32 a84, v224
    v_accvgpr_write_b32 a85, v225
    v_accvgpr_write_b32 a86, v226
    v_accvgpr_write_b32 a87, v227
    v_accvgpr_read_b32 v224, a100
    v_accvgpr_read_b32 v225, a101
    v_accvgpr_read_b32 v226, a102
    v_accvgpr_read_b32 v227, a103
    v_mul_f32 v224, v224, v220
    v_mul_f32 v225, v225, v220
    v_mul_f32 v226, v226, v220
    v_mul_f32 v227, v227, v220
    v_accvgpr_write_b32 a100, v224
    v_accvgpr_write_b32 a101, v225
    v_accvgpr_write_b32 a102, v226
    v_accvgpr_write_b32 a103, v227
    v_accvgpr_read_b32 v224, a116
    v_accvgpr_read_b32 v225, a117
    v_accvgpr_read_b32 v226, a118
    v_accvgpr_read_b32 v227, a119
    v_mul_f32 v224, v224, v220
    v_mul_f32 v225, v225, v220
    v_mul_f32 v226, v226, v220
    v_mul_f32 v227, v227, v220
    v_accvgpr_write_b32 a116, v224
    v_accvgpr_write_b32 a117, v225
    v_accvgpr_write_b32 a118, v226
    v_accvgpr_write_b32 a119, v227
    v_add_f32 v217, v217, v120
    v_add_f32 v217, v217, v121
    v_add_f32 v217, v217, v122
    v_add_f32 v217, v217, v123
    v_add_f32 v217, v217, v136
    v_add_f32 v217, v217, v137
    v_add_f32 v217, v217, v138
    v_add_f32 v217, v217, v139
    v_cvt_pk_bf16_f32 v184, v120, v121
    v_cvt_pk_bf16_f32 v185, v122, v123
    v_cvt_pk_bf16_f32 v186, v136, v137
    v_cvt_pk_bf16_f32 v187, v138, v139
    s_nop 1
    v_mfma_f32_16x16x32_bf16 a[4:7], v[196:199], v[184:187], a[4:7]
    v_mfma_f32_16x16x32_bf16 a[20:23], v[200:203], v[184:187], a[20:23]
    v_mfma_f32_16x16x32_bf16 a[36:39], v[204:207], v[184:187], a[36:39]
    v_mfma_f32_16x16x32_bf16 a[52:55], v[208:211], v[184:187], a[52:55]
    v_mfma_f32_16x16x32_bf16 a[68:71], v[228:231], v[184:187], a[68:71]
    v_mfma_f32_16x16x32_bf16 a[84:87], v[232:235], v[184:187], a[84:87]
    v_mfma_f32_16x16x32_bf16 a[100:103], v[236:239], v[184:187], a[100:103]
    v_mfma_f32_16x16x32_bf16 a[116:119], v[240:243], v[184:187], a[116:119]
    v_max3_f32 v224, v124, v125, v126
    v_max3_f32 v224, v224, v127, v140
    v_max3_f32 v224, v224, v141, v142
    v_max3_f32 v224, v224, v143, v214
    v_mov_b32 v225, v224
    s_nop 1
    v_permlane32_swap_b32 v224, v225
    v_max_f32 v224, v224, v225
    v_mov_b32 v225, v224
    s_nop 1
    v_permlane16_swap_b32 v224, v225
    v_max_f32 v224, v224, v225
    v_sub_f32 v220, v214, v224
    v_exp_f32 v220, v220
    v_mov_b32 v214, v224
    v_sub_f32 v124, v124, v224
    v_sub_f32 v125, v125, v224
    v_sub_f32 v126, v126, v224
    v_sub_f32 v127, v127, v224
    v_sub_f32 v140, v140, v224
    v_sub_f32 v141, v141, v224
    v_sub_f32 v142, v142, v224
    v_sub_f32 v143, v143, v224
    v_mul_f32 v218, v218, v220
    v_exp_f32 v124, v124
    v_exp_f32 v125, v125
    v_exp_f32 v126, v126
    v_exp_f32 v127, v127
    v_exp_f32 v140, v140
    v_exp_f32 v141, v141
    v_exp_f32 v142, v142
    v_exp_f32 v143, v143
    v_accvgpr_read_b32 v224, a8
    v_accvgpr_read_b32 v225, a9
    v_accvgpr_read_b32 v226, a10
    v_accvgpr_read_b32 v227, a11
    v_mul_f32 v224, v224, v220
    v_mul_f32 v225, v225, v220
    v_mul_f32 v226, v226, v220
    v_mul_f32 v227, v227, v220
    v_accvgpr_write_b32 a8, v224
    v_accvgpr_write_b32 a9, v225
    v_accvgpr_write_b32 a10, v226
    v_accvgpr_write_b32 a11, v227
    v_accvgpr_read_b32 v224, a24
    v_accvgpr_read_b32 v225, a25
    v_accvgpr_read_b32 v226, a26
    v_accvgpr_read_b32 v227, a27
    v_mul_f32 v224, v224, v220
    v_mul_f32 v225, v225, v220
    v_mul_f32 v226, v226, v220
    v_mul_f32 v227, v227, v220
    v_accvgpr_write_b32 a24, v224
    v_accvgpr_write_b32 a25, v225
    v_accvgpr_write_b32 a26, v226
    v_accvgpr_write_b32 a27, v227
    v_accvgpr_read_b32 v224, a40
    v_accvgpr_read_b32 v225, a41
    v_accvgpr_read_b32 v226, a42
    v_accvgpr_read_b32 v227, a43
    v_mul_f32 v224, v224, v220
    v_mul_f32 v225, v225, v220
    v_mul_f32 v226, v226, v220
    v_mul_f32 v227, v227, v220
    v_accvgpr_write_b32 a40, v224
    v_accvgpr_write_b32 a41, v225
    v_accvgpr_write_b32 a42, v226
    v_accvgpr_write_b32 a43, v227
    v_accvgpr_read_b32 v224, a56
    v_accvgpr_read_b32 v225, a57
    v_accvgpr_read_b32 v226, a58
    v_accvgpr_read_b32 v227, a59
    v_mul_f32 v224, v224, v220
    v_mul_f32 v225, v225, v220
    v_mul_f32 v226, v226, v220
    v_mul_f32 v227, v227, v220
    v_accvgpr_write_b32 a56, v224
    v_accvgpr_write_b32 a57, v225
    v_accvgpr_write_b32 a58, v226
    v_accvgpr_write_b32 a59, v227
    v_accvgpr_read_b32 v224, a72
    v_accvgpr_read_b32 v225, a73
    v_accvgpr_read_b32 v226, a74
    v_accvgpr_read_b32 v227, a75
    v_mul_f32 v224, v224, v220
    v_mul_f32 v225, v225, v220
    v_mul_f32 v226, v226, v220
    v_mul_f32 v227, v227, v220
    v_accvgpr_write_b32 a72, v224
    v_accvgpr_write_b32 a73, v225
    v_accvgpr_write_b32 a74, v226
    v_accvgpr_write_b32 a75, v227
    v_accvgpr_read_b32 v224, a88
    v_accvgpr_read_b32 v225, a89
    v_accvgpr_read_b32 v226, a90
    v_accvgpr_read_b32 v227, a91
    v_mul_f32 v224, v224, v220
    v_mul_f32 v225, v225, v220
    v_mul_f32 v226, v226, v220
    v_mul_f32 v227, v227, v220
    v_accvgpr_write_b32 a88, v224
    v_accvgpr_write_b32 a89, v225
    v_accvgpr_write_b32 a90, v226
    v_accvgpr_write_b32 a91, v227
    v_accvgpr_read_b32 v224, a104
    v_accvgpr_read_b32 v225, a105
    v_accvgpr_read_b32 v226, a106
    v_accvgpr_read_b32 v227, a107
    v_mul_f32 v224, v224, v220
    v_mul_f32 v225, v225, v220
    v_mul_f32 v226, v226, v220
    v_mul_f32 v227, v227, v220
    v_accvgpr_write_b32 a104, v224
    v_accvgpr_write_b32 a105, v225
    v_accvgpr_write_b32 a106, v226
    v_accvgpr_write_b32 a107, v227
    v_accvgpr_read_b32 v224, a120
    v_accvgpr_read_b32 v225, a121
    v_accvgpr_read_b32 v226, a122
    v_accvgpr_read_b32 v227, a123
    v_mul_f32 v224, v224, v220
    v_mul_f32 v225, v225, v220
    v_mul_f32 v226, v226, v220
    v_mul_f32 v227, v227, v220
    v_accvgpr_write_b32 a120, v224
    v_accvgpr_write_b32 a121, v225
    v_accvgpr_write_b32 a122, v226
    v_accvgpr_write_b32 a123, v227
    v_add_f32 v218, v218, v124
    v_add_f32 v218, v218, v125
    v_add_f32 v218, v218, v126
    v_add_f32 v218, v218, v127
    v_add_f32 v218, v218, v140
    v_add_f32 v218, v218, v141
    v_add_f32 v218, v218, v142
    v_add_f32 v218, v218, v143
    v_cvt_pk_bf16_f32 v188, v124, v125
    v_cvt_pk_bf16_f32 v189, v126, v127
    v_cvt_pk_bf16_f32 v190, v140, v141
    v_cvt_pk_bf16_f32 v191, v142, v143
    s_nop 1
    v_mfma_f32_16x16x32_bf16 a[8:11], v[196:199], v[188:191], a[8:11]
    v_mfma_f32_16x16x32_bf16 a[24:27], v[200:203], v[188:191], a[24:27]
    v_mfma_f32_16x16x32_bf16 a[40:43], v[204:207], v[188:191], a[40:43]
    v_mfma_f32_16x16x32_bf16 a[56:59], v[208:211], v[188:191], a[56:59]
    v_mfma_f32_16x16x32_bf16 a[72:75], v[228:231], v[188:191], a[72:75]
    v_mfma_f32_16x16x32_bf16 a[88:91], v[232:235], v[188:191], a[88:91]
    v_mfma_f32_16x16x32_bf16 a[104:107], v[236:239], v[188:191], a[104:107]
    v_mfma_f32_16x16x32_bf16 a[120:123], v[240:243], v[188:191], a[120:123]
    v_max3_f32 v224, v128, v129, v130
    v_max3_f32 v224, v224, v131, v144
    v_max3_f32 v224, v224, v145, v146
    v_max3_f32 v224, v224, v147, v215
    v_mov_b32 v225, v224
    s_nop 1
    v_permlane32_swap_b32 v224, v225
    v_max_f32 v224, v224, v225
    v_mov_b32 v225, v224
    s_nop 1
    v_permlane16_swap_b32 v224, v225
    v_max_f32 v224, v224, v225
    v_sub_f32 v220, v215, v224
    v_exp_f32 v220, v220
    v_mov_b32 v215, v224
    v_sub_f32 v128, v128, v224
    v_sub_f32 v129, v129, v224
    v_sub_f32 v130, v130, v224
    v_sub_f32 v131, v131, v224
    v_sub_f32 v144, v144, v224
    v_sub_f32 v145, v145, v224
    v_sub_f32 v146, v146, v224
    v_sub_f32 v147, v147, v224
    v_mul_f32 v219, v219, v220
    v_exp_f32 v128, v128
    v_exp_f32 v129, v129
    v_exp_f32 v130, v130
    v_exp_f32 v131, v131
    v_exp_f32 v144, v144
    v_exp_f32 v145, v145
    v_exp_f32 v146, v146
    v_exp_f32 v147, v147
    v_accvgpr_read_b32 v224, a12
    v_accvgpr_read_b32 v225, a13
    v_accvgpr_read_b32 v226, a14
    v_accvgpr_read_b32 v227, a15
    v_mul_f32 v224, v224, v220
    v_mul_f32 v225, v225, v220
    v_mul_f32 v226, v226, v220
    v_mul_f32 v227, v227, v220
    v_accvgpr_write_b32 a12, v224
    v_accvgpr_write_b32 a13, v225
    v_accvgpr_write_b32 a14, v226
    v_accvgpr_write_b32 a15, v227
    v_accvgpr_read_b32 v224, a28
    v_accvgpr_read_b32 v225, a29
    v_accvgpr_read_b32 v226, a30
    v_accvgpr_read_b32 v227, a31
    v_mul_f32 v224, v224, v220
    v_mul_f32 v225, v225, v220
    v_mul_f32 v226, v226, v220
    v_mul_f32 v227, v227, v220
    v_accvgpr_write_b32 a28, v224
    v_accvgpr_write_b32 a29, v225
    v_accvgpr_write_b32 a30, v226
    v_accvgpr_write_b32 a31, v227
    v_accvgpr_read_b32 v224, a44
    v_accvgpr_read_b32 v225, a45
    v_accvgpr_read_b32 v226, a46
    v_accvgpr_read_b32 v227, a47
    v_mul_f32 v224, v224, v220
    v_mul_f32 v225, v225, v220
    v_mul_f32 v226, v226, v220
    v_mul_f32 v227, v227, v220
    v_accvgpr_write_b32 a44, v224
    v_accvgpr_write_b32 a45, v225
    v_accvgpr_write_b32 a46, v226
    v_accvgpr_write_b32 a47, v227
    v_accvgpr_read_b32 v224, a60
    v_accvgpr_read_b32 v225, a61
    v_accvgpr_read_b32 v226, a62
    v_accvgpr_read_b32 v227, a63
    v_mul_f32 v224, v224, v220
    v_mul_f32 v225, v225, v220
    v_mul_f32 v226, v226, v220
    v_mul_f32 v227, v227, v220
    v_accvgpr_write_b32 a60, v224
    v_accvgpr_write_b32 a61, v225
    v_accvgpr_write_b32 a62, v226
    v_accvgpr_write_b32 a63, v227
    v_accvgpr_read_b32 v224, a76
    v_accvgpr_read_b32 v225, a77
    v_accvgpr_read_b32 v226, a78
    v_accvgpr_read_b32 v227, a79
    v_mul_f32 v224, v224, v220
    v_mul_f32 v225, v225, v220
    v_mul_f32 v226, v226, v220
    v_mul_f32 v227, v227, v220
    v_accvgpr_write_b32 a76, v224
    v_accvgpr_write_b32 a77, v225
    v_accvgpr_write_b32 a78, v226
    v_accvgpr_write_b32 a79, v227
    v_accvgpr_read_b32 v224, a92
    v_accvgpr_read_b32 v225, a93
    v_accvgpr_read_b32 v226, a94
    v_accvgpr_read_b32 v227, a95
    v_mul_f32 v224, v224, v220
    v_mul_f32 v225, v225, v220
    v_mul_f32 v226, v226, v220
    v_mul_f32 v227, v227, v220
    v_accvgpr_write_b32 a92, v224
    v_accvgpr_write_b32 a93, v225
    v_accvgpr_write_b32 a94, v226
    v_accvgpr_write_b32 a95, v227
    v_accvgpr_read_b32 v224, a108
    v_accvgpr_read_b32 v225, a109
    v_accvgpr_read_b32 v226, a110
    v_accvgpr_read_b32 v227, a111
    v_mul_f32 v224, v224, v220
    v_mul_f32 v225, v225, v220
    v_mul_f32 v226, v226, v220
    v_mul_f32 v227, v227, v220
    v_accvgpr_write_b32 a108, v224
    v_accvgpr_write_b32 a109, v225
    v_accvgpr_write_b32 a110, v226
    v_accvgpr_write_b32 a111, v227
    v_accvgpr_read_b32 v224, a124
    v_accvgpr_read_b32 v225, a125
    v_accvgpr_read_b32 v226, a126
    v_accvgpr_read_b32 v227, a127
    v_mul_f32 v224, v224, v220
    v_mul_f32 v225, v225, v220
    v_mul_f32 v226, v226, v220
    v_mul_f32 v227, v227, v220
    v_accvgpr_write_b32 a124, v224
    v_accvgpr_write_b32 a125, v225
    v_accvgpr_write_b32 a126, v226
    v_accvgpr_write_b32 a127, v227
    v_add_f32 v219, v219, v128
    v_add_f32 v219, v219, v129
    v_add_f32 v219, v219, v130
    v_add_f32 v219, v219, v131
    v_add_f32 v219, v219, v144
    v_add_f32 v219, v219, v145
    v_add_f32 v219, v219, v146
    v_add_f32 v219, v219, v147
    v_cvt_pk_bf16_f32 v192, v128, v129
    v_cvt_pk_bf16_f32 v193, v130, v131
    v_cvt_pk_bf16_f32 v194, v144, v145
    v_cvt_pk_bf16_f32 v195, v146, v147
    s_nop 1
    v_mfma_f32_16x16x32_bf16 a[12:15], v[196:199], v[192:195], a[12:15]
    v_mfma_f32_16x16x32_bf16 a[28:31], v[200:203], v[192:195], a[28:31]
    v_mfma_f32_16x16x32_bf16 a[44:47], v[204:207], v[192:195], a[44:47]
    v_mfma_f32_16x16x32_bf16 a[60:63], v[208:211], v[192:195], a[60:63]
    v_mfma_f32_16x16x32_bf16 a[76:79], v[228:231], v[192:195], a[76:79]
    v_mfma_f32_16x16x32_bf16 a[92:95], v[232:235], v[192:195], a[92:95]
    v_mfma_f32_16x16x32_bf16 a[108:111], v[236:239], v[192:195], a[108:111]
    v_mfma_f32_16x16x32_bf16 a[124:127], v[240:243], v[192:195], a[124:127]
    s_add_u32 s28, s28, 8192
    s_cmp_lt_u32 s28, 524288
    s_cbranch_scc1 L_slow_loop
    v_mov_b32 v224, v216
    s_nop 1
    v_permlane32_swap_b32 v216, v224
    v_add_f32 v216, v216, v224
    v_mov_b32 v224, v216
    s_nop 1
    v_permlane16_swap_b32 v216, v224
    v_add_f32 v216, v216, v224
    v_rcp_f32 v100, v216
    v_mov_b32 v224, v217
    s_nop 1
    v_permlane32_swap_b32 v217, v224
    v_add_f32 v217, v217, v224
    v_mov_b32 v224, v217
    s_nop 1
    v_permlane16_swap_b32 v217, v224
    v_add_f32 v217, v217, v224
    v_rcp_f32 v101, v217
    v_mov_b32 v224, v218
    s_nop 1
    v_permlane32_swap_b32 v218, v224
    v_add_f32 v218, v218, v224
    v_mov_b32 v224, v218
    s_nop 1
    v_permlane16_swap_b32 v218, v224
    v_add_f32 v218, v218, v224
    v_rcp_f32 v102, v218
    v_mov_b32 v224, v219
    s_nop 1
    v_permlane32_swap_b32 v219, v224
    v_add_f32 v219, v219, v224
    v_mov_b32 v224, v219
    s_nop 1
    v_permlane16_swap_b32 v219, v224
    v_add_f32 v219, v219, v224
    v_rcp_f32 v103, v219
    s_mov_b32 s36, 0
    v_accvgpr_read_b32 v120, a0
    v_accvgpr_read_b32 v121, a1
    v_accvgpr_read_b32 v122, a2
    v_accvgpr_read_b32 v123, a3
    v_accvgpr_read_b32 v124, a16
    v_accvgpr_read_b32 v125, a17
    v_accvgpr_read_b32 v126, a18
    v_accvgpr_read_b32 v127, a19
    v_mul_f32 v120, v120, v100
    v_mul_f32 v121, v121, v100
    v_mul_f32 v122, v122, v100
    v_mul_f32 v123, v123, v100
    v_mul_f32 v124, v124, v100
    v_mul_f32 v125, v125, v100
    v_mul_f32 v126, v126, v100
    v_mul_f32 v127, v127, v100
    v_cvt_pk_bf16_f32 v152, v120, v121
    v_cvt_pk_bf16_f32 v153, v122, v123
    v_cvt_pk_bf16_f32 v154, v124, v125
    v_cvt_pk_bf16_f32 v155, v126, v127
    buffer_store_dwordx4 v[152:155], v110, s[24:27], s36 offen offset:0 sc1
    v_accvgpr_read_b32 v128, a4
    v_accvgpr_read_b32 v129, a5
    v_accvgpr_read_b32 v130, a6
    v_accvgpr_read_b32 v131, a7
    v_accvgpr_read_b32 v132, a20
    v_accvgpr_read_b32 v133, a21
    v_accvgpr_read_b32 v134, a22
    v_accvgpr_read_b32 v135, a23
    v_mul_f32 v128, v128, v101
    v_mul_f32 v129, v129, v101
    v_mul_f32 v130, v130, v101
    v_mul_f32 v131, v131, v101
    v_mul_f32 v132, v132, v101
    v_mul_f32 v133, v133, v101
    v_mul_f32 v134, v134, v101
    v_mul_f32 v135, v135, v101
    v_cvt_pk_bf16_f32 v156, v128, v129
    v_cvt_pk_bf16_f32 v157, v130, v131
    v_cvt_pk_bf16_f32 v158, v132, v133
    v_cvt_pk_bf16_f32 v159, v134, v135
    buffer_store_dwordx4 v[156:159], v110, s[24:27], s36 offen offset:1024 sc1
    v_accvgpr_read_b32 v136, a8
    v_accvgpr_read_b32 v137, a9
    v_accvgpr_read_b32 v138, a10
    v_accvgpr_read_b32 v139, a11
    v_accvgpr_read_b32 v140, a24
    v_accvgpr_read_b32 v141, a25
    v_accvgpr_read_b32 v142, a26
    v_accvgpr_read_b32 v143, a27
    v_mul_f32 v136, v136, v102
    v_mul_f32 v137, v137, v102
    v_mul_f32 v138, v138, v102
    v_mul_f32 v139, v139, v102
    v_mul_f32 v140, v140, v102
    v_mul_f32 v141, v141, v102
    v_mul_f32 v142, v142, v102
    v_mul_f32 v143, v143, v102
    v_cvt_pk_bf16_f32 v160, v136, v137
    v_cvt_pk_bf16_f32 v161, v138, v139
    v_cvt_pk_bf16_f32 v162, v140, v141
    v_cvt_pk_bf16_f32 v163, v142, v143
    buffer_store_dwordx4 v[160:163], v110, s[24:27], s36 offen offset:2048 sc1
    v_accvgpr_read_b32 v144, a12
    v_accvgpr_read_b32 v145, a13
    v_accvgpr_read_b32 v146, a14
    v_accvgpr_read_b32 v147, a15
    v_accvgpr_read_b32 v148, a28
    v_accvgpr_read_b32 v149, a29
    v_accvgpr_read_b32 v150, a30
    v_accvgpr_read_b32 v151, a31
    v_mul_f32 v144, v144, v103
    v_mul_f32 v145, v145, v103
    v_mul_f32 v146, v146, v103
    v_mul_f32 v147, v147, v103
    v_mul_f32 v148, v148, v103
    v_mul_f32 v149, v149, v103
    v_mul_f32 v150, v150, v103
    v_mul_f32 v151, v151, v103
    v_cvt_pk_bf16_f32 v164, v144, v145
    v_cvt_pk_bf16_f32 v165, v146, v147
    v_cvt_pk_bf16_f32 v166, v148, v149
    v_cvt_pk_bf16_f32 v167, v150, v151
    buffer_store_dwordx4 v[164:167], v110, s[24:27], s36 offen offset:3072 sc1
    s_mov_b32 s36, 4096
    v_accvgpr_read_b32 v120, a32
    v_accvgpr_read_b32 v121, a33
    v_accvgpr_read_b32 v122, a34
    v_accvgpr_read_b32 v123, a35
    v_accvgpr_read_b32 v124, a48
    v_accvgpr_read_b32 v125, a49
    v_accvgpr_read_b32 v126, a50
    v_accvgpr_read_b32 v127, a51
    v_mul_f32 v120, v120, v100
    v_mul_f32 v121, v121, v100
    v_mul_f32 v122, v122, v100
    v_mul_f32 v123, v123, v100
    v_mul_f32 v124, v124, v100
    v_mul_f32 v125, v125, v100
    v_mul_f32 v126, v126, v100
    v_mul_f32 v127, v127, v100
    v_cvt_pk_bf16_f32 v152, v120, v121
    v_cvt_pk_bf16_f32 v153, v122, v123
    v_cvt_pk_bf16_f32 v154, v124, v125
    v_cvt_pk_bf16_f32 v155, v126, v127
    buffer_store_dwordx4 v[152:155], v110, s[24:27], s36 offen offset:0 sc1
    v_accvgpr_read_b32 v128, a36
    v_accvgpr_read_b32 v129, a37
    v_accvgpr_read_b32 v130, a38
    v_accvgpr_read_b32 v131, a39
    v_accvgpr_read_b32 v132, a52
    v_accvgpr_read_b32 v133, a53
    v_accvgpr_read_b32 v134, a54
    v_accvgpr_read_b32 v135, a55
    v_mul_f32 v128, v128, v101
    v_mul_f32 v129, v129, v101
    v_mul_f32 v130, v130, v101
    v_mul_f32 v131, v131, v101
    v_mul_f32 v132, v132, v101
    v_mul_f32 v133, v133, v101
    v_mul_f32 v134, v134, v101
    v_mul_f32 v135, v135, v101
    v_cvt_pk_bf16_f32 v156, v128, v129
    v_cvt_pk_bf16_f32 v157, v130, v131
    v_cvt_pk_bf16_f32 v158, v132, v133
    v_cvt_pk_bf16_f32 v159, v134, v135
    buffer_store_dwordx4 v[156:159], v110, s[24:27], s36 offen offset:1024 sc1
    v_accvgpr_read_b32 v136, a40
    v_accvgpr_read_b32 v137, a41
    v_accvgpr_read_b32 v138, a42
    v_accvgpr_read_b32 v139, a43
    v_accvgpr_read_b32 v140, a56
    v_accvgpr_read_b32 v141, a57
    v_accvgpr_read_b32 v142, a58
    v_accvgpr_read_b32 v143, a59
    v_mul_f32 v136, v136, v102
    v_mul_f32 v137, v137, v102
    v_mul_f32 v138, v138, v102
    v_mul_f32 v139, v139, v102
    v_mul_f32 v140, v140, v102
    v_mul_f32 v141, v141, v102
    v_mul_f32 v142, v142, v102
    v_mul_f32 v143, v143, v102
    v_cvt_pk_bf16_f32 v160, v136, v137
    v_cvt_pk_bf16_f32 v161, v138, v139
    v_cvt_pk_bf16_f32 v162, v140, v141
    v_cvt_pk_bf16_f32 v163, v142, v143
    buffer_store_dwordx4 v[160:163], v110, s[24:27], s36 offen offset:2048 sc1
    v_accvgpr_read_b32 v144, a44
    v_accvgpr_read_b32 v145, a45
    v_accvgpr_read_b32 v146, a46
    v_accvgpr_read_b32 v147, a47
    v_accvgpr_read_b32 v148, a60
    v_accvgpr_read_b32 v149, a61
    v_accvgpr_read_b32 v150, a62
    v_accvgpr_read_b32 v151, a63
    v_mul_f32 v144, v144, v103
    v_mul_f32 v145, v145, v103
    v_mul_f32 v146, v146, v103
    v_mul_f32 v147, v147, v103
    v_mul_f32 v148, v148, v103
    v_mul_f32 v149, v149, v103
    v_mul_f32 v150, v150, v103
    v_mul_f32 v151, v151, v103
    v_cvt_pk_bf16_f32 v164, v144, v145
    v_cvt_pk_bf16_f32 v165, v146, v147
    v_cvt_pk_bf16_f32 v166, v148, v149
    v_cvt_pk_bf16_f32 v167, v150, v151
    buffer_store_dwordx4 v[164:167], v110, s[24:27], s36 offen offset:3072 sc1
    s_mov_b32 s36, 8192
    v_accvgpr_read_b32 v120, a64
    v_accvgpr_read_b32 v121, a65
    v_accvgpr_read_b32 v122, a66
    v_accvgpr_read_b32 v123, a67
    v_accvgpr_read_b32 v124, a80
    v_accvgpr_read_b32 v125, a81
    v_accvgpr_read_b32 v126, a82
    v_accvgpr_read_b32 v127, a83
    v_mul_f32 v120, v120, v100
    v_mul_f32 v121, v121, v100
    v_mul_f32 v122, v122, v100
    v_mul_f32 v123, v123, v100
    v_mul_f32 v124, v124, v100
    v_mul_f32 v125, v125, v100
    v_mul_f32 v126, v126, v100
    v_mul_f32 v127, v127, v100
    v_cvt_pk_bf16_f32 v152, v120, v121
    v_cvt_pk_bf16_f32 v153, v122, v123
    v_cvt_pk_bf16_f32 v154, v124, v125
    v_cvt_pk_bf16_f32 v155, v126, v127
    buffer_store_dwordx4 v[152:155], v110, s[24:27], s36 offen offset:0 sc1
    v_accvgpr_read_b32 v128, a68
    v_accvgpr_read_b32 v129, a69
    v_accvgpr_read_b32 v130, a70
    v_accvgpr_read_b32 v131, a71
    v_accvgpr_read_b32 v132, a84
    v_accvgpr_read_b32 v133, a85
    v_accvgpr_read_b32 v134, a86
    v_accvgpr_read_b32 v135, a87
    v_mul_f32 v128, v128, v101
    v_mul_f32 v129, v129, v101
    v_mul_f32 v130, v130, v101
    v_mul_f32 v131, v131, v101
    v_mul_f32 v132, v132, v101
    v_mul_f32 v133, v133, v101
    v_mul_f32 v134, v134, v101
    v_mul_f32 v135, v135, v101
    v_cvt_pk_bf16_f32 v156, v128, v129
    v_cvt_pk_bf16_f32 v157, v130, v131
    v_cvt_pk_bf16_f32 v158, v132, v133
    v_cvt_pk_bf16_f32 v159, v134, v135
    buffer_store_dwordx4 v[156:159], v110, s[24:27], s36 offen offset:1024 sc1
    v_accvgpr_read_b32 v136, a72
    v_accvgpr_read_b32 v137, a73
    v_accvgpr_read_b32 v138, a74
    v_accvgpr_read_b32 v139, a75
    v_accvgpr_read_b32 v140, a88
    v_accvgpr_read_b32 v141, a89
    v_accvgpr_read_b32 v142, a90
    v_accvgpr_read_b32 v143, a91
    v_mul_f32 v136, v136, v102
    v_mul_f32 v137, v137, v102
    v_mul_f32 v138, v138, v102
    v_mul_f32 v139, v139, v102
    v_mul_f32 v140, v140, v102
    v_mul_f32 v141, v141, v102
    v_mul_f32 v142, v142, v102
    v_mul_f32 v143, v143, v102
    v_cvt_pk_bf16_f32 v160, v136, v137
    v_cvt_pk_bf16_f32 v161, v138, v139
    v_cvt_pk_bf16_f32 v162, v140, v141
    v_cvt_pk_bf16_f32 v163, v142, v143
    buffer_store_dwordx4 v[160:163], v110, s[24:27], s36 offen offset:2048 sc1
    v_accvgpr_read_b32 v144, a76
    v_accvgpr_read_b32 v145, a77
    v_accvgpr_read_b32 v146, a78
    v_accvgpr_read_b32 v147, a79
    v_accvgpr_read_b32 v148, a92
    v_accvgpr_read_b32 v149, a93
    v_accvgpr_read_b32 v150, a94
    v_accvgpr_read_b32 v151, a95
    v_mul_f32 v144, v144, v103
    v_mul_f32 v145, v145, v103
    v_mul_f32 v146, v146, v103
    v_mul_f32 v147, v147, v103
    v_mul_f32 v148, v148, v103
    v_mul_f32 v149, v149, v103
    v_mul_f32 v150, v150, v103
    v_mul_f32 v151, v151, v103
    v_cvt_pk_bf16_f32 v164, v144, v145
    v_cvt_pk_bf16_f32 v165, v146, v147
    v_cvt_pk_bf16_f32 v166, v148, v149
    v_cvt_pk_bf16_f32 v167, v150, v151
    buffer_store_dwordx4 v[164:167], v110, s[24:27], s36 offen offset:3072 sc1
    s_mov_b32 s36, 12288
    v_accvgpr_read_b32 v120, a96
    v_accvgpr_read_b32 v121, a97
    v_accvgpr_read_b32 v122, a98
    v_accvgpr_read_b32 v123, a99
    v_accvgpr_read_b32 v124, a112
    v_accvgpr_read_b32 v125, a113
    v_accvgpr_read_b32 v126, a114
    v_accvgpr_read_b32 v127, a115
    v_mul_f32 v120, v120, v100
    v_mul_f32 v121, v121, v100
    v_mul_f32 v122, v122, v100
    v_mul_f32 v123, v123, v100
    v_mul_f32 v124, v124, v100
    v_mul_f32 v125, v125, v100
    v_mul_f32 v126, v126, v100
    v_mul_f32 v127, v127, v100
    v_cvt_pk_bf16_f32 v152, v120, v121
    v_cvt_pk_bf16_f32 v153, v122, v123
    v_cvt_pk_bf16_f32 v154, v124, v125
    v_cvt_pk_bf16_f32 v155, v126, v127
    buffer_store_dwordx4 v[152:155], v110, s[24:27], s36 offen offset:0 sc1
    v_accvgpr_read_b32 v128, a100
    v_accvgpr_read_b32 v129, a101
    v_accvgpr_read_b32 v130, a102
    v_accvgpr_read_b32 v131, a103
    v_accvgpr_read_b32 v132, a116
    v_accvgpr_read_b32 v133, a117
    v_accvgpr_read_b32 v134, a118
    v_accvgpr_read_b32 v135, a119
    v_mul_f32 v128, v128, v101
    v_mul_f32 v129, v129, v101
    v_mul_f32 v130, v130, v101
    v_mul_f32 v131, v131, v101
    v_mul_f32 v132, v132, v101
    v_mul_f32 v133, v133, v101
    v_mul_f32 v134, v134, v101
    v_mul_f32 v135, v135, v101
    v_cvt_pk_bf16_f32 v156, v128, v129
    v_cvt_pk_bf16_f32 v157, v130, v131
    v_cvt_pk_bf16_f32 v158, v132, v133
    v_cvt_pk_bf16_f32 v159, v134, v135
    buffer_store_dwordx4 v[156:159], v110, s[24:27], s36 offen offset:1024 sc1
    v_accvgpr_read_b32 v136, a104
    v_accvgpr_read_b32 v137, a105
    v_accvgpr_read_b32 v138, a106
    v_accvgpr_read_b32 v139, a107
    v_accvgpr_read_b32 v140, a120
    v_accvgpr_read_b32 v141, a121
    v_accvgpr_read_b32 v142, a122
    v_accvgpr_read_b32 v143, a123
    v_mul_f32 v136, v136, v102
    v_mul_f32 v137, v137, v102
    v_mul_f32 v138, v138, v102
    v_mul_f32 v139, v139, v102
    v_mul_f32 v140, v140, v102
    v_mul_f32 v141, v141, v102
    v_mul_f32 v142, v142, v102
    v_mul_f32 v143, v143, v102
    v_cvt_pk_bf16_f32 v160, v136, v137
    v_cvt_pk_bf16_f32 v161, v138, v139
    v_cvt_pk_bf16_f32 v162, v140, v141
    v_cvt_pk_bf16_f32 v163, v142, v143
    buffer_store_dwordx4 v[160:163], v110, s[24:27], s36 offen offset:2048 sc1
    v_accvgpr_read_b32 v144, a108
    v_accvgpr_read_b32 v145, a109
    v_accvgpr_read_b32 v146, a110
    v_accvgpr_read_b32 v147, a111
    v_accvgpr_read_b32 v148, a124
    v_accvgpr_read_b32 v149, a125
    v_accvgpr_read_b32 v150, a126
    v_accvgpr_read_b32 v151, a127
    v_mul_f32 v144, v144, v103
    v_mul_f32 v145, v145, v103
    v_mul_f32 v146, v146, v103
    v_mul_f32 v147, v147, v103
    v_mul_f32 v148, v148, v103
    v_mul_f32 v149, v149, v103
    v_mul_f32 v150, v150, v103
    v_mul_f32 v151, v151, v103
    v_cvt_pk_bf16_f32 v164, v144, v145
    v_cvt_pk_bf16_f32 v165, v146, v147
    v_cvt_pk_bf16_f32 v166, v148, v149
    v_cvt_pk_bf16_f32 v167, v150, v151
    buffer_store_dwordx4 v[164:167], v110, s[24:27], s36 offen offset:3072 sc1
    s_mov_b32 s45, 61440
    buffer_load_dwordx4 a[0:3], v114, s[20:23], s45 offen offset:1024 sc1
    s_mov_b32 s45, 61440
    buffer_load_dwordx4 a[4:7], v114, s[20:23], s45 offen offset:2048 sc1
    s_mov_b32 s45, 61440
    buffer_load_dwordx4 a[8:11], v114, s[20:23], s45 offen offset:3072 sc1
    s_mov_b32 s45, 61440
    buffer_load_dwordx4 a[12:15], v115, s[20:23], s45 offen offset:0 sc1
    s_mov_b32 s45, 81920
    buffer_load_dwordx4 a[16:19], v114, s[20:23], s45 offen offset:0 sc1
    s_mov_b32 s45, 81920
    buffer_load_dwordx4 a[20:23], v114, s[20:23], s45 offen offset:1024 sc1
    s_mov_b32 s45, 81920
    buffer_load_dwordx4 a[24:27], v114, s[20:23], s45 offen offset:2048 sc1
    s_mov_b32 s45, 81920
    buffer_load_dwordx4 a[28:31], v114, s[20:23], s45 offen offset:3072 sc1
    s_mov_b32 s45, 81920
    buffer_load_dwordx4 a[32:35], v115, s[20:23], s45 offen offset:0 sc1
    s_mov_b32 s45, 102400
    buffer_load_dwordx4 a[36:39], v114, s[20:23], s45 offen offset:0 sc1
    s_mov_b32 s45, 102400
    buffer_load_dwordx4 a[40:43], v114, s[20:23], s45 offen offset:1024 sc1
    s_mov_b32 s45, 102400
    buffer_load_dwordx4 a[44:47], v114, s[20:23], s45 offen offset:2048 sc1
    s_mov_b32 s45, 102400
    buffer_load_dwordx4 a[48:51], v114, s[20:23], s45 offen offset:3072 sc1
    s_mov_b32 s45, 102400
    buffer_load_dwordx4 a[52:55], v115, s[20:23], s45 offen offset:0 sc1
    s_mov_b32 s45, 122880
    buffer_load_dwordx4 a[56:59], v114, s[20:23], s45 offen offset:0 sc1
    s_mov_b32 s45, 122880
    buffer_load_dwordx4 a[60:63], v114, s[20:23], s45 offen offset:1024 sc1
    s_mov_b32 s45, 122880
    buffer_load_dwordx4 a[64:67], v114, s[20:23], s45 offen offset:2048 sc1
    s_mov_b32 s45, 122880
    buffer_load_dwordx4 a[68:71], v114, s[20:23], s45 offen offset:3072 sc1
    s_mov_b32 s45, 122880
    buffer_load_dwordx4 a[72:75], v115, s[20:23], s45 offen offset:0 sc1
    s_mov_b32 s45, 143360
    buffer_load_dwordx4 a[76:79], v114, s[20:23], s45 offen offset:0 sc1
    s_mov_b32 s45, 143360
    buffer_load_dwordx4 a[80:83], v114, s[20:23], s45 offen offset:1024 sc1
    s_mov_b32 s45, 143360
    buffer_load_dwordx4 a[84:87], v114, s[20:23], s45 offen offset:2048 sc1
    s_mov_b32 s45, 143360
    buffer_load_dwordx4 a[88:91], v114, s[20:23], s45 offen offset:3072 sc1
    s_mov_b32 s45, 143360
    buffer_load_dwordx4 a[92:95], v115, s[20:23], s45 offen offset:0 sc1
    s_waitcnt vmcnt(0)
    s_branch L_published
L_spin_rows:
    s_mov_b32 s7, 262144
L_retry_rows:
    s_sleep 4
    buffer_load_dword v252, off, s[92:95], s74 sc1
    s_waitcnt vmcnt(0)
    v_cmp_gt_u32 vcc, 32, v252
    s_and_b64 vcc, vcc, exec
    s_cbranch_scc0 L_back_rows
    s_sub_u32 s7, s7, 1
    s_cbranch_scc0 L_retry_rows
    s_branch L_back_rows
L_spin_all:
    s_mov_b32 s7, 262144
L_retry_all:
    s_sleep 4
    buffer_load_dword v252, v253, s[92:95], 0 offen sc1
    s_waitcnt vmcnt(0)
    v_cmp_gt_u32 vcc, 32, v252
    s_and_b64 vcc, vcc, exec
    s_cbranch_scc0 L_back_all
    s_sub_u32 s7, s7, 1
    s_cbranch_scc0 L_retry_all
    s_branch L_back_all
L_rt_keys:
    s_lshl_b32 s40, s5, 13
    s_add_u32 s40, s40, 0x280008
    v_lshlrev_b32 v253, 4, v19
    buffer_load_dword v28, v253, s[76:79], s40 offen offset:0 sc1
    buffer_load_dword v29, v253, s[76:79], s40 offen offset:1024 sc1
    buffer_load_dword v30, v253, s[76:79], s40 offen offset:2048 sc1
    buffer_load_dword v31, v253, s[76:79], s40 offen offset:3072 sc1
    s_add_u32 s40, s40, 4096
    buffer_load_dword v32, v253, s[76:79], s40 offen offset:0 sc1
    buffer_load_dword v33, v253, s[76:79], s40 offen offset:1024 sc1
    buffer_load_dword v34, v253, s[76:79], s40 offen offset:2048 sc1
    buffer_load_dword v35, v253, s[76:79], s40 offen offset:3072 sc1
    s_branch L_rt_back_keys
L_rt_local:
    s_waitcnt vmcnt(11)
    s_mov_b32 s42, -1
    v_sub_u32 v20, s42, v28
    v_sub_u32 v21, s42, v29
    v_sub_u32 v22, s42, v30
    v_min3_u32 v20, v20, v21, v22
    v_sub_u32 v21, s42, v31
    v_sub_u32 v22, s42, v32
    v_min3_u32 v20, v20, v21, v22
    v_sub_u32 v21, s42, v33
    v_sub_u32 v22, s42, v34
    v_min3_u32 v20, v20, v21, v22
    v_sub_u32 v21, s42, v35
    v_min_u32 v20, v20, v21
    s_nop 1
    v_min_u32_dpp v20, v20, v20 row_shr:1 row_mask:0xf bank_mask:0xf
    s_nop 1
    v_min_u32_dpp v20, v20, v20 row_shr:2 row_mask:0xf bank_mask:0xf
    s_nop 1
    v_min_u32_dpp v20, v20, v20 row_shr:4 row_mask:0xf bank_mask:0xf
    s_nop 1
    v_min_u32_dpp v20, v20, v20 row_shr:8 row_mask:0xf bank_mask:0xf
    s_nop 1
    v_min_u32_dpp v20, v20, v20 row_bcast:15 row_mask:0xa bank_mask:0xf
    s_nop 1
    v_min_u32_dpp v20, v20, v20 row_bcast:31 row_mask:0xc bank_mask:0xf
    s_nop 0
    v_readlane_b32 s50, v20, 63
    s_sub_u32 s50, s42, s50
    s_sub_u32 s42, s50, 1
    v_sub_u32 v20, s42, v28
    v_sub_u32 v21, s42, v29
    v_sub_u32 v22, s42, v30
    v_min3_u32 v20, v20, v21, v22
    v_sub_u32 v21, s42, v31
    v_sub_u32 v22, s42, v32
    v_min3_u32 v20, v20, v21, v22
    v_sub_u32 v21, s42, v33
    v_sub_u32 v22, s42, v34
    v_min3_u32 v20, v20, v21, v22
    v_sub_u32 v21, s42, v35
    v_min_u32 v20, v20, v21
    s_nop 1
    v_min_u32_dpp v20, v20, v20 row_shr:1 row_mask:0xf bank_mask:0xf
    s_nop 1
    v_min_u32_dpp v20, v20, v20 row_shr:2 row_mask:0xf bank_mask:0xf
    s_nop 1
    v_min_u32_dpp v20, v20, v20 row_shr:4 row_mask:0xf bank_mask:0xf
    s_nop 1
    v_min_u32_dpp v20, v20, v20 row_shr:8 row_mask:0xf bank_mask:0xf
    s_nop 1
    v_min_u32_dpp v20, v20, v20 row_bcast:15 row_mask:0xa bank_mask:0xf
    s_nop 1
    v_min_u32_dpp v20, v20, v20 row_bcast:31 row_mask:0xc bank_mask:0xf
    s_nop 0
    v_readlane_b32 s51, v20, 63
    s_sub_u32 s51, s42, s51
    s_sub_u32 s42, s51, 1
    v_sub_u32 v20, s42, v28
    v_sub_u32 v21, s42, v29
    v_sub_u32 v22, s42, v30
    v_min3_u32 v20, v20, v21, v22
    v_sub_u32 v21, s42, v31
    v_sub_u32 v22, s42, v32
    v_min3_u32 v20, v20, v21, v22
    v_sub_u32 v21, s42, v33
    v_sub_u32 v22, s42, v34
    v_min3_u32 v20, v20, v21, v22
    v_sub_u32 v21, s42, v35
    v_min_u32 v20, v20, v21
    s_nop 1
    v_min_u32_dpp v20, v20, v20 row_shr:1 row_mask:0xf bank_mask:0xf
    s_nop 1
    v_min_u32_dpp v20, v20, v20 row_shr:2 row_mask:0xf bank_mask:0xf
    s_nop 1
    v_min_u32_dpp v20, v20, v20 row_shr:4 row_mask:0xf bank_mask:0xf
    s_nop 1
    v_min_u32_dpp v20, v20, v20 row_shr:8 row_mask:0xf bank_mask:0xf
    s_nop 1
    v_min_u32_dpp v20, v20, v20 row_bcast:15 row_mask:0xa bank_mask:0xf
    s_nop 1
    v_min_u32_dpp v20, v20, v20 row_bcast:31 row_mask:0xc bank_mask:0xf
    s_nop 0
    v_readlane_b32 s52, v20, 63
    s_sub_u32 s52, s42, s52
    s_sub_u32 s42, s52, 1
    v_sub_u32 v20, s42, v28
    v_sub_u32 v21, s42, v29
    v_sub_u32 v22, s42, v30
    v_min3_u32 v20, v20, v21, v22
    v_sub_u32 v21, s42, v31
    v_sub_u32 v22, s42, v32
    v_min3_u32 v20, v20, v21, v22
    v_sub_u32 v21, s42, v33
    v_sub_u32 v22, s42, v34
    v_min3_u32 v20, v20, v21, v22
    v_sub_u32 v21, s42, v35
    v_min_u32 v20, v20, v21
    s_nop 1
    v_min_u32_dpp v20, v20, v20 row_shr:1 row_mask:0xf bank_mask:0xf
    s_nop 1
    v_min_u32_dpp v20, v20, v20 row_shr:2 row_mask:0xf bank_mask:0xf
    s_nop 1
    v_min_u32_dpp v20, v20, v20 row_shr:4 row_mask:0xf bank_mask:0xf
    s_nop 1
    v_min_u32_dpp v20, v20, v20 row_shr:8 row_mask:0xf bank_mask:0xf
    s_nop 1
    v_min_u32_dpp v20, v20, v20 row_bcast:15 row_mask:0xa bank_mask:0xf
    s_nop 1
    v_min_u32_dpp v20, v20, v20 row_bcast:31 row_mask:0xc bank_mask:0xf
    s_nop 0
    v_readlane_b32 s53, v20, 63
    s_sub_u32 s53, s42, s53
    s_sub_u32 s42, s53, 1
    v_sub_u32 v20, s42, v28
    v_sub_u32 v21, s42, v29
    v_sub_u32 v22, s42, v30
    v_min3_u32 v20, v20, v21, v22
    v_sub_u32 v21, s42, v31
    v_sub_u32 v22, s42, v32
    v_min3_u32 v20, v20, v21, v22
    v_sub_u32 v21, s42, v33
    v_sub_u32 v22, s42, v34
    v_min3_u32 v20, v20, v21, v22
    v_sub_u32 v21, s42, v35
    v_min_u32 v20, v20, v21
    s_nop 1
    v_min_u32_dpp v20, v20, v20 row_shr:1 row_mask:0xf bank_mask:0xf
    s_nop 1
    v_min_u32_dpp v20, v20, v20 row_shr:2 row_mask:0xf bank_mask:0xf
    s_nop 1
    v_min_u32_dpp v20, v20, v20 row_shr:4 row_mask:0xf bank_mask:0xf
    s_nop 1
    v_min_u32_dpp v20, v20, v20 row_shr:8 row_mask:0xf bank_mask:0xf
    s_nop 1
    v_min_u32_dpp v20, v20, v20 row_bcast:15 row_mask:0xa bank_mask:0xf
    s_nop 1
    v_min_u32_dpp v20, v20, v20 row_bcast:31 row_mask:0xc bank_mask:0xf
    s_nop 0
    v_readlane_b32 s54, v20, 63
    s_sub_u32 s54, s42, s54
    s_sub_u32 s42, s54, 1
    v_sub_u32 v20, s42, v28
    v_sub_u32 v21, s42, v29
    v_sub_u32 v22, s42, v30
    v_min3_u32 v20, v20, v21, v22
    v_sub_u32 v21, s42, v31
    v_sub_u32 v22, s42, v32
    v_min3_u32 v20, v20, v21, v22
    v_sub_u32 v21, s42, v33
    v_sub_u32 v22, s42, v34
    v_min3_u32 v20, v20, v21, v22
    v_sub_u32 v21, s42, v35
    v_min_u32 v20, v20, v21
    s_nop 1
    v_min_u32_dpp v20, v20, v20 row_shr:1 row_mask:0xf bank_mask:0xf
    s_nop 1
    v_min_u32_dpp v20, v20, v20 row_shr:2 row_mask:0xf bank_mask:0xf
    s_nop 1
    v_min_u32_dpp v20, v20, v20 row_shr:4 row_mask:0xf bank_mask:0xf
    s_nop 1
    v_min_u32_dpp v20, v20, v20 row_shr:8 row_mask:0xf bank_mask:0xf
    s_nop 1
    v_min_u32_dpp v20, v20, v20 row_bcast:15 row_mask:0xa bank_mask:0xf
    s_nop 1
    v_min_u32_dpp v20, v20, v20 row_bcast:31 row_mask:0xc bank_mask:0xf
    s_nop 0
    v_readlane_b32 s55, v20, 63
    s_sub_u32 s55, s42, s55
    s_sub_u32 s42, s55, 1
    v_sub_u32 v20, s42, v28
    v_sub_u32 v21, s42, v29
    v_sub_u32 v22, s42, v30
    v_min3_u32 v20, v20, v21, v22
    v_sub_u32 v21, s42, v31
    v_sub_u32 v22, s42, v32
    v_min3_u32 v20, v20, v21, v22
    v_sub_u32 v21, s42, v33
    v_sub_u32 v22, s42, v34
    v_min3_u32 v20, v20, v21, v22
    v_sub_u32 v21, s42, v35
    v_min_u32 v20, v20, v21
    s_nop 1
    v_min_u32_dpp v20, v20, v20 row_shr:1 row_mask:0xf bank_mask:0xf
    s_nop 1
    v_min_u32_dpp v20, v20, v20 row_shr:2 row_mask:0xf bank_mask:0xf
    s_nop 1
    v_min_u32_dpp v20, v20, v20 row_shr:4 row_mask:0xf bank_mask:0xf
    s_nop 1
    v_min_u32_dpp v20, v20, v20 row_shr:8 row_mask:0xf bank_mask:0xf
    s_nop 1
    v_min_u32_dpp v20, v20, v20 row_bcast:15 row_mask:0xa bank_mask:0xf
    s_nop 1
    v_min_u32_dpp v20, v20, v20 row_bcast:31 row_mask:0xc bank_mask:0xf
    s_nop 0
    v_readlane_b32 s56, v20, 63
    s_sub_u32 s56, s42, s56
    s_sub_u32 s42, s56, 1
    v_sub_u32 v20, s42, v28
    v_sub_u32 v21, s42, v29
    v_sub_u32 v22, s42, v30
    v_min3_u32 v20, v20, v21, v22
    v_sub_u32 v21, s42, v31
    v_sub_u32 v22, s42, v32
    v_min3_u32 v20, v20, v21, v22
    v_sub_u32 v21, s42, v33
    v_sub_u32 v22, s42, v34
    v_min3_u32 v20, v20, v21, v22
    v_sub_u32 v21, s42, v35
    v_min_u32 v20, v20, v21
    s_nop 1
    v_min_u32_dpp v20, v20, v20 row_shr:1 row_mask:0xf bank_mask:0xf
    s_nop 1
    v_min_u32_dpp v20, v20, v20 row_shr:2 row_mask:0xf bank_mask:0xf
    s_nop 1
    v_min_u32_dpp v20, v20, v20 row_shr:4 row_mask:0xf bank_mask:0xf
    s_nop 1
    v_min_u32_dpp v20, v20, v20 row_shr:8 row_mask:0xf bank_mask:0xf
    s_nop 1
    v_min_u32_dpp v20, v20, v20 row_bcast:15 row_mask:0xa bank_mask:0xf
    s_nop 1
    v_min_u32_dpp v20, v20, v20 row_bcast:31 row_mask:0xc bank_mask:0xf
    s_nop 0
    v_readlane_b32 s57, v20, 63
    s_sub_u32 s57, s42, s57
    s_sub_u32 s42, s57, 1
    v_mov_b32 v20, s50
    v_writelane_b32 v20, s51, 1
    v_writelane_b32 v20, s52, 2
    v_writelane_b32 v20, s53, 3
    v_writelane_b32 v20, s54, 4
    v_writelane_b32 v20, s55, 5
    v_writelane_b32 v20, s56, 6
    v_writelane_b32 v20, s57, 7
    s_lshl_b32 s42, s5, 8
    s_add_u32 s42, s42, 86016
    v_lshl_add_u32 v21, v19, 2, s42
    ds_write_b32 v21, v20
    s_waitcnt lgkmcnt(0)
    s_branch L_rt_back_local
L_rt_merge:
    v_bfe_u32 v21, v19, 3, 2
    v_lshlrev_b32 v21, 8, v21
    v_and_b32 v20, 7, v19
    v_lshl_add_u32 v21, v20, 2, v21
    v_add_u32 v21, 86016, v21
    ds_read_b32 v20, v21
    s_waitcnt lgkmcnt(0)
    s_mov_b32 s42, -1
    v_sub_u32 v21, s42, v20
    s_nop 1
    v_min_u32_dpp v21, v21, v21 row_shr:1 row_mask:0xf bank_mask:0xf
    s_nop 1
    v_min_u32_dpp v21, v21, v21 row_shr:2 row_mask:0xf bank_mask:0xf
    s_nop 1
    v_min_u32_dpp v21, v21, v21 row_shr:4 row_mask:0xf bank_mask:0xf
    s_nop 1
    v_min_u32_dpp v21, v21, v21 row_shr:8 row_mask:0xf bank_mask:0xf
    s_nop 1
    v_min_u32_dpp v21, v21, v21 row_bcast:15 row_mask:0xa bank_mask:0xf
    s_nop 1
    v_min_u32_dpp v21, v21, v21 row_bcast:31 row_mask:0xc bank_mask:0xf
    s_nop 0
    v_readlane_b32 s50, v21, 63
    s_sub_u32 s50, s42, s50
    s_sub_u32 s42, s50, 1
    v_sub_u32 v21, s42, v20
    s_nop 1
    v_min_u32_dpp v21, v21, v21 row_shr:1 row_mask:0xf bank_mask:0xf
    s_nop 1
    v_min_u32_dpp v21, v21, v21 row_shr:2 row_mask:0xf bank_mask:0xf
    s_nop 1
    v_min_u32_dpp v21, v21, v21 row_shr:4 row_mask:0xf bank_mask:0xf
    s_nop 1
    v_min_u32_dpp v21, v21, v21 row_shr:8 row_mask:0xf bank_mask:0xf
    s_nop 1
    v_min_u32_dpp v21, v21, v21 row_bcast:15 row_mask:0xa bank_mask:0xf
    s_nop 1
    v_min_u32_dpp v21, v21, v21 row_bcast:31 row_mask:0xc bank_mask:0xf
    s_nop 0
    v_readlane_b32 s51, v21, 63
    s_sub_u32 s51, s42, s51
    s_sub_u32 s42, s51, 1
    v_sub_u32 v21, s42, v20
    s_nop 1
    v_min_u32_dpp v21, v21, v21 row_shr:1 row_mask:0xf bank_mask:0xf
    s_nop 1
    v_min_u32_dpp v21, v21, v21 row_shr:2 row_mask:0xf bank_mask:0xf
    s_nop 1
    v_min_u32_dpp v21, v21, v21 row_shr:4 row_mask:0xf bank_mask:0xf
    s_nop 1
    v_min_u32_dpp v21, v21, v21 row_shr:8 row_mask:0xf bank_mask:0xf
    s_nop 1
    v_min_u32_dpp v21, v21, v21 row_bcast:15 row_mask:0xa bank_mask:0xf
    s_nop 1
    v_min_u32_dpp v21, v21, v21 row_bcast:31 row_mask:0xc bank_mask:0xf
    s_nop 0
    v_readlane_b32 s52, v21, 63
    s_sub_u32 s52, s42, s52
    s_sub_u32 s42, s52, 1
    v_sub_u32 v21, s42, v20
    s_nop 1
    v_min_u32_dpp v21, v21, v21 row_shr:1 row_mask:0xf bank_mask:0xf
    s_nop 1
    v_min_u32_dpp v21, v21, v21 row_shr:2 row_mask:0xf bank_mask:0xf
    s_nop 1
    v_min_u32_dpp v21, v21, v21 row_shr:4 row_mask:0xf bank_mask:0xf
    s_nop 1
    v_min_u32_dpp v21, v21, v21 row_shr:8 row_mask:0xf bank_mask:0xf
    s_nop 1
    v_min_u32_dpp v21, v21, v21 row_bcast:15 row_mask:0xa bank_mask:0xf
    s_nop 1
    v_min_u32_dpp v21, v21, v21 row_bcast:31 row_mask:0xc bank_mask:0xf
    s_nop 0
    v_readlane_b32 s53, v21, 63
    s_sub_u32 s53, s42, s53
    s_sub_u32 s42, s53, 1
    v_sub_u32 v21, s42, v20
    s_nop 1
    v_min_u32_dpp v21, v21, v21 row_shr:1 row_mask:0xf bank_mask:0xf
    s_nop 1
    v_min_u32_dpp v21, v21, v21 row_shr:2 row_mask:0xf bank_mask:0xf
    s_nop 1
    v_min_u32_dpp v21, v21, v21 row_shr:4 row_mask:0xf bank_mask:0xf
    s_nop 1
    v_min_u32_dpp v21, v21, v21 row_shr:8 row_mask:0xf bank_mask:0xf
    s_nop 1
    v_min_u32_dpp v21, v21, v21 row_bcast:15 row_mask:0xa bank_mask:0xf
    s_nop 1
    v_min_u32_dpp v21, v21, v21 row_bcast:31 row_mask:0xc bank_mask:0xf
    s_nop 0
    v_readlane_b32 s54, v21, 63
    s_sub_u32 s54, s42, s54
    s_sub_u32 s42, s54, 1
    v_sub_u32 v21, s42, v20
    s_nop 1
    v_min_u32_dpp v21, v21, v21 row_shr:1 row_mask:0xf bank_mask:0xf
    s_nop 1
    v_min_u32_dpp v21, v21, v21 row_shr:2 row_mask:0xf bank_mask:0xf
    s_nop 1
    v_min_u32_dpp v21, v21, v21 row_shr:4 row_mask:0xf bank_mask:0xf
    s_nop 1
    v_min_u32_dpp v21, v21, v21 row_shr:8 row_mask:0xf bank_mask:0xf
    s_nop 1
    v_min_u32_dpp v21, v21, v21 row_bcast:15 row_mask:0xa bank_mask:0xf
    s_nop 1
    v_min_u32_dpp v21, v21, v21 row_bcast:31 row_mask:0xc bank_mask:0xf
    s_nop 0
    v_readlane_b32 s55, v21, 63
    s_sub_u32 s55, s42, s55
    s_sub_u32 s42, s55, 1
    v_sub_u32 v21, s42, v20
    s_nop 1
    v_min_u32_dpp v21, v21, v21 row_shr:1 row_mask:0xf bank_mask:0xf
    s_nop 1
    v_min_u32_dpp v21, v21, v21 row_shr:2 row_mask:0xf bank_mask:0xf
    s_nop 1
    v_min_u32_dpp v21, v21, v21 row_shr:4 row_mask:0xf bank_mask:0xf
    s_nop 1
    v_min_u32_dpp v21, v21, v21 row_shr:8 row_mask:0xf bank_mask:0xf
    s_nop 1
    v_min_u32_dpp v21, v21, v21 row_bcast:15 row_mask:0xa bank_mask:0xf
    s_nop 1
    v_min_u32_dpp v21, v21, v21 row_bcast:31 row_mask:0xc bank_mask:0xf
    s_nop 0
    v_readlane_b32 s56, v21, 63
    s_sub_u32 s56, s42, s56
    s_sub_u32 s42, s56, 1
    v_sub_u32 v21, s42, v20
    s_nop 1
    v_min_u32_dpp v21, v21, v21 row_shr:1 row_mask:0xf bank_mask:0xf
    s_nop 1
    v_min_u32_dpp v21, v21, v21 row_shr:2 row_mask:0xf bank_mask:0xf
    s_nop 1
    v_min_u32_dpp v21, v21, v21 row_shr:4 row_mask:0xf bank_mask:0xf
    s_nop 1
    v_min_u32_dpp v21, v21, v21 row_shr:8 row_mask:0xf bank_mask:0xf
    s_nop 1
    v_min_u32_dpp v21, v21, v21 row_bcast:15 row_mask:0xa bank_mask:0xf
    s_nop 1
    v_min_u32_dpp v21, v21, v21 row_bcast:31 row_mask:0xc bank_mask:0xf
    s_nop 0
    v_readlane_b32 s57, v21, 63
    s_sub_u32 s57, s42, s57
    s_sub_u32 s42, s57, 1
    v_mov_b32 v20, s50
    v_writelane_b32 v20, s51, 1
    v_writelane_b32 v20, s52, 2
    v_writelane_b32 v20, s53, 3
    v_writelane_b32 v20, s54, 4
    v_writelane_b32 v20, s55, 5
    v_writelane_b32 v20, s56, 6
    v_writelane_b32 v20, s57, 7
    v_lshlrev_b32 v21, 2, v19
    s_mov_b32 s42, 0x29b000
    s_mov_b64 exec, 0xff
    buffer_store_dword v20, v21, s[76:79], s42 offen sc1
    s_mov_b64 exec, -1
    s_branch L_rt_back_merge
L_site0:
    s_mov_b32 s43, m0
    s_mov_b32 m0, s38
    s_add_u32 s38, s38, 1024
    buffer_load_dwordx4 v24, s[16:19], s37 offen lds
    s_mov_b32 m0, s43
    s_add_u32 s37, s37, 221184
    s_branch L_site_back0
L_site1:
    s_mov_b32 s43, m0
    s_mov_b32 m0, s38
    s_add_u32 s38, s38, 1024
    buffer_load_dwordx4 v24, s[16:19], s37 offen lds
    s_mov_b32 m0, s43
    s_add_u32 s37, s37, 221184
    s_branch L_site_back1
L_site2:
    s_mov_b32 s43, m0
    s_mov_b32 m0, s38
    s_add_u32 s38, s38, 1024
    buffer_load_dwordx4 v24, s[16:19], s37 offen lds
    s_mov_b32 m0, s43
    s_add_u32 s37, s37, 221184
    s_branch L_site_back2
L_site3:
    s_mov_b32 s43, m0
    s_mov_b32 m0, s38
    s_add_u32 s38, s38, 1024
    buffer_load_dwordx4 v24, s[16:19], s37 offen lds
    s_mov_b32 m0, s43
    s_add_u32 s37, s37, 221184
    s_branch L_site_back3
L_spin_sel:
    s_mov_b32 s7, 262144
L_retry_sel:
    s_sleep 4
    buffer_load_dword v249, v21, s[76:79], 0 offen sc1
    s_waitcnt vmcnt(0)
    v_cmp_eq_u32 vcc, 0, v249
    s_and_b64 vcc, vcc, exec
    s_cbranch_scc0 L_back_sel
    s_sub_u32 s7, s7, 1
    s_cbranch_scc0 L_retry_sel
    s_branch L_back_sel
L_spin_ffn:
    s_mov_b32 s7, 262144
L_retry_ffn:
    s_sleep 4
    buffer_load_dwordx4 v[28:31], v32, s[76:79], 0 offen sc1
    s_waitcnt vmcnt(0)
    v_min3_u32 v28, v28, v29, v30
    v_min_u32 v28, v28, v31
    v_cmp_gt_u32 vcc, 1, v28
    s_and_b64 vcc, vcc, exec
    s_cbranch_scc0 L_back_ffn
    s_sub_u32 s7, s7, 1
    s_cbranch_scc0 L_retry_ffn
    s_branch L_back_ffn
L_spin_upd:
    s_mov_b32 s7, 262144
L_retry_upd:
    s_sleep 4
    buffer_load_dwordx2 v[20:21], v11, s[76:79], 0 offen offset:0 sc1
    buffer_load_dwordx2 v[246:247], v11, s[76:79], 0 offen offset:32 sc1
    buffer_load_dwordx2 v[248:249], v11, s[76:79], 0 offen offset:64 sc1
    buffer_load_dwordx2 v[252:253], v11, s[76:79], 0 offen offset:96 sc1
    buffer_load_dwordx2 v[254:255], v11, s[76:79], 0 offen offset:128 sc1
    s_waitcnt vmcnt(0)
    v_max3_u32 v3, v20, v21, v246
    v_max3_u32 v3, v3, v247, v248
    v_max3_u32 v3, v3, v249, v252
    v_max3_u32 v3, v3, v253, v254
    v_max_u32 v3, v3, v255
    v_cmp_eq_u32 vcc, -1, v3
    s_and_b64 vcc, vcc, exec
    s_cbranch_scc0 L_back_upd
    s_sub_u32 s7, s7, 1
    s_cbranch_scc0 L_retry_upd
    s_branch L_back_upd
L_spin_o:
    s_mov_b32 s7, 262144
L_retry_o:
    s_sleep 4
    buffer_load_dwordx4 v[126:129], v1, s[76:79], 0 offen sc1
    s_waitcnt vmcnt(0)
    v_min3_u32 v126, v126, v127, v128
    v_min_u32 v126, v126, v129
    v_cmp_gt_u32 vcc, 1, v126
    s_and_b64 vcc, vcc, exec
    s_cbranch_scc0 L_back_o
    s_sub_u32 s7, s7, 1
    s_cbranch_scc0 L_retry_o
    s_branch L_back_o
L_spin_half:
    s_mov_b32 s7, 262144
L_retry_half:
    s_sleep 4
    buffer_load_dword v1, off, s[76:79], s37 sc1
    s_waitcnt vmcnt(0)
    v_cmp_ne_u32 vcc, 3, v1
    s_and_b64 vcc, vcc, exec
    s_cbranch_scc0 L_back_half
    s_sub_u32 s7, s7, 1
    s_cbranch_scc0 L_retry_half
    s_branch L_back_half
L_code_end:
    s_endpgm

.section .rodata,"a"
.p2align 6
.amdhsa_kernel recurrent_scan__mha_block_cached__moe_arch_mod__prompt_kernel
  .amdhsa_next_free_vgpr 512
  .amdhsa_next_free_sgpr 102
  .amdhsa_accum_offset 256
  .amdhsa_group_segment_fixed_size 0
  .amdhsa_kernarg_size 104
  .amdhsa_user_sgpr_count 2
  .amdhsa_user_sgpr_kernarg_segment_ptr 1
  .amdhsa_system_sgpr_workgroup_id_x 1
  .amdhsa_float_denorm_mode_32 3
.end_amdhsa_kernel
```
